```python
import torch

def _softmax(x, axis=-1):
    return torch.softmax(x, dim=axis)
def _gelu(x):
    return torch.nn.functional.gelu(x, approximate="tanh")
def _silu(x):
    return torch.nn.functional.silu(x)
def _sigmoid(x):
    return torch.sigmoid(x)
def _layernorm(x, axis=-1, eps=1e-5):
    m = x.mean(dim=axis, keepdim=True)
    v = x.var(dim=axis, keepdim=True, unbiased=False)
    return (x - m) / torch.sqrt(v + eps)
def _scatter_add(tgt, idx, src, axis=0):
    return tgt.clone().index_add_(axis, idx, src)
def _segment_sum(src, seg, n):
    out = torch.zeros((n,) + src.shape[1:], dtype=src.dtype)
    return out.index_add_(0, seg, src)
def _pad(x, pw):
    flat = tuple(v for pair in reversed(pw) for v in pair)
    return torch.nn.functional.pad(x, flat)

kernel_name = 'sequential_preLN__sliding_local_dilated__moe_arch_mod__prompt'

def setup_inputs():

    _w = (lambda a: (lambda t: t.to(torch.bfloat16) if t.is_floating_point() else t)(torch.as_tensor(a)))
    def _A_setup():
        B, S, D = 1, 2048, 640
        return {
            "x": _w((lambda *s: torch.randn(*s, dtype=torch.bfloat16) * 0.05)(B, S, D)),
            "wqkv": _w((lambda *s: torch.randn(*s, dtype=torch.bfloat16) * 0.05)(D, 3 * D)),
            "wo": _w((lambda *s: torch.randn(*s, dtype=torch.bfloat16) * 0.05)(D, D)),
        }
    _A_in = _A_setup()

    def _B_setup():
        B, S, D, F, C = 1, 2048, 640, 1536, 1
        return {
            "x": _w((lambda *s: torch.randn(*s, dtype=torch.bfloat16) * 0.05)(B, S, D)),
            "w_r": _w((lambda *s: torch.randn(*s, dtype=torch.bfloat16) * 0.05)(D)),
            "w_gate": _w((lambda *s: torch.randn(*s, dtype=torch.bfloat16) * 0.05)(D, F)),
            "w_up": _w((lambda *s: torch.randn(*s, dtype=torch.bfloat16) * 0.05)(D, F)),
            "w_down": _w((lambda *s: torch.randn(*s, dtype=torch.bfloat16) * 0.05)(F, D)),
        }
    _B_in = _B_setup()

    return {
        "A_x": _A_in["x"],
        "A_wqkv": _A_in["wqkv"],
        "A_wo": _A_in["wo"],
        "B_x": _B_in["x"],
        "B_w_r": _B_in["w_r"],
        "B_w_gate": _B_in["w_gate"],
        "B_w_up": _B_in["w_up"],
        "B_w_down": _B_in["w_down"],
    }

def reference(A_x, A_wqkv, A_wo, B_x, B_w_r, B_w_gate, B_w_up, B_w_down):
    def _A_ref(x, wqkv, wo):
        B, S, D = x.shape
        H = 32; Dh = D // H
        W, dil = 8, 2
        qkv = (lambda x, *d: x.permute(*d))((x @ wqkv).reshape(B, S, 3, H, Dh), 2, 0, 3, 1, 4)
        q, k, v = qkv[0], qkv[1], qkv[2]
        scale = Dh ** -0.5
        pos = torch.arange(S)
        off = torch.arange(W) * dil
        idx = pos[:, None] - off[None, :]
        mask = idx >= 0
        idx_c = torch.where(mask, idx, 0).reshape(-1)
        kg = k[:, :, idx_c, :].reshape(B, H, S, W, Dh)
        vg = v[:, :, idx_c, :].reshape(B, H, S, W, Dh)
        logits = torch.einsum("bhsd,bhswd->bhsw", q, kg) * scale
        logits = torch.where(mask[None, None, :, :], logits, -1e9)
        attn = _softmax(logits, axis=-1)
        o = torch.einsum("bhsw,bhswd->bhsd", attn, vg)
        return (lambda x, *d: x.permute(*d))(o, 0, 2, 1, 3).reshape(B, S, D) @ wo

    def _B_ref(x, w_r, w_gate, w_up, w_down):
        B, S, D = x.shape
        C = 1
        r = x @ w_r
        idx = torch.argsort(-r, axis=-1)[:, :C]
        idx_e = (lambda x, n, axis: torch.repeat_interleave(x, n, dim=axis))(idx.reshape(B, C, 1), D, axis=2)
        x_sel = (lambda x, i, axis: torch.take_along_dim(x, i, dim=axis))(x, idx_e, axis=1)
        g = _silu(x_sel @ w_gate)
        u = x_sel @ w_up
        y = (g * u) @ w_down
        r_sel = _sigmoid((lambda x, i, axis: torch.take_along_dim(x, i, dim=axis))(r, idx, axis=1))
        y = y * r_sel.reshape(B, C, 1)
        b_off = (torch.arange(B) * S).reshape(B, 1)
        flat_idx = (idx + b_off).reshape(B * C)
        zero = (x * 0.0).reshape(B * S, D)
        upd = _scatter_add(zero, flat_idx, y.reshape(B * C, D), axis=0)
        return x + upd.reshape(B, S, D)

    x = A_x
    h = x + _A_ref(_layernorm(x, axis=-1), A_wqkv, A_wo)
    h2 = h + _B_ref(_layernorm(h, axis=-1), B_w_r, B_w_gate, B_w_up, B_w_down)
    return h2
```

```asm
; @launch grid=(256,1,1) block=(512,1,1) lds=163840
.amdgcn_target "amdgcn-amd-amdhsa--gfx950"
.text
.p2align 12
.globl sequential_preLN__sliding_local_dilated__moe_arch_mod__prompt_kernel
.p2align 8
.type sequential_preLN__sliding_local_dilated__moe_arch_mod__prompt_kernel,@function
sequential_preLN__sliding_local_dilated__moe_arch_mod__prompt_kernel:
s_load_dwordx16 s[44:59], s[0:1], 0
s_load_dwordx8 s[60:67], s[0:1], 56
s_lshr_b32 s34, s2, 3
s_and_b32 s33, s2, 7
v_readfirstlane_b32 s32, v0
s_getpc_b64 s[100:101]
s_mul_i32 s3, s34, 9
v_min_u32 v2, 8, v0
v_add_lshl_u32 v2, v2, s3, 7
s_cmp_ge_u32 s34, 30
s_cbranch_scc1 L_moe
global_load_dword v255, v2, s[100:101]
s_mul_i32 s35, s34, 26
s_lshr_b32 s35, s35, 8
s_mul_i32 s3, s35, 10
s_sub_u32 s36, s34, s3
s_lshr_b32 s32, s32, 6
s_add_u32 s3, s36, s33
s_add_u32 s3, s3, 2
s_sub_u32 s68, s3, 10
s_cselect_b32 s69, s3, s68
s_mul_i32 s3, s69, 245760
s_lshl_b32 s68, s36, 7
s_add_u32 s3, s3, s68
v_lshrrev_b32 v1, 3, v0
v_lshrrev_b32 v3, 4, v0
v_and_b32 v2, 2, v1
v_and_or_b32 v2, v3, 4, v2
v_xor_b32 v2, v2, v0
v_and_b32 v2, 7, v2
v_mul_u32_u24 v4, 3840, v1
v_lshl_add_u32 v4, v2, 4, v4
v_add_u32 v4, s3, v4
s_mul_i32 s3, s32, 3072
s_add_u32 m0, s3, 20480
v_and_b32 v0, 63, v0
s_and_b32 s38, s32, 3
s_lshr_b32 s3, s33, 1
s_lshl_b32 s3, s3, 9
s_mul_i32 s68, s35, 176
s_add_u32 s3, s3, s68
s_and_b32 s68, s33, 1
s_add_u32 s3, s3, s68
s_mul_i32 s39, s3, 1280
s_sub_u32 s42, s32, 5
s_mul_i32 s3, s42, 81920
s_add_u32 s3, s3, s39
s_sub_u32 s3, s3, 20480
v_lshrrev_b32 v1, 3, v0
v_lshrrev_b32 v3, 4, v0
v_xor_b32 v3, v3, v0
v_and_b32 v3, 7, v3
v_mul_u32_u24 v1, 2560, v1
v_lshl_add_u32 v1, v3, 4, v1
v_add_u32 v24, s3, v1
s_add_u32 s3, s42, s35
s_cmp_eq_u32 s3, 4
s_cselect_b32 s3, 0x80000000, 0
v_xor_b32 v25, 64, v24
v_add_u32 v25, 20480, v25
v_add_u32 v26, 40960, v24
v_add_u32 v27, 40960, v25
v_or_b32 v27, s3, v27
s_mov_b32 s6, 0x280000
s_mov_b32 s7, 0x20000
s_mov_b32 s10, 0x258000
s_mov_b32 s11, 0x20000
s_mov_b32 s14, 0xc8000
s_mov_b32 s15, 0x20000
s_mov_b32 s18, 0x10000000
s_mov_b32 s19, 0x20000
s_mov_b32 s22, 0x280000
s_mov_b32 s23, 0x20000
s_mov_b32 s26, 0x100
s_mov_b32 s27, 0x20000
s_mov_b32 s30, 0x500
s_mov_b32 s31, 0x20000
s_waitcnt lgkmcnt(0)
global_load_lds_dwordx4 v4, s[46:47]
s_addk_i32 m0, -256
s_mov_b64 s[4:5], s[44:45]
global_load_lds_dwordx4 v4, s[46:47] offset:1280
s_addk_i32 m0, -256
s_mov_b64 s[20:21], s[62:63]
global_load_lds_dwordx4 v4, s[46:47] offset:2560
s_mov_b64 s[24:25], s[64:65]
s_mov_b64 s[16:17], s[66:67]
s_mov_b64 s[8:9], s[46:47]
s_mov_b64 s[12:13], s[48:49]
s_mov_b64 s[28:29], s[52:53]
s_cmp_lt_u32 s32, 5
s_cbranch_scc1 L_nx
s_lshl_b32 s64, s42, 12
s_cselect_b32 s62, -1, 0xffffff00
s_lshl_b32 s63, s69, 7
s_mov_b32 s61, 8192
s_add_u32 m0, s61, s64
s_mov_b32 exec_lo, s62
buffer_load_dwordx4 v24, s[4:7], s63 offen lds
s_addk_i32 m0, 1024
s_mov_b32 exec_lo, -1
buffer_load_dwordx4 v25, s[4:7], s63 offen lds
s_addk_i32 m0, 1024
s_nop 0
buffer_load_dwordx4 v26, s[4:7], s63 offen lds
s_addk_i32 m0, 1024
s_nop 0
buffer_load_dwordx4 v27, s[4:7], s63 offen lds
L_nx:
s_cmp_eq_u32 s32, 4
s_cbranch_scc1 L_h0
s_mov_b32 s40, 524288
s_mul_i32 s43, s33, 3
s_add_u32 s43, s43, s35
s_sub_u32 s3, s36, 5
s_cselect_b32 s37, s36, s3
s_lshl_b32 s3, s32, 2
s_lshr_b32 s44, 0x32105454, s3
s_and_b32 s44, s44, 7
s_lshr_b32 s45, s38, 1
s_add_u32 s45, s45, 4
s_cmp_eq_u32 s35, 2
s_cselect_b32 s60, 10, 11
s_sub_u32 s57, 8, s33
v_lshlrev_b32 v233, 4, v0
s_mul_i32 s58, s43, 6
s_add_u32 s58, s58, s44
s_mul_i32 s58, s58, 2560
s_add_u32 s58, s58, 2097152
s_lshl_b32 s59, s33, 15
s_add_u32 s59, s59, 3145728
s_sub_u32 s51, 5, s37
s_add_u32 s1, s37, 1
s_sub_u32 s3, 15, s37
s_cmp_le_u32 s37, 2
s_cselect_b32 s46, 0, s3
s_cselect_b32 s47, s51, s1
s_cselect_b32 s48, s3, 0
s_cselect_b32 s49, s1, s51
s_cselect_b32 s50, 1, 0
v_and_b32 v3, 15, v0
v_add_u32 v3, 8, v3
v_lshrrev_b32 v4, 1, v3
v_lshrrev_b32 v5, 5, v0
v_xor_b32 v4, v4, v5
v_and_b32 v4, 7, v4
v_lshlrev_b32 v4, 4, v4
v_lshl_add_u32 v4, v3, 7, v4
v_bfe_u32 v5, v0, 4, 1
v_lshl_add_u32 v4, v5, 3, v4
s_lshl_b32 s3, s44, 11
v_add_u32 v235, s3, v4
s_cmp_lt_u32 s32, 4
s_cbranch_scc1 L_cons
v_mov_b32 v4, 0x3f803f80
v_mov_b32 v5, v4
v_lshrrev_b32 v1, 4, v0
v_mul_u32_u24 v1, 36736, v1
v_lshl_add_u32 v1, v0, 3, v1
ds_write_b64 v1, v[4:5] offset:8192
v_mov_b32 v28, 0
v_mov_b32 v29, 0
v_mov_b32 v30, 0
v_mov_b32 v31, 0
v_mov_b32 v32, 0
v_mov_b32 v33, 0
v_mov_b32 v34, 0
v_mov_b32 v35, 0
s_sub_u32 s0, s32, 5
s_mul_i32 s3, s0, 81920
s_add_u32 s66, s3, s39
s_lshl_b32 s3, s36, 7
s_add_u32 s66, s66, s3
s_mul_i32 s3, s43, 3
s_add_u32 s3, s3, s0
s_mul_i32 s3, s3, 2560
s_add_u32 s67, s3, 2621440
s_mul_i32 s3, s35, 1280
s_add_u32 s3, s3, s59
s_add_u32 s3, s3, 12288
v_min_u32 v1, 9, v0
v_lshl_add_u32 v55, v1, 7, s3
s_lshl_b32 s68, s36, 7
s_add_u32 s68, s68, s3
v_and_b32 v1, 1, v0
v_lshrrev_b32 v2, 5, v0
v_lshl_add_u32 v1, v1, 1, v2
v_bfe_u32 v2, v0, 1, 3
v_lshl_add_u32 v1, v1, 3, v2
s_lshl_b32 s0, s0, 5
v_add_lshl_u32 v52, v1, s0, 4
s_cmp_lt_u32 s39, 2560
s_cselect_b32 s3, 128, 0
v_mov_b32 v1, 0xf149f2ca
v_cmp_gt_u32 vcc, s3, v52
s_nop 1
v_cndmask_b32 v53, 0, v1, vcc
s_setprio 1
s_add_u32 s69, s69, 1
s_cmp_eq_u32 s69, 10
s_cselect_b32 s69, 0, s69
s_lshl_b32 s63, s69, 7
s_mov_b32 s61, 45056
s_add_u32 m0, s61, s64
s_mov_b32 exec_lo, s62
buffer_load_dwordx4 v24, s[4:7], s63 offen lds
s_addk_i32 m0, 1024
s_mov_b32 exec_lo, -1
buffer_load_dwordx4 v25, s[4:7], s63 offen lds
s_addk_i32 m0, 1024
s_nop 0
buffer_load_dwordx4 v26, s[4:7], s63 offen lds
s_addk_i32 m0, 1024
s_nop 0
buffer_load_dwordx4 v27, s[4:7], s63 offen lds
s_waitcnt vmcnt(4) lgkmcnt(0)
s_barrier
s_add_u32 s69, s69, 1
s_cmp_eq_u32 s69, 10
s_cselect_b32 s69, 0, s69
s_lshl_b32 s63, s69, 7
s_mov_b32 s61, 81920
s_add_u32 m0, s61, s64
s_mov_b32 exec_lo, s62
buffer_load_dwordx4 v24, s[4:7], s63 offen lds
s_addk_i32 m0, 1024
s_mov_b32 exec_lo, -1
buffer_load_dwordx4 v25, s[4:7], s63 offen lds
s_addk_i32 m0, 1024
s_nop 0
buffer_load_dwordx4 v26, s[4:7], s63 offen lds
s_addk_i32 m0, 1024
s_nop 0
buffer_load_dwordx4 v27, s[4:7], s63 offen lds
v_add_u32 v1, s64, v233
s_mov_b32 s0, 0x3f803f80
ds_read_b128 v[36:39], v1 offset:8192
ds_read_b128 v[40:43], v1 offset:9216
ds_read_b128 v[44:47], v1 offset:10240
ds_read_b128 v[48:51], v1 offset:11264
v_lshrrev_b32 v2, 3, v0
v_lshlrev_b32 v2, 5, v2
s_lshl_b32 s3, s36, 8
s_add_u32 s3, s3, s67
s_waitcnt lgkmcnt(0)
v_dot2c_f32_bf16 v28, s0, v36
v_dot2c_f32_bf16 v29, v36, v36
v_dot2c_f32_bf16 v30, s0, v40
v_dot2c_f32_bf16 v31, v40, v40
v_dot2c_f32_bf16 v32, s0, v44
v_dot2c_f32_bf16 v33, v44, v44
v_dot2c_f32_bf16 v34, s0, v48
v_dot2c_f32_bf16 v35, v48, v48
v_dot2c_f32_bf16 v28, s0, v37
v_dot2c_f32_bf16 v29, v37, v37
v_dot2c_f32_bf16 v30, s0, v41
v_dot2c_f32_bf16 v31, v41, v41
v_dot2c_f32_bf16 v32, s0, v45
v_dot2c_f32_bf16 v33, v45, v45
v_dot2c_f32_bf16 v34, s0, v49
v_dot2c_f32_bf16 v35, v49, v49
v_dot2c_f32_bf16 v28, s0, v38
v_dot2c_f32_bf16 v29, v38, v38
v_dot2c_f32_bf16 v30, s0, v42
v_dot2c_f32_bf16 v31, v42, v42
v_dot2c_f32_bf16 v32, s0, v46
v_dot2c_f32_bf16 v33, v46, v46
v_dot2c_f32_bf16 v34, s0, v50
v_dot2c_f32_bf16 v35, v50, v50
v_dot2c_f32_bf16 v28, s0, v39
v_dot2c_f32_bf16 v29, v39, v39
v_dot2c_f32_bf16 v30, s0, v43
v_dot2c_f32_bf16 v31, v43, v43
v_dot2c_f32_bf16 v32, s0, v47
v_dot2c_f32_bf16 v33, v47, v47
v_dot2c_f32_bf16 v34, s0, v51
v_dot2c_f32_bf16 v35, v51, v51
v_add_f32_dpp v28, v28, v28 quad_perm:[1,0,3,2] row_mask:0xf bank_mask:0xf
v_add_f32_dpp v29, v29, v29 quad_perm:[1,0,3,2] row_mask:0xf bank_mask:0xf
v_add_f32_dpp v30, v30, v30 quad_perm:[1,0,3,2] row_mask:0xf bank_mask:0xf
v_add_f32_dpp v31, v31, v31 quad_perm:[1,0,3,2] row_mask:0xf bank_mask:0xf
v_add_f32_dpp v32, v32, v32 quad_perm:[1,0,3,2] row_mask:0xf bank_mask:0xf
v_add_f32_dpp v33, v33, v33 quad_perm:[1,0,3,2] row_mask:0xf bank_mask:0xf
v_add_f32_dpp v34, v34, v34 quad_perm:[1,0,3,2] row_mask:0xf bank_mask:0xf
v_add_f32_dpp v35, v35, v35 quad_perm:[1,0,3,2] row_mask:0xf bank_mask:0xf
v_add_f32_dpp v28, v28, v28 quad_perm:[2,3,0,1] row_mask:0xf bank_mask:0xf
v_add_f32_dpp v29, v29, v29 quad_perm:[2,3,0,1] row_mask:0xf bank_mask:0xf
v_add_f32_dpp v30, v30, v30 quad_perm:[2,3,0,1] row_mask:0xf bank_mask:0xf
v_add_f32_dpp v31, v31, v31 quad_perm:[2,3,0,1] row_mask:0xf bank_mask:0xf
v_add_f32_dpp v32, v32, v32 quad_perm:[2,3,0,1] row_mask:0xf bank_mask:0xf
v_add_f32_dpp v33, v33, v33 quad_perm:[2,3,0,1] row_mask:0xf bank_mask:0xf
v_add_f32_dpp v34, v34, v34 quad_perm:[2,3,0,1] row_mask:0xf bank_mask:0xf
v_add_f32_dpp v35, v35, v35 quad_perm:[2,3,0,1] row_mask:0xf bank_mask:0xf
v_add_f32_dpp v28, v28, v28 row_half_mirror row_mask:0xf bank_mask:0xf
v_add_f32_dpp v29, v29, v29 row_half_mirror row_mask:0xf bank_mask:0xf
v_add_f32_dpp v30, v30, v30 row_half_mirror row_mask:0xf bank_mask:0xf
v_add_f32_dpp v31, v31, v31 row_half_mirror row_mask:0xf bank_mask:0xf
v_add_f32_dpp v32, v32, v32 row_half_mirror row_mask:0xf bank_mask:0xf
v_add_f32_dpp v33, v33, v33 row_half_mirror row_mask:0xf bank_mask:0xf
v_add_f32_dpp v34, v34, v34 row_half_mirror row_mask:0xf bank_mask:0xf
v_add_f32_dpp v35, v35, v35 row_half_mirror row_mask:0xf bank_mask:0xf
s_mov_b32 exec_lo, 0x1010101
s_mov_b32 exec_hi, 0x1010101
buffer_store_dwordx4 v[28:31], v2, s[16:19], s3 offen offset:0 sc1
buffer_store_dwordx4 v[32:35], v2, s[16:19], s3 offen offset:16 sc1
s_mov_b64 exec, -1
v_mov_b32 v44, 0
v_mov_b32 v45, 0
v_mov_b32 v46, 0
v_mov_b32 v47, 0
s_waitcnt vmcnt(6)
s_barrier
s_cmp_eq_u32 s32, 5
s_cbranch_scc0 L_o5a
s_lshl_b32 s0, s33, 5
buffer_load_dword v54, off, s[24:27], s0 sc1
L_o5a:
s_add_u32 s69, s69, 1
s_cmp_eq_u32 s69, 10
s_cselect_b32 s69, 0, s69
s_lshl_b32 s63, s69, 7
s_mov_b32 s61, 118784
s_add_u32 m0, s61, s64
s_mov_b32 exec_lo, s62
buffer_load_dwordx4 v24, s[4:7], s63 offen lds
s_addk_i32 m0, 1024
s_mov_b32 exec_lo, -1
buffer_load_dwordx4 v25, s[4:7], s63 offen lds
s_addk_i32 m0, 1024
s_nop 0
buffer_load_dwordx4 v26, s[4:7], s63 offen lds
s_addk_i32 m0, 1024
s_nop 0
buffer_load_dwordx4 v27, s[4:7], s63 offen lds
s_cmp_eq_u32 s57, 1
s_cbranch_scc0 L_xc1
s_mov_b32 s0, 45056
s_call_b64 s[100:101], L_xcap
L_xc1:
v_and_b32 v1, 15, v0
v_lshrrev_b32 v2, 4, v0
v_mov_b32 v7, 1792
s_mul_i32 s0, s44, 2304
s_movk_i32 s1, 144
v_bfe_u32 v3, v0, 2, 1
v_and_b32 v4, 3, v0
v_lshlrev_b32 v4, 1, v4
v_lshl_add_u32 v3, v3, 3, v4
v_bfe_u32 v4, v0, 3, 1
v_add_u32 v3, v3, v4
s_add_u32 s3, s0, 17408
v_mov_b32 v4, s3
v_mad_u32_u24 v3, v3, s1, v4
s_add_u32 s3, s0, 4736
v_mov_b32 v4, s3
v_mad_u32_u24 v4, v1, s1, v4
s_mov_b32 s52, 0xff00ff
s_mov_b32 s53, 0xff00ff
v_add_u32 v5, s51, v2
v_lshl_add_u32 v200, v5, 3, v3
v_lshl_add_u32 v5, v5, 3, v4
v_cndmask_b32 v204, v7, v5, s[52:53]
v_cndmask_b32 v205, v5, v7, s[52:53]
v_add_u32 v5, s46, v2
v_lshl_add_u32 v202, v5, 3, v3
v_lshl_add_u32 v5, v5, 3, v4
v_cmp_gt_u32 vcc, s47, v2
s_nop 1
v_cndmask_b32 v5, v7, v5, vcc
v_cndmask_b32 v206, v7, v5, s[52:53]
v_cndmask_b32 v207, v5, v7, s[52:53]
v_add_u32 v5, s48, v2
v_min_u32 v5, 15, v5
v_lshl_add_u32 v203, v5, 3, v3
v_lshl_add_u32 v5, v5, 3, v4
v_cmp_gt_u32 vcc, s49, v2
s_nop 1
v_cndmask_b32 v5, v7, v5, vcc
v_cndmask_b32 v208, v7, v5, s[52:53]
v_cndmask_b32 v209, v5, v7, s[52:53]
s_sub_u32 s3, s51, 1
v_mad_u32_u24 v5, v2, 5, s3
s_add_u32 s3, s46, 4
v_mov_b32 v6, s3
s_mov_b64 vcc, 0xffff
v_cndmask_b32 v5, v5, v6, vcc
v_min_u32 v5, 15, v5
v_lshl_add_u32 v201, v5, 3, v3
v_lshl_add_u32 v5, v5, 3, v4
s_cmp_eq_u32 s47, 5
s_cselect_b64 vcc, 0xff, 0
v_cndmask_b32 v210, v7, v5, vcc
s_lshl_b64 vcc, vcc, 8
v_cndmask_b32 v211, v7, v5, vcc
s_bfm_b64 vcc, 8, 16
v_cndmask_b32 v212, v7, v5, vcc
s_bfm_b64 vcc, 8, 24
v_cndmask_b32 v213, v7, v5, vcc
s_bfm_b64 vcc, 8, 32
v_cndmask_b32 v214, v7, v5, vcc
s_bfm_b64 vcc, 8, 40
v_cndmask_b32 v215, v7, v5, vcc
s_cmp_eq_u32 s32, 5
s_cbranch_scc1 L_w51
s_waitcnt vmcnt(4)
L_w51:
s_waitcnt vmcnt(5)
s_barrier
s_add_u32 s69, s69, 1
s_cmp_eq_u32 s69, 10
s_cselect_b32 s69, 0, s69
s_lshl_b32 s63, s69, 7
s_mov_b32 s61, 8192
s_add_u32 m0, s61, s64
s_mov_b32 exec_lo, s62
buffer_load_dwordx4 v24, s[4:7], s63 offen lds
s_addk_i32 m0, 1024
s_mov_b32 exec_lo, -1
buffer_load_dwordx4 v25, s[4:7], s63 offen lds
s_addk_i32 m0, 1024
s_nop 0
buffer_load_dwordx4 v26, s[4:7], s63 offen lds
s_addk_i32 m0, 1024
s_nop 0
buffer_load_dwordx4 v27, s[4:7], s63 offen lds
s_cmp_eq_u32 s57, 2
s_cbranch_scc0 L_xc2
s_mov_b32 s0, 81920
s_call_b64 s[100:101], L_xcap
L_xc2:
s_mul_i32 s0, s44, 2304
s_movk_i32 s1, 144
v_bfe_u32 v3, v0, 2, 3
v_lshrrev_b32 v4, 5, v0
v_lshl_add_u32 v3, v3, 1, v4
s_add_u32 s3, s0, 31232
v_mov_b32 v4, s3
v_mad_u32_u24 v3, v3, s1, v4
v_and_b32 v4, 3, v0
s_mov_b32 s54, 0x11111111
s_mov_b32 s55, 0x11111111
v_add_u32 v5, s51, v4
v_lshl_add_u32 v216, v5, 3, v3
v_add_u32 v7, 32, v216
s_cmp_eq_u32 s50, 1
s_cselect_b32 s3, -1, 12
s_cselect_b32 s56, 2, -1
v_add_u32 v5, s3, v4
v_lshl_add_u32 v5, v5, 3, v3
v_cndmask_b32 v217, v5, v7, s[54:55]
v_add_u32 v7, 40, v7
v_add_u32 v5, s56, v4
v_add_u32 v6, 10, v5
v_cmp_gt_i32 vcc, s51, v5
s_nop 1
v_cndmask_b32 v5, v6, v5, vcc
v_lshl_add_u32 v5, v5, 3, v3
v_cndmask_b32 v218, v5, v7, s[54:55]
s_lshl_b32 s0, s44, 8
v_lshrrev_b32 v4, 5, v0
v_and_or_b32 v3, v0, 8, v4
s_add_u32 s3, s0, 8
v_lshl_add_u32 v222, v3, 4, s3
v_and_b32 v1, 15, v0
s_add_u32 s3, s0, 132
v_lshl_add_u32 v223, v1, 4, s3
s_lshr_b32 s3, s39, 8
s_mul_i32 s3, s3, 52429
s_lshr_b32 s3, s3, 18
s_lshl_b32 s0, s44, 5
s_add_u32 s3, s3, s0
s_sub_u32 s3, 2047, s3
v_mad_i32_i24 v234, v1, -2, s3
s_waitcnt vmcnt(4)
s_cmp_eq_u32 s32, 5
s_cbranch_scc0 L_o5c
v_cmp_ne_u32 vcc, 1, v54
s_cbranch_vccnz L_era
L_ega:
s_getreg_b32 s0, hwreg(HW_REG_XCC_ID, 0, 4)
v_mov_b32 v1, s0
s_mov_b64 exec, 1
buffer_store_dword v1, off, s[16:19], s68 sc1
s_mov_b64 exec, -1
L_o5c:
s_barrier
s_add_u32 s69, s69, 1
s_cmp_eq_u32 s69, 10
s_cselect_b32 s69, 0, s69
s_lshl_b32 s63, s69, 7
s_mov_b32 s61, 45056
s_add_u32 m0, s61, s64
s_mov_b32 exec_lo, s62
buffer_load_dwordx4 v24, s[4:7], s63 offen lds
s_addk_i32 m0, 1024
s_mov_b32 exec_lo, -1
buffer_load_dwordx4 v25, s[4:7], s63 offen lds
s_addk_i32 m0, 1024
s_nop 0
buffer_load_dwordx4 v26, s[4:7], s63 offen lds
s_addk_i32 m0, 1024
s_nop 0
buffer_load_dwordx4 v27, s[4:7], s63 offen lds
s_cmp_eq_u32 s57, 3
s_cbranch_scc0 L_xc3
s_mov_b32 s0, 118784
s_call_b64 s[100:101], L_xcap
L_xc3:
v_lshrrev_b32 v2, 4, v0
v_and_or_b32 v3, v0, 8, v2
v_and_b32 v4, 0x70, v233
v_bfrev_b32 v6, 1
s_lshl_b32 s3, s45, 4
v_add_u32 v5, s3, v3
s_lshl_b32 s3, s60, 3
v_cmp_gt_u32 vcc, s3, v5
v_mul_u32_u24 v5, 2560, v5
v_add3_u32 v5, v5, v4, s39
v_cndmask_b32 v236, v6, v5, vcc
s_lshl_b32 s3, s44, 4
v_add_u32 v5, s3, v3
s_lshl_b32 s3, s60, 3
v_cmp_gt_u32 vcc, s3, v5
v_mul_u32_u24 v5, 2560, v5
v_add3_u32 v5, v5, v4, s39
v_cndmask_b32 v227, v6, v5, vcc
s_lshl_b32 s3, s36, 7
v_add_u32 v226, s3, v227
v_bfe_u32 v3, v0, 4, 1
v_cmp_eq_u32 s[54:55], s50, v3
s_cmp_lg_u32 s37, 0
s_cselect_b64 s[0:1], -1, s[54:55]
s_and_b64 vcc, vcc, s[0:1]
s_cmp_lg_u32 s37, 4
s_cselect_b64 s[0:1], 0, s[54:55]
s_andn2_b64 vcc, vcc, s[0:1]
v_cndmask_b32 v225, v6, v226, vcc
s_cmp_le_u32 s37, 3
s_cselect_b32 s3, 2560, 0
s_sub_u32 s3, s3, 128
v_mov_b32 v4, s3
s_cmp_ge_u32 s37, 2
s_cselect_b32 s3, 2560, 0
s_add_u32 s3, s3, 128
v_mov_b32 v5, s3
v_cndmask_b32 v4, v4, v5, s[54:55]
v_mul_u32_u24 v3, 2560, v3
v_sub_u32 v4, v4, v3
v_add_u32 v4, v4, v226
v_cndmask_b32 v224, v6, v4, vcc
s_waitcnt vmcnt(4)
s_barrier
s_cmp_eq_u32 s32, 5
s_cbranch_scc0 L_o5b
buffer_load_dword v54, v55, s[16:19], 0 offen sc1
L_o5b:
s_add_u32 s69, s69, 1
s_cmp_eq_u32 s69, 10
s_cselect_b32 s69, 0, s69
s_lshl_b32 s63, s69, 7
s_mov_b32 s61, 81920
s_add_u32 m0, s61, s64
s_mov_b32 exec_lo, s62
buffer_load_dwordx4 v24, s[4:7], s63 offen lds
s_addk_i32 m0, 1024
s_mov_b32 exec_lo, -1
buffer_load_dwordx4 v25, s[4:7], s63 offen lds
s_addk_i32 m0, 1024
s_nop 0
buffer_load_dwordx4 v26, s[4:7], s63 offen lds
s_addk_i32 m0, 1024
s_nop 0
buffer_load_dwordx4 v27, s[4:7], s63 offen lds
s_cmp_eq_u32 s57, 4
s_cbranch_scc0 L_xc4
s_mov_b32 s0, 8192
s_call_b64 s[100:101], L_xcap
L_xc4:
v_and_b32 v1, 15, v0
v_bfrev_b32 v6, 1
v_bfe_u32 v3, v0, 4, 1
v_lshrrev_b32 v4, 5, v0
v_lshl_add_u32 v3, v3, 1, v4
s_lshl_b32 s3, s36, 7
v_lshl_add_u32 v4, v3, 4, s3
s_lshl_b32 s3, s44, 4
v_add_u32 v5, s3, v1
s_lshl_b32 s3, s60, 3
v_cmp_gt_u32 vcc, s3, v5
v_mul_u32_u24 v5, 2560, v5
v_add3_u32 v5, v5, v4, s39
v_cndmask_b32 v232, v6, v5, vcc
v_bfe_u32 v3, v0, 3, 2
v_lshlrev_b32 v3, 2, v3
v_and_or_b32 v3, v0, 3, v3
v_lshlrev_b32 v3, 3, v3
v_bfe_u32 v4, v0, 2, 2
v_lshl_add_u32 v3, v4, 7, v3
v_lshrrev_b32 v2, 4, v0
s_and_b32 s3, s32, 1
s_lshl_b32 s3, s3, 12
s_add_u32 s3, s3, 81920
v_lshl_add_u32 v4, v2, 10, v3
v_add_u32 v228, s3, v4
v_xor_b32 v229, 32, v228
v_xor_b32 v230, 64, v228
v_xor_b32 v231, 96, v228
s_mov_b32 s44, 0x0
s_mov_b32 s45, 0x1010101
s_mov_b32 s46, 0x3030303
s_mov_b32 s47, 0x7070707
s_mov_b32 s48, 0xf0f0f0f
s_mov_b32 s49, 0x1f1f1f1f
s_mov_b32 s50, 0x3f3f3f3f
s_mov_b32 s51, 0x7f7f7f7f
s_movk_i32 s54, 10240
s_mov_b32 s55, 0x07060501
s_mov_b32 s56, 0x0706000c
v_mov_b32 v5, 0xffff
v_mov_b32 v6, 0xffff0000
v_cndmask_b32 v1, 0, v5, s[44:45]
v_cndmask_b32 v4, 0, v6, s[46:47]
v_or_b32 v220, v1, v4
v_cndmask_b32 v1, 0, v5, s[48:49]
v_cndmask_b32 v4, 0, v6, s[50:51]
v_or_b32 v221, v1, v4
s_cmp_eq_u32 s32, 5
s_cbranch_scc1 L_w54
s_waitcnt vmcnt(4)
L_w54:
s_waitcnt vmcnt(5)
s_barrier
v_lshrrev_b32 v1, 4, v0
v_lshlrev_b32 v1, 3, v1
s_lshl_b32 s3, s36, 7
buffer_load_dwordx2 v[244:245], v1, s[28:31], s3 offen offset:0
buffer_load_dwordx2 v[246:247], v1, s[28:31], s3 offen offset:32
buffer_load_dwordx2 v[248:249], v1, s[28:31], s3 offen offset:64
buffer_load_dwordx2 v[250:251], v1, s[28:31], s3 offen offset:96
s_add_u32 s69, s69, 1
s_cmp_eq_u32 s69, 10
s_cselect_b32 s69, 0, s69
s_lshl_b32 s63, s69, 7
s_mov_b32 s61, 118784
s_add_u32 m0, s61, s64
s_mov_b32 exec_lo, s62
buffer_load_dwordx4 v24, s[4:7], s63 offen lds
s_addk_i32 m0, 1024
s_mov_b32 exec_lo, -1
buffer_load_dwordx4 v25, s[4:7], s63 offen lds
s_addk_i32 m0, 1024
s_nop 0
buffer_load_dwordx4 v26, s[4:7], s63 offen lds
s_addk_i32 m0, 1024
s_nop 0
buffer_load_dwordx4 v27, s[4:7], s63 offen lds
s_cmp_eq_u32 s57, 5
s_cbranch_scc0 L_xc5
s_mov_b32 s0, 45056
s_call_b64 s[100:101], L_xcap
L_xc5:
v_lshrrev_b32 v1, 3, v0
v_and_b32 v2, 2, v1
v_xor_b32 v2, v2, v0
s_lshl_b32 s3, s32, 2
v_xor_b32 v2, s3, v2
v_and_b32 v2, 7, v2
s_lshl_b32 s3, s36, 7
v_lshl_add_u32 v2, v2, 4, s3
v_and_b32 v3, 3, v1
v_mul_u32_u24 v3, 1280, v3
v_add_u32 v2, v3, v2
v_lshrrev_b32 v3, 5, v0
v_mul_u32_u24 v3, 5120, v3
v_sub_u32 v4, 5120, v3
v_mad_u32_u24 v56, v3, 5, v2
v_mad_u32_u24 v57, v3, 3, v2
v_mad_u32_u24 v58, v3, 13, v2
v_mad_u32_u24 v59, v4, 3, v2
v_mad_u32_u24 v60, v4, 13, v2
s_mul_i32 s3, s38, 24
v_add_u32 v1, s3, v0
s_add_u32 s3, s3, 24
s_lshl_b32 s0, s60, 3
s_min_u32 s3, s3, s0
v_cmp_gt_u32 vcc, s3, v1
v_mul_u32_u24 v1, 2560, v1
s_lshl_b32 s0, s36, 7
s_add_u32 s3, s0, s39
v_add_u32 v1, s3, v1
v_bfrev_b32 v2, 1
v_cndmask_b32 v61, v2, v1, vcc
s_lshl_b32 s3, s35, 2
s_add_u32 s3, s3, s38
s_mul_i32 s3, s3, 1280
s_add_u32 s3, s3, s0
v_mul_u32_u24 v1, 15360, v0
v_add_u32 v62, s3, v1
s_mul_i32 s3, s38, 3
v_min_u32 v1, 2, v0
v_add_u32 v1, s3, v1
v_lshrrev_b32 v2, 1, v1
v_mul_u32_u24 v2, 2304, v2
v_lshl_add_u32 v1, v1, 7, v2
s_mul_i32 s3, s43, 15360
s_lshl_b32 s0, s36, 8
s_add_u32 s3, s3, s0
s_add_u32 s3, s3, 2097152
v_add_u32 v63, s3, v1
s_waitcnt vmcnt(8)
s_cmp_eq_u32 s32, 5
s_cbranch_scc0 L_o5d
v_cmp_eq_u32 vcc, -1, v54
s_cbranch_vccnz L_erb
L_egb:
s_getreg_b32 s0, hwreg(HW_REG_XCC_ID, 0, 4)
v_cmp_ne_u32 vcc, s0, v54
s_cmp_eq_u64 vcc, 0
s_cselect_b32 s0, 1, 0
v_mov_b32 v1, 1728
v_mov_b32 v2, s0
ds_write_b32 v1, v2
L_o5d:
s_barrier
buffer_load_dwordx4 v[36:39], v233, s[16:19], s67 offen offset:0 sc1
buffer_load_dwordx4 v[40:43], v233, s[16:19], s67 offen offset:1024 sc1
s_mov_b32 exec_hi, 0
buffer_load_dwordx4 v[44:47], v233, s[16:19], s67 offen offset:2048 sc1
s_mov_b32 exec_hi, -1
s_add_u32 s69, s69, 1
s_cmp_eq_u32 s69, 10
s_cselect_b32 s69, 0, s69
s_lshl_b32 s63, s69, 7
s_mov_b32 s61, 8192
s_add_u32 m0, s61, s64
s_mov_b32 exec_lo, s62
buffer_load_dwordx4 v24, s[4:7], s63 offen lds
s_addk_i32 m0, 1024
s_mov_b32 exec_lo, -1
buffer_load_dwordx4 v25, s[4:7], s63 offen lds
s_addk_i32 m0, 1024
s_nop 0
buffer_load_dwordx4 v26, s[4:7], s63 offen lds
s_addk_i32 m0, 1024
s_nop 0
buffer_load_dwordx4 v27, s[4:7], s63 offen lds
s_cmp_eq_u32 s57, 6
s_cbranch_scc0 L_xc6
s_mov_b32 s0, 81920
s_call_b64 s[100:101], L_xcap
L_xc6:
v_mov_b32 v176, 0
v_mov_b32 v177, 0
v_mov_b32 v178, 0
v_mov_b32 v179, 0
v_mov_b32 v180, 0
v_mov_b32 v181, 0
v_mov_b32 v182, 0
v_mov_b32 v183, 0
v_mov_b32 v184, 0
v_mov_b32 v185, 0
v_mov_b32 v186, 0
v_mov_b32 v187, 0
v_mov_b32 v188, 0
v_mov_b32 v189, 0
v_mov_b32 v190, 0
v_mov_b32 v191, 0
s_waitcnt vmcnt(7)
s_mov_b32 s3, 0x3f803f80
v_mov_b32 v64, s3
v_mov_b32 v65, s3
v_mov_b32 v66, s3
v_mov_b32 v67, s3
s_mov_b32 exec_lo, 0x11111111
s_mov_b32 exec_hi, 0x11111111
v_mov_b32 v244, s3
v_mov_b32 v245, s3
v_mov_b32 v246, s3
v_mov_b32 v247, s3
v_mov_b32 v248, s3
v_mov_b32 v249, s3
v_mov_b32 v250, s3
v_mov_b32 v251, s3
s_mov_b64 exec, -1
v_mfma_f32_16x16x32_bf16 v[252:255], v[244:247], v[64:67], 0
v_mfma_f32_16x16x32_bf16 v[252:255], v[248:251], v[64:67], v[252:255]
s_barrier
s_add_u32 s69, s69, 1
s_cmp_eq_u32 s69, 10
s_cselect_b32 s69, 0, s69
s_lshl_b32 s63, s69, 7
s_mov_b32 s61, 45056
s_add_u32 m0, s61, s64
s_mov_b32 exec_lo, s62
buffer_load_dwordx4 v24, s[4:7], s63 offen lds
s_addk_i32 m0, 1024
s_mov_b32 exec_lo, -1
buffer_load_dwordx4 v25, s[4:7], s63 offen lds
s_addk_i32 m0, 1024
s_nop 0
buffer_load_dwordx4 v26, s[4:7], s63 offen lds
s_addk_i32 m0, 1024
s_nop 0
buffer_load_dwordx4 v27, s[4:7], s63 offen lds
s_cmp_eq_u32 s57, 7
s_cbranch_scc0 L_xc7
s_mov_b32 s0, 118784
s_call_b64 s[100:101], L_xcap
L_xc7:
s_waitcnt vmcnt(8)
v_add_f32 v36, v36, v40
v_add_f32 v37, v37, v41
v_add_f32 v38, v38, v42
v_add_f32 v39, v39, v43
v_add_f32 v36, v36, v44
v_add_f32 v37, v37, v45
v_add_f32 v38, v38, v46
v_add_f32 v39, v39, v47
s_nop 0
v_permlane32_swap_b32 v36, v38
v_permlane32_swap_b32 v37, v39
v_add_f32 v36, v36, v38
v_add_f32 v37, v37, v39
v_mov_b32 v38, v36
v_mov_b32 v39, v37
s_mov_b32 s1, 0x3acccccd
v_mov_b32 v1, 0x3727c5ac
v_permlane16_swap_b32 v36, v38
v_permlane16_swap_b32 v37, v39
v_add_f32 v36, v36, v38
v_add_f32 v37, v37, v39
v_mul_f32 v36, 0xbacccccd, v36
v_fma_f32 v2, v37, s1, v1
v_fma_f32 v2, -v36, v36, v2
v_max_f32 v2, v2, v1
v_rsq_f32 v37, v2
v_mov_b32 v39, v53
v_mov_b32 v38, v37
ds_write_b128 v52, v[36:39] offset:0
s_waitcnt lgkmcnt(0)
s_waitcnt vmcnt(4)
s_barrier
s_cmp_eq_u32 s57, 8
s_cbranch_scc0 L_xc8
s_mov_b32 s0, 8192
s_call_b64 s[100:101], L_xcap
L_xc8:
L_h8:
s_mul_i32 s66, s38, 5120
s_lshl_b32 s3, s38, 10
s_add_u32 m0, s3, 81920
s_add_u32 s3, s66, 25600
buffer_load_dwordx4 v56, s[12:15], s3 offen lds
s_addk_i32 m0, 4096
s_add_u32 s3, s66, 102400
buffer_load_dwordx4 v56, s[12:15], s3 offen lds
s_addk_i32 m0, 4096
s_add_u32 s3, s66, 179200
buffer_load_dwordx4 v56, s[12:15], s3 offen lds
s_addk_i32 m0, 4096
s_add_u32 s3, s66, 256000
buffer_load_dwordx4 v56, s[12:15], s3 offen lds
s_addk_i32 m0, 4096
s_add_u32 s3, s66, 332800
buffer_load_dwordx4 v56, s[12:15], s3 offen lds
s_addk_i32 m0, 4096
s_add_u32 s3, s66, 435200
buffer_load_dwordx4 v56, s[12:15], s3 offen lds
s_addk_i32 m0, 4096
s_add_u32 s3, s66, 512000
buffer_load_dwordx4 v56, s[12:15], s3 offen lds
s_addk_i32 m0, 4096
s_add_u32 s3, s66, 588800
buffer_load_dwordx4 v56, s[12:15], s3 offen lds
v_add_u32 v1, 128, v222
v_cndmask_b32 v2, v1, v222, s[44:45]
ds_read_b64 v[168:169], v2 offset:0
v_cndmask_b32 v2, v1, v222, s[46:47]
ds_read_b64 v[170:171], v2 offset:32
v_cndmask_b32 v2, v1, v222, s[48:49]
ds_read_b64 v[172:173], v2 offset:64
v_cndmask_b32 v2, v1, v222, s[50:51]
ds_read_b64 v[174:175], v2 offset:96
ds_read_b32 v5, v223
v_mov_b32 v1, 1728
ds_read_b32 v1, v1
s_waitcnt lgkmcnt(0)
v_readfirstlane_b32 s41, v1
s_waitcnt vmcnt(8)
s_barrier
s_cmp_eq_u32 s41, 1
s_cbranch_scc0 L_gh_1g
L_gh_1b:
buffer_load_dword v61, v61, s[20:23], 0 offen
buffer_load_dword v63, v63, s[16:19], 0 offen
s_addk_i32 m0, 4096
s_add_u32 s3, s66, 665600
buffer_load_dwordx4 v56, s[12:15], s3 offen lds
s_addk_i32 m0, 4096
s_add_u32 s3, s66, 742400
buffer_load_dwordx4 v56, s[12:15], s3 offen lds
s_and_b32 s3, s32, 1
s_lshl_b32 s61, s3, 7
s_xor_b32 s62, s61, 128
s_add_u32 s63, s62, s54
s_add_u32 s64, s61, s54
s_lshl_b32 s3, s3, 13
s_sub_u32 s65, 4096, s3
s_add_u32 s0, s37, 1
s_sub_u32 s1, 5, s37
s_min_u32 s0, s0, s1
s_lshl_b32 s0, s0, 4
s_sub_u32 s1, 64, s0
s_cmp_le_u32 s37, 2
s_cselect_b32 s1, s1, 16
s_bfm_b64 s[100:101], s0, s1
v_mul_f32 v5, 0x3ea52b5c, v5
s_barrier
ds_read_b64 v[96:97], v202 offset:0
ds_read_b64 v[98:99], v202 offset:1152
ds_read_b64 v[100:101], v203 offset:0
ds_read_b64 v[102:103], v203 offset:1152
ds_read_b64 v[104:105], v201 offset:0
ds_read_b64 v[106:107], v201 offset:1152
ds_read_b64 v[108:109], v200 offset:0
ds_read_b64 v[110:111], v200 offset:1152
ds_read_b64 v[112:113], v200 offset:40
ds_read_b64 v[114:115], v200 offset:1192
s_cmp_eq_u32 s38, 1
s_cbranch_scc1 L_woe1
s_cmp_eq_u32 s38, 2
s_cbranch_scc1 L_woe2
s_cmp_eq_u32 s38, 3
s_cbranch_scc1 L_woe3
s_addk_i32 m0, 4096
s_mov_b32 s3, 46080
buffer_load_dwordx4 v56, s[12:15], s3 offen lds
s_addk_i32 m0, 4096
s_mov_b32 s3, 122880
buffer_load_dwordx4 v56, s[12:15], s3 offen lds
s_addk_i32 m0, 4096
s_mov_b32 s3, 199680
buffer_load_dwordx4 v56, s[12:15], s3 offen lds
s_addk_i32 m0, 4096
s_mov_b32 s3, 276480
buffer_load_dwordx4 v56, s[12:15], s3 offen lds
s_addk_i32 m0, 4096
s_mov_b32 s3, 353280
buffer_load_dwordx4 v56, s[12:15], s3 offen lds
s_addk_i32 m0, 4096
s_mov_b32 s3, 455680
buffer_load_dwordx4 v56, s[12:15], s3 offen lds
s_addk_i32 m0, 4096
s_mov_b32 s3, 532480
buffer_load_dwordx4 v56, s[12:15], s3 offen lds
s_addk_i32 m0, 4096
s_mov_b32 s3, 609280
buffer_load_dwordx4 v56, s[12:15], s3 offen lds
s_addk_i32 m0, 4096
s_mov_b32 s3, 686080
buffer_load_dwordx4 v56, s[12:15], s3 offen lds
s_addk_i32 m0, 4096
s_mov_b32 s3, 762880
buffer_load_dwordx4 v56, s[12:15], s3 offen lds
L_woe:
s_setprio 1
s_waitcnt vmcnt(14)
s_barrier
ds_read_b64 v[116:117], v206 offset:0
ds_read_b64 v[118:119], v207 offset:0
ds_read_b64 v[120:121], v208 offset:0
ds_read_b64 v[122:123], v209 offset:0
ds_read_b64 v[124:125], v210 offset:0
ds_read_b64 v[126:127], v211 offset:0
ds_read_b64 v[128:129], v204 offset:0
ds_read_b64 v[130:131], v205 offset:0
ds_read_b64 v[132:133], v204 offset:40
ds_read_b64 v[134:135], v205 offset:40
s_waitcnt lgkmcnt(8)
v_mfma_f32_16x16x32_bf16 v[152:155], v[96:99], v[116:119], 0
ds_read_b64 v[136:137], v212 offset:0
ds_read_b64 v[138:139], v213 offset:0
s_waitcnt lgkmcnt(8)
v_mfma_f32_16x16x32_bf16 v[156:159], v[100:103], v[120:123], 0
ds_read_b64 v[140:141], v214 offset:0
ds_read_b64 v[142:143], v215 offset:0
s_waitcnt lgkmcnt(8)
v_mfma_f32_16x16x32_bf16 v[152:155], v[104:107], v[124:127], v[152:155]
s_waitcnt lgkmcnt(6)
v_mfma_f32_16x16x32_bf16 v[160:163], v[108:111], v[128:131], 0
s_waitcnt lgkmcnt(4)
v_mfma_f32_16x16x32_bf16 v[164:167], v[112:115], v[132:135], 0
s_waitcnt lgkmcnt(2)
v_mfma_f32_16x16x32_bf16 v[160:163], v[104:107], v[136:139], v[160:163]
s_waitcnt lgkmcnt(0)
v_mfma_f32_16x16x32_bf16 v[164:167], v[104:107], v[140:143], v[164:167]
v_permlane16_swap_b32 v152, v156
v_permlane16_swap_b32 v153, v157
v_permlane16_swap_b32 v154, v158
v_permlane16_swap_b32 v155, v159
v_cndmask_b32 v2, v156, v152, s[44:45]
v_cndmask_b32 v3, v157, v153, s[46:47]
v_cndmask_b32 v194, v158, v154, s[48:49]
v_cndmask_b32 v195, v159, v155, s[50:51]
v_or_b32 v192, 0xffff, v2
v_perm_b32 v193, v3, v2, s55
s_cmp_eq_u32 s41, 1
s_cbranch_scc0 L_gl_2g
buffer_store_dwordx4 v[192:195], v224, s[20:23], s54 offen
L_gl_2b:
v_permlane16_swap_b32 v160, v164
v_permlane16_swap_b32 v161, v165
v_permlane16_swap_b32 v162, v166
v_permlane16_swap_b32 v163, v167
v_cndmask_b32 v196, v164, v160, s[44:45]
v_cndmask_b32 v197, v165, v161, s[46:47]
v_cndmask_b32 v198, v166, v162, s[48:49]
v_cndmask_b32 v199, v167, v163, s[50:51]
v_fma_f32 v196, v196, v168, v169
v_fma_f32 v197, v197, v170, v171
v_fma_f32 v198, v198, v172, v173
v_fma_f32 v199, v199, v174, v175
v_max3_f32 v6, v196, v197, v198
v_max_f32 v6, v6, v199
v_mov_b32 v7, v6
s_nop 1
v_permlane32_swap_b32 v6, v7
v_max_f32 v6, v6, v7
v_mul_f32 v6, v6, v5
v_fma_f32 v196, v196, v5, -v6
v_fma_f32 v197, v197, v5, -v6
v_fma_f32 v198, v198, v5, -v6
v_fma_f32 v199, v199, v5, -v6
v_exp_f32 v196, v196
v_exp_f32 v197, v197
v_exp_f32 v198, v198
v_exp_f32 v199, v199
ds_read_b64_tr_b16 v[64:65], v216 offset:0
ds_read_b64_tr_b16 v[66:67], v216 offset:1152
ds_read_b64_tr_b16 v[68:69], v216 offset:40
ds_read_b64_tr_b16 v[70:71], v216 offset:1192
ds_read_b64_tr_b16 v[72:73], v217 offset:0
ds_read_b64_tr_b16 v[74:75], v217 offset:1152
ds_read_b64_tr_b16 v[76:77], v218 offset:0
ds_read_b64_tr_b16 v[78:79], v218 offset:1152
v_add_f32 v6, v196, v197
v_add_f32 v7, v198, v199
v_add_f32 v6, v6, v7
v_mov_b32 v7, v6
v_mul_f32 v196, v196, v168
v_mul_f32 v197, v197, v170
v_permlane32_swap_b32 v6, v7
v_mul_f32 v198, v198, v172
v_add_f32 v6, v6, v7
v_rcp_f32 v6, v6
v_mul_f32 v199, v199, v174
v_mul_f32 v196, v196, v6
v_mul_f32 v197, v197, v6
v_mul_f32 v198, v198, v6
v_mul_f32 v199, v199, v6
v_cvt_pk_bf16_f32 v196, v196, v197
v_cvt_pk_bf16_f32 v197, v198, v199
s_mov_b64 exec, s[52:53]
v_and_b32 v176, v220, v196
v_bfi_b32 v180, v220, 0, v196
v_and_b32 v177, v221, v197
v_bfi_b32 v181, v221, 0, v197
s_not_b64 exec, exec
v_and_b32 v178, v220, v196
v_bfi_b32 v182, v220, 0, v196
v_and_b32 v179, v221, v197
v_bfi_b32 v183, v221, 0, v197
s_mov_b64 exec, -1
v_permlane16_swap_b32 v176, v180
v_permlane16_swap_b32 v177, v181
v_permlane16_swap_b32 v178, v182
v_permlane16_swap_b32 v179, v183
buffer_load_dwordx4 v[92:95], v225, s[20:23], s54 offen sc1
s_waitcnt lgkmcnt(0)
v_mfma_f32_16x16x32_bf16 v[152:155], v[64:67], v[176:179], 0
v_mfma_f32_16x16x32_bf16 v[156:159], v[68:71], v[180:183], 0
v_mfma_f32_16x16x32_bf16 v[160:163], v[72:75], v[176:179], 0
v_mfma_f32_16x16x32_bf16 v[164:167], v[76:79], v[180:183], 0
s_nop 4
v_cvt_pk_bf16_f32 v196, v152, v153
v_cvt_pk_bf16_f32 v197, v154, v155
v_cvt_pk_bf16_f32 v198, v156, v157
v_cvt_pk_bf16_f32 v199, v158, v159
s_cmp_eq_u32 s41, 1
s_cbranch_scc0 L_gl_3g
buffer_store_dwordx4 v[196:199], v226, s[20:23], 0 offen
L_gl_3b:
v_cvt_pk_bf16_f32 v80, v160, v161
v_cvt_pk_bf16_f32 v81, v162, v163
v_cvt_pk_bf16_f32 v82, v164, v165
v_cvt_pk_bf16_f32 v83, v166, v167
ds_read_b64_tr_b16 v[104:105], v228 offset:0
ds_read_b64_tr_b16 v[106:107], v228 offset:512
ds_read_b64_tr_b16 v[108:109], v229 offset:0
ds_read_b64_tr_b16 v[110:111], v229 offset:512
ds_read_b64_tr_b16 v[112:113], v230 offset:0
ds_read_b64_tr_b16 v[114:115], v230 offset:512
ds_read_b64_tr_b16 v[116:117], v231 offset:0
ds_read_b64_tr_b16 v[118:119], v231 offset:512
ds_read_b64_tr_b16 v[120:121], v228 offset:8192
ds_read_b64_tr_b16 v[122:123], v228 offset:8704
ds_read_b64_tr_b16 v[124:125], v229 offset:8192
ds_read_b64_tr_b16 v[126:127], v229 offset:8704
ds_read_b64_tr_b16 v[128:129], v230 offset:8192
ds_read_b64_tr_b16 v[130:131], v230 offset:8704
ds_read_b64_tr_b16 v[132:133], v231 offset:8192
ds_read_b64_tr_b16 v[134:135], v231 offset:8704
ds_read_b64_tr_b16 v[136:137], v228 offset:16384
ds_read_b64_tr_b16 v[138:139], v228 offset:16896
ds_read_b64_tr_b16 v[140:141], v229 offset:16384
ds_read_b64_tr_b16 v[142:143], v229 offset:16896
ds_read_b64_tr_b16 v[144:145], v230 offset:16384
ds_read_b64_tr_b16 v[146:147], v230 offset:16896
ds_read_b64_tr_b16 v[148:149], v231 offset:16384
ds_read_b64_tr_b16 v[150:151], v231 offset:16896
s_waitcnt vmcnt(1)
v_cmp_eq_u32 vcc, -1, v94
s_cbranch_vccnz L_h0rh
L_h0gh:
v_mov_b32 v1, 1744
v_mov_b32 v4, 1
s_mov_b64 exec, 1
ds_add_u32 v1, v4
s_mov_b64 exec, -1
v_perm_b32 v92, v92, v93, s56
v_add_f32 v193, v3, v93
v_add_f32 v194, v194, v94
v_add_f32 v195, v195, v95
v_add_f32 v192, v2, v92
v_fma_f32 v192, v192, v168, v169
v_fma_f32 v193, v193, v170, v171
v_fma_f32 v194, v194, v172, v173
v_fma_f32 v195, v195, v174, v175
v_max3_f32 v6, v192, v193, v194
v_max_f32 v6, v6, v195
v_mov_b32 v7, v6
s_nop 1
v_permlane32_swap_b32 v6, v7
v_max_f32 v6, v6, v7
v_mul_f32 v6, v6, v5
v_fma_f32 v192, v192, v5, -v6
v_fma_f32 v193, v193, v5, -v6
v_fma_f32 v194, v194, v5, -v6
v_fma_f32 v195, v195, v5, -v6
v_exp_f32 v192, v192
v_exp_f32 v193, v193
v_exp_f32 v194, v194
v_exp_f32 v195, v195
buffer_load_dwordx4 v[24:27], v227, s[20:23], s61 offen offset:0 sc1
buffer_load_dwordx4 v[28:31], v227, s[20:23], s61 offen offset:256 sc1
buffer_load_dwordx4 v[32:35], v227, s[20:23], s61 offen offset:512 sc1
buffer_load_dwordx4 v[36:39], v227, s[20:23], s61 offen offset:768 sc1
buffer_load_dwordx4 v[40:43], v227, s[20:23], s61 offen offset:1024 sc1
buffer_load_dwordx4 v[44:47], v227, s[20:23], s62 offen offset:0 sc1
v_add_f32 v6, v192, v193
v_add_f32 v7, v194, v195
v_add_f32 v6, v6, v7
v_mov_b32 v7, v6
v_mul_f32 v192, v192, v168
v_mul_f32 v193, v193, v170
v_permlane32_swap_b32 v6, v7
v_mul_f32 v194, v194, v172
v_add_f32 v6, v6, v7
v_rcp_f32 v6, v6
v_mul_f32 v195, v195, v174
v_mul_f32 v192, v192, v6
v_mul_f32 v193, v193, v6
v_mul_f32 v194, v194, v6
v_mul_f32 v195, v195, v6
v_cvt_pk_bf16_f32 v192, v192, v193
v_cvt_pk_bf16_f32 v193, v194, v195
s_mov_b64 exec, s[52:53]
v_and_b32 v184, v220, v192
v_bfi_b32 v188, v220, 0, v192
v_and_b32 v185, v221, v193
v_bfi_b32 v189, v221, 0, v193
s_not_b64 exec, exec
v_and_b32 v186, v220, v192
v_bfi_b32 v190, v220, 0, v192
v_and_b32 v187, v221, v193
v_bfi_b32 v191, v221, 0, v193
s_mov_b64 exec, -1
v_permlane16_swap_b32 v184, v188
v_permlane16_swap_b32 v185, v189
v_permlane16_swap_b32 v186, v190
v_permlane16_swap_b32 v187, v191
s_nop 1
v_mfma_f32_16x16x32_bf16 v[152:155], v[72:75], v[184:187], 0
v_mfma_f32_16x16x32_bf16 v[156:159], v[76:79], v[184:187], 0
v_mfma_f32_16x16x32_bf16 v[160:163], v[76:79], v[188:191], 0
ds_read_b32 v1, v1
s_mov_b32 exec_lo, 0xffff0000
s_nop 3
v_cvt_pk_bf16_f32 v80, v152, v153
v_cvt_pk_bf16_f32 v81, v154, v155
v_cvt_pk_bf16_f32 v82, v156, v157
v_cvt_pk_bf16_f32 v83, v158, v159
s_mov_b64 exec, s[100:101]
v_cvt_pk_bf16_f32 v82, v160, v161
v_cvt_pk_bf16_f32 v83, v162, v163
s_mov_b64 exec, -1
s_cmp_eq_u32 s41, 1
s_cbranch_scc0 L_gl_4g
buffer_store_dwordx4 v[80:83], v226, s[20:23], s54 offen
L_gl_4b:
s_lshl_b32 s0, s38, 12
s_add_u32 s0, s0, 57344
v_add_u32 v4, s0, v233
s_and_b32 s0, s38, 2
s_lshl_b32 s0, s0, 1
s_add_u32 s0, s0, 1760
v_mov_b32 v3, s0
v_mov_b32 v5, 1
s_waitcnt lgkmcnt(0)
v_cmp_ne_u32 vcc, 4, v1
s_cbranch_vccnz L_spw
L_sbw:
s_waitcnt vmcnt(5)
v_max_u16 v2, v24, v28
v_cmp_eq_u16 vcc, -1, v2
s_cbranch_vccnz L_st0
L_go0:
v_mfma_f32_16x16x32_bf16 v[8:11], v[104:107], v[24:27], v[8:11]
buffer_load_dwordx4 v[48:51], v236, s[20:23], s62 offen offset:0 sc1
ds_read_b64_tr_b16 v[152:153], v228 offset:24576
v_mfma_f32_16x16x32_bf16 v[12:15], v[108:111], v[24:27], v[12:15]
ds_read_b64_tr_b16 v[154:155], v228 offset:25088
ds_read_b64_tr_b16 v[156:157], v229 offset:24576
v_mfma_f32_16x16x32_bf16 v[16:19], v[112:115], v[24:27], v[16:19]
ds_read_b64_tr_b16 v[158:159], v229 offset:25088
ds_read_b64_tr_b16 v[160:161], v230 offset:24576
v_mfma_f32_16x16x32_bf16 v[20:23], v[116:119], v[24:27], v[20:23]
ds_read_b64_tr_b16 v[162:163], v230 offset:25088
ds_read_b64_tr_b16 v[164:165], v231 offset:24576
v_mfma_f32_16x16x32_bf16 v[8:11], v[120:123], v[28:31], v[8:11]
buffer_load_dwordx4 v[52:55], v227, s[20:23], s62 offen offset:256 sc1
ds_read_b64_tr_b16 v[166:167], v231 offset:25088
v_mfma_f32_16x16x32_bf16 v[12:15], v[124:127], v[28:31], v[12:15]
ds_read_b64_tr_b16 v[168:169], v228 offset:32768
ds_read_b64_tr_b16 v[170:171], v228 offset:33280
s_waitcnt vmcnt(5)
v_max_u16 v2, v32, v36
v_cmp_eq_u16 vcc, -1, v2
v_mfma_f32_16x16x32_bf16 v[16:19], v[128:131], v[28:31], v[16:19]
ds_read_b64_tr_b16 v[172:173], v229 offset:32768
ds_read_b64_tr_b16 v[174:175], v229 offset:33280
s_cbranch_vccnz L_st1
L_go1:
v_mfma_f32_16x16x32_bf16 v[20:23], v[132:135], v[28:31], v[20:23]
ds_read_b64_tr_b16 v[176:177], v230 offset:32768
ds_read_b64_tr_b16 v[178:179], v230 offset:33280
v_mfma_f32_16x16x32_bf16 v[8:11], v[136:139], v[32:35], v[8:11]
buffer_load_dwordx4 v[56:59], v236, s[20:23], s62 offen offset:256 sc1
ds_read_b64_tr_b16 v[180:181], v231 offset:32768
v_mfma_f32_16x16x32_bf16 v[12:15], v[140:143], v[32:35], v[12:15]
ds_read_b64_tr_b16 v[182:183], v231 offset:33280
v_add_u32 v228, s65, v228
ds_read_b64_tr_b16 v[184:185], v228 offset:0
v_mfma_f32_16x16x32_bf16 v[16:19], v[144:147], v[32:35], v[16:19]
ds_read_b64_tr_b16 v[186:187], v228 offset:512
v_add_u32 v229, s65, v229
ds_read_b64_tr_b16 v[188:189], v229 offset:0
v_mfma_f32_16x16x32_bf16 v[20:23], v[148:151], v[32:35], v[20:23]
ds_read_b64_tr_b16 v[190:191], v229 offset:512
v_add_u32 v230, s65, v230
ds_read_b64_tr_b16 v[192:193], v230 offset:0
s_waitcnt lgkmcnt(13)
v_mfma_f32_16x16x32_bf16 v[8:11], v[152:155], v[36:39], v[8:11]
buffer_load_dwordx4 v[60:63], v227, s[20:23], s62 offen offset:512 sc1
ds_read_b64_tr_b16 v[194:195], v230 offset:512
v_mfma_f32_16x16x32_bf16 v[12:15], v[156:159], v[36:39], v[12:15]
buffer_load_dwordx4 v[64:67], v236, s[20:23], s62 offen offset:512 sc1
v_add_u32 v231, s65, v231
ds_read_b64_tr_b16 v[196:197], v231 offset:0
s_waitcnt vmcnt(7)
v_cmp_eq_u16 vcc, -1, v40
v_mfma_f32_16x16x32_bf16 v[16:19], v[160:163], v[36:39], v[16:19]
ds_read_b64_tr_b16 v[198:199], v231 offset:512
ds_read_b64_tr_b16 v[104:105], v228 offset:8192
s_cbranch_vccnz L_st2
L_go2:
v_mfma_f32_16x16x32_bf16 v[20:23], v[164:167], v[36:39], v[20:23]
ds_read_b64_tr_b16 v[106:107], v228 offset:8704
ds_read_b64_tr_b16 v[108:109], v229 offset:8192
s_waitcnt lgkmcnt(11)
v_mfma_f32_16x16x32_bf16 v[8:11], v[168:171], v[40:43], v[8:11]
buffer_load_dwordx4 v[68:71], v227, s[20:23], s62 offen offset:768 sc1
ds_read_b64_tr_b16 v[110:111], v229 offset:8704
v_mfma_f32_16x16x32_bf16 v[12:15], v[172:175], v[40:43], v[12:15]
buffer_load_dwordx4 v[72:75], v236, s[20:23], s62 offen offset:768 sc1
ds_read_b64_tr_b16 v[112:113], v230 offset:8192
s_waitcnt vmcnt(6)
v_max_u16 v2, v44, v48
v_cmp_eq_u16 vcc, -1, v2
v_mfma_f32_16x16x32_bf16 v[16:19], v[176:179], v[40:43], v[16:19]
ds_read_b64_tr_b16 v[114:115], v230 offset:8704
ds_read_b64_tr_b16 v[116:117], v231 offset:8192
s_cbranch_vccnz L_st3
L_go3:
v_mfma_f32_16x16x32_bf16 v[20:23], v[180:183], v[40:43], v[20:23]
ds_read_b64_tr_b16 v[118:119], v231 offset:8704
ds_read_b64_tr_b16 v[120:121], v228 offset:16384
s_waitcnt lgkmcnt(9)
v_mfma_f32_16x16x32_bf16 v[8:11], v[184:187], v[44:47], v[8:11]
buffer_load_dwordx4 v[76:79], v227, s[20:23], s62 offen offset:1024 sc1
ds_read_b64_tr_b16 v[122:123], v228 offset:16896
v_mfma_f32_16x16x32_bf16 v[200:203], v[184:187], v[48:51], 0
ds_read_b64_tr_b16 v[124:125], v229 offset:16384
ds_read_b64_tr_b16 v[126:127], v229 offset:16896
v_mfma_f32_16x16x32_bf16 v[12:15], v[188:191], v[44:47], v[12:15]
ds_read_b64_tr_b16 v[128:129], v230 offset:16384
ds_read_b64_tr_b16 v[130:131], v230 offset:16896
v_mfma_f32_16x16x32_bf16 v[204:207], v[188:191], v[48:51], 0
ds_read_b64_tr_b16 v[132:133], v231 offset:16384
ds_read_b64_tr_b16 v[134:135], v231 offset:16896
v_mfma_f32_16x16x32_bf16 v[16:19], v[192:195], v[44:47], v[16:19]
buffer_load_dwordx4 v[80:83], v236, s[20:23], s62 offen offset:1024 sc1
ds_read_b64_tr_b16 v[136:137], v228 offset:24576
v_mfma_f32_16x16x32_bf16 v[208:211], v[192:195], v[48:51], 0
ds_read_b64_tr_b16 v[138:139], v228 offset:25088
s_waitcnt vmcnt(6)
v_max_u16 v2, v52, v56
v_cmp_eq_u16 vcc, -1, v2
v_mfma_f32_16x16x32_bf16 v[20:23], v[196:199], v[44:47], v[20:23]
ds_read_b64_tr_b16 v[140:141], v229 offset:24576
s_cbranch_vccnz L_st4
L_go4:
v_mfma_f32_16x16x32_bf16 v[212:215], v[196:199], v[48:51], 0
ds_read_b64_tr_b16 v[142:143], v229 offset:25088
s_waitcnt lgkmcnt(12)
v_mfma_f32_16x16x32_bf16 v[8:11], v[104:107], v[52:55], v[8:11]
buffer_load_dwordx4 v[84:87], v227, s[20:23], s63 offen offset:0 sc1
ds_read_b64_tr_b16 v[144:145], v230 offset:24576
v_mfma_f32_16x16x32_bf16 v[200:203], v[104:107], v[56:59], v[200:203]
ds_read_b64_tr_b16 v[146:147], v230 offset:25088
ds_read_b64_tr_b16 v[148:149], v231 offset:24576
v_mfma_f32_16x16x32_bf16 v[12:15], v[108:111], v[52:55], v[12:15]
ds_read_b64_tr_b16 v[150:151], v231 offset:25088
ds_read_b64_tr_b16 v[152:153], v228 offset:32768
v_mfma_f32_16x16x32_bf16 v[204:207], v[108:111], v[56:59], v[204:207]
ds_read_b64_tr_b16 v[154:155], v228 offset:33280
ds_read_b64_tr_b16 v[156:157], v229 offset:32768
v_mfma_f32_16x16x32_bf16 v[16:19], v[112:115], v[52:55], v[16:19]
buffer_load_dwordx4 v[88:91], v236, s[20:23], s63 offen offset:0 sc1
ds_read_b64_tr_b16 v[158:159], v229 offset:33280
v_mfma_f32_16x16x32_bf16 v[208:211], v[112:115], v[56:59], v[208:211]
ds_read_b64_tr_b16 v[160:161], v230 offset:32768
s_waitcnt vmcnt(6)
v_max_u16 v2, v60, v64
v_cmp_eq_u16 vcc, -1, v2
v_mfma_f32_16x16x32_bf16 v[20:23], v[116:119], v[52:55], v[20:23]
ds_read_b64_tr_b16 v[162:163], v230 offset:33280
s_cbranch_vccnz L_st5
L_go5:
v_mfma_f32_16x16x32_bf16 v[212:215], v[116:119], v[56:59], v[212:215]
ds_read_b64_tr_b16 v[164:165], v231 offset:32768
s_waitcnt lgkmcnt(15)
v_mfma_f32_16x16x32_bf16 v[8:11], v[120:123], v[60:63], v[8:11]
buffer_load_dwordx4 v[92:95], v227, s[20:23], s63 offen offset:256 sc1
ds_read_b64_tr_b16 v[166:167], v231 offset:33280
v_mfma_f32_16x16x32_bf16 v[200:203], v[120:123], v[64:67], v[200:203]
v_add_u32 v228, 40960, v228
ds_read_b64_tr_b16 v[168:169], v228 offset:0
ds_read_b64_tr_b16 v[170:171], v228 offset:512
v_mfma_f32_16x16x32_bf16 v[12:15], v[124:127], v[60:63], v[12:15]
v_add_u32 v229, 40960, v229
ds_read_b64_tr_b16 v[172:173], v229 offset:0
ds_read_b64_tr_b16 v[174:175], v229 offset:512
v_mfma_f32_16x16x32_bf16 v[204:207], v[124:127], v[64:67], v[204:207]
v_add_u32 v230, 40960, v230
ds_read_b64_tr_b16 v[176:177], v230 offset:0
ds_read_b64_tr_b16 v[178:179], v230 offset:512
v_mfma_f32_16x16x32_bf16 v[16:19], v[128:131], v[60:63], v[16:19]
buffer_load_dwordx4 v[96:99], v236, s[20:23], s63 offen offset:256 sc1
v_add_u32 v231, 40960, v231
ds_read_b64_tr_b16 v[180:181], v231 offset:0
v_mfma_f32_16x16x32_bf16 v[208:211], v[128:131], v[64:67], v[208:211]
ds_read_b64_tr_b16 v[182:183], v231 offset:512
s_waitcnt vmcnt(6)
v_max_u16 v2, v68, v72
v_cmp_eq_u16 vcc, -1, v2
v_mfma_f32_16x16x32_bf16 v[20:23], v[132:135], v[60:63], v[20:23]
ds_read_b64_tr_b16 v[184:185], v228 offset:8192
s_cbranch_vccnz L_st6
L_go6:
v_mfma_f32_16x16x32_bf16 v[212:215], v[132:135], v[64:67], v[212:215]
ds_read_b64_tr_b16 v[186:187], v228 offset:8704
s_waitcnt lgkmcnt(15)
v_mfma_f32_16x16x32_bf16 v[8:11], v[136:139], v[68:71], v[8:11]
buffer_load_dwordx4 v[100:103], v227, s[20:23], s63 offen offset:512 sc1
ds_read_b64_tr_b16 v[188:189], v229 offset:8192
v_mfma_f32_16x16x32_bf16 v[200:203], v[136:139], v[72:75], v[200:203]
ds_read_b64_tr_b16 v[190:191], v229 offset:8704
ds_read_b64_tr_b16 v[192:193], v230 offset:8192
v_mfma_f32_16x16x32_bf16 v[12:15], v[140:143], v[68:71], v[12:15]
ds_read_b64_tr_b16 v[194:195], v230 offset:8704
ds_read_b64_tr_b16 v[196:197], v231 offset:8192
v_mfma_f32_16x16x32_bf16 v[204:207], v[140:143], v[72:75], v[204:207]
ds_read_b64_tr_b16 v[198:199], v231 offset:8704
ds_read_b64_tr_b16 v[104:105], v228 offset:16384
v_mfma_f32_16x16x32_bf16 v[16:19], v[144:147], v[68:71], v[16:19]
buffer_load_dwordx4 v[24:27], v236, s[20:23], s63 offen offset:512 sc1
ds_read_b64_tr_b16 v[106:107], v228 offset:16896
v_mfma_f32_16x16x32_bf16 v[208:211], v[144:147], v[72:75], v[208:211]
ds_read_b64_tr_b16 v[108:109], v229 offset:16384
s_waitcnt vmcnt(6)
v_max_u16 v2, v76, v80
v_cmp_eq_u16 vcc, -1, v2
v_mfma_f32_16x16x32_bf16 v[20:23], v[148:151], v[68:71], v[20:23]
ds_read_b64_tr_b16 v[110:111], v229 offset:16896
s_cbranch_vccnz L_st7
L_go7:
v_mfma_f32_16x16x32_bf16 v[212:215], v[148:151], v[72:75], v[212:215]
ds_read_b64_tr_b16 v[112:113], v230 offset:16384
s_waitcnt lgkmcnt(15)
v_mfma_f32_16x16x32_bf16 v[8:11], v[152:155], v[76:79], v[8:11]
buffer_load_dwordx4 v[28:31], v227, s[20:23], s63 offen offset:768 sc1
ds_read_b64_tr_b16 v[114:115], v230 offset:16896
v_mfma_f32_16x16x32_bf16 v[200:203], v[152:155], v[80:83], v[200:203]
ds_read_b64_tr_b16 v[116:117], v231 offset:16384
ds_read_b64_tr_b16 v[118:119], v231 offset:16896
v_mfma_f32_16x16x32_bf16 v[12:15], v[156:159], v[76:79], v[12:15]
ds_read_b64_tr_b16 v[120:121], v228 offset:24576
ds_read_b64_tr_b16 v[122:123], v228 offset:25088
v_mfma_f32_16x16x32_bf16 v[204:207], v[156:159], v[80:83], v[204:207]
ds_read_b64_tr_b16 v[124:125], v229 offset:24576
ds_read_b64_tr_b16 v[126:127], v229 offset:25088
v_mfma_f32_16x16x32_bf16 v[16:19], v[160:163], v[76:79], v[16:19]
buffer_load_dwordx4 v[32:35], v236, s[20:23], s63 offen offset:768 sc1
ds_read_b64_tr_b16 v[128:129], v230 offset:24576
v_mfma_f32_16x16x32_bf16 v[208:211], v[160:163], v[80:83], v[208:211]
ds_read_b64_tr_b16 v[130:131], v230 offset:25088
s_waitcnt vmcnt(6)
v_max_u16 v2, v84, v88
v_cmp_eq_u16 vcc, -1, v2
v_mfma_f32_16x16x32_bf16 v[20:23], v[164:167], v[76:79], v[20:23]
ds_read_b64_tr_b16 v[132:133], v231 offset:24576
s_cbranch_vccnz L_st8
L_go8:
v_mfma_f32_16x16x32_bf16 v[212:215], v[164:167], v[80:83], v[212:215]
ds_read_b64_tr_b16 v[134:135], v231 offset:25088
s_waitcnt lgkmcnt(15)
v_mfma_f32_16x16x32_bf16 v[8:11], v[168:171], v[84:87], v[8:11]
buffer_load_dwordx4 v[36:39], v227, s[20:23], s63 offen offset:1024 sc1
ds_read_b64_tr_b16 v[136:137], v228 offset:32768
v_mfma_f32_16x16x32_bf16 v[200:203], v[168:171], v[88:91], v[200:203]
ds_read_b64_tr_b16 v[138:139], v228 offset:33280
ds_read_b64_tr_b16 v[140:141], v229 offset:32768
v_mfma_f32_16x16x32_bf16 v[12:15], v[172:175], v[84:87], v[12:15]
ds_read_b64_tr_b16 v[142:143], v229 offset:33280
ds_read_b64_tr_b16 v[144:145], v230 offset:32768
v_mfma_f32_16x16x32_bf16 v[204:207], v[172:175], v[88:91], v[204:207]
ds_read_b64_tr_b16 v[146:147], v230 offset:33280
ds_read_b64_tr_b16 v[148:149], v231 offset:32768
v_mfma_f32_16x16x32_bf16 v[16:19], v[176:179], v[84:87], v[16:19]
buffer_load_dwordx4 v[40:43], v236, s[20:23], s63 offen offset:1024 sc1
ds_read_b64_tr_b16 v[150:151], v231 offset:33280
v_mfma_f32_16x16x32_bf16 v[208:211], v[176:179], v[88:91], v[208:211]
v_subrev_u32 v228, s65, v228
ds_read_b64_tr_b16 v[152:153], v228 offset:0
s_waitcnt vmcnt(6)
v_max_u16 v2, v92, v96
v_cmp_eq_u16 vcc, -1, v2
v_mfma_f32_16x16x32_bf16 v[20:23], v[180:183], v[84:87], v[20:23]
ds_read_b64_tr_b16 v[154:155], v228 offset:512
s_cbranch_vccnz L_st9
L_go9:
v_mfma_f32_16x16x32_bf16 v[212:215], v[180:183], v[88:91], v[212:215]
v_subrev_u32 v229, s65, v229
ds_read_b64_tr_b16 v[156:157], v229 offset:0
v_mfma_f32_16x16x32_bf16 v[8:11], v[184:187], v[92:95], v[8:11]
buffer_load_dwordx4 v[44:47], v227, s[20:23], s64 offen offset:0 sc1
ds_read_b64_tr_b16 v[158:159], v229 offset:512
v_mfma_f32_16x16x32_bf16 v[200:203], v[184:187], v[96:99], v[200:203]
v_subrev_u32 v230, s65, v230
ds_read_b64_tr_b16 v[160:161], v230 offset:0
ds_read_b64_tr_b16 v[162:163], v230 offset:512
v_mfma_f32_16x16x32_bf16 v[12:15], v[188:191], v[92:95], v[12:15]
v_subrev_u32 v231, s65, v231
ds_read_b64_tr_b16 v[164:165], v231 offset:0
ds_read_b64_tr_b16 v[166:167], v231 offset:512
v_mfma_f32_16x16x32_bf16 v[204:207], v[188:191], v[96:99], v[204:207]
ds_read_b64_tr_b16 v[168:169], v228 offset:8192
ds_read_b64_tr_b16 v[170:171], v228 offset:8704
v_mfma_f32_16x16x32_bf16 v[16:19], v[192:195], v[92:95], v[16:19]
buffer_load_dwordx4 v[48:51], v227, s[20:23], s64 offen offset:256 sc1
ds_read_b64_tr_b16 v[172:173], v229 offset:8192
v_mfma_f32_16x16x32_bf16 v[208:211], v[192:195], v[96:99], v[208:211]
ds_read_b64_tr_b16 v[174:175], v229 offset:8704
s_waitcnt vmcnt(6)
v_max_u16 v2, v100, v24
v_cmp_eq_u16 vcc, -1, v2
v_mfma_f32_16x16x32_bf16 v[20:23], v[196:199], v[92:95], v[20:23]
ds_read_b64_tr_b16 v[176:177], v230 offset:8192
s_cbranch_vccnz L_st10
L_go10:
v_mfma_f32_16x16x32_bf16 v[212:215], v[196:199], v[96:99], v[212:215]
ds_read_b64_tr_b16 v[178:179], v230 offset:8704
s_waitcnt lgkmcnt(15)
v_mfma_f32_16x16x32_bf16 v[8:11], v[104:107], v[100:103], v[8:11]
buffer_load_dwordx4 v[52:55], v227, s[20:23], s64 offen offset:512 sc1
ds_read_b64_tr_b16 v[180:181], v231 offset:8192
v_mfma_f32_16x16x32_bf16 v[200:203], v[104:107], v[24:27], v[200:203]
ds_read_b64_tr_b16 v[182:183], v231 offset:8704
ds_read_b64_tr_b16 v[184:185], v228 offset:16384
v_mfma_f32_16x16x32_bf16 v[12:15], v[108:111], v[100:103], v[12:15]
ds_read_b64_tr_b16 v[186:187], v228 offset:16896
ds_read_b64_tr_b16 v[188:189], v229 offset:16384
v_mfma_f32_16x16x32_bf16 v[204:207], v[108:111], v[24:27], v[204:207]
ds_read_b64_tr_b16 v[190:191], v229 offset:16896
ds_read_b64_tr_b16 v[192:193], v230 offset:16384
v_mfma_f32_16x16x32_bf16 v[16:19], v[112:115], v[100:103], v[16:19]
buffer_load_dwordx4 v[56:59], v227, s[20:23], s64 offen offset:768 sc1
ds_read_b64_tr_b16 v[194:195], v230 offset:16896
v_mfma_f32_16x16x32_bf16 v[208:211], v[112:115], v[24:27], v[208:211]
ds_read_b64_tr_b16 v[196:197], v231 offset:16384
s_waitcnt vmcnt(6)
v_max_u16 v2, v28, v32
v_cmp_eq_u16 vcc, -1, v2
v_mfma_f32_16x16x32_bf16 v[20:23], v[116:119], v[100:103], v[20:23]
ds_read_b64_tr_b16 v[198:199], v231 offset:16896
s_cbranch_vccnz L_st11
L_go11:
v_mfma_f32_16x16x32_bf16 v[212:215], v[116:119], v[24:27], v[212:215]
ds_read_b64_tr_b16 v[104:105], v228 offset:24576
v_mfma_f32_16x16x32_bf16 v[8:11], v[120:123], v[28:31], v[8:11]
buffer_load_dwordx4 v[60:63], v227, s[20:23], s64 offen offset:1024 sc1
ds_read_b64_tr_b16 v[106:107], v228 offset:25088
v_mfma_f32_16x16x32_bf16 v[200:203], v[120:123], v[32:35], v[200:203]
ds_read_b64_tr_b16 v[108:109], v229 offset:24576
ds_read_b64_tr_b16 v[110:111], v229 offset:25088
v_mfma_f32_16x16x32_bf16 v[12:15], v[124:127], v[28:31], v[12:15]
ds_read_b64_tr_b16 v[112:113], v230 offset:24576
ds_read_b64_tr_b16 v[114:115], v230 offset:25088
v_mfma_f32_16x16x32_bf16 v[204:207], v[124:127], v[32:35], v[204:207]
ds_read_b64_tr_b16 v[116:117], v231 offset:24576
ds_read_b64_tr_b16 v[118:119], v231 offset:25088
v_mfma_f32_16x16x32_bf16 v[16:19], v[128:131], v[28:31], v[16:19]
ds_read_b64_tr_b16 v[120:121], v228 offset:32768
ds_read_b64_tr_b16 v[122:123], v228 offset:33280
v_mfma_f32_16x16x32_bf16 v[208:211], v[128:131], v[32:35], v[208:211]
ds_read_b64_tr_b16 v[124:125], v229 offset:32768
s_waitcnt vmcnt(5)
v_max_u16 v2, v36, v40
v_cmp_eq_u16 vcc, -1, v2
v_mfma_f32_16x16x32_bf16 v[20:23], v[132:135], v[28:31], v[20:23]
ds_read_b64_tr_b16 v[126:127], v229 offset:33280
s_cbranch_vccnz L_st12
L_go12:
v_mfma_f32_16x16x32_bf16 v[212:215], v[132:135], v[32:35], v[212:215]
ds_read_b64_tr_b16 v[128:129], v230 offset:32768
s_waitcnt lgkmcnt(15)
v_mfma_f32_16x16x32_bf16 v[8:11], v[136:139], v[36:39], v[8:11]
ds_read_b64_tr_b16 v[130:131], v230 offset:33280
ds_read_b64_tr_b16 v[132:133], v231 offset:32768
v_mfma_f32_16x16x32_bf16 v[200:203], v[136:139], v[40:43], v[200:203]
ds_read_b64_tr_b16 v[134:135], v231 offset:33280
v_mfma_f32_16x16x32_bf16 v[12:15], v[140:143], v[36:39], v[12:15]
v_mfma_f32_16x16x32_bf16 v[204:207], v[140:143], v[40:43], v[204:207]
v_mfma_f32_16x16x32_bf16 v[16:19], v[144:147], v[36:39], v[16:19]
v_mfma_f32_16x16x32_bf16 v[208:211], v[144:147], v[40:43], v[208:211]
s_waitcnt vmcnt(3)
v_max_u16 v2, v44, v48
v_cmp_eq_u16 vcc, -1, v2
v_mfma_f32_16x16x32_bf16 v[20:23], v[148:151], v[36:39], v[20:23]
s_cbranch_vccnz L_st13
L_go13:
v_mfma_f32_16x16x32_bf16 v[212:215], v[148:151], v[40:43], v[212:215]
v_mfma_f32_16x16x32_bf16 v[8:11], v[152:155], v[44:47], v[8:11]
v_mfma_f32_16x16x32_bf16 v[12:15], v[156:159], v[44:47], v[12:15]
ds_write_b128 v4, v[200:203] offset:0
v_mfma_f32_16x16x32_bf16 v[16:19], v[160:163], v[44:47], v[16:19]
ds_write_b128 v4, v[204:207] offset:1024
v_mfma_f32_16x16x32_bf16 v[20:23], v[164:167], v[44:47], v[20:23]
ds_write_b128 v4, v[208:211] offset:2048
v_mfma_f32_16x16x32_bf16 v[8:11], v[168:171], v[48:51], v[8:11]
v_mfma_f32_16x16x32_bf16 v[12:15], v[172:175], v[48:51], v[12:15]
ds_write_b128 v4, v[212:215] offset:3072
s_waitcnt vmcnt(1)
v_max_u16 v2, v52, v56
v_cmp_eq_u16 vcc, -1, v2
v_mfma_f32_16x16x32_bf16 v[16:19], v[176:179], v[48:51], v[16:19]
s_mov_b64 exec, 1
ds_add_u32 v3, v5
s_mov_b64 exec, -1
s_cbranch_vccnz L_st14
L_go14:
v_mfma_f32_16x16x32_bf16 v[20:23], v[180:183], v[48:51], v[20:23]
s_waitcnt lgkmcnt(15)
v_mfma_f32_16x16x32_bf16 v[8:11], v[184:187], v[52:55], v[8:11]
v_mfma_f32_16x16x32_bf16 v[12:15], v[188:191], v[52:55], v[12:15]
v_mfma_f32_16x16x32_bf16 v[16:19], v[192:195], v[52:55], v[16:19]
v_mfma_f32_16x16x32_bf16 v[20:23], v[196:199], v[52:55], v[20:23]
s_waitcnt lgkmcnt(13)
v_mfma_f32_16x16x32_bf16 v[8:11], v[104:107], v[56:59], v[8:11]
v_mfma_f32_16x16x32_bf16 v[12:15], v[108:111], v[56:59], v[12:15]
s_waitcnt vmcnt(0)
v_cmp_eq_u16 vcc, -1, v60
v_mfma_f32_16x16x32_bf16 v[16:19], v[112:115], v[56:59], v[16:19]
s_cbranch_vccnz L_st15
L_go15:
v_mfma_f32_16x16x32_bf16 v[20:23], v[116:119], v[56:59], v[20:23]
s_waitcnt lgkmcnt(11)
v_mfma_f32_16x16x32_bf16 v[8:11], v[120:123], v[60:63], v[8:11]
s_waitcnt lgkmcnt(9)
v_mfma_f32_16x16x32_bf16 v[12:15], v[124:127], v[60:63], v[12:15]
s_waitcnt lgkmcnt(7)
v_mfma_f32_16x16x32_bf16 v[16:19], v[128:131], v[60:63], v[16:19]
s_waitcnt lgkmcnt(5)
v_mfma_f32_16x16x32_bf16 v[20:23], v[132:135], v[60:63], v[20:23]
L_tail:
s_nop 1
v_cvt_pk_bf16_f32 v24, v8, v9
v_cvt_pk_bf16_f32 v25, v10, v11
v_cvt_pk_bf16_f32 v26, v12, v13
v_cvt_pk_bf16_f32 v27, v14, v15
v_cvt_pk_bf16_f32 v28, v16, v17
v_cvt_pk_bf16_f32 v29, v18, v19
v_cvt_pk_bf16_f32 v30, v20, v21
v_cvt_pk_bf16_f32 v31, v22, v23
v_mfma_f32_16x16x32_bf16 v[36:39], v[24:27], v[24:27], 0
v_mfma_f32_16x16x32_bf16 v[32:35], v[244:247], v[24:27], 0
v_mfma_f32_16x16x32_bf16 v[36:39], v[28:31], v[28:31], v[36:39]
v_mfma_f32_16x16x32_bf16 v[32:35], v[248:251], v[28:31], v[32:35]
s_mov_b32 s0, 0x22222222
s_mov_b32 s1, s0
s_mov_b32 s44, 0x44444444
s_mov_b32 s45, s44
s_mov_b32 vcc_lo, 0x88888888
s_mov_b32 vcc_hi, 0x88888888
s_lshl_b32 s3, s36, 8
s_add_u32 s3, s3, s58
v_and_b32 v1, 0xf0, v233
v_cndmask_b32 v36, v36, v37, s[0:1]
v_cndmask_b32 v38, v38, v39, vcc
s_or_b64 vcc, vcc, s[44:45]
v_cndmask_b32 v34, v36, v38, vcc
v_mov_b32 v35, v253
s_mov_b32 exec_lo, 0xf0000f
s_mov_b32 exec_hi, 0xf0000f00
s_cmp_eq_u32 s41, 1
s_cbranch_scc0 L_gl_5g
buffer_store_dwordx4 v[32:35], v1, s[16:19], s3 offen
L_gl_5b:
s_mov_b64 exec, -1
v_mov_b32 v48, 0
v_mov_b32 v49, 0
v_mov_b32 v50, 0
v_mov_b32 v51, 0
v_mov_b32 v4, 1.0
s_mov_b32 s0, 0xbacccccd
s_mov_b32 s1, 0x3acccccd
v_mov_b32 v5, 0x3727c5ac
s_mov_b32 s44, 0xfffff800
v_mov_b32 v1, 1732
v_cmp_le_i32 s[46:47], 0, v232
L_e2:
buffer_load_dwordx4 v[40:43], v233, s[16:19], s58 offen sc1
buffer_load_dwordx4 v[44:47], v233, s[16:19], s58 offen offset:1024 sc1
s_mov_b32 exec_hi, 0
buffer_load_dwordx4 v[48:51], v233, s[16:19], s58 offen offset:2048 sc1
s_mov_b32 exec_hi, -1
s_waitcnt vmcnt(1)
v_pk_add_f32 v[40:41], v[40:41], v[44:45]
v_pk_add_f32 v[42:43], v[42:43], v[46:47]
s_waitcnt vmcnt(0)
v_pk_add_f32 v[40:41], v[40:41], v[48:49]
v_pk_add_f32 v[42:43], v[42:43], v[50:51]
v_cmp_u_f32 vcc, v40, v40
s_cbranch_vccnz L_e2r
L_e2go:
v_mfma_f32_16x16x4_f32 v[52:55], v4, v40, 0
v_mfma_f32_16x16x4_f32 v[60:63], v4, v42, 0
v_mfma_f32_16x16x4_f32 v[64:67], v4, v43, 0
v_mfma_f32_16x16x4_f32 v[56:59], v4, v41, 0
s_nop 6
v_mul_f32 v6, s0, v52
v_fma_f32 v7, v60, s1, v5
v_fma_f32 v7, -v6, v6, v7
v_max_f32 v7, v7, v5
v_rsq_f32 v2, v7
v_fma_f32 v7, v6, v64, v56
v_mul_f32 v7, v7, v2
v_mul_f32 v3, v6, v2
v_ashrrev_i32 v6, 31, v7
v_or_b32 v6, 0x80000000, v6
v_xor_b32 v7, v7, v6
v_and_or_b32 v7, v7, s44, v234
v_cndmask_b32 v7, 0, v7, s[46:47]
v_pk_fma_f32 v[72:73], v[8:9], v[2:3], v[2:3] op_sel:[0,0,1] op_sel_hi:[1,0,1]
v_pk_fma_f32 v[74:75], v[10:11], v[2:3], v[2:3] op_sel:[0,0,1] op_sel_hi:[1,0,1]
v_max_u32_dpp v6, v7, v7 row_ror:8 row_mask:0xf bank_mask:0xf
v_pk_fma_f32 v[76:77], v[12:13], v[2:3], v[2:3] op_sel:[0,0,1] op_sel_hi:[1,0,1]
v_pk_fma_f32 v[78:79], v[14:15], v[2:3], v[2:3] op_sel:[0,0,1] op_sel_hi:[1,0,1]
v_max_u32_dpp v6, v6, v6 row_ror:4 row_mask:0xf bank_mask:0xf
v_pk_fma_f32 v[80:81], v[16:17], v[2:3], v[2:3] op_sel:[0,0,1] op_sel_hi:[1,0,1]
v_pk_fma_f32 v[82:83], v[18:19], v[2:3], v[2:3] op_sel:[0,0,1] op_sel_hi:[1,0,1]
v_max_u32_dpp v6, v6, v6 row_ror:2 row_mask:0xf bank_mask:0xf
v_pk_fma_f32 v[84:85], v[20:21], v[2:3], v[2:3] op_sel:[0,0,1] op_sel_hi:[1,0,1]
v_pk_fma_f32 v[86:87], v[22:23], v[2:3], v[2:3] op_sel:[0,0,1] op_sel_hi:[1,0,1]
v_max_u32_dpp v6, v6, v6 row_ror:1 row_mask:0xf bank_mask:0xf
s_mov_b64 exec, 1
ds_max_u32 v1, v6
s_mov_b64 exec, -1
v_cvt_pk_bf16_f32 v88, v72, v73
v_cvt_pk_bf16_f32 v89, v74, v75
v_cvt_pk_bf16_f32 v90, v76, v77
v_cvt_pk_bf16_f32 v91, v78, v79
v_cvt_pk_bf16_f32 v92, v80, v81
v_cvt_pk_bf16_f32 v93, v82, v83
v_cvt_pk_bf16_f32 v94, v84, v85
v_cvt_pk_bf16_f32 v95, v86, v87
s_mul_i32 s0, s35, 1280
s_lshl_b32 s3, s36, 7
s_add_u32 s0, s0, s3
s_lshl_b32 s1, s0, 1
s_add_u32 s0, s0, s59
s_add_u32 s1, s1, s59
s_add_u32 s1, s1, 4096
s_lshl_b32 s3, s35, 7
s_add_u32 s3, s3, s59
s_add_u32 s3, s3, 21504
s_lshl_b32 s44, s36, 3
s_add_u32 s44, s44, s32
v_mul_u32_u24 v6, 384, v0
v_and_b32 v5, 48, v0
v_lshlrev_b32 v4, 1, v5
s_waitcnt lgkmcnt(0)
s_barrier
ds_read_b32 v1, v1
v_pk_add_f32 v[72:73], v[72:73], v[8:9]
v_pk_add_f32 v[74:75], v[74:75], v[10:11]
v_pk_add_f32 v[76:77], v[76:77], v[12:13]
v_pk_add_f32 v[78:79], v[78:79], v[14:15]
v_pk_add_f32 v[80:81], v[80:81], v[16:17]
v_pk_add_f32 v[82:83], v[82:83], v[18:19]
v_pk_add_f32 v[84:85], v[84:85], v[20:21]
v_pk_add_f32 v[86:87], v[86:87], v[22:23]
s_cmp_eq_u32 s44, 4
s_waitcnt lgkmcnt(0)
v_cmp_eq_u32 s[46:47], v1, v7
s_cbranch_scc0 L_nk
s_mov_b64 exec, 0xffff
buffer_store_dword v1, v6, s[16:19], s3 offen sc1
L_nk:
s_and_b64 exec, s[46:47], -1
s_cbranch_scc0 L_nc
buffer_store_dwordx4 v[88:91], v4, s[16:19], s0 offen sc1
buffer_store_dwordx4 v[92:95], v4, s[16:19], s0 offen offset:16 sc1
L_nc:
s_mov_b64 exec, -1
v_cvt_pk_bf16_f32 v96, v72, v73
v_cvt_pk_bf16_f32 v97, v74, v75
v_cvt_pk_bf16_f32 v98, v76, v77
v_cvt_pk_bf16_f32 v99, v78, v79
v_cvt_pk_bf16_f32 v100, v80, v81
v_cvt_pk_bf16_f32 v101, v82, v83
v_cvt_pk_bf16_f32 v102, v84, v85
v_cvt_pk_bf16_f32 v103, v86, v87
v_permlane16_swap_b32 v96, v98
v_permlane16_swap_b32 v97, v99
v_permlane16_swap_b32 v100, v102
v_permlane16_swap_b32 v101, v103
s_not_b64 exec, s[46:47]
buffer_store_dwordx4 v[96:99], v232, s[20:23], 0 offen offset:0
buffer_store_dwordx4 v[100:103], v232, s[20:23], 0 offen offset:64
s_and_b64 exec, s[46:47], -1
s_cbranch_scc0 L_fin
buffer_store_dwordx4 v[96:99], v232, s[20:23], 0 offen offset:0 sc1
buffer_store_dwordx4 v[100:103], v232, s[20:23], 0 offen offset:64 sc1
s_waitcnt vmcnt(0)
buffer_store_dwordx4 v[72:75], v5, s[16:19], s1 offen offset:0 sc1
buffer_store_dwordx4 v[76:79], v5, s[16:19], s1 offen offset:64 sc1
buffer_store_dwordx4 v[80:83], v5, s[16:19], s1 offen offset:128 sc1
buffer_store_dwordx4 v[84:87], v5, s[16:19], s1 offen offset:192 sc1
L_fin:
s_endpgm
L_era:
s_sub_u32 s40, s40, 1
s_cbranch_scc1 L_exa
s_lshl_b32 s0, s33, 5
buffer_load_dword v54, off, s[24:27], s0 sc1
s_waitcnt vmcnt(0)
v_cmp_ne_u32 vcc, 1, v54
s_cbranch_vccnz L_era
s_branch L_ega
L_exa:
s_mov_b32 s40, 0
s_branch L_ega
L_erb:
s_sub_u32 s40, s40, 1
s_cbranch_scc1 L_exb
buffer_load_dword v54, v55, s[16:19], 0 offen sc1
s_waitcnt vmcnt(0)
v_cmp_eq_u32 vcc, -1, v54
s_cbranch_vccnz L_erb
s_branch L_egb
L_exb:
s_mov_b32 s40, 0
s_branch L_egb
L_gh_1g:
s_barrier
s_cmp_eq_u32 s32, 5
s_cbranch_scc0 L_gh_1e
v_mov_b32 v1, 1
s_mov_b64 exec, 1
buffer_store_dword v1, off, s[16:19], s68 offset:64 sc1
s_mov_b64 exec, -1
L_gh_1p:
buffer_load_dword v1, v55, s[16:19], 0 offen offset:64 sc1
s_waitcnt vmcnt(0)
v_cmp_ne_u32 vcc, 1, v1
s_cbranch_vccz L_gh_1e
s_sub_u32 s40, s40, 1
s_cbranch_scc0 L_gh_1p
s_mov_b32 s40, 0
L_gh_1e:
s_barrier
s_branch L_gh_1b
L_xcap:
v_add_u32 v1, s0, v235
ds_read_b64 v[72:73], v1
v_xor_b32 v2, 32, v1
ds_read_b64 v[74:75], v2
v_xor_b32 v3, 64, v1
ds_read_b64 v[76:77], v3
v_xor_b32 v4, 96, v1
ds_read_b64 v[78:79], v4
s_waitcnt lgkmcnt(0)
v_lshlrev_b32 v8, 16, v72
v_and_b32 v9, 0xffff0000, v72
v_lshlrev_b32 v10, 16, v73
v_and_b32 v11, 0xffff0000, v73
v_lshlrev_b32 v12, 16, v74
v_and_b32 v13, 0xffff0000, v74
v_lshlrev_b32 v14, 16, v75
v_and_b32 v15, 0xffff0000, v75
v_lshlrev_b32 v16, 16, v76
v_and_b32 v17, 0xffff0000, v76
v_lshlrev_b32 v18, 16, v77
v_and_b32 v19, 0xffff0000, v77
v_lshlrev_b32 v20, 16, v78
v_and_b32 v21, 0xffff0000, v78
v_lshlrev_b32 v22, 16, v79
v_and_b32 v23, 0xffff0000, v79
s_setpc_b64 s[100:101]
L_woe1:
s_addk_i32 m0, 4096
s_mov_b32 s3, 0
buffer_load_dwordx4 v57, s[12:15], s3 offen lds
s_addk_i32 m0, 4096
s_mov_b32 s3, 81920
buffer_load_dwordx4 v57, s[12:15], s3 offen lds
s_addk_i32 m0, 4096
s_mov_b32 s3, 163840
buffer_load_dwordx4 v58, s[12:15], s3 offen lds
s_addk_i32 m0, 4096
s_mov_b32 s3, 245760
buffer_load_dwordx4 v60, s[12:15], s3 offen lds
s_addk_i32 m0, 4096
s_mov_b32 s3, 327680
buffer_load_dwordx4 v60, s[12:15], s3 offen lds
s_addk_i32 m0, 4096
s_mov_b32 s3, 409600
buffer_load_dwordx4 v57, s[12:15], s3 offen lds
s_addk_i32 m0, 4096
s_mov_b32 s3, 491520
buffer_load_dwordx4 v57, s[12:15], s3 offen lds
s_addk_i32 m0, 4096
s_mov_b32 s3, 573440
buffer_load_dwordx4 v58, s[12:15], s3 offen lds
s_addk_i32 m0, 4096
s_mov_b32 s3, 655360
buffer_load_dwordx4 v60, s[12:15], s3 offen lds
s_addk_i32 m0, 4096
s_mov_b32 s3, 737280
buffer_load_dwordx4 v60, s[12:15], s3 offen lds
s_branch L_woe
L_woe2:
s_addk_i32 m0, 4096
s_mov_b32 s3, 5120
buffer_load_dwordx4 v57, s[12:15], s3 offen lds
s_addk_i32 m0, 4096
s_mov_b32 s3, 87040
buffer_load_dwordx4 v58, s[12:15], s3 offen lds
s_addk_i32 m0, 4096
s_mov_b32 s3, 168960
buffer_load_dwordx4 v58, s[12:15], s3 offen lds
s_addk_i32 m0, 4096
s_mov_b32 s3, 250880
buffer_load_dwordx4 v60, s[12:15], s3 offen lds
s_addk_i32 m0, 4096
s_mov_b32 s3, 384000
buffer_load_dwordx4 v59, s[12:15], s3 offen lds
s_addk_i32 m0, 4096
s_mov_b32 s3, 414720
buffer_load_dwordx4 v57, s[12:15], s3 offen lds
s_addk_i32 m0, 4096
s_mov_b32 s3, 496640
buffer_load_dwordx4 v58, s[12:15], s3 offen lds
s_addk_i32 m0, 4096
s_mov_b32 s3, 578560
buffer_load_dwordx4 v58, s[12:15], s3 offen lds
s_addk_i32 m0, 4096
s_mov_b32 s3, 660480
buffer_load_dwordx4 v60, s[12:15], s3 offen lds
s_addk_i32 m0, 4096
s_mov_b32 s3, 793600
buffer_load_dwordx4 v59, s[12:15], s3 offen lds
s_branch L_woe
L_woe3:
s_addk_i32 m0, 4096
s_mov_b32 s3, 10240
buffer_load_dwordx4 v58, s[12:15], s3 offen lds
s_addk_i32 m0, 4096
s_mov_b32 s3, 92160
buffer_load_dwordx4 v58, s[12:15], s3 offen lds
s_addk_i32 m0, 4096
s_mov_b32 s3, 174080
buffer_load_dwordx4 v58, s[12:15], s3 offen lds
s_addk_i32 m0, 4096
s_mov_b32 s3, 307200
buffer_load_dwordx4 v59, s[12:15], s3 offen lds
s_addk_i32 m0, 4096
s_mov_b32 s3, 389120
buffer_load_dwordx4 v59, s[12:15], s3 offen lds
s_addk_i32 m0, 4096
s_mov_b32 s3, 419840
buffer_load_dwordx4 v58, s[12:15], s3 offen lds
s_addk_i32 m0, 4096
s_mov_b32 s3, 501760
buffer_load_dwordx4 v58, s[12:15], s3 offen lds
s_addk_i32 m0, 4096
s_mov_b32 s3, 583680
buffer_load_dwordx4 v58, s[12:15], s3 offen lds
s_addk_i32 m0, 4096
s_mov_b32 s3, 716800
buffer_load_dwordx4 v59, s[12:15], s3 offen lds
s_addk_i32 m0, 4096
s_mov_b32 s3, 798720
buffer_load_dwordx4 v59, s[12:15], s3 offen lds
s_branch L_woe
L_gl_2g:
buffer_store_dwordx4 v[192:195], v224, s[20:23], s54 offen sc1
s_branch L_gl_2b
L_gl_3g:
buffer_store_dwordx4 v[196:199], v226, s[20:23], 0 offen sc1
s_branch L_gl_3b
L_h0rh:
s_sub_u32 s40, s40, 1
s_cbranch_scc1 L_h0xh
buffer_load_dwordx4 v[92:95], v225, s[20:23], s54 offen sc1
s_waitcnt vmcnt(0)
v_cmp_eq_u32 vcc, -1, v94
s_cbranch_vccnz L_h0rh
s_branch L_h0gh
L_h0xh:
s_mov_b32 s40, 0
s_branch L_h0gh
L_gl_4g:
buffer_store_dwordx4 v[80:83], v226, s[20:23], s54 offen sc1
s_branch L_gl_4b
L_spw:
v_mov_b32 v1, 1744
ds_read_b32 v1, v1
s_waitcnt lgkmcnt(0)
v_cmp_ne_u32 vcc, 4, v1
s_cbranch_vccnz L_spw
s_branch L_sbw
L_st0:
s_sub_u32 s40, s40, 1
s_cbranch_scc1 L_sx0
buffer_load_dwordx4 v[24:27], v227, s[20:23], s61 offen offset:0 sc1
buffer_load_dwordx4 v[28:31], v227, s[20:23], s61 offen offset:256 sc1
s_waitcnt vmcnt(0)
v_max_u16 v2, v24, v28
v_cmp_eq_u16 vcc, -1, v2
s_cbranch_vccnz L_st0
s_branch L_go0
L_sx0:
s_mov_b32 s40, 0
s_branch L_go0
L_st1:
s_sub_u32 s40, s40, 1
s_cbranch_scc1 L_sx1
buffer_load_dwordx4 v[32:35], v227, s[20:23], s61 offen offset:512 sc1
buffer_load_dwordx4 v[36:39], v227, s[20:23], s61 offen offset:768 sc1
s_waitcnt vmcnt(0)
v_max_u16 v2, v32, v36
v_cmp_eq_u16 vcc, -1, v2
s_cbranch_vccnz L_st1
s_branch L_go1
L_sx1:
s_mov_b32 s40, 0
s_branch L_go1
L_st2:
s_sub_u32 s40, s40, 1
s_cbranch_scc1 L_sx2
buffer_load_dwordx4 v[40:43], v227, s[20:23], s61 offen offset:1024 sc1
s_waitcnt vmcnt(0)
v_cmp_eq_u16 vcc, -1, v40
s_cbranch_vccnz L_st2
s_branch L_go2
L_sx2:
s_mov_b32 s40, 0
s_branch L_go2
L_st3:
s_sub_u32 s40, s40, 1
s_cbranch_scc1 L_sx3
buffer_load_dwordx4 v[44:47], v227, s[20:23], s62 offen offset:0 sc1
buffer_load_dwordx4 v[48:51], v236, s[20:23], s62 offen offset:0 sc1
s_waitcnt vmcnt(0)
v_max_u16 v2, v44, v48
v_cmp_eq_u16 vcc, -1, v2
s_cbranch_vccnz L_st3
s_branch L_go3
L_sx3:
s_mov_b32 s40, 0
s_branch L_go3
L_st4:
s_sub_u32 s40, s40, 1
s_cbranch_scc1 L_sx4
buffer_load_dwordx4 v[52:55], v227, s[20:23], s62 offen offset:256 sc1
buffer_load_dwordx4 v[56:59], v236, s[20:23], s62 offen offset:256 sc1
s_waitcnt vmcnt(0)
v_max_u16 v2, v52, v56
v_cmp_eq_u16 vcc, -1, v2
s_cbranch_vccnz L_st4
s_branch L_go4
L_sx4:
s_mov_b32 s40, 0
s_branch L_go4
L_st5:
s_sub_u32 s40, s40, 1
s_cbranch_scc1 L_sx5
buffer_load_dwordx4 v[60:63], v227, s[20:23], s62 offen offset:512 sc1
buffer_load_dwordx4 v[64:67], v236, s[20:23], s62 offen offset:512 sc1
s_waitcnt vmcnt(0)
v_max_u16 v2, v60, v64
v_cmp_eq_u16 vcc, -1, v2
s_cbranch_vccnz L_st5
s_branch L_go5
L_sx5:
s_mov_b32 s40, 0
s_branch L_go5
L_st6:
s_sub_u32 s40, s40, 1
s_cbranch_scc1 L_sx6
buffer_load_dwordx4 v[68:71], v227, s[20:23], s62 offen offset:768 sc1
buffer_load_dwordx4 v[72:75], v236, s[20:23], s62 offen offset:768 sc1
s_waitcnt vmcnt(0)
v_max_u16 v2, v68, v72
v_cmp_eq_u16 vcc, -1, v2
s_cbranch_vccnz L_st6
s_branch L_go6
L_sx6:
s_mov_b32 s40, 0
s_branch L_go6
L_st7:
s_sub_u32 s40, s40, 1
s_cbranch_scc1 L_sx7
buffer_load_dwordx4 v[76:79], v227, s[20:23], s62 offen offset:1024 sc1
buffer_load_dwordx4 v[80:83], v236, s[20:23], s62 offen offset:1024 sc1
s_waitcnt vmcnt(0)
v_max_u16 v2, v76, v80
v_cmp_eq_u16 vcc, -1, v2
s_cbranch_vccnz L_st7
s_branch L_go7
L_sx7:
s_mov_b32 s40, 0
s_branch L_go7
L_st8:
s_sub_u32 s40, s40, 1
s_cbranch_scc1 L_sx8
buffer_load_dwordx4 v[84:87], v227, s[20:23], s63 offen offset:0 sc1
buffer_load_dwordx4 v[88:91], v236, s[20:23], s63 offen offset:0 sc1
s_waitcnt vmcnt(0)
v_max_u16 v2, v84, v88
v_cmp_eq_u16 vcc, -1, v2
s_cbranch_vccnz L_st8
s_branch L_go8
L_sx8:
s_mov_b32 s40, 0
s_branch L_go8
L_st9:
s_sub_u32 s40, s40, 1
s_cbranch_scc1 L_sx9
buffer_load_dwordx4 v[92:95], v227, s[20:23], s63 offen offset:256 sc1
buffer_load_dwordx4 v[96:99], v236, s[20:23], s63 offen offset:256 sc1
s_waitcnt vmcnt(0)
v_max_u16 v2, v92, v96
v_cmp_eq_u16 vcc, -1, v2
s_cbranch_vccnz L_st9
s_branch L_go9
L_sx9:
s_mov_b32 s40, 0
s_branch L_go9
L_st10:
s_sub_u32 s40, s40, 1
s_cbranch_scc1 L_sx10
buffer_load_dwordx4 v[100:103], v227, s[20:23], s63 offen offset:512 sc1
buffer_load_dwordx4 v[24:27], v236, s[20:23], s63 offen offset:512 sc1
s_waitcnt vmcnt(0)
v_max_u16 v2, v100, v24
v_cmp_eq_u16 vcc, -1, v2
s_cbranch_vccnz L_st10
s_branch L_go10
L_sx10:
s_mov_b32 s40, 0
s_branch L_go10
L_st11:
s_sub_u32 s40, s40, 1
s_cbranch_scc1 L_sx11
buffer_load_dwordx4 v[28:31], v227, s[20:23], s63 offen offset:768 sc1
buffer_load_dwordx4 v[32:35], v236, s[20:23], s63 offen offset:768 sc1
s_waitcnt vmcnt(0)
v_max_u16 v2, v28, v32
v_cmp_eq_u16 vcc, -1, v2
s_cbranch_vccnz L_st11
s_branch L_go11
L_sx11:
s_mov_b32 s40, 0
s_branch L_go11
L_st12:
s_sub_u32 s40, s40, 1
s_cbranch_scc1 L_sx12
buffer_load_dwordx4 v[36:39], v227, s[20:23], s63 offen offset:1024 sc1
buffer_load_dwordx4 v[40:43], v236, s[20:23], s63 offen offset:1024 sc1
s_waitcnt vmcnt(0)
v_max_u16 v2, v36, v40
v_cmp_eq_u16 vcc, -1, v2
s_cbranch_vccnz L_st12
s_branch L_go12
L_sx12:
s_mov_b32 s40, 0
s_branch L_go12
L_st13:
s_sub_u32 s40, s40, 1
s_cbranch_scc1 L_sx13
buffer_load_dwordx4 v[44:47], v227, s[20:23], s64 offen offset:0 sc1
buffer_load_dwordx4 v[48:51], v227, s[20:23], s64 offen offset:256 sc1
s_waitcnt vmcnt(0)
v_max_u16 v2, v44, v48
v_cmp_eq_u16 vcc, -1, v2
s_cbranch_vccnz L_st13
s_branch L_go13
L_sx13:
s_mov_b32 s40, 0
s_branch L_go13
L_st14:
s_sub_u32 s40, s40, 1
s_cbranch_scc1 L_sx14
buffer_load_dwordx4 v[52:55], v227, s[20:23], s64 offen offset:512 sc1
buffer_load_dwordx4 v[56:59], v227, s[20:23], s64 offen offset:768 sc1
s_waitcnt vmcnt(0)
v_max_u16 v2, v52, v56
v_cmp_eq_u16 vcc, -1, v2
s_cbranch_vccnz L_st14
s_branch L_go14
L_sx14:
s_mov_b32 s40, 0
s_branch L_go14
L_st15:
s_sub_u32 s40, s40, 1
s_cbranch_scc1 L_sx15
buffer_load_dwordx4 v[60:63], v227, s[20:23], s64 offen offset:1024 sc1
s_waitcnt vmcnt(0)
v_cmp_eq_u16 vcc, -1, v60
s_cbranch_vccnz L_st15
s_branch L_go15
L_sx15:
s_mov_b32 s40, 0
s_branch L_go15
L_gl_5g:
buffer_store_dwordx4 v[32:35], v1, s[16:19], s3 offen sc1
s_branch L_gl_5b
L_e2r:
s_sub_u32 s40, s40, 1
s_cbranch_scc0 L_e2
s_mov_b32 s40, 0
s_branch L_e2go
L_h0:
v_lshrrev_b32 v1, 3, v0
v_and_b32 v2, 2, v1
v_xor_b32 v2, v2, v0
v_and_b32 v2, 7, v2
s_lshl_b32 s3, s36, 7
v_lshl_add_u32 v2, v2, 4, s3
v_mul_u32_u24 v3, 3840, v1
v_add_u32 v24, v3, v2
v_xor_b32 v27, 64, v24
v_add_u32 v27, 30720, v27
v_mov_b32 v55, 0
v_add_u32 v25, 256, v24
v_add_u32 v26, 512, v24
v_add_u32 v28, 256, v27
v_add_u32 v29, 512, v27
s_add_u32 s69, s69, 1
s_cmp_eq_u32 s69, 10
s_cselect_b32 s69, 0, s69
s_mul_i32 s63, s69, 245760
s_mov_b32 m0, 57344
s_nop 0
buffer_load_dwordx4 v24, s[8:11], s63 offen offset:0 lds
s_mov_b32 s40, 524288
s_mul_i32 s43, s33, 3
s_add_u32 s43, s43, s35
s_sub_u32 s3, s36, 5
s_cselect_b32 s37, s36, s3
buffer_load_dwordx4 v25, s[8:11], s63 offen offset:1024 lds
s_lshl_b32 s3, s32, 2
s_lshr_b32 s44, 0x32105454, s3
s_and_b32 s44, s44, 7
s_lshr_b32 s45, s38, 1
s_add_u32 s45, s45, 4
buffer_load_dwordx4 v26, s[8:11], s63 offen offset:2048 lds
s_addk_i32 m0, 3072
s_cmp_eq_u32 s35, 2
s_cselect_b32 s60, 10, 11
buffer_load_dwordx4 v27, s[8:11], s63 offen offset:0 lds
s_sub_u32 s57, 8, s33
v_lshlrev_b32 v233, 4, v0
buffer_load_dwordx4 v28, s[8:11], s63 offen offset:1024 lds
s_mul_i32 s58, s43, 6
s_add_u32 s58, s58, s44
s_mul_i32 s58, s58, 2560
s_add_u32 s58, s58, 2097152
buffer_load_dwordx4 v29, s[8:11], s63 offen offset:2048 lds
s_addk_i32 m0, 3072
s_add_u32 s63, s63, 61440
s_lshl_b32 s59, s33, 15
s_add_u32 s59, s59, 3145728
buffer_load_dwordx4 v24, s[8:11], s63 offen offset:0 lds
s_sub_u32 s51, 5, s37
s_add_u32 s1, s37, 1
s_sub_u32 s3, 15, s37
s_cmp_le_u32 s37, 2
s_cselect_b32 s46, 0, s3
s_cselect_b32 s47, s51, s1
s_cselect_b32 s48, s3, 0
s_cselect_b32 s49, s1, s51
s_cselect_b32 s50, 1, 0
buffer_load_dwordx4 v25, s[8:11], s63 offen offset:1024 lds
v_and_b32 v3, 15, v0
v_add_u32 v3, 8, v3
v_lshrrev_b32 v4, 1, v3
v_lshrrev_b32 v5, 5, v0
v_xor_b32 v4, v4, v5
v_and_b32 v4, 7, v4
buffer_load_dwordx4 v26, s[8:11], s63 offen offset:2048 lds
s_addk_i32 m0, 3072
v_lshlrev_b32 v4, 4, v4
v_lshl_add_u32 v4, v3, 7, v4
v_bfe_u32 v5, v0, 4, 1
v_lshl_add_u32 v4, v5, 3, v4
s_lshl_b32 s3, s44, 11
v_add_u32 v235, s3, v4
buffer_load_dwordx4 v27, s[8:11], s63 offen offset:0 lds
buffer_load_dwordx4 v28, s[8:11], s63 offen offset:1024 lds
buffer_load_dwordx4 v29, s[8:11], s63 offen offset:2048 lds
s_addk_i32 m0, 3072
s_add_u32 s63, s63, 61440
buffer_load_dwordx4 v24, s[8:11], s63 offen offset:0 lds
buffer_load_dwordx4 v25, s[8:11], s63 offen offset:1024 lds
buffer_load_dwordx4 v26, s[8:11], s63 offen offset:2048 lds
s_addk_i32 m0, 3072
s_nop 0
buffer_load_dwordx4 v27, s[8:11], s63 offen offset:0 lds
buffer_load_dwordx4 v28, s[8:11], s63 offen offset:1024 lds
buffer_load_dwordx4 v29, s[8:11], s63 offen offset:2048 lds
s_addk_i32 m0, 3072
s_add_u32 s63, s63, 61440
buffer_load_dwordx4 v24, s[8:11], s63 offen offset:0 lds
buffer_load_dwordx4 v25, s[8:11], s63 offen offset:1024 lds
buffer_load_dwordx4 v26, s[8:11], s63 offen offset:2048 lds
s_addk_i32 m0, 3072
s_nop 0
buffer_load_dwordx4 v27, s[8:11], s63 offen offset:0 lds
buffer_load_dwordx4 v28, s[8:11], s63 offen offset:1024 lds
buffer_load_dwordx4 v29, s[8:11], s63 offen offset:2048 lds
s_waitcnt vmcnt(24)
s_barrier
s_add_u32 s69, s69, 1
s_cmp_eq_u32 s69, 10
s_cselect_b32 s69, 0, s69
s_mul_i32 s63, s69, 245760
s_mov_b32 m0, 94208
v_lshrrev_b32 v1, 4, v0
v_lshlrev_b32 v1, 3, v1
s_lshl_b32 s3, s36, 7
buffer_load_dwordx2 v[244:245], v1, s[28:31], s3 offen offset:0
buffer_load_dwordx2 v[246:247], v1, s[28:31], s3 offen offset:32
buffer_load_dwordx2 v[248:249], v1, s[28:31], s3 offen offset:64
buffer_load_dwordx2 v[250:251], v1, s[28:31], s3 offen offset:96
buffer_load_dwordx4 v24, s[8:11], s63 offen offset:0 lds
v_and_b32 v1, 15, v0
v_lshrrev_b32 v2, 4, v0
v_mov_b32 v7, 1792
s_mul_i32 s0, s44, 2304
s_movk_i32 s1, 144
v_bfe_u32 v3, v0, 2, 1
v_and_b32 v4, 3, v0
v_lshlrev_b32 v4, 1, v4
buffer_load_dwordx4 v25, s[8:11], s63 offen offset:1024 lds
v_lshl_add_u32 v3, v3, 3, v4
v_bfe_u32 v4, v0, 3, 1
v_add_u32 v3, v3, v4
s_add_u32 s3, s0, 17408
v_mov_b32 v4, s3
v_mad_u32_u24 v3, v3, s1, v4
buffer_load_dwordx4 v26, s[8:11], s63 offen offset:2048 lds
s_addk_i32 m0, 3072
s_add_u32 s3, s0, 4736
v_mov_b32 v4, s3
v_mad_u32_u24 v4, v1, s1, v4
s_mov_b32 s52, 0xff00ff
s_mov_b32 s53, 0xff00ff
buffer_load_dwordx4 v27, s[8:11], s63 offen offset:0 lds
v_add_u32 v5, s51, v2
v_lshl_add_u32 v200, v5, 3, v3
v_lshl_add_u32 v5, v5, 3, v4
buffer_load_dwordx4 v28, s[8:11], s63 offen offset:1024 lds
v_cndmask_b32 v204, v7, v5, s[52:53]
v_cndmask_b32 v205, v5, v7, s[52:53]
v_add_u32 v5, s46, v2
buffer_load_dwordx4 v29, s[8:11], s63 offen offset:2048 lds
s_addk_i32 m0, 3072
s_add_u32 s63, s63, 61440
v_lshl_add_u32 v202, v5, 3, v3
v_lshl_add_u32 v5, v5, 3, v4
v_cmp_gt_u32 vcc, s47, v2
buffer_load_dwordx4 v24, s[8:11], s63 offen offset:0 lds
s_nop 0
v_cndmask_b32 v5, v7, v5, vcc
v_cndmask_b32 v206, v7, v5, s[52:53]
v_cndmask_b32 v207, v5, v7, s[52:53]
buffer_load_dwordx4 v25, s[8:11], s63 offen offset:1024 lds
v_add_u32 v5, s48, v2
v_min_u32 v5, 15, v5
v_lshl_add_u32 v203, v5, 3, v3
v_lshl_add_u32 v5, v5, 3, v4
buffer_load_dwordx4 v26, s[8:11], s63 offen offset:2048 lds
s_addk_i32 m0, 3072
v_cmp_gt_u32 vcc, s49, v2
s_nop 1
v_cndmask_b32 v5, v7, v5, vcc
buffer_load_dwordx4 v27, s[8:11], s63 offen offset:0 lds
v_cndmask_b32 v208, v7, v5, s[52:53]
v_cndmask_b32 v209, v5, v7, s[52:53]
s_sub_u32 s3, s51, 1
v_mad_u32_u24 v5, v2, 5, s3
s_add_u32 s3, s46, 4
v_mov_b32 v6, s3
s_mov_b64 vcc, 0xffff
v_cndmask_b32 v5, v5, v6, vcc
buffer_load_dwordx4 v28, s[8:11], s63 offen offset:1024 lds
v_min_u32 v5, 15, v5
v_lshl_add_u32 v201, v5, 3, v3
v_lshl_add_u32 v5, v5, 3, v4
s_cmp_eq_u32 s47, 5
s_cselect_b64 vcc, 0xff, 0
v_cndmask_b32 v210, v7, v5, vcc
s_lshl_b64 vcc, vcc, 8
v_cndmask_b32 v211, v7, v5, vcc
buffer_load_dwordx4 v29, s[8:11], s63 offen offset:2048 lds
s_addk_i32 m0, 3072
s_add_u32 s63, s63, 61440
s_bfm_b64 vcc, 8, 16
v_cndmask_b32 v212, v7, v5, vcc
s_bfm_b64 vcc, 8, 24
v_cndmask_b32 v213, v7, v5, vcc
buffer_load_dwordx4 v24, s[8:11], s63 offen offset:0 lds
s_bfm_b64 vcc, 8, 32
v_cndmask_b32 v214, v7, v5, vcc
s_bfm_b64 vcc, 8, 40
v_cndmask_b32 v215, v7, v5, vcc
buffer_load_dwordx4 v25, s[8:11], s63 offen offset:1024 lds
buffer_load_dwordx4 v26, s[8:11], s63 offen offset:2048 lds
s_addk_i32 m0, 3072
s_nop 0
buffer_load_dwordx4 v27, s[8:11], s63 offen offset:0 lds
buffer_load_dwordx4 v28, s[8:11], s63 offen offset:1024 lds
buffer_load_dwordx4 v29, s[8:11], s63 offen offset:2048 lds
s_addk_i32 m0, 3072
s_add_u32 s63, s63, 61440
buffer_load_dwordx4 v24, s[8:11], s63 offen offset:0 lds
buffer_load_dwordx4 v25, s[8:11], s63 offen offset:1024 lds
buffer_load_dwordx4 v26, s[8:11], s63 offen offset:2048 lds
s_addk_i32 m0, 3072
s_nop 0
buffer_load_dwordx4 v27, s[8:11], s63 offen offset:0 lds
buffer_load_dwordx4 v28, s[8:11], s63 offen offset:1024 lds
buffer_load_dwordx4 v29, s[8:11], s63 offen offset:2048 lds
s_waitcnt vmcnt(24)
s_barrier
s_cmp_eq_u32 s57, 1
s_cbranch_scc0 L_wc1
s_mov_b32 s0, 45056
s_call_b64 s[100:101], L_xcap
L_wc1:
s_add_u32 s69, s69, 1
s_cmp_eq_u32 s69, 10
s_cselect_b32 s69, 0, s69
s_mul_i32 s63, s69, 245760
s_mov_b32 m0, 131072
s_nop 0
buffer_load_dwordx4 v24, s[8:11], s63 offen offset:0 lds
s_mul_i32 s0, s44, 2304
s_movk_i32 s1, 144
buffer_load_dwordx4 v25, s[8:11], s63 offen offset:1024 lds
v_bfe_u32 v3, v0, 2, 3
v_lshrrev_b32 v4, 5, v0
v_lshl_add_u32 v3, v3, 1, v4
buffer_load_dwordx4 v26, s[8:11], s63 offen offset:2048 lds
s_addk_i32 m0, 3072
s_add_u32 s3, s0, 31232
v_mov_b32 v4, s3
v_mad_u32_u24 v3, v3, s1, v4
v_and_b32 v4, 3, v0
buffer_load_dwordx4 v27, s[8:11], s63 offen offset:0 lds
s_mov_b32 s54, 0x11111111
s_mov_b32 s55, 0x11111111
buffer_load_dwordx4 v28, s[8:11], s63 offen offset:1024 lds
v_add_u32 v5, s51, v4
v_lshl_add_u32 v216, v5, 3, v3
v_add_u32 v7, 32, v216
buffer_load_dwordx4 v29, s[8:11], s63 offen offset:2048 lds
s_addk_i32 m0, 3072
s_add_u32 s63, s63, 61440
s_cmp_eq_u32 s50, 1
s_cselect_b32 s3, -1, 12
s_cselect_b32 s56, 2, -1
buffer_load_dwordx4 v24, s[8:11], s63 offen offset:0 lds
v_add_u32 v5, s3, v4
v_lshl_add_u32 v5, v5, 3, v3
v_cndmask_b32 v217, v5, v7, s[54:55]
v_add_u32 v7, 40, v7
buffer_load_dwordx4 v25, s[8:11], s63 offen offset:1024 lds
v_add_u32 v5, s56, v4
v_add_u32 v6, 10, v5
v_cmp_gt_i32 vcc, s51, v5
buffer_load_dwordx4 v26, s[8:11], s63 offen offset:2048 lds
s_addk_i32 m0, 3072
v_cndmask_b32 v5, v6, v5, vcc
v_lshl_add_u32 v5, v5, 3, v3
v_cndmask_b32 v218, v5, v7, s[54:55]
buffer_load_dwordx4 v27, s[8:11], s63 offen offset:0 lds
s_lshl_b32 s0, s44, 8
v_lshrrev_b32 v4, 5, v0
v_and_or_b32 v3, v0, 8, v4
s_add_u32 s3, s0, 8
v_lshl_add_u32 v222, v3, 4, s3
buffer_load_dwordx4 v28, s[8:11], s63 offen offset:1024 lds
v_and_b32 v1, 15, v0
s_add_u32 s3, s0, 132
v_lshl_add_u32 v223, v1, 4, s3
buffer_load_dwordx4 v29, s[8:11], s63 offen offset:2048 lds
s_addk_i32 m0, 3072
s_add_u32 s63, s63, 61440
s_lshr_b32 s3, s39, 8
s_mul_i32 s3, s3, 52429
s_lshr_b32 s3, s3, 18
s_lshl_b32 s0, s44, 5
s_add_u32 s3, s3, s0
s_sub_u32 s3, 2047, s3
v_mad_i32_i24 v234, v1, -2, s3
buffer_load_dwordx4 v24, s[8:11], s63 offen offset:0 lds
buffer_load_dwordx4 v25, s[8:11], s63 offen offset:1024 lds
buffer_load_dwordx4 v26, s[8:11], s63 offen offset:2048 lds
s_addk_i32 m0, 3072
s_nop 0
buffer_load_dwordx4 v27, s[8:11], s63 offen offset:0 lds
buffer_load_dwordx4 v28, s[8:11], s63 offen offset:1024 lds
buffer_load_dwordx4 v29, s[8:11], s63 offen offset:2048 lds
s_addk_i32 m0, 3072
s_add_u32 s63, s63, 61440
buffer_load_dwordx4 v24, s[8:11], s63 offen offset:0 lds
buffer_load_dwordx4 v25, s[8:11], s63 offen offset:1024 lds
buffer_load_dwordx4 v26, s[8:11], s63 offen offset:2048 lds
s_addk_i32 m0, 3072
s_nop 0
buffer_load_dwordx4 v27, s[8:11], s63 offen offset:0 lds
buffer_load_dwordx4 v28, s[8:11], s63 offen offset:1024 lds
buffer_load_dwordx4 v29, s[8:11], s63 offen offset:2048 lds
s_waitcnt vmcnt(24)
s_barrier
s_cmp_eq_u32 s57, 2
s_cbranch_scc0 L_wc2
s_mov_b32 s0, 81920
s_call_b64 s[100:101], L_xcap
L_wc2:
s_add_u32 s69, s69, 1
s_cmp_eq_u32 s69, 10
s_cselect_b32 s69, 0, s69
s_mul_i32 s63, s69, 245760
s_mov_b32 m0, 20480
s_nop 0
buffer_load_dwordx4 v24, s[8:11], s63 offen offset:0 lds
v_lshrrev_b32 v2, 4, v0
v_and_or_b32 v3, v0, 8, v2
v_and_b32 v4, 0x70, v233
v_bfrev_b32 v6, 1
buffer_load_dwordx4 v25, s[8:11], s63 offen offset:1024 lds
s_lshl_b32 s3, s45, 4
v_add_u32 v5, s3, v3
s_lshl_b32 s3, s60, 3
v_cmp_gt_u32 vcc, s3, v5
buffer_load_dwordx4 v26, s[8:11], s63 offen offset:2048 lds
s_addk_i32 m0, 3072
v_mul_u32_u24 v5, 2560, v5
v_add3_u32 v5, v5, v4, s39
v_cndmask_b32 v236, v6, v5, vcc
buffer_load_dwordx4 v27, s[8:11], s63 offen offset:0 lds
s_lshl_b32 s3, s44, 4
v_add_u32 v5, s3, v3
s_lshl_b32 s3, s60, 3
v_cmp_gt_u32 vcc, s3, v5
buffer_load_dwordx4 v28, s[8:11], s63 offen offset:1024 lds
v_mul_u32_u24 v5, 2560, v5
v_add3_u32 v5, v5, v4, s39
v_cndmask_b32 v227, v6, v5, vcc
buffer_load_dwordx4 v29, s[8:11], s63 offen offset:2048 lds
s_addk_i32 m0, 3072
s_add_u32 s63, s63, 61440
s_lshl_b32 s3, s36, 7
v_add_u32 v226, s3, v227
buffer_load_dwordx4 v24, s[8:11], s63 offen offset:0 lds
v_bfe_u32 v3, v0, 4, 1
v_cmp_eq_u32 s[54:55], s50, v3
s_cmp_lg_u32 s37, 0
s_cselect_b64 s[0:1], -1, s[54:55]
s_and_b64 vcc, vcc, s[0:1]
buffer_load_dwordx4 v25, s[8:11], s63 offen offset:1024 lds
s_cmp_lg_u32 s37, 4
s_cselect_b64 s[0:1], 0, s[54:55]
s_andn2_b64 vcc, vcc, s[0:1]
buffer_load_dwordx4 v26, s[8:11], s63 offen offset:2048 lds
s_addk_i32 m0, 3072
v_cndmask_b32 v225, v6, v226, vcc
buffer_load_dwordx4 v27, s[8:11], s63 offen offset:0 lds
s_cmp_le_u32 s37, 3
s_cselect_b32 s3, 2560, 0
s_sub_u32 s3, s3, 128
v_mov_b32 v4, s3
buffer_load_dwordx4 v28, s[8:11], s63 offen offset:1024 lds
s_cmp_ge_u32 s37, 2
s_cselect_b32 s3, 2560, 0
s_add_u32 s3, s3, 128
v_mov_b32 v5, s3
buffer_load_dwordx4 v29, s[8:11], s63 offen offset:2048 lds
s_addk_i32 m0, 3072
s_add_u32 s63, s63, 61440
v_cndmask_b32 v4, v4, v5, s[54:55]
v_mul_u32_u24 v3, 2560, v3
v_sub_u32 v4, v4, v3
buffer_load_dwordx4 v24, s[8:11], s63 offen offset:0 lds
v_add_u32 v4, v4, v226
v_cndmask_b32 v224, v6, v4, vcc
buffer_load_dwordx4 v25, s[8:11], s63 offen offset:1024 lds
buffer_load_dwordx4 v26, s[8:11], s63 offen offset:2048 lds
s_addk_i32 m0, 3072
s_nop 0
buffer_load_dwordx4 v27, s[8:11], s63 offen offset:0 lds
buffer_load_dwordx4 v28, s[8:11], s63 offen offset:1024 lds
buffer_load_dwordx4 v29, s[8:11], s63 offen offset:2048 lds
s_addk_i32 m0, 3072
s_add_u32 s63, s63, 61440
buffer_load_dwordx4 v24, s[8:11], s63 offen offset:0 lds
buffer_load_dwordx4 v25, s[8:11], s63 offen offset:1024 lds
buffer_load_dwordx4 v26, s[8:11], s63 offen offset:2048 lds
s_addk_i32 m0, 3072
s_nop 0
buffer_load_dwordx4 v27, s[8:11], s63 offen offset:0 lds
buffer_load_dwordx4 v28, s[8:11], s63 offen offset:1024 lds
buffer_load_dwordx4 v29, s[8:11], s63 offen offset:2048 lds
s_waitcnt vmcnt(24)
s_barrier
s_cmp_eq_u32 s57, 3
s_cbranch_scc0 L_wc3
s_mov_b32 s0, 118784
s_call_b64 s[100:101], L_xcap
L_wc3:
s_add_u32 s69, s69, 1
s_cmp_eq_u32 s69, 10
s_cselect_b32 s69, 0, s69
s_mul_i32 s63, s69, 245760
s_mov_b32 m0, 57344
s_nop 0
buffer_load_dwordx4 v24, s[8:11], s63 offen offset:0 lds
v_and_b32 v1, 15, v0
v_bfrev_b32 v6, 1
v_bfe_u32 v3, v0, 4, 1
v_lshrrev_b32 v4, 5, v0
buffer_load_dwordx4 v25, s[8:11], s63 offen offset:1024 lds
v_lshl_add_u32 v3, v3, 1, v4
s_lshl_b32 s3, s36, 7
v_lshl_add_u32 v4, v3, 4, s3
buffer_load_dwordx4 v26, s[8:11], s63 offen offset:2048 lds
s_addk_i32 m0, 3072
s_lshl_b32 s3, s44, 4
v_add_u32 v5, s3, v1
s_lshl_b32 s3, s60, 3
v_cmp_gt_u32 vcc, s3, v5
buffer_load_dwordx4 v27, s[8:11], s63 offen offset:0 lds
v_mul_u32_u24 v5, 2560, v5
v_add3_u32 v5, v5, v4, s39
v_cndmask_b32 v232, v6, v5, vcc
buffer_load_dwordx4 v28, s[8:11], s63 offen offset:1024 lds
v_bfe_u32 v3, v0, 3, 2
v_lshlrev_b32 v3, 2, v3
v_and_or_b32 v3, v0, 3, v3
buffer_load_dwordx4 v29, s[8:11], s63 offen offset:2048 lds
s_addk_i32 m0, 3072
s_add_u32 s63, s63, 61440
v_lshlrev_b32 v3, 3, v3
v_bfe_u32 v4, v0, 2, 2
v_lshl_add_u32 v3, v4, 7, v3
buffer_load_dwordx4 v24, s[8:11], s63 offen offset:0 lds
v_lshrrev_b32 v2, 4, v0
buffer_load_dwordx4 v25, s[8:11], s63 offen offset:1024 lds
s_and_b32 s3, s32, 1
s_lshl_b32 s3, s3, 12
s_add_u32 s3, s3, 81920
v_lshl_add_u32 v4, v2, 10, v3
v_add_u32 v228, s3, v4
buffer_load_dwordx4 v26, s[8:11], s63 offen offset:2048 lds
s_addk_i32 m0, 3072
v_xor_b32 v229, 32, v228
buffer_load_dwordx4 v27, s[8:11], s63 offen offset:0 lds
v_xor_b32 v230, 64, v228
buffer_load_dwordx4 v28, s[8:11], s63 offen offset:1024 lds
v_xor_b32 v231, 96, v228
buffer_load_dwordx4 v29, s[8:11], s63 offen offset:2048 lds
s_addk_i32 m0, 3072
s_add_u32 s63, s63, 61440
s_mov_b32 s44, 0x0
s_mov_b32 s45, 0x1010101
buffer_load_dwordx4 v24, s[8:11], s63 offen offset:0 lds
s_mov_b32 s46, 0x3030303
s_mov_b32 s47, 0x7070707
buffer_load_dwordx4 v25, s[8:11], s63 offen offset:1024 lds
s_mov_b32 s48, 0xf0f0f0f
s_mov_b32 s49, 0x1f1f1f1f
buffer_load_dwordx4 v26, s[8:11], s63 offen offset:2048 lds
s_addk_i32 m0, 3072
s_mov_b32 s50, 0x3f3f3f3f
s_mov_b32 s51, 0x7f7f7f7f
buffer_load_dwordx4 v27, s[8:11], s63 offen offset:0 lds
s_movk_i32 s54, 10240
s_mov_b32 s55, 0x07060501
s_mov_b32 s56, 0x0706000c
buffer_load_dwordx4 v28, s[8:11], s63 offen offset:1024 lds
v_mov_b32 v5, 0xffff
v_mov_b32 v6, 0xffff0000
buffer_load_dwordx4 v29, s[8:11], s63 offen offset:2048 lds
s_addk_i32 m0, 3072
s_add_u32 s63, s63, 61440
v_cndmask_b32 v1, 0, v5, s[44:45]
v_cndmask_b32 v4, 0, v6, s[46:47]
v_or_b32 v220, v1, v4
buffer_load_dwordx4 v24, s[8:11], s63 offen offset:0 lds
v_cndmask_b32 v1, 0, v5, s[48:49]
v_cndmask_b32 v4, 0, v6, s[50:51]
v_or_b32 v221, v1, v4
buffer_load_dwordx4 v25, s[8:11], s63 offen offset:1024 lds
buffer_load_dwordx4 v26, s[8:11], s63 offen offset:2048 lds
s_addk_i32 m0, 3072
s_nop 0
buffer_load_dwordx4 v27, s[8:11], s63 offen offset:0 lds
buffer_load_dwordx4 v28, s[8:11], s63 offen offset:1024 lds
buffer_load_dwordx4 v29, s[8:11], s63 offen offset:2048 lds
s_waitcnt vmcnt(24)
s_barrier
s_cmp_eq_u32 s57, 4
s_cbranch_scc0 L_wc4
s_mov_b32 s0, 8192
s_call_b64 s[100:101], L_xcap
L_wc4:
s_add_u32 s69, s69, 1
s_cmp_eq_u32 s69, 10
s_cselect_b32 s69, 0, s69
s_mul_i32 s63, s69, 245760
s_mov_b32 m0, 94208
s_nop 0
buffer_load_dwordx4 v24, s[8:11], s63 offen offset:0 lds
v_lshrrev_b32 v1, 3, v0
v_and_b32 v2, 2, v1
v_xor_b32 v2, v2, v0
s_lshl_b32 s3, s32, 2
v_xor_b32 v2, s3, v2
buffer_load_dwordx4 v25, s[8:11], s63 offen offset:1024 lds
v_and_b32 v2, 7, v2
s_lshl_b32 s3, s36, 7
v_lshl_add_u32 v2, v2, 4, s3
buffer_load_dwordx4 v26, s[8:11], s63 offen offset:2048 lds
s_addk_i32 m0, 3072
v_and_b32 v3, 3, v1
v_mul_u32_u24 v3, 1280, v3
v_add_u32 v2, v3, v2
buffer_load_dwordx4 v27, s[8:11], s63 offen offset:0 lds
v_lshrrev_b32 v3, 5, v0
v_mul_u32_u24 v3, 5120, v3
v_sub_u32 v4, 5120, v3
buffer_load_dwordx4 v28, s[8:11], s63 offen offset:1024 lds
v_mad_u32_u24 v56, v3, 5, v2
buffer_load_dwordx4 v29, s[8:11], s63 offen offset:2048 lds
s_addk_i32 m0, 3072
s_add_u32 s63, s63, 61440
v_mad_u32_u24 v57, v3, 3, v2
buffer_load_dwordx4 v24, s[8:11], s63 offen offset:0 lds
v_mad_u32_u24 v58, v3, 13, v2
buffer_load_dwordx4 v25, s[8:11], s63 offen offset:1024 lds
v_mad_u32_u24 v59, v4, 3, v2
buffer_load_dwordx4 v26, s[8:11], s63 offen offset:2048 lds
s_addk_i32 m0, 3072
v_mad_u32_u24 v60, v4, 13, v2
buffer_load_dwordx4 v27, s[8:11], s63 offen offset:0 lds
buffer_load_dwordx4 v28, s[8:11], s63 offen offset:1024 lds
buffer_load_dwordx4 v29, s[8:11], s63 offen offset:2048 lds
s_addk_i32 m0, 3072
s_add_u32 s63, s63, 61440
buffer_load_dwordx4 v24, s[8:11], s63 offen offset:0 lds
buffer_load_dwordx4 v25, s[8:11], s63 offen offset:1024 lds
buffer_load_dwordx4 v26, s[8:11], s63 offen offset:2048 lds
s_addk_i32 m0, 3072
s_nop 0
buffer_load_dwordx4 v27, s[8:11], s63 offen offset:0 lds
buffer_load_dwordx4 v28, s[8:11], s63 offen offset:1024 lds
buffer_load_dwordx4 v29, s[8:11], s63 offen offset:2048 lds
s_addk_i32 m0, 3072
s_add_u32 s63, s63, 61440
buffer_load_dwordx4 v24, s[8:11], s63 offen offset:0 lds
buffer_load_dwordx4 v25, s[8:11], s63 offen offset:1024 lds
buffer_load_dwordx4 v26, s[8:11], s63 offen offset:2048 lds
s_addk_i32 m0, 3072
s_nop 0
buffer_load_dwordx4 v27, s[8:11], s63 offen offset:0 lds
buffer_load_dwordx4 v28, s[8:11], s63 offen offset:1024 lds
buffer_load_dwordx4 v29, s[8:11], s63 offen offset:2048 lds
s_waitcnt vmcnt(24)
s_barrier
s_cmp_eq_u32 s57, 5
s_cbranch_scc0 L_wc5
s_mov_b32 s0, 45056
s_call_b64 s[100:101], L_xcap
L_wc5:
s_add_u32 s69, s69, 1
s_cmp_eq_u32 s69, 10
s_cselect_b32 s69, 0, s69
s_mul_i32 s63, s69, 245760
s_mov_b32 m0, 131072
s_nop 0
buffer_load_dwordx4 v24, s[8:11], s63 offen offset:0 lds
s_mul_i32 s3, s38, 24
v_add_u32 v1, s3, v0
s_add_u32 s3, s3, 24
s_lshl_b32 s0, s60, 3
s_min_u32 s3, s3, s0
v_cmp_gt_u32 vcc, s3, v1
buffer_load_dwordx4 v25, s[8:11], s63 offen offset:1024 lds
v_mul_u32_u24 v1, 2560, v1
s_lshl_b32 s0, s36, 7
s_add_u32 s3, s0, s39
v_add_u32 v1, s3, v1
v_bfrev_b32 v2, 1
v_cndmask_b32 v61, v2, v1, vcc
buffer_load_dwordx4 v26, s[8:11], s63 offen offset:2048 lds
s_addk_i32 m0, 3072
s_lshl_b32 s3, s35, 2
s_add_u32 s3, s3, s38
s_mul_i32 s3, s3, 1280
s_add_u32 s3, s3, s0
v_mul_u32_u24 v1, 15360, v0
v_add_u32 v62, s3, v1
buffer_load_dwordx4 v27, s[8:11], s63 offen offset:0 lds
s_mul_i32 s3, s38, 3
v_min_u32 v1, 2, v0
v_add_u32 v1, s3, v1
v_lshrrev_b32 v2, 1, v1
v_mul_u32_u24 v2, 2304, v2
v_lshl_add_u32 v1, v1, 7, v2
buffer_load_dwordx4 v28, s[8:11], s63 offen offset:1024 lds
s_mul_i32 s3, s43, 15360
s_lshl_b32 s0, s36, 8
s_add_u32 s3, s3, s0
s_add_u32 s3, s3, 2097152
v_add_u32 v63, s3, v1
buffer_load_dwordx4 v29, s[8:11], s63 offen offset:2048 lds
s_addk_i32 m0, 3072
s_add_u32 s63, s63, 61440
buffer_load_dwordx4 v24, s[8:11], s63 offen offset:0 lds
buffer_load_dwordx4 v25, s[8:11], s63 offen offset:1024 lds
buffer_load_dwordx4 v26, s[8:11], s63 offen offset:2048 lds
s_addk_i32 m0, 3072
s_nop 0
buffer_load_dwordx4 v27, s[8:11], s63 offen offset:0 lds
buffer_load_dwordx4 v28, s[8:11], s63 offen offset:1024 lds
buffer_load_dwordx4 v29, s[8:11], s63 offen offset:2048 lds
s_addk_i32 m0, 3072
s_add_u32 s63, s63, 61440
buffer_load_dwordx4 v24, s[8:11], s63 offen offset:0 lds
buffer_load_dwordx4 v25, s[8:11], s63 offen offset:1024 lds
buffer_load_dwordx4 v26, s[8:11], s63 offen offset:2048 lds
s_addk_i32 m0, 3072
s_nop 0
buffer_load_dwordx4 v27, s[8:11], s63 offen offset:0 lds
buffer_load_dwordx4 v28, s[8:11], s63 offen offset:1024 lds
buffer_load_dwordx4 v29, s[8:11], s63 offen offset:2048 lds
s_addk_i32 m0, 3072
s_add_u32 s63, s63, 61440
buffer_load_dwordx4 v24, s[8:11], s63 offen offset:0 lds
buffer_load_dwordx4 v25, s[8:11], s63 offen offset:1024 lds
buffer_load_dwordx4 v26, s[8:11], s63 offen offset:2048 lds
s_addk_i32 m0, 3072
s_nop 0
buffer_load_dwordx4 v27, s[8:11], s63 offen offset:0 lds
buffer_load_dwordx4 v28, s[8:11], s63 offen offset:1024 lds
buffer_load_dwordx4 v29, s[8:11], s63 offen offset:2048 lds
s_waitcnt vmcnt(24)
s_barrier
s_cmp_eq_u32 s57, 6
s_cbranch_scc0 L_wc6
s_mov_b32 s0, 81920
s_call_b64 s[100:101], L_xcap
L_wc6:
s_add_u32 s69, s69, 1
s_cmp_eq_u32 s69, 10
s_cselect_b32 s69, 0, s69
s_mul_i32 s63, s69, 245760
s_mov_b32 m0, 20480
s_nop 0
buffer_load_dwordx4 v24, s[8:11], s63 offen offset:0 lds
s_mov_b32 s3, 0x3f803f80
v_mov_b32 v64, s3
v_mov_b32 v65, s3
v_mov_b32 v66, s3
v_mov_b32 v67, s3
s_mov_b32 exec_lo, 0x11111111
s_mov_b32 exec_hi, 0x11111111
v_mov_b32 v244, s3
v_mov_b32 v245, s3
v_mov_b32 v246, s3
v_mov_b32 v247, s3
v_mov_b32 v248, s3
v_mov_b32 v249, s3
v_mov_b32 v250, s3
v_mov_b32 v251, s3
s_mov_b64 exec, -1
v_mfma_f32_16x16x32_bf16 v[252:255], v[244:247], v[64:67], 0
v_mfma_f32_16x16x32_bf16 v[252:255], v[248:251], v[64:67], v[252:255]
buffer_load_dwordx4 v25, s[8:11], s63 offen offset:1024 lds
buffer_load_dwordx4 v26, s[8:11], s63 offen offset:2048 lds
s_addk_i32 m0, 3072
s_nop 0
buffer_load_dwordx4 v27, s[8:11], s63 offen offset:0 lds
buffer_load_dwordx4 v28, s[8:11], s63 offen offset:1024 lds
buffer_load_dwordx4 v29, s[8:11], s63 offen offset:2048 lds
s_addk_i32 m0, 3072
s_add_u32 s63, s63, 61440
buffer_load_dwordx4 v24, s[8:11], s63 offen offset:0 lds
buffer_load_dwordx4 v25, s[8:11], s63 offen offset:1024 lds
buffer_load_dwordx4 v26, s[8:11], s63 offen offset:2048 lds
s_addk_i32 m0, 3072
s_nop 0
buffer_load_dwordx4 v27, s[8:11], s63 offen offset:0 lds
buffer_load_dwordx4 v28, s[8:11], s63 offen offset:1024 lds
buffer_load_dwordx4 v29, s[8:11], s63 offen offset:2048 lds
s_addk_i32 m0, 3072
s_add_u32 s63, s63, 61440
buffer_load_dwordx4 v24, s[8:11], s63 offen offset:0 lds
buffer_load_dwordx4 v25, s[8:11], s63 offen offset:1024 lds
buffer_load_dwordx4 v26, s[8:11], s63 offen offset:2048 lds
s_addk_i32 m0, 3072
s_nop 0
buffer_load_dwordx4 v27, s[8:11], s63 offen offset:0 lds
buffer_load_dwordx4 v28, s[8:11], s63 offen offset:1024 lds
buffer_load_dwordx4 v29, s[8:11], s63 offen offset:2048 lds
s_addk_i32 m0, 3072
s_add_u32 s63, s63, 61440
buffer_load_dwordx4 v24, s[8:11], s63 offen offset:0 lds
buffer_load_dwordx4 v25, s[8:11], s63 offen offset:1024 lds
buffer_load_dwordx4 v26, s[8:11], s63 offen offset:2048 lds
s_addk_i32 m0, 3072
s_nop 0
buffer_load_dwordx4 v27, s[8:11], s63 offen offset:0 lds
buffer_load_dwordx4 v28, s[8:11], s63 offen offset:1024 lds
buffer_load_dwordx4 v29, s[8:11], s63 offen offset:2048 lds
s_waitcnt vmcnt(24)
s_barrier
s_cmp_eq_u32 s57, 7
s_cbranch_scc0 L_wc7
s_mov_b32 s0, 118784
s_call_b64 s[100:101], L_xcap
L_wc7:
s_add_u32 s69, s69, 1
s_cmp_eq_u32 s69, 10
s_cselect_b32 s69, 0, s69
s_mul_i32 s63, s69, 245760
s_mov_b32 m0, 57344
s_nop 0
buffer_load_dwordx4 v24, s[8:11], s63 offen offset:0 lds
v_mov_b32 v176, 0
buffer_load_dwordx4 v25, s[8:11], s63 offen offset:1024 lds
v_mov_b32 v177, 0
buffer_load_dwordx4 v26, s[8:11], s63 offen offset:2048 lds
s_addk_i32 m0, 3072
v_mov_b32 v178, 0
buffer_load_dwordx4 v27, s[8:11], s63 offen offset:0 lds
v_mov_b32 v179, 0
buffer_load_dwordx4 v28, s[8:11], s63 offen offset:1024 lds
v_mov_b32 v180, 0
buffer_load_dwordx4 v29, s[8:11], s63 offen offset:2048 lds
s_addk_i32 m0, 3072
s_add_u32 s63, s63, 61440
v_mov_b32 v181, 0
buffer_load_dwordx4 v24, s[8:11], s63 offen offset:0 lds
v_mov_b32 v182, 0
buffer_load_dwordx4 v25, s[8:11], s63 offen offset:1024 lds
v_mov_b32 v183, 0
buffer_load_dwordx4 v26, s[8:11], s63 offen offset:2048 lds
s_addk_i32 m0, 3072
v_mov_b32 v184, 0
buffer_load_dwordx4 v27, s[8:11], s63 offen offset:0 lds
v_mov_b32 v185, 0
buffer_load_dwordx4 v28, s[8:11], s63 offen offset:1024 lds
v_mov_b32 v186, 0
buffer_load_dwordx4 v29, s[8:11], s63 offen offset:2048 lds
s_addk_i32 m0, 3072
s_add_u32 s63, s63, 61440
v_mov_b32 v187, 0
buffer_load_dwordx4 v24, s[8:11], s63 offen offset:0 lds
v_mov_b32 v188, 0
buffer_load_dwordx4 v25, s[8:11], s63 offen offset:1024 lds
v_mov_b32 v189, 0
buffer_load_dwordx4 v26, s[8:11], s63 offen offset:2048 lds
s_addk_i32 m0, 3072
v_mov_b32 v190, 0
buffer_load_dwordx4 v27, s[8:11], s63 offen offset:0 lds
v_mov_b32 v191, 0
buffer_load_dwordx4 v28, s[8:11], s63 offen offset:1024 lds
buffer_load_dwordx4 v29, s[8:11], s63 offen offset:2048 lds
s_addk_i32 m0, 3072
s_add_u32 s63, s63, 61440
buffer_load_dwordx4 v24, s[8:11], s63 offen offset:0 lds
buffer_load_dwordx4 v25, s[8:11], s63 offen offset:1024 lds
buffer_load_dwordx4 v26, s[8:11], s63 offen offset:2048 lds
s_addk_i32 m0, 3072
s_nop 0
buffer_load_dwordx4 v27, s[8:11], s63 offen offset:0 lds
buffer_load_dwordx4 v28, s[8:11], s63 offen offset:1024 lds
buffer_load_dwordx4 v29, s[8:11], s63 offen offset:2048 lds
s_waitcnt vmcnt(24)
s_barrier
s_cmp_eq_u32 s57, 8
s_cbranch_scc0 L_wc8
s_mov_b32 s0, 8192
s_call_b64 s[100:101], L_xcap
L_wc8:
s_branch L_h8
L_cons:
v_and_b32 v1, 15, v0
v_lshrrev_b32 v2, 4, v0
v_mov_b32 v7, 1792
s_mul_i32 s0, s44, 2304
s_movk_i32 s1, 144
v_bfe_u32 v3, v0, 2, 1
v_and_b32 v4, 3, v0
v_lshlrev_b32 v4, 1, v4
v_lshl_add_u32 v3, v3, 3, v4
v_bfe_u32 v4, v0, 3, 1
v_add_u32 v3, v3, v4
s_add_u32 s3, s0, 17408
v_mov_b32 v4, s3
v_mad_u32_u24 v3, v3, s1, v4
s_add_u32 s3, s0, 4736
v_mov_b32 v4, s3
v_mad_u32_u24 v4, v1, s1, v4
s_mov_b32 s52, 0xff00ff
s_mov_b32 s53, 0xff00ff
v_add_u32 v5, s51, v2
v_lshl_add_u32 v200, v5, 3, v3
v_lshl_add_u32 v5, v5, 3, v4
v_cndmask_b32 v204, v7, v5, s[52:53]
v_cndmask_b32 v205, v5, v7, s[52:53]
v_add_u32 v5, s46, v2
v_lshl_add_u32 v202, v5, 3, v3
v_lshl_add_u32 v5, v5, 3, v4
v_cmp_gt_u32 vcc, s47, v2
s_nop 1
v_cndmask_b32 v5, v7, v5, vcc
v_cndmask_b32 v206, v7, v5, s[52:53]
v_cndmask_b32 v207, v5, v7, s[52:53]
v_add_u32 v5, s48, v2
v_min_u32 v5, 15, v5
v_lshl_add_u32 v203, v5, 3, v3
v_lshl_add_u32 v5, v5, 3, v4
v_cmp_gt_u32 vcc, s49, v2
s_nop 1
v_cndmask_b32 v5, v7, v5, vcc
v_cndmask_b32 v208, v7, v5, s[52:53]
v_cndmask_b32 v209, v5, v7, s[52:53]
s_sub_u32 s3, s51, 1
v_mad_u32_u24 v5, v2, 5, s3
s_add_u32 s3, s46, 4
v_mov_b32 v6, s3
s_mov_b64 vcc, 0xffff
v_cndmask_b32 v5, v5, v6, vcc
v_min_u32 v5, 15, v5
v_lshl_add_u32 v201, v5, 3, v3
v_lshl_add_u32 v5, v5, 3, v4
s_cmp_eq_u32 s47, 5
s_cselect_b64 vcc, 0xff, 0
v_cndmask_b32 v210, v7, v5, vcc
s_lshl_b64 vcc, vcc, 8
v_cndmask_b32 v211, v7, v5, vcc
s_bfm_b64 vcc, 8, 16
v_cndmask_b32 v212, v7, v5, vcc
s_bfm_b64 vcc, 8, 24
v_cndmask_b32 v213, v7, v5, vcc
s_bfm_b64 vcc, 8, 32
v_cndmask_b32 v214, v7, v5, vcc
s_bfm_b64 vcc, 8, 40
v_cndmask_b32 v215, v7, v5, vcc
s_mul_i32 s0, s44, 2304
s_movk_i32 s1, 144
v_bfe_u32 v3, v0, 2, 3
v_lshrrev_b32 v4, 5, v0
v_lshl_add_u32 v3, v3, 1, v4
s_add_u32 s3, s0, 31232
v_mov_b32 v4, s3
v_mad_u32_u24 v3, v3, s1, v4
v_and_b32 v4, 3, v0
s_mov_b32 s54, 0x11111111
s_mov_b32 s55, 0x11111111
v_add_u32 v5, s51, v4
v_lshl_add_u32 v216, v5, 3, v3
v_add_u32 v7, 32, v216
s_cmp_eq_u32 s50, 1
s_cselect_b32 s3, -1, 12
s_cselect_b32 s56, 2, -1
v_add_u32 v5, s3, v4
v_lshl_add_u32 v5, v5, 3, v3
v_cndmask_b32 v217, v5, v7, s[54:55]
v_add_u32 v7, 40, v7
v_add_u32 v5, s56, v4
v_add_u32 v6, 10, v5
v_cmp_gt_i32 vcc, s51, v5
s_nop 1
v_cndmask_b32 v5, v6, v5, vcc
v_lshl_add_u32 v5, v5, 3, v3
v_cndmask_b32 v218, v5, v7, s[54:55]
s_lshl_b32 s0, s44, 8
v_lshrrev_b32 v4, 5, v0
v_and_or_b32 v3, v0, 8, v4
s_add_u32 s3, s0, 8
v_lshl_add_u32 v222, v3, 4, s3
v_and_b32 v1, 15, v0
s_add_u32 s3, s0, 132
v_lshl_add_u32 v223, v1, 4, s3
s_lshr_b32 s3, s39, 8
s_mul_i32 s3, s3, 52429
s_lshr_b32 s3, s3, 18
s_lshl_b32 s0, s44, 5
s_add_u32 s3, s3, s0
s_sub_u32 s3, 2047, s3
v_mad_i32_i24 v234, v1, -2, s3
v_lshrrev_b32 v2, 4, v0
v_and_or_b32 v3, v0, 8, v2
v_and_b32 v4, 0x70, v233
v_bfrev_b32 v6, 1
s_lshl_b32 s3, s44, 4
v_add_u32 v5, s3, v3
s_lshl_b32 s3, s60, 3
v_cmp_gt_u32 vcc, s3, v5
v_mul_u32_u24 v5, 2560, v5
v_add3_u32 v5, v5, v4, s39
v_cndmask_b32 v227, v6, v5, vcc
s_lshl_b32 s3, s36, 7
v_add_u32 v226, s3, v227
v_bfe_u32 v3, v0, 4, 1
v_cmp_eq_u32 s[54:55], s50, v3
s_cmp_lg_u32 s37, 0
s_cselect_b64 s[0:1], -1, s[54:55]
s_and_b64 vcc, vcc, s[0:1]
s_cmp_lg_u32 s37, 4
s_cselect_b64 s[0:1], 0, s[54:55]
s_andn2_b64 vcc, vcc, s[0:1]
v_cndmask_b32 v225, v6, v226, vcc
s_cmp_le_u32 s37, 3
s_cselect_b32 s3, 2560, 0
s_sub_u32 s3, s3, 128
v_mov_b32 v4, s3
s_cmp_ge_u32 s37, 2
s_cselect_b32 s3, 2560, 0
s_add_u32 s3, s3, 128
v_mov_b32 v5, s3
v_cndmask_b32 v4, v4, v5, s[54:55]
v_mul_u32_u24 v3, 2560, v3
v_sub_u32 v4, v4, v3
v_add_u32 v4, v4, v226
v_cndmask_b32 v224, v6, v4, vcc
v_and_b32 v1, 15, v0
v_bfrev_b32 v6, 1
v_bfe_u32 v3, v0, 4, 1
v_lshrrev_b32 v4, 5, v0
v_lshl_add_u32 v3, v3, 1, v4
s_lshl_b32 s3, s36, 7
v_lshl_add_u32 v4, v3, 4, s3
s_lshl_b32 s3, s44, 4
v_add_u32 v5, s3, v1
s_lshl_b32 s3, s60, 3
v_cmp_gt_u32 vcc, s3, v5
v_mul_u32_u24 v5, 2560, v5
v_add3_u32 v5, v5, v4, s39
v_cndmask_b32 v232, v6, v5, vcc
v_bfe_u32 v3, v0, 3, 2
v_lshlrev_b32 v3, 2, v3
v_and_or_b32 v3, v0, 3, v3
v_lshlrev_b32 v3, 3, v3
v_bfe_u32 v4, v0, 2, 2
v_lshl_add_u32 v3, v4, 7, v3
v_lshrrev_b32 v2, 4, v0
s_mov_b32 s44, 0x0
s_mov_b32 s45, 0x1010101
s_mov_b32 s46, 0x3030303
s_mov_b32 s47, 0x7070707
s_mov_b32 s48, 0xf0f0f0f
s_mov_b32 s49, 0x1f1f1f1f
s_mov_b32 s50, 0x3f3f3f3f
s_mov_b32 s51, 0x7f7f7f7f
s_movk_i32 s54, 10240
s_mov_b32 s55, 0x07060501
s_mov_b32 s56, 0x0706000c
v_mov_b32 v5, 0xffff
v_mov_b32 v6, 0xffff0000
v_cndmask_b32 v1, 0, v5, s[44:45]
v_cndmask_b32 v4, 0, v6, s[46:47]
v_or_b32 v220, v1, v4
v_cndmask_b32 v1, 0, v5, s[48:49]
v_cndmask_b32 v4, 0, v6, s[50:51]
v_or_b32 v221, v1, v4
s_lshl_b32 s3, s38, 5
v_xor_b32 v3, s3, v3
v_mul_u32_u24 v4, 3072, v2
v_add_u32 v3, v3, v4
v_add_u32 v244, 20480, v3
s_mov_b32 s42, 0
v_mov_b32 v3, 0
v_lshlrev_b32 v2, 2, v0
s_mov_b32 exec_hi, 0
ds_write_b32 v2, v3 offset:1728
ds_write_b32 v2, v3 offset:2880
s_mov_b64 exec, -1
v_and_b32 v1, 15, v0
v_lshrrev_b32 v2, 4, v0
v_lshrrev_b32 v3, 1, v1
v_xor_b32 v3, v3, v2
v_lshlrev_b32 v3, 4, v3
v_lshl_add_u32 v3, v1, 7, v3
v_add_u32 v245, 8192, v3
v_xor_b32 v246, 64, v245
v_mul_u32_u24 v3, 144, v1
v_lshl_add_u32 v3, v2, 3, v3
s_lshl_b32 s3, s38, 5
s_add_u32 s3, s3, 3584
v_add_u32 v247, s3, v3
v_lshlrev_b32 v248, 4, v1
v_mov_b32 v4, -1
v_mov_b32 v5, -1
v_mov_b32 v6, -1
v_mov_b32 v7, -1
v_lshrrev_b32 v1, 3, v0
v_mul_u32_u24 v1, 2560, v1
v_and_b32 v2, 0x70, v233
s_lshl_b32 s3, s36, 7
s_add_u32 s3, s3, s39
v_add3_u32 v1, v1, v2, s3
s_mul_i32 s0, s38, 20480
s_add_u32 s1, s0, 81920
s_add_u32 s3, s38, 8
s_cmp_lt_u32 s3, s60
s_cselect_b32 s3, s1, 0x80000000
s_add_u32 s3, s3, 81920
buffer_store_dwordx4 v[4:7], v1, s[20:23], s0 offen
buffer_store_dwordx4 v[4:7], v1, s[20:23], s1 offen
buffer_store_dwordx4 v[4:7], v1, s[20:23], s3 offen
v_lshrrev_b32 v1, 4, v0
v_mul_u32_u24 v1, 2304, v1
v_add_u32 v1, v1, v233
s_mul_i32 s1, s43, 15360
s_lshl_b32 s3, s36, 8
s_add_u32 s1, s1, s3
s_and_b32 s3, s38, 1
s_mul_i32 s3, s3, 7680
s_add_u32 s1, s1, s3
s_add_u32 s1, s1, 2097152
s_cmp_lt_u32 s38, 2
s_cselect_b32 s1, s1, 0x80000000
s_mov_b32 exec_hi, 0xffff
buffer_store_dwordx4 v[4:7], v1, s[16:19], s1 offen
s_mov_b64 exec, -1
s_cmp_lt_u32 s32, 2
s_cselect_b32 s57, s57, 99
s_mov_b32 s65, 8192
s_min_u32 s62, s57, 32
s_waitcnt vmcnt(4) lgkmcnt(0)
s_barrier
ds_read_b64_tr_b16 v[156:157], v244 offset:1024
ds_read_b64_tr_b16 v[158:159], v244 offset:1536
ds_read_b128 v[80:83], v245 offset:0
ds_read_b128 v[84:87], v245 offset:2048
ds_read_b128 v[88:91], v245 offset:4096
ds_read_b128 v[92:95], v245 offset:6144
ds_read_b128 v[96:99], v245 offset:8192
ds_read_b128 v[100:103], v245 offset:10240
ds_read_b64_tr_b16 v[160:161], v244 offset:2048
ds_read_b64_tr_b16 v[162:163], v244 offset:2560
ds_read_b64_tr_b16 v[152:153], v244 offset:0
ds_read_b64_tr_b16 v[154:155], v244 offset:512
s_waitcnt lgkmcnt(4)
v_mfma_f32_16x16x32_bf16 v[32:35], v[156:159], v[80:83], 0
ds_read_b64_tr_b16 v[168:169], v244 offset:13312
v_mfma_f32_16x16x32_bf16 v[36:39], v[156:159], v[84:87], 0
ds_read_b64_tr_b16 v[170:171], v244 offset:13824
v_mfma_f32_16x16x32_bf16 v[40:43], v[156:159], v[88:91], 0
ds_read_b128 v[104:107], v246 offset:0
v_mfma_f32_16x16x32_bf16 v[44:47], v[156:159], v[92:95], 0
ds_read_b128 v[108:111], v246 offset:2048
v_mfma_f32_16x16x32_bf16 v[48:51], v[156:159], v[96:99], 0
ds_read_b128 v[112:115], v246 offset:4096
v_mfma_f32_16x16x32_bf16 v[52:55], v[156:159], v[100:103], 0
ds_read_b128 v[116:119], v246 offset:6144
s_waitcnt lgkmcnt(8)
v_mfma_f32_16x16x32_bf16 v[56:59], v[160:163], v[80:83], 0
ds_read_b128 v[120:123], v246 offset:8192
v_mfma_f32_16x16x32_bf16 v[60:63], v[160:163], v[84:87], 0
ds_read_b128 v[124:127], v246 offset:10240
v_mfma_f32_16x16x32_bf16 v[64:67], v[160:163], v[88:91], 0
ds_read_b64_tr_b16 v[172:173], v244 offset:14336
v_mfma_f32_16x16x32_bf16 v[68:71], v[160:163], v[92:95], 0
ds_read_b64_tr_b16 v[174:175], v244 offset:14848
v_mfma_f32_16x16x32_bf16 v[72:75], v[160:163], v[96:99], 0
ds_read_b64_tr_b16 v[164:165], v244 offset:12288
v_mfma_f32_16x16x32_bf16 v[76:79], v[160:163], v[100:103], 0
ds_read_b64_tr_b16 v[166:167], v244 offset:12800
s_waitcnt lgkmcnt(12)
v_mfma_f32_16x16x32_bf16 v[8:11], v[152:155], v[80:83], 0
s_add_u32 s3, s65, 36864
s_cmp_eq_u32 s3, 155648
v_mfma_f32_16x16x32_bf16 v[12:15], v[152:155], v[84:87], 0
s_cselect_b32 s3, 8192, s3
s_sub_u32 s63, s3, s65
v_mfma_f32_16x16x32_bf16 v[16:19], v[152:155], v[88:91], 0
s_mov_b32 s65, s3
v_add_u32 v245, s63, v245
v_mfma_f32_16x16x32_bf16 v[20:23], v[152:155], v[92:95], 0
v_add_u32 v244, s63, v244
v_add_u32 v246, s63, v246
v_mfma_f32_16x16x32_bf16 v[24:27], v[152:155], v[96:99], 0
v_mfma_f32_16x16x32_bf16 v[28:31], v[152:155], v[100:103], 0
s_add_u32 s42, s42, 1
s_cmp_lt_u32 s42, 9
s_waitcnt lgkmcnt(4)
v_mfma_f32_16x16x32_bf16 v[32:35], v[168:171], v[104:107], v[32:35]
v_mfma_f32_16x16x32_bf16 v[36:39], v[168:171], v[108:111], v[36:39]
v_mfma_f32_16x16x32_bf16 v[40:43], v[168:171], v[112:115], v[40:43]
v_mfma_f32_16x16x32_bf16 v[44:47], v[168:171], v[116:119], v[44:47]
v_mfma_f32_16x16x32_bf16 v[48:51], v[168:171], v[120:123], v[48:51]
v_mfma_f32_16x16x32_bf16 v[52:55], v[168:171], v[124:127], v[52:55]
s_waitcnt lgkmcnt(2)
v_mfma_f32_16x16x32_bf16 v[56:59], v[172:175], v[104:107], v[56:59]
v_mfma_f32_16x16x32_bf16 v[60:63], v[172:175], v[108:111], v[60:63]
v_mfma_f32_16x16x32_bf16 v[64:67], v[172:175], v[112:115], v[64:67]
v_mfma_f32_16x16x32_bf16 v[68:71], v[172:175], v[116:119], v[68:71]
v_mfma_f32_16x16x32_bf16 v[72:75], v[172:175], v[120:123], v[72:75]
s_waitcnt lgkmcnt(0)
v_mfma_f32_16x16x32_bf16 v[76:79], v[172:175], v[124:127], v[76:79]
L_cloop:
s_barrier
ds_read_b64_tr_b16 v[156:157], v244 offset:1024
ds_read_b64_tr_b16 v[158:159], v244 offset:1536
v_mfma_f32_16x16x32_bf16 v[8:11], v[164:167], v[104:107], v[8:11]
ds_read_b128 v[80:83], v245 offset:0
v_mfma_f32_16x16x32_bf16 v[12:15], v[164:167], v[108:111], v[12:15]
ds_read_b128 v[84:87], v245 offset:2048
v_mfma_f32_16x16x32_bf16 v[16:19], v[164:167], v[112:115], v[16:19]
ds_read_b128 v[88:91], v245 offset:4096
v_mfma_f32_16x16x32_bf16 v[20:23], v[164:167], v[116:119], v[20:23]
ds_read_b128 v[92:95], v245 offset:6144
v_mfma_f32_16x16x32_bf16 v[24:27], v[164:167], v[120:123], v[24:27]
ds_read_b128 v[96:99], v245 offset:8192
v_mfma_f32_16x16x32_bf16 v[28:31], v[164:167], v[124:127], v[28:31]
ds_read_b128 v[100:103], v245 offset:10240
s_waitcnt lgkmcnt(5)
v_mfma_f32_16x16x32_bf16 v[32:35], v[156:159], v[80:83], v[32:35]
ds_read_b64_tr_b16 v[160:161], v244 offset:2048
s_waitcnt lgkmcnt(5)
v_mfma_f32_16x16x32_bf16 v[36:39], v[156:159], v[84:87], v[36:39]
ds_read_b64_tr_b16 v[162:163], v244 offset:2560
s_waitcnt lgkmcnt(5)
v_mfma_f32_16x16x32_bf16 v[40:43], v[156:159], v[88:91], v[40:43]
ds_read_b64_tr_b16 v[152:153], v244 offset:0
s_waitcnt lgkmcnt(5)
v_mfma_f32_16x16x32_bf16 v[44:47], v[156:159], v[92:95], v[44:47]
ds_read_b64_tr_b16 v[154:155], v244 offset:512
s_waitcnt lgkmcnt(5)
v_mfma_f32_16x16x32_bf16 v[48:51], v[156:159], v[96:99], v[48:51]
ds_read_b64_tr_b16 v[168:169], v244 offset:13312
s_waitcnt lgkmcnt(5)
v_mfma_f32_16x16x32_bf16 v[52:55], v[156:159], v[100:103], v[52:55]
ds_read_b64_tr_b16 v[170:171], v244 offset:13824
s_waitcnt lgkmcnt(4)
v_mfma_f32_16x16x32_bf16 v[56:59], v[160:163], v[80:83], v[56:59]
ds_read_b128 v[104:107], v246 offset:0
v_mfma_f32_16x16x32_bf16 v[60:63], v[160:163], v[84:87], v[60:63]
ds_read_b128 v[108:111], v246 offset:2048
v_mfma_f32_16x16x32_bf16 v[64:67], v[160:163], v[88:91], v[64:67]
ds_read_b128 v[112:115], v246 offset:4096
v_mfma_f32_16x16x32_bf16 v[68:71], v[160:163], v[92:95], v[68:71]
ds_read_b128 v[116:119], v246 offset:6144
v_mfma_f32_16x16x32_bf16 v[72:75], v[160:163], v[96:99], v[72:75]
ds_read_b128 v[120:123], v246 offset:8192
v_mfma_f32_16x16x32_bf16 v[76:79], v[160:163], v[100:103], v[76:79]
ds_read_b128 v[124:127], v246 offset:10240
s_waitcnt lgkmcnt(8)
v_mfma_f32_16x16x32_bf16 v[8:11], v[152:155], v[80:83], v[8:11]
ds_read_b64_tr_b16 v[172:173], v244 offset:14336
v_mfma_f32_16x16x32_bf16 v[12:15], v[152:155], v[84:87], v[12:15]
ds_read_b64_tr_b16 v[174:175], v244 offset:14848
v_mfma_f32_16x16x32_bf16 v[16:19], v[152:155], v[88:91], v[16:19]
ds_read_b64_tr_b16 v[164:165], v244 offset:12288
v_mfma_f32_16x16x32_bf16 v[20:23], v[152:155], v[92:95], v[20:23]
ds_read_b64_tr_b16 v[166:167], v244 offset:12800
v_mfma_f32_16x16x32_bf16 v[24:27], v[152:155], v[96:99], v[24:27]
s_add_u32 s3, s65, 36864
s_cmp_eq_u32 s3, 155648
v_mfma_f32_16x16x32_bf16 v[28:31], v[152:155], v[100:103], v[28:31]
s_cselect_b32 s3, 8192, s3
s_sub_u32 s63, s3, s65
s_waitcnt lgkmcnt(4)
v_mfma_f32_16x16x32_bf16 v[32:35], v[168:171], v[104:107], v[32:35]
s_mov_b32 s65, s3
v_add_u32 v245, s63, v245
v_mfma_f32_16x16x32_bf16 v[36:39], v[168:171], v[108:111], v[36:39]
v_add_u32 v244, s63, v244
v_add_u32 v246, s63, v246
v_mfma_f32_16x16x32_bf16 v[40:43], v[168:171], v[112:115], v[40:43]
s_cmp_eq_u32 s42, s62
s_cbranch_scc1 L_ev
L_evb:
v_mfma_f32_16x16x32_bf16 v[44:47], v[168:171], v[116:119], v[44:47]
v_mfma_f32_16x16x32_bf16 v[48:51], v[168:171], v[120:123], v[48:51]
s_add_u32 s42, s42, 1
s_cmp_lt_u32 s42, 9
v_mfma_f32_16x16x32_bf16 v[52:55], v[168:171], v[124:127], v[52:55]
s_waitcnt lgkmcnt(2)
v_mfma_f32_16x16x32_bf16 v[56:59], v[172:175], v[104:107], v[56:59]
v_mfma_f32_16x16x32_bf16 v[60:63], v[172:175], v[108:111], v[60:63]
v_mfma_f32_16x16x32_bf16 v[64:67], v[172:175], v[112:115], v[64:67]
v_mfma_f32_16x16x32_bf16 v[68:71], v[172:175], v[116:119], v[68:71]
v_mfma_f32_16x16x32_bf16 v[72:75], v[172:175], v[120:123], v[72:75]
s_waitcnt lgkmcnt(0)
v_mfma_f32_16x16x32_bf16 v[76:79], v[172:175], v[124:127], v[76:79]
s_cbranch_scc1 L_cloop
v_mov_b32 v1, 1728
ds_read_b32 v1, v1
ds_read2_b64 v[180:183], v248 offset0:0 offset1:32
ds_read2_b64 v[184:187], v248 offset0:64 offset1:96
ds_read2_b64 v[188:191], v248 offset0:128 offset1:160
s_waitcnt lgkmcnt(0)
v_readfirstlane_b32 s41, v1
s_barrier
s_cmp_eq_u32 s41, 1
s_cbranch_scc0 L_gs
L_gsb:
ds_read_b64_tr_b16 v[156:157], v244 offset:1024
ds_read_b64_tr_b16 v[158:159], v244 offset:1536
v_mfma_f32_16x16x32_bf16 v[8:11], v[164:167], v[104:107], v[8:11]
ds_read_b128 v[80:83], v245 offset:0
v_mfma_f32_16x16x32_bf16 v[12:15], v[164:167], v[108:111], v[12:15]
ds_read_b128 v[84:87], v245 offset:2048
v_mfma_f32_16x16x32_bf16 v[16:19], v[164:167], v[112:115], v[16:19]
ds_read_b128 v[88:91], v245 offset:4096
v_mfma_f32_16x16x32_bf16 v[20:23], v[164:167], v[116:119], v[20:23]
ds_read_b128 v[92:95], v245 offset:6144
v_mfma_f32_16x16x32_bf16 v[24:27], v[164:167], v[120:123], v[24:27]
ds_read_b128 v[96:99], v245 offset:8192
v_mfma_f32_16x16x32_bf16 v[28:31], v[164:167], v[124:127], v[28:31]
ds_read_b128 v[100:103], v245 offset:10240
ds_read_b64_tr_b16 v[176:177], v244 offset:13312
ds_read_b64_tr_b16 v[178:179], v244 offset:13824
s_waitcnt lgkmcnt(7)
v_mfma_f32_16x16x32_bf16 v[32:35], v[156:159], v[80:83], v[32:35]
ds_read_b128 v[128:131], v246 offset:0
s_waitcnt lgkmcnt(7)
v_mfma_f32_16x16x32_bf16 v[36:39], v[156:159], v[84:87], v[36:39]
ds_read_b128 v[132:135], v246 offset:2048
s_waitcnt lgkmcnt(7)
v_mfma_f32_16x16x32_bf16 v[40:43], v[156:159], v[88:91], v[40:43]
ds_read_b128 v[136:139], v246 offset:4096
s_waitcnt lgkmcnt(7)
v_mfma_f32_16x16x32_bf16 v[44:47], v[156:159], v[92:95], v[44:47]
ds_read_b128 v[140:143], v246 offset:6144
s_waitcnt lgkmcnt(7)
v_mfma_f32_16x16x32_bf16 v[48:51], v[156:159], v[96:99], v[48:51]
ds_read_b128 v[144:147], v246 offset:8192
s_waitcnt lgkmcnt(7)
v_mfma_f32_16x16x32_bf16 v[52:55], v[156:159], v[100:103], v[52:55]
ds_read_b128 v[148:151], v246 offset:10240
s_waitcnt lgkmcnt(5)
v_mfma_f32_16x16x32_bf16 v[32:35], v[176:179], v[128:131], v[32:35]
ds_read_b64_tr_b16 v[160:161], v244 offset:2048
s_waitcnt lgkmcnt(5)
v_mfma_f32_16x16x32_bf16 v[36:39], v[176:179], v[132:135], v[36:39]
ds_read_b64_tr_b16 v[162:163], v244 offset:2560
s_waitcnt lgkmcnt(5)
v_mfma_f32_16x16x32_bf16 v[40:43], v[176:179], v[136:139], v[40:43]
ds_read_b64_tr_b16 v[152:153], v244 offset:0
s_waitcnt lgkmcnt(5)
v_mfma_f32_16x16x32_bf16 v[44:47], v[176:179], v[140:143], v[44:47]
ds_read_b64_tr_b16 v[154:155], v244 offset:512
s_waitcnt lgkmcnt(5)
v_mfma_f32_16x16x32_bf16 v[48:51], v[176:179], v[144:147], v[48:51]
ds_read_b64_tr_b16 v[172:173], v244 offset:14336
s_waitcnt lgkmcnt(5)
v_mfma_f32_16x16x32_bf16 v[52:55], v[176:179], v[148:151], v[52:55]
ds_read_b64_tr_b16 v[174:175], v244 offset:14848
s_waitcnt lgkmcnt(4)
v_mfma_f32_16x16x32_bf16 v[56:59], v[160:163], v[80:83], v[56:59]
ds_read_b64_tr_b16 v[164:165], v244 offset:12288
ds_read_b64_tr_b16 v[166:167], v244 offset:12800
v_mov_b32_dpp v192, v32 row_newbcast:0 row_mask:0xf bank_mask:0xf
v_mov_b32_dpp v193, v33 row_newbcast:0 row_mask:0xf bank_mask:0xf
v_mov_b32_dpp v194, v34 row_newbcast:0 row_mask:0xf bank_mask:0xf
v_mov_b32_dpp v195, v35 row_newbcast:0 row_mask:0xf bank_mask:0xf
v_fmac_f32 v32, v192, v180
v_fmac_f32 v33, v193, v180
v_fmac_f32 v34, v194, v180
v_mfma_f32_16x16x32_bf16 v[60:63], v[160:163], v[84:87], v[60:63]
v_fmac_f32 v35, v195, v180
v_cvt_pk_bf16_f32 v32, v32, v33
v_cvt_pk_bf16_f32 v33, v34, v35
v_mfma_f32_16x16x32_bf16 v[64:67], v[160:163], v[88:91], v[64:67]
ds_write_b64 v247, v[32:33] offset:13824
v_fmac_f32 v36, v192, v182
v_fmac_f32 v37, v193, v182
v_fmac_f32 v38, v194, v182
v_mfma_f32_16x16x32_bf16 v[68:71], v[160:163], v[92:95], v[68:71]
v_fmac_f32 v39, v195, v182
v_cvt_pk_bf16_f32 v36, v36, v37
v_cvt_pk_bf16_f32 v37, v38, v39
v_mfma_f32_16x16x32_bf16 v[72:75], v[160:163], v[96:99], v[72:75]
ds_write_b64 v247, v[36:37] offset:16128
v_fmac_f32 v40, v192, v184
v_fmac_f32 v41, v193, v184
v_fmac_f32 v42, v194, v184
v_mfma_f32_16x16x32_bf16 v[76:79], v[160:163], v[100:103], v[76:79]
v_fmac_f32 v43, v195, v184
v_cvt_pk_bf16_f32 v40, v40, v41
v_cvt_pk_bf16_f32 v41, v42, v43
s_waitcnt lgkmcnt(4)
v_mfma_f32_16x16x32_bf16 v[56:59], v[172:175], v[128:131], v[56:59]
ds_write_b64 v247, v[40:41] offset:18432
v_fmac_f32 v44, v192, v186
v_fmac_f32 v45, v193, v186
v_fmac_f32 v46, v194, v186
v_mfma_f32_16x16x32_bf16 v[60:63], v[172:175], v[132:135], v[60:63]
v_fmac_f32 v47, v195, v186
v_cvt_pk_bf16_f32 v44, v44, v45
v_cvt_pk_bf16_f32 v45, v46, v47
v_mfma_f32_16x16x32_bf16 v[64:67], v[172:175], v[136:139], v[64:67]
ds_write_b64 v247, v[44:45] offset:20736
v_fmac_f32 v48, v192, v188
v_fmac_f32 v49, v193, v188
v_fmac_f32 v50, v194, v188
v_mfma_f32_16x16x32_bf16 v[68:71], v[172:175], v[140:143], v[68:71]
v_fmac_f32 v51, v195, v188
v_cvt_pk_bf16_f32 v48, v48, v49
v_cvt_pk_bf16_f32 v49, v50, v51
v_mfma_f32_16x16x32_bf16 v[72:75], v[172:175], v[144:147], v[72:75]
ds_write_b64 v247, v[48:49] offset:23040
v_fmac_f32 v52, v192, v190
v_fmac_f32 v53, v193, v190
v_fmac_f32 v54, v194, v190
v_mfma_f32_16x16x32_bf16 v[76:79], v[172:175], v[148:151], v[76:79]
v_fmac_f32 v55, v195, v190
v_cvt_pk_bf16_f32 v52, v52, v53
v_cvt_pk_bf16_f32 v53, v54, v55
ds_write_b64 v247, v[52:53] offset:25344
v_mfma_f32_16x16x32_bf16 v[8:11], v[152:155], v[80:83], v[8:11]
v_mov_b32_dpp v192, v56 row_newbcast:0 row_mask:0xf bank_mask:0xf
v_mov_b32_dpp v193, v57 row_newbcast:0 row_mask:0xf bank_mask:0xf
v_mov_b32_dpp v194, v58 row_newbcast:0 row_mask:0xf bank_mask:0xf
v_mov_b32_dpp v195, v59 row_newbcast:0 row_mask:0xf bank_mask:0xf
v_fmac_f32 v56, v192, v180
v_fmac_f32 v57, v193, v180
v_fmac_f32 v58, v194, v180
v_mfma_f32_16x16x32_bf16 v[12:15], v[152:155], v[84:87], v[12:15]
v_fmac_f32 v59, v195, v180
v_cvt_pk_bf16_f32 v56, v56, v57
v_cvt_pk_bf16_f32 v57, v58, v59
v_mfma_f32_16x16x32_bf16 v[16:19], v[152:155], v[88:91], v[16:19]
s_waitcnt lgkmcnt(0)
s_barrier
ds_write_b64 v247, v[56:57] offset:27648
v_fmac_f32 v60, v192, v182
v_fmac_f32 v61, v193, v182
v_fmac_f32 v62, v194, v182
v_mfma_f32_16x16x32_bf16 v[20:23], v[152:155], v[92:95], v[20:23]
v_fmac_f32 v63, v195, v182
v_cvt_pk_bf16_f32 v60, v60, v61
v_cvt_pk_bf16_f32 v61, v62, v63
v_mfma_f32_16x16x32_bf16 v[24:27], v[152:155], v[96:99], v[24:27]
ds_write_b64 v247, v[60:61] offset:29952
v_fmac_f32 v64, v192, v184
v_fmac_f32 v65, v193, v184
v_fmac_f32 v66, v194, v184
v_mfma_f32_16x16x32_bf16 v[28:31], v[152:155], v[100:103], v[28:31]
v_fmac_f32 v67, v195, v184
v_cvt_pk_bf16_f32 v64, v64, v65
v_cvt_pk_bf16_f32 v65, v66, v67
v_mfma_f32_16x16x32_bf16 v[8:11], v[164:167], v[128:131], v[8:11]
ds_write_b64 v247, v[64:65] offset:32256
v_fmac_f32 v68, v192, v186
v_fmac_f32 v69, v193, v186
v_fmac_f32 v70, v194, v186
v_mfma_f32_16x16x32_bf16 v[12:15], v[164:167], v[132:135], v[12:15]
v_fmac_f32 v71, v195, v186
v_cvt_pk_bf16_f32 v68, v68, v69
v_cvt_pk_bf16_f32 v69, v70, v71
v_mfma_f32_16x16x32_bf16 v[16:19], v[164:167], v[136:139], v[16:19]
ds_write_b64 v247, v[68:69] offset:34560
v_fmac_f32 v72, v192, v188
v_fmac_f32 v73, v193, v188
v_fmac_f32 v74, v194, v188
v_mfma_f32_16x16x32_bf16 v[20:23], v[164:167], v[140:143], v[20:23]
v_fmac_f32 v75, v195, v188
v_cvt_pk_bf16_f32 v72, v72, v73
v_cvt_pk_bf16_f32 v73, v74, v75
v_mfma_f32_16x16x32_bf16 v[24:27], v[164:167], v[144:147], v[24:27]
ds_write_b64 v247, v[72:73] offset:36864
v_fmac_f32 v76, v192, v190
v_fmac_f32 v77, v193, v190
v_fmac_f32 v78, v194, v190
v_mfma_f32_16x16x32_bf16 v[28:31], v[164:167], v[148:151], v[28:31]
v_fmac_f32 v79, v195, v190
v_cvt_pk_bf16_f32 v76, v76, v77
v_cvt_pk_bf16_f32 v77, v78, v79
ds_write_b64 v247, v[76:77] offset:39168
v_mov_b32_dpp v192, v8 row_newbcast:0 row_mask:0xf bank_mask:0xf
v_mov_b32_dpp v193, v9 row_newbcast:0 row_mask:0xf bank_mask:0xf
v_mov_b32_dpp v194, v10 row_newbcast:0 row_mask:0xf bank_mask:0xf
v_mov_b32_dpp v195, v11 row_newbcast:0 row_mask:0xf bank_mask:0xf
v_pk_fma_f32 v[8:9], v[192:193], v[180:181], v[8:9] op_sel_hi:[1,0,1]
v_pk_fma_f32 v[10:11], v[194:195], v[180:181], v[10:11] op_sel_hi:[1,0,1]
v_cvt_pk_bf16_f32 v8, v8, v9
v_cvt_pk_bf16_f32 v9, v10, v11
ds_write_b64 v247, v[8:9] offset:0
v_pk_fma_f32 v[12:13], v[192:193], v[182:183], v[12:13] op_sel_hi:[1,0,1]
v_pk_fma_f32 v[14:15], v[194:195], v[182:183], v[14:15] op_sel_hi:[1,0,1]
v_cvt_pk_bf16_f32 v12, v12, v13
v_cvt_pk_bf16_f32 v13, v14, v15
ds_write_b64 v247, v[12:13] offset:2304
v_pk_fma_f32 v[16:17], v[192:193], v[184:185], v[16:17] op_sel_hi:[1,0,1]
v_pk_fma_f32 v[18:19], v[194:195], v[184:185], v[18:19] op_sel_hi:[1,0,1]
v_cvt_pk_bf16_f32 v16, v16, v17
v_cvt_pk_bf16_f32 v17, v18, v19
ds_write_b64 v247, v[16:17] offset:4608
v_pk_fma_f32 v[20:21], v[192:193], v[186:187], v[20:21] op_sel_hi:[1,0,1]
v_pk_fma_f32 v[22:23], v[194:195], v[186:187], v[22:23] op_sel_hi:[1,0,1]
v_cvt_pk_bf16_f32 v20, v20, v21
v_cvt_pk_bf16_f32 v21, v22, v23
ds_write_b64 v247, v[20:21] offset:6912
v_pk_fma_f32 v[24:25], v[192:193], v[188:189], v[24:25] op_sel_hi:[1,0,1]
v_pk_fma_f32 v[26:27], v[194:195], v[188:189], v[26:27] op_sel_hi:[1,0,1]
v_cvt_pk_bf16_f32 v24, v24, v25
v_cvt_pk_bf16_f32 v25, v26, v27
ds_write_b64 v247, v[24:25] offset:9216
v_pk_fma_f32 v[28:29], v[192:193], v[190:191], v[28:29] op_sel_hi:[1,0,1]
v_pk_fma_f32 v[30:31], v[194:195], v[190:191], v[30:31] op_sel_hi:[1,0,1]
v_cvt_pk_bf16_f32 v28, v28, v29
v_cvt_pk_bf16_f32 v29, v30, v31
ds_write_b64 v247, v[28:29] offset:11520
s_waitcnt lgkmcnt(0)
s_barrier
s_cmp_lt_u32 s32, 2
s_cbranch_scc0 L_c23
ds_read_b64 v[108:109], v200 offset:0
ds_read_b64 v[110:111], v200 offset:1152
ds_read_b64 v[128:129], v204 offset:0
ds_read_b64 v[130:131], v205 offset:0
ds_read_b64 v[112:113], v200 offset:40
ds_read_b64 v[114:115], v200 offset:1192
ds_read_b64 v[132:133], v204 offset:40
ds_read_b64 v[134:135], v205 offset:40
ds_read_b64 v[104:105], v201 offset:0
ds_read_b64 v[106:107], v201 offset:1152
ds_read_b64 v[136:137], v212 offset:0
ds_read_b64 v[138:139], v213 offset:0
ds_read_b64 v[140:141], v214 offset:0
ds_read_b64 v[142:143], v215 offset:0
v_mov_b32 v176, 0
v_mov_b32 v177, 0
v_mov_b32 v178, 0
v_mov_b32 v179, 0
v_mov_b32 v180, 0
v_mov_b32 v181, 0
v_mov_b32 v182, 0
v_mov_b32 v183, 0
s_waitcnt lgkmcnt(10)
v_mfma_f32_16x16x32_bf16 v[160:163], v[108:111], v[128:131], 0
s_waitcnt lgkmcnt(6)
v_mfma_f32_16x16x32_bf16 v[164:167], v[112:115], v[132:135], 0
v_add_u32 v1, 128, v222
v_cndmask_b32 v2, v1, v222, s[44:45]
ds_read_b64 v[168:169], v2 offset:0
v_cndmask_b32 v2, v1, v222, s[46:47]
ds_read_b64 v[170:171], v2 offset:32
v_cndmask_b32 v2, v1, v222, s[48:49]
ds_read_b64 v[172:173], v2 offset:64
v_cndmask_b32 v2, v1, v222, s[50:51]
ds_read_b64 v[174:175], v2 offset:96
ds_read_b32 v5, v223
s_waitcnt lgkmcnt(7)
v_mfma_f32_16x16x32_bf16 v[160:163], v[104:107], v[136:139], v[160:163]
s_waitcnt lgkmcnt(5)
v_mfma_f32_16x16x32_bf16 v[164:167], v[104:107], v[140:143], v[164:167]
s_nop 7
v_permlane16_swap_b32 v160, v164
v_permlane16_swap_b32 v161, v165
v_permlane16_swap_b32 v162, v166
v_permlane16_swap_b32 v163, v167
v_cndmask_b32 v196, v164, v160, s[44:45]
v_cndmask_b32 v197, v165, v161, s[46:47]
v_cndmask_b32 v198, v166, v162, s[48:49]
v_cndmask_b32 v199, v167, v163, s[50:51]
s_waitcnt lgkmcnt(0)
v_mul_f32 v5, 0x3ea52b5c, v5
v_fma_f32 v196, v196, v168, v169
v_fma_f32 v197, v197, v170, v171
v_fma_f32 v198, v198, v172, v173
v_fma_f32 v199, v199, v174, v175
v_max3_f32 v6, v196, v197, v198
v_max_f32 v6, v6, v199
v_mov_b32 v7, v6
s_nop 1
v_permlane32_swap_b32 v6, v7
v_max_f32 v6, v6, v7
v_mul_f32 v6, v6, v5
v_fma_f32 v196, v196, v5, -v6
v_fma_f32 v197, v197, v5, -v6
v_fma_f32 v198, v198, v5, -v6
v_fma_f32 v199, v199, v5, -v6
v_exp_f32 v196, v196
v_exp_f32 v197, v197
v_exp_f32 v198, v198
v_exp_f32 v199, v199
ds_read_b64_tr_b16 v[64:65], v216 offset:0
ds_read_b64_tr_b16 v[66:67], v216 offset:1152
ds_read_b64_tr_b16 v[68:69], v216 offset:40
ds_read_b64_tr_b16 v[70:71], v216 offset:1192
ds_read_b64_tr_b16 v[72:73], v217 offset:0
ds_read_b64_tr_b16 v[74:75], v217 offset:1152
ds_read_b64_tr_b16 v[76:77], v218 offset:0
ds_read_b64_tr_b16 v[78:79], v218 offset:1152
v_add_f32 v6, v196, v197
v_add_f32 v7, v198, v199
v_add_f32 v6, v6, v7
v_mov_b32 v7, v6
v_mul_f32 v196, v196, v168
v_mul_f32 v197, v197, v170
v_permlane32_swap_b32 v6, v7
v_mul_f32 v198, v198, v172
v_add_f32 v6, v6, v7
v_rcp_f32 v6, v6
v_mul_f32 v199, v199, v174
v_mul_f32 v196, v196, v6
v_mul_f32 v197, v197, v6
v_mul_f32 v198, v198, v6
v_mul_f32 v199, v199, v6
v_cvt_pk_bf16_f32 v196, v196, v197
v_cvt_pk_bf16_f32 v197, v198, v199
s_mov_b64 exec, s[52:53]
v_and_b32 v176, v220, v196
v_bfi_b32 v180, v220, 0, v196
v_and_b32 v177, v221, v197
v_bfi_b32 v181, v221, 0, v197
s_not_b64 exec, exec
v_and_b32 v178, v220, v196
v_bfi_b32 v182, v220, 0, v196
v_and_b32 v179, v221, v197
v_bfi_b32 v183, v221, 0, v197
s_mov_b64 exec, -1
v_permlane16_swap_b32 v176, v180
v_permlane16_swap_b32 v177, v181
v_permlane16_swap_b32 v178, v182
v_permlane16_swap_b32 v179, v183
s_waitcnt lgkmcnt(0)
s_nop 0
v_mfma_f32_16x16x32_bf16 v[152:155], v[64:67], v[176:179], 0
v_mfma_f32_16x16x32_bf16 v[156:159], v[68:71], v[180:183], 0
v_mfma_f32_16x16x32_bf16 v[160:163], v[72:75], v[176:179], 0
v_mfma_f32_16x16x32_bf16 v[164:167], v[76:79], v[180:183], 0
s_nop 4
v_cvt_pk_bf16_f32 v196, v152, v153
v_cvt_pk_bf16_f32 v197, v154, v155
v_cvt_pk_bf16_f32 v198, v156, v157
v_cvt_pk_bf16_f32 v199, v158, v159
s_cmp_eq_u32 s41, 1
s_cbranch_scc0 L_gl_6g
buffer_store_dwordx4 v[196:199], v226, s[20:23], 0 offen
L_gl_6b:
s_lshl_b32 s0, s32, 2
s_add_u32 s0, s0, 1752
v_mov_b32 v1, s0
ds_read_b32 v1, v1
v_cvt_pk_bf16_f32 v80, v160, v161
v_cvt_pk_bf16_f32 v81, v162, v163
v_cvt_pk_bf16_f32 v82, v164, v165
v_cvt_pk_bf16_f32 v83, v166, v167
s_waitcnt lgkmcnt(0)
v_cmp_eq_u32 vcc, 0, v1
s_cbranch_vccnz L_spr
L_sbr:
s_mov_b64 exec, 0xffff
s_cmp_eq_u32 s41, 1
s_cbranch_scc0 L_gl_7g
buffer_store_dwordx4 v[80:83], v226, s[20:23], s54 offen
L_gl_7b:
s_mov_b64 exec, -1
v_lshrrev_b32 v1, 4, v0
v_lshlrev_b32 v1, 3, v1
s_lshl_b32 s3, s36, 7
buffer_load_dwordx2 v[244:245], v1, s[28:31], s3 offen offset:0
buffer_load_dwordx2 v[246:247], v1, s[28:31], s3 offen offset:32
buffer_load_dwordx2 v[248:249], v1, s[28:31], s3 offen offset:64
buffer_load_dwordx2 v[250:251], v1, s[28:31], s3 offen offset:96
v_lshlrev_b32 v8, 16, v236
v_and_b32 v9, 0xffff0000, v236
v_lshlrev_b32 v10, 16, v237
v_and_b32 v11, 0xffff0000, v237
v_lshlrev_b32 v12, 16, v238
v_and_b32 v13, 0xffff0000, v238
v_lshlrev_b32 v14, 16, v239
v_and_b32 v15, 0xffff0000, v239
v_lshlrev_b32 v16, 16, v240
v_and_b32 v17, 0xffff0000, v240
v_lshlrev_b32 v18, 16, v241
v_and_b32 v19, 0xffff0000, v241
v_lshlrev_b32 v20, 16, v242
v_and_b32 v21, 0xffff0000, v242
v_lshlrev_b32 v22, 16, v243
v_and_b32 v23, 0xffff0000, v243
s_lshl_b32 s0, s32, 13
s_add_u32 s0, s0, 57344
v_add_u32 v4, s0, v233
s_lshl_b32 s0, s32, 2
s_add_u32 s0, s0, 1760
s_waitcnt vmcnt(0)
s_mov_b32 s3, 0x3f803f80
v_mov_b32 v236, s3
v_mov_b32 v237, s3
v_mov_b32 v238, s3
v_mov_b32 v239, s3
s_mov_b32 exec_lo, 0x11111111
s_mov_b32 exec_hi, 0x11111111
v_mov_b32 v244, s3
v_mov_b32 v245, s3
v_mov_b32 v246, s3
v_mov_b32 v247, s3
v_mov_b32 v248, s3
v_mov_b32 v249, s3
v_mov_b32 v250, s3
v_mov_b32 v251, s3
s_mov_b64 exec, -1
v_mfma_f32_16x16x32_bf16 v[252:255], v[244:247], v[236:239], 0
v_mfma_f32_16x16x32_bf16 v[252:255], v[248:251], v[236:239], v[252:255]
L_fx:
s_sleep 1
v_mov_b32 v1, s0
ds_read_b32 v1, v1
s_waitcnt lgkmcnt(0)
v_cmp_ne_u32 vcc, 2, v1
s_cbranch_vccnz L_fx
s_setprio 1
ds_read_b128 v[24:27], v4 offset:0
ds_read_b128 v[28:31], v4 offset:1024
ds_read_b128 v[32:35], v4 offset:2048
ds_read_b128 v[36:39], v4 offset:3072
ds_read_b128 v[40:43], v4 offset:4096
ds_read_b128 v[44:47], v4 offset:5120
ds_read_b128 v[48:51], v4 offset:6144
ds_read_b128 v[52:55], v4 offset:7168
s_waitcnt lgkmcnt(7)
v_add_f32 v8, v8, v24
v_add_f32 v9, v9, v25
v_add_f32 v10, v10, v26
v_add_f32 v11, v11, v27
s_waitcnt lgkmcnt(6)
v_add_f32 v12, v12, v28
v_add_f32 v13, v13, v29
v_add_f32 v14, v14, v30
v_add_f32 v15, v15, v31
s_waitcnt lgkmcnt(5)
v_add_f32 v16, v16, v32
v_add_f32 v17, v17, v33
v_add_f32 v18, v18, v34
v_add_f32 v19, v19, v35
s_waitcnt lgkmcnt(4)
v_add_f32 v20, v20, v36
v_add_f32 v21, v21, v37
v_add_f32 v22, v22, v38
v_add_f32 v23, v23, v39
s_waitcnt lgkmcnt(3)
v_add_f32 v8, v8, v40
v_add_f32 v9, v9, v41
v_add_f32 v10, v10, v42
v_add_f32 v11, v11, v43
s_waitcnt lgkmcnt(2)
v_add_f32 v12, v12, v44
v_add_f32 v13, v13, v45
v_add_f32 v14, v14, v46
v_add_f32 v15, v15, v47
s_waitcnt lgkmcnt(1)
v_add_f32 v16, v16, v48
v_add_f32 v17, v17, v49
v_add_f32 v18, v18, v50
v_add_f32 v19, v19, v51
s_waitcnt lgkmcnt(0)
v_add_f32 v20, v20, v52
v_add_f32 v21, v21, v53
v_add_f32 v22, v22, v54
v_add_f32 v23, v23, v55
s_branch L_tail
L_gl_6g:
buffer_store_dwordx4 v[196:199], v226, s[20:23], 0 offen sc1
s_branch L_gl_6b
L_spr:
s_sleep 1
v_mov_b32 v1, s0
ds_read_b32 v1, v1
s_waitcnt lgkmcnt(0)
v_cmp_eq_u32 vcc, 0, v1
s_cbranch_vccnz L_spr
s_branch L_sbr
L_gl_7g:
buffer_store_dwordx4 v[80:83], v226, s[20:23], s54 offen sc1
s_branch L_gl_7b
L_c23:
ds_read_b64 v[96:97], v202 offset:0
ds_read_b64 v[98:99], v202 offset:1152
ds_read_b64 v[116:117], v206 offset:0
ds_read_b64 v[118:119], v207 offset:0
ds_read_b64 v[100:101], v203 offset:0
ds_read_b64 v[102:103], v203 offset:1152
ds_read_b64 v[120:121], v208 offset:0
ds_read_b64 v[122:123], v209 offset:0
ds_read_b64 v[104:105], v201 offset:0
ds_read_b64 v[106:107], v201 offset:1152
ds_read_b64 v[124:125], v210 offset:0
ds_read_b64 v[126:127], v211 offset:0
s_add_u32 s0, s37, 1
s_sub_u32 s1, 5, s37
s_min_u32 s0, s0, s1
s_lshl_b32 s0, s0, 4
s_sub_u32 s1, 64, s0
s_cmp_le_u32 s37, 2
s_cselect_b32 s1, s1, 16
s_bfm_b64 s[100:101], s0, s1
s_waitcnt lgkmcnt(8)
v_mfma_f32_16x16x32_bf16 v[152:155], v[96:99], v[116:119], 0
s_waitcnt lgkmcnt(4)
v_mfma_f32_16x16x32_bf16 v[156:159], v[100:103], v[120:123], 0
s_waitcnt lgkmcnt(0)
v_mfma_f32_16x16x32_bf16 v[152:155], v[104:107], v[124:127], v[152:155]
v_add_u32 v1, 128, v222
v_cndmask_b32 v2, v1, v222, s[44:45]
ds_read_b64 v[168:169], v2 offset:0
v_cndmask_b32 v2, v1, v222, s[46:47]
ds_read_b64 v[170:171], v2 offset:32
v_cndmask_b32 v2, v1, v222, s[48:49]
ds_read_b64 v[172:173], v2 offset:64
v_cndmask_b32 v2, v1, v222, s[50:51]
ds_read_b64 v[174:175], v2 offset:96
ds_read_b32 v5, v223
v_permlane16_swap_b32 v152, v156
v_permlane16_swap_b32 v153, v157
v_permlane16_swap_b32 v154, v158
v_permlane16_swap_b32 v155, v159
v_cndmask_b32 v2, v156, v152, s[44:45]
v_cndmask_b32 v3, v157, v153, s[46:47]
v_cndmask_b32 v194, v158, v154, s[48:49]
v_cndmask_b32 v195, v159, v155, s[50:51]
v_or_b32 v192, 0xffff, v2
v_perm_b32 v193, v3, v2, s55
s_cmp_eq_u32 s41, 1
s_cbranch_scc0 L_gl_8g
buffer_store_dwordx4 v[192:195], v224, s[20:23], s54 offen
L_gl_8b:
ds_read_b64_tr_b16 v[72:73], v217 offset:0
ds_read_b64_tr_b16 v[74:75], v217 offset:1152
ds_read_b64_tr_b16 v[76:77], v218 offset:0
ds_read_b64_tr_b16 v[78:79], v218 offset:1152
v_mov_b32 v184, 0
v_mov_b32 v185, 0
v_mov_b32 v186, 0
v_mov_b32 v187, 0
v_mov_b32 v188, 0
v_mov_b32 v189, 0
v_mov_b32 v190, 0
v_mov_b32 v191, 0
s_waitcnt lgkmcnt(0)
v_mul_f32 v5, 0x3ea52b5c, v5
buffer_load_dwordx4 v[92:95], v225, s[20:23], s54 offen sc1
s_waitcnt vmcnt(0)
v_cmp_eq_u32 vcc, -1, v94
s_cbranch_vccnz L_h0rl
L_h0gl:
s_lshl_b32 s0, s32, 2
s_add_u32 s0, s0, 1744
v_mov_b32 v1, s0
ds_write_b32 v1, v1
v_perm_b32 v92, v92, v93, s56
v_add_f32 v193, v3, v93
v_add_f32 v194, v194, v94
v_add_f32 v195, v195, v95
v_add_f32 v192, v2, v92
v_fma_f32 v192, v192, v168, v169
v_fma_f32 v193, v193, v170, v171
v_fma_f32 v194, v194, v172, v173
v_fma_f32 v195, v195, v174, v175
v_max3_f32 v6, v192, v193, v194
v_max_f32 v6, v6, v195
v_mov_b32 v7, v6
s_nop 1
v_permlane32_swap_b32 v6, v7
v_max_f32 v6, v6, v7
v_mul_f32 v6, v6, v5
v_fma_f32 v192, v192, v5, -v6
v_fma_f32 v193, v193, v5, -v6
v_fma_f32 v194, v194, v5, -v6
v_fma_f32 v195, v195, v5, -v6
v_exp_f32 v192, v192
v_exp_f32 v193, v193
v_exp_f32 v194, v194
v_exp_f32 v195, v195
v_add_f32 v6, v192, v193
v_add_f32 v7, v194, v195
v_add_f32 v6, v6, v7
v_mov_b32 v7, v6
v_mul_f32 v192, v192, v168
v_mul_f32 v193, v193, v170
v_permlane32_swap_b32 v6, v7
v_mul_f32 v194, v194, v172
v_add_f32 v6, v6, v7
v_rcp_f32 v6, v6
v_mul_f32 v195, v195, v174
v_mul_f32 v192, v192, v6
v_mul_f32 v193, v193, v6
v_mul_f32 v194, v194, v6
v_mul_f32 v195, v195, v6
v_cvt_pk_bf16_f32 v192, v192, v193
v_cvt_pk_bf16_f32 v193, v194, v195
s_mov_b64 exec, s[52:53]
v_and_b32 v184, v220, v192
v_bfi_b32 v188, v220, 0, v192
v_and_b32 v185, v221, v193
v_bfi_b32 v189, v221, 0, v193
s_not_b64 exec, exec
v_and_b32 v186, v220, v192
v_bfi_b32 v190, v220, 0, v192
v_and_b32 v187, v221, v193
v_bfi_b32 v191, v221, 0, v193
s_mov_b64 exec, -1
v_permlane16_swap_b32 v184, v188
v_permlane16_swap_b32 v185, v189
v_permlane16_swap_b32 v186, v190
v_permlane16_swap_b32 v187, v191
s_nop 1
v_mfma_f32_16x16x32_bf16 v[152:155], v[72:75], v[184:187], 0
v_mfma_f32_16x16x32_bf16 v[156:159], v[76:79], v[184:187], 0
v_mfma_f32_16x16x32_bf16 v[160:163], v[76:79], v[188:191], 0
s_mov_b32 exec_lo, 0xffff0000
s_nop 4
v_cvt_pk_bf16_f32 v80, v152, v153
v_cvt_pk_bf16_f32 v81, v154, v155
v_cvt_pk_bf16_f32 v82, v156, v157
v_cvt_pk_bf16_f32 v83, v158, v159
s_mov_b64 exec, s[100:101]
v_cvt_pk_bf16_f32 v82, v160, v161
v_cvt_pk_bf16_f32 v83, v162, v163
s_mov_b32 exec_lo, 0xffff0000
s_mov_b32 exec_hi, 0xffffffff
s_cmp_eq_u32 s41, 1
s_cbranch_scc0 L_gl_9g
buffer_store_dwordx4 v[80:83], v226, s[20:23], s54 offen
L_gl_9b:
s_endpgm
L_gl_8g:
buffer_store_dwordx4 v[192:195], v224, s[20:23], s54 offen sc1
s_branch L_gl_8b
L_h0rl:
s_sub_u32 s40, s40, 1
s_cbranch_scc1 L_h0xl
buffer_load_dwordx4 v[92:95], v225, s[20:23], s54 offen sc1
s_waitcnt vmcnt(0)
v_cmp_eq_u32 vcc, -1, v94
s_cbranch_vccnz L_h0rl
s_branch L_h0gl
L_h0xl:
s_mov_b32 s40, 0
s_branch L_h0gl
L_gl_9g:
buffer_store_dwordx4 v[80:83], v226, s[20:23], s54 offen sc1
s_branch L_gl_9b
L_ev:
s_cmp_eq_u32 s42, 1
s_cbranch_scc0 L_ev1
s_waitcnt vmcnt(0)
L_ev1:
s_max_u32 s62, s57, 1
s_cmp_eq_u32 s42, s57
s_cbranch_scc0 L_evb
s_sub_u32 s0, s65, s63
v_add_u32 v1, s0, v235
ds_read_b64 v[236:237], v1
v_xor_b32 v2, 32, v1
ds_read_b64 v[238:239], v2
v_xor_b32 v3, 64, v1
ds_read_b64 v[240:241], v3
v_xor_b32 v4, 96, v1
ds_read_b64 v[242:243], v4
s_branch L_evb
L_gs:
v_mov_b32 v4, -1
v_mov_b32 v5, -1
v_mov_b32 v6, -1
v_mov_b32 v7, -1
v_lshrrev_b32 v1, 3, v0
v_mul_u32_u24 v1, 2560, v1
v_and_b32 v2, 0x70, v233
s_lshl_b32 s3, s36, 7
s_add_u32 s3, s3, s39
v_add3_u32 v1, v1, v2, s3
s_mul_i32 s0, s38, 20480
s_add_u32 s1, s0, 81920
s_add_u32 s3, s38, 8
s_cmp_lt_u32 s3, s60
s_cselect_b32 s3, s1, 0x80000000
s_add_u32 s3, s3, 81920
buffer_store_dwordx4 v[4:7], v1, s[20:23], s0 offen sc1
buffer_store_dwordx4 v[4:7], v1, s[20:23], s1 offen sc1
buffer_store_dwordx4 v[4:7], v1, s[20:23], s3 offen sc1
v_lshrrev_b32 v1, 4, v0
v_mul_u32_u24 v1, 2304, v1
v_add_u32 v1, v1, v233
s_mul_i32 s1, s43, 15360
s_lshl_b32 s3, s36, 8
s_add_u32 s1, s1, s3
s_and_b32 s3, s38, 1
s_mul_i32 s3, s3, 7680
s_add_u32 s1, s1, s3
s_add_u32 s1, s1, 2097152
s_cmp_lt_u32 s38, 2
s_cselect_b32 s1, s1, 0x80000000
s_mov_b32 exec_hi, 0xffff
buffer_store_dwordx4 v[4:7], v1, s[16:19], s1 offen sc1
s_mov_b64 exec, -1
s_waitcnt vmcnt(0)
s_barrier
s_barrier
s_branch L_gsb
L_moe:
s_cmp_ge_u32 s34, 32
s_cbranch_scc1 L_end
s_lshr_b32 s32, s32, 6
v_and_b32 v0, 63, v0
s_lshl_b32 s36, s33, 1
s_add_u32 s36, s36, s34
s_sub_u32 s36, s36, 30
s_mov_b32 s40, 524288
v_lshlrev_b32 v6, 4, v0
v_mov_b32 v128, 0
v_mov_b32 v129, 0
s_waitcnt lgkmcnt(0)
s_mov_b64 s[16:17], s[66:67]
s_mov_b32 s18, 0x10000000
s_mov_b32 s19, 0x20000
s_mov_b64 s[24:25], s[64:65]
s_mov_b32 s26, 0x100
s_mov_b32 s27, 0x20000
s_mov_b64 s[4:5], s[54:55]
s_mov_b32 s6, 0x1e0000
s_mov_b32 s7, 0x20000
s_mov_b64 s[8:9], s[56:57]
s_mov_b32 s10, 0x1e0000
s_mov_b32 s11, 0x20000
s_mov_b64 s[12:13], s[60:61]
s_mov_b32 s14, 0x1e0000
s_mov_b32 s15, 0x20000
s_mov_b64 s[20:21], s[62:63]
s_mov_b32 s22, 0x280000
s_mov_b32 s23, 0x20000
s_cmp_eq_u32 s34, 30
s_cbranch_scc0 L_nroot
v_mov_b32 v8, -1
v_mov_b32 v9, -1
v_mov_b32 v10, -1
v_mov_b32 v11, -1
s_lshl_b32 s0, s33, 15
s_lshl_b32 s3, s32, 12
s_add_u32 s0, s0, s3
s_add_u32 s0, s0, 3145728
buffer_store_dwordx4 v[8:11], v6, s[16:19], s0 offen offset:0 sc1
buffer_store_dwordx4 v[8:11], v6, s[16:19], s0 offen offset:1024 sc1
buffer_store_dwordx4 v[8:11], v6, s[16:19], s0 offen offset:2048 sc1
buffer_store_dwordx4 v[8:11], v6, s[16:19], s0 offen offset:3072 sc1
s_waitcnt vmcnt(0)
s_barrier
s_cmp_eq_u32 s32, 0
s_cbranch_scc0 L_nroot
s_lshl_b32 s0, s33, 5
v_mov_b32 v8, 1
s_mov_b64 exec, 1
buffer_store_dword v8, off, s[24:27], s0 sc1
s_mov_b64 exec, -1
s_waitcnt vmcnt(0)
L_nroot:
v_mul_u32_u24 v1, 43, v0
v_lshrrev_b32 v1, 9, v1
v_mul_u32_u24 v1, 2880, v1
s_mul_i32 s0, s36, 192
s_mul_i32 s3, s32, 24576
s_add_u32 s0, s0, s3
v_add3_u32 v4, v1, v6, s0
s_mul_i32 s45, s32, 1536
s_lshr_b32 s3, s32, 1
s_lshl_b32 s3, s3, 4
s_add_u32 s45, s45, s3
s_mov_b32 s44, 0
s_mov_b32 s3, 12288
s_mov_b32 exec_hi, 0xffff
s_add_u32 m0, s45, 0
s_nop 0
buffer_load_dwordx4 v4, s[4:7], s44 offen lds
s_add_u32 m0, s45, 768
s_nop 0
buffer_load_dwordx4 v4, s[4:7], s3 offen lds
s_add_u32 m0, s45, 12416
s_nop 0
buffer_load_dwordx4 v4, s[8:11], s44 offen lds
s_add_u32 m0, s45, 13184
s_nop 0
buffer_load_dwordx4 v4, s[8:11], s3 offen lds
s_mov_b32 exec_hi, -1
s_mov_b32 s44, 196608
s_mov_b32 s3, 208896
s_mov_b32 exec_hi, 0xffff
s_add_u32 m0, s45, 24832
s_nop 0
buffer_load_dwordx4 v4, s[4:7], s44 offen lds
s_add_u32 m0, s45, 25600
s_nop 0
buffer_load_dwordx4 v4, s[4:7], s3 offen lds
s_add_u32 m0, s45, 37248
s_nop 0
buffer_load_dwordx4 v4, s[8:11], s44 offen lds
s_add_u32 m0, s45, 38016
s_nop 0
buffer_load_dwordx4 v4, s[8:11], s3 offen lds
s_mov_b32 exec_hi, -1
v_lshrrev_b32 v1, 5, v0
v_lshlrev_b32 v1, 2, v1
v_bfe_u32 v2, v0, 2, 1
v_add_u32 v1, v1, v2
v_mul_u32_u24 v1, 192, v1
v_bfe_u32 v2, v0, 4, 1
v_bfe_u32 v3, v0, 3, 1
v_lshl_add_u32 v2, v3, 1, v2
v_mul_u32_u24 v2, 3088, v2
v_add_u32 v1, v1, v2
v_and_b32 v2, 1, v0
v_lshl_add_u32 v1, v2, 3, v1
v_bfe_u32 v2, v0, 1, 1
v_mul_u32_u24 v2, 12416, v2
s_lshl_b32 s3, s32, 4
v_add3_u32 v5, v1, v2, s3
s_mul_i32 s46, s36, 122880
s_waitcnt vmcnt(4) lgkmcnt(0)
s_barrier
s_mov_b32 s44, 393216
s_mov_b32 s3, 405504
s_mov_b32 exec_hi, 0xffff
s_add_u32 m0, s45, 49664
s_nop 0
buffer_load_dwordx4 v4, s[4:7], s44 offen lds
s_add_u32 m0, s45, 50432
s_nop 0
buffer_load_dwordx4 v4, s[4:7], s3 offen lds
s_add_u32 m0, s45, 62080
s_nop 0
buffer_load_dwordx4 v4, s[8:11], s44 offen lds
s_add_u32 m0, s45, 62848
s_nop 0
buffer_load_dwordx4 v4, s[8:11], s3 offen lds
s_mov_b32 exec_hi, -1
ds_read_b64_tr_b16 v[8:9], v5 offset:64
ds_read_b64_tr_b16 v[10:11], v5 offset:448
ds_read_b64_tr_b16 v[12:13], v5 offset:1600
ds_read_b64_tr_b16 v[14:15], v5 offset:1984
s_cmp_lt_u32 s32, 4
s_cbranch_scc0 L_g0
ds_read_b64_tr_b16 v[88:89], v5 offset:0
ds_read_b64_tr_b16 v[90:91], v5 offset:384
ds_read_b64_tr_b16 v[92:93], v5 offset:1536
ds_read_b64_tr_b16 v[94:95], v5 offset:1920
L_g0:
s_waitcnt vmcnt(4) lgkmcnt(0)
s_barrier
s_mov_b32 s44, 589824
s_mov_b32 s3, 602112
s_mov_b32 exec_hi, 0xffff
s_add_u32 m0, s45, 0
s_nop 0
buffer_load_dwordx4 v4, s[4:7], s44 offen lds
s_add_u32 m0, s45, 768
s_nop 0
buffer_load_dwordx4 v4, s[4:7], s3 offen lds
s_add_u32 m0, s45, 12416
s_nop 0
buffer_load_dwordx4 v4, s[8:11], s44 offen lds
s_add_u32 m0, s45, 13184
s_nop 0
buffer_load_dwordx4 v4, s[8:11], s3 offen lds
s_mov_b32 exec_hi, -1
ds_read_b64_tr_b16 v[16:17], v5 offset:24896
ds_read_b64_tr_b16 v[18:19], v5 offset:25280
ds_read_b64_tr_b16 v[20:21], v5 offset:26432
ds_read_b64_tr_b16 v[22:23], v5 offset:26816
s_cmp_lt_u32 s32, 4
s_cbranch_scc0 L_g1
ds_read_b64_tr_b16 v[96:97], v5 offset:24832
ds_read_b64_tr_b16 v[98:99], v5 offset:25216
ds_read_b64_tr_b16 v[100:101], v5 offset:26368
ds_read_b64_tr_b16 v[102:103], v5 offset:26752
L_g1:
s_waitcnt vmcnt(4) lgkmcnt(0)
s_barrier
s_mov_b32 s44, 786432
s_mov_b32 s3, 798720
s_mov_b32 exec_hi, 0xffff
s_add_u32 m0, s45, 24832
s_nop 0
buffer_load_dwordx4 v4, s[4:7], s44 offen lds
s_add_u32 m0, s45, 25600
s_nop 0
buffer_load_dwordx4 v4, s[4:7], s3 offen lds
s_add_u32 m0, s45, 37248
s_nop 0
buffer_load_dwordx4 v4, s[8:11], s44 offen lds
s_add_u32 m0, s45, 38016
s_nop 0
buffer_load_dwordx4 v4, s[8:11], s3 offen lds
s_mov_b32 exec_hi, -1
ds_read_b64_tr_b16 v[24:25], v5 offset:49728
ds_read_b64_tr_b16 v[26:27], v5 offset:50112
ds_read_b64_tr_b16 v[28:29], v5 offset:51264
ds_read_b64_tr_b16 v[30:31], v5 offset:51648
s_cmp_lt_u32 s32, 4
s_cbranch_scc0 L_g2
ds_read_b64_tr_b16 v[104:105], v5 offset:49664
ds_read_b64_tr_b16 v[106:107], v5 offset:50048
ds_read_b64_tr_b16 v[108:109], v5 offset:51200
ds_read_b64_tr_b16 v[110:111], v5 offset:51584
L_g2:
s_waitcnt vmcnt(4) lgkmcnt(0)
s_barrier
s_mov_b32 s44, 983040
s_mov_b32 s3, 995328
s_mov_b32 exec_hi, 0xffff
s_add_u32 m0, s45, 49664
s_nop 0
buffer_load_dwordx4 v4, s[4:7], s44 offen lds
s_add_u32 m0, s45, 50432
s_nop 0
buffer_load_dwordx4 v4, s[4:7], s3 offen lds
s_add_u32 m0, s45, 62080
s_nop 0
buffer_load_dwordx4 v4, s[8:11], s44 offen lds
s_add_u32 m0, s45, 62848
s_nop 0
buffer_load_dwordx4 v4, s[8:11], s3 offen lds
s_mov_b32 exec_hi, -1
ds_read_b64_tr_b16 v[32:33], v5 offset:64
ds_read_b64_tr_b16 v[34:35], v5 offset:448
ds_read_b64_tr_b16 v[36:37], v5 offset:1600
ds_read_b64_tr_b16 v[38:39], v5 offset:1984
s_cmp_lt_u32 s32, 4
s_cbranch_scc0 L_g3
ds_read_b64_tr_b16 v[112:113], v5 offset:0
ds_read_b64_tr_b16 v[114:115], v5 offset:384
ds_read_b64_tr_b16 v[116:117], v5 offset:1536
ds_read_b64_tr_b16 v[118:119], v5 offset:1920
L_g3:
s_waitcnt vmcnt(4) lgkmcnt(0)
s_barrier
s_mov_b32 s44, 1179648
s_mov_b32 s3, 1191936
s_mov_b32 exec_hi, 0xffff
s_add_u32 m0, s45, 0
s_nop 0
buffer_load_dwordx4 v4, s[4:7], s44 offen lds
s_add_u32 m0, s45, 768
s_nop 0
buffer_load_dwordx4 v4, s[4:7], s3 offen lds
s_add_u32 m0, s45, 12416
s_nop 0
buffer_load_dwordx4 v4, s[8:11], s44 offen lds
s_add_u32 m0, s45, 13184
s_nop 0
buffer_load_dwordx4 v4, s[8:11], s3 offen lds
s_mov_b32 exec_hi, -1
ds_read_b64_tr_b16 v[40:41], v5 offset:24896
ds_read_b64_tr_b16 v[42:43], v5 offset:25280
ds_read_b64_tr_b16 v[44:45], v5 offset:26432
ds_read_b64_tr_b16 v[46:47], v5 offset:26816
s_cmp_lt_u32 s32, 4
s_cbranch_scc0 L_g4
ds_read_b64_tr_b16 v[120:121], v5 offset:24832
ds_read_b64_tr_b16 v[122:123], v5 offset:25216
ds_read_b64_tr_b16 v[124:125], v5 offset:26368
ds_read_b64_tr_b16 v[126:127], v5 offset:26752
L_g4:
s_waitcnt vmcnt(4) lgkmcnt(0)
s_barrier
s_mov_b32 s44, 1376256
s_mov_b32 s3, 1388544
s_mov_b32 exec_hi, 0xffff
s_add_u32 m0, s45, 24832
s_nop 0
buffer_load_dwordx4 v4, s[4:7], s44 offen lds
s_add_u32 m0, s45, 25600
s_nop 0
buffer_load_dwordx4 v4, s[4:7], s3 offen lds
s_add_u32 m0, s45, 37248
s_nop 0
buffer_load_dwordx4 v4, s[8:11], s44 offen lds
s_add_u32 m0, s45, 38016
s_nop 0
buffer_load_dwordx4 v4, s[8:11], s3 offen lds
s_mov_b32 exec_hi, -1
ds_read_b64_tr_b16 v[48:49], v5 offset:49728
ds_read_b64_tr_b16 v[50:51], v5 offset:50112
ds_read_b64_tr_b16 v[52:53], v5 offset:51264
ds_read_b64_tr_b16 v[54:55], v5 offset:51648
s_cmp_lt_u32 s32, 4
s_cbranch_scc0 L_g5
ds_read_b64_tr_b16 v[128:129], v5 offset:49664
ds_read_b64_tr_b16 v[130:131], v5 offset:50048
ds_read_b64_tr_b16 v[132:133], v5 offset:51200
ds_read_b64_tr_b16 v[134:135], v5 offset:51584
L_g5:
s_waitcnt vmcnt(4) lgkmcnt(0)
s_barrier
s_mov_b32 s44, 1572864
s_mov_b32 s3, 1585152
s_mov_b32 exec_hi, 0xffff
s_add_u32 m0, s45, 49664
s_nop 0
buffer_load_dwordx4 v4, s[4:7], s44 offen lds
s_add_u32 m0, s45, 50432
s_nop 0
buffer_load_dwordx4 v4, s[4:7], s3 offen lds
s_add_u32 m0, s45, 62080
s_nop 0
buffer_load_dwordx4 v4, s[8:11], s44 offen lds
s_add_u32 m0, s45, 62848
s_nop 0
buffer_load_dwordx4 v4, s[8:11], s3 offen lds
s_mov_b32 exec_hi, -1
ds_read_b64_tr_b16 v[56:57], v5 offset:64
ds_read_b64_tr_b16 v[58:59], v5 offset:448
ds_read_b64_tr_b16 v[60:61], v5 offset:1600
ds_read_b64_tr_b16 v[62:63], v5 offset:1984
s_cmp_lt_u32 s32, 4
s_cbranch_scc0 L_g6
ds_read_b64_tr_b16 v[136:137], v5 offset:0
ds_read_b64_tr_b16 v[138:139], v5 offset:384
ds_read_b64_tr_b16 v[140:141], v5 offset:1536
ds_read_b64_tr_b16 v[142:143], v5 offset:1920
L_g6:
s_waitcnt vmcnt(4) lgkmcnt(0)
s_barrier
s_mov_b32 s44, 1769472
s_mov_b32 s3, 1781760
s_mov_b32 exec_hi, 0xffff
s_add_u32 m0, s45, 0
s_nop 0
buffer_load_dwordx4 v4, s[4:7], s44 offen lds
s_add_u32 m0, s45, 768
s_nop 0
buffer_load_dwordx4 v4, s[4:7], s3 offen lds
s_add_u32 m0, s45, 12416
s_nop 0
buffer_load_dwordx4 v4, s[8:11], s44 offen lds
s_add_u32 m0, s45, 13184
s_nop 0
buffer_load_dwordx4 v4, s[8:11], s3 offen lds
s_mov_b32 exec_hi, -1
ds_read_b64_tr_b16 v[64:65], v5 offset:24896
ds_read_b64_tr_b16 v[66:67], v5 offset:25280
ds_read_b64_tr_b16 v[68:69], v5 offset:26432
ds_read_b64_tr_b16 v[70:71], v5 offset:26816
s_cmp_lt_u32 s32, 4
s_cbranch_scc0 L_g7
ds_read_b64_tr_b16 v[144:145], v5 offset:24832
ds_read_b64_tr_b16 v[146:147], v5 offset:25216
ds_read_b64_tr_b16 v[148:149], v5 offset:26368
ds_read_b64_tr_b16 v[150:151], v5 offset:26752
L_g7:
s_waitcnt vmcnt(4) lgkmcnt(0)
s_barrier
s_lshl_b32 s3, s32, 6
s_addk_i32 s3, 0
v_add_u32 v1, s3, v0
v_mul_u32_u24 v2, 52429, v1
v_lshrrev_b32 v2, 22, v2
v_and_b32 v3, 3, v2
v_lshlrev_b32 v3, 1, v3
v_and_or_b32 v3, v2, 8, v3
v_xor_b32 v1, v1, v3
v_lshlrev_b32 v1, 4, v1
s_lshl_b32 s3, s32, 10
s_add_u32 m0, s3, 74496
s_nop 0
buffer_load_dwordx4 v1, s[12:15], s46 offen lds
s_lshl_b32 s3, s32, 6
s_addk_i32 s3, 512
v_add_u32 v1, s3, v0
v_mul_u32_u24 v2, 52429, v1
v_lshrrev_b32 v2, 22, v2
v_and_b32 v3, 3, v2
v_lshlrev_b32 v3, 1, v3
v_and_or_b32 v3, v2, 8, v3
v_xor_b32 v1, v1, v3
v_lshlrev_b32 v1, 4, v1
s_lshl_b32 s3, s32, 10
s_add_u32 m0, s3, 82688
s_nop 0
buffer_load_dwordx4 v1, s[12:15], s46 offen lds
s_lshl_b32 s3, s32, 6
s_addk_i32 s3, 1024
v_add_u32 v1, s3, v0
v_mul_u32_u24 v2, 52429, v1
v_lshrrev_b32 v2, 22, v2
v_and_b32 v3, 3, v2
v_lshlrev_b32 v3, 1, v3
v_and_or_b32 v3, v2, 8, v3
v_xor_b32 v1, v1, v3
v_lshlrev_b32 v1, 4, v1
s_lshl_b32 s3, s32, 10
s_add_u32 m0, s3, 90880
s_nop 0
buffer_load_dwordx4 v1, s[12:15], s46 offen lds
s_lshl_b32 s3, s32, 6
s_addk_i32 s3, 1536
v_add_u32 v1, s3, v0
v_mul_u32_u24 v2, 52429, v1
v_lshrrev_b32 v2, 22, v2
v_and_b32 v3, 3, v2
v_lshlrev_b32 v3, 1, v3
v_and_or_b32 v3, v2, 8, v3
v_xor_b32 v1, v1, v3
v_lshlrev_b32 v1, 4, v1
s_lshl_b32 s3, s32, 10
s_add_u32 m0, s3, 99072
s_nop 0
buffer_load_dwordx4 v1, s[12:15], s46 offen lds
s_lshl_b32 s3, s32, 6
s_addk_i32 s3, 2048
v_add_u32 v1, s3, v0
v_mul_u32_u24 v2, 52429, v1
v_lshrrev_b32 v2, 22, v2
v_and_b32 v3, 3, v2
v_lshlrev_b32 v3, 1, v3
v_and_or_b32 v3, v2, 8, v3
v_xor_b32 v1, v1, v3
v_lshlrev_b32 v1, 4, v1
s_lshl_b32 s3, s32, 10
s_add_u32 m0, s3, 107264
s_nop 0
buffer_load_dwordx4 v1, s[12:15], s46 offen lds
ds_read_b64_tr_b16 v[72:73], v5 offset:49728
ds_read_b64_tr_b16 v[74:75], v5 offset:50112
ds_read_b64_tr_b16 v[76:77], v5 offset:51264
ds_read_b64_tr_b16 v[78:79], v5 offset:51648
s_cmp_lt_u32 s32, 4
s_cbranch_scc0 L_g8
ds_read_b64_tr_b16 v[152:153], v5 offset:49664
ds_read_b64_tr_b16 v[154:155], v5 offset:50048
ds_read_b64_tr_b16 v[156:157], v5 offset:51200
ds_read_b64_tr_b16 v[158:159], v5 offset:51584
L_g8:
s_waitcnt vmcnt(5) lgkmcnt(0)
s_barrier
s_lshl_b32 s3, s32, 6
s_addk_i32 s3, 2560
v_add_u32 v1, s3, v0
v_mul_u32_u24 v2, 52429, v1
v_lshrrev_b32 v2, 22, v2
v_and_b32 v3, 3, v2
v_lshlrev_b32 v3, 1, v3
v_and_or_b32 v3, v2, 8, v3
v_xor_b32 v1, v1, v3
v_lshlrev_b32 v1, 4, v1
s_lshl_b32 s3, s32, 10
s_add_u32 m0, s3, 115456
s_nop 0
buffer_load_dwordx4 v1, s[12:15], s46 offen lds
s_lshl_b32 s3, s32, 6
s_addk_i32 s3, 3072
v_add_u32 v1, s3, v0
v_mul_u32_u24 v2, 52429, v1
v_lshrrev_b32 v2, 22, v2
v_and_b32 v3, 3, v2
v_lshlrev_b32 v3, 1, v3
v_and_or_b32 v3, v2, 8, v3
v_xor_b32 v1, v1, v3
v_lshlrev_b32 v1, 4, v1
s_lshl_b32 s3, s32, 10
s_add_u32 m0, s3, 123648
s_nop 0
buffer_load_dwordx4 v1, s[12:15], s46 offen lds
s_lshl_b32 s3, s32, 6
s_addk_i32 s3, 3584
v_add_u32 v1, s3, v0
v_mul_u32_u24 v2, 52429, v1
v_lshrrev_b32 v2, 22, v2
v_and_b32 v3, 3, v2
v_lshlrev_b32 v3, 1, v3
v_and_or_b32 v3, v2, 8, v3
v_xor_b32 v1, v1, v3
v_lshlrev_b32 v1, 4, v1
s_lshl_b32 s3, s32, 10
s_add_u32 m0, s3, 131840
s_nop 0
buffer_load_dwordx4 v1, s[12:15], s46 offen lds
s_lshl_b32 s3, s32, 6
s_addk_i32 s3, 4096
v_add_u32 v1, s3, v0
v_mul_u32_u24 v2, 52429, v1
v_lshrrev_b32 v2, 22, v2
v_and_b32 v3, 3, v2
v_lshlrev_b32 v3, 1, v3
v_and_or_b32 v3, v2, 8, v3
v_xor_b32 v1, v1, v3
v_lshlrev_b32 v1, 4, v1
s_lshl_b32 s3, s32, 10
s_add_u32 m0, s3, 140032
s_nop 0
buffer_load_dwordx4 v1, s[12:15], s46 offen lds
s_lshl_b32 s3, s32, 6
s_addk_i32 s3, 4608
v_add_u32 v1, s3, v0
v_mul_u32_u24 v2, 52429, v1
v_lshrrev_b32 v2, 22, v2
v_and_b32 v3, 3, v2
v_lshlrev_b32 v3, 1, v3
v_and_or_b32 v3, v2, 8, v3
v_xor_b32 v1, v1, v3
v_lshlrev_b32 v1, 4, v1
s_lshl_b32 s3, s32, 10
s_add_u32 m0, s3, 148224
s_nop 0
buffer_load_dwordx4 v1, s[12:15], s46 offen lds
ds_read_b64_tr_b16 v[80:81], v5 offset:64
ds_read_b64_tr_b16 v[82:83], v5 offset:448
ds_read_b64_tr_b16 v[84:85], v5 offset:1600
ds_read_b64_tr_b16 v[86:87], v5 offset:1984
s_cmp_lt_u32 s32, 4
s_cbranch_scc0 L_g9
ds_read_b64_tr_b16 v[160:161], v5 offset:0
ds_read_b64_tr_b16 v[162:163], v5 offset:384
ds_read_b64_tr_b16 v[164:165], v5 offset:1536
ds_read_b64_tr_b16 v[166:167], v5 offset:1920
L_g9:
s_waitcnt lgkmcnt(0)
s_barrier
s_lshl_b32 s3, s32, 6
s_addk_i32 s3, 5120
v_add_u32 v1, s3, v0
v_mul_u32_u24 v2, 52429, v1
v_lshrrev_b32 v2, 22, v2
v_and_b32 v3, 3, v2
v_lshlrev_b32 v3, 1, v3
v_and_or_b32 v3, v2, 8, v3
v_xor_b32 v1, v1, v3
v_lshlrev_b32 v1, 4, v1
s_lshl_b32 s3, s32, 10
s_add_u32 m0, s3, 0
s_nop 0
buffer_load_dwordx4 v1, s[12:15], s46 offen lds
s_lshl_b32 s3, s32, 6
s_addk_i32 s3, 5632
v_add_u32 v1, s3, v0
v_mul_u32_u24 v2, 52429, v1
v_lshrrev_b32 v2, 22, v2
v_and_b32 v3, 3, v2
v_lshlrev_b32 v3, 1, v3
v_and_or_b32 v3, v2, 8, v3
v_xor_b32 v1, v1, v3
v_lshlrev_b32 v1, 4, v1
s_lshl_b32 s3, s32, 10
s_add_u32 m0, s3, 8192
s_nop 0
buffer_load_dwordx4 v1, s[12:15], s46 offen lds
s_lshl_b32 s3, s32, 6
s_addk_i32 s3, 6144
v_add_u32 v1, s3, v0
v_mul_u32_u24 v2, 52429, v1
v_lshrrev_b32 v2, 22, v2
v_and_b32 v3, 3, v2
v_lshlrev_b32 v3, 1, v3
v_and_or_b32 v3, v2, 8, v3
v_xor_b32 v1, v1, v3
v_lshlrev_b32 v1, 4, v1
s_lshl_b32 s3, s32, 10
s_add_u32 m0, s3, 16384
s_nop 0
buffer_load_dwordx4 v1, s[12:15], s46 offen lds
s_lshl_b32 s3, s32, 6
s_addk_i32 s3, 6656
v_add_u32 v1, s3, v0
v_mul_u32_u24 v2, 52429, v1
v_lshrrev_b32 v2, 22, v2
v_and_b32 v3, 3, v2
v_lshlrev_b32 v3, 1, v3
v_and_or_b32 v3, v2, 8, v3
v_xor_b32 v1, v1, v3
v_lshlrev_b32 v1, 4, v1
s_lshl_b32 s3, s32, 10
s_add_u32 m0, s3, 24576
s_nop 0
buffer_load_dwordx4 v1, s[12:15], s46 offen lds
s_lshl_b32 s3, s32, 6
s_addk_i32 s3, 7168
v_add_u32 v1, s3, v0
v_mul_u32_u24 v2, 52429, v1
v_lshrrev_b32 v2, 22, v2
v_and_b32 v3, 3, v2
v_lshlrev_b32 v3, 1, v3
v_and_or_b32 v3, v2, 8, v3
v_xor_b32 v1, v1, v3
v_lshlrev_b32 v1, 4, v1
s_lshl_b32 s3, s32, 10
s_add_u32 m0, s3, 32768
s_nop 0
buffer_load_dwordx4 v1, s[12:15], s46 offen lds
v_lshrrev_b32 v1, 4, v0
v_bfe_u32 v2, v0, 2, 2
v_lshl_add_u32 v1, v1, 3, v2
v_mul_u32_u24 v1, 1280, v1
v_and_b32 v3, 1, v0
v_lshl_add_u32 v1, v3, 3, v1
v_bfe_u32 v2, v0, 2, 3
v_lshlrev_b32 v2, 1, v2
v_bfe_u32 v3, v0, 1, 1
s_mul_i32 s0, s32, 10
s_add_u32 s3, s0, 0
v_add_u32 v236, s3, v3
v_xor_b32 v236, v236, v2
v_lshl_add_u32 v236, v236, 4, v1
v_add_u32 v241, 74496, v236
s_add_u32 s3, s0, 2
v_add_u32 v237, s3, v3
v_xor_b32 v237, v237, v2
v_lshl_add_u32 v237, v237, 4, v1
v_add_u32 v242, 74496, v237
s_add_u32 s3, s0, 4
v_add_u32 v238, s3, v3
v_xor_b32 v238, v238, v2
v_lshl_add_u32 v238, v238, 4, v1
v_add_u32 v243, 74496, v238
s_add_u32 s3, s0, 6
v_add_u32 v239, s3, v3
v_xor_b32 v239, v239, v2
v_lshl_add_u32 v239, v239, 4, v1
v_add_u32 v244, 74496, v239
s_add_u32 s3, s0, 8
v_add_u32 v240, s3, v3
v_xor_b32 v240, v240, v2
v_lshl_add_u32 v240, v240, 4, v1
v_add_u32 v245, 74496, v240
s_waitcnt vmcnt(5)
s_barrier
ds_read_b64_tr_b16 v[168:169], v241 offset:0
ds_read_b64_tr_b16 v[170:171], v241 offset:5120
ds_read_b64_tr_b16 v[172:173], v241 offset:40960
ds_read_b64_tr_b16 v[174:175], v241 offset:46080
ds_read_b64_tr_b16 v[180:181], v242 offset:0
ds_read_b64_tr_b16 v[182:183], v242 offset:5120
ds_read_b64_tr_b16 v[184:185], v242 offset:40960
ds_read_b64_tr_b16 v[186:187], v242 offset:46080
ds_read_b64_tr_b16 v[192:193], v243 offset:0
ds_read_b64_tr_b16 v[194:195], v243 offset:5120
ds_read_b64_tr_b16 v[196:197], v243 offset:40960
ds_read_b64_tr_b16 v[198:199], v243 offset:46080
ds_read_b64_tr_b16 v[204:205], v244 offset:0
ds_read_b64_tr_b16 v[206:207], v244 offset:5120
ds_read_b64_tr_b16 v[208:209], v244 offset:40960
ds_read_b64_tr_b16 v[210:211], v244 offset:46080
ds_read_b64_tr_b16 v[216:217], v245 offset:0
ds_read_b64_tr_b16 v[218:219], v245 offset:5120
ds_read_b64_tr_b16 v[220:221], v245 offset:40960
ds_read_b64_tr_b16 v[222:223], v245 offset:46080
s_waitcnt vmcnt(0)
s_barrier
ds_read_b64_tr_b16 v[176:177], v236 offset:0
ds_read_b64_tr_b16 v[178:179], v236 offset:5120
ds_read_b64_tr_b16 v[188:189], v237 offset:0
ds_read_b64_tr_b16 v[190:191], v237 offset:5120
ds_read_b64_tr_b16 v[200:201], v238 offset:0
ds_read_b64_tr_b16 v[202:203], v238 offset:5120
ds_read_b64_tr_b16 v[212:213], v239 offset:0
ds_read_b64_tr_b16 v[214:215], v239 offset:5120
ds_read_b64_tr_b16 v[224:225], v240 offset:0
ds_read_b64_tr_b16 v[226:227], v240 offset:5120
v_mov_b32 v228, 0
v_mov_b32 v229, 0
v_mov_b32 v230, 0
v_mov_b32 v231, 0
v_mov_b32 v232, 0
v_mov_b32 v233, 0
v_mov_b32 v234, 0
v_mov_b32 v235, 0
v_mov_b32 v1, 0x4444
v_mov_b32 v2, 0xeeee
s_mov_b32 vcc_lo, 0xaaaaaaaa
s_mov_b32 vcc_hi, 0xaaaaaaaa
v_cndmask_b32 v7, v1, v2, vcc
v_and_b32 v1, 48, v0
v_and_b32 v2, 1, v0
v_lshlrev_b32 v2, 4, v2
v_lshl_add_u32 v252, v1, 1, v2
v_add_u32 v254, 156416, v252
v_add_u32 v252, 156928, v252
v_add_u32 v1, 156544, v1
v_mov_b32 v2, 156608
v_cndmask_b32 v255, v1, v2, vcc
v_mov_b32 v3, 0
v_lshl_add_u32 v2, v0, 2, v2
s_mov_b64 exec, 0xff
ds_write_b32 v2, v3
s_mov_b64 exec, -1
v_bfe_u32 v1, v0, 4, 1
v_lshlrev_b32 v1, 2, v1
s_add_u32 s3, s32, 4
v_sub_u32 v1, s3, v1
v_lshrrev_b32 v2, 1, v1
v_lshlrev_b32 v2, 2, v2
v_and_or_b32 v2, v1, 1, v2
v_and_or_b32 v2, v0, 2, v2
v_bfe_u32 v3, v0, 2, 1
v_lshl_add_u32 v2, v2, 1, v3
v_and_b32 v3, 1, v0
v_lshl_add_u32 v2, v2, 1, v3
v_and_b32 v3, 7, v0
v_lshl_add_u32 v3, v1, 3, v3
v_cmp_gt_u32 vcc, 8, v1
s_nop 1
v_cndmask_b32 v2, v3, v2, vcc
v_lshlrev_b32 v2, 1, v2
v_add_u32 v253, 156416, v2
s_lshl_b32 s47, s32, 15
s_lshl_b32 s3, s36, 6
s_add_u32 s47, s47, s3
s_add_u32 s47, s47, 3162112
v_lshrrev_b32 v1, 2, v0
v_and_b32 v2, 3, v0
v_lshlrev_b32 v2, 4, v2
v_lshl_add_u32 v2, v1, 10, v2
v_lshlrev_b32 v1, 4, v1
v_add_u32 v1, 4032, v1
s_mov_b64 vcc, 0xffff
v_cndmask_b32 v5, v1, v2, vcc
s_cmp_lt_u32 s32, 4
s_cselect_b32 s50, 0x00ff0000, 0
s_or_b32 s50, s50, 0xff
s_mov_b32 s51, 0
s_sub_u32 s3, s32, 4
s_lshl_b32 s3, s3, 4
s_add_u32 s52, s3, s36
s_mul_i32 s3, s52, 52
s_lshr_b32 s3, s3, 8
s_mul_i32 s3, s3, 27648
s_lshl_b32 s53, s52, 10
s_add_u32 s53, s53, s3
s_add_u32 s53, s53, 3162112
s_mov_b32 s49, 131072
v_mov_b32 v4, 156672
s_cmp_lt_u32 s32, 4
s_cbranch_scc1 L_np
s_mul_i32 s3, s52, 52
s_lshr_b32 s3, s3, 8
s_mul_i32 s0, s3, 5
s_sub_u32 s0, s52, s0
s_mul_i32 s3, s3, 80
s_lshl_b32 s1, s0, 2
s_cmp_eq_u32 s0, 4
s_cselect_b32 s1, 64, s1
s_cselect_b32 s0, 0, 4
s_cselect_b32 s48, 2, 0
s_add_u32 s3, s3, s1
v_bfe_u32 v1, v0, 4, 1
v_lshrrev_b32 v2, 5, v0
v_lshl_add_u32 v1, v1, 1, v2
v_lshlrev_b32 v1, s0, v1
v_and_b32 v2, 3, v0
v_lshlrev_b32 v2, s48, v2
v_add3_u32 v1, v1, v2, s3
v_lshlrev_b32 v128, 1, v1
v_lshlrev_b32 v129, 2, v1
s_cmp_eq_u32 s32, 7
s_cbranch_scc0 L_np
v_and_b32 v1, 7, v0
v_lshlrev_b32 v1, 5, v1
L_rt:
buffer_load_dword v2, v1, s[24:27], 0 offen sc1
s_waitcnt vmcnt(0)
v_cmp_ne_u32 vcc, 1, v2
s_cbranch_vccz L_rtg
s_sub_u32 s40, s40, 1
s_cbranch_scc0 L_rt
s_mov_b32 s40, 0
L_rtg:
v_bfe_u32 v1, v0, 2, 3
v_lshlrev_b32 v1, 15, v1
v_and_b32 v2, 3, v0
v_min_u32 v2, 2, v2
v_mul_u32_u24 v3, 1280, v2
s_mov_b32 s0, 3145728
v_add3_u32 v3, v3, v1, s0
v_lshl_add_u32 v1, v2, 7, v1
s_mul_i32 s0, s36, 384
s_add_u32 s0, s0, 3167232
s_mov_b32 s54, 0
s_mov_b32 s55, 0x80000000
s_mov_b32 m0, 156928
v_mov_b32 v140, -1
v_mov_b32 v141, -1
v_mov_b32 v142, -1
L_pk:
s_mov_b64 exec, -1
s_nop 0
buffer_load_dwordx4 v6, s[16:19], s55 offen sc1 lds
s_mov_b64 exec, 0xffff
buffer_load_dwordx4 v6, s[16:19], s55 offen offset:1024 sc1 lds
s_mov_b64 exec, 0x77777777
buffer_atomic_umin v140, v1, s[16:19], s0 offen sc0 sc1
s_waitcnt vmcnt(0)
v_cmp_lt_u32 vcc, s54, v140
s_cbranch_vccz L_pg
s_nop 0
v_cndmask_b32 v2, -1, v140, vcc
v_cmp_ne_u32 vcc, -1, v2
s_cbranch_vccnz L_pn
s_mov_b64 exec, -1
buffer_load_dwordx4 v6, s[16:19], s55 offen sc1 lds
s_mov_b64 exec, 0xffff
buffer_load_dwordx4 v6, s[16:19], s55 offen offset:1024 sc1 lds
s_mov_b64 exec, 0x77777777
buffer_atomic_umin v140, v1, s[16:19], s0 offen sc0 sc1
s_sleep 2
buffer_atomic_umin v141, v1, s[16:19], s0 offen sc0 sc1
s_sleep 2
L_pl:
buffer_atomic_umin v142, v1, s[16:19], s0 offen sc0 sc1
s_waitcnt vmcnt(2)
v_cmp_lt_u32 vcc, s54, v140
s_cbranch_vccz L_pg
s_nop 0
v_cndmask_b32 v2, -1, v140, vcc
v_cmp_ne_u32 vcc, -1, v2
s_cbranch_vccnz L_pn
s_sleep 2
s_mov_b64 exec, -1
buffer_load_dwordx4 v6, s[16:19], s55 offen sc1 lds
s_mov_b64 exec, 0xffff
buffer_load_dwordx4 v6, s[16:19], s55 offen offset:1024 sc1 lds
s_mov_b64 exec, 0x77777777
buffer_atomic_umin v140, v1, s[16:19], s0 offen sc0 sc1
s_waitcnt vmcnt(4)
v_cmp_lt_u32 vcc, s54, v141
s_cbranch_vccz L_pg
s_nop 0
v_cndmask_b32 v2, -1, v141, vcc
v_cmp_ne_u32 vcc, -1, v2
s_cbranch_vccnz L_pn
s_sleep 2
buffer_atomic_umin v141, v1, s[16:19], s0 offen sc0 sc1
s_waitcnt vmcnt(4)
v_cmp_lt_u32 vcc, s54, v142
s_cbranch_vccz L_pg
s_nop 0
v_cndmask_b32 v2, -1, v142, vcc
v_cmp_ne_u32 vcc, -1, v2
s_cbranch_vccnz L_pn
s_sleep 2
s_sub_u32 s40, s40, 1
s_cbranch_scc0 L_pl
s_branch L_px
L_pn:
s_mov_b64 exec, -1
v_cndmask_b32 v2, 0, v2, vcc
s_nop 1
v_max_u32_dpp v236, v2, v2 row_ror:8 row_mask:0xf bank_mask:0xf
s_nop 1
v_max_u32_dpp v236, v236, v236 row_ror:4 row_mask:0xf bank_mask:0xf
s_nop 1
v_max_u32_dpp v236, v236, v236 row_ror:2 row_mask:0xf bank_mask:0xf
s_nop 1
v_max_u32_dpp v236, v236, v236 row_ror:1 row_mask:0xf bank_mask:0xf
v_mov_b32 v237, v236
s_nop 1
v_permlane16_swap_b32 v236, v237
v_max_u32 v236, v236, v237
s_mov_b32 exec_hi, 0
v_cmpx_eq_u32 vcc, v236, v2
ds_write_b64 v4, v[2:3]
s_nop 2
v_readfirstlane_b32 s55, v3
v_readfirstlane_b32 s54, v2
s_mov_b64 exec, -1
s_branch L_pk
L_xf:
s_mov_b64 exec, -1
buffer_load_dwordx4 v6, s[16:19], s55 offen sc1 lds
s_mov_b64 exec, 0xffff
buffer_load_dwordx4 v6, s[16:19], s55 offen offset:1024 sc1 lds
s_waitcnt vmcnt(0)
s_branch L_pg
L_px:
s_mov_b32 s40, 0
L_pg:
s_mov_b64 exec, -1
L_np:
s_waitcnt lgkmcnt(0)
s_barrier
s_cmp_lt_u32 s32, 4
s_cbranch_scc1 L_xh
ds_read_b64 v[2:3], v4
ds_read_b128 v[88:91], v252 offset:0
ds_read_b128 v[92:95], v252 offset:128
ds_read_b128 v[96:99], v252 offset:256
ds_read_b128 v[100:103], v252 offset:384
ds_read_b128 v[104:107], v252 offset:512
ds_read_b128 v[108:111], v252 offset:640
ds_read_b128 v[112:115], v252 offset:768
ds_read_b128 v[116:119], v252 offset:896
ds_read_b128 v[120:123], v252 offset:1024
ds_read_b128 v[124:127], v252 offset:1152
s_waitcnt lgkmcnt(10)
v_readfirstlane_b32 s56, v2
v_readfirstlane_b32 s57, v3
s_waitcnt lgkmcnt(9)
v_smfmac_f32_16x16x64_bf16 v[228:231], v[88:91], v[8:15], v7
s_and_b32 s0, s57, 0x7fff
s_add_u32 s57, s57, s0
s_add_u32 s57, s57, 4096
s_and_b32 s1, s56, 0xfffff800
s_waitcnt lgkmcnt(8)
v_smfmac_f32_16x16x64_bf16 v[228:231], v[92:95], v[16:23], v7
s_ashr_i32 s3, s1, 31
s_not_b32 s3, s3
s_or_b32 s3, s3, 0x80000000
s_xor_b32 s1, s1, s3
s_waitcnt lgkmcnt(7)
v_smfmac_f32_16x16x64_bf16 v[228:231], v[96:99], v[24:31], v7
s_andn2_b32 s56, 2047, s56
s_mul_i32 s56, s56, 1280
v_mov_b32 v130, s1
s_waitcnt lgkmcnt(6)
v_smfmac_f32_16x16x64_bf16 v[228:231], v[100:103], v[32:39], v7
v_mul_f32 v130, 0xbfb8aa3b, v130
s_waitcnt lgkmcnt(5)
v_smfmac_f32_16x16x64_bf16 v[228:231], v[104:107], v[40:47], v7
v_exp_f32 v130, v130
s_waitcnt lgkmcnt(4)
v_smfmac_f32_16x16x64_bf16 v[228:231], v[108:111], v[48:55], v7
v_add_f32 v130, 1.0, v130
s_waitcnt lgkmcnt(3)
v_smfmac_f32_16x16x64_bf16 v[228:231], v[112:115], v[56:63], v7
v_rcp_f32 v130, v130
s_waitcnt lgkmcnt(2)
v_smfmac_f32_16x16x64_bf16 v[228:231], v[116:119], v[64:71], v7
s_waitcnt lgkmcnt(1)
v_smfmac_f32_16x16x64_bf16 v[228:231], v[120:123], v[72:79], v7
s_waitcnt lgkmcnt(0)
v_smfmac_f32_16x16x64_bf16 v[228:231], v[124:127], v[80:87], v7
s_branch L_xj
L_xh:
ds_read_b128 v[236:239], v252 offset:0
ds_read_b128 v[240:243], v252 offset:128
ds_read_b128 v[244:247], v252 offset:256
ds_read_b128 v[248:251], v252 offset:384
s_waitcnt lgkmcnt(3)
v_smfmac_f32_16x16x64_bf16 v[228:231], v[236:239], v[8:15], v7
v_smfmac_f32_16x16x64_bf16 v[232:235], v[236:239], v[88:95], v7
ds_read_b128 v[236:239], v252 offset:512
s_waitcnt lgkmcnt(3)
v_smfmac_f32_16x16x64_bf16 v[228:231], v[240:243], v[16:23], v7
v_smfmac_f32_16x16x64_bf16 v[232:235], v[240:243], v[96:103], v7
ds_read_b128 v[240:243], v252 offset:640
s_waitcnt lgkmcnt(3)
v_smfmac_f32_16x16x64_bf16 v[228:231], v[244:247], v[24:31], v7
v_smfmac_f32_16x16x64_bf16 v[232:235], v[244:247], v[104:111], v7
ds_read_b128 v[244:247], v252 offset:768
s_waitcnt lgkmcnt(3)
v_smfmac_f32_16x16x64_bf16 v[228:231], v[248:251], v[32:39], v7
v_smfmac_f32_16x16x64_bf16 v[232:235], v[248:251], v[112:119], v7
ds_read_b128 v[248:251], v252 offset:896
s_waitcnt lgkmcnt(3)
v_smfmac_f32_16x16x64_bf16 v[228:231], v[236:239], v[40:47], v7
v_smfmac_f32_16x16x64_bf16 v[232:235], v[236:239], v[120:127], v7
ds_read_b128 v[236:239], v252 offset:1024
s_waitcnt lgkmcnt(3)
v_smfmac_f32_16x16x64_bf16 v[228:231], v[240:243], v[48:55], v7
v_smfmac_f32_16x16x64_bf16 v[232:235], v[240:243], v[128:135], v7
ds_read_b128 v[240:243], v252 offset:1152
s_waitcnt lgkmcnt(3)
v_smfmac_f32_16x16x64_bf16 v[228:231], v[244:247], v[56:63], v7
v_smfmac_f32_16x16x64_bf16 v[232:235], v[244:247], v[136:143], v7
s_waitcnt lgkmcnt(2)
v_smfmac_f32_16x16x64_bf16 v[228:231], v[248:251], v[64:71], v7
v_smfmac_f32_16x16x64_bf16 v[232:235], v[248:251], v[144:151], v7
s_waitcnt lgkmcnt(1)
v_smfmac_f32_16x16x64_bf16 v[228:231], v[236:239], v[72:79], v7
v_smfmac_f32_16x16x64_bf16 v[232:235], v[236:239], v[152:159], v7
s_waitcnt lgkmcnt(0)
v_smfmac_f32_16x16x64_bf16 v[228:231], v[240:243], v[80:87], v7
v_smfmac_f32_16x16x64_bf16 v[232:235], v[240:243], v[160:167], v7
L_xj:
s_mov_b64 vcc, 0xffff
s_nop 5
v_add_f32 v1, v228, v229
v_add_f32 v2, v232, v233
v_cndmask_b32 v1, v2, v1, vcc
v_cmp_u_f32 vcc, v1, v1
s_cbranch_vccnz L_xn
L_xnb:
v_mul_f32 v2, 0xbfb8aa3b, v1
v_exp_f32 v2, v2
v_mul_f32_dpp v3, v1, v1 row_ror:8 row_mask:0xf bank_mask:0xf
v_add_f32 v2, 1.0, v2
v_rcp_f32 v2, v2
s_nop 0
v_mul_f32 v1, v2, v3
v_cvt_pk_bf16_f32 v1, v1, v1
s_mov_b64 exec, s[50:51]
ds_write_b16 v253, v1
s_mov_b64 exec, -1
v_mov_b32 v2, 156624
s_waitcnt lgkmcnt(0)
s_barrier
ds_read_b32 v1, v2
ds_read_b128 v[236:239], v255
ds_read_b128 v[240:243], v254
s_waitcnt lgkmcnt(2)
v_cmp_ne_u32 vcc, 0, v1
s_cbranch_vccnz L_xsr
L_xsgo:
s_waitcnt lgkmcnt(1)
v_mfma_f32_16x16x32_bf16 v[24:27], v[236:239], v[224:227], 0
v_mfma_f32_16x16x32_bf16 v[8:11], v[236:239], v[176:179], 0
v_mfma_f32_16x16x32_bf16 v[12:15], v[236:239], v[188:191], 0
v_mfma_f32_16x16x32_bf16 v[16:19], v[236:239], v[200:203], 0
v_mfma_f32_16x16x32_bf16 v[20:23], v[236:239], v[212:215], 0
s_waitcnt lgkmcnt(0)
s_nop 0
v_smfmac_f32_16x16x64_bf16 v[24:27], v[240:243], v[216:223], v7
v_smfmac_f32_16x16x64_bf16 v[8:11], v[240:243], v[168:175], v7
v_smfmac_f32_16x16x64_bf16 v[12:15], v[240:243], v[180:187], v7
v_smfmac_f32_16x16x64_bf16 v[16:19], v[240:243], v[192:199], v7
v_smfmac_f32_16x16x64_bf16 v[20:23], v[240:243], v[204:211], v7
s_nop 3
v_add_f32 v1, v24, v25
v_add_f32 v32, v8, v9
v_add_f32 v33, v12, v13
v_add_f32 v34, v16, v17
v_add_f32 v35, v20, v21
v_mov_b32_dpp v32, v1 quad_perm:[0,0,0,0] row_mask:0x2 bank_mask:0xf
v_mov_b32_dpp v33, v1 quad_perm:[1,1,1,1] row_mask:0x2 bank_mask:0xf
v_mov_b32_dpp v34, v1 quad_perm:[2,2,2,2] row_mask:0x2 bank_mask:0xf
v_mov_b32_dpp v35, v1 quad_perm:[3,3,3,3] row_mask:0x2 bank_mask:0xf
s_mov_b64 exec, 0x1111ffff
buffer_store_dwordx4 v[32:35], v5, s[16:19], s47 offen sc1
s_mov_b64 exec, -1
s_cmp_lt_u32 s52, 40
s_cbranch_scc0 L_mfin
buffer_load_dword v44, v129, s[16:19], s57 offen sc1
buffer_load_dwordx4 v[40:43], v6, s[16:19], s53 offen sc1
L_fd:
buffer_load_dword v52, v129, s[16:19], s57 offen sc1
buffer_load_dwordx4 v[48:51], v6, s[16:19], s53 offen sc1
s_waitcnt vmcnt(2)
v_max3_u32 v1, v40, v42, v44
v_cmp_eq_u32 vcc, -1, v1
s_cbranch_vccz L_fg0
buffer_load_dword v44, v129, s[16:19], s57 offen sc1
buffer_load_dwordx4 v[40:43], v6, s[16:19], s53 offen sc1
s_waitcnt vmcnt(2)
v_max3_u32 v1, v48, v50, v52
v_cmp_eq_u32 vcc, -1, v1
s_cbranch_vccz L_fg1
s_sub_u32 s40, s40, 1
s_cbranch_scc0 L_fd
L_fg1:
v_permlane32_swap_b32 v48, v49
v_permlane32_swap_b32 v50, v51
v_add_f32 v48, v48, v49
v_add_f32 v50, v50, v51
s_nop 1
v_permlane16_swap_b32 v48, v50
v_add_f32 v48, v48, v50
s_nop 1
v_add_f32_dpp v48, v48, v48 row_ror:4 row_mask:0xf bank_mask:0xf
s_nop 1
v_add_f32_dpp v48, v48, v48 row_ror:8 row_mask:0xf bank_mask:0xf
v_fma_f32 v8, v48, v130, v52
v_cvt_pk_bf16_f32 v8, v8, v8
s_mov_b32 exec_lo, 0xf000f
s_mov_b32 exec_hi, 0xf000f
buffer_store_short v8, v128, s[20:23], s56 offen
s_endpgm
L_fg0:
v_permlane32_swap_b32 v40, v41
v_permlane32_swap_b32 v42, v43
v_add_f32 v40, v40, v41
v_add_f32 v42, v42, v43
s_nop 1
v_permlane16_swap_b32 v40, v42
v_add_f32 v40, v40, v42
s_nop 1
v_add_f32_dpp v40, v40, v40 row_ror:4 row_mask:0xf bank_mask:0xf
s_nop 1
v_add_f32_dpp v40, v40, v40 row_ror:8 row_mask:0xf bank_mask:0xf
v_fma_f32 v8, v40, v130, v44
v_cvt_pk_bf16_f32 v8, v8, v8
s_mov_b32 exec_lo, 0xf000f
s_mov_b32 exec_hi, 0xf000f
buffer_store_short v8, v128, s[20:23], s56 offen
L_mfin:
s_endpgm
L_xn:
v_mov_b32 v2, 156624
ds_write_b32 v2, v2
s_branch L_xnb
L_xsr:
s_sub_u32 s49, s49, 1
s_cbranch_scc1 L_xsgo
v_mov_b32 v228, 0
v_mov_b32 v229, 0
v_mov_b32 v230, 0
v_mov_b32 v231, 0
v_mov_b32 v232, 0
v_mov_b32 v233, 0
v_mov_b32 v234, 0
v_mov_b32 v235, 0
s_waitcnt lgkmcnt(0)
s_barrier
s_cmp_eq_u32 s32, 7
s_cbranch_scc0 L_np
ds_write_b32 v2, v228
s_branch L_xf
L_end:
s_endpgm
.if L_end - sequential_preLN__sliding_local_dilated__moe_arch_mod__prompt_kernel < 34816
.fill (34816 - (L_end - sequential_preLN__sliding_local_dilated__moe_arch_mod__prompt_kernel)) / 4, 4, 0xbf810000
.endif
.if L_end - sequential_preLN__sliding_local_dilated__moe_arch_mod__prompt_kernel > 34688
.error "program prefetch does not cover the code"
.endif
.section .rodata,"a"
.p2align 6
.amdhsa_kernel sequential_preLN__sliding_local_dilated__moe_arch_mod__prompt_kernel
  .amdhsa_next_free_vgpr 256
  .amdhsa_next_free_sgpr 102
  .amdhsa_accum_offset 256
  .amdhsa_group_segment_fixed_size 0
  .amdhsa_kernarg_size 88
  .amdhsa_user_sgpr_count 2
  .amdhsa_user_sgpr_kernarg_segment_ptr 1
  .amdhsa_system_sgpr_workgroup_id_x 1
  .amdhsa_float_denorm_mode_32 3
.end_amdhsa_kernel
```

```asm
; @launch grid=(256,1,1) block=(512,1,1) lds=163840
.amdgcn_target "amdgcn-amd-amdhsa--gfx950"
.text
.p2align 12
.globl sequential_preLN__sliding_local_dilated__moe_arch_mod__prompt_kernel
.p2align 8
.type sequential_preLN__sliding_local_dilated__moe_arch_mod__prompt_kernel,@function
sequential_preLN__sliding_local_dilated__moe_arch_mod__prompt_kernel:
s_load_dwordx16 s[44:59], s[0:1], 0
s_load_dwordx8 s[60:67], s[0:1], 56
s_lshr_b32 s34, s2, 3
s_and_b32 s33, s2, 7
v_readfirstlane_b32 s32, v0
s_getpc_b64 s[100:101]
L_pc:
s_mul_i32 s3, s34, 8
v_min_u32 v2, 7, v0
v_add_lshl_u32 v2, v2, s3, 7
v_min_u32 v2, L_end-L_pc, v2
s_cmp_ge_u32 s34, 30
s_cbranch_scc1 L_moe
global_load_dword v255, v2, s[100:101]
s_mul_i32 s35, s34, 26
s_lshr_b32 s35, s35, 8
s_mul_i32 s3, s35, 10
s_sub_u32 s36, s34, s3
s_lshr_b32 s32, s32, 6
s_add_u32 s3, s36, s33
s_add_u32 s3, s3, 2
s_sub_u32 s68, s3, 10
s_cselect_b32 s69, s3, s68
s_mul_i32 s3, s69, 245760
s_lshl_b32 s68, s36, 7
s_add_u32 s3, s3, s68
v_lshrrev_b32 v1, 3, v0
v_lshrrev_b32 v3, 4, v0
v_and_b32 v2, 2, v1
v_and_or_b32 v2, v3, 4, v2
v_xor_b32 v2, v2, v0
v_and_b32 v2, 7, v2
v_mul_u32_u24 v4, 3840, v1
v_lshl_add_u32 v4, v2, 4, v4
v_add_u32 v4, s3, v4
s_mul_i32 s3, s32, 3072
s_add_u32 m0, s3, 20480
v_and_b32 v0, 63, v0
s_and_b32 s38, s32, 3
s_lshr_b32 s3, s33, 1
s_lshl_b32 s3, s3, 9
s_mul_i32 s68, s35, 176
s_add_u32 s3, s3, s68
s_and_b32 s68, s33, 1
s_add_u32 s3, s3, s68
s_mul_i32 s39, s3, 1280
s_sub_u32 s42, s32, 5
s_mul_i32 s3, s42, 81920
s_add_u32 s3, s3, s39
s_sub_u32 s3, s3, 20480
v_lshrrev_b32 v1, 3, v0
v_lshrrev_b32 v3, 4, v0
v_xor_b32 v3, v3, v0
v_and_b32 v3, 7, v3
v_mul_u32_u24 v1, 2560, v1
v_lshl_add_u32 v1, v3, 4, v1
v_add_u32 v24, s3, v1
s_add_u32 s3, s42, s35
s_cmp_eq_u32 s3, 4
s_cselect_b32 s3, 0x80000000, 0
v_xor_b32 v25, 64, v24
v_add_u32 v25, 20480, v25
v_add_u32 v26, 40960, v24
v_add_u32 v27, 40960, v25
v_or_b32 v27, s3, v27
s_mov_b32 s6, 0x280000
s_mov_b32 s7, 0x20000
s_mov_b32 s10, 0x258000
s_mov_b32 s11, 0x20000
s_mov_b32 s14, 0xc8000
s_mov_b32 s15, 0x20000
s_mov_b32 s18, 0x10000000
s_mov_b32 s19, 0x20000
s_mov_b32 s22, 0x280000
s_mov_b32 s23, 0x20000
s_mov_b32 s26, 0x100
s_mov_b32 s27, 0x20000
s_mov_b32 s30, 0x500
s_mov_b32 s31, 0x20000
s_waitcnt lgkmcnt(0)
global_load_lds_dwordx4 v4, s[46:47]
s_addk_i32 m0, -256
s_mov_b64 s[4:5], s[44:45]
global_load_lds_dwordx4 v4, s[46:47] offset:1280
s_addk_i32 m0, -256
s_mov_b64 s[20:21], s[62:63]
global_load_lds_dwordx4 v4, s[46:47] offset:2560
s_mov_b64 s[24:25], s[64:65]
s_mov_b64 s[16:17], s[66:67]
s_mov_b64 s[8:9], s[46:47]
s_mov_b64 s[12:13], s[48:49]
s_mov_b64 s[28:29], s[52:53]
s_cmp_eq_u32 s32, 4
s_cselect_b64 s[96:97], s[54:55], s[58:59]
s_cmp_eq_u32 s32, 5
s_cselect_b64 s[96:97], s[56:57], s[96:97]
s_cmp_lt_u32 s32, 5
s_cbranch_scc1 L_nx
s_lshl_b32 s64, s42, 12
s_cselect_b32 s62, -1, 0xffffff00
s_lshl_b32 s63, s69, 7
s_mov_b32 s61, 8192
s_add_u32 m0, s61, s64
s_mov_b32 exec_lo, s62
buffer_load_dwordx4 v24, s[4:7], s63 offen lds
s_addk_i32 m0, 1024
s_mov_b32 exec_lo, -1
buffer_load_dwordx4 v25, s[4:7], s63 offen lds
s_addk_i32 m0, 1024
s_nop 0
buffer_load_dwordx4 v26, s[4:7], s63 offen lds
s_addk_i32 m0, 1024
s_nop 0
buffer_load_dwordx4 v27, s[4:7], s63 offen lds
L_nx:
v_mov_b32 v254, v4
s_mov_b32 s40, 524288
s_mul_i32 s43, s33, 3
s_add_u32 s43, s43, s35
s_sub_u32 s3, s36, 5
s_cselect_b32 s37, s36, s3
s_lshl_b32 s3, s32, 2
s_lshr_b32 s44, 0x32105454, s3
s_and_b32 s44, s44, 7
s_lshr_b32 s45, s38, 1
s_add_u32 s45, s45, 4
s_cmp_eq_u32 s35, 2
s_cselect_b32 s60, 10, 11
s_sub_u32 s57, 8, s33
v_lshlrev_b32 v233, 4, v0
s_mul_i32 s58, s43, 6
s_add_u32 s58, s58, s44
s_mul_i32 s58, s58, 2560
s_add_u32 s58, s58, 2097152
s_lshl_b32 s59, s33, 15
s_add_u32 s59, s59, 3145728
s_sub_u32 s51, 5, s37
s_add_u32 s1, s37, 1
s_sub_u32 s3, 15, s37
s_cmp_le_u32 s37, 2
s_cselect_b32 s46, 0, s3
s_cselect_b32 s47, s51, s1
s_cselect_b32 s48, s3, 0
s_cselect_b32 s49, s1, s51
s_cselect_b32 s50, 1, 0
v_and_b32 v3, 15, v0
v_add_u32 v3, 8, v3
v_lshrrev_b32 v4, 1, v3
v_lshrrev_b32 v5, 5, v0
v_xor_b32 v4, v4, v5
v_and_b32 v4, 7, v4
v_lshlrev_b32 v4, 4, v4
v_lshl_add_u32 v4, v3, 7, v4
v_bfe_u32 v5, v0, 4, 1
v_lshl_add_u32 v4, v5, 3, v4
s_lshl_b32 s3, s44, 11
v_add_u32 v235, s3, v4
s_cmp_lt_u32 s32, 4
s_cbranch_scc1 L_cons
s_add_u32 s69, s69, 1
s_cmp_eq_u32 s69, 10
s_cselect_b32 s69, 0, s69
s_lshl_b32 s63, s69, 7
s_mov_b32 s61, 45056
v_and_b32 v1, 15, v0
v_lshrrev_b32 v2, 4, v0
v_mov_b32 v7, 1792
s_mul_i32 s0, s44, 2304
s_movk_i32 s1, 144
v_bfe_u32 v3, v0, 2, 1
v_and_b32 v4, 3, v0
v_lshlrev_b32 v4, 1, v4
v_lshl_add_u32 v3, v3, 3, v4
v_bfe_u32 v4, v0, 3, 1
v_add_u32 v3, v3, v4
s_add_u32 s3, s0, 17408
v_mov_b32 v4, s3
v_mad_u32_u24 v3, v3, s1, v4
s_add_u32 s3, s0, 4736
v_mov_b32 v4, s3
v_mad_u32_u24 v4, v1, s1, v4
s_mov_b32 s52, 0xff00ff
s_mov_b32 s53, 0xff00ff
v_add_u32 v5, s51, v2
v_lshl_add_u32 v200, v5, 3, v3
v_lshl_add_u32 v5, v5, 3, v4
v_cndmask_b32 v204, v7, v5, s[52:53]
v_cndmask_b32 v205, v5, v7, s[52:53]
v_add_u32 v5, s46, v2
v_lshl_add_u32 v202, v5, 3, v3
v_lshl_add_u32 v5, v5, 3, v4
v_cmp_gt_u32 vcc, s47, v2
s_nop 1
v_cndmask_b32 v5, v7, v5, vcc
v_cndmask_b32 v206, v7, v5, s[52:53]
v_cndmask_b32 v207, v5, v7, s[52:53]
v_add_u32 v5, s48, v2
v_min_u32 v5, 15, v5
v_lshl_add_u32 v203, v5, 3, v3
v_lshl_add_u32 v5, v5, 3, v4
v_cmp_gt_u32 vcc, s49, v2
s_nop 1
v_cndmask_b32 v5, v7, v5, vcc
v_cndmask_b32 v208, v7, v5, s[52:53]
v_cndmask_b32 v209, v5, v7, s[52:53]
s_sub_u32 s3, s51, 1
v_mad_u32_u24 v5, v2, 5, s3
s_add_u32 s3, s46, 4
v_mov_b32 v6, s3
s_mov_b64 vcc, 0xffff
v_cndmask_b32 v5, v5, v6, vcc
v_min_u32 v5, 15, v5
v_lshl_add_u32 v201, v5, 3, v3
v_lshl_add_u32 v5, v5, 3, v4
s_cmp_eq_u32 s47, 5
s_cselect_b64 vcc, 0xff, 0
v_cndmask_b32 v210, v7, v5, vcc
s_lshl_b64 vcc, vcc, 8
v_cndmask_b32 v211, v7, v5, vcc
s_bfm_b64 vcc, 8, 16
v_cndmask_b32 v212, v7, v5, vcc
s_bfm_b64 vcc, 8, 24
v_cndmask_b32 v213, v7, v5, vcc
s_bfm_b64 vcc, 8, 32
v_cndmask_b32 v214, v7, v5, vcc
s_bfm_b64 vcc, 8, 40
v_cndmask_b32 v215, v7, v5, vcc
s_mul_i32 s0, s44, 2304
s_movk_i32 s1, 144
v_bfe_u32 v3, v0, 2, 3
v_lshrrev_b32 v4, 5, v0
v_lshl_add_u32 v3, v3, 1, v4
s_add_u32 s3, s0, 31232
v_mov_b32 v4, s3
v_mad_u32_u24 v3, v3, s1, v4
v_and_b32 v4, 3, v0
s_mov_b32 s54, 0x11111111
s_mov_b32 s55, 0x11111111
v_add_u32 v5, s51, v4
v_lshl_add_u32 v216, v5, 3, v3
v_add_u32 v7, 32, v216
s_cmp_eq_u32 s50, 1
s_cselect_b32 s3, -1, 12
s_cselect_b32 s56, 2, -1
v_add_u32 v5, s3, v4
v_lshl_add_u32 v5, v5, 3, v3
v_cndmask_b32 v217, v5, v7, s[54:55]
v_add_u32 v7, 40, v7
v_add_u32 v5, s56, v4
v_add_u32 v6, 10, v5
v_cmp_gt_i32 vcc, s51, v5
s_nop 1
v_cndmask_b32 v5, v6, v5, vcc
v_lshl_add_u32 v5, v5, 3, v3
v_cndmask_b32 v218, v5, v7, s[54:55]
s_lshl_b32 s0, s44, 8
v_lshrrev_b32 v4, 5, v0
v_and_or_b32 v3, v0, 8, v4
s_add_u32 s3, s0, 8
v_lshl_add_u32 v222, v3, 4, s3
v_and_b32 v1, 15, v0
s_add_u32 s3, s0, 132
v_lshl_add_u32 v223, v1, 4, s3
s_lshr_b32 s3, s39, 8
s_mul_i32 s3, s3, 52429
s_lshr_b32 s3, s3, 18
s_lshl_b32 s0, s44, 5
s_add_u32 s3, s3, s0
s_sub_u32 s3, 2047, s3
v_mad_i32_i24 v234, v1, -2, s3
v_lshrrev_b32 v2, 4, v0
v_and_or_b32 v3, v0, 8, v2
v_and_b32 v4, 0x70, v233
v_bfrev_b32 v6, 1
s_lshl_b32 s3, s45, 4
v_add_u32 v5, s3, v3
s_lshl_b32 s3, s60, 3
v_cmp_gt_u32 vcc, s3, v5
v_mul_u32_u24 v5, 2560, v5
v_add3_u32 v5, v5, v4, s39
v_cndmask_b32 v236, v6, v5, vcc
s_lshl_b32 s3, s44, 4
v_add_u32 v5, s3, v3
s_lshl_b32 s3, s60, 3
v_cmp_gt_u32 vcc, s3, v5
v_mul_u32_u24 v5, 2560, v5
v_add3_u32 v5, v5, v4, s39
v_cndmask_b32 v227, v6, v5, vcc
s_lshl_b32 s3, s36, 7
v_add_u32 v226, s3, v227
v_bfe_u32 v3, v0, 4, 1
v_cmp_eq_u32 s[54:55], s50, v3
s_cmp_lg_u32 s37, 0
s_cselect_b64 s[0:1], -1, s[54:55]
s_and_b64 vcc, vcc, s[0:1]
s_cmp_lg_u32 s37, 4
s_cselect_b64 s[0:1], 0, s[54:55]
s_andn2_b64 vcc, vcc, s[0:1]
v_cndmask_b32 v225, v6, v226, vcc
s_cmp_le_u32 s37, 3
s_cselect_b32 s3, 2560, 0
s_sub_u32 s3, s3, 128
v_mov_b32 v4, s3
s_cmp_ge_u32 s37, 2
s_cselect_b32 s3, 2560, 0
s_add_u32 s3, s3, 128
v_mov_b32 v5, s3
v_cndmask_b32 v4, v4, v5, s[54:55]
v_mul_u32_u24 v3, 2560, v3
v_sub_u32 v4, v4, v3
v_add_u32 v4, v4, v226
v_cndmask_b32 v224, v6, v4, vcc
v_and_b32 v1, 15, v0
v_bfrev_b32 v6, 1
v_bfe_u32 v3, v0, 4, 1
v_lshrrev_b32 v4, 5, v0
v_lshl_add_u32 v3, v3, 1, v4
s_lshl_b32 s3, s36, 7
v_lshl_add_u32 v4, v3, 4, s3
s_lshl_b32 s3, s44, 4
v_add_u32 v5, s3, v1
s_lshl_b32 s3, s60, 3
v_cmp_gt_u32 vcc, s3, v5
v_mul_u32_u24 v5, 2560, v5
v_add3_u32 v5, v5, v4, s39
v_cndmask_b32 v232, v6, v5, vcc
v_bfe_u32 v3, v0, 3, 2
v_lshlrev_b32 v3, 2, v3
v_and_or_b32 v3, v0, 3, v3
v_lshlrev_b32 v3, 3, v3
v_bfe_u32 v4, v0, 2, 2
v_lshl_add_u32 v3, v4, 7, v3
v_lshrrev_b32 v2, 4, v0
s_and_b32 s3, s32, 1
s_lshl_b32 s3, s3, 12
s_add_u32 s3, s3, 81920
v_lshl_add_u32 v4, v2, 10, v3
v_add_u32 v228, s3, v4
v_xor_b32 v229, 32, v228
v_xor_b32 v230, 64, v228
v_xor_b32 v231, 96, v228
s_mov_b32 s44, 0x0
s_mov_b32 s45, 0x1010101
s_mov_b32 s46, 0x3030303
s_mov_b32 s47, 0x7070707
s_mov_b32 s48, 0xf0f0f0f
s_mov_b32 s49, 0x1f1f1f1f
s_mov_b32 s50, 0x3f3f3f3f
s_mov_b32 s51, 0x7f7f7f7f
s_movk_i32 s54, 10240
s_mov_b32 s55, 0x07060501
s_mov_b32 s56, 0x0706000c
v_mov_b32 v5, 0xffff
v_mov_b32 v6, 0xffff0000
v_cndmask_b32 v1, 0, v5, s[44:45]
v_cndmask_b32 v4, 0, v6, s[46:47]
v_or_b32 v220, v1, v4
v_cndmask_b32 v1, 0, v5, s[48:49]
v_cndmask_b32 v4, 0, v6, s[50:51]
v_or_b32 v221, v1, v4
v_lshrrev_b32 v1, 3, v0
v_and_b32 v2, 2, v1
v_xor_b32 v2, v2, v0
s_lshl_b32 s3, s32, 2
v_xor_b32 v2, s3, v2
v_and_b32 v2, 7, v2
s_lshl_b32 s3, s36, 7
v_lshl_add_u32 v2, v2, 4, s3
v_and_b32 v3, 3, v1
v_mul_u32_u24 v3, 1280, v3
v_add_u32 v2, v3, v2
v_lshrrev_b32 v3, 5, v0
v_mul_u32_u24 v3, 5120, v3
v_sub_u32 v4, 5120, v3
v_mad_u32_u24 v56, v3, 5, v2
v_mad_u32_u24 v57, v3, 3, v2
v_mad_u32_u24 v58, v3, 13, v2
v_mad_u32_u24 v59, v4, 3, v2
v_mad_u32_u24 v60, v4, 13, v2
s_mul_i32 s3, s38, 24
v_add_u32 v1, s3, v0
s_add_u32 s3, s3, 24
s_lshl_b32 s0, s60, 3
s_min_u32 s3, s3, s0
v_cmp_gt_u32 vcc, s3, v1
v_mul_u32_u24 v1, 2560, v1
s_lshl_b32 s0, s36, 7
s_add_u32 s3, s0, s39
v_add_u32 v1, s3, v1
v_bfrev_b32 v2, 1
v_cndmask_b32 v61, v2, v1, vcc
s_lshl_b32 s3, s35, 2
s_add_u32 s3, s3, s38
s_mul_i32 s3, s3, 1280
s_add_u32 s3, s3, s0
v_mul_u32_u24 v1, 15360, v0
v_add_u32 v62, s3, v1
s_mul_i32 s3, s38, 3
v_min_u32 v1, 2, v0
v_add_u32 v1, s3, v1
v_lshrrev_b32 v2, 1, v1
v_mul_u32_u24 v2, 2304, v2
v_lshl_add_u32 v1, v1, 7, v2
s_mul_i32 s3, s43, 15360
s_lshl_b32 s0, s36, 8
s_add_u32 s3, s3, s0
s_add_u32 s3, s3, 2097152
v_add_u32 v63, s3, v1
s_mul_i32 s3, s34, 18
v_min_u32 v1, 17, v0
v_add_u32 v1, s3, v1
v_min_u32 v1, 511, v1
v_cmp_le_u32 vcc, 256, v1
v_mul_u32_u24 v1, 3072, v1
s_mul_i32 s3, s33, 384
s_add_u32 s3, s3, 1179648
v_add_u32 v1, s3, v1
v_subrev_u32 v2, 1769216, v1
v_cndmask_b32 v1, v1, v2, vcc
s_mul_i32 s3, s33, 60
s_lshl_b32 s0, s34, 1
s_add_u32 s3, s3, s0
s_and_b32 s0, s32, 1
s_add_u32 s3, s3, s0
s_lshl_b32 s3, s3, 12
v_min_u32 v2, 31, v0
v_lshl_add_u32 v2, v2, 7, s3
s_cmp_ge_u32 s32, 6
s_cselect_b64 vcc, -1, 0
v_cndmask_b32 v84, v1, v2, vcc
v_mov_b32 v176, 0
v_mov_b32 v177, 0
v_mov_b32 v178, 0
v_mov_b32 v179, 0
v_mov_b32 v180, 0
v_mov_b32 v181, 0
v_mov_b32 v182, 0
v_mov_b32 v183, 0
v_mov_b32 v184, 0
v_mov_b32 v185, 0
v_mov_b32 v186, 0
v_mov_b32 v187, 0
v_mov_b32 v188, 0
v_mov_b32 v189, 0
v_mov_b32 v190, 0
v_mov_b32 v191, 0
s_cmp_eq_u32 s32, 4
s_cbranch_scc1 L_h0
v_mov_b32 v4, 0x3f803f80
v_mov_b32 v5, v4
v_lshrrev_b32 v1, 4, v0
v_mul_u32_u24 v1, 36736, v1
v_lshl_add_u32 v1, v0, 3, v1
ds_write_b64 v1, v[4:5] offset:8192
s_sub_u32 s0, s32, 5
s_mul_i32 s3, s43, 3
s_add_u32 s3, s3, s0
s_mul_i32 s3, s3, 2560
s_add_u32 s67, s3, 2621440
s_mul_i32 s3, s35, 1280
s_add_u32 s3, s3, s59
s_add_u32 s66, s3, 12288
v_min_u32 v1, 9, v0
v_lshl_add_u32 v55, v1, 7, s66
s_lshl_b32 s68, s36, 7
s_add_u32 s68, s68, s66
v_and_b32 v1, 15, v0
v_lshrrev_b32 v2, 5, v0
v_lshl_add_u32 v2, v2, 4, v1
s_lshl_b32 s0, s0, 5
v_add_lshl_u32 v52, v2, s0, 4
v_lshrrev_b32 v2, 4, v0
v_lshrrev_b32 v3, 1, v1
v_xor_b32 v3, v3, v2
v_lshlrev_b32 v3, 4, v3
v_lshl_add_u32 v3, v1, 7, v3
v_add_u32 v54, s64, v3
s_cmp_lt_u32 s39, 2560
s_cselect_b32 s3, 128, 0
v_mov_b32 v1, 0xf149f2ca
v_cmp_gt_u32 vcc, s3, v52
s_nop 1
v_cndmask_b32 v53, 0, v1, vcc
s_setprio 1
s_add_u32 m0, s61, s64
s_mov_b32 exec_lo, s62
buffer_load_dwordx4 v24, s[4:7], s63 offen lds
s_addk_i32 m0, 1024
s_mov_b32 exec_lo, -1
buffer_load_dwordx4 v25, s[4:7], s63 offen lds
s_addk_i32 m0, 1024
s_nop 0
buffer_load_dwordx4 v26, s[4:7], s63 offen lds
s_addk_i32 m0, 1024
s_nop 0
buffer_load_dwordx4 v27, s[4:7], s63 offen lds
v_lshrrev_b32 v1, 4, v0
v_lshlrev_b32 v1, 3, v1
s_lshl_b32 s3, s36, 7
buffer_load_dwordx2 v[244:245], v1, s[28:31], s3 offen offset:0
buffer_load_dwordx2 v[246:247], v1, s[28:31], s3 offen offset:32
buffer_load_dwordx2 v[248:249], v1, s[28:31], s3 offen offset:64
buffer_load_dwordx2 v[250:251], v1, s[28:31], s3 offen offset:96
v_mov_b32 v64, 0x3f803f80
v_mov_b32 v65, 0x3f803f80
v_mov_b32 v66, 0x3f803f80
v_mov_b32 v67, 0x3f803f80
s_waitcnt vmcnt(8) lgkmcnt(0)
s_barrier
v_xor_b32 v1, 64, v54
ds_read_b128 v[36:39], v54 offset:8192
ds_read_b128 v[40:43], v1 offset:8192
ds_read_b128 v[44:47], v54 offset:10240
ds_read_b128 v[48:51], v1 offset:10240
s_lshl_b32 s3, s36, 8
s_add_u32 s3, s3, s67
v_and_b32 v2, 0xf0, v233
s_mov_b32 s0, 0xaaaaaaaa
s_mov_b32 s1, s0
s_mov_b32 vcc_lo, 0xcccccccc
s_mov_b32 vcc_hi, 0xcccccccc
s_waitcnt lgkmcnt(3)
v_mfma_f32_16x16x32_bf16 v[96:99], v[36:39], v[36:39], 0
v_mfma_f32_16x16x32_bf16 v[100:103], v[64:67], v[36:39], 0
s_waitcnt lgkmcnt(2)
v_mfma_f32_16x16x32_bf16 v[96:99], v[40:43], v[40:43], v[96:99]
v_mfma_f32_16x16x32_bf16 v[100:103], v[64:67], v[40:43], v[100:103]
s_waitcnt lgkmcnt(1)
v_mfma_f32_16x16x32_bf16 v[104:107], v[44:47], v[44:47], 0
v_mfma_f32_16x16x32_bf16 v[108:111], v[64:67], v[44:47], 0
s_waitcnt lgkmcnt(0)
v_mfma_f32_16x16x32_bf16 v[104:107], v[48:51], v[48:51], v[104:107]
v_mfma_f32_16x16x32_bf16 v[108:111], v[64:67], v[48:51], v[108:111]
s_nop 0
v_cndmask_b32 v96, v96, v97, s[0:1]
v_cndmask_b32 v98, v98, v99, s[0:1]
v_cndmask_b32 v29, v96, v98, vcc
v_mov_b32 v28, v100
s_nop 1
v_cndmask_b32 v104, v104, v105, s[0:1]
v_cndmask_b32 v106, v106, v107, s[0:1]
v_cndmask_b32 v31, v104, v106, vcc
v_mov_b32 v30, v108
s_mov_b32 exec_lo, 0xf0000f
s_mov_b32 exec_hi, 0xf0000f00
buffer_store_dwordx4 v[28:31], v2, s[16:19], s3 offen sc1
s_mov_b64 exec, -1
v_mov_b32 v44, 0
v_mov_b32 v45, 0
v_mov_b32 v46, 0
v_mov_b32 v47, 0
s_add_u32 s69, s69, 1
s_cmp_eq_u32 s69, 10
s_cselect_b32 s69, 0, s69
s_lshl_b32 s63, s69, 7
s_mov_b32 s61, 81920
s_add_u32 m0, s61, s64
s_mov_b32 exec_lo, s62
buffer_load_dwordx4 v24, s[4:7], s63 offen lds
s_addk_i32 m0, 1024
s_mov_b32 exec_lo, -1
buffer_load_dwordx4 v25, s[4:7], s63 offen lds
s_addk_i32 m0, 1024
s_nop 0
buffer_load_dwordx4 v26, s[4:7], s63 offen lds
s_addk_i32 m0, 1024
s_nop 0
buffer_load_dwordx4 v27, s[4:7], s63 offen lds
s_branch L_pb_1
.p2align 12
L_pad_2:
s_setpc_b64 s[100:101]
L_pb_1:
s_waitcnt vmcnt(5) lgkmcnt(0)
s_cmp_eq_u32 s32, 5
s_cbranch_scc0 L_o5a
s_lshl_b32 s0, s33, 5
v_and_b32 v1, 16, v0
buffer_load_dword v32, v1, s[24:27], s0 offen sc1
L_o5a:
s_barrier
s_add_u32 s69, s69, 1
s_cmp_eq_u32 s69, 10
s_cselect_b32 s69, 0, s69
s_lshl_b32 s63, s69, 7
s_mov_b32 s61, 118784
s_add_u32 m0, s61, s64
s_mov_b32 exec_lo, s62
buffer_load_dwordx4 v24, s[4:7], s63 offen lds
s_addk_i32 m0, 1024
s_mov_b32 exec_lo, -1
buffer_load_dwordx4 v25, s[4:7], s63 offen lds
s_addk_i32 m0, 1024
s_nop 0
buffer_load_dwordx4 v26, s[4:7], s63 offen lds
s_addk_i32 m0, 1024
s_nop 0
buffer_load_dwordx4 v27, s[4:7], s63 offen lds
s_cmp_eq_u32 s57, 1
s_cbranch_scc0 L_xc1
s_mov_b32 s0, 45056
s_call_b64 s[100:101], L_xcap
L_xc1:
s_cmp_eq_u32 s32, 7
s_cbranch_scc0 L_wm1
s_call_b64 s[100:101], L_pad_8
L_wm1:
s_waitcnt vmcnt(4) lgkmcnt(0)
s_barrier
s_cmp_eq_u32 s32, 5
s_cbranch_scc0 L_o5c
s_waitcnt lgkmcnt(0)
v_cmp_ne_u32 vcc, 1, v32
s_cmp_eq_u64 vcc, 0
s_cbranch_scc0 L_era
L_ega:
s_getreg_b32 s0, hwreg(HW_REG_XCC_ID, 0, 4)
v_mov_b32 v1, s0
s_mov_b64 exec, 1
buffer_store_dword v1, off, s[16:19], s68 sc1
s_mov_b64 exec, -1
L_o5c:
s_add_u32 s69, s69, 1
s_cmp_eq_u32 s69, 10
s_cselect_b32 s69, 0, s69
s_lshl_b32 s63, s69, 7
s_mov_b32 s61, 8192
s_add_u32 m0, s61, s64
s_mov_b32 exec_lo, s62
buffer_load_dwordx4 v24, s[4:7], s63 offen lds
s_addk_i32 m0, 1024
s_mov_b32 exec_lo, -1
buffer_load_dwordx4 v25, s[4:7], s63 offen lds
s_addk_i32 m0, 1024
s_nop 0
buffer_load_dwordx4 v26, s[4:7], s63 offen lds
s_addk_i32 m0, 1024
s_nop 0
buffer_load_dwordx4 v27, s[4:7], s63 offen lds
s_cmp_eq_u32 s57, 2
s_cbranch_scc0 L_xc2
s_mov_b32 s0, 81920
s_call_b64 s[100:101], L_xcap
L_xc2:
s_cmp_eq_u32 s32, 7
s_cbranch_scc0 L_wm2
s_call_b64 s[100:101], L_pad_11
L_wm2:
s_cmp_eq_u32 s32, 5
s_cbranch_scc1 L_w52
s_waitcnt vmcnt(4)
L_w52:
s_waitcnt vmcnt(5) lgkmcnt(0)
s_barrier
s_add_u32 s69, s69, 1
s_cmp_eq_u32 s69, 10
s_cselect_b32 s69, 0, s69
s_lshl_b32 s63, s69, 7
s_mov_b32 s61, 45056
s_add_u32 m0, s61, s64
s_mov_b32 exec_lo, s62
buffer_load_dwordx4 v24, s[4:7], s63 offen lds
s_addk_i32 m0, 1024
s_mov_b32 exec_lo, -1
buffer_load_dwordx4 v25, s[4:7], s63 offen lds
s_addk_i32 m0, 1024
s_nop 0
buffer_load_dwordx4 v26, s[4:7], s63 offen lds
s_addk_i32 m0, 1024
s_nop 0
buffer_load_dwordx4 v27, s[4:7], s63 offen lds
s_cmp_eq_u32 s57, 3
s_cbranch_scc0 L_xc3
s_mov_b32 s0, 118784
s_call_b64 s[100:101], L_xcap
L_xc3:
s_cmp_eq_u32 s32, 7
s_cbranch_scc0 L_wm3
s_call_b64 s[100:101], L_pad_12
L_wm3:
s_waitcnt vmcnt(4) lgkmcnt(0)
s_mov_b32 s3, 0x3f803f80
v_mov_b32 v64, s3
v_mov_b32 v65, s3
v_mov_b32 v66, s3
v_mov_b32 v67, s3
s_mov_b32 exec_lo, 0x11111111
s_mov_b32 exec_hi, 0x11111111
v_mov_b32 v244, s3
v_mov_b32 v245, s3
v_mov_b32 v246, s3
v_mov_b32 v247, s3
v_mov_b32 v248, s3
v_mov_b32 v249, s3
v_mov_b32 v250, s3
v_mov_b32 v251, s3
s_mov_b64 exec, -1
v_mfma_f32_16x16x32_bf16 v[252:255], v[244:247], v[64:67], 0
v_mfma_f32_16x16x32_bf16 v[252:255], v[248:251], v[64:67], v[252:255]
s_barrier
s_add_u32 s69, s69, 1
s_cmp_eq_u32 s69, 10
s_cselect_b32 s69, 0, s69
s_lshl_b32 s63, s69, 7
s_mov_b32 s61, 81920
s_add_u32 m0, s61, s64
s_mov_b32 exec_lo, s62
buffer_load_dwordx4 v24, s[4:7], s63 offen lds
s_addk_i32 m0, 1024
s_mov_b32 exec_lo, -1
buffer_load_dwordx4 v25, s[4:7], s63 offen lds
s_addk_i32 m0, 1024
s_nop 0
buffer_load_dwordx4 v26, s[4:7], s63 offen lds
s_addk_i32 m0, 1024
s_nop 0
buffer_load_dwordx4 v27, s[4:7], s63 offen lds
s_cmp_eq_u32 s57, 4
s_cbranch_scc0 L_xc4
s_mov_b32 s0, 8192
s_call_b64 s[100:101], L_xcap
L_xc4:
s_cmp_eq_u32 s32, 7
s_cbranch_scc0 L_wm4
s_call_b64 s[100:101], L_pad_13
L_wm4:
s_waitcnt vmcnt(4) lgkmcnt(0)
s_cmp_eq_u32 s32, 5
s_cbranch_scc0 L_o5b
s_buffer_load_dword s71, s[16:19], s66 offset:0 glc
s_buffer_load_dword s73, s[16:19], s66 offset:128 glc
s_buffer_load_dword s75, s[16:19], s66 offset:256 glc
s_buffer_load_dword s77, s[16:19], s66 offset:384 glc
s_buffer_load_dword s83, s[16:19], s66 offset:512 glc
s_buffer_load_dword s85, s[16:19], s66 offset:640 glc
s_buffer_load_dword s89, s[16:19], s66 offset:768 glc
s_buffer_load_dword s91, s[16:19], s66 offset:896 glc
s_buffer_load_dword s93, s[16:19], s66 offset:1024 glc
s_buffer_load_dword s95, s[16:19], s66 offset:1152 glc
L_o5b:
s_barrier
s_add_u32 s69, s69, 1
s_cmp_eq_u32 s69, 10
s_cselect_b32 s69, 0, s69
s_lshl_b32 s63, s69, 7
s_mov_b32 s61, 118784
s_add_u32 m0, s61, s64
s_mov_b32 exec_lo, s62
buffer_load_dwordx4 v24, s[4:7], s63 offen lds
s_addk_i32 m0, 1024
s_mov_b32 exec_lo, -1
buffer_load_dwordx4 v25, s[4:7], s63 offen lds
s_addk_i32 m0, 1024
s_nop 0
buffer_load_dwordx4 v26, s[4:7], s63 offen lds
s_addk_i32 m0, 1024
s_nop 0
buffer_load_dwordx4 v27, s[4:7], s63 offen lds
s_cmp_eq_u32 s57, 5
s_cbranch_scc0 L_xc5
s_mov_b32 s0, 45056
s_call_b64 s[100:101], L_xcap
L_xc5:
s_cmp_eq_u32 s32, 5
s_cbranch_scc0 L_o5d
s_waitcnt lgkmcnt(0)
s_max_u32 s0, s71, s73
s_max_u32 s0, s0, s75
s_max_u32 s0, s0, s77
s_max_u32 s0, s0, s83
s_max_u32 s0, s0, s85
s_max_u32 s0, s0, s89
s_max_u32 s0, s0, s91
s_max_u32 s0, s0, s93
s_max_u32 s0, s0, s95
s_cmp_lg_u32 s0, -1
s_cbranch_scc0 L_erb
L_egb:
s_min_u32 s1, s71, s73
s_min_u32 s1, s1, s75
s_min_u32 s1, s1, s77
s_min_u32 s1, s1, s83
s_min_u32 s1, s1, s85
s_min_u32 s1, s1, s89
s_min_u32 s1, s1, s91
s_min_u32 s1, s1, s93
s_min_u32 s1, s1, s95
s_cmp_eq_u32 s0, s1
s_cselect_b32 s0, 1, 0
v_mov_b32 v1, 1728
v_mov_b32 v2, s0
ds_write_b32 v1, v2
L_o5d:
s_cmp_eq_u32 s32, 7
s_cbranch_scc0 L_wm5
s_call_b64 s[100:101], L_pad_14
L_wm5:
s_waitcnt vmcnt(4) lgkmcnt(0)
s_barrier
buffer_load_dwordx4 v[36:39], v233, s[16:19], s67 offen offset:0 sc1
buffer_load_dwordx4 v[40:43], v233, s[16:19], s67 offen offset:1024 sc1
s_mov_b32 exec_hi, 0
buffer_load_dwordx4 v[44:47], v233, s[16:19], s67 offen offset:2048 sc1
s_mov_b32 exec_hi, -1
s_add_u32 s69, s69, 1
s_cmp_eq_u32 s69, 10
s_cselect_b32 s69, 0, s69
s_lshl_b32 s63, s69, 7
s_mov_b32 s61, 8192
s_add_u32 m0, s61, s64
s_mov_b32 exec_lo, s62
buffer_load_dwordx4 v24, s[4:7], s63 offen lds
s_addk_i32 m0, 1024
s_mov_b32 exec_lo, -1
buffer_load_dwordx4 v25, s[4:7], s63 offen lds
s_addk_i32 m0, 1024
s_nop 0
buffer_load_dwordx4 v26, s[4:7], s63 offen lds
s_addk_i32 m0, 1024
s_nop 0
buffer_load_dwordx4 v27, s[4:7], s63 offen lds
s_cmp_eq_u32 s57, 6
s_cbranch_scc0 L_xc6
s_mov_b32 s0, 81920
s_call_b64 s[100:101], L_xcap
L_xc6:
s_cmp_eq_u32 s32, 7
s_cbranch_scc0 L_wm6
s_call_b64 s[100:101], L_pad_21
L_wm6:
s_waitcnt vmcnt(7) lgkmcnt(0)
s_barrier
s_add_u32 s69, s69, 1
s_cmp_eq_u32 s69, 10
s_cselect_b32 s69, 0, s69
s_lshl_b32 s63, s69, 7
s_mov_b32 s61, 45056
s_add_u32 m0, s61, s64
s_mov_b32 exec_lo, s62
buffer_load_dwordx4 v24, s[4:7], s63 offen lds
s_addk_i32 m0, 1024
s_mov_b32 exec_lo, -1
buffer_load_dwordx4 v25, s[4:7], s63 offen lds
s_addk_i32 m0, 1024
s_nop 0
buffer_load_dwordx4 v26, s[4:7], s63 offen lds
s_addk_i32 m0, 1024
s_nop 0
buffer_load_dwordx4 v27, s[4:7], s63 offen lds
s_cmp_eq_u32 s57, 7
s_cbranch_scc0 L_xc7
s_mov_b32 s0, 118784
s_call_b64 s[100:101], L_xcap
L_xc7:
s_waitcnt vmcnt(8)
v_add_f32 v36, v36, v40
v_add_f32 v37, v37, v41
v_add_f32 v38, v38, v42
v_add_f32 v39, v39, v43
v_add_f32 v36, v36, v44
v_add_f32 v37, v37, v45
v_add_f32 v38, v38, v46
v_add_f32 v39, v39, v47
s_nop 0
v_permlane32_swap_b32 v36, v38
v_permlane32_swap_b32 v37, v39
v_add_f32 v36, v36, v38
v_add_f32 v37, v37, v39
v_mov_b32 v38, v36
v_mov_b32 v39, v37
s_mov_b32 s1, 0x3acccccd
v_mov_b32 v1, 0x3727c5ac
v_permlane16_swap_b32 v36, v38
v_permlane16_swap_b32 v37, v39
v_add_f32 v36, v36, v38
v_add_f32 v37, v37, v39
v_mul_f32 v36, 0xbacccccd, v36
v_fma_f32 v2, v37, s1, v1
v_fma_f32 v2, -v36, v36, v2
v_max_f32 v2, v2, v1
v_rsq_f32 v37, v2
v_mov_b32 v39, v53
v_mov_b32 v38, v37
ds_write_b128 v52, v[36:39] offset:0
s_waitcnt vmcnt(4) lgkmcnt(0)
s_barrier
s_cmp_eq_u32 s57, 8
s_cbranch_scc0 L_xc8
s_mov_b32 s0, 8192
s_call_b64 s[100:101], L_xcap
L_xc8:
L_h8:
s_mul_i32 s66, s38, 5120
s_lshl_b32 s3, s38, 10
s_add_u32 m0, s3, 81920
s_add_u32 s3, s66, 25600
buffer_load_dwordx4 v56, s[12:15], s3 offen lds
s_addk_i32 m0, 4096
s_add_u32 s3, s66, 102400
buffer_load_dwordx4 v56, s[12:15], s3 offen lds
s_addk_i32 m0, 4096
s_add_u32 s3, s66, 179200
buffer_load_dwordx4 v56, s[12:15], s3 offen lds
s_addk_i32 m0, 4096
s_add_u32 s3, s66, 256000
buffer_load_dwordx4 v56, s[12:15], s3 offen lds
s_addk_i32 m0, 4096
s_add_u32 s3, s66, 332800
buffer_load_dwordx4 v56, s[12:15], s3 offen lds
s_addk_i32 m0, 4096
s_add_u32 s3, s66, 435200
buffer_load_dwordx4 v56, s[12:15], s3 offen lds
s_addk_i32 m0, 4096
s_add_u32 s3, s66, 512000
buffer_load_dwordx4 v56, s[12:15], s3 offen lds
s_addk_i32 m0, 4096
s_add_u32 s3, s66, 588800
buffer_load_dwordx4 v56, s[12:15], s3 offen lds
v_add_u32 v1, 128, v222
v_cndmask_b32 v2, v1, v222, s[44:45]
ds_read_b64 v[168:169], v2 offset:0
v_cndmask_b32 v2, v1, v222, s[46:47]
ds_read_b64 v[170:171], v2 offset:32
v_cndmask_b32 v2, v1, v222, s[48:49]
ds_read_b64 v[172:173], v2 offset:64
v_cndmask_b32 v2, v1, v222, s[50:51]
ds_read_b64 v[174:175], v2 offset:96
ds_read_b32 v5, v223
v_mov_b32 v1, 1728
ds_read_b32 v1, v1
s_waitcnt lgkmcnt(0)
v_readfirstlane_b32 s41, v1
v_lshlrev_b32 v8, 16, v72
v_and_b32 v9, 0xffff0000, v72
v_lshlrev_b32 v10, 16, v73
v_and_b32 v11, 0xffff0000, v73
v_lshlrev_b32 v12, 16, v74
v_and_b32 v13, 0xffff0000, v74
v_lshlrev_b32 v14, 16, v75
v_and_b32 v15, 0xffff0000, v75
v_lshlrev_b32 v16, 16, v76
v_and_b32 v17, 0xffff0000, v76
v_lshlrev_b32 v18, 16, v77
v_and_b32 v19, 0xffff0000, v77
v_lshlrev_b32 v20, 16, v78
v_and_b32 v21, 0xffff0000, v78
v_lshlrev_b32 v22, 16, v79
v_and_b32 v23, 0xffff0000, v79
s_waitcnt vmcnt(8)
s_barrier
s_cmp_eq_u32 s41, 1
s_cbranch_scc0 L_gh_3g
L_gh_3b:
buffer_load_dword v61, v61, s[20:23], 0 offen
buffer_load_dword v63, v63, s[16:19], 0 offen
s_addk_i32 m0, 4096
s_add_u32 s3, s66, 665600
buffer_load_dwordx4 v56, s[12:15], s3 offen lds
s_addk_i32 m0, 4096
s_add_u32 s3, s66, 742400
buffer_load_dwordx4 v56, s[12:15], s3 offen lds
s_and_b32 s3, s32, 1
s_lshl_b32 s61, s3, 7
s_xor_b32 s62, s61, 128
s_add_u32 s63, s62, s54
s_add_u32 s64, s61, s54
s_lshl_b32 s3, s3, 13
s_sub_u32 s65, 4096, s3
s_add_u32 s0, s37, 1
s_sub_u32 s1, 5, s37
s_min_u32 s0, s0, s1
s_lshl_b32 s0, s0, 4
s_sub_u32 s1, 64, s0
s_cmp_le_u32 s37, 2
s_cselect_b32 s1, s1, 16
s_bfm_b64 s[100:101], s0, s1
v_mul_f32 v5, 0x3ea52b5c, v5
s_barrier
ds_read_b64 v[96:97], v202 offset:0
ds_read_b64 v[98:99], v202 offset:1152
ds_read_b64 v[100:101], v203 offset:0
ds_read_b64 v[102:103], v203 offset:1152
ds_read_b64 v[104:105], v201 offset:0
ds_read_b64 v[106:107], v201 offset:1152
ds_read_b64 v[108:109], v200 offset:0
ds_read_b64 v[110:111], v200 offset:1152
ds_read_b64 v[112:113], v200 offset:40
ds_read_b64 v[114:115], v200 offset:1192
s_cmp_eq_u32 s38, 1
s_cbranch_scc1 L_woe1
s_cmp_eq_u32 s38, 2
s_cbranch_scc1 L_woe2
s_cmp_eq_u32 s38, 3
s_cbranch_scc1 L_woe3
s_addk_i32 m0, 4096
s_mov_b32 s3, 46080
buffer_load_dwordx4 v56, s[12:15], s3 offen lds
s_addk_i32 m0, 4096
s_mov_b32 s3, 122880
buffer_load_dwordx4 v56, s[12:15], s3 offen lds
s_addk_i32 m0, 4096
s_mov_b32 s3, 199680
buffer_load_dwordx4 v56, s[12:15], s3 offen lds
s_addk_i32 m0, 4096
s_mov_b32 s3, 276480
buffer_load_dwordx4 v56, s[12:15], s3 offen lds
s_addk_i32 m0, 4096
s_mov_b32 s3, 353280
buffer_load_dwordx4 v56, s[12:15], s3 offen lds
s_addk_i32 m0, 4096
s_mov_b32 s3, 455680
buffer_load_dwordx4 v56, s[12:15], s3 offen lds
s_addk_i32 m0, 4096
s_mov_b32 s3, 532480
buffer_load_dwordx4 v56, s[12:15], s3 offen lds
s_addk_i32 m0, 4096
s_mov_b32 s3, 609280
buffer_load_dwordx4 v56, s[12:15], s3 offen lds
s_addk_i32 m0, 4096
s_mov_b32 s3, 686080
buffer_load_dwordx4 v56, s[12:15], s3 offen lds
s_addk_i32 m0, 4096
s_mov_b32 s3, 762880
buffer_load_dwordx4 v56, s[12:15], s3 offen lds
L_woe:
global_load_dword v84, v84, s[96:97]
s_setprio 1
s_waitcnt vmcnt(15)
s_barrier
ds_read_b64 v[116:117], v206 offset:0
ds_read_b64 v[118:119], v207 offset:0
ds_read_b64 v[120:121], v208 offset:0
ds_read_b64 v[122:123], v209 offset:0
ds_read_b64 v[124:125], v210 offset:0
ds_read_b64 v[126:127], v211 offset:0
ds_read_b64 v[128:129], v204 offset:0
ds_read_b64 v[130:131], v205 offset:0
ds_read_b64 v[132:133], v204 offset:40
ds_read_b64 v[134:135], v205 offset:40
s_waitcnt lgkmcnt(8)
v_mfma_f32_16x16x32_bf16 v[152:155], v[96:99], v[116:119], 0
ds_read_b64 v[136:137], v212 offset:0
ds_read_b64 v[138:139], v213 offset:0
s_waitcnt lgkmcnt(8)
v_mfma_f32_16x16x32_bf16 v[156:159], v[100:103], v[120:123], 0
ds_read_b64 v[140:141], v214 offset:0
ds_read_b64 v[142:143], v215 offset:0
s_waitcnt lgkmcnt(8)
v_mfma_f32_16x16x32_bf16 v[152:155], v[104:107], v[124:127], v[152:155]
s_waitcnt lgkmcnt(6)
v_mfma_f32_16x16x32_bf16 v[160:163], v[108:111], v[128:131], 0
s_waitcnt lgkmcnt(4)
v_mfma_f32_16x16x32_bf16 v[164:167], v[112:115], v[132:135], 0
s_waitcnt lgkmcnt(2)
v_mfma_f32_16x16x32_bf16 v[160:163], v[104:107], v[136:139], v[160:163]
s_waitcnt lgkmcnt(0)
v_mfma_f32_16x16x32_bf16 v[164:167], v[104:107], v[140:143], v[164:167]
v_permlane16_swap_b32 v152, v156
v_permlane16_swap_b32 v153, v157
v_permlane16_swap_b32 v154, v158
v_permlane16_swap_b32 v155, v159
v_cndmask_b32 v2, v156, v152, s[44:45]
v_cndmask_b32 v3, v157, v153, s[46:47]
v_cndmask_b32 v194, v158, v154, s[48:49]
v_cndmask_b32 v195, v159, v155, s[50:51]
v_or_b32 v192, 0xffff, v2
v_perm_b32 v193, v3, v2, s55
s_cmp_eq_u32 s41, 1
s_cbranch_scc0 L_gl_4g
buffer_store_dwordx4 v[192:195], v224, s[20:23], s54 offen
L_gl_4b:
v_permlane16_swap_b32 v160, v164
v_permlane16_swap_b32 v161, v165
v_permlane16_swap_b32 v162, v166
v_permlane16_swap_b32 v163, v167
v_cndmask_b32 v196, v164, v160, s[44:45]
v_cndmask_b32 v197, v165, v161, s[46:47]
v_cndmask_b32 v198, v166, v162, s[48:49]
v_cndmask_b32 v199, v167, v163, s[50:51]
v_fma_f32 v196, v196, v168, v169
v_fma_f32 v197, v197, v170, v171
v_fma_f32 v198, v198, v172, v173
v_fma_f32 v199, v199, v174, v175
v_max3_f32 v6, v196, v197, v198
v_max_f32 v6, v6, v199
v_mov_b32 v7, v6
s_nop 1
v_permlane32_swap_b32 v6, v7
v_max_f32 v6, v6, v7
v_mul_f32 v6, v6, v5
v_fma_f32 v196, v196, v5, -v6
v_fma_f32 v197, v197, v5, -v6
v_fma_f32 v198, v198, v5, -v6
v_fma_f32 v199, v199, v5, -v6
v_exp_f32 v196, v196
v_exp_f32 v197, v197
v_exp_f32 v198, v198
v_exp_f32 v199, v199
ds_read_b64_tr_b16 v[64:65], v216 offset:0
ds_read_b64_tr_b16 v[66:67], v216 offset:1152
ds_read_b64_tr_b16 v[68:69], v216 offset:40
ds_read_b64_tr_b16 v[70:71], v216 offset:1192
ds_read_b64_tr_b16 v[72:73], v217 offset:0
ds_read_b64_tr_b16 v[74:75], v217 offset:1152
ds_read_b64_tr_b16 v[76:77], v218 offset:0
ds_read_b64_tr_b16 v[78:79], v218 offset:1152
v_add_f32 v6, v196, v197
v_add_f32 v7, v198, v199
v_add_f32 v6, v6, v7
v_mov_b32 v7, v6
v_mul_f32 v196, v196, v168
v_mul_f32 v197, v197, v170
v_permlane32_swap_b32 v6, v7
v_mul_f32 v198, v198, v172
v_add_f32 v6, v6, v7
v_rcp_f32 v6, v6
v_mul_f32 v199, v199, v174
v_mul_f32 v196, v196, v6
v_mul_f32 v197, v197, v6
v_mul_f32 v198, v198, v6
v_mul_f32 v199, v199, v6
v_cvt_pk_bf16_f32 v196, v196, v197
v_cvt_pk_bf16_f32 v197, v198, v199
s_mov_b64 exec, s[52:53]
v_and_b32 v176, v220, v196
v_bfi_b32 v180, v220, 0, v196
v_and_b32 v177, v221, v197
v_bfi_b32 v181, v221, 0, v197
s_not_b64 exec, exec
v_and_b32 v178, v220, v196
v_bfi_b32 v182, v220, 0, v196
v_and_b32 v179, v221, v197
v_bfi_b32 v183, v221, 0, v197
s_mov_b64 exec, -1
v_permlane16_swap_b32 v176, v180
v_permlane16_swap_b32 v177, v181
v_permlane16_swap_b32 v178, v182
v_permlane16_swap_b32 v179, v183
buffer_load_dwordx4 v[92:95], v225, s[20:23], s54 offen sc1
s_waitcnt lgkmcnt(0)
v_mfma_f32_16x16x32_bf16 v[152:155], v[64:67], v[176:179], 0
v_mfma_f32_16x16x32_bf16 v[156:159], v[68:71], v[180:183], 0
v_mfma_f32_16x16x32_bf16 v[160:163], v[72:75], v[176:179], 0
v_mfma_f32_16x16x32_bf16 v[164:167], v[76:79], v[180:183], 0
s_nop 4
v_cvt_pk_bf16_f32 v196, v152, v153
v_cvt_pk_bf16_f32 v197, v154, v155
v_cvt_pk_bf16_f32 v198, v156, v157
v_cvt_pk_bf16_f32 v199, v158, v159
s_cmp_eq_u32 s41, 1
s_cbranch_scc0 L_gl_5g
buffer_store_dwordx4 v[196:199], v226, s[20:23], 0 offen
L_gl_5b:
v_cvt_pk_bf16_f32 v80, v160, v161
v_cvt_pk_bf16_f32 v81, v162, v163
v_cvt_pk_bf16_f32 v82, v164, v165
v_cvt_pk_bf16_f32 v83, v166, v167
ds_read_b64_tr_b16 v[104:105], v228 offset:0
ds_read_b64_tr_b16 v[106:107], v228 offset:512
ds_read_b64_tr_b16 v[108:109], v229 offset:0
ds_read_b64_tr_b16 v[110:111], v229 offset:512
ds_read_b64_tr_b16 v[112:113], v230 offset:0
ds_read_b64_tr_b16 v[114:115], v230 offset:512
ds_read_b64_tr_b16 v[116:117], v231 offset:0
ds_read_b64_tr_b16 v[118:119], v231 offset:512
ds_read_b64_tr_b16 v[120:121], v228 offset:8192
ds_read_b64_tr_b16 v[122:123], v228 offset:8704
ds_read_b64_tr_b16 v[124:125], v229 offset:8192
ds_read_b64_tr_b16 v[126:127], v229 offset:8704
ds_read_b64_tr_b16 v[128:129], v230 offset:8192
ds_read_b64_tr_b16 v[130:131], v230 offset:8704
ds_read_b64_tr_b16 v[132:133], v231 offset:8192
ds_read_b64_tr_b16 v[134:135], v231 offset:8704
ds_read_b64_tr_b16 v[136:137], v228 offset:16384
ds_read_b64_tr_b16 v[138:139], v228 offset:16896
ds_read_b64_tr_b16 v[140:141], v229 offset:16384
ds_read_b64_tr_b16 v[142:143], v229 offset:16896
ds_read_b64_tr_b16 v[144:145], v230 offset:16384
ds_read_b64_tr_b16 v[146:147], v230 offset:16896
ds_read_b64_tr_b16 v[148:149], v231 offset:16384
ds_read_b64_tr_b16 v[150:151], v231 offset:16896
s_waitcnt vmcnt(1)
v_cmp_eq_u32 vcc, -1, v94
s_cbranch_vccnz L_h0rh
L_h0gh:
v_mov_b32 v1, 1744
v_mov_b32 v4, 1
s_mov_b64 exec, 1
ds_add_u32 v1, v4
s_mov_b64 exec, -1
v_perm_b32 v92, v92, v93, s56
v_add_f32 v193, v3, v93
v_add_f32 v194, v194, v94
v_add_f32 v195, v195, v95
v_add_f32 v192, v2, v92
v_fma_f32 v192, v192, v168, v169
v_fma_f32 v193, v193, v170, v171
v_fma_f32 v194, v194, v172, v173
v_fma_f32 v195, v195, v174, v175
v_max3_f32 v6, v192, v193, v194
v_max_f32 v6, v6, v195
v_mov_b32 v7, v6
s_nop 1
v_permlane32_swap_b32 v6, v7
v_max_f32 v6, v6, v7
v_mul_f32 v6, v6, v5
v_fma_f32 v192, v192, v5, -v6
v_fma_f32 v193, v193, v5, -v6
v_fma_f32 v194, v194, v5, -v6
v_fma_f32 v195, v195, v5, -v6
v_exp_f32 v192, v192
v_exp_f32 v193, v193
v_exp_f32 v194, v194
v_exp_f32 v195, v195
buffer_load_dwordx4 v[24:27], v227, s[20:23], s61 offen offset:0 sc1
buffer_load_dwordx4 v[28:31], v227, s[20:23], s61 offen offset:256 sc1
buffer_load_dwordx4 v[32:35], v227, s[20:23], s61 offen offset:512 sc1
buffer_load_dwordx4 v[36:39], v227, s[20:23], s61 offen offset:768 sc1
buffer_load_dwordx4 v[40:43], v227, s[20:23], s61 offen offset:1024 sc1
buffer_load_dwordx4 v[44:47], v227, s[20:23], s62 offen offset:0 sc1
v_add_f32 v6, v192, v193
v_add_f32 v7, v194, v195
v_add_f32 v6, v6, v7
v_mov_b32 v7, v6
v_mul_f32 v192, v192, v168
v_mul_f32 v193, v193, v170
v_permlane32_swap_b32 v6, v7
v_mul_f32 v194, v194, v172
v_add_f32 v6, v6, v7
v_rcp_f32 v6, v6
v_mul_f32 v195, v195, v174
v_mul_f32 v192, v192, v6
v_mul_f32 v193, v193, v6
v_mul_f32 v194, v194, v6
v_mul_f32 v195, v195, v6
v_cvt_pk_bf16_f32 v192, v192, v193
v_cvt_pk_bf16_f32 v193, v194, v195
s_mov_b64 exec, s[52:53]
v_and_b32 v184, v220, v192
v_bfi_b32 v188, v220, 0, v192
v_and_b32 v185, v221, v193
v_bfi_b32 v189, v221, 0, v193
s_not_b64 exec, exec
v_and_b32 v186, v220, v192
v_bfi_b32 v190, v220, 0, v192
v_and_b32 v187, v221, v193
v_bfi_b32 v191, v221, 0, v193
s_mov_b64 exec, -1
v_permlane16_swap_b32 v184, v188
v_permlane16_swap_b32 v185, v189
v_permlane16_swap_b32 v186, v190
v_permlane16_swap_b32 v187, v191
s_nop 1
v_mfma_f32_16x16x32_bf16 v[152:155], v[72:75], v[184:187], 0
v_mfma_f32_16x16x32_bf16 v[156:159], v[76:79], v[184:187], 0
v_mfma_f32_16x16x32_bf16 v[160:163], v[76:79], v[188:191], 0
ds_read_b32 v1, v1
s_mov_b32 exec_lo, 0xffff0000
s_nop 3
v_cvt_pk_bf16_f32 v80, v152, v153
v_cvt_pk_bf16_f32 v81, v154, v155
v_cvt_pk_bf16_f32 v82, v156, v157
v_cvt_pk_bf16_f32 v83, v158, v159
s_mov_b64 exec, s[100:101]
v_cvt_pk_bf16_f32 v82, v160, v161
v_cvt_pk_bf16_f32 v83, v162, v163
s_mov_b64 exec, -1
s_cmp_eq_u32 s41, 1
s_cbranch_scc0 L_gl_6g
buffer_store_dwordx4 v[80:83], v226, s[20:23], s54 offen
L_gl_6b:
s_branch L_pb_7
.p2align 12
L_pad_8:
s_setpc_b64 s[100:101]
L_pb_7:
s_lshl_b32 s0, s38, 12
s_add_u32 s0, s0, 57344
v_add_u32 v4, s0, v233
s_and_b32 s0, s38, 2
s_lshl_b32 s0, s0, 1
s_add_u32 s0, s0, 1760
v_mov_b32 v3, s0
v_mov_b32 v5, 1
s_waitcnt lgkmcnt(0)
v_cmp_ne_u32 vcc, 4, v1
s_cbranch_vccnz L_spw
L_sbw:
s_waitcnt vmcnt(5)
v_max_u16 v2, v24, v28
v_cmp_eq_u16 vcc, -1, v2
s_cbranch_vccnz L_st0
L_go0:
v_mfma_f32_16x16x32_bf16 v[8:11], v[104:107], v[24:27], v[8:11]
buffer_load_dwordx4 v[48:51], v236, s[20:23], s62 offen offset:0 sc1
ds_read_b64_tr_b16 v[152:153], v228 offset:24576
v_mfma_f32_16x16x32_bf16 v[12:15], v[108:111], v[24:27], v[12:15]
ds_read_b64_tr_b16 v[154:155], v228 offset:25088
ds_read_b64_tr_b16 v[156:157], v229 offset:24576
v_mfma_f32_16x16x32_bf16 v[16:19], v[112:115], v[24:27], v[16:19]
ds_read_b64_tr_b16 v[158:159], v229 offset:25088
ds_read_b64_tr_b16 v[160:161], v230 offset:24576
v_mfma_f32_16x16x32_bf16 v[20:23], v[116:119], v[24:27], v[20:23]
ds_read_b64_tr_b16 v[162:163], v230 offset:25088
ds_read_b64_tr_b16 v[164:165], v231 offset:24576
v_mfma_f32_16x16x32_bf16 v[8:11], v[120:123], v[28:31], v[8:11]
buffer_load_dwordx4 v[52:55], v227, s[20:23], s62 offen offset:256 sc1
ds_read_b64_tr_b16 v[166:167], v231 offset:25088
v_mfma_f32_16x16x32_bf16 v[12:15], v[124:127], v[28:31], v[12:15]
ds_read_b64_tr_b16 v[168:169], v228 offset:32768
ds_read_b64_tr_b16 v[170:171], v228 offset:33280
s_waitcnt vmcnt(5)
v_max_u16 v2, v32, v36
v_cmp_eq_u16 vcc, -1, v2
v_mfma_f32_16x16x32_bf16 v[16:19], v[128:131], v[28:31], v[16:19]
ds_read_b64_tr_b16 v[172:173], v229 offset:32768
ds_read_b64_tr_b16 v[174:175], v229 offset:33280
s_cbranch_vccnz L_st1
L_go1:
v_mfma_f32_16x16x32_bf16 v[20:23], v[132:135], v[28:31], v[20:23]
ds_read_b64_tr_b16 v[176:177], v230 offset:32768
ds_read_b64_tr_b16 v[178:179], v230 offset:33280
v_mfma_f32_16x16x32_bf16 v[8:11], v[136:139], v[32:35], v[8:11]
buffer_load_dwordx4 v[56:59], v236, s[20:23], s62 offen offset:256 sc1
ds_read_b64_tr_b16 v[180:181], v231 offset:32768
v_mfma_f32_16x16x32_bf16 v[12:15], v[140:143], v[32:35], v[12:15]
ds_read_b64_tr_b16 v[182:183], v231 offset:33280
v_add_u32 v228, s65, v228
ds_read_b64_tr_b16 v[184:185], v228 offset:0
v_mfma_f32_16x16x32_bf16 v[16:19], v[144:147], v[32:35], v[16:19]
ds_read_b64_tr_b16 v[186:187], v228 offset:512
v_add_u32 v229, s65, v229
ds_read_b64_tr_b16 v[188:189], v229 offset:0
v_mfma_f32_16x16x32_bf16 v[20:23], v[148:151], v[32:35], v[20:23]
ds_read_b64_tr_b16 v[190:191], v229 offset:512
v_add_u32 v230, s65, v230
ds_read_b64_tr_b16 v[192:193], v230 offset:0
s_waitcnt lgkmcnt(13)
v_mfma_f32_16x16x32_bf16 v[8:11], v[152:155], v[36:39], v[8:11]
buffer_load_dwordx4 v[60:63], v227, s[20:23], s62 offen offset:512 sc1
ds_read_b64_tr_b16 v[194:195], v230 offset:512
v_mfma_f32_16x16x32_bf16 v[12:15], v[156:159], v[36:39], v[12:15]
buffer_load_dwordx4 v[64:67], v236, s[20:23], s62 offen offset:512 sc1
v_add_u32 v231, s65, v231
ds_read_b64_tr_b16 v[196:197], v231 offset:0
s_waitcnt vmcnt(7)
v_cmp_eq_u16 vcc, -1, v40
v_mfma_f32_16x16x32_bf16 v[16:19], v[160:163], v[36:39], v[16:19]
ds_read_b64_tr_b16 v[198:199], v231 offset:512
ds_read_b64_tr_b16 v[104:105], v228 offset:8192
s_cbranch_vccnz L_st2
L_go2:
v_mfma_f32_16x16x32_bf16 v[20:23], v[164:167], v[36:39], v[20:23]
ds_read_b64_tr_b16 v[106:107], v228 offset:8704
ds_read_b64_tr_b16 v[108:109], v229 offset:8192
s_waitcnt lgkmcnt(11)
v_mfma_f32_16x16x32_bf16 v[8:11], v[168:171], v[40:43], v[8:11]
buffer_load_dwordx4 v[68:71], v227, s[20:23], s62 offen offset:768 sc1
ds_read_b64_tr_b16 v[110:111], v229 offset:8704
v_mfma_f32_16x16x32_bf16 v[12:15], v[172:175], v[40:43], v[12:15]
buffer_load_dwordx4 v[72:75], v236, s[20:23], s62 offen offset:768 sc1
ds_read_b64_tr_b16 v[112:113], v230 offset:8192
s_waitcnt vmcnt(6)
v_max_u16 v2, v44, v48
v_cmp_eq_u16 vcc, -1, v2
v_mfma_f32_16x16x32_bf16 v[16:19], v[176:179], v[40:43], v[16:19]
ds_read_b64_tr_b16 v[114:115], v230 offset:8704
ds_read_b64_tr_b16 v[116:117], v231 offset:8192
s_cbranch_vccnz L_st3
L_go3:
v_mfma_f32_16x16x32_bf16 v[20:23], v[180:183], v[40:43], v[20:23]
ds_read_b64_tr_b16 v[118:119], v231 offset:8704
ds_read_b64_tr_b16 v[120:121], v228 offset:16384
s_waitcnt lgkmcnt(9)
v_mfma_f32_16x16x32_bf16 v[8:11], v[184:187], v[44:47], v[8:11]
buffer_load_dwordx4 v[76:79], v227, s[20:23], s62 offen offset:1024 sc1
ds_read_b64_tr_b16 v[122:123], v228 offset:16896
v_mfma_f32_16x16x32_bf16 v[200:203], v[184:187], v[48:51], 0
ds_read_b64_tr_b16 v[124:125], v229 offset:16384
ds_read_b64_tr_b16 v[126:127], v229 offset:16896
v_mfma_f32_16x16x32_bf16 v[12:15], v[188:191], v[44:47], v[12:15]
ds_read_b64_tr_b16 v[128:129], v230 offset:16384
ds_read_b64_tr_b16 v[130:131], v230 offset:16896
v_mfma_f32_16x16x32_bf16 v[204:207], v[188:191], v[48:51], 0
ds_read_b64_tr_b16 v[132:133], v231 offset:16384
ds_read_b64_tr_b16 v[134:135], v231 offset:16896
v_mfma_f32_16x16x32_bf16 v[16:19], v[192:195], v[44:47], v[16:19]
buffer_load_dwordx4 v[80:83], v236, s[20:23], s62 offen offset:1024 sc1
ds_read_b64_tr_b16 v[136:137], v228 offset:24576
v_mfma_f32_16x16x32_bf16 v[208:211], v[192:195], v[48:51], 0
ds_read_b64_tr_b16 v[138:139], v228 offset:25088
s_waitcnt vmcnt(6)
v_max_u16 v2, v52, v56
v_cmp_eq_u16 vcc, -1, v2
v_mfma_f32_16x16x32_bf16 v[20:23], v[196:199], v[44:47], v[20:23]
ds_read_b64_tr_b16 v[140:141], v229 offset:24576
s_cbranch_vccnz L_st4
L_go4:
v_mfma_f32_16x16x32_bf16 v[212:215], v[196:199], v[48:51], 0
ds_read_b64_tr_b16 v[142:143], v229 offset:25088
s_waitcnt lgkmcnt(12)
v_mfma_f32_16x16x32_bf16 v[8:11], v[104:107], v[52:55], v[8:11]
buffer_load_dwordx4 v[84:87], v227, s[20:23], s63 offen offset:0 sc1
ds_read_b64_tr_b16 v[144:145], v230 offset:24576
v_mfma_f32_16x16x32_bf16 v[200:203], v[104:107], v[56:59], v[200:203]
ds_read_b64_tr_b16 v[146:147], v230 offset:25088
ds_read_b64_tr_b16 v[148:149], v231 offset:24576
v_mfma_f32_16x16x32_bf16 v[12:15], v[108:111], v[52:55], v[12:15]
ds_read_b64_tr_b16 v[150:151], v231 offset:25088
ds_read_b64_tr_b16 v[152:153], v228 offset:32768
v_mfma_f32_16x16x32_bf16 v[204:207], v[108:111], v[56:59], v[204:207]
ds_read_b64_tr_b16 v[154:155], v228 offset:33280
ds_read_b64_tr_b16 v[156:157], v229 offset:32768
v_mfma_f32_16x16x32_bf16 v[16:19], v[112:115], v[52:55], v[16:19]
buffer_load_dwordx4 v[88:91], v236, s[20:23], s63 offen offset:0 sc1
ds_read_b64_tr_b16 v[158:159], v229 offset:33280
v_mfma_f32_16x16x32_bf16 v[208:211], v[112:115], v[56:59], v[208:211]
ds_read_b64_tr_b16 v[160:161], v230 offset:32768
s_waitcnt vmcnt(6)
v_max_u16 v2, v60, v64
v_cmp_eq_u16 vcc, -1, v2
v_mfma_f32_16x16x32_bf16 v[20:23], v[116:119], v[52:55], v[20:23]
ds_read_b64_tr_b16 v[162:163], v230 offset:33280
s_cbranch_vccnz L_st5
L_go5:
v_mfma_f32_16x16x32_bf16 v[212:215], v[116:119], v[56:59], v[212:215]
ds_read_b64_tr_b16 v[164:165], v231 offset:32768
s_waitcnt lgkmcnt(15)
v_mfma_f32_16x16x32_bf16 v[8:11], v[120:123], v[60:63], v[8:11]
buffer_load_dwordx4 v[92:95], v227, s[20:23], s63 offen offset:256 sc1
ds_read_b64_tr_b16 v[166:167], v231 offset:33280
v_mfma_f32_16x16x32_bf16 v[200:203], v[120:123], v[64:67], v[200:203]
v_add_u32 v228, 40960, v228
ds_read_b64_tr_b16 v[168:169], v228 offset:0
ds_read_b64_tr_b16 v[170:171], v228 offset:512
v_mfma_f32_16x16x32_bf16 v[12:15], v[124:127], v[60:63], v[12:15]
v_add_u32 v229, 40960, v229
ds_read_b64_tr_b16 v[172:173], v229 offset:0
ds_read_b64_tr_b16 v[174:175], v229 offset:512
v_mfma_f32_16x16x32_bf16 v[204:207], v[124:127], v[64:67], v[204:207]
v_add_u32 v230, 40960, v230
ds_read_b64_tr_b16 v[176:177], v230 offset:0
ds_read_b64_tr_b16 v[178:179], v230 offset:512
v_mfma_f32_16x16x32_bf16 v[16:19], v[128:131], v[60:63], v[16:19]
buffer_load_dwordx4 v[96:99], v236, s[20:23], s63 offen offset:256 sc1
v_add_u32 v231, 40960, v231
ds_read_b64_tr_b16 v[180:181], v231 offset:0
v_mfma_f32_16x16x32_bf16 v[208:211], v[128:131], v[64:67], v[208:211]
ds_read_b64_tr_b16 v[182:183], v231 offset:512
s_waitcnt vmcnt(6)
v_max_u16 v2, v68, v72
v_cmp_eq_u16 vcc, -1, v2
v_mfma_f32_16x16x32_bf16 v[20:23], v[132:135], v[60:63], v[20:23]
ds_read_b64_tr_b16 v[184:185], v228 offset:8192
s_cbranch_vccnz L_st6
L_go6:
v_mfma_f32_16x16x32_bf16 v[212:215], v[132:135], v[64:67], v[212:215]
ds_read_b64_tr_b16 v[186:187], v228 offset:8704
s_waitcnt lgkmcnt(15)
v_mfma_f32_16x16x32_bf16 v[8:11], v[136:139], v[68:71], v[8:11]
buffer_load_dwordx4 v[100:103], v227, s[20:23], s63 offen offset:512 sc1
ds_read_b64_tr_b16 v[188:189], v229 offset:8192
v_mfma_f32_16x16x32_bf16 v[200:203], v[136:139], v[72:75], v[200:203]
ds_read_b64_tr_b16 v[190:191], v229 offset:8704
ds_read_b64_tr_b16 v[192:193], v230 offset:8192
v_mfma_f32_16x16x32_bf16 v[12:15], v[140:143], v[68:71], v[12:15]
ds_read_b64_tr_b16 v[194:195], v230 offset:8704
ds_read_b64_tr_b16 v[196:197], v231 offset:8192
v_mfma_f32_16x16x32_bf16 v[204:207], v[140:143], v[72:75], v[204:207]
ds_read_b64_tr_b16 v[198:199], v231 offset:8704
ds_read_b64_tr_b16 v[104:105], v228 offset:16384
v_mfma_f32_16x16x32_bf16 v[16:19], v[144:147], v[68:71], v[16:19]
buffer_load_dwordx4 v[24:27], v236, s[20:23], s63 offen offset:512 sc1
ds_read_b64_tr_b16 v[106:107], v228 offset:16896
v_mfma_f32_16x16x32_bf16 v[208:211], v[144:147], v[72:75], v[208:211]
ds_read_b64_tr_b16 v[108:109], v229 offset:16384
s_waitcnt vmcnt(6)
v_max_u16 v2, v76, v80
v_cmp_eq_u16 vcc, -1, v2
v_mfma_f32_16x16x32_bf16 v[20:23], v[148:151], v[68:71], v[20:23]
ds_read_b64_tr_b16 v[110:111], v229 offset:16896
s_cbranch_vccnz L_st7
L_go7:
v_mfma_f32_16x16x32_bf16 v[212:215], v[148:151], v[72:75], v[212:215]
ds_read_b64_tr_b16 v[112:113], v230 offset:16384
s_waitcnt lgkmcnt(15)
v_mfma_f32_16x16x32_bf16 v[8:11], v[152:155], v[76:79], v[8:11]
buffer_load_dwordx4 v[28:31], v227, s[20:23], s63 offen offset:768 sc1
ds_read_b64_tr_b16 v[114:115], v230 offset:16896
v_mfma_f32_16x16x32_bf16 v[200:203], v[152:155], v[80:83], v[200:203]
ds_read_b64_tr_b16 v[116:117], v231 offset:16384
ds_read_b64_tr_b16 v[118:119], v231 offset:16896
v_mfma_f32_16x16x32_bf16 v[12:15], v[156:159], v[76:79], v[12:15]
ds_read_b64_tr_b16 v[120:121], v228 offset:24576
ds_read_b64_tr_b16 v[122:123], v228 offset:25088
v_mfma_f32_16x16x32_bf16 v[204:207], v[156:159], v[80:83], v[204:207]
ds_read_b64_tr_b16 v[124:125], v229 offset:24576
ds_read_b64_tr_b16 v[126:127], v229 offset:25088
v_mfma_f32_16x16x32_bf16 v[16:19], v[160:163], v[76:79], v[16:19]
buffer_load_dwordx4 v[32:35], v236, s[20:23], s63 offen offset:768 sc1
ds_read_b64_tr_b16 v[128:129], v230 offset:24576
v_mfma_f32_16x16x32_bf16 v[208:211], v[160:163], v[80:83], v[208:211]
ds_read_b64_tr_b16 v[130:131], v230 offset:25088
s_waitcnt vmcnt(6)
v_max_u16 v2, v84, v88
v_cmp_eq_u16 vcc, -1, v2
v_mfma_f32_16x16x32_bf16 v[20:23], v[164:167], v[76:79], v[20:23]
ds_read_b64_tr_b16 v[132:133], v231 offset:24576
s_cbranch_vccnz L_st8
L_go8:
v_mfma_f32_16x16x32_bf16 v[212:215], v[164:167], v[80:83], v[212:215]
ds_read_b64_tr_b16 v[134:135], v231 offset:25088
s_waitcnt lgkmcnt(15)
v_mfma_f32_16x16x32_bf16 v[8:11], v[168:171], v[84:87], v[8:11]
buffer_load_dwordx4 v[36:39], v227, s[20:23], s63 offen offset:1024 sc1
ds_read_b64_tr_b16 v[136:137], v228 offset:32768
v_mfma_f32_16x16x32_bf16 v[200:203], v[168:171], v[88:91], v[200:203]
ds_read_b64_tr_b16 v[138:139], v228 offset:33280
ds_read_b64_tr_b16 v[140:141], v229 offset:32768
v_mfma_f32_16x16x32_bf16 v[12:15], v[172:175], v[84:87], v[12:15]
ds_read_b64_tr_b16 v[142:143], v229 offset:33280
ds_read_b64_tr_b16 v[144:145], v230 offset:32768
v_mfma_f32_16x16x32_bf16 v[204:207], v[172:175], v[88:91], v[204:207]
ds_read_b64_tr_b16 v[146:147], v230 offset:33280
ds_read_b64_tr_b16 v[148:149], v231 offset:32768
v_mfma_f32_16x16x32_bf16 v[16:19], v[176:179], v[84:87], v[16:19]
buffer_load_dwordx4 v[40:43], v236, s[20:23], s63 offen offset:1024 sc1
ds_read_b64_tr_b16 v[150:151], v231 offset:33280
v_mfma_f32_16x16x32_bf16 v[208:211], v[176:179], v[88:91], v[208:211]
v_subrev_u32 v228, s65, v228
ds_read_b64_tr_b16 v[152:153], v228 offset:0
s_waitcnt vmcnt(6)
v_max_u16 v2, v92, v96
v_cmp_eq_u16 vcc, -1, v2
v_mfma_f32_16x16x32_bf16 v[20:23], v[180:183], v[84:87], v[20:23]
ds_read_b64_tr_b16 v[154:155], v228 offset:512
s_cbranch_vccnz L_st9
L_go9:
v_mfma_f32_16x16x32_bf16 v[212:215], v[180:183], v[88:91], v[212:215]
v_subrev_u32 v229, s65, v229
ds_read_b64_tr_b16 v[156:157], v229 offset:0
v_mfma_f32_16x16x32_bf16 v[8:11], v[184:187], v[92:95], v[8:11]
buffer_load_dwordx4 v[44:47], v227, s[20:23], s64 offen offset:0 sc1
ds_read_b64_tr_b16 v[158:159], v229 offset:512
v_mfma_f32_16x16x32_bf16 v[200:203], v[184:187], v[96:99], v[200:203]
v_subrev_u32 v230, s65, v230
ds_read_b64_tr_b16 v[160:161], v230 offset:0
ds_read_b64_tr_b16 v[162:163], v230 offset:512
v_mfma_f32_16x16x32_bf16 v[12:15], v[188:191], v[92:95], v[12:15]
v_subrev_u32 v231, s65, v231
ds_read_b64_tr_b16 v[164:165], v231 offset:0
ds_read_b64_tr_b16 v[166:167], v231 offset:512
v_mfma_f32_16x16x32_bf16 v[204:207], v[188:191], v[96:99], v[204:207]
ds_read_b64_tr_b16 v[168:169], v228 offset:8192
ds_read_b64_tr_b16 v[170:171], v228 offset:8704
v_mfma_f32_16x16x32_bf16 v[16:19], v[192:195], v[92:95], v[16:19]
buffer_load_dwordx4 v[48:51], v227, s[20:23], s64 offen offset:256 sc1
ds_read_b64_tr_b16 v[172:173], v229 offset:8192
v_mfma_f32_16x16x32_bf16 v[208:211], v[192:195], v[96:99], v[208:211]
ds_read_b64_tr_b16 v[174:175], v229 offset:8704
s_waitcnt vmcnt(6)
v_max_u16 v2, v100, v24
v_cmp_eq_u16 vcc, -1, v2
v_mfma_f32_16x16x32_bf16 v[20:23], v[196:199], v[92:95], v[20:23]
ds_read_b64_tr_b16 v[176:177], v230 offset:8192
s_cbranch_vccnz L_st10
L_go10:
v_mfma_f32_16x16x32_bf16 v[212:215], v[196:199], v[96:99], v[212:215]
ds_read_b64_tr_b16 v[178:179], v230 offset:8704
s_waitcnt lgkmcnt(15)
v_mfma_f32_16x16x32_bf16 v[8:11], v[104:107], v[100:103], v[8:11]
buffer_load_dwordx4 v[52:55], v227, s[20:23], s64 offen offset:512 sc1
ds_read_b64_tr_b16 v[180:181], v231 offset:8192
v_mfma_f32_16x16x32_bf16 v[200:203], v[104:107], v[24:27], v[200:203]
ds_read_b64_tr_b16 v[182:183], v231 offset:8704
ds_read_b64_tr_b16 v[184:185], v228 offset:16384
v_mfma_f32_16x16x32_bf16 v[12:15], v[108:111], v[100:103], v[12:15]
ds_read_b64_tr_b16 v[186:187], v228 offset:16896
ds_read_b64_tr_b16 v[188:189], v229 offset:16384
v_mfma_f32_16x16x32_bf16 v[204:207], v[108:111], v[24:27], v[204:207]
ds_read_b64_tr_b16 v[190:191], v229 offset:16896
ds_read_b64_tr_b16 v[192:193], v230 offset:16384
v_mfma_f32_16x16x32_bf16 v[16:19], v[112:115], v[100:103], v[16:19]
buffer_load_dwordx4 v[56:59], v227, s[20:23], s64 offen offset:768 sc1
ds_read_b64_tr_b16 v[194:195], v230 offset:16896
v_mfma_f32_16x16x32_bf16 v[208:211], v[112:115], v[24:27], v[208:211]
ds_read_b64_tr_b16 v[196:197], v231 offset:16384
s_waitcnt vmcnt(6)
v_max_u16 v2, v28, v32
v_cmp_eq_u16 vcc, -1, v2
v_mfma_f32_16x16x32_bf16 v[20:23], v[116:119], v[100:103], v[20:23]
ds_read_b64_tr_b16 v[198:199], v231 offset:16896
s_cbranch_vccnz L_st11
L_go11:
v_mfma_f32_16x16x32_bf16 v[212:215], v[116:119], v[24:27], v[212:215]
ds_read_b64_tr_b16 v[104:105], v228 offset:24576
v_mfma_f32_16x16x32_bf16 v[8:11], v[120:123], v[28:31], v[8:11]
buffer_load_dwordx4 v[60:63], v227, s[20:23], s64 offen offset:1024 sc1
ds_read_b64_tr_b16 v[106:107], v228 offset:25088
v_mfma_f32_16x16x32_bf16 v[200:203], v[120:123], v[32:35], v[200:203]
ds_read_b64_tr_b16 v[108:109], v229 offset:24576
ds_read_b64_tr_b16 v[110:111], v229 offset:25088
v_mfma_f32_16x16x32_bf16 v[12:15], v[124:127], v[28:31], v[12:15]
ds_read_b64_tr_b16 v[112:113], v230 offset:24576
ds_read_b64_tr_b16 v[114:115], v230 offset:25088
v_mfma_f32_16x16x32_bf16 v[204:207], v[124:127], v[32:35], v[204:207]
ds_read_b64_tr_b16 v[116:117], v231 offset:24576
ds_read_b64_tr_b16 v[118:119], v231 offset:25088
v_mfma_f32_16x16x32_bf16 v[16:19], v[128:131], v[28:31], v[16:19]
ds_read_b64_tr_b16 v[120:121], v228 offset:32768
ds_read_b64_tr_b16 v[122:123], v228 offset:33280
v_mfma_f32_16x16x32_bf16 v[208:211], v[128:131], v[32:35], v[208:211]
ds_read_b64_tr_b16 v[124:125], v229 offset:32768
s_waitcnt vmcnt(5)
v_max_u16 v2, v36, v40
v_cmp_eq_u16 vcc, -1, v2
v_mfma_f32_16x16x32_bf16 v[20:23], v[132:135], v[28:31], v[20:23]
ds_read_b64_tr_b16 v[126:127], v229 offset:33280
s_cbranch_vccnz L_st12
L_go12:
v_mfma_f32_16x16x32_bf16 v[212:215], v[132:135], v[32:35], v[212:215]
ds_read_b64_tr_b16 v[128:129], v230 offset:32768
s_waitcnt lgkmcnt(15)
v_mfma_f32_16x16x32_bf16 v[8:11], v[136:139], v[36:39], v[8:11]
ds_read_b64_tr_b16 v[130:131], v230 offset:33280
ds_read_b64_tr_b16 v[132:133], v231 offset:32768
v_mfma_f32_16x16x32_bf16 v[200:203], v[136:139], v[40:43], v[200:203]
ds_read_b64_tr_b16 v[134:135], v231 offset:33280
v_mfma_f32_16x16x32_bf16 v[12:15], v[140:143], v[36:39], v[12:15]
v_mfma_f32_16x16x32_bf16 v[204:207], v[140:143], v[40:43], v[204:207]
v_mfma_f32_16x16x32_bf16 v[16:19], v[144:147], v[36:39], v[16:19]
v_mfma_f32_16x16x32_bf16 v[208:211], v[144:147], v[40:43], v[208:211]
s_waitcnt vmcnt(3)
v_max_u16 v2, v44, v48
v_cmp_eq_u16 vcc, -1, v2
v_mfma_f32_16x16x32_bf16 v[20:23], v[148:151], v[36:39], v[20:23]
s_cbranch_vccnz L_st13
L_go13:
v_mfma_f32_16x16x32_bf16 v[212:215], v[148:151], v[40:43], v[212:215]
v_mfma_f32_16x16x32_bf16 v[8:11], v[152:155], v[44:47], v[8:11]
v_mfma_f32_16x16x32_bf16 v[12:15], v[156:159], v[44:47], v[12:15]
ds_write_b128 v4, v[200:203] offset:0
v_mfma_f32_16x16x32_bf16 v[16:19], v[160:163], v[44:47], v[16:19]
ds_write_b128 v4, v[204:207] offset:1024
v_mfma_f32_16x16x32_bf16 v[20:23], v[164:167], v[44:47], v[20:23]
ds_write_b128 v4, v[208:211] offset:2048
v_mfma_f32_16x16x32_bf16 v[8:11], v[168:171], v[48:51], v[8:11]
v_mfma_f32_16x16x32_bf16 v[12:15], v[172:175], v[48:51], v[12:15]
ds_write_b128 v4, v[212:215] offset:3072
s_waitcnt vmcnt(1)
v_max_u16 v2, v52, v56
v_cmp_eq_u16 vcc, -1, v2
v_mfma_f32_16x16x32_bf16 v[16:19], v[176:179], v[48:51], v[16:19]
s_mov_b64 exec, 1
ds_add_u32 v3, v5
s_mov_b64 exec, -1
s_cbranch_vccnz L_st14
L_go14:
v_mfma_f32_16x16x32_bf16 v[20:23], v[180:183], v[48:51], v[20:23]
s_waitcnt lgkmcnt(15)
v_mfma_f32_16x16x32_bf16 v[8:11], v[184:187], v[52:55], v[8:11]
v_mfma_f32_16x16x32_bf16 v[12:15], v[188:191], v[52:55], v[12:15]
v_mfma_f32_16x16x32_bf16 v[16:19], v[192:195], v[52:55], v[16:19]
v_mfma_f32_16x16x32_bf16 v[20:23], v[196:199], v[52:55], v[20:23]
s_waitcnt lgkmcnt(13)
v_mfma_f32_16x16x32_bf16 v[8:11], v[104:107], v[56:59], v[8:11]
v_mfma_f32_16x16x32_bf16 v[12:15], v[108:111], v[56:59], v[12:15]
s_waitcnt vmcnt(0)
v_cmp_eq_u16 vcc, -1, v60
v_mfma_f32_16x16x32_bf16 v[16:19], v[112:115], v[56:59], v[16:19]
s_cbranch_vccnz L_st15
L_go15:
v_mfma_f32_16x16x32_bf16 v[20:23], v[116:119], v[56:59], v[20:23]
s_waitcnt lgkmcnt(11)
v_mfma_f32_16x16x32_bf16 v[8:11], v[120:123], v[60:63], v[8:11]
s_waitcnt lgkmcnt(9)
v_mfma_f32_16x16x32_bf16 v[12:15], v[124:127], v[60:63], v[12:15]
s_waitcnt lgkmcnt(7)
v_mfma_f32_16x16x32_bf16 v[16:19], v[128:131], v[60:63], v[16:19]
s_waitcnt lgkmcnt(5)
v_mfma_f32_16x16x32_bf16 v[20:23], v[132:135], v[60:63], v[20:23]
L_tail:
s_nop 1
v_cvt_pk_bf16_f32 v24, v8, v9
v_cvt_pk_bf16_f32 v25, v10, v11
v_cvt_pk_bf16_f32 v26, v12, v13
v_cvt_pk_bf16_f32 v27, v14, v15
v_cvt_pk_bf16_f32 v28, v16, v17
v_cvt_pk_bf16_f32 v29, v18, v19
v_cvt_pk_bf16_f32 v30, v20, v21
v_cvt_pk_bf16_f32 v31, v22, v23
v_mfma_f32_16x16x32_bf16 v[36:39], v[24:27], v[24:27], 0
v_mfma_f32_16x16x32_bf16 v[32:35], v[244:247], v[24:27], 0
v_mfma_f32_16x16x32_bf16 v[36:39], v[28:31], v[28:31], v[36:39]
v_mfma_f32_16x16x32_bf16 v[32:35], v[248:251], v[28:31], v[32:35]
s_mov_b32 s0, 0x22222222
s_mov_b32 s1, s0
s_mov_b32 s44, 0x44444444
s_mov_b32 s45, s44
s_mov_b32 vcc_lo, 0x88888888
s_mov_b32 vcc_hi, 0x88888888
s_lshl_b32 s3, s36, 8
s_add_u32 s3, s3, s58
v_and_b32 v1, 0xf0, v233
v_cndmask_b32 v36, v36, v37, s[0:1]
v_cndmask_b32 v38, v38, v39, vcc
s_or_b64 vcc, vcc, s[44:45]
v_cndmask_b32 v34, v36, v38, vcc
v_mov_b32 v35, v253
s_mov_b32 exec_lo, 0xf0000f
s_mov_b32 exec_hi, 0xf0000f00
s_cmp_eq_u32 s41, 1
s_cbranch_scc0 L_gl_9g
buffer_store_dwordx4 v[32:35], v1, s[16:19], s3 offen
L_gl_9b:
s_mov_b64 exec, -1
v_mov_b32 v48, 0
v_mov_b32 v49, 0
v_mov_b32 v50, 0
v_mov_b32 v51, 0
v_mov_b32 v4, 1.0
s_mov_b32 s0, 0xbacccccd
s_mov_b32 s1, 0x3acccccd
v_mov_b32 v5, 0x3727c5ac
s_mov_b32 s44, 0xfffff800
v_mov_b32 v1, 1732
v_cmp_le_i32 s[46:47], 0, v232
L_e2:
buffer_load_dwordx4 v[40:43], v233, s[16:19], s58 offen sc1
buffer_load_dwordx4 v[44:47], v233, s[16:19], s58 offen offset:1024 sc1
s_mov_b32 exec_hi, 0
buffer_load_dwordx4 v[48:51], v233, s[16:19], s58 offen offset:2048 sc1
s_mov_b32 exec_hi, -1
s_waitcnt vmcnt(1)
v_pk_add_f32 v[40:41], v[40:41], v[44:45]
v_pk_add_f32 v[42:43], v[42:43], v[46:47]
s_waitcnt vmcnt(0)
v_pk_add_f32 v[40:41], v[40:41], v[48:49]
v_pk_add_f32 v[42:43], v[42:43], v[50:51]
v_cmp_u_f32 vcc, v40, v40
s_cbranch_vccnz L_e2r
L_e2go:
v_mfma_f32_16x16x4_f32 v[52:55], v4, v40, 0
v_mfma_f32_16x16x4_f32 v[60:63], v4, v42, 0
v_mfma_f32_16x16x4_f32 v[64:67], v4, v43, 0
v_mfma_f32_16x16x4_f32 v[56:59], v4, v41, 0
s_nop 6
v_mul_f32 v6, s0, v52
v_fma_f32 v7, v60, s1, v5
v_fma_f32 v7, -v6, v6, v7
v_max_f32 v7, v7, v5
v_rsq_f32 v2, v7
v_fma_f32 v7, v6, v64, v56
v_mul_f32 v7, v7, v2
v_mul_f32 v3, v6, v2
v_ashrrev_i32 v6, 31, v7
v_or_b32 v6, 0x80000000, v6
v_xor_b32 v7, v7, v6
v_and_or_b32 v7, v7, s44, v234
v_cndmask_b32 v7, 0, v7, s[46:47]
v_pk_fma_f32 v[72:73], v[8:9], v[2:3], v[2:3] op_sel:[0,0,1] op_sel_hi:[1,0,1]
v_pk_fma_f32 v[74:75], v[10:11], v[2:3], v[2:3] op_sel:[0,0,1] op_sel_hi:[1,0,1]
v_max_u32_dpp v6, v7, v7 row_ror:8 row_mask:0xf bank_mask:0xf
v_pk_fma_f32 v[76:77], v[12:13], v[2:3], v[2:3] op_sel:[0,0,1] op_sel_hi:[1,0,1]
v_pk_fma_f32 v[78:79], v[14:15], v[2:3], v[2:3] op_sel:[0,0,1] op_sel_hi:[1,0,1]
v_max_u32_dpp v6, v6, v6 row_ror:4 row_mask:0xf bank_mask:0xf
v_pk_fma_f32 v[80:81], v[16:17], v[2:3], v[2:3] op_sel:[0,0,1] op_sel_hi:[1,0,1]
v_pk_fma_f32 v[82:83], v[18:19], v[2:3], v[2:3] op_sel:[0,0,1] op_sel_hi:[1,0,1]
v_max_u32_dpp v6, v6, v6 row_ror:2 row_mask:0xf bank_mask:0xf
v_pk_fma_f32 v[84:85], v[20:21], v[2:3], v[2:3] op_sel:[0,0,1] op_sel_hi:[1,0,1]
v_pk_fma_f32 v[86:87], v[22:23], v[2:3], v[2:3] op_sel:[0,0,1] op_sel_hi:[1,0,1]
v_max_u32_dpp v6, v6, v6 row_ror:1 row_mask:0xf bank_mask:0xf
s_mov_b64 exec, 1
ds_max_u32 v1, v6
s_mov_b64 exec, -1
v_cvt_pk_bf16_f32 v88, v72, v73
v_cvt_pk_bf16_f32 v89, v74, v75
v_cvt_pk_bf16_f32 v90, v76, v77
v_cvt_pk_bf16_f32 v91, v78, v79
v_cvt_pk_bf16_f32 v92, v80, v81
v_cvt_pk_bf16_f32 v93, v82, v83
v_cvt_pk_bf16_f32 v94, v84, v85
v_cvt_pk_bf16_f32 v95, v86, v87
s_mul_i32 s0, s35, 1280
s_lshl_b32 s3, s36, 7
s_add_u32 s0, s0, s3
s_lshl_b32 s1, s0, 1
s_add_u32 s0, s0, s59
s_add_u32 s1, s1, s59
s_add_u32 s1, s1, 4096
s_lshl_b32 s3, s35, 7
s_add_u32 s3, s3, s59
s_add_u32 s3, s3, 21504
s_lshl_b32 s44, s36, 3
s_add_u32 s44, s44, s32
v_mul_u32_u24 v6, 384, v0
v_and_b32 v5, 48, v0
v_lshlrev_b32 v4, 1, v5
s_waitcnt lgkmcnt(0)
s_barrier
ds_read_b32 v1, v1
v_pk_add_f32 v[72:73], v[72:73], v[8:9]
v_pk_add_f32 v[74:75], v[74:75], v[10:11]
v_pk_add_f32 v[76:77], v[76:77], v[12:13]
v_pk_add_f32 v[78:79], v[78:79], v[14:15]
v_pk_add_f32 v[80:81], v[80:81], v[16:17]
v_pk_add_f32 v[82:83], v[82:83], v[18:19]
v_pk_add_f32 v[84:85], v[84:85], v[20:21]
v_pk_add_f32 v[86:87], v[86:87], v[22:23]
s_cmp_eq_u32 s44, 4
s_waitcnt lgkmcnt(0)
v_cmp_eq_u32 s[46:47], v1, v7
s_cbranch_scc0 L_nk
s_mov_b64 exec, 0xffff
buffer_store_dword v1, v6, s[16:19], s3 offen sc1
L_nk:
s_and_b64 exec, s[46:47], -1
s_cbranch_scc0 L_nc
buffer_store_dwordx4 v[88:91], v4, s[16:19], s0 offen sc1
buffer_store_dwordx4 v[92:95], v4, s[16:19], s0 offen offset:16 sc1
L_nc:
s_mov_b64 exec, -1
v_cvt_pk_bf16_f32 v96, v72, v73
v_cvt_pk_bf16_f32 v97, v74, v75
v_cvt_pk_bf16_f32 v98, v76, v77
v_cvt_pk_bf16_f32 v99, v78, v79
v_cvt_pk_bf16_f32 v100, v80, v81
v_cvt_pk_bf16_f32 v101, v82, v83
v_cvt_pk_bf16_f32 v102, v84, v85
v_cvt_pk_bf16_f32 v103, v86, v87
v_permlane16_swap_b32 v96, v98
v_permlane16_swap_b32 v97, v99
v_permlane16_swap_b32 v100, v102
v_permlane16_swap_b32 v101, v103
s_not_b64 exec, s[46:47]
buffer_store_dwordx4 v[96:99], v232, s[20:23], 0 offen offset:0
buffer_store_dwordx4 v[100:103], v232, s[20:23], 0 offen offset:64
s_and_b64 exec, s[46:47], -1
s_cbranch_scc0 L_fin
buffer_store_dwordx4 v[96:99], v232, s[20:23], 0 offen offset:0 sc1
buffer_store_dwordx4 v[100:103], v232, s[20:23], 0 offen offset:64 sc1
s_waitcnt vmcnt(0)
buffer_store_dwordx4 v[72:75], v5, s[16:19], s1 offen offset:0 sc1
buffer_store_dwordx4 v[76:79], v5, s[16:19], s1 offen offset:64 sc1
buffer_store_dwordx4 v[80:83], v5, s[16:19], s1 offen offset:128 sc1
buffer_store_dwordx4 v[84:87], v5, s[16:19], s1 offen offset:192 sc1
L_fin:
s_endpgm
.p2align 12
L_pb_10:
L_pad_11:
s_setpc_b64 s[100:101]
L_era:
s_sub_u32 s40, s40, 1
s_cbranch_scc1 L_exa
s_lshl_b32 s0, s33, 5
v_and_b32 v1, 16, v0
buffer_load_dword v32, v1, s[24:27], s0 offen sc1
s_waitcnt vmcnt(0)
s_waitcnt lgkmcnt(0)
v_cmp_ne_u32 vcc, 1, v32
s_cmp_eq_u64 vcc, 0
s_cbranch_scc0 L_era
s_branch L_ega
L_exa:
s_mov_b32 s40, 0
s_branch L_ega
L_erb:
s_sub_u32 s40, s40, 1
s_cbranch_scc1 L_exb
s_buffer_load_dword s71, s[16:19], s66 offset:0 glc
s_buffer_load_dword s73, s[16:19], s66 offset:128 glc
s_buffer_load_dword s75, s[16:19], s66 offset:256 glc
s_buffer_load_dword s77, s[16:19], s66 offset:384 glc
s_buffer_load_dword s83, s[16:19], s66 offset:512 glc
s_buffer_load_dword s85, s[16:19], s66 offset:640 glc
s_buffer_load_dword s89, s[16:19], s66 offset:768 glc
s_buffer_load_dword s91, s[16:19], s66 offset:896 glc
s_buffer_load_dword s93, s[16:19], s66 offset:1024 glc
s_buffer_load_dword s95, s[16:19], s66 offset:1152 glc
s_waitcnt lgkmcnt(0)
s_max_u32 s0, s71, s73
s_max_u32 s0, s0, s75
s_max_u32 s0, s0, s77
s_max_u32 s0, s0, s83
s_max_u32 s0, s0, s85
s_max_u32 s0, s0, s89
s_max_u32 s0, s0, s91
s_max_u32 s0, s0, s93
s_max_u32 s0, s0, s95
s_cmp_lg_u32 s0, -1
s_cbranch_scc0 L_erb
s_branch L_egb
L_exb:
s_mov_b32 s40, 0
s_branch L_egb
L_gh_3g:
s_barrier
s_cmp_eq_u32 s32, 5
s_cbranch_scc0 L_gh_3e
v_mov_b32 v1, 1
s_mov_b64 exec, 1
buffer_store_dword v1, off, s[16:19], s68 offset:64 sc1
s_mov_b64 exec, -1
L_gh_3p:
buffer_load_dword v1, v55, s[16:19], 0 offen offset:64 sc1
s_waitcnt vmcnt(0)
v_cmp_ne_u32 vcc, 1, v1
s_cbranch_vccz L_gh_3e
s_sub_u32 s40, s40, 1
s_cbranch_scc0 L_gh_3p
s_mov_b32 s40, 0
L_gh_3e:
s_barrier
s_branch L_gh_3b
L_xcap:
v_add_u32 v1, s0, v235
ds_read_b64 v[72:73], v1
v_xor_b32 v2, 32, v1
ds_read_b64 v[74:75], v2
v_xor_b32 v3, 64, v1
ds_read_b64 v[76:77], v3
v_xor_b32 v4, 96, v1
ds_read_b64 v[78:79], v4
s_setpc_b64 s[100:101]
L_woe1:
s_addk_i32 m0, 4096
s_mov_b32 s3, 0
buffer_load_dwordx4 v57, s[12:15], s3 offen lds
s_addk_i32 m0, 4096
s_mov_b32 s3, 81920
buffer_load_dwordx4 v57, s[12:15], s3 offen lds
s_addk_i32 m0, 4096
s_mov_b32 s3, 163840
buffer_load_dwordx4 v58, s[12:15], s3 offen lds
s_addk_i32 m0, 4096
s_mov_b32 s3, 245760
buffer_load_dwordx4 v60, s[12:15], s3 offen lds
s_addk_i32 m0, 4096
s_mov_b32 s3, 327680
buffer_load_dwordx4 v60, s[12:15], s3 offen lds
s_addk_i32 m0, 4096
s_mov_b32 s3, 409600
buffer_load_dwordx4 v57, s[12:15], s3 offen lds
s_addk_i32 m0, 4096
s_mov_b32 s3, 491520
buffer_load_dwordx4 v57, s[12:15], s3 offen lds
s_addk_i32 m0, 4096
s_mov_b32 s3, 573440
buffer_load_dwordx4 v58, s[12:15], s3 offen lds
s_addk_i32 m0, 4096
s_mov_b32 s3, 655360
buffer_load_dwordx4 v60, s[12:15], s3 offen lds
s_addk_i32 m0, 4096
s_mov_b32 s3, 737280
buffer_load_dwordx4 v60, s[12:15], s3 offen lds
s_branch L_woe
L_woe2:
s_addk_i32 m0, 4096
s_mov_b32 s3, 5120
buffer_load_dwordx4 v57, s[12:15], s3 offen lds
s_addk_i32 m0, 4096
s_mov_b32 s3, 87040
buffer_load_dwordx4 v58, s[12:15], s3 offen lds
s_addk_i32 m0, 4096
s_mov_b32 s3, 168960
buffer_load_dwordx4 v58, s[12:15], s3 offen lds
s_addk_i32 m0, 4096
s_mov_b32 s3, 250880
buffer_load_dwordx4 v60, s[12:15], s3 offen lds
s_addk_i32 m0, 4096
s_mov_b32 s3, 384000
buffer_load_dwordx4 v59, s[12:15], s3 offen lds
s_addk_i32 m0, 4096
s_mov_b32 s3, 414720
buffer_load_dwordx4 v57, s[12:15], s3 offen lds
s_addk_i32 m0, 4096
s_mov_b32 s3, 496640
buffer_load_dwordx4 v58, s[12:15], s3 offen lds
s_addk_i32 m0, 4096
s_mov_b32 s3, 578560
buffer_load_dwordx4 v58, s[12:15], s3 offen lds
s_addk_i32 m0, 4096
s_mov_b32 s3, 660480
buffer_load_dwordx4 v60, s[12:15], s3 offen lds
s_addk_i32 m0, 4096
s_mov_b32 s3, 793600
buffer_load_dwordx4 v59, s[12:15], s3 offen lds
s_branch L_woe
L_pad_12:
s_setpc_b64 s[100:101]
L_woe3:
s_addk_i32 m0, 4096
s_mov_b32 s3, 10240
buffer_load_dwordx4 v58, s[12:15], s3 offen lds
s_addk_i32 m0, 4096
s_mov_b32 s3, 92160
buffer_load_dwordx4 v58, s[12:15], s3 offen lds
s_addk_i32 m0, 4096
s_mov_b32 s3, 174080
buffer_load_dwordx4 v58, s[12:15], s3 offen lds
s_addk_i32 m0, 4096
s_mov_b32 s3, 307200
buffer_load_dwordx4 v59, s[12:15], s3 offen lds
s_addk_i32 m0, 4096
s_mov_b32 s3, 389120
buffer_load_dwordx4 v59, s[12:15], s3 offen lds
s_addk_i32 m0, 4096
s_mov_b32 s3, 419840
buffer_load_dwordx4 v58, s[12:15], s3 offen lds
s_addk_i32 m0, 4096
s_mov_b32 s3, 501760
buffer_load_dwordx4 v58, s[12:15], s3 offen lds
s_addk_i32 m0, 4096
s_mov_b32 s3, 583680
buffer_load_dwordx4 v58, s[12:15], s3 offen lds
s_addk_i32 m0, 4096
s_mov_b32 s3, 716800
buffer_load_dwordx4 v59, s[12:15], s3 offen lds
s_addk_i32 m0, 4096
s_mov_b32 s3, 798720
buffer_load_dwordx4 v59, s[12:15], s3 offen lds
s_branch L_woe
L_gl_4g:
buffer_store_dwordx4 v[192:195], v224, s[20:23], s54 offen sc1
s_branch L_gl_4b
L_gl_5g:
buffer_store_dwordx4 v[196:199], v226, s[20:23], 0 offen sc1
s_branch L_gl_5b
L_h0rh:
s_sub_u32 s40, s40, 1
s_cbranch_scc1 L_h0xh
buffer_load_dwordx4 v[92:95], v225, s[20:23], s54 offen sc1
s_waitcnt vmcnt(0)
v_cmp_eq_u32 vcc, -1, v94
s_cbranch_vccnz L_h0rh
s_branch L_h0gh
L_h0xh:
s_mov_b32 s40, 0
s_branch L_h0gh
L_gl_6g:
buffer_store_dwordx4 v[80:83], v226, s[20:23], s54 offen sc1
s_branch L_gl_6b
L_spw:
v_mov_b32 v1, 1744
ds_read_b32 v1, v1
s_waitcnt lgkmcnt(0)
v_cmp_ne_u32 vcc, 4, v1
s_cbranch_vccnz L_spw
s_branch L_sbw
L_st0:
s_sub_u32 s40, s40, 1
s_cbranch_scc1 L_sx0
buffer_load_dwordx4 v[24:27], v227, s[20:23], s61 offen offset:0 sc1
buffer_load_dwordx4 v[28:31], v227, s[20:23], s61 offen offset:256 sc1
s_waitcnt vmcnt(0)
v_max_u16 v2, v24, v28
v_cmp_eq_u16 vcc, -1, v2
s_cbranch_vccnz L_st0
s_branch L_go0
L_sx0:
s_mov_b32 s40, 0
s_branch L_go0
L_st1:
s_sub_u32 s40, s40, 1
s_cbranch_scc1 L_sx1
buffer_load_dwordx4 v[32:35], v227, s[20:23], s61 offen offset:512 sc1
buffer_load_dwordx4 v[36:39], v227, s[20:23], s61 offen offset:768 sc1
s_waitcnt vmcnt(0)
v_max_u16 v2, v32, v36
v_cmp_eq_u16 vcc, -1, v2
s_cbranch_vccnz L_st1
s_branch L_go1
L_sx1:
s_mov_b32 s40, 0
s_branch L_go1
L_st2:
s_sub_u32 s40, s40, 1
s_cbranch_scc1 L_sx2
buffer_load_dwordx4 v[40:43], v227, s[20:23], s61 offen offset:1024 sc1
s_waitcnt vmcnt(0)
v_cmp_eq_u16 vcc, -1, v40
s_cbranch_vccnz L_st2
s_branch L_go2
L_sx2:
s_mov_b32 s40, 0
s_branch L_go2
L_st3:
s_sub_u32 s40, s40, 1
s_cbranch_scc1 L_sx3
buffer_load_dwordx4 v[44:47], v227, s[20:23], s62 offen offset:0 sc1
buffer_load_dwordx4 v[48:51], v236, s[20:23], s62 offen offset:0 sc1
s_waitcnt vmcnt(0)
v_max_u16 v2, v44, v48
v_cmp_eq_u16 vcc, -1, v2
s_cbranch_vccnz L_st3
s_branch L_go3
L_sx3:
s_mov_b32 s40, 0
s_branch L_go3
L_st4:
s_sub_u32 s40, s40, 1
s_cbranch_scc1 L_sx4
buffer_load_dwordx4 v[52:55], v227, s[20:23], s62 offen offset:256 sc1
buffer_load_dwordx4 v[56:59], v236, s[20:23], s62 offen offset:256 sc1
s_waitcnt vmcnt(0)
v_max_u16 v2, v52, v56
v_cmp_eq_u16 vcc, -1, v2
s_cbranch_vccnz L_st4
s_branch L_go4
L_sx4:
s_mov_b32 s40, 0
s_branch L_go4
L_pad_13:
s_setpc_b64 s[100:101]
L_st5:
s_sub_u32 s40, s40, 1
s_cbranch_scc1 L_sx5
buffer_load_dwordx4 v[60:63], v227, s[20:23], s62 offen offset:512 sc1
buffer_load_dwordx4 v[64:67], v236, s[20:23], s62 offen offset:512 sc1
s_waitcnt vmcnt(0)
v_max_u16 v2, v60, v64
v_cmp_eq_u16 vcc, -1, v2
s_cbranch_vccnz L_st5
s_branch L_go5
L_sx5:
s_mov_b32 s40, 0
s_branch L_go5
L_st6:
s_sub_u32 s40, s40, 1
s_cbranch_scc1 L_sx6
buffer_load_dwordx4 v[68:71], v227, s[20:23], s62 offen offset:768 sc1
buffer_load_dwordx4 v[72:75], v236, s[20:23], s62 offen offset:768 sc1
s_waitcnt vmcnt(0)
v_max_u16 v2, v68, v72
v_cmp_eq_u16 vcc, -1, v2
s_cbranch_vccnz L_st6
s_branch L_go6
L_sx6:
s_mov_b32 s40, 0
s_branch L_go6
L_st7:
s_sub_u32 s40, s40, 1
s_cbranch_scc1 L_sx7
buffer_load_dwordx4 v[76:79], v227, s[20:23], s62 offen offset:1024 sc1
buffer_load_dwordx4 v[80:83], v236, s[20:23], s62 offen offset:1024 sc1
s_waitcnt vmcnt(0)
v_max_u16 v2, v76, v80
v_cmp_eq_u16 vcc, -1, v2
s_cbranch_vccnz L_st7
s_branch L_go7
L_sx7:
s_mov_b32 s40, 0
s_branch L_go7
L_st8:
s_sub_u32 s40, s40, 1
s_cbranch_scc1 L_sx8
buffer_load_dwordx4 v[84:87], v227, s[20:23], s63 offen offset:0 sc1
buffer_load_dwordx4 v[88:91], v236, s[20:23], s63 offen offset:0 sc1
s_waitcnt vmcnt(0)
v_max_u16 v2, v84, v88
v_cmp_eq_u16 vcc, -1, v2
s_cbranch_vccnz L_st8
s_branch L_go8
L_sx8:
s_mov_b32 s40, 0
s_branch L_go8
L_st9:
s_sub_u32 s40, s40, 1
s_cbranch_scc1 L_sx9
buffer_load_dwordx4 v[92:95], v227, s[20:23], s63 offen offset:256 sc1
buffer_load_dwordx4 v[96:99], v236, s[20:23], s63 offen offset:256 sc1
s_waitcnt vmcnt(0)
v_max_u16 v2, v92, v96
v_cmp_eq_u16 vcc, -1, v2
s_cbranch_vccnz L_st9
s_branch L_go9
L_sx9:
s_mov_b32 s40, 0
s_branch L_go9
L_st10:
s_sub_u32 s40, s40, 1
s_cbranch_scc1 L_sx10
buffer_load_dwordx4 v[100:103], v227, s[20:23], s63 offen offset:512 sc1
buffer_load_dwordx4 v[24:27], v236, s[20:23], s63 offen offset:512 sc1
s_waitcnt vmcnt(0)
v_max_u16 v2, v100, v24
v_cmp_eq_u16 vcc, -1, v2
s_cbranch_vccnz L_st10
s_branch L_go10
L_sx10:
s_mov_b32 s40, 0
s_branch L_go10
L_st11:
s_sub_u32 s40, s40, 1
s_cbranch_scc1 L_sx11
buffer_load_dwordx4 v[28:31], v227, s[20:23], s63 offen offset:768 sc1
buffer_load_dwordx4 v[32:35], v236, s[20:23], s63 offen offset:768 sc1
s_waitcnt vmcnt(0)
v_max_u16 v2, v28, v32
v_cmp_eq_u16 vcc, -1, v2
s_cbranch_vccnz L_st11
s_branch L_go11
L_sx11:
s_mov_b32 s40, 0
s_branch L_go11
L_st12:
s_sub_u32 s40, s40, 1
s_cbranch_scc1 L_sx12
buffer_load_dwordx4 v[36:39], v227, s[20:23], s63 offen offset:1024 sc1
buffer_load_dwordx4 v[40:43], v236, s[20:23], s63 offen offset:1024 sc1
s_waitcnt vmcnt(0)
v_max_u16 v2, v36, v40
v_cmp_eq_u16 vcc, -1, v2
s_cbranch_vccnz L_st12
s_branch L_go12
L_sx12:
s_mov_b32 s40, 0
s_branch L_go12
L_st13:
s_sub_u32 s40, s40, 1
s_cbranch_scc1 L_sx13
buffer_load_dwordx4 v[44:47], v227, s[20:23], s64 offen offset:0 sc1
buffer_load_dwordx4 v[48:51], v227, s[20:23], s64 offen offset:256 sc1
s_waitcnt vmcnt(0)
v_max_u16 v2, v44, v48
v_cmp_eq_u16 vcc, -1, v2
s_cbranch_vccnz L_st13
s_branch L_go13
L_sx13:
s_mov_b32 s40, 0
s_branch L_go13
L_pad_14:
s_setpc_b64 s[100:101]
L_st14:
s_sub_u32 s40, s40, 1
s_cbranch_scc1 L_sx14
buffer_load_dwordx4 v[52:55], v227, s[20:23], s64 offen offset:512 sc1
buffer_load_dwordx4 v[56:59], v227, s[20:23], s64 offen offset:768 sc1
s_waitcnt vmcnt(0)
v_max_u16 v2, v52, v56
v_cmp_eq_u16 vcc, -1, v2
s_cbranch_vccnz L_st14
s_branch L_go14
L_sx14:
s_mov_b32 s40, 0
s_branch L_go14
L_st15:
s_sub_u32 s40, s40, 1
s_cbranch_scc1 L_sx15
buffer_load_dwordx4 v[60:63], v227, s[20:23], s64 offen offset:1024 sc1
s_waitcnt vmcnt(0)
v_cmp_eq_u16 vcc, -1, v60
s_cbranch_vccnz L_st15
s_branch L_go15
L_sx15:
s_mov_b32 s40, 0
s_branch L_go15
L_gl_9g:
buffer_store_dwordx4 v[32:35], v1, s[16:19], s3 offen sc1
s_branch L_gl_9b
L_e2r:
s_sub_u32 s40, s40, 1
s_cbranch_scc0 L_e2
s_mov_b32 s40, 0
s_branch L_e2go
L_pad_15:
s_setpc_b64 s[100:101]
L_h0:
s_setprio 2
v_lshrrev_b32 v1, 3, v0
v_and_b32 v2, 2, v1
v_xor_b32 v2, v2, v0
v_and_b32 v2, 7, v2
s_lshl_b32 s3, s36, 7
v_lshl_add_u32 v2, v2, 4, s3
v_mul_u32_u24 v3, 3840, v1
v_add_u32 v24, v3, v2
v_xor_b32 v27, 64, v24
v_add_u32 v27, 30720, v27
v_mov_b32 v55, 0
v_add_u32 v25, 256, v24
v_add_u32 v26, 512, v24
v_add_u32 v28, 256, v27
v_add_u32 v29, 512, v27
v_lshrrev_b32 v1, 4, v0
v_lshlrev_b32 v1, 3, v1
s_lshl_b32 s3, s36, 7
buffer_load_dwordx2 v[244:245], v1, s[28:31], s3 offen offset:0
buffer_load_dwordx2 v[246:247], v1, s[28:31], s3 offen offset:32
buffer_load_dwordx2 v[248:249], v1, s[28:31], s3 offen offset:64
buffer_load_dwordx2 v[250:251], v1, s[28:31], s3 offen offset:96
s_waitcnt vmcnt(0)
s_mov_b32 s3, 0x3f803f80
v_mov_b32 v64, s3
v_mov_b32 v65, s3
v_mov_b32 v66, s3
v_mov_b32 v67, s3
s_mov_b32 exec_lo, 0x11111111
s_mov_b32 exec_hi, 0x11111111
v_mov_b32 v244, s3
v_mov_b32 v245, s3
v_mov_b32 v246, s3
v_mov_b32 v247, s3
v_mov_b32 v248, s3
v_mov_b32 v249, s3
v_mov_b32 v250, s3
v_mov_b32 v251, s3
s_mov_b64 exec, -1
v_mfma_f32_16x16x32_bf16 v[252:255], v[244:247], v[64:67], 0
v_mfma_f32_16x16x32_bf16 v[252:255], v[248:251], v[64:67], v[252:255]
s_barrier
s_mov_b32 s42, 1
s_mov_b32 s65, 45056
L_wl:
s_add_u32 s69, s69, 1
s_cmp_eq_u32 s69, 10
s_cselect_b32 s69, 0, s69
s_add_u32 s61, s61, 36864
s_cmp_eq_u32 s61, 155648
s_cselect_b32 s61, 8192, s61
s_mul_i32 s63, s69, 245760
s_add_u32 m0, s61, 12288
s_nop 0
buffer_load_dwordx4 v24, s[8:11], s63 offen offset:0 lds
buffer_load_dwordx4 v25, s[8:11], s63 offen offset:1024 lds
buffer_load_dwordx4 v26, s[8:11], s63 offen offset:2048 lds
s_addk_i32 m0, 3072
s_nop 0
buffer_load_dwordx4 v27, s[8:11], s63 offen offset:0 lds
buffer_load_dwordx4 v28, s[8:11], s63 offen offset:1024 lds
buffer_load_dwordx4 v29, s[8:11], s63 offen offset:2048 lds
s_addk_i32 m0, 3072
s_add_u32 s63, s63, 61440
buffer_load_dwordx4 v24, s[8:11], s63 offen offset:0 lds
buffer_load_dwordx4 v25, s[8:11], s63 offen offset:1024 lds
buffer_load_dwordx4 v26, s[8:11], s63 offen offset:2048 lds
s_addk_i32 m0, 3072
s_nop 0
buffer_load_dwordx4 v27, s[8:11], s63 offen offset:0 lds
buffer_load_dwordx4 v28, s[8:11], s63 offen offset:1024 lds
buffer_load_dwordx4 v29, s[8:11], s63 offen offset:2048 lds
s_addk_i32 m0, 3072
s_add_u32 s63, s63, 61440
buffer_load_dwordx4 v24, s[8:11], s63 offen offset:0 lds
buffer_load_dwordx4 v25, s[8:11], s63 offen offset:1024 lds
buffer_load_dwordx4 v26, s[8:11], s63 offen offset:2048 lds
s_addk_i32 m0, 3072
s_nop 0
buffer_load_dwordx4 v27, s[8:11], s63 offen offset:0 lds
buffer_load_dwordx4 v28, s[8:11], s63 offen offset:1024 lds
buffer_load_dwordx4 v29, s[8:11], s63 offen offset:2048 lds
s_addk_i32 m0, 3072
s_add_u32 s63, s63, 61440
buffer_load_dwordx4 v24, s[8:11], s63 offen offset:0 lds
buffer_load_dwordx4 v25, s[8:11], s63 offen offset:1024 lds
buffer_load_dwordx4 v26, s[8:11], s63 offen offset:2048 lds
s_addk_i32 m0, 3072
s_nop 0
buffer_load_dwordx4 v27, s[8:11], s63 offen offset:0 lds
buffer_load_dwordx4 v28, s[8:11], s63 offen offset:1024 lds
buffer_load_dwordx4 v29, s[8:11], s63 offen offset:2048 lds
s_mov_b32 s0, s65
s_mov_b32 s65, s61
s_cmp_eq_u32 s57, s42
s_waitcnt vmcnt(24) lgkmcnt(0)
s_barrier
s_cbranch_scc0 L_wc
s_call_b64 s[100:101], L_xcap
L_wc:
s_add_u32 s42, s42, 1
s_cmp_lt_u32 s42, 9
s_cbranch_scc1 L_wl
s_branch L_h8
.p2align 12
L_pb_16:
L_cons:
s_cmp_eq_u32 s32, 0
s_cbranch_scc0 L_pa
s_mul_i32 s3, s2, 3456
v_lshlrev_b32 v1, 7, v0
s_mov_b64 exec, 0x7ffffff
buffer_load_dword v255, v1, s[12:15], s3 offen
s_mov_b64 exec, -1
L_pa:
s_cmp_eq_u32 s32, 1
s_cbranch_scc0 L_pb
s_lshl_b32 s3, s36, 2
s_add_u32 s3, s3, s33
s_sub_u32 s0, s3, 40
s_cselect_b32 s3, s3, s0
s_mul_i32 s3, s3, 61440
s_mul_i32 s0, s35, 1280
s_add_u32 s3, s3, s0
s_lshl_b32 s0, s36, 7
s_add_u32 s3, s3, s0
v_mul_u32_u24 v1, 3840, v0
s_mov_b64 exec, 0xffff
buffer_load_dword v255, v1, s[8:11], s3 offen
s_mov_b64 exec, -1
L_pb:
v_and_b32 v1, 15, v0
v_lshrrev_b32 v2, 4, v0
v_mov_b32 v7, 1792
s_mul_i32 s0, s44, 2304
s_movk_i32 s1, 144
v_bfe_u32 v3, v0, 2, 1
v_and_b32 v4, 3, v0
v_lshlrev_b32 v4, 1, v4
v_lshl_add_u32 v3, v3, 3, v4
v_bfe_u32 v4, v0, 3, 1
v_add_u32 v3, v3, v4
s_add_u32 s3, s0, 17408
v_mov_b32 v4, s3
v_mad_u32_u24 v3, v3, s1, v4
s_add_u32 s3, s0, 4736
v_mov_b32 v4, s3
v_mad_u32_u24 v4, v1, s1, v4
s_mov_b32 s52, 0xff00ff
s_mov_b32 s53, 0xff00ff
v_add_u32 v5, s51, v2
v_lshl_add_u32 v200, v5, 3, v3
v_lshl_add_u32 v5, v5, 3, v4
v_cndmask_b32 v204, v7, v5, s[52:53]
v_cndmask_b32 v205, v5, v7, s[52:53]
v_add_u32 v5, s46, v2
v_lshl_add_u32 v202, v5, 3, v3
v_lshl_add_u32 v5, v5, 3, v4
v_cmp_gt_u32 vcc, s47, v2
s_nop 1
v_cndmask_b32 v5, v7, v5, vcc
v_cndmask_b32 v206, v7, v5, s[52:53]
v_cndmask_b32 v207, v5, v7, s[52:53]
v_add_u32 v5, s48, v2
v_min_u32 v5, 15, v5
v_lshl_add_u32 v203, v5, 3, v3
v_lshl_add_u32 v5, v5, 3, v4
v_cmp_gt_u32 vcc, s49, v2
s_nop 1
v_cndmask_b32 v5, v7, v5, vcc
v_cndmask_b32 v208, v7, v5, s[52:53]
v_cndmask_b32 v209, v5, v7, s[52:53]
s_sub_u32 s3, s51, 1
v_mad_u32_u24 v5, v2, 5, s3
s_add_u32 s3, s46, 4
v_mov_b32 v6, s3
s_mov_b64 vcc, 0xffff
v_cndmask_b32 v5, v5, v6, vcc
v_min_u32 v5, 15, v5
v_lshl_add_u32 v201, v5, 3, v3
v_lshl_add_u32 v5, v5, 3, v4
s_cmp_eq_u32 s47, 5
s_cselect_b64 vcc, 0xff, 0
v_cndmask_b32 v210, v7, v5, vcc
s_lshl_b64 vcc, vcc, 8
v_cndmask_b32 v211, v7, v5, vcc
s_bfm_b64 vcc, 8, 16
v_cndmask_b32 v212, v7, v5, vcc
s_bfm_b64 vcc, 8, 24
v_cndmask_b32 v213, v7, v5, vcc
s_bfm_b64 vcc, 8, 32
v_cndmask_b32 v214, v7, v5, vcc
s_bfm_b64 vcc, 8, 40
v_cndmask_b32 v215, v7, v5, vcc
s_mul_i32 s0, s44, 2304
s_movk_i32 s1, 144
v_bfe_u32 v3, v0, 2, 3
v_lshrrev_b32 v4, 5, v0
v_lshl_add_u32 v3, v3, 1, v4
s_add_u32 s3, s0, 31232
v_mov_b32 v4, s3
v_mad_u32_u24 v3, v3, s1, v4
v_and_b32 v4, 3, v0
s_mov_b32 s54, 0x11111111
s_mov_b32 s55, 0x11111111
v_add_u32 v5, s51, v4
v_lshl_add_u32 v216, v5, 3, v3
v_add_u32 v7, 32, v216
s_cmp_eq_u32 s50, 1
s_cselect_b32 s3, -1, 12
s_cselect_b32 s56, 2, -1
v_add_u32 v5, s3, v4
v_lshl_add_u32 v5, v5, 3, v3
v_cndmask_b32 v217, v5, v7, s[54:55]
v_add_u32 v7, 40, v7
v_add_u32 v5, s56, v4
v_add_u32 v6, 10, v5
v_cmp_gt_i32 vcc, s51, v5
s_nop 1
v_cndmask_b32 v5, v6, v5, vcc
v_lshl_add_u32 v5, v5, 3, v3
v_cndmask_b32 v218, v5, v7, s[54:55]
s_lshl_b32 s0, s44, 8
v_lshrrev_b32 v4, 5, v0
v_and_or_b32 v3, v0, 8, v4
s_add_u32 s3, s0, 8
v_lshl_add_u32 v222, v3, 4, s3
v_and_b32 v1, 15, v0
s_add_u32 s3, s0, 132
v_lshl_add_u32 v223, v1, 4, s3
s_lshr_b32 s3, s39, 8
s_mul_i32 s3, s3, 52429
s_lshr_b32 s3, s3, 18
s_lshl_b32 s0, s44, 5
s_add_u32 s3, s3, s0
s_sub_u32 s3, 2047, s3
v_mad_i32_i24 v234, v1, -2, s3
v_lshrrev_b32 v2, 4, v0
v_and_or_b32 v3, v0, 8, v2
v_and_b32 v4, 0x70, v233
v_bfrev_b32 v6, 1
s_lshl_b32 s3, s44, 4
v_add_u32 v5, s3, v3
s_lshl_b32 s3, s60, 3
v_cmp_gt_u32 vcc, s3, v5
v_mul_u32_u24 v5, 2560, v5
v_add3_u32 v5, v5, v4, s39
v_cndmask_b32 v227, v6, v5, vcc
s_lshl_b32 s3, s36, 7
v_add_u32 v226, s3, v227
v_bfe_u32 v3, v0, 4, 1
v_cmp_eq_u32 s[54:55], s50, v3
s_cmp_lg_u32 s37, 0
s_cselect_b64 s[0:1], -1, s[54:55]
s_and_b64 vcc, vcc, s[0:1]
s_cmp_lg_u32 s37, 4
s_cselect_b64 s[0:1], 0, s[54:55]
s_andn2_b64 vcc, vcc, s[0:1]
v_cndmask_b32 v225, v6, v226, vcc
s_cmp_le_u32 s37, 3
s_cselect_b32 s3, 2560, 0
s_sub_u32 s3, s3, 128
v_mov_b32 v4, s3
s_cmp_ge_u32 s37, 2
s_cselect_b32 s3, 2560, 0
s_add_u32 s3, s3, 128
v_mov_b32 v5, s3
v_cndmask_b32 v4, v4, v5, s[54:55]
v_mul_u32_u24 v3, 2560, v3
v_sub_u32 v4, v4, v3
v_add_u32 v4, v4, v226
v_cndmask_b32 v224, v6, v4, vcc
v_and_b32 v1, 15, v0
v_bfrev_b32 v6, 1
v_bfe_u32 v3, v0, 4, 1
v_lshrrev_b32 v4, 5, v0
v_lshl_add_u32 v3, v3, 1, v4
s_lshl_b32 s3, s36, 7
v_lshl_add_u32 v4, v3, 4, s3
s_lshl_b32 s3, s44, 4
v_add_u32 v5, s3, v1
s_lshl_b32 s3, s60, 3
v_cmp_gt_u32 vcc, s3, v5
v_mul_u32_u24 v5, 2560, v5
v_add3_u32 v5, v5, v4, s39
v_cndmask_b32 v232, v6, v5, vcc
v_bfe_u32 v3, v0, 3, 2
v_lshlrev_b32 v3, 2, v3
v_and_or_b32 v3, v0, 3, v3
v_lshlrev_b32 v3, 3, v3
v_bfe_u32 v4, v0, 2, 2
v_lshl_add_u32 v3, v4, 7, v3
v_lshrrev_b32 v2, 4, v0
s_mov_b32 s44, 0x0
s_mov_b32 s45, 0x1010101
s_mov_b32 s46, 0x3030303
s_mov_b32 s47, 0x7070707
s_mov_b32 s48, 0xf0f0f0f
s_mov_b32 s49, 0x1f1f1f1f
s_mov_b32 s50, 0x3f3f3f3f
s_mov_b32 s51, 0x7f7f7f7f
s_movk_i32 s54, 10240
s_mov_b32 s55, 0x07060501
s_mov_b32 s56, 0x0706000c
v_mov_b32 v5, 0xffff
v_mov_b32 v6, 0xffff0000
v_cndmask_b32 v1, 0, v5, s[44:45]
v_cndmask_b32 v4, 0, v6, s[46:47]
v_or_b32 v220, v1, v4
v_cndmask_b32 v1, 0, v5, s[48:49]
v_cndmask_b32 v4, 0, v6, s[50:51]
v_or_b32 v221, v1, v4
s_lshl_b32 s3, s38, 5
v_xor_b32 v3, s3, v3
v_mul_u32_u24 v4, 3072, v2
v_add_u32 v3, v3, v4
v_add_u32 v244, 20480, v3
s_mov_b32 s42, 0
v_mov_b32 v3, 0
v_lshlrev_b32 v2, 2, v0
s_mov_b32 exec_hi, 0
ds_write_b32 v2, v3 offset:1728
ds_write_b32 v2, v3 offset:2880
s_mov_b64 exec, -1
v_and_b32 v1, 15, v0
v_lshrrev_b32 v2, 4, v0
v_lshrrev_b32 v3, 1, v1
v_xor_b32 v3, v3, v2
v_lshlrev_b32 v3, 4, v3
v_lshl_add_u32 v3, v1, 7, v3
v_add_u32 v245, 8192, v3
v_xor_b32 v246, 64, v245
v_mul_u32_u24 v3, 144, v1
v_lshl_add_u32 v3, v2, 3, v3
s_lshl_b32 s3, s38, 5
s_add_u32 s3, s3, 3584
v_add_u32 v247, s3, v3
v_lshlrev_b32 v248, 4, v1
s_cmp_eq_u32 s32, 0
s_cbranch_scc0 L_cw0
s_call_b64 s[100:101], L_pad_2
L_cw0:
s_cmp_eq_u32 s32, 1
s_cbranch_scc0 L_cw1
s_call_b64 s[100:101], L_pad_15
L_cw1:
s_cmp_eq_u32 s32, 2
s_cbranch_scc0 L_cw2
s_call_b64 s[100:101], L_pad_18
L_cw2:
s_cmp_eq_u32 s32, 3
s_cbranch_scc0 L_cw3
L_cw3:
s_cmp_eq_u32 s69, 9
s_cselect_b32 s3, -2457600, 0
s_add_u32 s3, s3, 245760
v_add_u32 v254, s3, v254
s_mul_i32 s3, s38, 3072
s_add_u32 m0, s3, 57344
s_mov_b32 s0, 122880
buffer_load_dwordx4 v254, s[8:11], 0 offen offset:0 lds
s_addk_i32 m0, -256
s_nop 0
buffer_load_dwordx4 v254, s[8:11], 0 offen offset:1280 lds
s_addk_i32 m0, -256
s_nop 0
buffer_load_dwordx4 v254, s[8:11], 0 offen offset:2560 lds
s_addk_i32 m0, 12800
s_nop 0
buffer_load_dwordx4 v254, s[8:11], s0 offen offset:0 lds
s_addk_i32 m0, -256
s_nop 0
buffer_load_dwordx4 v254, s[8:11], s0 offen offset:1280 lds
s_addk_i32 m0, -256
s_nop 0
buffer_load_dwordx4 v254, s[8:11], s0 offen offset:2560 lds
v_mov_b32 v4, -1
v_mov_b32 v5, -1
v_mov_b32 v6, -1
v_mov_b32 v7, -1
v_lshrrev_b32 v1, 3, v0
v_mul_u32_u24 v1, 2560, v1
v_and_b32 v2, 0x70, v233
s_lshl_b32 s3, s36, 7
s_add_u32 s3, s3, s39
v_add3_u32 v1, v1, v2, s3
s_mul_i32 s0, s38, 20480
s_add_u32 s1, s0, 81920
s_add_u32 s3, s38, 8
s_cmp_lt_u32 s3, s60
s_cselect_b32 s3, s1, 0x80000000
s_add_u32 s3, s3, 81920
buffer_store_dwordx4 v[4:7], v1, s[20:23], s0 offen
buffer_store_dwordx4 v[4:7], v1, s[20:23], s1 offen
buffer_store_dwordx4 v[4:7], v1, s[20:23], s3 offen
v_lshrrev_b32 v1, 4, v0
v_mul_u32_u24 v1, 2304, v1
v_add_u32 v1, v1, v233
s_mul_i32 s1, s43, 15360
s_lshl_b32 s3, s36, 8
s_add_u32 s1, s1, s3
s_and_b32 s3, s38, 1
s_mul_i32 s3, s3, 7680
s_add_u32 s1, s1, s3
s_add_u32 s1, s1, 2097152
s_cmp_lt_u32 s38, 2
s_cselect_b32 s1, s1, 0x80000000
s_mov_b32 exec_hi, 0xffff
buffer_store_dwordx4 v[4:7], v1, s[16:19], s1 offen
s_mov_b64 exec, -1
s_cmp_lt_u32 s32, 2
s_cselect_b32 s57, s57, 99
s_mov_b32 s65, 8192
s_min_u32 s62, s57, 32
s_waitcnt vmcnt(10) lgkmcnt(0)
s_barrier
ds_read_b64_tr_b16 v[156:157], v244 offset:1024
ds_read_b64_tr_b16 v[158:159], v244 offset:1536
ds_read_b128 v[80:83], v245 offset:0
ds_read_b128 v[84:87], v245 offset:2048
ds_read_b128 v[88:91], v245 offset:4096
ds_read_b128 v[92:95], v245 offset:6144
ds_read_b128 v[96:99], v245 offset:8192
ds_read_b128 v[100:103], v245 offset:10240
ds_read_b64_tr_b16 v[160:161], v244 offset:2048
ds_read_b64_tr_b16 v[162:163], v244 offset:2560
ds_read_b64_tr_b16 v[152:153], v244 offset:0
ds_read_b64_tr_b16 v[154:155], v244 offset:512
s_waitcnt lgkmcnt(4)
v_mfma_f32_16x16x32_bf16 v[32:35], v[156:159], v[80:83], 0
ds_read_b64_tr_b16 v[168:169], v244 offset:13312
v_mfma_f32_16x16x32_bf16 v[36:39], v[156:159], v[84:87], 0
ds_read_b64_tr_b16 v[170:171], v244 offset:13824
v_mfma_f32_16x16x32_bf16 v[40:43], v[156:159], v[88:91], 0
ds_read_b128 v[104:107], v246 offset:0
v_mfma_f32_16x16x32_bf16 v[44:47], v[156:159], v[92:95], 0
ds_read_b128 v[108:111], v246 offset:2048
v_mfma_f32_16x16x32_bf16 v[48:51], v[156:159], v[96:99], 0
ds_read_b128 v[112:115], v246 offset:4096
v_mfma_f32_16x16x32_bf16 v[52:55], v[156:159], v[100:103], 0
ds_read_b128 v[116:119], v246 offset:6144
s_waitcnt lgkmcnt(8)
v_mfma_f32_16x16x32_bf16 v[56:59], v[160:163], v[80:83], 0
ds_read_b128 v[120:123], v246 offset:8192
v_mfma_f32_16x16x32_bf16 v[60:63], v[160:163], v[84:87], 0
ds_read_b128 v[124:127], v246 offset:10240
v_mfma_f32_16x16x32_bf16 v[64:67], v[160:163], v[88:91], 0
ds_read_b64_tr_b16 v[172:173], v244 offset:14336
v_mfma_f32_16x16x32_bf16 v[68:71], v[160:163], v[92:95], 0
ds_read_b64_tr_b16 v[174:175], v244 offset:14848
v_mfma_f32_16x16x32_bf16 v[72:75], v[160:163], v[96:99], 0
ds_read_b64_tr_b16 v[164:165], v244 offset:12288
v_mfma_f32_16x16x32_bf16 v[76:79], v[160:163], v[100:103], 0
ds_read_b64_tr_b16 v[166:167], v244 offset:12800
s_waitcnt lgkmcnt(12)
v_mfma_f32_16x16x32_bf16 v[8:11], v[152:155], v[80:83], 0
s_add_u32 s3, s65, 36864
s_cmp_eq_u32 s3, 155648
v_mfma_f32_16x16x32_bf16 v[12:15], v[152:155], v[84:87], 0
s_cselect_b32 s3, 8192, s3
s_sub_u32 s63, s3, s65
v_mfma_f32_16x16x32_bf16 v[16:19], v[152:155], v[88:91], 0
s_mov_b32 s65, s3
v_add_u32 v245, s63, v245
v_mfma_f32_16x16x32_bf16 v[20:23], v[152:155], v[92:95], 0
v_add_u32 v244, s63, v244
v_add_u32 v246, s63, v246
v_mfma_f32_16x16x32_bf16 v[24:27], v[152:155], v[96:99], 0
v_mfma_f32_16x16x32_bf16 v[28:31], v[152:155], v[100:103], 0
s_add_u32 s42, s42, 1
s_cmp_lt_u32 s42, 9
s_waitcnt lgkmcnt(4)
v_mfma_f32_16x16x32_bf16 v[32:35], v[168:171], v[104:107], v[32:35]
v_mfma_f32_16x16x32_bf16 v[36:39], v[168:171], v[108:111], v[36:39]
v_mfma_f32_16x16x32_bf16 v[40:43], v[168:171], v[112:115], v[40:43]
v_mfma_f32_16x16x32_bf16 v[44:47], v[168:171], v[116:119], v[44:47]
v_mfma_f32_16x16x32_bf16 v[48:51], v[168:171], v[120:123], v[48:51]
v_mfma_f32_16x16x32_bf16 v[52:55], v[168:171], v[124:127], v[52:55]
s_waitcnt lgkmcnt(2)
v_mfma_f32_16x16x32_bf16 v[56:59], v[172:175], v[104:107], v[56:59]
v_mfma_f32_16x16x32_bf16 v[60:63], v[172:175], v[108:111], v[60:63]
v_mfma_f32_16x16x32_bf16 v[64:67], v[172:175], v[112:115], v[64:67]
v_mfma_f32_16x16x32_bf16 v[68:71], v[172:175], v[116:119], v[68:71]
v_mfma_f32_16x16x32_bf16 v[72:75], v[172:175], v[120:123], v[72:75]
s_waitcnt vmcnt(4) lgkmcnt(0)
v_mfma_f32_16x16x32_bf16 v[76:79], v[172:175], v[124:127], v[76:79]
s_branch L_pb_17
L_pad_21:
s_setpc_b64 s[100:101]
L_c23:
ds_read_b64 v[96:97], v202 offset:0
ds_read_b64 v[98:99], v202 offset:1152
ds_read_b64 v[116:117], v206 offset:0
ds_read_b64 v[118:119], v207 offset:0
ds_read_b64 v[100:101], v203 offset:0
ds_read_b64 v[102:103], v203 offset:1152
ds_read_b64 v[120:121], v208 offset:0
ds_read_b64 v[122:123], v209 offset:0
ds_read_b64 v[104:105], v201 offset:0
ds_read_b64 v[106:107], v201 offset:1152
ds_read_b64 v[124:125], v210 offset:0
ds_read_b64 v[126:127], v211 offset:0
s_add_u32 s0, s37, 1
s_sub_u32 s1, 5, s37
s_min_u32 s0, s0, s1
s_lshl_b32 s0, s0, 4
s_sub_u32 s1, 64, s0
s_cmp_le_u32 s37, 2
s_cselect_b32 s1, s1, 16
s_bfm_b64 s[100:101], s0, s1
s_waitcnt lgkmcnt(8)
v_mfma_f32_16x16x32_bf16 v[152:155], v[96:99], v[116:119], 0
s_waitcnt lgkmcnt(4)
v_mfma_f32_16x16x32_bf16 v[156:159], v[100:103], v[120:123], 0
s_waitcnt lgkmcnt(0)
v_mfma_f32_16x16x32_bf16 v[152:155], v[104:107], v[124:127], v[152:155]
v_add_u32 v1, 128, v222
v_cndmask_b32 v2, v1, v222, s[44:45]
ds_read_b64 v[168:169], v2 offset:0
v_cndmask_b32 v2, v1, v222, s[46:47]
ds_read_b64 v[170:171], v2 offset:32
v_cndmask_b32 v2, v1, v222, s[48:49]
ds_read_b64 v[172:173], v2 offset:64
v_cndmask_b32 v2, v1, v222, s[50:51]
ds_read_b64 v[174:175], v2 offset:96
ds_read_b32 v5, v223
v_permlane16_swap_b32 v152, v156
v_permlane16_swap_b32 v153, v157
v_permlane16_swap_b32 v154, v158
v_permlane16_swap_b32 v155, v159
v_cndmask_b32 v2, v156, v152, s[44:45]
v_cndmask_b32 v3, v157, v153, s[46:47]
v_cndmask_b32 v194, v158, v154, s[48:49]
v_cndmask_b32 v195, v159, v155, s[50:51]
v_or_b32 v192, 0xffff, v2
v_perm_b32 v193, v3, v2, s55
s_cmp_eq_u32 s41, 1
s_cbranch_scc0 L_gl_22g
buffer_store_dwordx4 v[192:195], v224, s[20:23], s54 offen
L_gl_22b:
ds_read_b64_tr_b16 v[72:73], v217 offset:0
ds_read_b64_tr_b16 v[74:75], v217 offset:1152
ds_read_b64_tr_b16 v[76:77], v218 offset:0
ds_read_b64_tr_b16 v[78:79], v218 offset:1152
v_mov_b32 v184, 0
v_mov_b32 v185, 0
v_mov_b32 v186, 0
v_mov_b32 v187, 0
v_mov_b32 v188, 0
v_mov_b32 v189, 0
v_mov_b32 v190, 0
v_mov_b32 v191, 0
s_waitcnt lgkmcnt(0)
v_mul_f32 v5, 0x3ea52b5c, v5
buffer_load_dwordx4 v[92:95], v225, s[20:23], s54 offen sc1
s_waitcnt vmcnt(0)
v_cmp_eq_u32 vcc, -1, v94
s_cbranch_vccnz L_h0rl
L_h0gl:
s_lshl_b32 s0, s32, 2
s_add_u32 s0, s0, 1744
v_mov_b32 v1, s0
ds_write_b32 v1, v1
v_perm_b32 v92, v92, v93, s56
v_add_f32 v193, v3, v93
v_add_f32 v194, v194, v94
v_add_f32 v195, v195, v95
v_add_f32 v192, v2, v92
v_fma_f32 v192, v192, v168, v169
v_fma_f32 v193, v193, v170, v171
v_fma_f32 v194, v194, v172, v173
v_fma_f32 v195, v195, v174, v175
v_max3_f32 v6, v192, v193, v194
v_max_f32 v6, v6, v195
v_mov_b32 v7, v6
s_nop 1
v_permlane32_swap_b32 v6, v7
v_max_f32 v6, v6, v7
v_mul_f32 v6, v6, v5
v_fma_f32 v192, v192, v5, -v6
v_fma_f32 v193, v193, v5, -v6
v_fma_f32 v194, v194, v5, -v6
v_fma_f32 v195, v195, v5, -v6
v_exp_f32 v192, v192
v_exp_f32 v193, v193
v_exp_f32 v194, v194
v_exp_f32 v195, v195
v_add_f32 v6, v192, v193
v_add_f32 v7, v194, v195
v_add_f32 v6, v6, v7
v_mov_b32 v7, v6
v_mul_f32 v192, v192, v168
v_mul_f32 v193, v193, v170
v_permlane32_swap_b32 v6, v7
v_mul_f32 v194, v194, v172
v_add_f32 v6, v6, v7
v_rcp_f32 v6, v6
v_mul_f32 v195, v195, v174
v_mul_f32 v192, v192, v6
v_mul_f32 v193, v193, v6
v_mul_f32 v194, v194, v6
v_mul_f32 v195, v195, v6
v_cvt_pk_bf16_f32 v192, v192, v193
v_cvt_pk_bf16_f32 v193, v194, v195
s_mov_b64 exec, s[52:53]
v_and_b32 v184, v220, v192
v_bfi_b32 v188, v220, 0, v192
v_and_b32 v185, v221, v193
v_bfi_b32 v189, v221, 0, v193
s_not_b64 exec, exec
v_and_b32 v186, v220, v192
v_bfi_b32 v190, v220, 0, v192
v_and_b32 v187, v221, v193
v_bfi_b32 v191, v221, 0, v193
s_mov_b64 exec, -1
v_permlane16_swap_b32 v184, v188
v_permlane16_swap_b32 v185, v189
v_permlane16_swap_b32 v186, v190
v_permlane16_swap_b32 v187, v191
s_nop 1
v_mfma_f32_16x16x32_bf16 v[152:155], v[72:75], v[184:187], 0
v_mfma_f32_16x16x32_bf16 v[156:159], v[76:79], v[184:187], 0
v_mfma_f32_16x16x32_bf16 v[160:163], v[76:79], v[188:191], 0
s_mov_b32 exec_lo, 0xffff0000
s_nop 4
v_cvt_pk_bf16_f32 v80, v152, v153
v_cvt_pk_bf16_f32 v81, v154, v155
v_cvt_pk_bf16_f32 v82, v156, v157
v_cvt_pk_bf16_f32 v83, v158, v159
s_mov_b64 exec, s[100:101]
v_cvt_pk_bf16_f32 v82, v160, v161
v_cvt_pk_bf16_f32 v83, v162, v163
s_mov_b32 exec_lo, 0xffff0000
s_mov_b32 exec_hi, 0xffffffff
s_cmp_eq_u32 s41, 1
s_cbranch_scc0 L_gl_23g
buffer_store_dwordx4 v[80:83], v226, s[20:23], s54 offen
L_gl_23b:
s_endpgm
L_gl_22g:
buffer_store_dwordx4 v[192:195], v224, s[20:23], s54 offen sc1
s_branch L_gl_22b
L_h0rl:
s_sub_u32 s40, s40, 1
s_cbranch_scc1 L_h0xl
buffer_load_dwordx4 v[92:95], v225, s[20:23], s54 offen sc1
s_waitcnt vmcnt(0)
v_cmp_eq_u32 vcc, -1, v94
s_cbranch_vccnz L_h0rl
s_branch L_h0gl
L_h0xl:
s_mov_b32 s40, 0
s_branch L_h0gl
L_gl_23g:
buffer_store_dwordx4 v[80:83], v226, s[20:23], s54 offen sc1
s_branch L_gl_23b
L_ev:
s_cmp_eq_u32 s42, 1
s_cbranch_scc0 L_ev1
s_waitcnt vmcnt(0)
L_ev1:
s_max_u32 s62, s57, 1
s_cmp_eq_u32 s42, s57
s_cbranch_scc0 L_evb
s_sub_u32 s0, s65, s63
v_add_u32 v1, s0, v235
ds_read_b64 v[236:237], v1
v_xor_b32 v2, 32, v1
ds_read_b64 v[238:239], v2
v_xor_b32 v3, 64, v1
ds_read_b64 v[240:241], v3
v_xor_b32 v4, 96, v1
ds_read_b64 v[242:243], v4
s_branch L_evb
L_gs:
v_mov_b32 v4, -1
v_mov_b32 v5, -1
v_mov_b32 v6, -1
v_mov_b32 v7, -1
v_lshrrev_b32 v1, 3, v0
v_mul_u32_u24 v1, 2560, v1
v_and_b32 v2, 0x70, v233
s_lshl_b32 s3, s36, 7
s_add_u32 s3, s3, s39
v_add3_u32 v1, v1, v2, s3
s_mul_i32 s0, s38, 20480
s_add_u32 s1, s0, 81920
s_add_u32 s3, s38, 8
s_cmp_lt_u32 s3, s60
s_cselect_b32 s3, s1, 0x80000000
s_add_u32 s3, s3, 81920
buffer_store_dwordx4 v[4:7], v1, s[20:23], s0 offen sc1
buffer_store_dwordx4 v[4:7], v1, s[20:23], s1 offen sc1
buffer_store_dwordx4 v[4:7], v1, s[20:23], s3 offen sc1
v_lshrrev_b32 v1, 4, v0
v_mul_u32_u24 v1, 2304, v1
v_add_u32 v1, v1, v233
s_mul_i32 s1, s43, 15360
s_lshl_b32 s3, s36, 8
s_add_u32 s1, s1, s3
s_and_b32 s3, s38, 1
s_mul_i32 s3, s3, 7680
s_add_u32 s1, s1, s3
s_add_u32 s1, s1, 2097152
s_cmp_lt_u32 s38, 2
s_cselect_b32 s1, s1, 0x80000000
s_mov_b32 exec_hi, 0xffff
buffer_store_dwordx4 v[4:7], v1, s[16:19], s1 offen sc1
s_mov_b64 exec, -1
s_waitcnt vmcnt(0)
s_barrier
s_barrier
s_branch L_gsb
.p2align 12
L_pad_18:
s_setpc_b64 s[100:101]
L_pb_17:
L_cloop:
s_barrier
ds_read_b64_tr_b16 v[156:157], v244 offset:1024
ds_read_b64_tr_b16 v[158:159], v244 offset:1536
v_mfma_f32_16x16x32_bf16 v[8:11], v[164:167], v[104:107], v[8:11]
ds_read_b128 v[80:83], v245 offset:0
v_mfma_f32_16x16x32_bf16 v[12:15], v[164:167], v[108:111], v[12:15]
ds_read_b128 v[84:87], v245 offset:2048
v_mfma_f32_16x16x32_bf16 v[16:19], v[164:167], v[112:115], v[16:19]
ds_read_b128 v[88:91], v245 offset:4096
v_mfma_f32_16x16x32_bf16 v[20:23], v[164:167], v[116:119], v[20:23]
ds_read_b128 v[92:95], v245 offset:6144
v_mfma_f32_16x16x32_bf16 v[24:27], v[164:167], v[120:123], v[24:27]
ds_read_b128 v[96:99], v245 offset:8192
v_mfma_f32_16x16x32_bf16 v[28:31], v[164:167], v[124:127], v[28:31]
ds_read_b128 v[100:103], v245 offset:10240
s_waitcnt lgkmcnt(5)
v_mfma_f32_16x16x32_bf16 v[32:35], v[156:159], v[80:83], v[32:35]
ds_read_b64_tr_b16 v[160:161], v244 offset:2048
s_waitcnt lgkmcnt(5)
v_mfma_f32_16x16x32_bf16 v[36:39], v[156:159], v[84:87], v[36:39]
ds_read_b64_tr_b16 v[162:163], v244 offset:2560
s_waitcnt lgkmcnt(5)
v_mfma_f32_16x16x32_bf16 v[40:43], v[156:159], v[88:91], v[40:43]
ds_read_b64_tr_b16 v[152:153], v244 offset:0
s_waitcnt lgkmcnt(5)
v_mfma_f32_16x16x32_bf16 v[44:47], v[156:159], v[92:95], v[44:47]
ds_read_b64_tr_b16 v[154:155], v244 offset:512
s_waitcnt lgkmcnt(5)
v_mfma_f32_16x16x32_bf16 v[48:51], v[156:159], v[96:99], v[48:51]
ds_read_b64_tr_b16 v[168:169], v244 offset:13312
s_waitcnt lgkmcnt(5)
v_mfma_f32_16x16x32_bf16 v[52:55], v[156:159], v[100:103], v[52:55]
ds_read_b64_tr_b16 v[170:171], v244 offset:13824
s_waitcnt lgkmcnt(4)
v_mfma_f32_16x16x32_bf16 v[56:59], v[160:163], v[80:83], v[56:59]
ds_read_b128 v[104:107], v246 offset:0
v_mfma_f32_16x16x32_bf16 v[60:63], v[160:163], v[84:87], v[60:63]
ds_read_b128 v[108:111], v246 offset:2048
v_mfma_f32_16x16x32_bf16 v[64:67], v[160:163], v[88:91], v[64:67]
ds_read_b128 v[112:115], v246 offset:4096
v_mfma_f32_16x16x32_bf16 v[68:71], v[160:163], v[92:95], v[68:71]
ds_read_b128 v[116:119], v246 offset:6144
v_mfma_f32_16x16x32_bf16 v[72:75], v[160:163], v[96:99], v[72:75]
ds_read_b128 v[120:123], v246 offset:8192
v_mfma_f32_16x16x32_bf16 v[76:79], v[160:163], v[100:103], v[76:79]
ds_read_b128 v[124:127], v246 offset:10240
s_waitcnt lgkmcnt(8)
v_mfma_f32_16x16x32_bf16 v[8:11], v[152:155], v[80:83], v[8:11]
ds_read_b64_tr_b16 v[172:173], v244 offset:14336
v_mfma_f32_16x16x32_bf16 v[12:15], v[152:155], v[84:87], v[12:15]
ds_read_b64_tr_b16 v[174:175], v244 offset:14848
v_mfma_f32_16x16x32_bf16 v[16:19], v[152:155], v[88:91], v[16:19]
ds_read_b64_tr_b16 v[164:165], v244 offset:12288
v_mfma_f32_16x16x32_bf16 v[20:23], v[152:155], v[92:95], v[20:23]
ds_read_b64_tr_b16 v[166:167], v244 offset:12800
v_mfma_f32_16x16x32_bf16 v[24:27], v[152:155], v[96:99], v[24:27]
s_add_u32 s3, s65, 36864
s_cmp_eq_u32 s3, 155648
v_mfma_f32_16x16x32_bf16 v[28:31], v[152:155], v[100:103], v[28:31]
s_cselect_b32 s3, 8192, s3
s_sub_u32 s63, s3, s65
s_waitcnt lgkmcnt(4)
v_mfma_f32_16x16x32_bf16 v[32:35], v[168:171], v[104:107], v[32:35]
s_mov_b32 s65, s3
v_add_u32 v245, s63, v245
v_mfma_f32_16x16x32_bf16 v[36:39], v[168:171], v[108:111], v[36:39]
v_add_u32 v244, s63, v244
v_add_u32 v246, s63, v246
v_mfma_f32_16x16x32_bf16 v[40:43], v[168:171], v[112:115], v[40:43]
s_cmp_eq_u32 s42, s62
s_cbranch_scc1 L_ev
L_evb:
v_mfma_f32_16x16x32_bf16 v[44:47], v[168:171], v[116:119], v[44:47]
v_mfma_f32_16x16x32_bf16 v[48:51], v[168:171], v[120:123], v[48:51]
s_add_u32 s42, s42, 1
s_cmp_lt_u32 s42, 9
v_mfma_f32_16x16x32_bf16 v[52:55], v[168:171], v[124:127], v[52:55]
s_waitcnt lgkmcnt(2)
v_mfma_f32_16x16x32_bf16 v[56:59], v[172:175], v[104:107], v[56:59]
v_mfma_f32_16x16x32_bf16 v[60:63], v[172:175], v[108:111], v[60:63]
v_mfma_f32_16x16x32_bf16 v[64:67], v[172:175], v[112:115], v[64:67]
v_mfma_f32_16x16x32_bf16 v[68:71], v[172:175], v[116:119], v[68:71]
v_mfma_f32_16x16x32_bf16 v[72:75], v[172:175], v[120:123], v[72:75]
s_waitcnt lgkmcnt(0)
v_mfma_f32_16x16x32_bf16 v[76:79], v[172:175], v[124:127], v[76:79]
s_cbranch_scc1 L_cloop
v_mov_b32 v1, 1728
ds_read_b32 v1, v1
ds_read2_b64 v[180:183], v248 offset0:0 offset1:32
ds_read2_b64 v[184:187], v248 offset0:64 offset1:96
ds_read2_b64 v[188:191], v248 offset0:128 offset1:160
s_waitcnt lgkmcnt(0)
v_readfirstlane_b32 s41, v1
s_barrier
s_cmp_eq_u32 s41, 1
s_cbranch_scc0 L_gs
L_gsb:
ds_read_b64_tr_b16 v[156:157], v244 offset:1024
ds_read_b64_tr_b16 v[158:159], v244 offset:1536
v_mfma_f32_16x16x32_bf16 v[8:11], v[164:167], v[104:107], v[8:11]
ds_read_b128 v[80:83], v245 offset:0
v_mfma_f32_16x16x32_bf16 v[12:15], v[164:167], v[108:111], v[12:15]
ds_read_b128 v[84:87], v245 offset:2048
v_mfma_f32_16x16x32_bf16 v[16:19], v[164:167], v[112:115], v[16:19]
ds_read_b128 v[88:91], v245 offset:4096
v_mfma_f32_16x16x32_bf16 v[20:23], v[164:167], v[116:119], v[20:23]
ds_read_b128 v[92:95], v245 offset:6144
v_mfma_f32_16x16x32_bf16 v[24:27], v[164:167], v[120:123], v[24:27]
ds_read_b128 v[96:99], v245 offset:8192
v_mfma_f32_16x16x32_bf16 v[28:31], v[164:167], v[124:127], v[28:31]
ds_read_b128 v[100:103], v245 offset:10240
ds_read_b64_tr_b16 v[176:177], v244 offset:13312
ds_read_b64_tr_b16 v[178:179], v244 offset:13824
s_waitcnt lgkmcnt(7)
v_mfma_f32_16x16x32_bf16 v[32:35], v[156:159], v[80:83], v[32:35]
ds_read_b128 v[128:131], v246 offset:0
s_waitcnt lgkmcnt(7)
v_mfma_f32_16x16x32_bf16 v[36:39], v[156:159], v[84:87], v[36:39]
ds_read_b128 v[132:135], v246 offset:2048
s_waitcnt lgkmcnt(7)
v_mfma_f32_16x16x32_bf16 v[40:43], v[156:159], v[88:91], v[40:43]
ds_read_b128 v[136:139], v246 offset:4096
s_waitcnt lgkmcnt(7)
v_mfma_f32_16x16x32_bf16 v[44:47], v[156:159], v[92:95], v[44:47]
ds_read_b128 v[140:143], v246 offset:6144
s_waitcnt lgkmcnt(7)
v_mfma_f32_16x16x32_bf16 v[48:51], v[156:159], v[96:99], v[48:51]
ds_read_b128 v[144:147], v246 offset:8192
s_waitcnt lgkmcnt(7)
v_mfma_f32_16x16x32_bf16 v[52:55], v[156:159], v[100:103], v[52:55]
ds_read_b128 v[148:151], v246 offset:10240
s_waitcnt lgkmcnt(5)
v_mfma_f32_16x16x32_bf16 v[32:35], v[176:179], v[128:131], v[32:35]
ds_read_b64_tr_b16 v[160:161], v244 offset:2048
s_waitcnt lgkmcnt(5)
v_mfma_f32_16x16x32_bf16 v[36:39], v[176:179], v[132:135], v[36:39]
ds_read_b64_tr_b16 v[162:163], v244 offset:2560
s_waitcnt lgkmcnt(5)
v_mfma_f32_16x16x32_bf16 v[40:43], v[176:179], v[136:139], v[40:43]
ds_read_b64_tr_b16 v[152:153], v244 offset:0
s_waitcnt lgkmcnt(5)
v_mfma_f32_16x16x32_bf16 v[44:47], v[176:179], v[140:143], v[44:47]
ds_read_b64_tr_b16 v[154:155], v244 offset:512
s_waitcnt lgkmcnt(5)
v_mfma_f32_16x16x32_bf16 v[48:51], v[176:179], v[144:147], v[48:51]
ds_read_b64_tr_b16 v[172:173], v244 offset:14336
s_waitcnt lgkmcnt(5)
v_mfma_f32_16x16x32_bf16 v[52:55], v[176:179], v[148:151], v[52:55]
ds_read_b64_tr_b16 v[174:175], v244 offset:14848
s_waitcnt lgkmcnt(4)
v_mfma_f32_16x16x32_bf16 v[56:59], v[160:163], v[80:83], v[56:59]
ds_read_b64_tr_b16 v[164:165], v244 offset:12288
ds_read_b64_tr_b16 v[166:167], v244 offset:12800
v_mov_b32_dpp v192, v32 row_newbcast:0 row_mask:0xf bank_mask:0xf
v_mov_b32_dpp v193, v33 row_newbcast:0 row_mask:0xf bank_mask:0xf
v_mov_b32_dpp v194, v34 row_newbcast:0 row_mask:0xf bank_mask:0xf
v_mov_b32_dpp v195, v35 row_newbcast:0 row_mask:0xf bank_mask:0xf
v_fmac_f32 v32, v192, v180
v_fmac_f32 v33, v193, v180
v_fmac_f32 v34, v194, v180
v_mfma_f32_16x16x32_bf16 v[60:63], v[160:163], v[84:87], v[60:63]
v_fmac_f32 v35, v195, v180
v_cvt_pk_bf16_f32 v32, v32, v33
v_cvt_pk_bf16_f32 v33, v34, v35
v_mfma_f32_16x16x32_bf16 v[64:67], v[160:163], v[88:91], v[64:67]
ds_write_b64 v247, v[32:33] offset:13824
v_fmac_f32 v36, v192, v182
v_fmac_f32 v37, v193, v182
v_fmac_f32 v38, v194, v182
v_mfma_f32_16x16x32_bf16 v[68:71], v[160:163], v[92:95], v[68:71]
v_fmac_f32 v39, v195, v182
v_cvt_pk_bf16_f32 v36, v36, v37
v_cvt_pk_bf16_f32 v37, v38, v39
v_mfma_f32_16x16x32_bf16 v[72:75], v[160:163], v[96:99], v[72:75]
ds_write_b64 v247, v[36:37] offset:16128
v_fmac_f32 v40, v192, v184
v_fmac_f32 v41, v193, v184
v_fmac_f32 v42, v194, v184
v_mfma_f32_16x16x32_bf16 v[76:79], v[160:163], v[100:103], v[76:79]
v_fmac_f32 v43, v195, v184
v_cvt_pk_bf16_f32 v40, v40, v41
v_cvt_pk_bf16_f32 v41, v42, v43
s_waitcnt lgkmcnt(4)
v_mfma_f32_16x16x32_bf16 v[56:59], v[172:175], v[128:131], v[56:59]
ds_write_b64 v247, v[40:41] offset:18432
v_fmac_f32 v44, v192, v186
v_fmac_f32 v45, v193, v186
v_fmac_f32 v46, v194, v186
v_mfma_f32_16x16x32_bf16 v[60:63], v[172:175], v[132:135], v[60:63]
v_fmac_f32 v47, v195, v186
v_cvt_pk_bf16_f32 v44, v44, v45
v_cvt_pk_bf16_f32 v45, v46, v47
v_mfma_f32_16x16x32_bf16 v[64:67], v[172:175], v[136:139], v[64:67]
ds_write_b64 v247, v[44:45] offset:20736
v_fmac_f32 v48, v192, v188
v_fmac_f32 v49, v193, v188
v_fmac_f32 v50, v194, v188
v_mfma_f32_16x16x32_bf16 v[68:71], v[172:175], v[140:143], v[68:71]
v_fmac_f32 v51, v195, v188
v_cvt_pk_bf16_f32 v48, v48, v49
v_cvt_pk_bf16_f32 v49, v50, v51
v_mfma_f32_16x16x32_bf16 v[72:75], v[172:175], v[144:147], v[72:75]
ds_write_b64 v247, v[48:49] offset:23040
v_fmac_f32 v52, v192, v190
v_fmac_f32 v53, v193, v190
v_fmac_f32 v54, v194, v190
v_mfma_f32_16x16x32_bf16 v[76:79], v[172:175], v[148:151], v[76:79]
v_fmac_f32 v55, v195, v190
v_cvt_pk_bf16_f32 v52, v52, v53
v_cvt_pk_bf16_f32 v53, v54, v55
ds_write_b64 v247, v[52:53] offset:25344
v_mfma_f32_16x16x32_bf16 v[8:11], v[152:155], v[80:83], v[8:11]
v_mov_b32_dpp v192, v56 row_newbcast:0 row_mask:0xf bank_mask:0xf
v_mov_b32_dpp v193, v57 row_newbcast:0 row_mask:0xf bank_mask:0xf
v_mov_b32_dpp v194, v58 row_newbcast:0 row_mask:0xf bank_mask:0xf
v_mov_b32_dpp v195, v59 row_newbcast:0 row_mask:0xf bank_mask:0xf
v_fmac_f32 v56, v192, v180
v_fmac_f32 v57, v193, v180
v_fmac_f32 v58, v194, v180
v_mfma_f32_16x16x32_bf16 v[12:15], v[152:155], v[84:87], v[12:15]
v_fmac_f32 v59, v195, v180
v_cvt_pk_bf16_f32 v56, v56, v57
v_cvt_pk_bf16_f32 v57, v58, v59
v_mfma_f32_16x16x32_bf16 v[16:19], v[152:155], v[88:91], v[16:19]
s_waitcnt lgkmcnt(0)
s_barrier
ds_write_b64 v247, v[56:57] offset:27648
v_fmac_f32 v60, v192, v182
v_fmac_f32 v61, v193, v182
v_fmac_f32 v62, v194, v182
v_mfma_f32_16x16x32_bf16 v[20:23], v[152:155], v[92:95], v[20:23]
v_fmac_f32 v63, v195, v182
v_cvt_pk_bf16_f32 v60, v60, v61
v_cvt_pk_bf16_f32 v61, v62, v63
v_mfma_f32_16x16x32_bf16 v[24:27], v[152:155], v[96:99], v[24:27]
ds_write_b64 v247, v[60:61] offset:29952
v_fmac_f32 v64, v192, v184
v_fmac_f32 v65, v193, v184
v_fmac_f32 v66, v194, v184
v_mfma_f32_16x16x32_bf16 v[28:31], v[152:155], v[100:103], v[28:31]
v_fmac_f32 v67, v195, v184
v_cvt_pk_bf16_f32 v64, v64, v65
v_cvt_pk_bf16_f32 v65, v66, v67
v_mfma_f32_16x16x32_bf16 v[8:11], v[164:167], v[128:131], v[8:11]
ds_write_b64 v247, v[64:65] offset:32256
v_fmac_f32 v68, v192, v186
v_fmac_f32 v69, v193, v186
v_fmac_f32 v70, v194, v186
v_mfma_f32_16x16x32_bf16 v[12:15], v[164:167], v[132:135], v[12:15]
v_fmac_f32 v71, v195, v186
v_cvt_pk_bf16_f32 v68, v68, v69
v_cvt_pk_bf16_f32 v69, v70, v71
v_mfma_f32_16x16x32_bf16 v[16:19], v[164:167], v[136:139], v[16:19]
ds_write_b64 v247, v[68:69] offset:34560
v_fmac_f32 v72, v192, v188
v_fmac_f32 v73, v193, v188
v_fmac_f32 v74, v194, v188
v_mfma_f32_16x16x32_bf16 v[20:23], v[164:167], v[140:143], v[20:23]
v_fmac_f32 v75, v195, v188
v_cvt_pk_bf16_f32 v72, v72, v73
v_cvt_pk_bf16_f32 v73, v74, v75
v_mfma_f32_16x16x32_bf16 v[24:27], v[164:167], v[144:147], v[24:27]
ds_write_b64 v247, v[72:73] offset:36864
v_fmac_f32 v76, v192, v190
v_fmac_f32 v77, v193, v190
v_fmac_f32 v78, v194, v190
v_mfma_f32_16x16x32_bf16 v[28:31], v[164:167], v[148:151], v[28:31]
v_fmac_f32 v79, v195, v190
v_cvt_pk_bf16_f32 v76, v76, v77
v_cvt_pk_bf16_f32 v77, v78, v79
ds_write_b64 v247, v[76:77] offset:39168
v_mov_b32_dpp v192, v8 row_newbcast:0 row_mask:0xf bank_mask:0xf
v_mov_b32_dpp v193, v9 row_newbcast:0 row_mask:0xf bank_mask:0xf
v_mov_b32_dpp v194, v10 row_newbcast:0 row_mask:0xf bank_mask:0xf
v_mov_b32_dpp v195, v11 row_newbcast:0 row_mask:0xf bank_mask:0xf
v_pk_fma_f32 v[8:9], v[192:193], v[180:181], v[8:9] op_sel_hi:[1,0,1]
v_pk_fma_f32 v[10:11], v[194:195], v[180:181], v[10:11] op_sel_hi:[1,0,1]
v_cvt_pk_bf16_f32 v8, v8, v9
v_cvt_pk_bf16_f32 v9, v10, v11
ds_write_b64 v247, v[8:9] offset:0
v_pk_fma_f32 v[12:13], v[192:193], v[182:183], v[12:13] op_sel_hi:[1,0,1]
v_pk_fma_f32 v[14:15], v[194:195], v[182:183], v[14:15] op_sel_hi:[1,0,1]
v_cvt_pk_bf16_f32 v12, v12, v13
v_cvt_pk_bf16_f32 v13, v14, v15
ds_write_b64 v247, v[12:13] offset:2304
v_pk_fma_f32 v[16:17], v[192:193], v[184:185], v[16:17] op_sel_hi:[1,0,1]
v_pk_fma_f32 v[18:19], v[194:195], v[184:185], v[18:19] op_sel_hi:[1,0,1]
v_cvt_pk_bf16_f32 v16, v16, v17
v_cvt_pk_bf16_f32 v17, v18, v19
ds_write_b64 v247, v[16:17] offset:4608
v_pk_fma_f32 v[20:21], v[192:193], v[186:187], v[20:21] op_sel_hi:[1,0,1]
v_pk_fma_f32 v[22:23], v[194:195], v[186:187], v[22:23] op_sel_hi:[1,0,1]
v_cvt_pk_bf16_f32 v20, v20, v21
v_cvt_pk_bf16_f32 v21, v22, v23
ds_write_b64 v247, v[20:21] offset:6912
v_pk_fma_f32 v[24:25], v[192:193], v[188:189], v[24:25] op_sel_hi:[1,0,1]
v_pk_fma_f32 v[26:27], v[194:195], v[188:189], v[26:27] op_sel_hi:[1,0,1]
v_cvt_pk_bf16_f32 v24, v24, v25
v_cvt_pk_bf16_f32 v25, v26, v27
ds_write_b64 v247, v[24:25] offset:9216
v_pk_fma_f32 v[28:29], v[192:193], v[190:191], v[28:29] op_sel_hi:[1,0,1]
v_pk_fma_f32 v[30:31], v[194:195], v[190:191], v[30:31] op_sel_hi:[1,0,1]
v_cvt_pk_bf16_f32 v28, v28, v29
v_cvt_pk_bf16_f32 v29, v30, v31
ds_write_b64 v247, v[28:29] offset:11520
s_waitcnt lgkmcnt(0)
s_barrier
s_cmp_lt_u32 s32, 2
s_cbranch_scc0 L_c23
ds_read_b64 v[108:109], v200 offset:0
ds_read_b64 v[110:111], v200 offset:1152
ds_read_b64 v[128:129], v204 offset:0
ds_read_b64 v[130:131], v205 offset:0
ds_read_b64 v[112:113], v200 offset:40
ds_read_b64 v[114:115], v200 offset:1192
ds_read_b64 v[132:133], v204 offset:40
ds_read_b64 v[134:135], v205 offset:40
ds_read_b64 v[104:105], v201 offset:0
ds_read_b64 v[106:107], v201 offset:1152
ds_read_b64 v[136:137], v212 offset:0
ds_read_b64 v[138:139], v213 offset:0
ds_read_b64 v[140:141], v214 offset:0
ds_read_b64 v[142:143], v215 offset:0
v_mov_b32 v176, 0
v_mov_b32 v177, 0
v_mov_b32 v178, 0
v_mov_b32 v179, 0
v_mov_b32 v180, 0
v_mov_b32 v181, 0
v_mov_b32 v182, 0
v_mov_b32 v183, 0
s_waitcnt lgkmcnt(10)
v_mfma_f32_16x16x32_bf16 v[160:163], v[108:111], v[128:131], 0
s_waitcnt lgkmcnt(6)
v_mfma_f32_16x16x32_bf16 v[164:167], v[112:115], v[132:135], 0
v_add_u32 v1, 128, v222
v_cndmask_b32 v2, v1, v222, s[44:45]
ds_read_b64 v[168:169], v2 offset:0
v_cndmask_b32 v2, v1, v222, s[46:47]
ds_read_b64 v[170:171], v2 offset:32
v_cndmask_b32 v2, v1, v222, s[48:49]
ds_read_b64 v[172:173], v2 offset:64
v_cndmask_b32 v2, v1, v222, s[50:51]
ds_read_b64 v[174:175], v2 offset:96
ds_read_b32 v5, v223
s_waitcnt lgkmcnt(7)
v_mfma_f32_16x16x32_bf16 v[160:163], v[104:107], v[136:139], v[160:163]
s_waitcnt lgkmcnt(5)
v_mfma_f32_16x16x32_bf16 v[164:167], v[104:107], v[140:143], v[164:167]
s_nop 7
v_permlane16_swap_b32 v160, v164
v_permlane16_swap_b32 v161, v165
v_permlane16_swap_b32 v162, v166
v_permlane16_swap_b32 v163, v167
v_cndmask_b32 v196, v164, v160, s[44:45]
v_cndmask_b32 v197, v165, v161, s[46:47]
v_cndmask_b32 v198, v166, v162, s[48:49]
v_cndmask_b32 v199, v167, v163, s[50:51]
s_waitcnt lgkmcnt(0)
v_mul_f32 v5, 0x3ea52b5c, v5
v_fma_f32 v196, v196, v168, v169
v_fma_f32 v197, v197, v170, v171
v_fma_f32 v198, v198, v172, v173
v_fma_f32 v199, v199, v174, v175
v_max3_f32 v6, v196, v197, v198
v_max_f32 v6, v6, v199
v_mov_b32 v7, v6
s_nop 1
v_permlane32_swap_b32 v6, v7
v_max_f32 v6, v6, v7
v_mul_f32 v6, v6, v5
v_fma_f32 v196, v196, v5, -v6
v_fma_f32 v197, v197, v5, -v6
v_fma_f32 v198, v198, v5, -v6
v_fma_f32 v199, v199, v5, -v6
v_exp_f32 v196, v196
v_exp_f32 v197, v197
v_exp_f32 v198, v198
v_exp_f32 v199, v199
ds_read_b64_tr_b16 v[64:65], v216 offset:0
ds_read_b64_tr_b16 v[66:67], v216 offset:1152
ds_read_b64_tr_b16 v[68:69], v216 offset:40
ds_read_b64_tr_b16 v[70:71], v216 offset:1192
ds_read_b64_tr_b16 v[72:73], v217 offset:0
ds_read_b64_tr_b16 v[74:75], v217 offset:1152
ds_read_b64_tr_b16 v[76:77], v218 offset:0
ds_read_b64_tr_b16 v[78:79], v218 offset:1152
v_add_f32 v6, v196, v197
v_add_f32 v7, v198, v199
v_add_f32 v6, v6, v7
v_mov_b32 v7, v6
v_mul_f32 v196, v196, v168
v_mul_f32 v197, v197, v170
v_permlane32_swap_b32 v6, v7
v_mul_f32 v198, v198, v172
v_add_f32 v6, v6, v7
v_rcp_f32 v6, v6
v_mul_f32 v199, v199, v174
v_mul_f32 v196, v196, v6
v_mul_f32 v197, v197, v6
v_mul_f32 v198, v198, v6
v_mul_f32 v199, v199, v6
v_cvt_pk_bf16_f32 v196, v196, v197
v_cvt_pk_bf16_f32 v197, v198, v199
s_mov_b64 exec, s[52:53]
v_and_b32 v176, v220, v196
v_bfi_b32 v180, v220, 0, v196
v_and_b32 v177, v221, v197
v_bfi_b32 v181, v221, 0, v197
s_not_b64 exec, exec
v_and_b32 v178, v220, v196
v_bfi_b32 v182, v220, 0, v196
v_and_b32 v179, v221, v197
v_bfi_b32 v183, v221, 0, v197
s_mov_b64 exec, -1
v_permlane16_swap_b32 v176, v180
v_permlane16_swap_b32 v177, v181
v_permlane16_swap_b32 v178, v182
v_permlane16_swap_b32 v179, v183
s_waitcnt lgkmcnt(0)
s_nop 0
v_mfma_f32_16x16x32_bf16 v[152:155], v[64:67], v[176:179], 0
v_mfma_f32_16x16x32_bf16 v[156:159], v[68:71], v[180:183], 0
v_mfma_f32_16x16x32_bf16 v[160:163], v[72:75], v[176:179], 0
v_mfma_f32_16x16x32_bf16 v[164:167], v[76:79], v[180:183], 0
s_nop 4
v_cvt_pk_bf16_f32 v196, v152, v153
v_cvt_pk_bf16_f32 v197, v154, v155
v_cvt_pk_bf16_f32 v198, v156, v157
v_cvt_pk_bf16_f32 v199, v158, v159
s_cmp_eq_u32 s41, 1
s_cbranch_scc0 L_gl_19g
buffer_store_dwordx4 v[196:199], v226, s[20:23], 0 offen
L_gl_19b:
s_lshl_b32 s0, s32, 2
s_add_u32 s0, s0, 1752
v_mov_b32 v1, s0
ds_read_b32 v1, v1
v_cvt_pk_bf16_f32 v80, v160, v161
v_cvt_pk_bf16_f32 v81, v162, v163
v_cvt_pk_bf16_f32 v82, v164, v165
v_cvt_pk_bf16_f32 v83, v166, v167
s_waitcnt lgkmcnt(0)
v_cmp_eq_u32 vcc, 0, v1
s_cbranch_vccnz L_spr
L_sbr:
s_mov_b64 exec, 0xffff
s_cmp_eq_u32 s41, 1
s_cbranch_scc0 L_gl_20g
buffer_store_dwordx4 v[80:83], v226, s[20:23], s54 offen
L_gl_20b:
s_mov_b64 exec, -1
v_lshrrev_b32 v1, 4, v0
v_lshlrev_b32 v1, 3, v1
s_lshl_b32 s3, s36, 7
buffer_load_dwordx2 v[244:245], v1, s[28:31], s3 offen offset:0
buffer_load_dwordx2 v[246:247], v1, s[28:31], s3 offen offset:32
buffer_load_dwordx2 v[248:249], v1, s[28:31], s3 offen offset:64
buffer_load_dwordx2 v[250:251], v1, s[28:31], s3 offen offset:96
v_lshlrev_b32 v8, 16, v236
v_and_b32 v9, 0xffff0000, v236
v_lshlrev_b32 v10, 16, v237
v_and_b32 v11, 0xffff0000, v237
v_lshlrev_b32 v12, 16, v238
v_and_b32 v13, 0xffff0000, v238
v_lshlrev_b32 v14, 16, v239
v_and_b32 v15, 0xffff0000, v239
v_lshlrev_b32 v16, 16, v240
v_and_b32 v17, 0xffff0000, v240
v_lshlrev_b32 v18, 16, v241
v_and_b32 v19, 0xffff0000, v241
v_lshlrev_b32 v20, 16, v242
v_and_b32 v21, 0xffff0000, v242
v_lshlrev_b32 v22, 16, v243
v_and_b32 v23, 0xffff0000, v243
s_lshl_b32 s0, s32, 13
s_add_u32 s0, s0, 57344
v_add_u32 v4, s0, v233
s_lshl_b32 s0, s32, 2
s_add_u32 s0, s0, 1760
s_waitcnt vmcnt(0)
s_mov_b32 s3, 0x3f803f80
v_mov_b32 v236, s3
v_mov_b32 v237, s3
v_mov_b32 v238, s3
v_mov_b32 v239, s3
s_mov_b32 exec_lo, 0x11111111
s_mov_b32 exec_hi, 0x11111111
v_mov_b32 v244, s3
v_mov_b32 v245, s3
v_mov_b32 v246, s3
v_mov_b32 v247, s3
v_mov_b32 v248, s3
v_mov_b32 v249, s3
v_mov_b32 v250, s3
v_mov_b32 v251, s3
s_mov_b64 exec, -1
v_mfma_f32_16x16x32_bf16 v[252:255], v[244:247], v[236:239], 0
v_mfma_f32_16x16x32_bf16 v[252:255], v[248:251], v[236:239], v[252:255]
L_fx:
s_sleep 1
v_mov_b32 v1, s0
ds_read_b32 v1, v1
s_waitcnt lgkmcnt(0)
v_cmp_ne_u32 vcc, 2, v1
s_cbranch_vccnz L_fx
s_setprio 1
ds_read_b128 v[24:27], v4 offset:0
ds_read_b128 v[28:31], v4 offset:1024
ds_read_b128 v[32:35], v4 offset:2048
ds_read_b128 v[36:39], v4 offset:3072
ds_read_b128 v[40:43], v4 offset:4096
ds_read_b128 v[44:47], v4 offset:5120
ds_read_b128 v[48:51], v4 offset:6144
ds_read_b128 v[52:55], v4 offset:7168
s_waitcnt lgkmcnt(7)
v_add_f32 v8, v8, v24
v_add_f32 v9, v9, v25
v_add_f32 v10, v10, v26
v_add_f32 v11, v11, v27
s_waitcnt lgkmcnt(6)
v_add_f32 v12, v12, v28
v_add_f32 v13, v13, v29
v_add_f32 v14, v14, v30
v_add_f32 v15, v15, v31
s_waitcnt lgkmcnt(5)
v_add_f32 v16, v16, v32
v_add_f32 v17, v17, v33
v_add_f32 v18, v18, v34
v_add_f32 v19, v19, v35
s_waitcnt lgkmcnt(4)
v_add_f32 v20, v20, v36
v_add_f32 v21, v21, v37
v_add_f32 v22, v22, v38
v_add_f32 v23, v23, v39
s_waitcnt lgkmcnt(3)
v_add_f32 v8, v8, v40
v_add_f32 v9, v9, v41
v_add_f32 v10, v10, v42
v_add_f32 v11, v11, v43
s_waitcnt lgkmcnt(2)
v_add_f32 v12, v12, v44
v_add_f32 v13, v13, v45
v_add_f32 v14, v14, v46
v_add_f32 v15, v15, v47
s_waitcnt lgkmcnt(1)
v_add_f32 v16, v16, v48
v_add_f32 v17, v17, v49
v_add_f32 v18, v18, v50
v_add_f32 v19, v19, v51
s_waitcnt lgkmcnt(0)
v_add_f32 v20, v20, v52
v_add_f32 v21, v21, v53
v_add_f32 v22, v22, v54
v_add_f32 v23, v23, v55
s_branch L_tail
L_gl_19g:
buffer_store_dwordx4 v[196:199], v226, s[20:23], 0 offen sc1
s_branch L_gl_19b
L_spr:
s_sleep 1
v_mov_b32 v1, s0
ds_read_b32 v1, v1
s_waitcnt lgkmcnt(0)
v_cmp_eq_u32 vcc, 0, v1
s_cbranch_vccnz L_spr
s_branch L_sbr
L_gl_20g:
buffer_store_dwordx4 v[80:83], v226, s[20:23], s54 offen sc1
s_branch L_gl_20b
L_moe:
s_cmp_ge_u32 s34, 32
s_cbranch_scc1 L_end
s_lshr_b32 s32, s32, 6
v_and_b32 v0, 63, v0
s_lshl_b32 s36, s33, 1
s_add_u32 s36, s36, s34
s_sub_u32 s36, s36, 30
s_mov_b32 s40, 524288
v_lshlrev_b32 v6, 4, v0
v_mov_b32 v132, 0
v_mov_b32 v133, 0
s_waitcnt lgkmcnt(0)
s_mov_b64 s[16:17], s[66:67]
s_mov_b32 s18, 0x10000000
s_mov_b32 s19, 0x20000
s_mov_b64 s[24:25], s[64:65]
s_mov_b32 s26, 0x100
s_mov_b32 s27, 0x20000
s_mov_b64 s[4:5], s[54:55]
s_mov_b32 s6, 0x1e0000
s_mov_b32 s7, 0x20000
s_mov_b64 s[8:9], s[56:57]
s_mov_b32 s10, 0x1e0000
s_mov_b32 s11, 0x20000
s_mov_b64 s[12:13], s[60:61]
s_mov_b32 s14, 0x1e0000
s_mov_b32 s15, 0x20000
s_mov_b64 s[20:21], s[62:63]
s_mov_b32 s22, 0x280000
s_mov_b32 s23, 0x20000
v_mov_b32 v8, -1
v_mov_b32 v9, -1
v_mov_b32 v10, -1
v_mov_b32 v11, -1
s_lshl_b32 s0, s36, 14
s_lshl_b32 s3, s32, 11
s_add_u32 s0, s0, s3
s_add_u32 s0, s0, 3145728
buffer_store_dwordx4 v[8:11], v6, s[16:19], s0 offen offset:0 sc1
buffer_store_dwordx4 v[8:11], v6, s[16:19], s0 offen offset:1024 sc1
s_and_b32 s44, s36, 1
s_mul_i32 s0, s33, 384
s_lshl_b32 s1, s44, 8
s_add_u32 s1, s1, s0
s_mul_i32 s3, s32, 24576
s_add_u32 s1, s1, s3
v_lshrrev_b32 v1, 3, v0
v_mul_u32_u24 v1, 3072, v1
s_lshr_b32 s3, s32, 1
v_xor_b32 v2, s3, v0
v_and_b32 v2, 7, v2
v_lshl_add_u32 v1, v2, 4, v1
v_add_u32 v4, s1, v1
v_xor_b32 v5, 64, v4
s_lshl_b32 s1, s44, 6
s_add_u32 s0, s0, s1
s_and_b32 s3, s32, 3
s_mul_i32 s1, s3, 49152
s_add_u32 s0, s0, s1
s_add_u32 s0, s0, 128
v_lshrrev_b32 v1, 2, v0
v_mul_u32_u24 v1, 3072, v1
v_xor_b32 v2, s3, v0
v_and_b32 v2, 3, v2
v_lshl_add_u32 v1, v2, 4, v1
v_add_u32 v249, s0, v1
s_cmp_lt_u32 s32, 4
s_cselect_b64 s[28:29], s[4:5], s[8:9]
s_cselect_b32 s62, 0, 128
s_mov_b32 s30, 0x1e0000
s_mov_b32 s31, 0x20000
s_lshl_b32 s61, s32, 10
s_add_u32 s62, s62, s61
s_mul_i32 s44, s44, 983040
s_mul_i32 s46, s36, 122880
s_cmp_lt_u32 s32, 5
s_cbranch_scc1 L_r0
s_add_u32 s45, s44, 0
s_add_u32 m0, s61, 0
s_nop 0
buffer_load_dwordx4 v4, s[4:7], s45 offen lds
s_add_u32 m0, s61, 8192
s_nop 0
buffer_load_dwordx4 v5, s[8:11], s45 offen lds
s_add_u32 s45, s44, 0
s_add_u32 m0, s62, 16384
s_nop 0
buffer_load_dwordx4 v249, s[28:31], s45 offen lds
s_waitcnt vmcnt(3)
s_barrier
s_branch L_r1
L_r0:
s_waitcnt vmcnt(0)
s_barrier
s_cmp_eq_u32 s32, 0
s_cbranch_scc0 L_nroot
s_lshl_b32 s0, s36, 4
v_mov_b32 v8, 1
s_mov_b64 exec, 1
buffer_store_dword v8, off, s[24:27], s0 sc1
s_mov_b64 exec, -1
L_nroot:
s_add_u32 s45, s44, 0
s_add_u32 m0, s61, 0
s_nop 0
buffer_load_dwordx4 v4, s[4:7], s45 offen lds
s_add_u32 m0, s61, 8192
s_nop 0
buffer_load_dwordx4 v5, s[8:11], s45 offen lds
s_add_u32 s45, s44, 0
s_add_u32 m0, s62, 16384
s_nop 0
buffer_load_dwordx4 v249, s[28:31], s45 offen lds
L_r1:
s_add_u32 s45, s44, 196608
s_add_u32 m0, s61, 42240
s_nop 0
buffer_load_dwordx4 v4, s[4:7], s45 offen lds
s_add_u32 m0, s61, 50432
s_nop 0
buffer_load_dwordx4 v5, s[8:11], s45 offen lds
s_add_u32 s45, s44, 196608
s_add_u32 m0, s62, 58624
s_nop 0
buffer_load_dwordx4 v249, s[28:31], s45 offen lds
v_lshrrev_b32 v1, 5, v0
v_bfe_u32 v2, v0, 2, 1
v_lshl_add_u32 v1, v1, 2, v2
v_bfe_u32 v2, v0, 4, 1
v_bfe_u32 v3, v0, 3, 1
v_lshl_add_u32 v3, v3, 1, v2
v_lshl_add_u32 v1, v3, 4, v1
v_xor_b32 v3, s32, v3
v_and_b32 v2, 1, v0
v_lshlrev_b32 v2, 3, v2
v_lshl_add_u32 v2, v3, 4, v2
v_bfe_u32 v3, v0, 1, 1
v_lshl_add_u32 v251, v1, 6, v2
v_mul_u32_u24 v8, 4224, v3
v_add_u32 v251, v251, v8
v_lshl_add_u32 v250, v1, 7, v2
v_mul_u32_u24 v8, 8256, v3
v_xor_b32 v250, v250, v8
v_mov_b32 v228, 0
v_mov_b32 v229, 0
v_mov_b32 v230, 0
v_mov_b32 v231, 0
v_mov_b32 v232, 0
v_mov_b32 v233, 0
v_mov_b32 v234, 0
v_mov_b32 v235, 0
v_mov_b32 v1, 0x4444
v_mov_b32 v2, 0xeeee
s_mov_b32 vcc_lo, 0xaaaaaaaa
s_mov_b32 vcc_hi, 0xaaaaaaaa
v_cndmask_b32 v7, v1, v2, vcc
v_and_b32 v1, 48, v0
v_and_b32 v2, 1, v0
v_lshlrev_b32 v2, 4, v2
v_lshl_add_u32 v252, v1, 1, v2
v_add_u32 v254, 126720, v252
v_add_u32 v252, 127232, v252
v_add_u32 v1, 126848, v1
v_mov_b32 v2, 126912
v_cndmask_b32 v255, v1, v2, vcc
v_mov_b32 v3, 0
v_lshl_add_u32 v2, v0, 2, v2
s_mov_b32 exec_hi, 0
ds_write_b32 v2, v3
s_mov_b64 exec, -1
s_and_b32 s3, s36, 1
s_cselect_b32 s0, 4, 0
s_cselect_b32 s1, -4, 8
s_add_u32 s0, s0, s32
v_bfe_u32 v1, v0, 4, 1
v_mul_i32_i24 v1, s1, v1
v_add_u32 v1, s0, v1
v_lshrrev_b32 v2, 1, v1
v_lshlrev_b32 v2, 2, v2
v_and_or_b32 v2, v1, 1, v2
v_and_or_b32 v2, v0, 2, v2
v_bfe_u32 v3, v0, 2, 1
v_lshl_add_u32 v2, v2, 1, v3
v_and_b32 v3, 1, v0
v_lshl_add_u32 v2, v2, 1, v3
v_and_b32 v3, 7, v0
v_lshl_add_u32 v3, v1, 3, v3
v_cmp_gt_u32 vcc, 8, v1
s_nop 1
v_cndmask_b32 v2, v3, v2, vcc
v_lshlrev_b32 v2, 1, v2
v_add_u32 v253, 126720, v2
s_lshl_b32 s47, s32, 15
s_lshl_b32 s3, s36, 6
s_add_u32 s47, s47, s3
s_add_u32 s47, s47, 3162112
v_lshrrev_b32 v1, 2, v0
v_and_b32 v2, 3, v0
v_lshlrev_b32 v2, 4, v2
v_lshl_add_u32 v2, v1, 10, v2
v_lshlrev_b32 v1, 4, v1
v_add_u32 v1, 4032, v1
s_mov_b64 vcc, 0xffff
v_cndmask_b32 v246, v1, v2, vcc
s_cmp_lt_u32 s32, 4
s_cselect_b32 s50, 0x00ff0000, 0
s_or_b32 s50, s50, 0xff
s_mov_b32 s51, 0
s_sub_u32 s3, s32, 4
s_lshl_b32 s3, s3, 4
s_add_u32 s52, s3, s36
s_mul_i32 s3, s52, 52
s_lshr_b32 s3, s3, 8
s_mul_i32 s3, s3, 27648
s_lshl_b32 s53, s52, 10
s_add_u32 s53, s53, s3
s_add_u32 s53, s53, 3162112
s_mov_b32 s49, 131072
s_mul_i32 s3, s52, 52
s_lshr_b32 s3, s3, 8
s_mul_i32 s0, s3, 5
s_sub_u32 s0, s52, s0
s_mul_i32 s3, s3, 80
s_lshl_b32 s1, s0, 2
s_cmp_eq_u32 s0, 4
s_cselect_b32 s1, 64, s1
s_cselect_b32 s0, 0, 4
s_cselect_b32 s48, 2, 0
s_add_u32 s3, s3, s1
v_bfe_u32 v1, v0, 4, 1
v_lshrrev_b32 v2, 5, v0
v_lshl_add_u32 v1, v1, 1, v2
v_lshlrev_b32 v1, s0, v1
v_and_b32 v2, 3, v0
v_lshlrev_b32 v2, s48, v2
v_add3_u32 v1, v1, v2, s3
v_lshlrev_b32 v128, 1, v1
v_lshlrev_b32 v129, 2, v1
v_lshrrev_b32 v1, 4, v0
v_bfe_u32 v2, v0, 2, 2
v_lshl_add_u32 v1, v1, 3, v2
v_mul_u32_u24 v1, 1280, v1
v_and_b32 v3, 1, v0
v_lshl_add_u32 v1, v3, 3, v1
v_bfe_u32 v2, v0, 2, 3
v_lshlrev_b32 v2, 1, v2
v_bfe_u32 v3, v0, 1, 1
s_mul_i32 s0, s32, 10
s_add_u32 s3, s0, 0
v_add_u32 v236, s3, v3
v_xor_b32 v236, v236, v2
v_lshl_add_u32 v236, v236, 4, v1
s_add_u32 s3, s0, 2
v_add_u32 v237, s3, v3
v_xor_b32 v237, v237, v2
v_lshl_add_u32 v237, v237, 4, v1
s_add_u32 s3, s0, 4
v_add_u32 v238, s3, v3
v_xor_b32 v238, v238, v2
v_lshl_add_u32 v238, v238, 4, v1
s_add_u32 s3, s0, 6
v_add_u32 v239, s3, v3
v_xor_b32 v239, v239, v2
v_lshl_add_u32 v239, v239, 4, v1
s_add_u32 s3, s0, 8
v_add_u32 v240, s3, v3
v_xor_b32 v240, v240, v2
v_lshl_add_u32 v240, v240, 4, v1
s_waitcnt vmcnt(3) lgkmcnt(0)
s_barrier
s_add_u32 s45, s44, 393216
s_add_u32 m0, s61, 84480
s_nop 0
buffer_load_dwordx4 v4, s[4:7], s45 offen lds
s_add_u32 m0, s61, 92672
s_nop 0
buffer_load_dwordx4 v5, s[8:11], s45 offen lds
s_add_u32 s45, s44, 393216
s_add_u32 m0, s62, 100864
s_nop 0
buffer_load_dwordx4 v249, s[28:31], s45 offen lds
v_add_u32 v1, 0, v250
ds_read_b64_tr_b16 v[8:9], v1 offset:0
ds_read_b64_tr_b16 v[10:11], v1 offset:256
ds_read_b64_tr_b16 v[12:13], v1 offset:1024
ds_read_b64_tr_b16 v[14:15], v1 offset:1280
s_cmp_lt_u32 s32, 4
s_cbranch_scc0 L_g0
v_add_u32 v1, 16384, v251
ds_read_b64_tr_b16 v[88:89], v1 offset:0
ds_read_b64_tr_b16 v[90:91], v1 offset:128
ds_read_b64_tr_b16 v[92:93], v1 offset:512
ds_read_b64_tr_b16 v[94:95], v1 offset:640
L_g0:
s_waitcnt vmcnt(3) lgkmcnt(0)
s_barrier
s_add_u32 s45, s44, 589824
s_add_u32 m0, s61, 0
s_nop 0
buffer_load_dwordx4 v4, s[4:7], s45 offen lds
s_add_u32 m0, s61, 8192
s_nop 0
buffer_load_dwordx4 v5, s[8:11], s45 offen lds
s_add_u32 s45, s44, 589824
s_add_u32 m0, s62, 16384
s_nop 0
buffer_load_dwordx4 v249, s[28:31], s45 offen lds
v_add_u32 v1, 42240, v250
ds_read_b64_tr_b16 v[16:17], v1 offset:0
ds_read_b64_tr_b16 v[18:19], v1 offset:256
ds_read_b64_tr_b16 v[20:21], v1 offset:1024
ds_read_b64_tr_b16 v[22:23], v1 offset:1280
s_cmp_lt_u32 s32, 4
s_cbranch_scc0 L_g1
v_add_u32 v1, 58624, v251
ds_read_b64_tr_b16 v[96:97], v1 offset:0
ds_read_b64_tr_b16 v[98:99], v1 offset:128
ds_read_b64_tr_b16 v[100:101], v1 offset:512
ds_read_b64_tr_b16 v[102:103], v1 offset:640
L_g1:
s_waitcnt vmcnt(3) lgkmcnt(0)
s_barrier
s_add_u32 s45, s44, 786432
s_add_u32 m0, s61, 42240
s_nop 0
buffer_load_dwordx4 v4, s[4:7], s45 offen lds
s_add_u32 m0, s61, 50432
s_nop 0
buffer_load_dwordx4 v5, s[8:11], s45 offen lds
s_add_u32 s45, s44, 786432
s_add_u32 m0, s62, 58624
s_nop 0
buffer_load_dwordx4 v249, s[28:31], s45 offen lds
v_add_u32 v1, 84480, v250
ds_read_b64_tr_b16 v[24:25], v1 offset:0
ds_read_b64_tr_b16 v[26:27], v1 offset:256
ds_read_b64_tr_b16 v[28:29], v1 offset:1024
ds_read_b64_tr_b16 v[30:31], v1 offset:1280
s_cmp_lt_u32 s32, 4
s_cbranch_scc0 L_g2
v_add_u32 v1, 100864, v251
ds_read_b64_tr_b16 v[104:105], v1 offset:0
ds_read_b64_tr_b16 v[106:107], v1 offset:128
ds_read_b64_tr_b16 v[108:109], v1 offset:512
ds_read_b64_tr_b16 v[110:111], v1 offset:640
L_g2:
s_waitcnt vmcnt(3) lgkmcnt(0)
s_barrier
s_sub_u32 s45, 983040, s44
s_add_u32 m0, s61, 84480
s_nop 0
buffer_load_dwordx4 v4, s[4:7], s45 offen lds
s_add_u32 m0, s61, 92672
s_nop 0
buffer_load_dwordx4 v5, s[8:11], s45 offen lds
s_sub_u32 s45, 1179648, s44
s_add_u32 m0, s61, 100864
s_nop 0
buffer_load_dwordx4 v4, s[4:7], s45 offen lds
s_add_u32 m0, s61, 109056
s_nop 0
buffer_load_dwordx4 v5, s[8:11], s45 offen lds
v_add_u32 v1, 0, v250
ds_read_b64_tr_b16 v[32:33], v1 offset:0
ds_read_b64_tr_b16 v[34:35], v1 offset:256
ds_read_b64_tr_b16 v[36:37], v1 offset:1024
ds_read_b64_tr_b16 v[38:39], v1 offset:1280
s_cmp_lt_u32 s32, 4
s_cbranch_scc0 L_g3
v_add_u32 v1, 16384, v251
ds_read_b64_tr_b16 v[112:113], v1 offset:0
ds_read_b64_tr_b16 v[114:115], v1 offset:128
ds_read_b64_tr_b16 v[116:117], v1 offset:512
ds_read_b64_tr_b16 v[118:119], v1 offset:640
L_g3:
s_waitcnt vmcnt(4) lgkmcnt(0)
s_barrier
s_sub_u32 s45, 1376256, s44
s_add_u32 m0, s61, 0
s_nop 0
buffer_load_dwordx4 v4, s[4:7], s45 offen lds
s_add_u32 m0, s61, 8192
s_nop 0
buffer_load_dwordx4 v5, s[8:11], s45 offen lds
s_sub_u32 s45, 1572864, s44
s_add_u32 m0, s61, 16384
s_nop 0
buffer_load_dwordx4 v4, s[4:7], s45 offen lds
s_add_u32 m0, s61, 24576
s_nop 0
buffer_load_dwordx4 v5, s[8:11], s45 offen lds
v_add_u32 v1, 42240, v250
ds_read_b64_tr_b16 v[40:41], v1 offset:0
ds_read_b64_tr_b16 v[42:43], v1 offset:256
ds_read_b64_tr_b16 v[44:45], v1 offset:1024
ds_read_b64_tr_b16 v[46:47], v1 offset:1280
s_cmp_lt_u32 s32, 4
s_cbranch_scc0 L_g4
v_add_u32 v1, 58624, v251
ds_read_b64_tr_b16 v[120:121], v1 offset:0
ds_read_b64_tr_b16 v[122:123], v1 offset:128
ds_read_b64_tr_b16 v[124:125], v1 offset:512
ds_read_b64_tr_b16 v[126:127], v1 offset:640
L_g4:
s_waitcnt vmcnt(4) lgkmcnt(0)
s_barrier
s_sub_u32 s45, 1769472, s44
s_add_u32 m0, s61, 42240
s_nop 0
buffer_load_dwordx4 v4, s[4:7], s45 offen lds
s_add_u32 m0, s61, 50432
s_nop 0
buffer_load_dwordx4 v5, s[8:11], s45 offen lds
v_add_u32 v1, 84480, v250
ds_read_b64_tr_b16 v[48:49], v1 offset:0
ds_read_b64_tr_b16 v[50:51], v1 offset:256
ds_read_b64_tr_b16 v[52:53], v1 offset:1024
ds_read_b64_tr_b16 v[54:55], v1 offset:1280
v_add_u32 v1, 100864, v250
ds_read_b64_tr_b16 v[56:57], v1 offset:0
ds_read_b64_tr_b16 v[58:59], v1 offset:256
ds_read_b64_tr_b16 v[60:61], v1 offset:1024
ds_read_b64_tr_b16 v[62:63], v1 offset:1280
v_and_b32 v248, 0xf0, v6
buffer_load_dword v247, v248, s[24:27], 0 offen sc1
s_waitcnt vmcnt(3) lgkmcnt(0)
s_barrier
s_lshl_b32 s3, s32, 6
s_addk_i32 s3, 0
v_add_u32 v1, s3, v0
v_mul_u32_u24 v2, 52429, v1
v_lshrrev_b32 v2, 22, v2
v_and_b32 v3, 3, v2
v_lshlrev_b32 v3, 1, v3
v_and_or_b32 v3, v2, 8, v3
v_xor_b32 v1, v1, v3
v_lshlrev_b32 v1, 4, v1
s_add_u32 m0, s61, 84480
s_add_u32 s3, s46, 0
buffer_load_dwordx4 v1, s[12:15], s3 offen lds
s_lshl_b32 s3, s32, 6
s_addk_i32 s3, 512
v_add_u32 v1, s3, v0
v_mul_u32_u24 v2, 52429, v1
v_lshrrev_b32 v2, 22, v2
v_and_b32 v3, 3, v2
v_lshlrev_b32 v3, 1, v3
v_and_or_b32 v3, v2, 8, v3
v_xor_b32 v1, v1, v3
v_lshlrev_b32 v1, 4, v1
s_add_u32 m0, s61, 92672
s_add_u32 s3, s46, 0
buffer_load_dwordx4 v1, s[12:15], s3 offen lds
s_lshl_b32 s3, s32, 6
s_addk_i32 s3, 1024
v_add_u32 v1, s3, v0
v_mul_u32_u24 v2, 52429, v1
v_lshrrev_b32 v2, 22, v2
v_and_b32 v3, 3, v2
v_lshlrev_b32 v3, 1, v3
v_and_or_b32 v3, v2, 8, v3
v_xor_b32 v1, v1, v3
v_lshlrev_b32 v1, 4, v1
s_add_u32 m0, s61, 100864
s_add_u32 s3, s46, 0
buffer_load_dwordx4 v1, s[12:15], s3 offen lds
s_lshl_b32 s3, s32, 6
s_addk_i32 s3, 1536
v_add_u32 v1, s3, v0
v_mul_u32_u24 v2, 52429, v1
v_lshrrev_b32 v2, 22, v2
v_and_b32 v3, 3, v2
v_lshlrev_b32 v3, 1, v3
v_and_or_b32 v3, v2, 8, v3
v_xor_b32 v1, v1, v3
v_lshlrev_b32 v1, 4, v1
s_add_u32 m0, s61, 109056
s_add_u32 s3, s46, 0
buffer_load_dwordx4 v1, s[12:15], s3 offen lds
s_lshl_b32 s3, s32, 6
s_addk_i32 s3, 2048
v_add_u32 v1, s3, v0
v_mul_u32_u24 v2, 52429, v1
v_lshrrev_b32 v2, 22, v2
v_and_b32 v3, 3, v2
v_lshlrev_b32 v3, 1, v3
v_and_or_b32 v3, v2, 8, v3
v_xor_b32 v1, v1, v3
v_lshlrev_b32 v1, 4, v1
s_add_u32 m0, s61, 117248
s_add_u32 s3, s46, 0
buffer_load_dwordx4 v1, s[12:15], s3 offen lds
v_add_u32 v1, 0, v250
ds_read_b64_tr_b16 v[64:65], v1 offset:0
ds_read_b64_tr_b16 v[66:67], v1 offset:256
ds_read_b64_tr_b16 v[68:69], v1 offset:1024
ds_read_b64_tr_b16 v[70:71], v1 offset:1280
v_add_u32 v1, 16384, v250
ds_read_b64_tr_b16 v[72:73], v1 offset:0
ds_read_b64_tr_b16 v[74:75], v1 offset:256
ds_read_b64_tr_b16 v[76:77], v1 offset:1024
ds_read_b64_tr_b16 v[78:79], v1 offset:1280
s_waitcnt vmcnt(5) lgkmcnt(0)
s_barrier
s_lshl_b32 s3, s32, 6
s_addk_i32 s3, 0
v_add_u32 v1, s3, v0
v_mul_u32_u24 v2, 52429, v1
v_lshrrev_b32 v2, 22, v2
v_and_b32 v3, 3, v2
v_lshlrev_b32 v3, 1, v3
v_and_or_b32 v3, v2, 8, v3
v_xor_b32 v1, v1, v3
v_lshlrev_b32 v1, 4, v1
s_add_u32 m0, s61, 0
s_add_u32 s3, s46, 40960
buffer_load_dwordx4 v1, s[12:15], s3 offen lds
s_lshl_b32 s3, s32, 6
s_addk_i32 s3, 512
v_add_u32 v1, s3, v0
v_mul_u32_u24 v2, 52429, v1
v_lshrrev_b32 v2, 22, v2
v_and_b32 v3, 3, v2
v_lshlrev_b32 v3, 1, v3
v_and_or_b32 v3, v2, 8, v3
v_xor_b32 v1, v1, v3
v_lshlrev_b32 v1, 4, v1
s_add_u32 m0, s61, 8192
s_add_u32 s3, s46, 40960
buffer_load_dwordx4 v1, s[12:15], s3 offen lds
s_lshl_b32 s3, s32, 6
s_addk_i32 s3, 1024
v_add_u32 v1, s3, v0
v_mul_u32_u24 v2, 52429, v1
v_lshrrev_b32 v2, 22, v2
v_and_b32 v3, 3, v2
v_lshlrev_b32 v3, 1, v3
v_and_or_b32 v3, v2, 8, v3
v_xor_b32 v1, v1, v3
v_lshlrev_b32 v1, 4, v1
s_add_u32 m0, s61, 16384
s_add_u32 s3, s46, 40960
buffer_load_dwordx4 v1, s[12:15], s3 offen lds
s_lshl_b32 s3, s32, 6
s_addk_i32 s3, 1536
v_add_u32 v1, s3, v0
v_mul_u32_u24 v2, 52429, v1
v_lshrrev_b32 v2, 22, v2
v_and_b32 v3, 3, v2
v_lshlrev_b32 v3, 1, v3
v_and_or_b32 v3, v2, 8, v3
v_xor_b32 v1, v1, v3
v_lshlrev_b32 v1, 4, v1
s_add_u32 m0, s61, 24576
s_add_u32 s3, s46, 40960
buffer_load_dwordx4 v1, s[12:15], s3 offen lds
s_lshl_b32 s3, s32, 6
s_addk_i32 s3, 2048
v_add_u32 v1, s3, v0
v_mul_u32_u24 v2, 52429, v1
v_lshrrev_b32 v2, 22, v2
v_and_b32 v3, 3, v2
v_lshlrev_b32 v3, 1, v3
v_and_or_b32 v3, v2, 8, v3
v_xor_b32 v1, v1, v3
v_lshlrev_b32 v1, 4, v1
s_add_u32 m0, s61, 32768
s_add_u32 s3, s46, 40960
buffer_load_dwordx4 v1, s[12:15], s3 offen lds
v_add_u32 v1, 42240, v250
ds_read_b64_tr_b16 v[80:81], v1 offset:0
ds_read_b64_tr_b16 v[82:83], v1 offset:256
ds_read_b64_tr_b16 v[84:85], v1 offset:1024
ds_read_b64_tr_b16 v[86:87], v1 offset:1280
s_waitcnt vmcnt(5) lgkmcnt(0)
s_barrier
s_lshl_b32 s3, s32, 6
s_addk_i32 s3, 0
v_add_u32 v1, s3, v0
v_mul_u32_u24 v2, 52429, v1
v_lshrrev_b32 v2, 22, v2
v_and_b32 v3, 3, v2
v_lshlrev_b32 v3, 1, v3
v_and_or_b32 v3, v2, 8, v3
v_xor_b32 v1, v1, v3
v_lshlrev_b32 v1, 4, v1
s_add_u32 m0, s61, 42240
s_add_u32 s3, s46, 81920
buffer_load_dwordx4 v1, s[12:15], s3 offen lds
s_lshl_b32 s3, s32, 6
s_addk_i32 s3, 512
v_add_u32 v1, s3, v0
v_mul_u32_u24 v2, 52429, v1
v_lshrrev_b32 v2, 22, v2
v_and_b32 v3, 3, v2
v_lshlrev_b32 v3, 1, v3
v_and_or_b32 v3, v2, 8, v3
v_xor_b32 v1, v1, v3
v_lshlrev_b32 v1, 4, v1
s_add_u32 m0, s61, 50432
s_add_u32 s3, s46, 81920
buffer_load_dwordx4 v1, s[12:15], s3 offen lds
s_lshl_b32 s3, s32, 6
s_addk_i32 s3, 1024
v_add_u32 v1, s3, v0
v_mul_u32_u24 v2, 52429, v1
v_lshrrev_b32 v2, 22, v2
v_and_b32 v3, 3, v2
v_lshlrev_b32 v3, 1, v3
v_and_or_b32 v3, v2, 8, v3
v_xor_b32 v1, v1, v3
v_lshlrev_b32 v1, 4, v1
s_add_u32 m0, s61, 58624
s_add_u32 s3, s46, 81920
buffer_load_dwordx4 v1, s[12:15], s3 offen lds
s_lshl_b32 s3, s32, 6
s_addk_i32 s3, 1536
v_add_u32 v1, s3, v0
v_mul_u32_u24 v2, 52429, v1
v_lshrrev_b32 v2, 22, v2
v_and_b32 v3, 3, v2
v_lshlrev_b32 v3, 1, v3
v_and_or_b32 v3, v2, 8, v3
v_xor_b32 v1, v1, v3
v_lshlrev_b32 v1, 4, v1
s_add_u32 m0, s61, 66816
s_add_u32 s3, s46, 81920
buffer_load_dwordx4 v1, s[12:15], s3 offen lds
s_lshl_b32 s3, s32, 6
s_addk_i32 s3, 2048
v_add_u32 v1, s3, v0
v_mul_u32_u24 v2, 52429, v1
v_lshrrev_b32 v2, 22, v2
v_and_b32 v3, 3, v2
v_lshlrev_b32 v3, 1, v3
v_and_or_b32 v3, v2, 8, v3
v_xor_b32 v1, v1, v3
v_lshlrev_b32 v1, 4, v1
s_add_u32 m0, s61, 75008
s_add_u32 s3, s46, 81920
buffer_load_dwordx4 v1, s[12:15], s3 offen lds
v_add_u32 v1, 84480, v236
ds_read_b64_tr_b16 v[168:169], v1 offset:0
ds_read_b64_tr_b16 v[170:171], v1 offset:5120
v_add_u32 v1, 84480, v237
ds_read_b64_tr_b16 v[180:181], v1 offset:0
ds_read_b64_tr_b16 v[182:183], v1 offset:5120
v_add_u32 v1, 84480, v238
ds_read_b64_tr_b16 v[192:193], v1 offset:0
ds_read_b64_tr_b16 v[194:195], v1 offset:5120
v_add_u32 v1, 84480, v239
ds_read_b64_tr_b16 v[204:205], v1 offset:0
ds_read_b64_tr_b16 v[206:207], v1 offset:5120
v_add_u32 v1, 84480, v240
ds_read_b64_tr_b16 v[216:217], v1 offset:0
ds_read_b64_tr_b16 v[218:219], v1 offset:5120
s_waitcnt vmcnt(5) lgkmcnt(0)
s_barrier
s_sub_u32 s45, 983040, s44
s_add_u32 m0, s62, 84480
s_nop 0
buffer_load_dwordx4 v249, s[28:31], s45 offen lds
s_sub_u32 s45, 1179648, s44
s_add_u32 m0, s62, 92928
s_nop 0
buffer_load_dwordx4 v249, s[28:31], s45 offen lds
s_sub_u32 s45, 1376256, s44
s_add_u32 m0, s62, 101376
s_nop 0
buffer_load_dwordx4 v249, s[28:31], s45 offen lds
s_sub_u32 s45, 1572864, s44
s_add_u32 m0, s62, 109824
s_nop 0
buffer_load_dwordx4 v249, s[28:31], s45 offen lds
s_sub_u32 s45, 1769472, s44
s_add_u32 m0, s62, 118272
s_nop 0
buffer_load_dwordx4 v249, s[28:31], s45 offen lds
v_add_u32 v1, 0, v236
ds_read_b64_tr_b16 v[172:173], v1 offset:0
ds_read_b64_tr_b16 v[174:175], v1 offset:5120
v_add_u32 v1, 0, v237
ds_read_b64_tr_b16 v[184:185], v1 offset:0
ds_read_b64_tr_b16 v[186:187], v1 offset:5120
v_add_u32 v1, 0, v238
ds_read_b64_tr_b16 v[196:197], v1 offset:0
ds_read_b64_tr_b16 v[198:199], v1 offset:5120
v_add_u32 v1, 0, v239
ds_read_b64_tr_b16 v[208:209], v1 offset:0
ds_read_b64_tr_b16 v[210:211], v1 offset:5120
v_add_u32 v1, 0, v240
ds_read_b64_tr_b16 v[220:221], v1 offset:0
ds_read_b64_tr_b16 v[222:223], v1 offset:5120
s_waitcnt vmcnt(5) lgkmcnt(0)
s_barrier
v_add_u32 v1, 42240, v236
ds_read_b64_tr_b16 v[176:177], v1 offset:0
ds_read_b64_tr_b16 v[178:179], v1 offset:5120
v_add_u32 v1, 42240, v237
ds_read_b64_tr_b16 v[188:189], v1 offset:0
ds_read_b64_tr_b16 v[190:191], v1 offset:5120
v_add_u32 v1, 42240, v238
ds_read_b64_tr_b16 v[200:201], v1 offset:0
ds_read_b64_tr_b16 v[202:203], v1 offset:5120
v_add_u32 v1, 42240, v239
ds_read_b64_tr_b16 v[212:213], v1 offset:0
ds_read_b64_tr_b16 v[214:215], v1 offset:5120
v_add_u32 v1, 42240, v240
ds_read_b64_tr_b16 v[224:225], v1 offset:0
ds_read_b64_tr_b16 v[226:227], v1 offset:5120
s_waitcnt vmcnt(0) lgkmcnt(0)
s_barrier
s_cmp_lt_u32 s32, 4
s_cbranch_scc0 L_g11
v_add_u32 v1, 84480, v251
ds_read_b64_tr_b16 v[128:129], v1 offset:0
ds_read_b64_tr_b16 v[130:131], v1 offset:128
ds_read_b64_tr_b16 v[132:133], v1 offset:512
ds_read_b64_tr_b16 v[134:135], v1 offset:640
v_add_u32 v1, 92928, v251
ds_read_b64_tr_b16 v[136:137], v1 offset:0
ds_read_b64_tr_b16 v[138:139], v1 offset:128
ds_read_b64_tr_b16 v[140:141], v1 offset:512
ds_read_b64_tr_b16 v[142:143], v1 offset:640
v_add_u32 v1, 101376, v251
ds_read_b64_tr_b16 v[144:145], v1 offset:0
ds_read_b64_tr_b16 v[146:147], v1 offset:128
ds_read_b64_tr_b16 v[148:149], v1 offset:512
ds_read_b64_tr_b16 v[150:151], v1 offset:640
v_add_u32 v1, 109824, v251
ds_read_b64_tr_b16 v[152:153], v1 offset:0
ds_read_b64_tr_b16 v[154:155], v1 offset:128
ds_read_b64_tr_b16 v[156:157], v1 offset:512
ds_read_b64_tr_b16 v[158:159], v1 offset:640
v_add_u32 v1, 118272, v251
ds_read_b64_tr_b16 v[160:161], v1 offset:0
ds_read_b64_tr_b16 v[162:163], v1 offset:128
ds_read_b64_tr_b16 v[164:165], v1 offset:512
ds_read_b64_tr_b16 v[166:167], v1 offset:640
L_g11:
s_branch L_pb_24
.p2align 12
L_pb_24:
s_call_b64 s[100:101], L_pad_25
s_call_b64 s[100:101], L_pad_26
s_call_b64 s[100:101], L_pad_27
v_mov_b32 v5, v246
v_mov_b32 v4, 126976
s_cmp_lt_u32 s32, 7
s_cbranch_scc1 L_np
L_rt:
v_cmp_ne_u32 vcc, 1, v247
s_cbranch_vccz L_rtg
buffer_load_dword v247, v248, s[24:27], 0 offen sc1
s_waitcnt vmcnt(0)
s_sub_u32 s40, s40, 1
s_cbranch_scc0 L_rt
s_mov_b32 s40, 0
L_rtg:
v_bfe_u32 v1, v0, 2, 3
v_lshlrev_b32 v1, 15, v1
v_and_b32 v2, 3, v0
v_min_u32 v2, 2, v2
v_mul_u32_u24 v3, 1280, v2
s_mov_b32 s0, 3145728
v_add3_u32 v3, v3, v1, s0
v_lshl_add_u32 v1, v2, 7, v1
s_mul_i32 s0, s36, 384
s_add_u32 s0, s0, 3167232
s_and_b32 s3, s36, 1
s_mul_i32 s3, s3, 640
v_add_u32 v132, s3, v6
v_subrev_u32 v2, 1280, v132
v_min_u32 v132, v132, v2
s_sub_u32 s3, 1024, s3
v_add_u32 v133, s3, v6
s_mov_b32 s54, 0
s_mov_b32 s55, 0x80000000
v_mov_b32 v140, -1
v_mov_b32 v141, -1
v_mov_b32 v142, -1
L_pk:
s_mov_b32 m0, 127232
s_mov_b64 exec, -1
s_nop 0
buffer_load_dwordx4 v132, s[16:19], s55 offen sc1 lds
s_mov_b32 m0, 128256
s_mov_b64 exec, 0xffff
buffer_load_dwordx4 v133, s[16:19], s55 offen sc1 lds
s_mov_b64 exec, 0x77777777
buffer_atomic_umin v140, v1, s[16:19], s0 offen sc0 sc1
s_sleep 2
buffer_atomic_umin v141, v1, s[16:19], s0 offen sc0 sc1
s_sleep 2
L_pl:
buffer_atomic_umin v142, v1, s[16:19], s0 offen sc0 sc1
s_waitcnt vmcnt(2)
v_cmp_lt_u32 vcc, s54, v140
s_cbranch_vccz L_pg
s_nop 0
v_cndmask_b32 v2, -1, v140, vcc
v_cmp_ne_u32 vcc, -1, v2
v_mov_b32 v238, v140
s_cbranch_vccnz L_pn
s_sleep 2
s_mov_b32 m0, 127232
s_mov_b64 exec, -1
buffer_load_dwordx4 v132, s[16:19], s55 offen sc1 lds
s_mov_b32 m0, 128256
s_mov_b64 exec, 0xffff
buffer_load_dwordx4 v133, s[16:19], s55 offen sc1 lds
s_mov_b64 exec, 0x77777777
buffer_atomic_umin v140, v1, s[16:19], s0 offen sc0 sc1
s_waitcnt vmcnt(4)
v_cmp_lt_u32 vcc, s54, v141
s_cbranch_vccz L_pg
s_nop 0
v_cndmask_b32 v2, -1, v141, vcc
v_cmp_ne_u32 vcc, -1, v2
v_mov_b32 v238, v141
s_cbranch_vccnz L_pn
s_sleep 2
buffer_atomic_umin v141, v1, s[16:19], s0 offen sc0 sc1
s_waitcnt vmcnt(4)
v_cmp_lt_u32 vcc, s54, v142
s_cbranch_vccz L_pg
s_nop 0
v_cndmask_b32 v2, -1, v142, vcc
v_cmp_ne_u32 vcc, -1, v2
v_mov_b32 v238, v142
s_cbranch_vccnz L_pn
s_sleep 2
s_sub_u32 s40, s40, 1
s_cbranch_scc0 L_pl
s_mov_b32 s40, 0
s_branch L_pg
L_pn:
v_cmp_eq_u32 s[58:59], -1, v238
s_mov_b64 exec, -1
v_cndmask_b32 v2, 0, v2, vcc
s_nop 1
v_max_u32_dpp v236, v2, v2 row_ror:8 row_mask:0xf bank_mask:0xf
s_nop 1
v_max_u32_dpp v236, v236, v236 row_ror:4 row_mask:0xf bank_mask:0xf
s_nop 1
v_max_u32_dpp v236, v236, v236 row_ror:2 row_mask:0xf bank_mask:0xf
s_nop 1
v_max_u32_dpp v236, v236, v236 row_ror:1 row_mask:0xf bank_mask:0xf
v_mov_b32 v237, v236
s_nop 1
v_permlane16_swap_b32 v236, v237
v_max_u32 v236, v236, v237
s_mov_b32 exec_hi, 0
v_cmpx_eq_u32 vcc, v236, v2
ds_write_b64 v4, v[2:3]
s_cmp_eq_u64 s[58:59], 0
s_nop 1
v_readfirstlane_b32 s55, v3
v_readfirstlane_b32 s54, v2
s_cbranch_scc0 L_pk
L_xf:
s_mov_b32 m0, 127232
s_mov_b64 exec, -1
s_nop 0
buffer_load_dwordx4 v132, s[16:19], s55 offen sc1 lds
s_mov_b32 m0, 128256
s_mov_b64 exec, 0xffff
buffer_load_dwordx4 v133, s[16:19], s55 offen sc1 lds
s_waitcnt vmcnt(0)
L_pg:
s_mov_b64 exec, -1
L_np:
s_waitcnt lgkmcnt(0)
s_barrier
s_cmp_lt_u32 s32, 4
s_cbranch_scc1 L_xh
ds_read_b64 v[2:3], v4
ds_read_b128 v[88:91], v252 offset:0
ds_read_b128 v[92:95], v252 offset:128
ds_read_b128 v[96:99], v252 offset:256
ds_read_b128 v[100:103], v252 offset:384
ds_read_b128 v[104:107], v252 offset:512
ds_read_b128 v[108:111], v252 offset:640
ds_read_b128 v[112:115], v252 offset:768
ds_read_b128 v[116:119], v252 offset:896
ds_read_b128 v[120:123], v252 offset:1024
ds_read_b128 v[124:127], v252 offset:1152
s_waitcnt lgkmcnt(10)
v_readfirstlane_b32 s56, v2
v_readfirstlane_b32 s57, v3
s_waitcnt lgkmcnt(9)
v_smfmac_f32_16x16x64_bf16 v[228:231], v[88:91], v[8:15], v7
s_and_b32 s0, s57, 0x7fff
s_add_u32 s57, s57, s0
s_add_u32 s57, s57, 4096
s_and_b32 s1, s56, 0xfffff800
s_waitcnt lgkmcnt(8)
v_smfmac_f32_16x16x64_bf16 v[228:231], v[92:95], v[16:23], v7
s_ashr_i32 s3, s1, 31
s_not_b32 s3, s3
s_or_b32 s3, s3, 0x80000000
s_xor_b32 s1, s1, s3
s_waitcnt lgkmcnt(7)
v_smfmac_f32_16x16x64_bf16 v[228:231], v[96:99], v[24:31], v7
s_andn2_b32 s56, 2047, s56
s_mul_i32 s56, s56, 1280
v_mov_b32 v130, s1
s_waitcnt lgkmcnt(6)
v_smfmac_f32_16x16x64_bf16 v[228:231], v[100:103], v[32:39], v7
v_mul_f32 v130, 0xbfb8aa3b, v130
s_waitcnt lgkmcnt(5)
v_smfmac_f32_16x16x64_bf16 v[228:231], v[104:107], v[40:47], v7
v_exp_f32 v130, v130
s_waitcnt lgkmcnt(4)
v_smfmac_f32_16x16x64_bf16 v[228:231], v[108:111], v[48:55], v7
v_add_f32 v130, 1.0, v130
s_waitcnt lgkmcnt(3)
v_smfmac_f32_16x16x64_bf16 v[228:231], v[112:115], v[56:63], v7
v_rcp_f32 v130, v130
s_waitcnt lgkmcnt(2)
v_smfmac_f32_16x16x64_bf16 v[228:231], v[116:119], v[64:71], v7
s_waitcnt lgkmcnt(1)
v_smfmac_f32_16x16x64_bf16 v[228:231], v[120:123], v[72:79], v7
s_waitcnt lgkmcnt(0)
v_smfmac_f32_16x16x64_bf16 v[228:231], v[124:127], v[80:87], v7
s_branch L_xj
L_pad_25:
s_setpc_b64 s[100:101]
L_xh:
ds_read_b128 v[236:239], v252 offset:0
ds_read_b128 v[240:243], v252 offset:128
ds_read_b128 v[244:247], v252 offset:256
ds_read_b128 v[248:251], v252 offset:384
s_waitcnt lgkmcnt(3)
v_smfmac_f32_16x16x64_bf16 v[228:231], v[236:239], v[8:15], v7
v_smfmac_f32_16x16x64_bf16 v[232:235], v[236:239], v[88:95], v7
ds_read_b128 v[236:239], v252 offset:512
s_waitcnt lgkmcnt(3)
v_smfmac_f32_16x16x64_bf16 v[228:231], v[240:243], v[16:23], v7
v_smfmac_f32_16x16x64_bf16 v[232:235], v[240:243], v[96:103], v7
ds_read_b128 v[240:243], v252 offset:640
s_waitcnt lgkmcnt(3)
v_smfmac_f32_16x16x64_bf16 v[228:231], v[244:247], v[24:31], v7
v_smfmac_f32_16x16x64_bf16 v[232:235], v[244:247], v[104:111], v7
ds_read_b128 v[244:247], v252 offset:768
s_waitcnt lgkmcnt(3)
v_smfmac_f32_16x16x64_bf16 v[228:231], v[248:251], v[32:39], v7
v_smfmac_f32_16x16x64_bf16 v[232:235], v[248:251], v[112:119], v7
ds_read_b128 v[248:251], v252 offset:896
s_waitcnt lgkmcnt(3)
v_smfmac_f32_16x16x64_bf16 v[228:231], v[236:239], v[40:47], v7
v_smfmac_f32_16x16x64_bf16 v[232:235], v[236:239], v[120:127], v7
ds_read_b128 v[236:239], v252 offset:1024
s_waitcnt lgkmcnt(3)
v_smfmac_f32_16x16x64_bf16 v[228:231], v[240:243], v[48:55], v7
v_smfmac_f32_16x16x64_bf16 v[232:235], v[240:243], v[128:135], v7
ds_read_b128 v[240:243], v252 offset:1152
s_waitcnt lgkmcnt(3)
v_smfmac_f32_16x16x64_bf16 v[228:231], v[244:247], v[56:63], v7
v_smfmac_f32_16x16x64_bf16 v[232:235], v[244:247], v[136:143], v7
s_waitcnt lgkmcnt(2)
v_smfmac_f32_16x16x64_bf16 v[228:231], v[248:251], v[64:71], v7
v_smfmac_f32_16x16x64_bf16 v[232:235], v[248:251], v[144:151], v7
s_waitcnt lgkmcnt(1)
v_smfmac_f32_16x16x64_bf16 v[228:231], v[236:239], v[72:79], v7
v_smfmac_f32_16x16x64_bf16 v[232:235], v[236:239], v[152:159], v7
s_waitcnt lgkmcnt(0)
v_smfmac_f32_16x16x64_bf16 v[228:231], v[240:243], v[80:87], v7
v_smfmac_f32_16x16x64_bf16 v[232:235], v[240:243], v[160:167], v7
L_xj:
s_mov_b64 vcc, 0xffff
s_nop 5
v_add_f32 v1, v228, v229
v_add_f32 v2, v232, v233
v_cndmask_b32 v1, v2, v1, vcc
v_cmp_u_f32 vcc, v1, v1
s_cbranch_vccnz L_xn
L_xnb:
v_mul_f32 v2, 0xbfb8aa3b, v1
v_exp_f32 v2, v2
v_mul_f32_dpp v3, v1, v1 row_ror:8 row_mask:0xf bank_mask:0xf
v_add_f32 v2, 1.0, v2
v_rcp_f32 v2, v2
s_nop 0
v_mul_f32 v1, v2, v3
v_cvt_pk_bf16_f32 v1, v1, v1
s_mov_b64 exec, s[50:51]
ds_write_b16 v253, v1
s_mov_b64 exec, -1
v_mov_b32 v2, 126928
s_waitcnt lgkmcnt(0)
s_barrier
ds_read_b32 v1, v2
ds_read_b128 v[236:239], v255
ds_read_b128 v[240:243], v254
s_waitcnt lgkmcnt(2)
v_cmp_ne_u32 vcc, 0, v1
s_cbranch_vccnz L_xsr
L_xsgo:
s_waitcnt lgkmcnt(1)
v_mfma_f32_16x16x32_bf16 v[24:27], v[236:239], v[224:227], 0
v_mfma_f32_16x16x32_bf16 v[8:11], v[236:239], v[176:179], 0
v_mfma_f32_16x16x32_bf16 v[12:15], v[236:239], v[188:191], 0
v_mfma_f32_16x16x32_bf16 v[16:19], v[236:239], v[200:203], 0
v_mfma_f32_16x16x32_bf16 v[20:23], v[236:239], v[212:215], 0
s_waitcnt lgkmcnt(0)
s_nop 0
v_smfmac_f32_16x16x64_bf16 v[24:27], v[240:243], v[216:223], v7
v_smfmac_f32_16x16x64_bf16 v[8:11], v[240:243], v[168:175], v7
v_smfmac_f32_16x16x64_bf16 v[12:15], v[240:243], v[180:187], v7
v_smfmac_f32_16x16x64_bf16 v[16:19], v[240:243], v[192:199], v7
v_smfmac_f32_16x16x64_bf16 v[20:23], v[240:243], v[204:211], v7
s_nop 3
v_add_f32 v1, v24, v25
v_add_f32 v32, v8, v9
v_add_f32 v33, v12, v13
v_add_f32 v34, v16, v17
v_add_f32 v35, v20, v21
v_mov_b32_dpp v32, v1 quad_perm:[0,0,0,0] row_mask:0x2 bank_mask:0xf
v_mov_b32_dpp v33, v1 quad_perm:[1,1,1,1] row_mask:0x2 bank_mask:0xf
v_mov_b32_dpp v34, v1 quad_perm:[2,2,2,2] row_mask:0x2 bank_mask:0xf
v_mov_b32_dpp v35, v1 quad_perm:[3,3,3,3] row_mask:0x2 bank_mask:0xf
s_mov_b64 exec, 0x1111ffff
buffer_store_dwordx4 v[32:35], v5, s[16:19], s47 offen sc1
s_mov_b64 exec, -1
s_cmp_lt_u32 s52, 40
s_cbranch_scc0 L_mfin
buffer_load_dword v44, v129, s[16:19], s57 offen sc1
buffer_load_dwordx4 v[40:43], v6, s[16:19], s53 offen sc1
L_fd:
buffer_load_dword v52, v129, s[16:19], s57 offen sc1
buffer_load_dwordx4 v[48:51], v6, s[16:19], s53 offen sc1
s_waitcnt vmcnt(2)
v_max3_u32 v1, v40, v42, v44
v_cmp_eq_u32 vcc, -1, v1
s_cbranch_vccz L_fg0
buffer_load_dword v44, v129, s[16:19], s57 offen sc1
buffer_load_dwordx4 v[40:43], v6, s[16:19], s53 offen sc1
s_waitcnt vmcnt(2)
v_max3_u32 v1, v48, v50, v52
v_cmp_eq_u32 vcc, -1, v1
s_cbranch_vccz L_fg1
s_sub_u32 s40, s40, 1
s_cbranch_scc0 L_fd
L_fg1:
v_permlane32_swap_b32 v48, v49
v_permlane32_swap_b32 v50, v51
v_add_f32 v48, v48, v49
v_add_f32 v50, v50, v51
s_nop 1
v_permlane16_swap_b32 v48, v50
v_add_f32 v48, v48, v50
s_nop 1
v_add_f32_dpp v48, v48, v48 row_ror:4 row_mask:0xf bank_mask:0xf
s_nop 1
v_add_f32_dpp v48, v48, v48 row_ror:8 row_mask:0xf bank_mask:0xf
v_fma_f32 v8, v48, v130, v52
v_cvt_pk_bf16_f32 v8, v8, v8
s_mov_b32 exec_lo, 0xf000f
s_mov_b32 exec_hi, 0xf000f
buffer_store_short v8, v128, s[20:23], s56 offen
s_endpgm
L_pad_26:
s_setpc_b64 s[100:101]
L_fg0:
v_permlane32_swap_b32 v40, v41
v_permlane32_swap_b32 v42, v43
v_add_f32 v40, v40, v41
v_add_f32 v42, v42, v43
s_nop 1
v_permlane16_swap_b32 v40, v42
v_add_f32 v40, v40, v42
s_nop 1
v_add_f32_dpp v40, v40, v40 row_ror:4 row_mask:0xf bank_mask:0xf
s_nop 1
v_add_f32_dpp v40, v40, v40 row_ror:8 row_mask:0xf bank_mask:0xf
v_fma_f32 v8, v40, v130, v44
v_cvt_pk_bf16_f32 v8, v8, v8
s_mov_b32 exec_lo, 0xf000f
s_mov_b32 exec_hi, 0xf000f
buffer_store_short v8, v128, s[20:23], s56 offen
L_mfin:
s_endpgm
L_pad_27:
s_setpc_b64 s[100:101]
L_xn:
v_mov_b32 v2, 126928
ds_write_b32 v2, v2
s_branch L_xnb
L_xsr:
s_sub_u32 s49, s49, 1
s_cbranch_scc1 L_xsgo
v_mov_b32 v228, 0
v_mov_b32 v229, 0
v_mov_b32 v230, 0
v_mov_b32 v231, 0
v_mov_b32 v232, 0
v_mov_b32 v233, 0
v_mov_b32 v234, 0
v_mov_b32 v235, 0
s_waitcnt lgkmcnt(0)
s_barrier
s_cmp_eq_u32 s32, 7
s_cbranch_scc0 L_np
ds_write_b32 v2, v228
s_branch L_xf
L_end:
s_endpgm
.section .rodata,"a"
.p2align 6
.amdhsa_kernel sequential_preLN__sliding_local_dilated__moe_arch_mod__prompt_kernel
  .amdhsa_next_free_vgpr 256
  .amdhsa_next_free_sgpr 102
  .amdhsa_accum_offset 256
  .amdhsa_group_segment_fixed_size 0
  .amdhsa_kernarg_size 88
  .amdhsa_user_sgpr_count 2
  .amdhsa_user_sgpr_kernarg_segment_ptr 1
  .amdhsa_system_sgpr_workgroup_id_x 1
  .amdhsa_float_denorm_mode_32 3
.end_amdhsa_kernel
```

```asm
; @launch grid=(256,1,1) block=(512,1,1) lds=163840
.amdgcn_target "amdgcn-amd-amdhsa--gfx950"
.text
.p2align 12
.globl sequential_preLN__sliding_local_dilated__moe_arch_mod__prompt_kernel
.p2align 8
.type sequential_preLN__sliding_local_dilated__moe_arch_mod__prompt_kernel,@function
sequential_preLN__sliding_local_dilated__moe_arch_mod__prompt_kernel:
s_load_dwordx16 s[44:59], s[0:1], 0
s_load_dwordx8 s[60:67], s[0:1], 56
s_lshr_b32 s34, s2, 3
s_and_b32 s33, s2, 7
v_readfirstlane_b32 s32, v0
s_getpc_b64 s[100:101]
L_pc:
s_mul_i32 s3, s34, 8
v_min_u32 v2, 7, v0
v_add_lshl_u32 v2, v2, s3, 7
v_min_u32 v2, L_end-L_pc, v2
s_cmp_ge_u32 s34, 30
s_cbranch_scc1 L_moe
global_load_dword v255, v2, s[100:101]
s_mul_i32 s35, s34, 26
s_lshr_b32 s35, s35, 8
s_mul_i32 s3, s35, 10
s_sub_u32 s36, s34, s3
s_lshr_b32 s32, s32, 6
s_add_u32 s3, s36, s33
s_add_u32 s3, s3, 2
s_sub_u32 s68, s3, 10
s_cselect_b32 s69, s3, s68
s_mul_i32 s3, s69, 245760
s_lshl_b32 s68, s36, 7
s_add_u32 s3, s3, s68
v_lshrrev_b32 v1, 3, v0
v_lshrrev_b32 v3, 4, v0
v_and_b32 v2, 2, v1
v_and_or_b32 v2, v3, 4, v2
v_xor_b32 v2, v2, v0
v_and_b32 v2, 7, v2
v_mul_u32_u24 v4, 3840, v1
v_lshl_add_u32 v4, v2, 4, v4
v_add_u32 v4, s3, v4
s_mul_i32 s3, s32, 3072
s_add_u32 m0, s3, 20480
v_and_b32 v0, 63, v0
s_and_b32 s38, s32, 3
s_lshr_b32 s3, s33, 1
s_lshl_b32 s3, s3, 9
s_mul_i32 s68, s35, 176
s_add_u32 s3, s3, s68
s_and_b32 s68, s33, 1
s_add_u32 s3, s3, s68
s_mul_i32 s39, s3, 1280
s_sub_u32 s42, s32, 5
s_mul_i32 s3, s42, 81920
s_add_u32 s3, s3, s39
s_sub_u32 s3, s3, 20480
v_lshrrev_b32 v1, 3, v0
v_lshrrev_b32 v3, 4, v0
v_xor_b32 v3, v3, v0
v_and_b32 v3, 7, v3
v_mul_u32_u24 v1, 2560, v1
v_lshl_add_u32 v1, v3, 4, v1
v_add_u32 v24, s3, v1
s_add_u32 s3, s42, s35
s_cmp_eq_u32 s3, 4
s_cselect_b32 s3, 0x80000000, 0
v_xor_b32 v25, 64, v24
v_add_u32 v25, 20480, v25
v_add_u32 v26, 40960, v24
v_add_u32 v27, 40960, v25
v_or_b32 v27, s3, v27
s_mov_b32 s6, 0x280000
s_mov_b32 s7, 0x20000
s_mov_b32 s10, 0x258000
s_mov_b32 s11, 0x20000
s_mov_b32 s14, 0xc8000
s_mov_b32 s15, 0x20000
s_mov_b32 s18, 0x10000000
s_mov_b32 s19, 0x20000
s_mov_b32 s22, 0x280000
s_mov_b32 s23, 0x20000
s_mov_b32 s26, 0x100
s_mov_b32 s27, 0x20000
s_mov_b32 s30, 0x500
s_mov_b32 s31, 0x20000
s_waitcnt lgkmcnt(0)
global_load_lds_dwordx4 v4, s[46:47]
s_addk_i32 m0, -256
s_mov_b64 s[4:5], s[44:45]
global_load_lds_dwordx4 v4, s[46:47] offset:1280
s_addk_i32 m0, -256
s_mov_b64 s[20:21], s[62:63]
global_load_lds_dwordx4 v4, s[46:47] offset:2560
s_mov_b64 s[24:25], s[64:65]
s_mov_b64 s[16:17], s[66:67]
s_mov_b64 s[8:9], s[46:47]
s_mov_b64 s[12:13], s[48:49]
s_mov_b64 s[28:29], s[52:53]
s_cmp_eq_u32 s32, 4
s_cselect_b64 s[96:97], s[54:55], s[58:59]
s_cmp_eq_u32 s32, 5
s_cselect_b64 s[96:97], s[56:57], s[96:97]
s_cmp_lt_u32 s32, 5
s_cbranch_scc1 L_nx
s_lshl_b32 s64, s42, 12
s_cselect_b32 s62, -1, 0xffffff00
s_lshl_b32 s63, s69, 7
s_mov_b32 s61, 8192
s_add_u32 m0, s61, s64
s_mov_b32 exec_lo, s62
buffer_load_dwordx4 v24, s[4:7], s63 offen lds
s_addk_i32 m0, 1024
s_mov_b32 exec_lo, -1
buffer_load_dwordx4 v25, s[4:7], s63 offen lds
s_addk_i32 m0, 1024
s_nop 0
buffer_load_dwordx4 v26, s[4:7], s63 offen lds
s_addk_i32 m0, 1024
s_nop 0
buffer_load_dwordx4 v27, s[4:7], s63 offen lds
L_nx:
v_mov_b32 v254, v4
s_mov_b32 s40, 524288
s_mul_i32 s43, s33, 3
s_add_u32 s43, s43, s35
s_sub_u32 s3, s36, 5
s_cselect_b32 s37, s36, s3
s_lshl_b32 s3, s32, 2
s_lshr_b32 s44, 0x32105454, s3
s_and_b32 s44, s44, 7
s_lshr_b32 s45, s38, 1
s_add_u32 s45, s45, 4
s_cmp_eq_u32 s35, 2
s_cselect_b32 s60, 10, 11
s_sub_u32 s57, 8, s33
v_lshlrev_b32 v233, 4, v0
s_mul_i32 s58, s43, 6
s_add_u32 s58, s58, s44
s_mul_i32 s58, s58, 2560
s_add_u32 s58, s58, 2097152
s_lshl_b32 s59, s33, 15
s_add_u32 s59, s59, 3145728
s_sub_u32 s51, 5, s37
s_add_u32 s1, s37, 1
s_sub_u32 s3, 15, s37
s_cmp_le_u32 s37, 2
s_cselect_b32 s46, 0, s3
s_cselect_b32 s47, s51, s1
s_cselect_b32 s48, s3, 0
s_cselect_b32 s49, s1, s51
s_cselect_b32 s50, 1, 0
v_and_b32 v3, 15, v0
v_add_u32 v3, 8, v3
v_lshrrev_b32 v4, 1, v3
v_lshrrev_b32 v5, 5, v0
v_xor_b32 v4, v4, v5
v_and_b32 v4, 7, v4
v_lshlrev_b32 v4, 4, v4
v_lshl_add_u32 v4, v3, 7, v4
v_bfe_u32 v5, v0, 4, 1
v_lshl_add_u32 v4, v5, 3, v4
s_lshl_b32 s3, s44, 11
v_add_u32 v235, s3, v4
s_cmp_lt_u32 s32, 4
s_cbranch_scc1 L_cons
s_add_u32 s69, s69, 1
s_cmp_eq_u32 s69, 10
s_cselect_b32 s69, 0, s69
s_lshl_b32 s63, s69, 7
s_mov_b32 s61, 45056
v_and_b32 v1, 15, v0
v_lshrrev_b32 v2, 4, v0
v_mov_b32 v7, 1792
s_mul_i32 s0, s44, 2304
s_movk_i32 s1, 144
v_bfe_u32 v3, v0, 2, 1
v_and_b32 v4, 3, v0
v_lshlrev_b32 v4, 1, v4
v_lshl_add_u32 v3, v3, 3, v4
v_bfe_u32 v4, v0, 3, 1
v_add_u32 v3, v3, v4
s_add_u32 s3, s0, 17408
v_mov_b32 v4, s3
v_mad_u32_u24 v3, v3, s1, v4
s_add_u32 s3, s0, 4736
v_mov_b32 v4, s3
v_mad_u32_u24 v4, v1, s1, v4
s_mov_b32 s52, 0xff00ff
s_mov_b32 s53, 0xff00ff
v_add_u32 v5, s51, v2
v_lshl_add_u32 v200, v5, 3, v3
v_lshl_add_u32 v5, v5, 3, v4
v_cndmask_b32 v204, v7, v5, s[52:53]
v_cndmask_b32 v205, v5, v7, s[52:53]
v_add_u32 v5, s46, v2
v_lshl_add_u32 v202, v5, 3, v3
v_lshl_add_u32 v5, v5, 3, v4
v_cmp_gt_u32 vcc, s47, v2
s_nop 1
v_cndmask_b32 v5, v7, v5, vcc
v_cndmask_b32 v206, v7, v5, s[52:53]
v_cndmask_b32 v207, v5, v7, s[52:53]
v_add_u32 v5, s48, v2
v_min_u32 v5, 15, v5
v_lshl_add_u32 v203, v5, 3, v3
v_lshl_add_u32 v5, v5, 3, v4
v_cmp_gt_u32 vcc, s49, v2
s_nop 1
v_cndmask_b32 v5, v7, v5, vcc
v_cndmask_b32 v208, v7, v5, s[52:53]
v_cndmask_b32 v209, v5, v7, s[52:53]
s_sub_u32 s3, s51, 1
v_mad_u32_u24 v5, v2, 5, s3
s_add_u32 s3, s46, 4
v_mov_b32 v6, s3
s_mov_b64 vcc, 0xffff
v_cndmask_b32 v5, v5, v6, vcc
v_min_u32 v5, 15, v5
v_lshl_add_u32 v201, v5, 3, v3
v_lshl_add_u32 v5, v5, 3, v4
s_cmp_eq_u32 s47, 5
s_cselect_b64 vcc, 0xff, 0
v_cndmask_b32 v210, v7, v5, vcc
s_lshl_b64 vcc, vcc, 8
v_cndmask_b32 v211, v7, v5, vcc
s_bfm_b64 vcc, 8, 16
v_cndmask_b32 v212, v7, v5, vcc
s_bfm_b64 vcc, 8, 24
v_cndmask_b32 v213, v7, v5, vcc
s_bfm_b64 vcc, 8, 32
v_cndmask_b32 v214, v7, v5, vcc
s_bfm_b64 vcc, 8, 40
v_cndmask_b32 v215, v7, v5, vcc
s_mul_i32 s0, s44, 2304
s_movk_i32 s1, 144
v_bfe_u32 v3, v0, 2, 3
v_lshrrev_b32 v4, 5, v0
v_lshl_add_u32 v3, v3, 1, v4
s_add_u32 s3, s0, 31232
v_mov_b32 v4, s3
v_mad_u32_u24 v3, v3, s1, v4
v_and_b32 v4, 3, v0
s_mov_b32 s54, 0x11111111
s_mov_b32 s55, 0x11111111
v_add_u32 v5, s51, v4
v_lshl_add_u32 v216, v5, 3, v3
v_add_u32 v7, 32, v216
s_cmp_eq_u32 s50, 1
s_cselect_b32 s3, -1, 12
s_cselect_b32 s56, 2, -1
v_add_u32 v5, s3, v4
v_lshl_add_u32 v5, v5, 3, v3
v_cndmask_b32 v217, v5, v7, s[54:55]
v_add_u32 v7, 40, v7
v_add_u32 v5, s56, v4
v_add_u32 v6, 10, v5
v_cmp_gt_i32 vcc, s51, v5
s_nop 1
v_cndmask_b32 v5, v6, v5, vcc
v_lshl_add_u32 v5, v5, 3, v3
v_cndmask_b32 v218, v5, v7, s[54:55]
s_lshl_b32 s0, s44, 8
v_lshrrev_b32 v4, 5, v0
v_and_or_b32 v3, v0, 8, v4
s_add_u32 s3, s0, 8
v_lshl_add_u32 v222, v3, 4, s3
v_and_b32 v1, 15, v0
s_add_u32 s3, s0, 132
v_lshl_add_u32 v223, v1, 4, s3
s_lshr_b32 s3, s39, 8
s_mul_i32 s3, s3, 52429
s_lshr_b32 s3, s3, 18
s_lshl_b32 s0, s44, 5
s_add_u32 s3, s3, s0
s_sub_u32 s3, 2047, s3
v_mad_i32_i24 v234, v1, -2, s3
v_lshrrev_b32 v2, 4, v0
v_and_or_b32 v3, v0, 8, v2
v_and_b32 v4, 0x70, v233
v_bfrev_b32 v6, 1
s_lshl_b32 s3, s45, 4
v_add_u32 v5, s3, v3
s_lshl_b32 s3, s60, 3
v_cmp_gt_u32 vcc, s3, v5
v_mul_u32_u24 v5, 2560, v5
v_add3_u32 v5, v5, v4, s39
v_cndmask_b32 v236, v6, v5, vcc
s_lshl_b32 s3, s44, 4
v_add_u32 v5, s3, v3
s_lshl_b32 s3, s60, 3
v_cmp_gt_u32 vcc, s3, v5
v_mul_u32_u24 v5, 2560, v5
v_add3_u32 v5, v5, v4, s39
v_cndmask_b32 v227, v6, v5, vcc
s_lshl_b32 s3, s36, 7
v_add_u32 v226, s3, v227
v_bfe_u32 v3, v0, 4, 1
v_cmp_eq_u32 s[54:55], s50, v3
s_cmp_lg_u32 s37, 0
s_cselect_b64 s[0:1], -1, s[54:55]
s_and_b64 vcc, vcc, s[0:1]
s_cmp_lg_u32 s37, 4
s_cselect_b64 s[0:1], 0, s[54:55]
s_andn2_b64 vcc, vcc, s[0:1]
v_cndmask_b32 v225, v6, v226, vcc
s_cmp_le_u32 s37, 3
s_cselect_b32 s3, 2560, 0
s_sub_u32 s3, s3, 128
v_mov_b32 v4, s3
s_cmp_ge_u32 s37, 2
s_cselect_b32 s3, 2560, 0
s_add_u32 s3, s3, 128
v_mov_b32 v5, s3
v_cndmask_b32 v4, v4, v5, s[54:55]
v_mul_u32_u24 v3, 2560, v3
v_sub_u32 v4, v4, v3
v_add_u32 v4, v4, v226
v_cndmask_b32 v224, v6, v4, vcc
v_and_b32 v1, 15, v0
v_bfrev_b32 v6, 1
v_bfe_u32 v3, v0, 4, 1
v_lshrrev_b32 v4, 5, v0
v_lshl_add_u32 v3, v3, 1, v4
s_lshl_b32 s3, s36, 7
v_lshl_add_u32 v4, v3, 4, s3
s_lshl_b32 s3, s44, 4
v_add_u32 v5, s3, v1
s_lshl_b32 s3, s60, 3
v_cmp_gt_u32 vcc, s3, v5
v_mul_u32_u24 v5, 2560, v5
v_add3_u32 v5, v5, v4, s39
v_cndmask_b32 v232, v6, v5, vcc
v_bfe_u32 v3, v0, 3, 2
v_lshlrev_b32 v3, 2, v3
v_and_or_b32 v3, v0, 3, v3
v_lshlrev_b32 v3, 3, v3
v_bfe_u32 v4, v0, 2, 2
v_lshl_add_u32 v3, v4, 7, v3
v_lshrrev_b32 v2, 4, v0
s_and_b32 s3, s32, 1
s_lshl_b32 s3, s3, 12
s_add_u32 s3, s3, 81920
v_lshl_add_u32 v4, v2, 10, v3
v_add_u32 v228, s3, v4
v_xor_b32 v229, 32, v228
v_xor_b32 v230, 64, v228
v_xor_b32 v231, 96, v228
s_mov_b32 s44, 0x0
s_mov_b32 s45, 0x1010101
s_mov_b32 s46, 0x3030303
s_mov_b32 s47, 0x7070707
s_mov_b32 s48, 0xf0f0f0f
s_mov_b32 s49, 0x1f1f1f1f
s_mov_b32 s50, 0x3f3f3f3f
s_mov_b32 s51, 0x7f7f7f7f
s_movk_i32 s54, 10240
s_mov_b32 s55, 0x07060501
s_mov_b32 s56, 0x0706000c
v_mov_b32 v5, 0xffff
v_mov_b32 v6, 0xffff0000
v_cndmask_b32 v1, 0, v5, s[44:45]
v_cndmask_b32 v4, 0, v6, s[46:47]
v_or_b32 v220, v1, v4
v_cndmask_b32 v1, 0, v5, s[48:49]
v_cndmask_b32 v4, 0, v6, s[50:51]
v_or_b32 v221, v1, v4
v_lshrrev_b32 v1, 3, v0
v_and_b32 v2, 2, v1
v_xor_b32 v2, v2, v0
s_lshl_b32 s3, s32, 2
v_xor_b32 v2, s3, v2
v_and_b32 v2, 7, v2
s_lshl_b32 s3, s36, 7
v_lshl_add_u32 v2, v2, 4, s3
v_and_b32 v3, 3, v1
v_mul_u32_u24 v3, 1280, v3
v_add_u32 v2, v3, v2
v_lshrrev_b32 v3, 5, v0
v_mul_u32_u24 v3, 5120, v3
v_sub_u32 v4, 5120, v3
v_mad_u32_u24 v56, v3, 5, v2
v_mad_u32_u24 v57, v3, 3, v2
v_mad_u32_u24 v58, v3, 13, v2
v_mad_u32_u24 v59, v4, 3, v2
v_mad_u32_u24 v60, v4, 13, v2
s_mul_i32 s3, s38, 24
v_add_u32 v1, s3, v0
s_add_u32 s3, s3, 24
s_lshl_b32 s0, s60, 3
s_min_u32 s3, s3, s0
v_cmp_gt_u32 vcc, s3, v1
v_mul_u32_u24 v1, 2560, v1
s_lshl_b32 s0, s36, 7
s_add_u32 s3, s0, s39
v_add_u32 v1, s3, v1
v_bfrev_b32 v2, 1
v_cndmask_b32 v61, v2, v1, vcc
s_lshl_b32 s3, s35, 2
s_add_u32 s3, s3, s38
s_mul_i32 s3, s3, 1280
s_add_u32 s3, s3, s0
v_mul_u32_u24 v1, 15360, v0
v_add_u32 v62, s3, v1
s_mul_i32 s3, s38, 3
v_min_u32 v1, 2, v0
v_add_u32 v1, s3, v1
v_lshrrev_b32 v2, 1, v1
v_mul_u32_u24 v2, 2304, v2
v_lshl_add_u32 v1, v1, 7, v2
s_mul_i32 s3, s43, 15360
s_lshl_b32 s0, s36, 8
s_add_u32 s3, s3, s0
s_add_u32 s3, s3, 2097152
v_add_u32 v63, s3, v1
s_mul_i32 s3, s34, 18
v_min_u32 v1, 17, v0
v_add_u32 v1, s3, v1
v_min_u32 v1, 511, v1
v_cmp_le_u32 vcc, 256, v1
v_mul_u32_u24 v1, 3072, v1
s_mul_i32 s3, s33, 384
s_add_u32 s3, s3, 1179648
v_add_u32 v1, s3, v1
v_subrev_u32 v2, 1769216, v1
v_cndmask_b32 v1, v1, v2, vcc
s_mul_i32 s3, s33, 60
s_lshl_b32 s0, s34, 1
s_add_u32 s3, s3, s0
s_and_b32 s0, s32, 1
s_add_u32 s3, s3, s0
s_lshl_b32 s3, s3, 12
v_min_u32 v2, 31, v0
v_lshl_add_u32 v2, v2, 7, s3
s_cmp_ge_u32 s32, 6
s_cselect_b64 vcc, -1, 0
v_cndmask_b32 v84, v1, v2, vcc
v_mov_b32 v176, 0
v_mov_b32 v177, 0
v_mov_b32 v178, 0
v_mov_b32 v179, 0
v_mov_b32 v180, 0
v_mov_b32 v181, 0
v_mov_b32 v182, 0
v_mov_b32 v183, 0
v_mov_b32 v184, 0
v_mov_b32 v185, 0
v_mov_b32 v186, 0
v_mov_b32 v187, 0
v_mov_b32 v188, 0
v_mov_b32 v189, 0
v_mov_b32 v190, 0
v_mov_b32 v191, 0
s_cmp_eq_u32 s32, 4
s_cbranch_scc1 L_h0
v_mov_b32 v4, 0x3f803f80
v_mov_b32 v5, v4
v_lshrrev_b32 v1, 4, v0
v_mul_u32_u24 v1, 36736, v1
v_lshl_add_u32 v1, v0, 3, v1
ds_write_b64 v1, v[4:5] offset:8192
s_sub_u32 s0, s32, 5
s_mul_i32 s3, s43, 3
s_add_u32 s3, s3, s0
s_mul_i32 s3, s3, 2560
s_add_u32 s67, s3, 2621440
s_mul_i32 s3, s35, 1280
s_add_u32 s3, s3, s59
s_add_u32 s66, s3, 12288
v_min_u32 v1, 9, v0
v_lshl_add_u32 v55, v1, 7, s66
s_lshl_b32 s68, s36, 7
s_add_u32 s68, s68, s66
v_and_b32 v1, 15, v0
v_lshrrev_b32 v2, 5, v0
v_lshl_add_u32 v2, v2, 4, v1
s_lshl_b32 s0, s0, 5
v_add_lshl_u32 v52, v2, s0, 4
v_lshrrev_b32 v2, 4, v0
v_lshrrev_b32 v3, 1, v1
v_xor_b32 v3, v3, v2
v_lshlrev_b32 v3, 4, v3
v_lshl_add_u32 v3, v1, 7, v3
v_add_u32 v54, s64, v3
s_cmp_lt_u32 s39, 2560
s_cselect_b32 s3, 128, 0
v_mov_b32 v1, 0xf149f2ca
v_cmp_gt_u32 vcc, s3, v52
s_nop 1
v_cndmask_b32 v53, 0, v1, vcc
s_setprio 1
s_add_u32 m0, s61, s64
s_mov_b32 exec_lo, s62
buffer_load_dwordx4 v24, s[4:7], s63 offen lds
s_addk_i32 m0, 1024
s_mov_b32 exec_lo, -1
buffer_load_dwordx4 v25, s[4:7], s63 offen lds
s_addk_i32 m0, 1024
s_nop 0
buffer_load_dwordx4 v26, s[4:7], s63 offen lds
s_addk_i32 m0, 1024
s_nop 0
buffer_load_dwordx4 v27, s[4:7], s63 offen lds
v_lshrrev_b32 v1, 4, v0
v_lshlrev_b32 v1, 3, v1
s_lshl_b32 s3, s36, 7
buffer_load_dwordx2 v[244:245], v1, s[28:31], s3 offen offset:0
buffer_load_dwordx2 v[246:247], v1, s[28:31], s3 offen offset:32
buffer_load_dwordx2 v[248:249], v1, s[28:31], s3 offen offset:64
buffer_load_dwordx2 v[250:251], v1, s[28:31], s3 offen offset:96
v_mov_b32 v64, 0x3f803f80
v_mov_b32 v65, 0x3f803f80
v_mov_b32 v66, 0x3f803f80
v_mov_b32 v67, 0x3f803f80
s_waitcnt vmcnt(8) lgkmcnt(0)
s_barrier
v_xor_b32 v1, 64, v54
ds_read_b128 v[36:39], v54 offset:8192
ds_read_b128 v[40:43], v1 offset:8192
ds_read_b128 v[44:47], v54 offset:10240
ds_read_b128 v[48:51], v1 offset:10240
s_lshl_b32 s3, s36, 8
s_add_u32 s3, s3, s67
v_and_b32 v2, 0xf0, v233
s_mov_b32 s0, 0xaaaaaaaa
s_mov_b32 s1, s0
s_mov_b32 vcc_lo, 0xcccccccc
s_mov_b32 vcc_hi, 0xcccccccc
s_waitcnt lgkmcnt(3)
v_mfma_f32_16x16x32_bf16 v[96:99], v[36:39], v[36:39], 0
v_mfma_f32_16x16x32_bf16 v[100:103], v[64:67], v[36:39], 0
s_waitcnt lgkmcnt(2)
v_mfma_f32_16x16x32_bf16 v[96:99], v[40:43], v[40:43], v[96:99]
v_mfma_f32_16x16x32_bf16 v[100:103], v[64:67], v[40:43], v[100:103]
s_waitcnt lgkmcnt(1)
v_mfma_f32_16x16x32_bf16 v[104:107], v[44:47], v[44:47], 0
v_mfma_f32_16x16x32_bf16 v[108:111], v[64:67], v[44:47], 0
s_waitcnt lgkmcnt(0)
v_mfma_f32_16x16x32_bf16 v[104:107], v[48:51], v[48:51], v[104:107]
v_mfma_f32_16x16x32_bf16 v[108:111], v[64:67], v[48:51], v[108:111]
s_nop 0
v_cndmask_b32 v96, v96, v97, s[0:1]
v_cndmask_b32 v98, v98, v99, s[0:1]
v_cndmask_b32 v29, v96, v98, vcc
v_mov_b32 v28, v100
s_nop 1
v_cndmask_b32 v104, v104, v105, s[0:1]
v_cndmask_b32 v106, v106, v107, s[0:1]
v_cndmask_b32 v31, v104, v106, vcc
v_mov_b32 v30, v108
s_mov_b32 exec_lo, 0xf0000f
s_mov_b32 exec_hi, 0xf0000f00
buffer_store_dwordx4 v[28:31], v2, s[16:19], s3 offen sc1
s_mov_b64 exec, -1
v_mov_b32 v44, 0
v_mov_b32 v45, 0
v_mov_b32 v46, 0
v_mov_b32 v47, 0
s_add_u32 s69, s69, 1
s_cmp_eq_u32 s69, 10
s_cselect_b32 s69, 0, s69
s_lshl_b32 s63, s69, 7
s_mov_b32 s61, 81920
s_add_u32 m0, s61, s64
s_mov_b32 exec_lo, s62
buffer_load_dwordx4 v24, s[4:7], s63 offen lds
s_addk_i32 m0, 1024
s_mov_b32 exec_lo, -1
buffer_load_dwordx4 v25, s[4:7], s63 offen lds
s_addk_i32 m0, 1024
s_nop 0
buffer_load_dwordx4 v26, s[4:7], s63 offen lds
s_addk_i32 m0, 1024
s_nop 0
buffer_load_dwordx4 v27, s[4:7], s63 offen lds
s_branch L_pb_1
.p2align 12
L_pad_2:
s_setpc_b64 s[100:101]
L_pb_1:
s_waitcnt vmcnt(5) lgkmcnt(0)
s_cmp_eq_u32 s32, 5
s_cbranch_scc0 L_o5a
s_lshl_b32 s0, s33, 5
v_and_b32 v1, 16, v0
buffer_load_dword v32, v1, s[24:27], s0 offen sc1
L_o5a:
s_barrier
s_add_u32 s69, s69, 1
s_cmp_eq_u32 s69, 10
s_cselect_b32 s69, 0, s69
s_lshl_b32 s63, s69, 7
s_mov_b32 s61, 118784
s_add_u32 m0, s61, s64
s_mov_b32 exec_lo, s62
buffer_load_dwordx4 v24, s[4:7], s63 offen lds
s_addk_i32 m0, 1024
s_mov_b32 exec_lo, -1
buffer_load_dwordx4 v25, s[4:7], s63 offen lds
s_addk_i32 m0, 1024
s_nop 0
buffer_load_dwordx4 v26, s[4:7], s63 offen lds
s_addk_i32 m0, 1024
s_nop 0
buffer_load_dwordx4 v27, s[4:7], s63 offen lds
s_cmp_eq_u32 s57, 1
s_cbranch_scc0 L_xc1
s_mov_b32 s0, 45056
s_call_b64 s[100:101], L_xcap
L_xc1:
s_cmp_eq_u32 s32, 7
s_cbranch_scc0 L_wm1
s_call_b64 s[100:101], L_pad_8
s_call_b64 s[100:101], L_pad_24
L_wm1:
s_waitcnt vmcnt(4) lgkmcnt(0)
s_barrier
s_cmp_eq_u32 s32, 5
s_cbranch_scc0 L_o5c
s_waitcnt lgkmcnt(0)
v_cmp_ne_u32 vcc, 1, v32
s_cmp_eq_u64 vcc, 0
s_cbranch_scc0 L_era
L_ega:
s_getreg_b32 s0, hwreg(HW_REG_XCC_ID, 0, 4)
v_mov_b32 v1, s0
s_mov_b64 exec, 1
buffer_store_dword v1, off, s[16:19], s68 sc1
s_mov_b64 exec, -1
L_o5c:
s_add_u32 s69, s69, 1
s_cmp_eq_u32 s69, 10
s_cselect_b32 s69, 0, s69
s_lshl_b32 s63, s69, 7
s_mov_b32 s61, 8192
s_add_u32 m0, s61, s64
s_mov_b32 exec_lo, s62
buffer_load_dwordx4 v24, s[4:7], s63 offen lds
s_addk_i32 m0, 1024
s_mov_b32 exec_lo, -1
buffer_load_dwordx4 v25, s[4:7], s63 offen lds
s_addk_i32 m0, 1024
s_nop 0
buffer_load_dwordx4 v26, s[4:7], s63 offen lds
s_addk_i32 m0, 1024
s_nop 0
buffer_load_dwordx4 v27, s[4:7], s63 offen lds
s_cmp_eq_u32 s57, 2
s_cbranch_scc0 L_xc2
s_mov_b32 s0, 81920
s_call_b64 s[100:101], L_xcap
L_xc2:
s_cmp_eq_u32 s32, 7
s_cbranch_scc0 L_wm2
s_call_b64 s[100:101], L_pad_11
s_call_b64 s[100:101], L_pad_25
L_wm2:
s_cmp_eq_u32 s32, 5
s_cbranch_scc1 L_w52
s_waitcnt vmcnt(4)
L_w52:
s_waitcnt vmcnt(5) lgkmcnt(0)
s_barrier
s_add_u32 s69, s69, 1
s_cmp_eq_u32 s69, 10
s_cselect_b32 s69, 0, s69
s_lshl_b32 s63, s69, 7
s_mov_b32 s61, 45056
s_add_u32 m0, s61, s64
s_mov_b32 exec_lo, s62
buffer_load_dwordx4 v24, s[4:7], s63 offen lds
s_addk_i32 m0, 1024
s_mov_b32 exec_lo, -1
buffer_load_dwordx4 v25, s[4:7], s63 offen lds
s_addk_i32 m0, 1024
s_nop 0
buffer_load_dwordx4 v26, s[4:7], s63 offen lds
s_addk_i32 m0, 1024
s_nop 0
buffer_load_dwordx4 v27, s[4:7], s63 offen lds
s_cmp_eq_u32 s57, 3
s_cbranch_scc0 L_xc3
s_mov_b32 s0, 118784
s_call_b64 s[100:101], L_xcap
L_xc3:
s_cmp_eq_u32 s32, 7
s_cbranch_scc0 L_wm3
s_call_b64 s[100:101], L_pad_12
L_wm3:
s_waitcnt vmcnt(4) lgkmcnt(0)
s_barrier
s_add_u32 s69, s69, 1
s_cmp_eq_u32 s69, 10
s_cselect_b32 s69, 0, s69
s_lshl_b32 s63, s69, 7
s_mov_b32 s61, 81920
s_add_u32 m0, s61, s64
s_mov_b32 exec_lo, s62
buffer_load_dwordx4 v24, s[4:7], s63 offen lds
s_addk_i32 m0, 1024
s_mov_b32 exec_lo, -1
buffer_load_dwordx4 v25, s[4:7], s63 offen lds
s_addk_i32 m0, 1024
s_nop 0
buffer_load_dwordx4 v26, s[4:7], s63 offen lds
s_addk_i32 m0, 1024
s_nop 0
buffer_load_dwordx4 v27, s[4:7], s63 offen lds
s_cmp_eq_u32 s57, 4
s_cbranch_scc0 L_xc4
s_mov_b32 s0, 8192
s_call_b64 s[100:101], L_xcap
L_xc4:
s_cmp_eq_u32 s32, 7
s_cbranch_scc0 L_wm4
s_call_b64 s[100:101], L_pad_13
L_wm4:
s_waitcnt vmcnt(4) lgkmcnt(0)
s_cmp_eq_u32 s32, 5
s_cbranch_scc0 L_o5b
s_buffer_load_dword s71, s[16:19], s66 offset:0 glc
s_buffer_load_dword s73, s[16:19], s66 offset:128 glc
s_buffer_load_dword s75, s[16:19], s66 offset:256 glc
s_buffer_load_dword s77, s[16:19], s66 offset:384 glc
s_buffer_load_dword s83, s[16:19], s66 offset:512 glc
s_buffer_load_dword s85, s[16:19], s66 offset:640 glc
s_buffer_load_dword s89, s[16:19], s66 offset:768 glc
s_buffer_load_dword s91, s[16:19], s66 offset:896 glc
s_buffer_load_dword s93, s[16:19], s66 offset:1024 glc
s_buffer_load_dword s95, s[16:19], s66 offset:1152 glc
L_o5b:
s_barrier
s_add_u32 s69, s69, 1
s_cmp_eq_u32 s69, 10
s_cselect_b32 s69, 0, s69
s_lshl_b32 s63, s69, 7
s_mov_b32 s61, 118784
s_add_u32 m0, s61, s64
s_mov_b32 exec_lo, s62
buffer_load_dwordx4 v24, s[4:7], s63 offen lds
s_addk_i32 m0, 1024
s_mov_b32 exec_lo, -1
buffer_load_dwordx4 v25, s[4:7], s63 offen lds
s_addk_i32 m0, 1024
s_nop 0
buffer_load_dwordx4 v26, s[4:7], s63 offen lds
s_addk_i32 m0, 1024
s_nop 0
buffer_load_dwordx4 v27, s[4:7], s63 offen lds
s_cmp_eq_u32 s57, 5
s_cbranch_scc0 L_xc5
s_mov_b32 s0, 45056
s_call_b64 s[100:101], L_xcap
L_xc5:
s_cmp_eq_u32 s32, 5
s_cbranch_scc0 L_o5d
s_waitcnt lgkmcnt(0)
s_max_u32 s0, s71, s73
s_max_u32 s0, s0, s75
s_max_u32 s0, s0, s77
s_max_u32 s0, s0, s83
s_max_u32 s0, s0, s85
s_max_u32 s0, s0, s89
s_max_u32 s0, s0, s91
s_max_u32 s0, s0, s93
s_max_u32 s0, s0, s95
s_cmp_lg_u32 s0, -1
s_cbranch_scc0 L_erb
L_egb:
s_min_u32 s1, s71, s73
s_min_u32 s1, s1, s75
s_min_u32 s1, s1, s77
s_min_u32 s1, s1, s83
s_min_u32 s1, s1, s85
s_min_u32 s1, s1, s89
s_min_u32 s1, s1, s91
s_min_u32 s1, s1, s93
s_min_u32 s1, s1, s95
s_cmp_eq_u32 s0, s1
s_cselect_b32 s0, 1, 0
v_mov_b32 v1, 1728
v_mov_b32 v2, s0
ds_write_b32 v1, v2
L_o5d:
s_cmp_eq_u32 s32, 7
s_cbranch_scc0 L_wm5
s_call_b64 s[100:101], L_pad_14
L_wm5:
s_waitcnt vmcnt(4) lgkmcnt(0)
s_barrier
buffer_load_dwordx4 v[36:39], v233, s[16:19], s67 offen offset:0 sc1
buffer_load_dwordx4 v[40:43], v233, s[16:19], s67 offen offset:1024 sc1
s_mov_b32 exec_hi, 0
buffer_load_dwordx4 v[44:47], v233, s[16:19], s67 offen offset:2048 sc1
s_mov_b32 exec_hi, -1
s_add_u32 s69, s69, 1
s_cmp_eq_u32 s69, 10
s_cselect_b32 s69, 0, s69
s_lshl_b32 s63, s69, 7
s_mov_b32 s61, 8192
s_add_u32 m0, s61, s64
s_mov_b32 exec_lo, s62
buffer_load_dwordx4 v24, s[4:7], s63 offen lds
s_addk_i32 m0, 1024
s_mov_b32 exec_lo, -1
buffer_load_dwordx4 v25, s[4:7], s63 offen lds
s_addk_i32 m0, 1024
s_nop 0
buffer_load_dwordx4 v26, s[4:7], s63 offen lds
s_addk_i32 m0, 1024
s_nop 0
buffer_load_dwordx4 v27, s[4:7], s63 offen lds
s_cmp_eq_u32 s57, 6
s_cbranch_scc0 L_xc6
s_mov_b32 s0, 81920
s_call_b64 s[100:101], L_xcap
L_xc6:
s_cmp_eq_u32 s32, 7
s_cbranch_scc0 L_wm6
s_call_b64 s[100:101], L_pad_21
L_wm6:
s_waitcnt vmcnt(7) lgkmcnt(0)
s_barrier
s_add_u32 s69, s69, 1
s_cmp_eq_u32 s69, 10
s_cselect_b32 s69, 0, s69
s_lshl_b32 s63, s69, 7
s_mov_b32 s61, 45056
s_add_u32 m0, s61, s64
s_mov_b32 exec_lo, s62
buffer_load_dwordx4 v24, s[4:7], s63 offen lds
s_addk_i32 m0, 1024
s_mov_b32 exec_lo, -1
buffer_load_dwordx4 v25, s[4:7], s63 offen lds
s_addk_i32 m0, 1024
s_nop 0
buffer_load_dwordx4 v26, s[4:7], s63 offen lds
s_addk_i32 m0, 1024
s_nop 0
buffer_load_dwordx4 v27, s[4:7], s63 offen lds
s_cmp_eq_u32 s57, 7
s_cbranch_scc0 L_xc7
s_mov_b32 s0, 118784
s_call_b64 s[100:101], L_xcap
L_xc7:
s_waitcnt vmcnt(8)
v_add_f32 v36, v36, v40
v_add_f32 v37, v37, v41
v_add_f32 v38, v38, v42
v_add_f32 v39, v39, v43
v_add_f32 v36, v36, v44
v_add_f32 v37, v37, v45
v_add_f32 v38, v38, v46
v_add_f32 v39, v39, v47
s_nop 0
v_permlane32_swap_b32 v36, v38
v_permlane32_swap_b32 v37, v39
v_add_f32 v36, v36, v38
v_add_f32 v37, v37, v39
v_mov_b32 v38, v36
v_mov_b32 v39, v37
s_mov_b32 s1, 0x3acccccd
v_mov_b32 v1, 0x3727c5ac
v_permlane16_swap_b32 v36, v38
v_permlane16_swap_b32 v37, v39
v_add_f32 v36, v36, v38
v_add_f32 v37, v37, v39
v_mul_f32 v36, 0xbacccccd, v36
v_fma_f32 v2, v37, s1, v1
v_fma_f32 v2, -v36, v36, v2
v_max_f32 v2, v2, v1
v_rsq_f32 v37, v2
v_mov_b32 v39, v53
v_mov_b32 v38, v37
ds_write_b128 v52, v[36:39] offset:0
s_waitcnt vmcnt(4) lgkmcnt(0)
s_barrier
s_cmp_eq_u32 s57, 8
s_cbranch_scc0 L_xc8
s_mov_b32 s0, 8192
s_call_b64 s[100:101], L_xcap
L_xc8:
L_h8:
s_mul_i32 s66, s38, 5120
s_lshl_b32 s3, s38, 10
s_add_u32 m0, s3, 81920
s_add_u32 s3, s66, 25600
buffer_load_dwordx4 v56, s[12:15], s3 offen lds
s_addk_i32 m0, 4096
s_add_u32 s3, s66, 102400
buffer_load_dwordx4 v56, s[12:15], s3 offen lds
s_addk_i32 m0, 4096
s_add_u32 s3, s66, 179200
buffer_load_dwordx4 v56, s[12:15], s3 offen lds
s_addk_i32 m0, 4096
s_add_u32 s3, s66, 256000
buffer_load_dwordx4 v56, s[12:15], s3 offen lds
s_addk_i32 m0, 4096
s_add_u32 s3, s66, 332800
buffer_load_dwordx4 v56, s[12:15], s3 offen lds
s_addk_i32 m0, 4096
s_add_u32 s3, s66, 435200
buffer_load_dwordx4 v56, s[12:15], s3 offen lds
s_addk_i32 m0, 4096
s_add_u32 s3, s66, 512000
buffer_load_dwordx4 v56, s[12:15], s3 offen lds
s_addk_i32 m0, 4096
s_add_u32 s3, s66, 588800
buffer_load_dwordx4 v56, s[12:15], s3 offen lds
v_add_u32 v1, 128, v222
v_cndmask_b32 v2, v1, v222, s[44:45]
ds_read_b64 v[168:169], v2 offset:0
v_cndmask_b32 v2, v1, v222, s[46:47]
ds_read_b64 v[170:171], v2 offset:32
v_cndmask_b32 v2, v1, v222, s[48:49]
ds_read_b64 v[172:173], v2 offset:64
v_cndmask_b32 v2, v1, v222, s[50:51]
ds_read_b64 v[174:175], v2 offset:96
ds_read_b32 v5, v223
v_mov_b32 v1, 1728
ds_read_b32 v1, v1
s_waitcnt lgkmcnt(0)
v_readfirstlane_b32 s41, v1
s_waitcnt vmcnt(8)
s_barrier
s_cmp_eq_u32 s41, 1
s_cbranch_scc0 L_gh_3g
L_gh_3b:
s_addk_i32 m0, 4096
s_add_u32 s3, s66, 665600
buffer_load_dwordx4 v56, s[12:15], s3 offen lds
s_addk_i32 m0, 4096
s_add_u32 s3, s66, 742400
buffer_load_dwordx4 v56, s[12:15], s3 offen lds
global_load_dword v84, v84, s[96:97]
v_lshlrev_b32 v8, 16, v72
v_and_b32 v9, 0xffff0000, v72
v_lshlrev_b32 v10, 16, v73
v_and_b32 v11, 0xffff0000, v73
v_lshlrev_b32 v12, 16, v74
v_and_b32 v13, 0xffff0000, v74
v_lshlrev_b32 v14, 16, v75
v_and_b32 v15, 0xffff0000, v75
v_lshlrev_b32 v16, 16, v76
v_and_b32 v17, 0xffff0000, v76
v_lshlrev_b32 v18, 16, v77
v_and_b32 v19, 0xffff0000, v77
v_lshlrev_b32 v20, 16, v78
v_and_b32 v21, 0xffff0000, v78
v_lshlrev_b32 v22, 16, v79
v_and_b32 v23, 0xffff0000, v79
s_mov_b32 s3, 0x3f803f80
v_mov_b32 v64, s3
v_mov_b32 v65, s3
v_mov_b32 v66, s3
v_mov_b32 v67, s3
s_mov_b32 exec_lo, 0x11111111
s_mov_b32 exec_hi, 0x11111111
v_mov_b32 v244, s3
v_mov_b32 v245, s3
v_mov_b32 v246, s3
v_mov_b32 v247, s3
v_mov_b32 v248, s3
v_mov_b32 v249, s3
v_mov_b32 v250, s3
v_mov_b32 v251, s3
s_mov_b64 exec, -1
v_mfma_f32_16x16x32_bf16 v[252:255], v[244:247], v[64:67], 0
v_mfma_f32_16x16x32_bf16 v[252:255], v[248:251], v[64:67], v[252:255]
s_and_b32 s3, s32, 1
s_lshl_b32 s61, s3, 7
s_xor_b32 s62, s61, 128
s_add_u32 s63, s62, s54
s_add_u32 s64, s61, s54
s_lshl_b32 s3, s3, 13
s_sub_u32 s65, 4096, s3
s_add_u32 s0, s37, 1
s_sub_u32 s1, 5, s37
s_min_u32 s0, s0, s1
s_lshl_b32 s0, s0, 4
s_sub_u32 s1, 64, s0
s_cmp_le_u32 s37, 2
s_cselect_b32 s1, s1, 16
s_bfm_b64 s[100:101], s0, s1
v_mul_f32 v5, 0x3ea52b5c, v5
s_barrier
ds_read_b64 v[96:97], v202 offset:0
ds_read_b64 v[98:99], v202 offset:1152
ds_read_b64 v[100:101], v203 offset:0
ds_read_b64 v[102:103], v203 offset:1152
ds_read_b64 v[104:105], v201 offset:0
ds_read_b64 v[106:107], v201 offset:1152
ds_read_b64 v[108:109], v200 offset:0
ds_read_b64 v[110:111], v200 offset:1152
ds_read_b64 v[112:113], v200 offset:40
ds_read_b64 v[114:115], v200 offset:1192
s_cmp_eq_u32 s38, 1
s_cbranch_scc1 L_woe1
s_cmp_eq_u32 s38, 2
s_cbranch_scc1 L_woe2
s_cmp_eq_u32 s38, 3
s_cbranch_scc1 L_woe3
s_addk_i32 m0, 4096
s_mov_b32 s3, 46080
buffer_load_dwordx4 v56, s[12:15], s3 offen lds
s_addk_i32 m0, 4096
s_mov_b32 s3, 122880
buffer_load_dwordx4 v56, s[12:15], s3 offen lds
s_addk_i32 m0, 4096
s_mov_b32 s3, 199680
buffer_load_dwordx4 v56, s[12:15], s3 offen lds
s_addk_i32 m0, 4096
s_mov_b32 s3, 276480
buffer_load_dwordx4 v56, s[12:15], s3 offen lds
s_addk_i32 m0, 4096
s_mov_b32 s3, 353280
buffer_load_dwordx4 v56, s[12:15], s3 offen lds
s_addk_i32 m0, 4096
s_mov_b32 s3, 455680
buffer_load_dwordx4 v56, s[12:15], s3 offen lds
s_addk_i32 m0, 4096
s_mov_b32 s3, 532480
buffer_load_dwordx4 v56, s[12:15], s3 offen lds
s_addk_i32 m0, 4096
s_mov_b32 s3, 609280
buffer_load_dwordx4 v56, s[12:15], s3 offen lds
s_addk_i32 m0, 4096
s_mov_b32 s3, 686080
buffer_load_dwordx4 v56, s[12:15], s3 offen lds
s_addk_i32 m0, 4096
s_mov_b32 s3, 762880
buffer_load_dwordx4 v56, s[12:15], s3 offen lds
L_woe:
buffer_load_dword v61, v61, s[20:23], 0 offen
buffer_load_dword v63, v63, s[16:19], 0 offen
s_setprio 1
s_waitcnt vmcnt(15)
s_barrier
ds_read_b64 v[116:117], v206 offset:0
ds_read_b64 v[118:119], v207 offset:0
ds_read_b64 v[120:121], v208 offset:0
ds_read_b64 v[122:123], v209 offset:0
ds_read_b64 v[124:125], v210 offset:0
ds_read_b64 v[126:127], v211 offset:0
ds_read_b64 v[128:129], v204 offset:0
ds_read_b64 v[130:131], v205 offset:0
ds_read_b64 v[132:133], v204 offset:40
ds_read_b64 v[134:135], v205 offset:40
s_waitcnt lgkmcnt(8)
v_mfma_f32_16x16x32_bf16 v[152:155], v[96:99], v[116:119], 0
ds_read_b64 v[136:137], v212 offset:0
ds_read_b64 v[138:139], v213 offset:0
s_waitcnt lgkmcnt(8)
v_mfma_f32_16x16x32_bf16 v[156:159], v[100:103], v[120:123], 0
ds_read_b64 v[140:141], v214 offset:0
ds_read_b64 v[142:143], v215 offset:0
s_waitcnt lgkmcnt(8)
v_mfma_f32_16x16x32_bf16 v[152:155], v[104:107], v[124:127], v[152:155]
s_waitcnt lgkmcnt(6)
v_mfma_f32_16x16x32_bf16 v[160:163], v[108:111], v[128:131], 0
s_waitcnt lgkmcnt(4)
v_mfma_f32_16x16x32_bf16 v[164:167], v[112:115], v[132:135], 0
s_waitcnt lgkmcnt(2)
v_mfma_f32_16x16x32_bf16 v[160:163], v[104:107], v[136:139], v[160:163]
s_waitcnt lgkmcnt(0)
v_mfma_f32_16x16x32_bf16 v[164:167], v[104:107], v[140:143], v[164:167]
v_permlane16_swap_b32 v152, v156
v_permlane16_swap_b32 v153, v157
v_permlane16_swap_b32 v154, v158
v_permlane16_swap_b32 v155, v159
v_cndmask_b32 v2, v156, v152, s[44:45]
v_cndmask_b32 v3, v157, v153, s[46:47]
v_cndmask_b32 v194, v158, v154, s[48:49]
v_cndmask_b32 v195, v159, v155, s[50:51]
v_or_b32 v192, 0xffff, v2
v_perm_b32 v193, v3, v2, s55
s_cmp_eq_u32 s41, 1
s_cbranch_scc0 L_gl_4g
buffer_store_dwordx4 v[192:195], v224, s[20:23], s54 offen
L_gl_4b:
v_permlane16_swap_b32 v160, v164
v_permlane16_swap_b32 v161, v165
v_permlane16_swap_b32 v162, v166
v_permlane16_swap_b32 v163, v167
v_cndmask_b32 v196, v164, v160, s[44:45]
v_cndmask_b32 v197, v165, v161, s[46:47]
v_cndmask_b32 v198, v166, v162, s[48:49]
v_cndmask_b32 v199, v167, v163, s[50:51]
v_fma_f32 v196, v196, v168, v169
v_fma_f32 v197, v197, v170, v171
v_fma_f32 v198, v198, v172, v173
v_fma_f32 v199, v199, v174, v175
v_max3_f32 v6, v196, v197, v198
v_max_f32 v6, v6, v199
v_mov_b32 v7, v6
s_nop 1
v_permlane32_swap_b32 v6, v7
v_max_f32 v6, v6, v7
v_mul_f32 v6, v6, v5
v_fma_f32 v196, v196, v5, -v6
v_fma_f32 v197, v197, v5, -v6
v_fma_f32 v198, v198, v5, -v6
v_fma_f32 v199, v199, v5, -v6
v_exp_f32 v196, v196
v_exp_f32 v197, v197
v_exp_f32 v198, v198
v_exp_f32 v199, v199
ds_read_b64_tr_b16 v[64:65], v216 offset:0
ds_read_b64_tr_b16 v[66:67], v216 offset:1152
ds_read_b64_tr_b16 v[68:69], v216 offset:40
ds_read_b64_tr_b16 v[70:71], v216 offset:1192
ds_read_b64_tr_b16 v[72:73], v217 offset:0
ds_read_b64_tr_b16 v[74:75], v217 offset:1152
ds_read_b64_tr_b16 v[76:77], v218 offset:0
ds_read_b64_tr_b16 v[78:79], v218 offset:1152
v_add_f32 v6, v196, v197
v_add_f32 v7, v198, v199
v_add_f32 v6, v6, v7
v_mov_b32 v7, v6
v_mul_f32 v196, v196, v168
v_mul_f32 v197, v197, v170
v_permlane32_swap_b32 v6, v7
v_mul_f32 v198, v198, v172
v_add_f32 v6, v6, v7
v_rcp_f32 v6, v6
v_mul_f32 v199, v199, v174
v_mul_f32 v196, v196, v6
v_mul_f32 v197, v197, v6
v_mul_f32 v198, v198, v6
v_mul_f32 v199, v199, v6
v_cvt_pk_bf16_f32 v196, v196, v197
v_cvt_pk_bf16_f32 v197, v198, v199
s_mov_b64 exec, s[52:53]
v_and_b32 v176, v220, v196
v_bfi_b32 v180, v220, 0, v196
v_and_b32 v177, v221, v197
v_bfi_b32 v181, v221, 0, v197
s_not_b64 exec, exec
v_and_b32 v178, v220, v196
v_bfi_b32 v182, v220, 0, v196
v_and_b32 v179, v221, v197
v_bfi_b32 v183, v221, 0, v197
s_mov_b64 exec, -1
v_permlane16_swap_b32 v176, v180
v_permlane16_swap_b32 v177, v181
v_permlane16_swap_b32 v178, v182
v_permlane16_swap_b32 v179, v183
buffer_load_dwordx4 v[92:95], v225, s[20:23], s54 offen sc1
s_waitcnt lgkmcnt(0)
v_mfma_f32_16x16x32_bf16 v[152:155], v[64:67], v[176:179], 0
v_mfma_f32_16x16x32_bf16 v[156:159], v[68:71], v[180:183], 0
v_mfma_f32_16x16x32_bf16 v[160:163], v[72:75], v[176:179], 0
v_mfma_f32_16x16x32_bf16 v[164:167], v[76:79], v[180:183], 0
s_nop 4
v_cvt_pk_bf16_f32 v196, v152, v153
v_cvt_pk_bf16_f32 v197, v154, v155
v_cvt_pk_bf16_f32 v198, v156, v157
v_cvt_pk_bf16_f32 v199, v158, v159
s_cmp_eq_u32 s41, 1
s_cbranch_scc0 L_gl_5g
buffer_store_dwordx4 v[196:199], v226, s[20:23], 0 offen
L_gl_5b:
v_cvt_pk_bf16_f32 v80, v160, v161
v_cvt_pk_bf16_f32 v81, v162, v163
v_cvt_pk_bf16_f32 v82, v164, v165
v_cvt_pk_bf16_f32 v83, v166, v167
ds_read_b64_tr_b16 v[104:105], v228 offset:0
ds_read_b64_tr_b16 v[106:107], v228 offset:512
ds_read_b64_tr_b16 v[108:109], v229 offset:0
ds_read_b64_tr_b16 v[110:111], v229 offset:512
ds_read_b64_tr_b16 v[112:113], v230 offset:0
ds_read_b64_tr_b16 v[114:115], v230 offset:512
ds_read_b64_tr_b16 v[116:117], v231 offset:0
ds_read_b64_tr_b16 v[118:119], v231 offset:512
ds_read_b64_tr_b16 v[120:121], v228 offset:8192
ds_read_b64_tr_b16 v[122:123], v228 offset:8704
ds_read_b64_tr_b16 v[124:125], v229 offset:8192
ds_read_b64_tr_b16 v[126:127], v229 offset:8704
ds_read_b64_tr_b16 v[128:129], v230 offset:8192
ds_read_b64_tr_b16 v[130:131], v230 offset:8704
ds_read_b64_tr_b16 v[132:133], v231 offset:8192
ds_read_b64_tr_b16 v[134:135], v231 offset:8704
ds_read_b64_tr_b16 v[136:137], v228 offset:16384
ds_read_b64_tr_b16 v[138:139], v228 offset:16896
ds_read_b64_tr_b16 v[140:141], v229 offset:16384
ds_read_b64_tr_b16 v[142:143], v229 offset:16896
ds_read_b64_tr_b16 v[144:145], v230 offset:16384
ds_read_b64_tr_b16 v[146:147], v230 offset:16896
ds_read_b64_tr_b16 v[148:149], v231 offset:16384
ds_read_b64_tr_b16 v[150:151], v231 offset:16896
s_waitcnt vmcnt(1)
v_cmp_eq_u32 vcc, -1, v92
s_cbranch_vccnz L_h0rh
L_h0gh:
v_mov_b32 v1, 1744
v_mov_b32 v4, 1
s_mov_b64 exec, 1
ds_add_u32 v1, v4
s_mov_b64 exec, -1
v_perm_b32 v92, v92, v93, s56
v_add_f32 v193, v3, v93
v_add_f32 v194, v194, v94
v_add_f32 v195, v195, v95
v_add_f32 v192, v2, v92
v_fma_f32 v192, v192, v168, v169
v_fma_f32 v193, v193, v170, v171
v_fma_f32 v194, v194, v172, v173
v_fma_f32 v195, v195, v174, v175
v_max3_f32 v6, v192, v193, v194
v_max_f32 v6, v6, v195
v_mov_b32 v7, v6
s_nop 1
v_permlane32_swap_b32 v6, v7
v_max_f32 v6, v6, v7
v_mul_f32 v6, v6, v5
v_fma_f32 v192, v192, v5, -v6
v_fma_f32 v193, v193, v5, -v6
v_fma_f32 v194, v194, v5, -v6
v_fma_f32 v195, v195, v5, -v6
v_exp_f32 v192, v192
v_exp_f32 v193, v193
v_exp_f32 v194, v194
v_exp_f32 v195, v195
buffer_load_dwordx4 v[24:27], v227, s[20:23], s61 offen offset:0 sc1
buffer_load_dwordx4 v[28:31], v227, s[20:23], s61 offen offset:256 sc1
buffer_load_dwordx4 v[32:35], v227, s[20:23], s61 offen offset:512 sc1
buffer_load_dwordx4 v[36:39], v227, s[20:23], s61 offen offset:768 sc1
buffer_load_dwordx4 v[40:43], v227, s[20:23], s61 offen offset:1024 sc1
buffer_load_dwordx4 v[44:47], v227, s[20:23], s62 offen offset:0 sc1
v_add_f32 v6, v192, v193
v_add_f32 v7, v194, v195
v_add_f32 v6, v6, v7
v_mov_b32 v7, v6
v_mul_f32 v192, v192, v168
v_mul_f32 v193, v193, v170
v_permlane32_swap_b32 v6, v7
v_mul_f32 v194, v194, v172
v_add_f32 v6, v6, v7
v_rcp_f32 v6, v6
v_mul_f32 v195, v195, v174
v_mul_f32 v192, v192, v6
v_mul_f32 v193, v193, v6
v_mul_f32 v194, v194, v6
v_mul_f32 v195, v195, v6
v_cvt_pk_bf16_f32 v192, v192, v193
v_cvt_pk_bf16_f32 v193, v194, v195
s_mov_b64 exec, s[52:53]
v_and_b32 v184, v220, v192
v_bfi_b32 v188, v220, 0, v192
v_and_b32 v185, v221, v193
v_bfi_b32 v189, v221, 0, v193
s_not_b64 exec, exec
v_and_b32 v186, v220, v192
v_bfi_b32 v190, v220, 0, v192
v_and_b32 v187, v221, v193
v_bfi_b32 v191, v221, 0, v193
s_mov_b64 exec, -1
v_permlane16_swap_b32 v184, v188
v_permlane16_swap_b32 v185, v189
v_permlane16_swap_b32 v186, v190
v_permlane16_swap_b32 v187, v191
s_nop 1
v_mfma_f32_16x16x32_bf16 v[152:155], v[72:75], v[184:187], 0
v_mfma_f32_16x16x32_bf16 v[156:159], v[76:79], v[184:187], 0
v_mfma_f32_16x16x32_bf16 v[160:163], v[76:79], v[188:191], 0
ds_read_b32 v1, v1
s_mov_b32 exec_lo, 0xffff0000
s_nop 3
v_cvt_pk_bf16_f32 v80, v152, v153
v_cvt_pk_bf16_f32 v81, v154, v155
v_cvt_pk_bf16_f32 v82, v156, v157
v_cvt_pk_bf16_f32 v83, v158, v159
s_mov_b64 exec, s[100:101]
v_cvt_pk_bf16_f32 v82, v160, v161
v_cvt_pk_bf16_f32 v83, v162, v163
s_mov_b64 exec, -1
s_cmp_eq_u32 s41, 1
s_cbranch_scc0 L_gl_6g
buffer_store_dwordx4 v[80:83], v226, s[20:23], s54 offen
L_gl_6b:
s_branch L_pb_7
.p2align 12
L_pad_8:
s_setpc_b64 s[100:101]
L_pb_7:
s_lshl_b32 s0, s38, 12
s_add_u32 s0, s0, 57344
v_add_u32 v4, s0, v233
s_and_b32 s0, s38, 2
s_lshl_b32 s0, s0, 1
s_add_u32 s0, s0, 1760
v_mov_b32 v3, s0
v_mov_b32 v5, 1
s_waitcnt lgkmcnt(0)
v_cmp_ne_u32 vcc, 4, v1
s_cbranch_vccnz L_spw
L_sbw:
s_waitcnt vmcnt(5)
v_max_u16 v2, v24, v28
v_cmp_eq_u16 vcc, -1, v2
s_cbranch_vccnz L_st0
L_go0:
v_mfma_f32_16x16x32_bf16 v[8:11], v[104:107], v[24:27], v[8:11]
buffer_load_dwordx4 v[48:51], v236, s[20:23], s62 offen offset:0 sc1
ds_read_b64_tr_b16 v[152:153], v228 offset:24576
v_mfma_f32_16x16x32_bf16 v[12:15], v[108:111], v[24:27], v[12:15]
ds_read_b64_tr_b16 v[154:155], v228 offset:25088
ds_read_b64_tr_b16 v[156:157], v229 offset:24576
v_mfma_f32_16x16x32_bf16 v[16:19], v[112:115], v[24:27], v[16:19]
ds_read_b64_tr_b16 v[158:159], v229 offset:25088
ds_read_b64_tr_b16 v[160:161], v230 offset:24576
v_mfma_f32_16x16x32_bf16 v[20:23], v[116:119], v[24:27], v[20:23]
ds_read_b64_tr_b16 v[162:163], v230 offset:25088
ds_read_b64_tr_b16 v[164:165], v231 offset:24576
v_mfma_f32_16x16x32_bf16 v[8:11], v[120:123], v[28:31], v[8:11]
buffer_load_dwordx4 v[52:55], v227, s[20:23], s62 offen offset:256 sc1
ds_read_b64_tr_b16 v[166:167], v231 offset:25088
v_mfma_f32_16x16x32_bf16 v[12:15], v[124:127], v[28:31], v[12:15]
ds_read_b64_tr_b16 v[168:169], v228 offset:32768
s_waitcnt vmcnt(5)
v_max_u16 v2, v32, v36
v_cmp_eq_u16 vcc, -1, v2
v_mfma_f32_16x16x32_bf16 v[16:19], v[128:131], v[28:31], v[16:19]
ds_read_b64_tr_b16 v[170:171], v228 offset:33280
s_cbranch_vccnz L_st1
L_go1:
v_mfma_f32_16x16x32_bf16 v[20:23], v[132:135], v[28:31], v[20:23]
ds_read_b64_tr_b16 v[172:173], v229 offset:32768
v_mfma_f32_16x16x32_bf16 v[8:11], v[136:139], v[32:35], v[8:11]
buffer_load_dwordx4 v[56:59], v236, s[20:23], s62 offen offset:256 sc1
ds_read_b64_tr_b16 v[174:175], v229 offset:33280
v_mfma_f32_16x16x32_bf16 v[12:15], v[140:143], v[32:35], v[12:15]
ds_read_b64_tr_b16 v[176:177], v230 offset:32768
ds_read_b64_tr_b16 v[178:179], v230 offset:33280
v_mfma_f32_16x16x32_bf16 v[16:19], v[144:147], v[32:35], v[16:19]
ds_read_b64_tr_b16 v[180:181], v231 offset:32768
ds_read_b64_tr_b16 v[182:183], v231 offset:33280
v_mfma_f32_16x16x32_bf16 v[20:23], v[148:151], v[32:35], v[20:23]
v_add_u32 v228, s65, v228
ds_read_b64_tr_b16 v[184:185], v228 offset:0
ds_read_b64_tr_b16 v[186:187], v228 offset:512
s_waitcnt lgkmcnt(10)
v_mfma_f32_16x16x32_bf16 v[8:11], v[152:155], v[36:39], v[8:11]
buffer_load_dwordx4 v[60:63], v227, s[20:23], s62 offen offset:512 sc1
v_add_u32 v229, s65, v229
ds_read_b64_tr_b16 v[188:189], v229 offset:0
v_mfma_f32_16x16x32_bf16 v[12:15], v[156:159], v[36:39], v[12:15]
buffer_load_dwordx4 v[64:67], v236, s[20:23], s62 offen offset:512 sc1
ds_read_b64_tr_b16 v[190:191], v229 offset:512
s_waitcnt vmcnt(7)
v_cmp_eq_u16 vcc, -1, v40
v_mfma_f32_16x16x32_bf16 v[16:19], v[160:163], v[36:39], v[16:19]
v_add_u32 v230, s65, v230
ds_read_b64_tr_b16 v[192:193], v230 offset:0
s_cbranch_vccnz L_st2
L_go2:
v_mfma_f32_16x16x32_bf16 v[20:23], v[164:167], v[36:39], v[20:23]
ds_read_b64_tr_b16 v[194:195], v230 offset:512
s_waitcnt lgkmcnt(6)
v_mfma_f32_16x16x32_bf16 v[8:11], v[168:171], v[40:43], v[8:11]
buffer_load_dwordx4 v[68:71], v227, s[20:23], s62 offen offset:768 sc1
v_add_u32 v231, s65, v231
ds_read_b64_tr_b16 v[196:197], v231 offset:0
v_mfma_f32_16x16x32_bf16 v[12:15], v[172:175], v[40:43], v[12:15]
buffer_load_dwordx4 v[72:75], v236, s[20:23], s62 offen offset:768 sc1
ds_read_b64_tr_b16 v[198:199], v231 offset:512
s_waitcnt vmcnt(6)
v_max_u16 v2, v44, v48
v_cmp_eq_u16 vcc, -1, v2
v_mfma_f32_16x16x32_bf16 v[16:19], v[176:179], v[40:43], v[16:19]
ds_read_b64_tr_b16 v[104:105], v228 offset:8192
s_cbranch_vccnz L_st3
L_go3:
v_mfma_f32_16x16x32_bf16 v[20:23], v[180:183], v[40:43], v[20:23]
ds_read_b64_tr_b16 v[106:107], v228 offset:8704
s_waitcnt lgkmcnt(8)
v_mfma_f32_16x16x32_bf16 v[8:11], v[184:187], v[44:47], v[8:11]
buffer_load_dwordx4 v[76:79], v227, s[20:23], s62 offen offset:1024 sc1
ds_read_b64_tr_b16 v[108:109], v229 offset:8192
v_mfma_f32_16x16x32_bf16 v[200:203], v[184:187], v[48:51], 0
ds_read_b64_tr_b16 v[110:111], v229 offset:8704
ds_read_b64_tr_b16 v[112:113], v230 offset:8192
s_waitcnt lgkmcnt(9)
v_mfma_f32_16x16x32_bf16 v[12:15], v[188:191], v[44:47], v[12:15]
ds_read_b64_tr_b16 v[114:115], v230 offset:8704
ds_read_b64_tr_b16 v[116:117], v231 offset:8192
v_mfma_f32_16x16x32_bf16 v[204:207], v[188:191], v[48:51], 0
ds_read_b64_tr_b16 v[118:119], v231 offset:8704
ds_read_b64_tr_b16 v[120:121], v228 offset:16384
s_waitcnt lgkmcnt(11)
v_mfma_f32_16x16x32_bf16 v[16:19], v[192:195], v[44:47], v[16:19]
buffer_load_dwordx4 v[80:83], v236, s[20:23], s62 offen offset:1024 sc1
ds_read_b64_tr_b16 v[122:123], v228 offset:16896
v_mfma_f32_16x16x32_bf16 v[208:211], v[192:195], v[48:51], 0
ds_read_b64_tr_b16 v[124:125], v229 offset:16384
s_waitcnt vmcnt(6)
v_max_u16 v2, v52, v56
v_cmp_eq_u16 vcc, -1, v2
s_waitcnt lgkmcnt(11)
v_mfma_f32_16x16x32_bf16 v[20:23], v[196:199], v[44:47], v[20:23]
ds_read_b64_tr_b16 v[126:127], v229 offset:16896
s_cbranch_vccnz L_st4
L_go4:
v_mfma_f32_16x16x32_bf16 v[212:215], v[196:199], v[48:51], 0
ds_read_b64_tr_b16 v[128:129], v230 offset:16384
s_waitcnt lgkmcnt(11)
v_mfma_f32_16x16x32_bf16 v[8:11], v[104:107], v[52:55], v[8:11]
buffer_load_dwordx4 v[84:87], v227, s[20:23], s63 offen offset:0 sc1
ds_read_b64_tr_b16 v[130:131], v230 offset:16896
s_waitcnt lgkmcnt(6)
v_mfma_f32_16x16x32_bf16 v[200:203], v[104:107], v[56:59], v[200:203]
ds_read_b64_tr_b16 v[132:133], v231 offset:16384
ds_read_b64_tr_b16 v[134:135], v231 offset:16896
v_mfma_f32_16x16x32_bf16 v[12:15], v[108:111], v[52:55], v[12:15]
ds_read_b64_tr_b16 v[136:137], v228 offset:24576
ds_read_b64_tr_b16 v[138:139], v228 offset:25088
v_mfma_f32_16x16x32_bf16 v[204:207], v[108:111], v[56:59], v[204:207]
ds_read_b64_tr_b16 v[140:141], v229 offset:24576
ds_read_b64_tr_b16 v[142:143], v229 offset:25088
v_mfma_f32_16x16x32_bf16 v[16:19], v[112:115], v[52:55], v[16:19]
buffer_load_dwordx4 v[88:91], v236, s[20:23], s63 offen offset:0 sc1
ds_read_b64_tr_b16 v[144:145], v230 offset:24576
v_mfma_f32_16x16x32_bf16 v[208:211], v[112:115], v[56:59], v[208:211]
ds_read_b64_tr_b16 v[146:147], v230 offset:25088
s_waitcnt vmcnt(6)
v_max_u16 v2, v60, v64
v_cmp_eq_u16 vcc, -1, v2
v_mfma_f32_16x16x32_bf16 v[20:23], v[116:119], v[52:55], v[20:23]
ds_read_b64_tr_b16 v[148:149], v231 offset:24576
s_cbranch_vccnz L_st5
L_go5:
v_mfma_f32_16x16x32_bf16 v[212:215], v[116:119], v[56:59], v[212:215]
ds_read_b64_tr_b16 v[150:151], v231 offset:25088
s_waitcnt lgkmcnt(8)
v_mfma_f32_16x16x32_bf16 v[8:11], v[120:123], v[60:63], v[8:11]
buffer_load_dwordx4 v[92:95], v227, s[20:23], s63 offen offset:256 sc1
ds_read_b64_tr_b16 v[152:153], v228 offset:32768
v_mfma_f32_16x16x32_bf16 v[200:203], v[120:123], v[64:67], v[200:203]
ds_read_b64_tr_b16 v[154:155], v228 offset:33280
ds_read_b64_tr_b16 v[156:157], v229 offset:32768
v_mfma_f32_16x16x32_bf16 v[12:15], v[124:127], v[60:63], v[12:15]
ds_read_b64_tr_b16 v[158:159], v229 offset:33280
ds_read_b64_tr_b16 v[160:161], v230 offset:32768
v_mfma_f32_16x16x32_bf16 v[204:207], v[124:127], v[64:67], v[204:207]
ds_read_b64_tr_b16 v[162:163], v230 offset:33280
ds_read_b64_tr_b16 v[164:165], v231 offset:32768
v_mfma_f32_16x16x32_bf16 v[16:19], v[128:131], v[60:63], v[16:19]
buffer_load_dwordx4 v[96:99], v236, s[20:23], s63 offen offset:256 sc1
ds_read_b64_tr_b16 v[166:167], v231 offset:33280
v_mfma_f32_16x16x32_bf16 v[208:211], v[128:131], v[64:67], v[208:211]
v_add_u32 v228, 40960, v228
ds_read_b64_tr_b16 v[168:169], v228 offset:0
s_waitcnt vmcnt(6)
v_max_u16 v2, v68, v72
v_cmp_eq_u16 vcc, -1, v2
v_mfma_f32_16x16x32_bf16 v[20:23], v[132:135], v[60:63], v[20:23]
ds_read_b64_tr_b16 v[170:171], v228 offset:512
s_cbranch_vccnz L_st6
L_go6:
v_mfma_f32_16x16x32_bf16 v[212:215], v[132:135], v[64:67], v[212:215]
v_add_u32 v229, 40960, v229
ds_read_b64_tr_b16 v[172:173], v229 offset:0
s_waitcnt lgkmcnt(11)
v_mfma_f32_16x16x32_bf16 v[8:11], v[136:139], v[68:71], v[8:11]
buffer_load_dwordx4 v[100:103], v227, s[20:23], s63 offen offset:512 sc1
ds_read_b64_tr_b16 v[174:175], v229 offset:512
v_mfma_f32_16x16x32_bf16 v[200:203], v[136:139], v[72:75], v[200:203]
v_add_u32 v230, 40960, v230
ds_read_b64_tr_b16 v[176:177], v230 offset:0
ds_read_b64_tr_b16 v[178:179], v230 offset:512
v_mfma_f32_16x16x32_bf16 v[12:15], v[140:143], v[68:71], v[12:15]
v_add_u32 v231, 40960, v231
ds_read_b64_tr_b16 v[180:181], v231 offset:0
ds_read_b64_tr_b16 v[182:183], v231 offset:512
v_mfma_f32_16x16x32_bf16 v[204:207], v[140:143], v[72:75], v[204:207]
ds_read_b64_tr_b16 v[184:185], v228 offset:8192
ds_read_b64_tr_b16 v[186:187], v228 offset:8704
v_mfma_f32_16x16x32_bf16 v[16:19], v[144:147], v[68:71], v[16:19]
buffer_load_dwordx4 v[24:27], v236, s[20:23], s63 offen offset:512 sc1
ds_read_b64_tr_b16 v[188:189], v229 offset:8192
v_mfma_f32_16x16x32_bf16 v[208:211], v[144:147], v[72:75], v[208:211]
ds_read_b64_tr_b16 v[190:191], v229 offset:8704
s_waitcnt vmcnt(6)
v_max_u16 v2, v76, v80
v_cmp_eq_u16 vcc, -1, v2
v_mfma_f32_16x16x32_bf16 v[20:23], v[148:151], v[68:71], v[20:23]
ds_read_b64_tr_b16 v[192:193], v230 offset:8192
s_cbranch_vccnz L_st7
L_go7:
v_mfma_f32_16x16x32_bf16 v[212:215], v[148:151], v[72:75], v[212:215]
ds_read_b64_tr_b16 v[194:195], v230 offset:8704
s_waitcnt lgkmcnt(14)
v_mfma_f32_16x16x32_bf16 v[8:11], v[152:155], v[76:79], v[8:11]
buffer_load_dwordx4 v[28:31], v236, s[20:23], s63 offen offset:768 sc1
ds_read_b64_tr_b16 v[196:197], v231 offset:8192
v_mfma_f32_16x16x32_bf16 v[200:203], v[152:155], v[80:83], v[200:203]
ds_read_b64_tr_b16 v[198:199], v231 offset:8704
ds_read_b64_tr_b16 v[104:105], v228 offset:16384
v_mfma_f32_16x16x32_bf16 v[12:15], v[156:159], v[76:79], v[12:15]
ds_read_b64_tr_b16 v[106:107], v228 offset:16896
ds_read_b64_tr_b16 v[108:109], v229 offset:16384
v_mfma_f32_16x16x32_bf16 v[204:207], v[156:159], v[80:83], v[204:207]
ds_read_b64_tr_b16 v[110:111], v229 offset:16896
ds_read_b64_tr_b16 v[112:113], v230 offset:16384
v_mfma_f32_16x16x32_bf16 v[16:19], v[160:163], v[76:79], v[16:19]
buffer_load_dwordx4 v[32:35], v236, s[20:23], s63 offen offset:1024 sc1
ds_read_b64_tr_b16 v[114:115], v230 offset:16896
v_mfma_f32_16x16x32_bf16 v[208:211], v[160:163], v[80:83], v[208:211]
ds_read_b64_tr_b16 v[116:117], v231 offset:16384
s_waitcnt vmcnt(6)
v_max_u16 v2, v84, v88
v_cmp_eq_u16 vcc, -1, v2
v_mfma_f32_16x16x32_bf16 v[20:23], v[164:167], v[76:79], v[20:23]
ds_read_b64_tr_b16 v[118:119], v231 offset:16896
s_cbranch_vccnz L_st8
L_go8:
v_mfma_f32_16x16x32_bf16 v[212:215], v[164:167], v[80:83], v[212:215]
ds_read_b64_tr_b16 v[120:121], v228 offset:24576
s_waitcnt lgkmcnt(15)
v_mfma_f32_16x16x32_bf16 v[8:11], v[168:171], v[84:87], v[8:11]
buffer_load_dwordx4 v[36:39], v227, s[20:23], s63 offen offset:768 sc1
ds_read_b64_tr_b16 v[122:123], v228 offset:25088
v_mfma_f32_16x16x32_bf16 v[200:203], v[168:171], v[88:91], v[200:203]
ds_read_b64_tr_b16 v[124:125], v229 offset:24576
ds_read_b64_tr_b16 v[126:127], v229 offset:25088
v_mfma_f32_16x16x32_bf16 v[12:15], v[172:175], v[84:87], v[12:15]
ds_read_b64_tr_b16 v[128:129], v230 offset:24576
ds_read_b64_tr_b16 v[130:131], v230 offset:25088
v_mfma_f32_16x16x32_bf16 v[204:207], v[172:175], v[88:91], v[204:207]
ds_read_b64_tr_b16 v[132:133], v231 offset:24576
ds_read_b64_tr_b16 v[134:135], v231 offset:25088
v_mfma_f32_16x16x32_bf16 v[16:19], v[176:179], v[84:87], v[16:19]
buffer_load_dwordx4 v[40:43], v227, s[20:23], s63 offen offset:1024 sc1
ds_read_b64_tr_b16 v[136:137], v228 offset:32768
v_mfma_f32_16x16x32_bf16 v[208:211], v[176:179], v[88:91], v[208:211]
ds_read_b64_tr_b16 v[138:139], v228 offset:33280
s_waitcnt vmcnt(6)
v_max_u16 v2, v92, v96
v_cmp_eq_u16 vcc, -1, v2
v_mfma_f32_16x16x32_bf16 v[20:23], v[180:183], v[84:87], v[20:23]
ds_read_b64_tr_b16 v[140:141], v229 offset:32768
s_cbranch_vccnz L_st9
L_go9:
v_mfma_f32_16x16x32_bf16 v[212:215], v[180:183], v[88:91], v[212:215]
ds_read_b64_tr_b16 v[142:143], v229 offset:33280
s_waitcnt lgkmcnt(15)
v_mfma_f32_16x16x32_bf16 v[8:11], v[184:187], v[92:95], v[8:11]
buffer_load_dwordx4 v[44:47], v227, s[20:23], s64 offen offset:0 sc1
ds_read_b64_tr_b16 v[144:145], v230 offset:32768
v_mfma_f32_16x16x32_bf16 v[200:203], v[184:187], v[96:99], v[200:203]
ds_read_b64_tr_b16 v[146:147], v230 offset:33280
ds_read_b64_tr_b16 v[148:149], v231 offset:32768
v_mfma_f32_16x16x32_bf16 v[12:15], v[188:191], v[92:95], v[12:15]
ds_read_b64_tr_b16 v[150:151], v231 offset:33280
v_subrev_u32 v228, s65, v228
ds_read_b64_tr_b16 v[152:153], v228 offset:0
v_mfma_f32_16x16x32_bf16 v[204:207], v[188:191], v[96:99], v[204:207]
ds_read_b64_tr_b16 v[154:155], v228 offset:512
v_subrev_u32 v229, s65, v229
ds_read_b64_tr_b16 v[156:157], v229 offset:0
v_mfma_f32_16x16x32_bf16 v[16:19], v[192:195], v[92:95], v[16:19]
buffer_load_dwordx4 v[48:51], v227, s[20:23], s64 offen offset:256 sc1
ds_read_b64_tr_b16 v[158:159], v229 offset:512
v_mfma_f32_16x16x32_bf16 v[208:211], v[192:195], v[96:99], v[208:211]
v_subrev_u32 v230, s65, v230
ds_read_b64_tr_b16 v[160:161], v230 offset:0
s_waitcnt vmcnt(6)
v_max_u16 v2, v100, v24
v_cmp_eq_u16 vcc, -1, v2
v_mfma_f32_16x16x32_bf16 v[20:23], v[196:199], v[92:95], v[20:23]
ds_read_b64_tr_b16 v[162:163], v230 offset:512
s_cbranch_vccnz L_st10
L_go10:
v_mfma_f32_16x16x32_bf16 v[212:215], v[196:199], v[96:99], v[212:215]
v_subrev_u32 v231, s65, v231
ds_read_b64_tr_b16 v[164:165], v231 offset:0
s_waitcnt lgkmcnt(15)
v_mfma_f32_16x16x32_bf16 v[8:11], v[104:107], v[100:103], v[8:11]
buffer_load_dwordx4 v[52:55], v227, s[20:23], s64 offen offset:512 sc1
ds_read_b64_tr_b16 v[166:167], v231 offset:512
v_mfma_f32_16x16x32_bf16 v[200:203], v[104:107], v[24:27], v[200:203]
ds_read_b64_tr_b16 v[168:169], v228 offset:8192
ds_read_b64_tr_b16 v[170:171], v228 offset:8704
v_mfma_f32_16x16x32_bf16 v[12:15], v[108:111], v[100:103], v[12:15]
ds_read_b64_tr_b16 v[172:173], v229 offset:8192
ds_read_b64_tr_b16 v[174:175], v229 offset:8704
v_mfma_f32_16x16x32_bf16 v[204:207], v[108:111], v[24:27], v[204:207]
ds_read_b64_tr_b16 v[176:177], v230 offset:8192
ds_read_b64_tr_b16 v[178:179], v230 offset:8704
v_mfma_f32_16x16x32_bf16 v[16:19], v[112:115], v[100:103], v[16:19]
buffer_load_dwordx4 v[56:59], v227, s[20:23], s64 offen offset:768 sc1
ds_read_b64_tr_b16 v[180:181], v231 offset:8192
v_mfma_f32_16x16x32_bf16 v[208:211], v[112:115], v[24:27], v[208:211]
ds_read_b64_tr_b16 v[182:183], v231 offset:8704
s_waitcnt vmcnt(6)
v_max_u16 v2, v28, v32
v_cmp_eq_u16 vcc, -1, v2
v_mfma_f32_16x16x32_bf16 v[20:23], v[116:119], v[100:103], v[20:23]
ds_read_b64_tr_b16 v[184:185], v228 offset:16384
s_cbranch_vccnz L_st11
L_go11:
v_mfma_f32_16x16x32_bf16 v[212:215], v[116:119], v[24:27], v[212:215]
ds_read_b64_tr_b16 v[186:187], v228 offset:16896
v_mfma_f32_16x16x32_bf16 v[200:203], v[120:123], v[28:31], v[200:203]
buffer_load_dwordx4 v[60:63], v227, s[20:23], s64 offen offset:1024 sc1
ds_read_b64_tr_b16 v[188:189], v229 offset:16384
v_mfma_f32_16x16x32_bf16 v[204:207], v[124:127], v[28:31], v[204:207]
ds_read_b64_tr_b16 v[190:191], v229 offset:16896
ds_read_b64_tr_b16 v[192:193], v230 offset:16384
v_mfma_f32_16x16x32_bf16 v[208:211], v[128:131], v[28:31], v[208:211]
ds_read_b64_tr_b16 v[194:195], v230 offset:16896
ds_read_b64_tr_b16 v[196:197], v231 offset:16384
v_mfma_f32_16x16x32_bf16 v[212:215], v[132:135], v[28:31], v[212:215]
ds_read_b64_tr_b16 v[198:199], v231 offset:16896
ds_read_b64_tr_b16 v[104:105], v228 offset:24576
s_waitcnt lgkmcnt(15)
v_mfma_f32_16x16x32_bf16 v[200:203], v[136:139], v[32:35], v[200:203]
ds_read_b64_tr_b16 v[106:107], v228 offset:25088
ds_read_b64_tr_b16 v[108:109], v229 offset:24576
v_mfma_f32_16x16x32_bf16 v[204:207], v[140:143], v[32:35], v[204:207]
ds_read_b64_tr_b16 v[110:111], v229 offset:25088
s_waitcnt vmcnt(5)
v_max_u16 v2, v36, v40
v_cmp_eq_u16 vcc, -1, v2
v_mfma_f32_16x16x32_bf16 v[208:211], v[144:147], v[32:35], v[208:211]
ds_read_b64_tr_b16 v[112:113], v230 offset:24576
s_cbranch_vccnz L_st12
L_go12:
v_mfma_f32_16x16x32_bf16 v[212:215], v[148:151], v[32:35], v[212:215]
ds_read_b64_tr_b16 v[114:115], v230 offset:25088
v_mfma_f32_16x16x32_bf16 v[8:11], v[120:123], v[36:39], v[8:11]
ds_read_b64_tr_b16 v[116:117], v231 offset:24576
ds_read_b64_tr_b16 v[118:119], v231 offset:25088
v_mfma_f32_16x16x32_bf16 v[12:15], v[124:127], v[36:39], v[12:15]
ds_write_b128 v4, v[200:203] offset:0
v_mfma_f32_16x16x32_bf16 v[16:19], v[128:131], v[36:39], v[16:19]
ds_write_b128 v4, v[204:207] offset:1024
v_mfma_f32_16x16x32_bf16 v[20:23], v[132:135], v[36:39], v[20:23]
ds_write_b128 v4, v[208:211] offset:2048
v_mfma_f32_16x16x32_bf16 v[8:11], v[136:139], v[40:43], v[8:11]
ds_read_b64_tr_b16 v[120:121], v228 offset:32768
ds_read_b64_tr_b16 v[122:123], v228 offset:33280
v_mfma_f32_16x16x32_bf16 v[12:15], v[140:143], v[40:43], v[12:15]
ds_read_b64_tr_b16 v[124:125], v229 offset:32768
s_waitcnt vmcnt(3)
v_max_u16 v2, v44, v48
v_cmp_eq_u16 vcc, -1, v2
v_mfma_f32_16x16x32_bf16 v[16:19], v[144:147], v[40:43], v[16:19]
ds_write_b128 v4, v[212:215] offset:3072
s_cbranch_vccnz L_st13
L_go13:
v_mfma_f32_16x16x32_bf16 v[20:23], v[148:151], v[40:43], v[20:23]
s_mov_b64 exec, 1
ds_add_u32 v3, v5
s_mov_b64 exec, -1
v_mfma_f32_16x16x32_bf16 v[8:11], v[152:155], v[44:47], v[8:11]
ds_read_b64_tr_b16 v[126:127], v229 offset:33280
ds_read_b64_tr_b16 v[128:129], v230 offset:32768
v_mfma_f32_16x16x32_bf16 v[12:15], v[156:159], v[44:47], v[12:15]
ds_read_b64_tr_b16 v[130:131], v230 offset:33280
ds_read_b64_tr_b16 v[132:133], v231 offset:32768
v_mfma_f32_16x16x32_bf16 v[16:19], v[160:163], v[44:47], v[16:19]
ds_read_b64_tr_b16 v[134:135], v231 offset:33280
v_mfma_f32_16x16x32_bf16 v[20:23], v[164:167], v[44:47], v[20:23]
s_waitcnt lgkmcnt(15)
v_mfma_f32_16x16x32_bf16 v[8:11], v[168:171], v[48:51], v[8:11]
v_mfma_f32_16x16x32_bf16 v[12:15], v[172:175], v[48:51], v[12:15]
s_waitcnt vmcnt(1)
v_max_u16 v2, v52, v56
v_cmp_eq_u16 vcc, -1, v2
v_mfma_f32_16x16x32_bf16 v[16:19], v[176:179], v[48:51], v[16:19]
s_cbranch_vccnz L_st14
L_go14:
v_mfma_f32_16x16x32_bf16 v[20:23], v[180:183], v[48:51], v[20:23]
v_mfma_f32_16x16x32_bf16 v[8:11], v[184:187], v[52:55], v[8:11]
v_mfma_f32_16x16x32_bf16 v[12:15], v[188:191], v[52:55], v[12:15]
v_mfma_f32_16x16x32_bf16 v[16:19], v[192:195], v[52:55], v[16:19]
v_mfma_f32_16x16x32_bf16 v[20:23], v[196:199], v[52:55], v[20:23]
s_waitcnt lgkmcnt(13)
v_mfma_f32_16x16x32_bf16 v[8:11], v[104:107], v[56:59], v[8:11]
v_mfma_f32_16x16x32_bf16 v[12:15], v[108:111], v[56:59], v[12:15]
s_waitcnt vmcnt(0)
v_cmp_eq_u16 vcc, -1, v60
v_mfma_f32_16x16x32_bf16 v[16:19], v[112:115], v[56:59], v[16:19]
s_cbranch_vccnz L_st15
L_go15:
v_mfma_f32_16x16x32_bf16 v[20:23], v[116:119], v[56:59], v[20:23]
s_waitcnt lgkmcnt(8)
v_mfma_f32_16x16x32_bf16 v[8:11], v[120:123], v[60:63], v[8:11]
s_waitcnt lgkmcnt(4)
v_mfma_f32_16x16x32_bf16 v[12:15], v[124:127], v[60:63], v[12:15]
s_waitcnt lgkmcnt(2)
v_mfma_f32_16x16x32_bf16 v[16:19], v[128:131], v[60:63], v[16:19]
s_waitcnt lgkmcnt(0)
v_mfma_f32_16x16x32_bf16 v[20:23], v[132:135], v[60:63], v[20:23]
L_tail:
s_nop 1
v_cvt_pk_bf16_f32 v24, v8, v9
v_cvt_pk_bf16_f32 v25, v10, v11
v_cvt_pk_bf16_f32 v26, v12, v13
v_cvt_pk_bf16_f32 v27, v14, v15
v_cvt_pk_bf16_f32 v28, v16, v17
v_cvt_pk_bf16_f32 v29, v18, v19
v_cvt_pk_bf16_f32 v30, v20, v21
v_cvt_pk_bf16_f32 v31, v22, v23
v_mfma_f32_16x16x32_bf16 v[36:39], v[24:27], v[24:27], 0
v_mfma_f32_16x16x32_bf16 v[32:35], v[244:247], v[24:27], 0
v_mfma_f32_16x16x32_bf16 v[36:39], v[28:31], v[28:31], v[36:39]
v_mfma_f32_16x16x32_bf16 v[32:35], v[248:251], v[28:31], v[32:35]
s_mov_b32 s0, 0x22222222
s_mov_b32 s1, s0
s_mov_b32 s44, 0x44444444
s_mov_b32 s45, s44
s_mov_b32 vcc_lo, 0x88888888
s_mov_b32 vcc_hi, 0x88888888
s_lshl_b32 s3, s36, 8
s_add_u32 s3, s3, s58
v_and_b32 v1, 0xf0, v233
v_cndmask_b32 v36, v36, v37, s[0:1]
v_cndmask_b32 v38, v38, v39, vcc
s_or_b64 vcc, vcc, s[44:45]
v_cndmask_b32 v34, v36, v38, vcc
v_mov_b32 v35, v253
s_mov_b32 exec_lo, 0xf0000f
s_mov_b32 exec_hi, 0xf0000f00
s_cmp_eq_u32 s41, 1
s_cbranch_scc0 L_gl_9g
buffer_store_dwordx4 v[32:35], v1, s[16:19], s3 offen
L_gl_9b:
s_mov_b64 exec, -1
v_mov_b32 v48, 0
v_mov_b32 v49, 0
v_mov_b32 v50, 0
v_mov_b32 v51, 0
v_mov_b32 v4, 1.0
s_mov_b32 s0, 0xbacccccd
s_mov_b32 s1, 0x3acccccd
v_mov_b32 v5, 0x3727c5ac
s_mov_b32 s44, 0xfffff800
v_mov_b32 v1, 1732
v_cmp_le_i32 s[46:47], 0, v232
s_mul_i32 s48, s35, 1280
s_lshl_b32 s3, s36, 7
s_add_u32 s48, s48, s3
s_lshl_b32 s49, s48, 1
s_add_u32 s48, s48, s59
s_add_u32 s49, s49, s59
s_add_u32 s49, s49, 4096
s_lshl_b32 s3, s35, 7
s_add_u32 s3, s3, s59
s_add_u32 s3, s3, 21504
s_lshl_b32 s45, s36, 3
s_add_u32 s45, s45, s32
v_mul_u32_u24 v70, 384, v0
v_and_b32 v69, 48, v0
v_lshlrev_b32 v68, 1, v69
L_e2:
buffer_load_dwordx4 v[40:43], v233, s[16:19], s58 offen sc1
buffer_load_dwordx4 v[44:47], v233, s[16:19], s58 offen offset:1024 sc1
s_mov_b32 exec_hi, 0
buffer_load_dwordx4 v[48:51], v233, s[16:19], s58 offen offset:2048 sc1
s_mov_b32 exec_hi, -1
s_sub_u32 s40, s40, 1
s_waitcnt vmcnt(1)
v_pk_add_f32 v[40:41], v[40:41], v[44:45]
v_pk_add_f32 v[42:43], v[42:43], v[46:47]
s_waitcnt vmcnt(0)
v_pk_add_f32 v[40:41], v[40:41], v[48:49]
v_pk_add_f32 v[42:43], v[42:43], v[50:51]
v_cmp_u_f32 vcc, v40, v40
s_cbranch_scc1 L_e2go
s_cbranch_vccnz L_e2
L_e2go:
v_mfma_f32_16x16x4_f32 v[52:55], v4, v40, 0
v_mfma_f32_16x16x4_f32 v[60:63], v4, v42, 0
v_mfma_f32_16x16x4_f32 v[64:67], v4, v43, 0
v_mfma_f32_16x16x4_f32 v[56:59], v4, v41, 0
s_nop 6
v_mul_f32 v6, s0, v52
v_fma_f32 v7, v60, s1, v5
v_fma_f32 v7, -v6, v6, v7
v_max_f32 v7, v7, v5
v_rsq_f32 v2, v7
v_fma_f32 v7, v6, v64, v56
v_mul_f32 v7, v7, v2
v_mul_f32 v3, v6, v2
v_ashrrev_i32 v6, 31, v7
v_or_b32 v6, 0x80000000, v6
v_xor_b32 v7, v7, v6
v_and_or_b32 v7, v7, s44, v234
v_cndmask_b32 v7, 0, v7, s[46:47]
v_pk_fma_f32 v[72:73], v[8:9], v[2:3], v[2:3] op_sel:[0,0,1] op_sel_hi:[1,0,1]
v_pk_fma_f32 v[74:75], v[10:11], v[2:3], v[2:3] op_sel:[0,0,1] op_sel_hi:[1,0,1]
v_max_u32_dpp v6, v7, v7 row_ror:8 row_mask:0xf bank_mask:0xf
v_pk_fma_f32 v[76:77], v[12:13], v[2:3], v[2:3] op_sel:[0,0,1] op_sel_hi:[1,0,1]
v_pk_fma_f32 v[78:79], v[14:15], v[2:3], v[2:3] op_sel:[0,0,1] op_sel_hi:[1,0,1]
v_max_u32_dpp v6, v6, v6 row_ror:4 row_mask:0xf bank_mask:0xf
s_mov_b64 exec, 15
ds_max_u32 v1, v6
s_mov_b64 exec, -1
v_pk_fma_f32 v[80:81], v[16:17], v[2:3], v[2:3] op_sel:[0,0,1] op_sel_hi:[1,0,1]
v_pk_fma_f32 v[82:83], v[18:19], v[2:3], v[2:3] op_sel:[0,0,1] op_sel_hi:[1,0,1]
v_pk_fma_f32 v[84:85], v[20:21], v[2:3], v[2:3] op_sel:[0,0,1] op_sel_hi:[1,0,1]
v_pk_fma_f32 v[86:87], v[22:23], v[2:3], v[2:3] op_sel:[0,0,1] op_sel_hi:[1,0,1]
v_cvt_pk_bf16_f32 v88, v72, v73
v_cvt_pk_bf16_f32 v89, v74, v75
v_cvt_pk_bf16_f32 v90, v76, v77
v_cvt_pk_bf16_f32 v91, v78, v79
s_waitcnt lgkmcnt(0)
s_barrier
ds_read_b32 v1, v1
v_cvt_pk_bf16_f32 v92, v80, v81
v_cvt_pk_bf16_f32 v93, v82, v83
v_cvt_pk_bf16_f32 v94, v84, v85
v_cvt_pk_bf16_f32 v95, v86, v87
v_pk_add_f32 v[72:73], v[72:73], v[8:9]
v_pk_add_f32 v[74:75], v[74:75], v[10:11]
v_pk_add_f32 v[76:77], v[76:77], v[12:13]
v_pk_add_f32 v[78:79], v[78:79], v[14:15]
v_pk_add_f32 v[80:81], v[80:81], v[16:17]
v_pk_add_f32 v[82:83], v[82:83], v[18:19]
v_pk_add_f32 v[84:85], v[84:85], v[20:21]
v_pk_add_f32 v[86:87], v[86:87], v[22:23]
s_cmp_eq_u32 s45, 4
s_waitcnt lgkmcnt(0)
v_cmp_eq_u32 s[46:47], v1, v7
s_cbranch_scc0 L_nk
s_mov_b64 exec, 0xffff
buffer_store_dword v1, v70, s[16:19], s3 offen sc1
L_nk:
s_and_b64 exec, s[46:47], -1
s_cbranch_scc0 L_nc
buffer_store_dwordx4 v[88:91], v68, s[16:19], s48 offen sc1
buffer_store_dwordx4 v[92:95], v68, s[16:19], s48 offen offset:16 sc1
L_nc:
s_mov_b64 exec, -1
v_cvt_pk_bf16_f32 v96, v72, v73
v_cvt_pk_bf16_f32 v97, v74, v75
v_cvt_pk_bf16_f32 v98, v76, v77
v_cvt_pk_bf16_f32 v99, v78, v79
v_cvt_pk_bf16_f32 v100, v80, v81
v_cvt_pk_bf16_f32 v101, v82, v83
v_cvt_pk_bf16_f32 v102, v84, v85
v_cvt_pk_bf16_f32 v103, v86, v87
v_permlane16_swap_b32 v96, v98
v_permlane16_swap_b32 v97, v99
v_permlane16_swap_b32 v100, v102
v_permlane16_swap_b32 v101, v103
s_not_b64 exec, s[46:47]
buffer_store_dwordx4 v[96:99], v232, s[20:23], 0 offen offset:0
buffer_store_dwordx4 v[100:103], v232, s[20:23], 0 offen offset:64
s_and_b64 exec, s[46:47], -1
s_cbranch_scc0 L_fin
buffer_store_dwordx4 v[96:99], v232, s[20:23], 0 offen offset:0 sc1
buffer_store_dwordx4 v[100:103], v232, s[20:23], 0 offen offset:64 sc1
s_waitcnt vmcnt(0)
buffer_store_dwordx4 v[72:75], v69, s[16:19], s49 offen offset:0 sc1
buffer_store_dwordx4 v[76:79], v69, s[16:19], s49 offen offset:64 sc1
buffer_store_dwordx4 v[80:83], v69, s[16:19], s49 offen offset:128 sc1
buffer_store_dwordx4 v[84:87], v69, s[16:19], s49 offen offset:192 sc1
L_fin:
s_endpgm
.p2align 12
L_pb_10:
L_pad_11:
s_setpc_b64 s[100:101]
L_era:
s_sub_u32 s40, s40, 1
s_cbranch_scc1 L_exa
s_lshl_b32 s0, s33, 5
v_and_b32 v1, 16, v0
buffer_load_dword v32, v1, s[24:27], s0 offen sc1
s_waitcnt vmcnt(0)
s_waitcnt lgkmcnt(0)
v_cmp_ne_u32 vcc, 1, v32
s_cmp_eq_u64 vcc, 0
s_cbranch_scc0 L_era
s_branch L_ega
L_exa:
s_mov_b32 s40, 0
s_branch L_ega
L_erb:
s_sub_u32 s40, s40, 1
s_cbranch_scc1 L_exb
s_buffer_load_dword s71, s[16:19], s66 offset:0 glc
s_buffer_load_dword s73, s[16:19], s66 offset:128 glc
s_buffer_load_dword s75, s[16:19], s66 offset:256 glc
s_buffer_load_dword s77, s[16:19], s66 offset:384 glc
s_buffer_load_dword s83, s[16:19], s66 offset:512 glc
s_buffer_load_dword s85, s[16:19], s66 offset:640 glc
s_buffer_load_dword s89, s[16:19], s66 offset:768 glc
s_buffer_load_dword s91, s[16:19], s66 offset:896 glc
s_buffer_load_dword s93, s[16:19], s66 offset:1024 glc
s_buffer_load_dword s95, s[16:19], s66 offset:1152 glc
s_waitcnt lgkmcnt(0)
s_max_u32 s0, s71, s73
s_max_u32 s0, s0, s75
s_max_u32 s0, s0, s77
s_max_u32 s0, s0, s83
s_max_u32 s0, s0, s85
s_max_u32 s0, s0, s89
s_max_u32 s0, s0, s91
s_max_u32 s0, s0, s93
s_max_u32 s0, s0, s95
s_cmp_lg_u32 s0, -1
s_cbranch_scc0 L_erb
s_branch L_egb
L_exb:
s_mov_b32 s40, 0
s_branch L_egb
L_gh_3g:
s_barrier
s_cmp_eq_u32 s32, 5
s_cbranch_scc0 L_gh_3e
v_mov_b32 v1, 1
s_mov_b64 exec, 1
buffer_store_dword v1, off, s[16:19], s68 offset:64 sc1
s_mov_b64 exec, -1
L_gh_3p:
buffer_load_dword v1, v55, s[16:19], 0 offen offset:64 sc1
s_waitcnt vmcnt(0)
v_cmp_ne_u32 vcc, 1, v1
s_cbranch_vccz L_gh_3e
s_sub_u32 s40, s40, 1
s_cbranch_scc0 L_gh_3p
s_mov_b32 s40, 0
L_gh_3e:
s_barrier
s_branch L_gh_3b
L_xcap:
v_add_u32 v1, s0, v235
ds_read_b64 v[72:73], v1
v_xor_b32 v2, 32, v1
ds_read_b64 v[74:75], v2
v_xor_b32 v3, 64, v1
ds_read_b64 v[76:77], v3
v_xor_b32 v4, 96, v1
ds_read_b64 v[78:79], v4
s_setpc_b64 s[100:101]
L_woe1:
s_addk_i32 m0, 4096
s_mov_b32 s3, 0
buffer_load_dwordx4 v57, s[12:15], s3 offen lds
s_addk_i32 m0, 4096
s_mov_b32 s3, 81920
buffer_load_dwordx4 v57, s[12:15], s3 offen lds
s_addk_i32 m0, 4096
s_mov_b32 s3, 163840
buffer_load_dwordx4 v58, s[12:15], s3 offen lds
s_addk_i32 m0, 4096
s_mov_b32 s3, 245760
buffer_load_dwordx4 v60, s[12:15], s3 offen lds
s_addk_i32 m0, 4096
s_mov_b32 s3, 327680
buffer_load_dwordx4 v60, s[12:15], s3 offen lds
s_addk_i32 m0, 4096
s_mov_b32 s3, 409600
buffer_load_dwordx4 v57, s[12:15], s3 offen lds
s_addk_i32 m0, 4096
s_mov_b32 s3, 491520
buffer_load_dwordx4 v57, s[12:15], s3 offen lds
s_addk_i32 m0, 4096
s_mov_b32 s3, 573440
buffer_load_dwordx4 v58, s[12:15], s3 offen lds
s_addk_i32 m0, 4096
s_mov_b32 s3, 655360
buffer_load_dwordx4 v60, s[12:15], s3 offen lds
s_addk_i32 m0, 4096
s_mov_b32 s3, 737280
buffer_load_dwordx4 v60, s[12:15], s3 offen lds
s_branch L_woe
L_woe2:
s_addk_i32 m0, 4096
s_mov_b32 s3, 5120
buffer_load_dwordx4 v57, s[12:15], s3 offen lds
s_addk_i32 m0, 4096
s_mov_b32 s3, 87040
buffer_load_dwordx4 v58, s[12:15], s3 offen lds
s_addk_i32 m0, 4096
s_mov_b32 s3, 168960
buffer_load_dwordx4 v58, s[12:15], s3 offen lds
s_addk_i32 m0, 4096
s_mov_b32 s3, 250880
buffer_load_dwordx4 v60, s[12:15], s3 offen lds
s_addk_i32 m0, 4096
s_mov_b32 s3, 384000
buffer_load_dwordx4 v59, s[12:15], s3 offen lds
s_addk_i32 m0, 4096
s_mov_b32 s3, 414720
buffer_load_dwordx4 v57, s[12:15], s3 offen lds
s_addk_i32 m0, 4096
s_mov_b32 s3, 496640
buffer_load_dwordx4 v58, s[12:15], s3 offen lds
s_addk_i32 m0, 4096
s_mov_b32 s3, 578560
buffer_load_dwordx4 v58, s[12:15], s3 offen lds
s_addk_i32 m0, 4096
s_mov_b32 s3, 660480
buffer_load_dwordx4 v60, s[12:15], s3 offen lds
s_addk_i32 m0, 4096
s_mov_b32 s3, 793600
buffer_load_dwordx4 v59, s[12:15], s3 offen lds
s_branch L_woe
L_pad_12:
s_setpc_b64 s[100:101]
L_woe3:
s_addk_i32 m0, 4096
s_mov_b32 s3, 10240
buffer_load_dwordx4 v58, s[12:15], s3 offen lds
s_addk_i32 m0, 4096
s_mov_b32 s3, 92160
buffer_load_dwordx4 v58, s[12:15], s3 offen lds
s_addk_i32 m0, 4096
s_mov_b32 s3, 174080
buffer_load_dwordx4 v58, s[12:15], s3 offen lds
s_addk_i32 m0, 4096
s_mov_b32 s3, 307200
buffer_load_dwordx4 v59, s[12:15], s3 offen lds
s_addk_i32 m0, 4096
s_mov_b32 s3, 389120
buffer_load_dwordx4 v59, s[12:15], s3 offen lds
s_addk_i32 m0, 4096
s_mov_b32 s3, 419840
buffer_load_dwordx4 v58, s[12:15], s3 offen lds
s_addk_i32 m0, 4096
s_mov_b32 s3, 501760
buffer_load_dwordx4 v58, s[12:15], s3 offen lds
s_addk_i32 m0, 4096
s_mov_b32 s3, 583680
buffer_load_dwordx4 v58, s[12:15], s3 offen lds
s_addk_i32 m0, 4096
s_mov_b32 s3, 716800
buffer_load_dwordx4 v59, s[12:15], s3 offen lds
s_addk_i32 m0, 4096
s_mov_b32 s3, 798720
buffer_load_dwordx4 v59, s[12:15], s3 offen lds
s_branch L_woe
L_gl_4g:
buffer_store_dwordx4 v[192:195], v224, s[20:23], s54 offen sc1
s_branch L_gl_4b
L_gl_5g:
buffer_store_dwordx4 v[196:199], v226, s[20:23], 0 offen sc1
s_branch L_gl_5b
L_h0rh:
s_sub_u32 s40, s40, 1
s_cbranch_scc1 L_h0xh
buffer_load_dwordx4 v[92:95], v225, s[20:23], s54 offen sc1
s_waitcnt vmcnt(0)
v_cmp_eq_u32 vcc, -1, v92
s_cbranch_vccnz L_h0rh
s_branch L_h0gh
L_h0xh:
s_mov_b32 s40, 0
s_branch L_h0gh
L_gl_6g:
buffer_store_dwordx4 v[80:83], v226, s[20:23], s54 offen sc1
s_branch L_gl_6b
L_spw:
v_mov_b32 v1, 1744
ds_read_b32 v1, v1
s_waitcnt lgkmcnt(0)
v_cmp_ne_u32 vcc, 4, v1
s_cbranch_vccnz L_spw
s_branch L_sbw
L_st0:
s_sub_u32 s40, s40, 1
s_cbranch_scc1 L_sx0
buffer_load_dwordx4 v[24:27], v227, s[20:23], s61 offen offset:0 sc1
buffer_load_dwordx4 v[28:31], v227, s[20:23], s61 offen offset:256 sc1
s_waitcnt vmcnt(0)
v_max_u16 v2, v24, v28
v_cmp_eq_u16 vcc, -1, v2
s_cbranch_vccnz L_st0
s_branch L_go0
L_sx0:
s_mov_b32 s40, 0
s_branch L_go0
L_st1:
s_sub_u32 s40, s40, 1
s_cbranch_scc1 L_sx1
buffer_load_dwordx4 v[32:35], v227, s[20:23], s61 offen offset:512 sc1
buffer_load_dwordx4 v[36:39], v227, s[20:23], s61 offen offset:768 sc1
s_waitcnt vmcnt(0)
v_max_u16 v2, v32, v36
v_cmp_eq_u16 vcc, -1, v2
s_cbranch_vccnz L_st1
s_branch L_go1
L_sx1:
s_mov_b32 s40, 0
s_branch L_go1
L_st2:
s_sub_u32 s40, s40, 1
s_cbranch_scc1 L_sx2
buffer_load_dwordx4 v[40:43], v227, s[20:23], s61 offen offset:1024 sc1
s_waitcnt vmcnt(0)
v_cmp_eq_u16 vcc, -1, v40
s_cbranch_vccnz L_st2
s_branch L_go2
L_sx2:
s_mov_b32 s40, 0
s_branch L_go2
L_st3:
s_sub_u32 s40, s40, 1
s_cbranch_scc1 L_sx3
buffer_load_dwordx4 v[44:47], v227, s[20:23], s62 offen offset:0 sc1
buffer_load_dwordx4 v[48:51], v236, s[20:23], s62 offen offset:0 sc1
s_waitcnt vmcnt(0)
v_max_u16 v2, v44, v48
v_cmp_eq_u16 vcc, -1, v2
s_cbranch_vccnz L_st3
s_branch L_go3
L_sx3:
s_mov_b32 s40, 0
s_branch L_go3
L_st4:
s_sub_u32 s40, s40, 1
s_cbranch_scc1 L_sx4
buffer_load_dwordx4 v[52:55], v227, s[20:23], s62 offen offset:256 sc1
buffer_load_dwordx4 v[56:59], v236, s[20:23], s62 offen offset:256 sc1
s_waitcnt vmcnt(0)
v_max_u16 v2, v52, v56
v_cmp_eq_u16 vcc, -1, v2
s_cbranch_vccnz L_st4
s_branch L_go4
L_sx4:
s_mov_b32 s40, 0
s_branch L_go4
L_pad_13:
s_setpc_b64 s[100:101]
L_st5:
s_sub_u32 s40, s40, 1
s_cbranch_scc1 L_sx5
buffer_load_dwordx4 v[60:63], v227, s[20:23], s62 offen offset:512 sc1
buffer_load_dwordx4 v[64:67], v236, s[20:23], s62 offen offset:512 sc1
s_waitcnt vmcnt(0)
v_max_u16 v2, v60, v64
v_cmp_eq_u16 vcc, -1, v2
s_cbranch_vccnz L_st5
s_branch L_go5
L_sx5:
s_mov_b32 s40, 0
s_branch L_go5
L_st6:
s_sub_u32 s40, s40, 1
s_cbranch_scc1 L_sx6
buffer_load_dwordx4 v[68:71], v227, s[20:23], s62 offen offset:768 sc1
buffer_load_dwordx4 v[72:75], v236, s[20:23], s62 offen offset:768 sc1
s_waitcnt vmcnt(0)
v_max_u16 v2, v68, v72
v_cmp_eq_u16 vcc, -1, v2
s_cbranch_vccnz L_st6
s_branch L_go6
L_sx6:
s_mov_b32 s40, 0
s_branch L_go6
L_st7:
s_sub_u32 s40, s40, 1
s_cbranch_scc1 L_sx7
buffer_load_dwordx4 v[76:79], v227, s[20:23], s62 offen offset:1024 sc1
buffer_load_dwordx4 v[80:83], v236, s[20:23], s62 offen offset:1024 sc1
s_waitcnt vmcnt(0)
v_max_u16 v2, v76, v80
v_cmp_eq_u16 vcc, -1, v2
s_cbranch_vccnz L_st7
s_branch L_go7
L_sx7:
s_mov_b32 s40, 0
s_branch L_go7
L_st8:
s_sub_u32 s40, s40, 1
s_cbranch_scc1 L_sx8
buffer_load_dwordx4 v[84:87], v227, s[20:23], s63 offen offset:0 sc1
buffer_load_dwordx4 v[88:91], v236, s[20:23], s63 offen offset:0 sc1
s_waitcnt vmcnt(0)
v_max_u16 v2, v84, v88
v_cmp_eq_u16 vcc, -1, v2
s_cbranch_vccnz L_st8
s_branch L_go8
L_sx8:
s_mov_b32 s40, 0
s_branch L_go8
L_st9:
s_sub_u32 s40, s40, 1
s_cbranch_scc1 L_sx9
buffer_load_dwordx4 v[92:95], v227, s[20:23], s63 offen offset:256 sc1
buffer_load_dwordx4 v[96:99], v236, s[20:23], s63 offen offset:256 sc1
s_waitcnt vmcnt(0)
v_max_u16 v2, v92, v96
v_cmp_eq_u16 vcc, -1, v2
s_cbranch_vccnz L_st9
s_branch L_go9
L_sx9:
s_mov_b32 s40, 0
s_branch L_go9
L_st10:
s_sub_u32 s40, s40, 1
s_cbranch_scc1 L_sx10
buffer_load_dwordx4 v[100:103], v227, s[20:23], s63 offen offset:512 sc1
buffer_load_dwordx4 v[24:27], v236, s[20:23], s63 offen offset:512 sc1
s_waitcnt vmcnt(0)
v_max_u16 v2, v100, v24
v_cmp_eq_u16 vcc, -1, v2
s_cbranch_vccnz L_st10
s_branch L_go10
L_sx10:
s_mov_b32 s40, 0
s_branch L_go10
L_st11:
s_sub_u32 s40, s40, 1
s_cbranch_scc1 L_sx11
buffer_load_dwordx4 v[28:31], v236, s[20:23], s63 offen offset:768 sc1
buffer_load_dwordx4 v[32:35], v236, s[20:23], s63 offen offset:1024 sc1
s_waitcnt vmcnt(0)
v_max_u16 v2, v28, v32
v_cmp_eq_u16 vcc, -1, v2
s_cbranch_vccnz L_st11
s_branch L_go11
L_sx11:
s_mov_b32 s40, 0
s_branch L_go11
L_st12:
s_sub_u32 s40, s40, 1
s_cbranch_scc1 L_sx12
buffer_load_dwordx4 v[36:39], v227, s[20:23], s63 offen offset:768 sc1
buffer_load_dwordx4 v[40:43], v227, s[20:23], s63 offen offset:1024 sc1
s_waitcnt vmcnt(0)
v_max_u16 v2, v36, v40
v_cmp_eq_u16 vcc, -1, v2
s_cbranch_vccnz L_st12
s_branch L_go12
L_sx12:
s_mov_b32 s40, 0
s_branch L_go12
L_st13:
s_sub_u32 s40, s40, 1
s_cbranch_scc1 L_sx13
buffer_load_dwordx4 v[44:47], v227, s[20:23], s64 offen offset:0 sc1
buffer_load_dwordx4 v[48:51], v227, s[20:23], s64 offen offset:256 sc1
s_waitcnt vmcnt(0)
v_max_u16 v2, v44, v48
v_cmp_eq_u16 vcc, -1, v2
s_cbranch_vccnz L_st13
s_branch L_go13
L_sx13:
s_mov_b32 s40, 0
s_branch L_go13
L_pad_14:
s_setpc_b64 s[100:101]
L_st14:
s_sub_u32 s40, s40, 1
s_cbranch_scc1 L_sx14
buffer_load_dwordx4 v[52:55], v227, s[20:23], s64 offen offset:512 sc1
buffer_load_dwordx4 v[56:59], v227, s[20:23], s64 offen offset:768 sc1
s_waitcnt vmcnt(0)
v_max_u16 v2, v52, v56
v_cmp_eq_u16 vcc, -1, v2
s_cbranch_vccnz L_st14
s_branch L_go14
L_sx14:
s_mov_b32 s40, 0
s_branch L_go14
L_st15:
s_sub_u32 s40, s40, 1
s_cbranch_scc1 L_sx15
buffer_load_dwordx4 v[60:63], v227, s[20:23], s64 offen offset:1024 sc1
s_waitcnt vmcnt(0)
v_cmp_eq_u16 vcc, -1, v60
s_cbranch_vccnz L_st15
s_branch L_go15
L_sx15:
s_mov_b32 s40, 0
s_branch L_go15
L_gl_9g:
buffer_store_dwordx4 v[32:35], v1, s[16:19], s3 offen sc1
s_branch L_gl_9b
L_pad_15:
s_setpc_b64 s[100:101]
L_h0:
s_setprio 2
v_lshrrev_b32 v1, 3, v0
v_and_b32 v2, 2, v1
v_xor_b32 v2, v2, v0
v_and_b32 v2, 7, v2
s_lshl_b32 s3, s36, 7
v_lshl_add_u32 v2, v2, 4, s3
v_mul_u32_u24 v3, 3840, v1
v_add_u32 v24, v3, v2
v_xor_b32 v27, 64, v24
v_add_u32 v27, 30720, v27
v_mov_b32 v55, 0
v_add_u32 v25, 256, v24
v_add_u32 v26, 512, v24
v_add_u32 v28, 256, v27
v_add_u32 v29, 512, v27
v_lshrrev_b32 v1, 4, v0
v_lshlrev_b32 v1, 3, v1
s_lshl_b32 s3, s36, 7
buffer_load_dwordx2 v[244:245], v1, s[28:31], s3 offen offset:0
buffer_load_dwordx2 v[246:247], v1, s[28:31], s3 offen offset:32
buffer_load_dwordx2 v[248:249], v1, s[28:31], s3 offen offset:64
buffer_load_dwordx2 v[250:251], v1, s[28:31], s3 offen offset:96
s_waitcnt vmcnt(4)
s_barrier
s_mov_b32 s42, 1
s_mov_b32 s65, 45056
L_wl:
s_add_u32 s69, s69, 1
s_cmp_eq_u32 s69, 10
s_cselect_b32 s69, 0, s69
s_add_u32 s61, s61, 36864
s_cmp_eq_u32 s61, 155648
s_cselect_b32 s61, 8192, s61
s_mul_i32 s63, s69, 245760
s_add_u32 m0, s61, 12288
s_nop 0
buffer_load_dwordx4 v24, s[8:11], s63 offen offset:0 lds
buffer_load_dwordx4 v25, s[8:11], s63 offen offset:1024 lds
buffer_load_dwordx4 v26, s[8:11], s63 offen offset:2048 lds
s_addk_i32 m0, 3072
s_nop 0
buffer_load_dwordx4 v27, s[8:11], s63 offen offset:0 lds
buffer_load_dwordx4 v28, s[8:11], s63 offen offset:1024 lds
buffer_load_dwordx4 v29, s[8:11], s63 offen offset:2048 lds
s_addk_i32 m0, 3072
s_add_u32 s63, s63, 61440
buffer_load_dwordx4 v24, s[8:11], s63 offen offset:0 lds
buffer_load_dwordx4 v25, s[8:11], s63 offen offset:1024 lds
buffer_load_dwordx4 v26, s[8:11], s63 offen offset:2048 lds
s_addk_i32 m0, 3072
s_nop 0
buffer_load_dwordx4 v27, s[8:11], s63 offen offset:0 lds
buffer_load_dwordx4 v28, s[8:11], s63 offen offset:1024 lds
buffer_load_dwordx4 v29, s[8:11], s63 offen offset:2048 lds
s_addk_i32 m0, 3072
s_add_u32 s63, s63, 61440
buffer_load_dwordx4 v24, s[8:11], s63 offen offset:0 lds
buffer_load_dwordx4 v25, s[8:11], s63 offen offset:1024 lds
buffer_load_dwordx4 v26, s[8:11], s63 offen offset:2048 lds
s_addk_i32 m0, 3072
s_nop 0
buffer_load_dwordx4 v27, s[8:11], s63 offen offset:0 lds
buffer_load_dwordx4 v28, s[8:11], s63 offen offset:1024 lds
buffer_load_dwordx4 v29, s[8:11], s63 offen offset:2048 lds
s_addk_i32 m0, 3072
s_add_u32 s63, s63, 61440
buffer_load_dwordx4 v24, s[8:11], s63 offen offset:0 lds
buffer_load_dwordx4 v25, s[8:11], s63 offen offset:1024 lds
buffer_load_dwordx4 v26, s[8:11], s63 offen offset:2048 lds
s_addk_i32 m0, 3072
s_nop 0
buffer_load_dwordx4 v27, s[8:11], s63 offen offset:0 lds
buffer_load_dwordx4 v28, s[8:11], s63 offen offset:1024 lds
buffer_load_dwordx4 v29, s[8:11], s63 offen offset:2048 lds
s_mov_b32 s0, s65
s_mov_b32 s65, s61
s_cmp_eq_u32 s57, s42
s_waitcnt vmcnt(24) lgkmcnt(0)
s_barrier
s_cbranch_scc0 L_wc
s_call_b64 s[100:101], L_xcap
L_wc:
s_add_u32 s42, s42, 1
s_cmp_lt_u32 s42, 9
s_cbranch_scc1 L_wl
s_branch L_h8
L_pad_21:
s_setpc_b64 s[100:101]
L_c23:
ds_read_b64 v[96:97], v202 offset:0
ds_read_b64 v[98:99], v202 offset:1152
ds_read_b64 v[116:117], v206 offset:0
ds_read_b64 v[118:119], v207 offset:0
ds_read_b64 v[100:101], v203 offset:0
ds_read_b64 v[102:103], v203 offset:1152
ds_read_b64 v[120:121], v208 offset:0
ds_read_b64 v[122:123], v209 offset:0
ds_read_b64 v[104:105], v201 offset:0
ds_read_b64 v[106:107], v201 offset:1152
ds_read_b64 v[124:125], v210 offset:0
ds_read_b64 v[126:127], v211 offset:0
s_add_u32 s0, s37, 1
s_sub_u32 s1, 5, s37
s_min_u32 s0, s0, s1
s_lshl_b32 s0, s0, 4
s_sub_u32 s1, 64, s0
s_cmp_le_u32 s37, 2
s_cselect_b32 s1, s1, 16
s_bfm_b64 s[100:101], s0, s1
s_waitcnt lgkmcnt(8)
v_mfma_f32_16x16x32_bf16 v[152:155], v[96:99], v[116:119], 0
s_waitcnt lgkmcnt(4)
v_mfma_f32_16x16x32_bf16 v[156:159], v[100:103], v[120:123], 0
s_waitcnt lgkmcnt(0)
v_mfma_f32_16x16x32_bf16 v[152:155], v[104:107], v[124:127], v[152:155]
v_add_u32 v1, 128, v222
v_cndmask_b32 v2, v1, v222, s[44:45]
ds_read_b64 v[168:169], v2 offset:0
v_cndmask_b32 v2, v1, v222, s[46:47]
ds_read_b64 v[170:171], v2 offset:32
v_cndmask_b32 v2, v1, v222, s[48:49]
ds_read_b64 v[172:173], v2 offset:64
v_cndmask_b32 v2, v1, v222, s[50:51]
ds_read_b64 v[174:175], v2 offset:96
ds_read_b32 v5, v223
v_permlane16_swap_b32 v152, v156
v_permlane16_swap_b32 v153, v157
v_permlane16_swap_b32 v154, v158
v_permlane16_swap_b32 v155, v159
v_cndmask_b32 v2, v156, v152, s[44:45]
v_cndmask_b32 v3, v157, v153, s[46:47]
v_cndmask_b32 v194, v158, v154, s[48:49]
v_cndmask_b32 v195, v159, v155, s[50:51]
v_or_b32 v192, 0xffff, v2
v_perm_b32 v193, v3, v2, s55
s_cmp_eq_u32 s41, 1
s_cbranch_scc0 L_gl_22g
buffer_store_dwordx4 v[192:195], v224, s[20:23], s54 offen
L_gl_22b:
ds_read_b64_tr_b16 v[72:73], v217 offset:0
ds_read_b64_tr_b16 v[74:75], v217 offset:1152
ds_read_b64_tr_b16 v[76:77], v218 offset:0
ds_read_b64_tr_b16 v[78:79], v218 offset:1152
v_mov_b32 v184, 0
v_mov_b32 v185, 0
v_mov_b32 v186, 0
v_mov_b32 v187, 0
v_mov_b32 v188, 0
v_mov_b32 v189, 0
v_mov_b32 v190, 0
v_mov_b32 v191, 0
s_waitcnt lgkmcnt(0)
v_mul_f32 v5, 0x3ea52b5c, v5
buffer_load_dwordx4 v[92:95], v225, s[20:23], s54 offen sc1
s_waitcnt vmcnt(0)
v_cmp_eq_u32 vcc, -1, v92
s_cbranch_vccnz L_h0rl
L_h0gl:
s_lshl_b32 s0, s32, 2
s_add_u32 s0, s0, 1744
v_mov_b32 v1, s0
ds_write_b32 v1, v1
v_perm_b32 v92, v92, v93, s56
v_add_f32 v193, v3, v93
v_add_f32 v194, v194, v94
v_add_f32 v195, v195, v95
v_add_f32 v192, v2, v92
v_fma_f32 v192, v192, v168, v169
v_fma_f32 v193, v193, v170, v171
v_fma_f32 v194, v194, v172, v173
v_fma_f32 v195, v195, v174, v175
v_max3_f32 v6, v192, v193, v194
v_max_f32 v6, v6, v195
v_mov_b32 v7, v6
s_nop 1
v_permlane32_swap_b32 v6, v7
v_max_f32 v6, v6, v7
v_mul_f32 v6, v6, v5
v_fma_f32 v192, v192, v5, -v6
v_fma_f32 v193, v193, v5, -v6
v_fma_f32 v194, v194, v5, -v6
v_fma_f32 v195, v195, v5, -v6
v_exp_f32 v192, v192
v_exp_f32 v193, v193
v_exp_f32 v194, v194
v_exp_f32 v195, v195
v_add_f32 v6, v192, v193
v_add_f32 v7, v194, v195
v_add_f32 v6, v6, v7
v_mov_b32 v7, v6
v_mul_f32 v192, v192, v168
v_mul_f32 v193, v193, v170
v_permlane32_swap_b32 v6, v7
v_mul_f32 v194, v194, v172
v_add_f32 v6, v6, v7
v_rcp_f32 v6, v6
v_mul_f32 v195, v195, v174
v_mul_f32 v192, v192, v6
v_mul_f32 v193, v193, v6
v_mul_f32 v194, v194, v6
v_mul_f32 v195, v195, v6
v_cvt_pk_bf16_f32 v192, v192, v193
v_cvt_pk_bf16_f32 v193, v194, v195
s_mov_b64 exec, s[52:53]
v_and_b32 v184, v220, v192
v_bfi_b32 v188, v220, 0, v192
v_and_b32 v185, v221, v193
v_bfi_b32 v189, v221, 0, v193
s_not_b64 exec, exec
v_and_b32 v186, v220, v192
v_bfi_b32 v190, v220, 0, v192
v_and_b32 v187, v221, v193
v_bfi_b32 v191, v221, 0, v193
s_mov_b64 exec, -1
v_permlane16_swap_b32 v184, v188
v_permlane16_swap_b32 v185, v189
v_permlane16_swap_b32 v186, v190
v_permlane16_swap_b32 v187, v191
s_nop 1
v_mfma_f32_16x16x32_bf16 v[152:155], v[72:75], v[184:187], 0
v_mfma_f32_16x16x32_bf16 v[156:159], v[76:79], v[184:187], 0
v_mfma_f32_16x16x32_bf16 v[160:163], v[76:79], v[188:191], 0
s_mov_b32 exec_lo, 0xffff0000
s_nop 4
v_cvt_pk_bf16_f32 v80, v152, v153
v_cvt_pk_bf16_f32 v81, v154, v155
v_cvt_pk_bf16_f32 v82, v156, v157
v_cvt_pk_bf16_f32 v83, v158, v159
s_mov_b64 exec, s[100:101]
v_cvt_pk_bf16_f32 v82, v160, v161
v_cvt_pk_bf16_f32 v83, v162, v163
s_mov_b32 exec_lo, 0xffff0000
s_mov_b32 exec_hi, 0xffffffff
s_cmp_eq_u32 s41, 1
s_cbranch_scc0 L_gl_23g
buffer_store_dwordx4 v[80:83], v226, s[20:23], s54 offen
L_gl_23b:
s_endpgm
L_pad_24:
s_setpc_b64 s[100:101]
L_gl_22g:
buffer_store_dwordx4 v[192:195], v224, s[20:23], s54 offen sc1
s_branch L_gl_22b
L_h0rl:
s_sub_u32 s40, s40, 1
s_cbranch_scc1 L_h0xl
buffer_load_dwordx4 v[92:95], v225, s[20:23], s54 offen sc1
s_waitcnt vmcnt(0)
v_cmp_eq_u32 vcc, -1, v92
s_cbranch_vccnz L_h0rl
s_branch L_h0gl
L_h0xl:
s_mov_b32 s40, 0
s_branch L_h0gl
L_gl_23g:
buffer_store_dwordx4 v[80:83], v226, s[20:23], s54 offen sc1
s_branch L_gl_23b
.p2align 12
L_pb_16:
L_cons:
s_cmp_eq_u32 s32, 0
s_cbranch_scc0 L_pa
s_mul_i32 s3, s2, 3456
v_lshlrev_b32 v1, 7, v0
s_mov_b64 exec, 0x7ffffff
buffer_load_dword v255, v1, s[12:15], s3 offen
s_mov_b64 exec, -1
L_pa:
s_cmp_eq_u32 s32, 1
s_cbranch_scc0 L_pb
s_lshl_b32 s3, s36, 2
s_add_u32 s3, s3, s33
s_sub_u32 s0, s3, 40
s_cselect_b32 s3, s3, s0
s_mul_i32 s3, s3, 61440
s_mul_i32 s0, s35, 1280
s_add_u32 s3, s3, s0
s_lshl_b32 s0, s36, 7
s_add_u32 s3, s3, s0
v_mul_u32_u24 v1, 3840, v0
s_mov_b64 exec, 0xffff
buffer_load_dword v255, v1, s[8:11], s3 offen
s_mov_b64 exec, -1
L_pb:
v_and_b32 v1, 15, v0
v_lshrrev_b32 v2, 4, v0
v_mov_b32 v7, 1792
s_mul_i32 s0, s44, 2304
s_movk_i32 s1, 144
v_bfe_u32 v3, v0, 2, 1
v_and_b32 v4, 3, v0
v_lshlrev_b32 v4, 1, v4
v_lshl_add_u32 v3, v3, 3, v4
v_bfe_u32 v4, v0, 3, 1
v_add_u32 v3, v3, v4
s_add_u32 s3, s0, 17408
v_mov_b32 v4, s3
v_mad_u32_u24 v3, v3, s1, v4
s_add_u32 s3, s0, 4736
v_mov_b32 v4, s3
v_mad_u32_u24 v4, v1, s1, v4
s_mov_b32 s52, 0xff00ff
s_mov_b32 s53, 0xff00ff
v_add_u32 v5, s51, v2
v_lshl_add_u32 v200, v5, 3, v3
v_lshl_add_u32 v5, v5, 3, v4
v_cndmask_b32 v204, v7, v5, s[52:53]
v_cndmask_b32 v205, v5, v7, s[52:53]
v_add_u32 v5, s46, v2
v_lshl_add_u32 v202, v5, 3, v3
v_lshl_add_u32 v5, v5, 3, v4
v_cmp_gt_u32 vcc, s47, v2
s_nop 1
v_cndmask_b32 v5, v7, v5, vcc
v_cndmask_b32 v206, v7, v5, s[52:53]
v_cndmask_b32 v207, v5, v7, s[52:53]
v_add_u32 v5, s48, v2
v_min_u32 v5, 15, v5
v_lshl_add_u32 v203, v5, 3, v3
v_lshl_add_u32 v5, v5, 3, v4
v_cmp_gt_u32 vcc, s49, v2
s_nop 1
v_cndmask_b32 v5, v7, v5, vcc
v_cndmask_b32 v208, v7, v5, s[52:53]
v_cndmask_b32 v209, v5, v7, s[52:53]
s_sub_u32 s3, s51, 1
v_mad_u32_u24 v5, v2, 5, s3
s_add_u32 s3, s46, 4
v_mov_b32 v6, s3
s_mov_b64 vcc, 0xffff
v_cndmask_b32 v5, v5, v6, vcc
v_min_u32 v5, 15, v5
v_lshl_add_u32 v201, v5, 3, v3
v_lshl_add_u32 v5, v5, 3, v4
s_cmp_eq_u32 s47, 5
s_cselect_b64 vcc, 0xff, 0
v_cndmask_b32 v210, v7, v5, vcc
s_lshl_b64 vcc, vcc, 8
v_cndmask_b32 v211, v7, v5, vcc
s_bfm_b64 vcc, 8, 16
v_cndmask_b32 v212, v7, v5, vcc
s_bfm_b64 vcc, 8, 24
v_cndmask_b32 v213, v7, v5, vcc
s_bfm_b64 vcc, 8, 32
v_cndmask_b32 v214, v7, v5, vcc
s_bfm_b64 vcc, 8, 40
v_cndmask_b32 v215, v7, v5, vcc
s_mul_i32 s0, s44, 2304
s_movk_i32 s1, 144
v_bfe_u32 v3, v0, 2, 3
v_lshrrev_b32 v4, 5, v0
v_lshl_add_u32 v3, v3, 1, v4
s_add_u32 s3, s0, 31232
v_mov_b32 v4, s3
v_mad_u32_u24 v3, v3, s1, v4
v_and_b32 v4, 3, v0
s_mov_b32 s54, 0x11111111
s_mov_b32 s55, 0x11111111
v_add_u32 v5, s51, v4
v_lshl_add_u32 v216, v5, 3, v3
v_add_u32 v7, 32, v216
s_cmp_eq_u32 s50, 1
s_cselect_b32 s3, -1, 12
s_cselect_b32 s56, 2, -1
v_add_u32 v5, s3, v4
v_lshl_add_u32 v5, v5, 3, v3
v_cndmask_b32 v217, v5, v7, s[54:55]
v_add_u32 v7, 40, v7
v_add_u32 v5, s56, v4
v_add_u32 v6, 10, v5
v_cmp_gt_i32 vcc, s51, v5
s_nop 1
v_cndmask_b32 v5, v6, v5, vcc
v_lshl_add_u32 v5, v5, 3, v3
v_cndmask_b32 v218, v5, v7, s[54:55]
s_lshl_b32 s0, s44, 8
v_lshrrev_b32 v4, 5, v0
v_and_or_b32 v3, v0, 8, v4
s_add_u32 s3, s0, 8
v_lshl_add_u32 v222, v3, 4, s3
v_and_b32 v1, 15, v0
s_add_u32 s3, s0, 132
v_lshl_add_u32 v223, v1, 4, s3
s_lshr_b32 s3, s39, 8
s_mul_i32 s3, s3, 52429
s_lshr_b32 s3, s3, 18
s_lshl_b32 s0, s44, 5
s_add_u32 s3, s3, s0
s_sub_u32 s3, 2047, s3
v_mad_i32_i24 v234, v1, -2, s3
v_lshrrev_b32 v2, 4, v0
v_and_or_b32 v3, v0, 8, v2
v_and_b32 v4, 0x70, v233
v_bfrev_b32 v6, 1
s_lshl_b32 s3, s44, 4
v_add_u32 v5, s3, v3
s_lshl_b32 s3, s60, 3
v_cmp_gt_u32 vcc, s3, v5
v_mul_u32_u24 v5, 2560, v5
v_add3_u32 v5, v5, v4, s39
v_cndmask_b32 v227, v6, v5, vcc
s_lshl_b32 s3, s36, 7
v_add_u32 v226, s3, v227
v_bfe_u32 v3, v0, 4, 1
v_cmp_eq_u32 s[54:55], s50, v3
s_cmp_lg_u32 s37, 0
s_cselect_b64 s[0:1], -1, s[54:55]
s_and_b64 vcc, vcc, s[0:1]
s_cmp_lg_u32 s37, 4
s_cselect_b64 s[0:1], 0, s[54:55]
s_andn2_b64 vcc, vcc, s[0:1]
v_cndmask_b32 v225, v6, v226, vcc
s_cmp_le_u32 s37, 3
s_cselect_b32 s3, 2560, 0
s_sub_u32 s3, s3, 128
v_mov_b32 v4, s3
s_cmp_ge_u32 s37, 2
s_cselect_b32 s3, 2560, 0
s_add_u32 s3, s3, 128
v_mov_b32 v5, s3
v_cndmask_b32 v4, v4, v5, s[54:55]
v_mul_u32_u24 v3, 2560, v3
v_sub_u32 v4, v4, v3
v_add_u32 v4, v4, v226
v_cndmask_b32 v224, v6, v4, vcc
v_and_b32 v1, 15, v0
v_bfrev_b32 v6, 1
v_bfe_u32 v3, v0, 4, 1
v_lshrrev_b32 v4, 5, v0
v_lshl_add_u32 v3, v3, 1, v4
s_lshl_b32 s3, s36, 7
v_lshl_add_u32 v4, v3, 4, s3
s_lshl_b32 s3, s44, 4
v_add_u32 v5, s3, v1
s_lshl_b32 s3, s60, 3
v_cmp_gt_u32 vcc, s3, v5
v_mul_u32_u24 v5, 2560, v5
v_add3_u32 v5, v5, v4, s39
v_cndmask_b32 v232, v6, v5, vcc
v_bfe_u32 v3, v0, 3, 2
v_lshlrev_b32 v3, 2, v3
v_and_or_b32 v3, v0, 3, v3
v_lshlrev_b32 v3, 3, v3
v_bfe_u32 v4, v0, 2, 2
v_lshl_add_u32 v3, v4, 7, v3
v_lshrrev_b32 v2, 4, v0
s_mov_b32 s44, 0x0
s_mov_b32 s45, 0x1010101
s_mov_b32 s46, 0x3030303
s_mov_b32 s47, 0x7070707
s_mov_b32 s48, 0xf0f0f0f
s_mov_b32 s49, 0x1f1f1f1f
s_mov_b32 s50, 0x3f3f3f3f
s_mov_b32 s51, 0x7f7f7f7f
s_movk_i32 s54, 10240
s_mov_b32 s55, 0x07060501
s_mov_b32 s56, 0x0706000c
v_mov_b32 v5, 0xffff
v_mov_b32 v6, 0xffff0000
v_cndmask_b32 v1, 0, v5, s[44:45]
v_cndmask_b32 v4, 0, v6, s[46:47]
v_or_b32 v220, v1, v4
v_cndmask_b32 v1, 0, v5, s[48:49]
v_cndmask_b32 v4, 0, v6, s[50:51]
v_or_b32 v221, v1, v4
s_lshl_b32 s3, s38, 5
v_xor_b32 v3, s3, v3
v_mul_u32_u24 v4, 3072, v2
v_add_u32 v3, v3, v4
v_add_u32 v244, 20480, v3
s_mov_b32 s42, 0
v_mov_b32 v3, 0
v_lshlrev_b32 v2, 2, v0
s_mov_b32 exec_hi, 0
ds_write_b32 v2, v3 offset:1728
ds_write_b32 v2, v3 offset:2880
s_mov_b64 exec, -1
v_and_b32 v1, 15, v0
v_lshrrev_b32 v2, 4, v0
v_lshrrev_b32 v3, 1, v1
v_xor_b32 v3, v3, v2
v_lshlrev_b32 v3, 4, v3
v_lshl_add_u32 v3, v1, 7, v3
v_add_u32 v245, 8192, v3
v_xor_b32 v246, 64, v245
v_mul_u32_u24 v3, 144, v1
v_lshl_add_u32 v3, v2, 3, v3
s_lshl_b32 s3, s38, 5
s_add_u32 s3, s3, 3584
v_add_u32 v247, s3, v3
v_lshlrev_b32 v248, 4, v1
s_cmp_eq_u32 s32, 0
s_cbranch_scc0 L_cw0
s_call_b64 s[100:101], L_pad_2
L_cw0:
s_cmp_eq_u32 s32, 1
s_cbranch_scc0 L_cw1
s_call_b64 s[100:101], L_pad_15
L_cw1:
s_cmp_eq_u32 s32, 2
s_cbranch_scc0 L_cw2
s_call_b64 s[100:101], L_pad_18
L_cw2:
s_cmp_eq_u32 s32, 3
s_cbranch_scc0 L_cw3
L_cw3:
s_cmp_eq_u32 s69, 9
s_cselect_b32 s3, -2457600, 0
s_add_u32 s3, s3, 245760
v_add_u32 v254, s3, v254
s_mul_i32 s3, s38, 3072
s_add_u32 m0, s3, 57344
s_mov_b32 s0, 122880
buffer_load_dwordx4 v254, s[8:11], 0 offen offset:0 lds
s_addk_i32 m0, -256
s_nop 0
buffer_load_dwordx4 v254, s[8:11], 0 offen offset:1280 lds
s_addk_i32 m0, -256
s_nop 0
buffer_load_dwordx4 v254, s[8:11], 0 offen offset:2560 lds
s_addk_i32 m0, 12800
s_nop 0
buffer_load_dwordx4 v254, s[8:11], s0 offen offset:0 lds
s_addk_i32 m0, -256
s_nop 0
buffer_load_dwordx4 v254, s[8:11], s0 offen offset:1280 lds
s_addk_i32 m0, -256
s_nop 0
buffer_load_dwordx4 v254, s[8:11], s0 offen offset:2560 lds
v_mov_b32 v4, -1
v_mov_b32 v5, -1
v_mov_b32 v6, -1
v_mov_b32 v7, -1
v_lshrrev_b32 v1, 3, v0
v_mul_u32_u24 v1, 2560, v1
v_and_b32 v2, 0x70, v233
s_lshl_b32 s3, s36, 7
s_add_u32 s3, s3, s39
v_add3_u32 v1, v1, v2, s3
s_mul_i32 s0, s38, 20480
s_add_u32 s1, s0, 81920
s_add_u32 s3, s38, 8
s_cmp_lt_u32 s3, s60
s_cselect_b32 s3, s1, 0x80000000
s_add_u32 s3, s3, 81920
buffer_store_dwordx4 v[4:7], v1, s[20:23], s0 offen
buffer_store_dwordx4 v[4:7], v1, s[20:23], s1 offen
buffer_store_dwordx4 v[4:7], v1, s[20:23], s3 offen
v_lshrrev_b32 v1, 4, v0
v_mul_u32_u24 v1, 2304, v1
v_add_u32 v1, v1, v233
s_mul_i32 s1, s43, 15360
s_lshl_b32 s3, s36, 8
s_add_u32 s1, s1, s3
s_and_b32 s3, s38, 1
s_mul_i32 s3, s3, 7680
s_add_u32 s1, s1, s3
s_add_u32 s1, s1, 2097152
s_cmp_lt_u32 s38, 2
s_cselect_b32 s1, s1, 0x80000000
s_mov_b32 exec_hi, 0xffff
buffer_store_dwordx4 v[4:7], v1, s[16:19], s1 offen
s_mov_b64 exec, -1
s_cmp_lt_u32 s32, 2
s_cselect_b32 s57, s57, 99
s_mov_b32 s65, 8192
s_min_u32 s62, s57, 1
s_waitcnt vmcnt(10) lgkmcnt(0)
s_barrier
ds_read_b64_tr_b16 v[156:157], v244 offset:1024
ds_read_b64_tr_b16 v[158:159], v244 offset:1536
ds_read_b128 v[80:83], v245 offset:0
ds_read_b128 v[84:87], v245 offset:2048
ds_read_b128 v[88:91], v245 offset:4096
ds_read_b128 v[92:95], v245 offset:6144
ds_read_b128 v[96:99], v245 offset:8192
ds_read_b128 v[100:103], v245 offset:10240
ds_read_b64_tr_b16 v[160:161], v244 offset:2048
ds_read_b64_tr_b16 v[162:163], v244 offset:2560
ds_read_b64_tr_b16 v[152:153], v244 offset:0
ds_read_b64_tr_b16 v[154:155], v244 offset:512
s_waitcnt lgkmcnt(4)
v_mfma_f32_16x16x32_bf16 v[32:35], v[156:159], v[80:83], 0
ds_read_b64_tr_b16 v[168:169], v244 offset:13312
v_mfma_f32_16x16x32_bf16 v[36:39], v[156:159], v[84:87], 0
ds_read_b64_tr_b16 v[170:171], v244 offset:13824
v_mfma_f32_16x16x32_bf16 v[40:43], v[156:159], v[88:91], 0
ds_read_b128 v[104:107], v246 offset:0
v_mfma_f32_16x16x32_bf16 v[44:47], v[156:159], v[92:95], 0
ds_read_b128 v[108:111], v246 offset:2048
v_mfma_f32_16x16x32_bf16 v[48:51], v[156:159], v[96:99], 0
ds_read_b128 v[112:115], v246 offset:4096
v_mfma_f32_16x16x32_bf16 v[52:55], v[156:159], v[100:103], 0
ds_read_b128 v[116:119], v246 offset:6144
s_waitcnt lgkmcnt(8)
v_mfma_f32_16x16x32_bf16 v[56:59], v[160:163], v[80:83], 0
ds_read_b128 v[120:123], v246 offset:8192
v_mfma_f32_16x16x32_bf16 v[60:63], v[160:163], v[84:87], 0
ds_read_b128 v[124:127], v246 offset:10240
v_mfma_f32_16x16x32_bf16 v[64:67], v[160:163], v[88:91], 0
ds_read_b64_tr_b16 v[172:173], v244 offset:14336
v_mfma_f32_16x16x32_bf16 v[68:71], v[160:163], v[92:95], 0
ds_read_b64_tr_b16 v[174:175], v244 offset:14848
v_mfma_f32_16x16x32_bf16 v[72:75], v[160:163], v[96:99], 0
ds_read_b64_tr_b16 v[164:165], v244 offset:12288
v_mfma_f32_16x16x32_bf16 v[76:79], v[160:163], v[100:103], 0
ds_read_b64_tr_b16 v[166:167], v244 offset:12800
s_waitcnt lgkmcnt(12)
v_mfma_f32_16x16x32_bf16 v[8:11], v[152:155], v[80:83], 0
s_add_u32 s3, s65, 36864
s_cmp_eq_u32 s3, 155648
v_mfma_f32_16x16x32_bf16 v[12:15], v[152:155], v[84:87], 0
s_cselect_b32 s3, 8192, s3
s_sub_u32 s63, s3, s65
v_mfma_f32_16x16x32_bf16 v[16:19], v[152:155], v[88:91], 0
s_mov_b32 s65, s3
v_add_u32 v245, s63, v245
v_mfma_f32_16x16x32_bf16 v[20:23], v[152:155], v[92:95], 0
v_add_u32 v244, s63, v244
v_add_u32 v246, s63, v246
v_mfma_f32_16x16x32_bf16 v[24:27], v[152:155], v[96:99], 0
v_mfma_f32_16x16x32_bf16 v[28:31], v[152:155], v[100:103], 0
s_add_u32 s42, s42, 1
s_cmp_lt_u32 s42, 9
s_waitcnt lgkmcnt(4)
v_mfma_f32_16x16x32_bf16 v[32:35], v[168:171], v[104:107], v[32:35]
v_mfma_f32_16x16x32_bf16 v[36:39], v[168:171], v[108:111], v[36:39]
v_mfma_f32_16x16x32_bf16 v[40:43], v[168:171], v[112:115], v[40:43]
v_mfma_f32_16x16x32_bf16 v[44:47], v[168:171], v[116:119], v[44:47]
v_mfma_f32_16x16x32_bf16 v[48:51], v[168:171], v[120:123], v[48:51]
v_mfma_f32_16x16x32_bf16 v[52:55], v[168:171], v[124:127], v[52:55]
s_waitcnt lgkmcnt(2)
v_mfma_f32_16x16x32_bf16 v[56:59], v[172:175], v[104:107], v[56:59]
v_mfma_f32_16x16x32_bf16 v[60:63], v[172:175], v[108:111], v[60:63]
v_mfma_f32_16x16x32_bf16 v[64:67], v[172:175], v[112:115], v[64:67]
v_mfma_f32_16x16x32_bf16 v[68:71], v[172:175], v[116:119], v[68:71]
v_mfma_f32_16x16x32_bf16 v[72:75], v[172:175], v[120:123], v[72:75]
s_waitcnt vmcnt(4) lgkmcnt(0)
v_mfma_f32_16x16x32_bf16 v[76:79], v[172:175], v[124:127], v[76:79]
s_branch L_pb_17
L_pad_25:
s_setpc_b64 s[100:101]
L_ev:
s_cmp_eq_u32 s42, 1
s_cbranch_scc0 L_ev1
s_waitcnt vmcnt(0)
L_ev1:
s_max_u32 s62, s57, 1
s_cmp_eq_u32 s42, s57
s_cbranch_scc0 L_evb
s_sub_u32 s0, s65, s63
v_add_u32 v1, s0, v235
ds_read_b64 v[236:237], v1
v_xor_b32 v2, 32, v1
ds_read_b64 v[238:239], v2
v_xor_b32 v3, 64, v1
ds_read_b64 v[240:241], v3
v_xor_b32 v4, 96, v1
ds_read_b64 v[242:243], v4
s_branch L_evb
L_gs:
v_mov_b32 v4, -1
v_mov_b32 v5, -1
v_mov_b32 v6, -1
v_mov_b32 v7, -1
v_lshrrev_b32 v1, 3, v0
v_mul_u32_u24 v1, 2560, v1
v_and_b32 v2, 0x70, v233
s_lshl_b32 s3, s36, 7
s_add_u32 s3, s3, s39
v_add3_u32 v1, v1, v2, s3
s_mul_i32 s0, s38, 20480
s_add_u32 s1, s0, 81920
s_add_u32 s3, s38, 8
s_cmp_lt_u32 s3, s60
s_cselect_b32 s3, s1, 0x80000000
s_add_u32 s3, s3, 81920
buffer_store_dwordx4 v[4:7], v1, s[20:23], s0 offen sc1
buffer_store_dwordx4 v[4:7], v1, s[20:23], s1 offen sc1
buffer_store_dwordx4 v[4:7], v1, s[20:23], s3 offen sc1
v_lshrrev_b32 v1, 4, v0
v_mul_u32_u24 v1, 2304, v1
v_add_u32 v1, v1, v233
s_mul_i32 s1, s43, 15360
s_lshl_b32 s3, s36, 8
s_add_u32 s1, s1, s3
s_and_b32 s3, s38, 1
s_mul_i32 s3, s3, 7680
s_add_u32 s1, s1, s3
s_add_u32 s1, s1, 2097152
s_cmp_lt_u32 s38, 2
s_cselect_b32 s1, s1, 0x80000000
s_mov_b32 exec_hi, 0xffff
buffer_store_dwordx4 v[4:7], v1, s[16:19], s1 offen sc1
s_mov_b64 exec, -1
s_waitcnt vmcnt(0)
s_barrier
s_barrier
s_branch L_gsb
.p2align 12
L_pad_18:
s_setpc_b64 s[100:101]
L_pb_17:
L_cloop:
s_barrier
ds_read_b64_tr_b16 v[156:157], v244 offset:1024
ds_read_b64_tr_b16 v[158:159], v244 offset:1536
v_mfma_f32_16x16x32_bf16 v[8:11], v[164:167], v[104:107], v[8:11]
ds_read_b128 v[80:83], v245 offset:0
v_mfma_f32_16x16x32_bf16 v[12:15], v[164:167], v[108:111], v[12:15]
ds_read_b128 v[84:87], v245 offset:2048
v_mfma_f32_16x16x32_bf16 v[16:19], v[164:167], v[112:115], v[16:19]
ds_read_b128 v[88:91], v245 offset:4096
v_mfma_f32_16x16x32_bf16 v[20:23], v[164:167], v[116:119], v[20:23]
ds_read_b128 v[92:95], v245 offset:6144
v_mfma_f32_16x16x32_bf16 v[24:27], v[164:167], v[120:123], v[24:27]
ds_read_b128 v[96:99], v245 offset:8192
v_mfma_f32_16x16x32_bf16 v[28:31], v[164:167], v[124:127], v[28:31]
ds_read_b128 v[100:103], v245 offset:10240
s_waitcnt lgkmcnt(5)
v_mfma_f32_16x16x32_bf16 v[32:35], v[156:159], v[80:83], v[32:35]
ds_read_b64_tr_b16 v[160:161], v244 offset:2048
s_waitcnt lgkmcnt(5)
v_mfma_f32_16x16x32_bf16 v[36:39], v[156:159], v[84:87], v[36:39]
ds_read_b64_tr_b16 v[162:163], v244 offset:2560
s_waitcnt lgkmcnt(5)
v_mfma_f32_16x16x32_bf16 v[40:43], v[156:159], v[88:91], v[40:43]
ds_read_b64_tr_b16 v[152:153], v244 offset:0
s_waitcnt lgkmcnt(5)
v_mfma_f32_16x16x32_bf16 v[44:47], v[156:159], v[92:95], v[44:47]
ds_read_b64_tr_b16 v[154:155], v244 offset:512
s_waitcnt lgkmcnt(5)
v_mfma_f32_16x16x32_bf16 v[48:51], v[156:159], v[96:99], v[48:51]
ds_read_b64_tr_b16 v[168:169], v244 offset:13312
s_waitcnt lgkmcnt(5)
v_mfma_f32_16x16x32_bf16 v[52:55], v[156:159], v[100:103], v[52:55]
ds_read_b64_tr_b16 v[170:171], v244 offset:13824
s_waitcnt lgkmcnt(4)
v_mfma_f32_16x16x32_bf16 v[56:59], v[160:163], v[80:83], v[56:59]
ds_read_b128 v[104:107], v246 offset:0
v_mfma_f32_16x16x32_bf16 v[60:63], v[160:163], v[84:87], v[60:63]
ds_read_b128 v[108:111], v246 offset:2048
v_mfma_f32_16x16x32_bf16 v[64:67], v[160:163], v[88:91], v[64:67]
ds_read_b128 v[112:115], v246 offset:4096
v_mfma_f32_16x16x32_bf16 v[68:71], v[160:163], v[92:95], v[68:71]
ds_read_b128 v[116:119], v246 offset:6144
v_mfma_f32_16x16x32_bf16 v[72:75], v[160:163], v[96:99], v[72:75]
ds_read_b128 v[120:123], v246 offset:8192
v_mfma_f32_16x16x32_bf16 v[76:79], v[160:163], v[100:103], v[76:79]
ds_read_b128 v[124:127], v246 offset:10240
s_waitcnt lgkmcnt(8)
v_mfma_f32_16x16x32_bf16 v[8:11], v[152:155], v[80:83], v[8:11]
ds_read_b64_tr_b16 v[172:173], v244 offset:14336
v_mfma_f32_16x16x32_bf16 v[12:15], v[152:155], v[84:87], v[12:15]
ds_read_b64_tr_b16 v[174:175], v244 offset:14848
v_mfma_f32_16x16x32_bf16 v[16:19], v[152:155], v[88:91], v[16:19]
ds_read_b64_tr_b16 v[164:165], v244 offset:12288
v_mfma_f32_16x16x32_bf16 v[20:23], v[152:155], v[92:95], v[20:23]
ds_read_b64_tr_b16 v[166:167], v244 offset:12800
v_mfma_f32_16x16x32_bf16 v[24:27], v[152:155], v[96:99], v[24:27]
s_add_u32 s3, s65, 36864
s_cmp_eq_u32 s3, 155648
v_mfma_f32_16x16x32_bf16 v[28:31], v[152:155], v[100:103], v[28:31]
s_cselect_b32 s3, 8192, s3
s_sub_u32 s63, s3, s65
s_waitcnt lgkmcnt(4)
v_mfma_f32_16x16x32_bf16 v[32:35], v[168:171], v[104:107], v[32:35]
s_mov_b32 s65, s3
v_add_u32 v245, s63, v245
v_mfma_f32_16x16x32_bf16 v[36:39], v[168:171], v[108:111], v[36:39]
v_add_u32 v244, s63, v244
v_add_u32 v246, s63, v246
v_mfma_f32_16x16x32_bf16 v[40:43], v[168:171], v[112:115], v[40:43]
s_cmp_eq_u32 s42, s62
s_cbranch_scc1 L_ev
L_evb:
v_mfma_f32_16x16x32_bf16 v[44:47], v[168:171], v[116:119], v[44:47]
v_mfma_f32_16x16x32_bf16 v[48:51], v[168:171], v[120:123], v[48:51]
s_add_u32 s42, s42, 1
s_cmp_lt_u32 s42, 9
v_mfma_f32_16x16x32_bf16 v[52:55], v[168:171], v[124:127], v[52:55]
s_waitcnt lgkmcnt(2)
v_mfma_f32_16x16x32_bf16 v[56:59], v[172:175], v[104:107], v[56:59]
v_mfma_f32_16x16x32_bf16 v[60:63], v[172:175], v[108:111], v[60:63]
v_mfma_f32_16x16x32_bf16 v[64:67], v[172:175], v[112:115], v[64:67]
v_mfma_f32_16x16x32_bf16 v[68:71], v[172:175], v[116:119], v[68:71]
v_mfma_f32_16x16x32_bf16 v[72:75], v[172:175], v[120:123], v[72:75]
s_waitcnt lgkmcnt(0)
v_mfma_f32_16x16x32_bf16 v[76:79], v[172:175], v[124:127], v[76:79]
s_cbranch_scc1 L_cloop
v_mov_b32 v1, 1728
ds_read_b32 v1, v1
ds_read2_b64 v[180:183], v248 offset0:0 offset1:32
ds_read2_b64 v[184:187], v248 offset0:64 offset1:96
ds_read2_b64 v[188:191], v248 offset0:128 offset1:160
s_waitcnt lgkmcnt(0)
v_readfirstlane_b32 s41, v1
s_barrier
s_cmp_eq_u32 s41, 1
s_cbranch_scc0 L_gs
L_gsb:
ds_read_b64_tr_b16 v[156:157], v244 offset:1024
ds_read_b64_tr_b16 v[158:159], v244 offset:1536
v_mfma_f32_16x16x32_bf16 v[8:11], v[164:167], v[104:107], v[8:11]
ds_read_b128 v[80:83], v245 offset:0
v_mfma_f32_16x16x32_bf16 v[12:15], v[164:167], v[108:111], v[12:15]
ds_read_b128 v[84:87], v245 offset:2048
v_mfma_f32_16x16x32_bf16 v[16:19], v[164:167], v[112:115], v[16:19]
ds_read_b128 v[88:91], v245 offset:4096
v_mfma_f32_16x16x32_bf16 v[20:23], v[164:167], v[116:119], v[20:23]
ds_read_b128 v[92:95], v245 offset:6144
v_mfma_f32_16x16x32_bf16 v[24:27], v[164:167], v[120:123], v[24:27]
ds_read_b128 v[96:99], v245 offset:8192
v_mfma_f32_16x16x32_bf16 v[28:31], v[164:167], v[124:127], v[28:31]
ds_read_b128 v[100:103], v245 offset:10240
ds_read_b64_tr_b16 v[176:177], v244 offset:13312
ds_read_b64_tr_b16 v[178:179], v244 offset:13824
s_waitcnt lgkmcnt(7)
v_mfma_f32_16x16x32_bf16 v[32:35], v[156:159], v[80:83], v[32:35]
ds_read_b128 v[128:131], v246 offset:0
s_waitcnt lgkmcnt(7)
v_mfma_f32_16x16x32_bf16 v[36:39], v[156:159], v[84:87], v[36:39]
ds_read_b128 v[132:135], v246 offset:2048
s_waitcnt lgkmcnt(7)
v_mfma_f32_16x16x32_bf16 v[40:43], v[156:159], v[88:91], v[40:43]
ds_read_b128 v[136:139], v246 offset:4096
s_waitcnt lgkmcnt(7)
v_mfma_f32_16x16x32_bf16 v[44:47], v[156:159], v[92:95], v[44:47]
ds_read_b128 v[140:143], v246 offset:6144
s_waitcnt lgkmcnt(7)
v_mfma_f32_16x16x32_bf16 v[48:51], v[156:159], v[96:99], v[48:51]
ds_read_b128 v[144:147], v246 offset:8192
s_waitcnt lgkmcnt(7)
v_mfma_f32_16x16x32_bf16 v[52:55], v[156:159], v[100:103], v[52:55]
ds_read_b128 v[148:151], v246 offset:10240
s_waitcnt lgkmcnt(5)
v_mfma_f32_16x16x32_bf16 v[32:35], v[176:179], v[128:131], v[32:35]
ds_read_b64_tr_b16 v[160:161], v244 offset:2048
s_waitcnt lgkmcnt(5)
v_mfma_f32_16x16x32_bf16 v[36:39], v[176:179], v[132:135], v[36:39]
ds_read_b64_tr_b16 v[162:163], v244 offset:2560
s_waitcnt lgkmcnt(5)
v_mfma_f32_16x16x32_bf16 v[40:43], v[176:179], v[136:139], v[40:43]
ds_read_b64_tr_b16 v[152:153], v244 offset:0
s_waitcnt lgkmcnt(5)
v_mfma_f32_16x16x32_bf16 v[44:47], v[176:179], v[140:143], v[44:47]
ds_read_b64_tr_b16 v[154:155], v244 offset:512
s_waitcnt lgkmcnt(5)
v_mfma_f32_16x16x32_bf16 v[48:51], v[176:179], v[144:147], v[48:51]
ds_read_b64_tr_b16 v[172:173], v244 offset:14336
s_waitcnt lgkmcnt(5)
v_mfma_f32_16x16x32_bf16 v[52:55], v[176:179], v[148:151], v[52:55]
ds_read_b64_tr_b16 v[174:175], v244 offset:14848
s_waitcnt lgkmcnt(4)
v_mfma_f32_16x16x32_bf16 v[56:59], v[160:163], v[80:83], v[56:59]
ds_read_b64_tr_b16 v[164:165], v244 offset:12288
ds_read_b64_tr_b16 v[166:167], v244 offset:12800
v_mov_b32_dpp v192, v32 row_newbcast:0 row_mask:0xf bank_mask:0xf
v_mov_b32_dpp v193, v33 row_newbcast:0 row_mask:0xf bank_mask:0xf
v_mov_b32_dpp v194, v34 row_newbcast:0 row_mask:0xf bank_mask:0xf
v_mov_b32_dpp v195, v35 row_newbcast:0 row_mask:0xf bank_mask:0xf
v_fmac_f32 v32, v192, v180
v_fmac_f32 v33, v193, v180
v_fmac_f32 v34, v194, v180
v_mfma_f32_16x16x32_bf16 v[60:63], v[160:163], v[84:87], v[60:63]
v_fmac_f32 v35, v195, v180
v_cvt_pk_bf16_f32 v32, v32, v33
v_cvt_pk_bf16_f32 v33, v34, v35
v_mfma_f32_16x16x32_bf16 v[64:67], v[160:163], v[88:91], v[64:67]
ds_write_b64 v247, v[32:33] offset:13824
v_fmac_f32 v36, v192, v182
v_fmac_f32 v37, v193, v182
v_fmac_f32 v38, v194, v182
v_mfma_f32_16x16x32_bf16 v[68:71], v[160:163], v[92:95], v[68:71]
v_fmac_f32 v39, v195, v182
v_cvt_pk_bf16_f32 v36, v36, v37
v_cvt_pk_bf16_f32 v37, v38, v39
v_mfma_f32_16x16x32_bf16 v[72:75], v[160:163], v[96:99], v[72:75]
ds_write_b64 v247, v[36:37] offset:16128
v_fmac_f32 v40, v192, v184
v_fmac_f32 v41, v193, v184
v_fmac_f32 v42, v194, v184
v_mfma_f32_16x16x32_bf16 v[76:79], v[160:163], v[100:103], v[76:79]
v_fmac_f32 v43, v195, v184
v_cvt_pk_bf16_f32 v40, v40, v41
v_cvt_pk_bf16_f32 v41, v42, v43
s_waitcnt lgkmcnt(4)
v_mfma_f32_16x16x32_bf16 v[56:59], v[172:175], v[128:131], v[56:59]
ds_write_b64 v247, v[40:41] offset:18432
v_fmac_f32 v44, v192, v186
v_fmac_f32 v45, v193, v186
v_fmac_f32 v46, v194, v186
v_mfma_f32_16x16x32_bf16 v[60:63], v[172:175], v[132:135], v[60:63]
v_fmac_f32 v47, v195, v186
v_cvt_pk_bf16_f32 v44, v44, v45
v_cvt_pk_bf16_f32 v45, v46, v47
v_mfma_f32_16x16x32_bf16 v[64:67], v[172:175], v[136:139], v[64:67]
ds_write_b64 v247, v[44:45] offset:20736
v_fmac_f32 v48, v192, v188
v_fmac_f32 v49, v193, v188
v_fmac_f32 v50, v194, v188
v_mfma_f32_16x16x32_bf16 v[68:71], v[172:175], v[140:143], v[68:71]
v_fmac_f32 v51, v195, v188
v_cvt_pk_bf16_f32 v48, v48, v49
v_cvt_pk_bf16_f32 v49, v50, v51
v_mfma_f32_16x16x32_bf16 v[72:75], v[172:175], v[144:147], v[72:75]
ds_write_b64 v247, v[48:49] offset:23040
v_fmac_f32 v52, v192, v190
v_fmac_f32 v53, v193, v190
v_fmac_f32 v54, v194, v190
v_mfma_f32_16x16x32_bf16 v[76:79], v[172:175], v[148:151], v[76:79]
v_fmac_f32 v55, v195, v190
v_cvt_pk_bf16_f32 v52, v52, v53
v_cvt_pk_bf16_f32 v53, v54, v55
ds_write_b64 v247, v[52:53] offset:25344
v_mfma_f32_16x16x32_bf16 v[8:11], v[152:155], v[80:83], v[8:11]
v_mov_b32_dpp v192, v56 row_newbcast:0 row_mask:0xf bank_mask:0xf
v_mov_b32_dpp v193, v57 row_newbcast:0 row_mask:0xf bank_mask:0xf
v_mov_b32_dpp v194, v58 row_newbcast:0 row_mask:0xf bank_mask:0xf
v_mov_b32_dpp v195, v59 row_newbcast:0 row_mask:0xf bank_mask:0xf
v_fmac_f32 v56, v192, v180
v_fmac_f32 v57, v193, v180
v_fmac_f32 v58, v194, v180
v_mfma_f32_16x16x32_bf16 v[12:15], v[152:155], v[84:87], v[12:15]
v_fmac_f32 v59, v195, v180
v_cvt_pk_bf16_f32 v56, v56, v57
v_cvt_pk_bf16_f32 v57, v58, v59
v_mfma_f32_16x16x32_bf16 v[16:19], v[152:155], v[88:91], v[16:19]
s_waitcnt lgkmcnt(0)
s_barrier
ds_write_b64 v247, v[56:57] offset:27648
v_fmac_f32 v60, v192, v182
v_fmac_f32 v61, v193, v182
v_fmac_f32 v62, v194, v182
v_mfma_f32_16x16x32_bf16 v[20:23], v[152:155], v[92:95], v[20:23]
v_fmac_f32 v63, v195, v182
v_cvt_pk_bf16_f32 v60, v60, v61
v_cvt_pk_bf16_f32 v61, v62, v63
v_mfma_f32_16x16x32_bf16 v[24:27], v[152:155], v[96:99], v[24:27]
ds_write_b64 v247, v[60:61] offset:29952
v_fmac_f32 v64, v192, v184
v_fmac_f32 v65, v193, v184
v_fmac_f32 v66, v194, v184
v_mfma_f32_16x16x32_bf16 v[28:31], v[152:155], v[100:103], v[28:31]
v_fmac_f32 v67, v195, v184
v_cvt_pk_bf16_f32 v64, v64, v65
v_cvt_pk_bf16_f32 v65, v66, v67
v_mfma_f32_16x16x32_bf16 v[8:11], v[164:167], v[128:131], v[8:11]
ds_write_b64 v247, v[64:65] offset:32256
v_fmac_f32 v68, v192, v186
v_fmac_f32 v69, v193, v186
v_fmac_f32 v70, v194, v186
v_mfma_f32_16x16x32_bf16 v[12:15], v[164:167], v[132:135], v[12:15]
v_fmac_f32 v71, v195, v186
v_cvt_pk_bf16_f32 v68, v68, v69
v_cvt_pk_bf16_f32 v69, v70, v71
v_mfma_f32_16x16x32_bf16 v[16:19], v[164:167], v[136:139], v[16:19]
ds_write_b64 v247, v[68:69] offset:34560
v_fmac_f32 v72, v192, v188
v_fmac_f32 v73, v193, v188
v_fmac_f32 v74, v194, v188
v_mfma_f32_16x16x32_bf16 v[20:23], v[164:167], v[140:143], v[20:23]
v_fmac_f32 v75, v195, v188
v_cvt_pk_bf16_f32 v72, v72, v73
v_cvt_pk_bf16_f32 v73, v74, v75
v_mfma_f32_16x16x32_bf16 v[24:27], v[164:167], v[144:147], v[24:27]
ds_write_b64 v247, v[72:73] offset:36864
v_fmac_f32 v76, v192, v190
v_fmac_f32 v77, v193, v190
v_fmac_f32 v78, v194, v190
v_mfma_f32_16x16x32_bf16 v[28:31], v[164:167], v[148:151], v[28:31]
v_fmac_f32 v79, v195, v190
v_cvt_pk_bf16_f32 v76, v76, v77
v_cvt_pk_bf16_f32 v77, v78, v79
ds_write_b64 v247, v[76:77] offset:39168
v_mov_b32_dpp v192, v8 row_newbcast:0 row_mask:0xf bank_mask:0xf
v_mov_b32_dpp v193, v9 row_newbcast:0 row_mask:0xf bank_mask:0xf
v_mov_b32_dpp v194, v10 row_newbcast:0 row_mask:0xf bank_mask:0xf
v_mov_b32_dpp v195, v11 row_newbcast:0 row_mask:0xf bank_mask:0xf
v_pk_fma_f32 v[8:9], v[192:193], v[180:181], v[8:9] op_sel_hi:[1,0,1]
v_pk_fma_f32 v[10:11], v[194:195], v[180:181], v[10:11] op_sel_hi:[1,0,1]
v_cvt_pk_bf16_f32 v8, v8, v9
v_cvt_pk_bf16_f32 v9, v10, v11
ds_write_b64 v247, v[8:9] offset:0
v_pk_fma_f32 v[12:13], v[192:193], v[182:183], v[12:13] op_sel_hi:[1,0,1]
v_pk_fma_f32 v[14:15], v[194:195], v[182:183], v[14:15] op_sel_hi:[1,0,1]
v_cvt_pk_bf16_f32 v12, v12, v13
v_cvt_pk_bf16_f32 v13, v14, v15
ds_write_b64 v247, v[12:13] offset:2304
v_pk_fma_f32 v[16:17], v[192:193], v[184:185], v[16:17] op_sel_hi:[1,0,1]
v_pk_fma_f32 v[18:19], v[194:195], v[184:185], v[18:19] op_sel_hi:[1,0,1]
v_cvt_pk_bf16_f32 v16, v16, v17
v_cvt_pk_bf16_f32 v17, v18, v19
ds_write_b64 v247, v[16:17] offset:4608
v_pk_fma_f32 v[20:21], v[192:193], v[186:187], v[20:21] op_sel_hi:[1,0,1]
v_pk_fma_f32 v[22:23], v[194:195], v[186:187], v[22:23] op_sel_hi:[1,0,1]
v_cvt_pk_bf16_f32 v20, v20, v21
v_cvt_pk_bf16_f32 v21, v22, v23
ds_write_b64 v247, v[20:21] offset:6912
v_pk_fma_f32 v[24:25], v[192:193], v[188:189], v[24:25] op_sel_hi:[1,0,1]
v_pk_fma_f32 v[26:27], v[194:195], v[188:189], v[26:27] op_sel_hi:[1,0,1]
v_cvt_pk_bf16_f32 v24, v24, v25
v_cvt_pk_bf16_f32 v25, v26, v27
ds_write_b64 v247, v[24:25] offset:9216
v_pk_fma_f32 v[28:29], v[192:193], v[190:191], v[28:29] op_sel_hi:[1,0,1]
v_pk_fma_f32 v[30:31], v[194:195], v[190:191], v[30:31] op_sel_hi:[1,0,1]
v_cvt_pk_bf16_f32 v28, v28, v29
v_cvt_pk_bf16_f32 v29, v30, v31
ds_write_b64 v247, v[28:29] offset:11520
s_waitcnt lgkmcnt(0)
s_barrier
s_cmp_lt_u32 s32, 2
s_cbranch_scc0 L_c23
ds_read_b64 v[108:109], v200 offset:0
ds_read_b64 v[110:111], v200 offset:1152
ds_read_b64 v[128:129], v204 offset:0
ds_read_b64 v[130:131], v205 offset:0
ds_read_b64 v[112:113], v200 offset:40
ds_read_b64 v[114:115], v200 offset:1192
ds_read_b64 v[132:133], v204 offset:40
ds_read_b64 v[134:135], v205 offset:40
ds_read_b64 v[104:105], v201 offset:0
ds_read_b64 v[106:107], v201 offset:1152
ds_read_b64 v[136:137], v212 offset:0
ds_read_b64 v[138:139], v213 offset:0
ds_read_b64 v[140:141], v214 offset:0
ds_read_b64 v[142:143], v215 offset:0
v_mov_b32 v176, 0
v_mov_b32 v177, 0
v_mov_b32 v178, 0
v_mov_b32 v179, 0
v_mov_b32 v180, 0
v_mov_b32 v181, 0
v_mov_b32 v182, 0
v_mov_b32 v183, 0
s_waitcnt lgkmcnt(10)
v_mfma_f32_16x16x32_bf16 v[160:163], v[108:111], v[128:131], 0
s_waitcnt lgkmcnt(6)
v_mfma_f32_16x16x32_bf16 v[164:167], v[112:115], v[132:135], 0
v_add_u32 v1, 128, v222
v_cndmask_b32 v2, v1, v222, s[44:45]
ds_read_b64 v[168:169], v2 offset:0
v_cndmask_b32 v2, v1, v222, s[46:47]
ds_read_b64 v[170:171], v2 offset:32
v_cndmask_b32 v2, v1, v222, s[48:49]
ds_read_b64 v[172:173], v2 offset:64
v_cndmask_b32 v2, v1, v222, s[50:51]
ds_read_b64 v[174:175], v2 offset:96
ds_read_b32 v5, v223
s_waitcnt lgkmcnt(7)
v_mfma_f32_16x16x32_bf16 v[160:163], v[104:107], v[136:139], v[160:163]
s_waitcnt lgkmcnt(5)
v_mfma_f32_16x16x32_bf16 v[164:167], v[104:107], v[140:143], v[164:167]
s_nop 7
v_permlane16_swap_b32 v160, v164
v_permlane16_swap_b32 v161, v165
v_permlane16_swap_b32 v162, v166
v_permlane16_swap_b32 v163, v167
v_cndmask_b32 v196, v164, v160, s[44:45]
v_cndmask_b32 v197, v165, v161, s[46:47]
v_cndmask_b32 v198, v166, v162, s[48:49]
v_cndmask_b32 v199, v167, v163, s[50:51]
s_waitcnt lgkmcnt(0)
v_mul_f32 v5, 0x3ea52b5c, v5
v_fma_f32 v196, v196, v168, v169
v_fma_f32 v197, v197, v170, v171
v_fma_f32 v198, v198, v172, v173
v_fma_f32 v199, v199, v174, v175
v_max3_f32 v6, v196, v197, v198
v_max_f32 v6, v6, v199
v_mov_b32 v7, v6
s_nop 1
v_permlane32_swap_b32 v6, v7
v_max_f32 v6, v6, v7
v_mul_f32 v6, v6, v5
v_fma_f32 v196, v196, v5, -v6
v_fma_f32 v197, v197, v5, -v6
v_fma_f32 v198, v198, v5, -v6
v_fma_f32 v199, v199, v5, -v6
v_exp_f32 v196, v196
v_exp_f32 v197, v197
v_exp_f32 v198, v198
v_exp_f32 v199, v199
ds_read_b64_tr_b16 v[64:65], v216 offset:0
ds_read_b64_tr_b16 v[66:67], v216 offset:1152
ds_read_b64_tr_b16 v[68:69], v216 offset:40
ds_read_b64_tr_b16 v[70:71], v216 offset:1192
ds_read_b64_tr_b16 v[72:73], v217 offset:0
ds_read_b64_tr_b16 v[74:75], v217 offset:1152
ds_read_b64_tr_b16 v[76:77], v218 offset:0
ds_read_b64_tr_b16 v[78:79], v218 offset:1152
v_add_f32 v6, v196, v197
v_add_f32 v7, v198, v199
v_add_f32 v6, v6, v7
v_mov_b32 v7, v6
v_mul_f32 v196, v196, v168
v_mul_f32 v197, v197, v170
v_permlane32_swap_b32 v6, v7
v_mul_f32 v198, v198, v172
v_add_f32 v6, v6, v7
v_rcp_f32 v6, v6
v_mul_f32 v199, v199, v174
v_mul_f32 v196, v196, v6
v_mul_f32 v197, v197, v6
v_mul_f32 v198, v198, v6
v_mul_f32 v199, v199, v6
v_cvt_pk_bf16_f32 v196, v196, v197
v_cvt_pk_bf16_f32 v197, v198, v199
s_mov_b64 exec, s[52:53]
v_and_b32 v176, v220, v196
v_bfi_b32 v180, v220, 0, v196
v_and_b32 v177, v221, v197
v_bfi_b32 v181, v221, 0, v197
s_not_b64 exec, exec
v_and_b32 v178, v220, v196
v_bfi_b32 v182, v220, 0, v196
v_and_b32 v179, v221, v197
v_bfi_b32 v183, v221, 0, v197
s_mov_b64 exec, -1
v_permlane16_swap_b32 v176, v180
v_permlane16_swap_b32 v177, v181
v_permlane16_swap_b32 v178, v182
v_permlane16_swap_b32 v179, v183
s_waitcnt lgkmcnt(0)
s_nop 0
v_mfma_f32_16x16x32_bf16 v[152:155], v[64:67], v[176:179], 0
v_mfma_f32_16x16x32_bf16 v[156:159], v[68:71], v[180:183], 0
v_mfma_f32_16x16x32_bf16 v[160:163], v[72:75], v[176:179], 0
v_mfma_f32_16x16x32_bf16 v[164:167], v[76:79], v[180:183], 0
s_nop 4
v_cvt_pk_bf16_f32 v196, v152, v153
v_cvt_pk_bf16_f32 v197, v154, v155
v_cvt_pk_bf16_f32 v198, v156, v157
v_cvt_pk_bf16_f32 v199, v158, v159
s_cmp_eq_u32 s41, 1
s_cbranch_scc0 L_gl_19g
buffer_store_dwordx4 v[196:199], v226, s[20:23], 0 offen
L_gl_19b:
s_lshl_b32 s0, s32, 2
s_add_u32 s0, s0, 1752
v_mov_b32 v1, s0
ds_read_b32 v1, v1
v_cvt_pk_bf16_f32 v80, v160, v161
v_cvt_pk_bf16_f32 v81, v162, v163
v_cvt_pk_bf16_f32 v82, v164, v165
v_cvt_pk_bf16_f32 v83, v166, v167
s_waitcnt lgkmcnt(0)
v_cmp_eq_u32 vcc, 0, v1
s_cbranch_vccnz L_spr
L_sbr:
s_mov_b64 exec, 0xffff
s_cmp_eq_u32 s41, 1
s_cbranch_scc0 L_gl_20g
buffer_store_dwordx4 v[80:83], v226, s[20:23], s54 offen
L_gl_20b:
s_mov_b64 exec, -1
v_lshrrev_b32 v1, 4, v0
v_lshlrev_b32 v1, 3, v1
s_lshl_b32 s3, s36, 7
buffer_load_dwordx2 v[244:245], v1, s[28:31], s3 offen offset:0
buffer_load_dwordx2 v[246:247], v1, s[28:31], s3 offen offset:32
buffer_load_dwordx2 v[248:249], v1, s[28:31], s3 offen offset:64
buffer_load_dwordx2 v[250:251], v1, s[28:31], s3 offen offset:96
v_lshlrev_b32 v8, 16, v236
v_and_b32 v9, 0xffff0000, v236
v_lshlrev_b32 v10, 16, v237
v_and_b32 v11, 0xffff0000, v237
v_lshlrev_b32 v12, 16, v238
v_and_b32 v13, 0xffff0000, v238
v_lshlrev_b32 v14, 16, v239
v_and_b32 v15, 0xffff0000, v239
v_lshlrev_b32 v16, 16, v240
v_and_b32 v17, 0xffff0000, v240
v_lshlrev_b32 v18, 16, v241
v_and_b32 v19, 0xffff0000, v241
v_lshlrev_b32 v20, 16, v242
v_and_b32 v21, 0xffff0000, v242
v_lshlrev_b32 v22, 16, v243
v_and_b32 v23, 0xffff0000, v243
s_lshl_b32 s0, s32, 13
s_add_u32 s0, s0, 57344
v_add_u32 v4, s0, v233
s_lshl_b32 s0, s32, 2
s_add_u32 s0, s0, 1760
s_waitcnt vmcnt(0)
s_mov_b32 s3, 0x3f803f80
v_mov_b32 v236, s3
v_mov_b32 v237, s3
v_mov_b32 v238, s3
v_mov_b32 v239, s3
s_mov_b32 exec_lo, 0x11111111
s_mov_b32 exec_hi, 0x11111111
v_mov_b32 v244, s3
v_mov_b32 v245, s3
v_mov_b32 v246, s3
v_mov_b32 v247, s3
v_mov_b32 v248, s3
v_mov_b32 v249, s3
v_mov_b32 v250, s3
v_mov_b32 v251, s3
s_mov_b64 exec, -1
v_mfma_f32_16x16x32_bf16 v[252:255], v[244:247], v[236:239], 0
v_mfma_f32_16x16x32_bf16 v[252:255], v[248:251], v[236:239], v[252:255]
v_mov_b32 v2, s0
L_fx:
s_sleep 1
ds_read_b32 v1, v2
s_waitcnt lgkmcnt(0)
v_cmp_ne_u32 vcc, 2, v1
s_cbranch_vccnz L_fx
s_setprio 2
ds_read_b128 v[24:27], v4 offset:0
ds_read_b128 v[28:31], v4 offset:1024
ds_read_b128 v[32:35], v4 offset:2048
ds_read_b128 v[36:39], v4 offset:3072
ds_read_b128 v[40:43], v4 offset:4096
ds_read_b128 v[44:47], v4 offset:5120
ds_read_b128 v[48:51], v4 offset:6144
ds_read_b128 v[52:55], v4 offset:7168
s_waitcnt lgkmcnt(7)
v_add_f32 v8, v8, v24
v_add_f32 v9, v9, v25
v_add_f32 v10, v10, v26
v_add_f32 v11, v11, v27
s_waitcnt lgkmcnt(6)
v_add_f32 v12, v12, v28
v_add_f32 v13, v13, v29
v_add_f32 v14, v14, v30
v_add_f32 v15, v15, v31
s_waitcnt lgkmcnt(5)
v_add_f32 v16, v16, v32
v_add_f32 v17, v17, v33
v_add_f32 v18, v18, v34
v_add_f32 v19, v19, v35
s_waitcnt lgkmcnt(4)
v_add_f32 v20, v20, v36
v_add_f32 v21, v21, v37
v_add_f32 v22, v22, v38
v_add_f32 v23, v23, v39
s_waitcnt lgkmcnt(3)
v_add_f32 v8, v8, v40
v_add_f32 v9, v9, v41
v_add_f32 v10, v10, v42
v_add_f32 v11, v11, v43
s_waitcnt lgkmcnt(2)
v_add_f32 v12, v12, v44
v_add_f32 v13, v13, v45
v_add_f32 v14, v14, v46
v_add_f32 v15, v15, v47
s_waitcnt lgkmcnt(1)
v_add_f32 v16, v16, v48
v_add_f32 v17, v17, v49
v_add_f32 v18, v18, v50
v_add_f32 v19, v19, v51
s_waitcnt lgkmcnt(0)
v_add_f32 v20, v20, v52
v_add_f32 v21, v21, v53
v_add_f32 v22, v22, v54
v_add_f32 v23, v23, v55
s_branch L_tail
L_gl_19g:
buffer_store_dwordx4 v[196:199], v226, s[20:23], 0 offen sc1
s_branch L_gl_19b
L_spr:
s_sleep 1
v_mov_b32 v1, s0
ds_read_b32 v1, v1
s_waitcnt lgkmcnt(0)
v_cmp_eq_u32 vcc, 0, v1
s_cbranch_vccnz L_spr
s_branch L_sbr
L_gl_20g:
buffer_store_dwordx4 v[80:83], v226, s[20:23], s54 offen sc1
s_branch L_gl_20b
L_moe:
s_cmp_ge_u32 s34, 32
s_cbranch_scc1 L_end
s_lshr_b32 s32, s32, 6
v_and_b32 v0, 63, v0
s_lshl_b32 s36, s33, 1
s_add_u32 s36, s36, s34
s_sub_u32 s36, s36, 30
s_mov_b32 s40, 524288
v_lshlrev_b32 v6, 4, v0
v_mov_b32 v132, 0
v_mov_b32 v133, 0
s_waitcnt lgkmcnt(0)
s_mov_b64 s[16:17], s[66:67]
s_mov_b32 s18, 0x10000000
s_mov_b32 s19, 0x20000
s_mov_b64 s[24:25], s[64:65]
s_mov_b32 s26, 0x100
s_mov_b32 s27, 0x20000
s_mov_b64 s[4:5], s[54:55]
s_mov_b32 s6, 0x1e0000
s_mov_b32 s7, 0x20000
s_mov_b64 s[8:9], s[56:57]
s_mov_b32 s10, 0x1e0000
s_mov_b32 s11, 0x20000
s_mov_b64 s[12:13], s[60:61]
s_mov_b32 s14, 0x1e0000
s_mov_b32 s15, 0x20000
s_mov_b64 s[20:21], s[62:63]
s_mov_b32 s22, 0x280000
s_mov_b32 s23, 0x20000
v_mov_b32 v8, -1
v_mov_b32 v9, -1
v_mov_b32 v10, -1
v_mov_b32 v11, -1
s_lshl_b32 s0, s36, 14
s_lshl_b32 s3, s32, 11
s_add_u32 s0, s0, s3
s_add_u32 s0, s0, 3145728
buffer_store_dwordx4 v[8:11], v6, s[16:19], s0 offen offset:0 sc1
buffer_store_dwordx4 v[8:11], v6, s[16:19], s0 offen offset:1024 sc1
s_and_b32 s44, s36, 1
s_mul_i32 s0, s33, 384
s_lshl_b32 s1, s44, 8
s_add_u32 s1, s1, s0
s_mul_i32 s3, s32, 24576
s_add_u32 s1, s1, s3
v_lshrrev_b32 v1, 3, v0
v_mul_u32_u24 v1, 3072, v1
s_lshr_b32 s3, s32, 1
v_xor_b32 v2, s3, v0
v_and_b32 v2, 7, v2
v_lshl_add_u32 v1, v2, 4, v1
v_add_u32 v4, s1, v1
v_xor_b32 v5, 64, v4
s_lshl_b32 s1, s44, 6
s_add_u32 s0, s0, s1
s_and_b32 s3, s32, 3
s_mul_i32 s1, s3, 49152
s_add_u32 s0, s0, s1
s_add_u32 s0, s0, 128
v_lshrrev_b32 v1, 2, v0
v_mul_u32_u24 v1, 3072, v1
v_xor_b32 v2, s3, v0
v_and_b32 v2, 3, v2
v_lshl_add_u32 v1, v2, 4, v1
v_add_u32 v249, s0, v1
s_cmp_lt_u32 s32, 4
s_cselect_b64 s[28:29], s[4:5], s[8:9]
s_cselect_b32 s62, 0, 128
s_mov_b32 s30, 0x1e0000
s_mov_b32 s31, 0x20000
s_lshl_b32 s61, s32, 10
s_add_u32 s62, s62, s61
s_mul_i32 s44, s44, 983040
s_mul_i32 s46, s36, 122880
s_cmp_lt_u32 s32, 5
s_cbranch_scc1 L_r0
s_add_u32 s45, s44, 0
s_add_u32 m0, s61, 0
s_nop 0
buffer_load_dwordx4 v4, s[4:7], s45 offen lds
s_add_u32 m0, s61, 8192
s_nop 0
buffer_load_dwordx4 v5, s[8:11], s45 offen lds
s_add_u32 s45, s44, 0
s_add_u32 m0, s62, 16384
s_nop 0
buffer_load_dwordx4 v249, s[28:31], s45 offen lds
s_waitcnt vmcnt(3)
s_barrier
s_branch L_r1
L_r0:
s_waitcnt vmcnt(0)
s_barrier
s_cmp_eq_u32 s32, 0
s_cbranch_scc0 L_nroot
s_lshl_b32 s0, s36, 4
v_mov_b32 v8, 1
s_mov_b64 exec, 1
buffer_store_dword v8, off, s[24:27], s0 sc1
s_mov_b64 exec, -1
L_nroot:
s_add_u32 s45, s44, 0
s_add_u32 m0, s61, 0
s_nop 0
buffer_load_dwordx4 v4, s[4:7], s45 offen lds
s_add_u32 m0, s61, 8192
s_nop 0
buffer_load_dwordx4 v5, s[8:11], s45 offen lds
s_add_u32 s45, s44, 0
s_add_u32 m0, s62, 16384
s_nop 0
buffer_load_dwordx4 v249, s[28:31], s45 offen lds
L_r1:
s_add_u32 s45, s44, 196608
s_add_u32 m0, s61, 42240
s_nop 0
buffer_load_dwordx4 v4, s[4:7], s45 offen lds
s_add_u32 m0, s61, 50432
s_nop 0
buffer_load_dwordx4 v5, s[8:11], s45 offen lds
s_add_u32 s45, s44, 196608
s_add_u32 m0, s62, 58624
s_nop 0
buffer_load_dwordx4 v249, s[28:31], s45 offen lds
v_lshrrev_b32 v1, 5, v0
v_bfe_u32 v2, v0, 2, 1
v_lshl_add_u32 v1, v1, 2, v2
v_bfe_u32 v2, v0, 4, 1
v_bfe_u32 v3, v0, 3, 1
v_lshl_add_u32 v3, v3, 1, v2
v_lshl_add_u32 v1, v3, 4, v1
v_xor_b32 v3, s32, v3
v_and_b32 v2, 1, v0
v_lshlrev_b32 v2, 3, v2
v_lshl_add_u32 v2, v3, 4, v2
v_bfe_u32 v3, v0, 1, 1
v_lshl_add_u32 v251, v1, 6, v2
v_mul_u32_u24 v8, 4224, v3
v_add_u32 v251, v251, v8
v_lshl_add_u32 v250, v1, 7, v2
v_mul_u32_u24 v8, 8256, v3
v_xor_b32 v250, v250, v8
v_mov_b32 v228, 0
v_mov_b32 v229, 0
v_mov_b32 v230, 0
v_mov_b32 v231, 0
v_mov_b32 v232, 0
v_mov_b32 v233, 0
v_mov_b32 v234, 0
v_mov_b32 v235, 0
v_mov_b32 v1, 0x4444
v_mov_b32 v2, 0xeeee
s_mov_b32 vcc_lo, 0xaaaaaaaa
s_mov_b32 vcc_hi, 0xaaaaaaaa
v_cndmask_b32 v7, v1, v2, vcc
v_and_b32 v1, 48, v0
v_and_b32 v2, 1, v0
v_lshlrev_b32 v2, 4, v2
v_lshl_add_u32 v252, v1, 1, v2
v_add_u32 v254, 126720, v252
v_add_u32 v252, 127232, v252
v_add_u32 v1, 126848, v1
v_mov_b32 v2, 126912
v_cndmask_b32 v255, v1, v2, vcc
v_mov_b32 v3, 0
v_lshl_add_u32 v2, v0, 2, v2
s_mov_b32 exec_hi, 0
ds_write_b32 v2, v3
s_mov_b64 exec, -1
s_and_b32 s3, s36, 1
s_cselect_b32 s0, 4, 0
s_cselect_b32 s1, -4, 8
s_add_u32 s0, s0, s32
v_bfe_u32 v1, v0, 4, 1
v_mul_i32_i24 v1, s1, v1
v_add_u32 v1, s0, v1
v_lshrrev_b32 v2, 1, v1
v_lshlrev_b32 v2, 2, v2
v_and_or_b32 v2, v1, 1, v2
v_and_or_b32 v2, v0, 2, v2
v_bfe_u32 v3, v0, 2, 1
v_lshl_add_u32 v2, v2, 1, v3
v_and_b32 v3, 1, v0
v_lshl_add_u32 v2, v2, 1, v3
v_and_b32 v3, 7, v0
v_lshl_add_u32 v3, v1, 3, v3
v_cmp_gt_u32 vcc, 8, v1
s_nop 1
v_cndmask_b32 v2, v3, v2, vcc
v_lshlrev_b32 v2, 1, v2
v_add_u32 v253, 126720, v2
s_lshl_b32 s47, s32, 15
s_lshl_b32 s3, s36, 6
s_add_u32 s47, s47, s3
s_add_u32 s47, s47, 3162112
v_lshrrev_b32 v1, 2, v0
v_and_b32 v2, 3, v0
v_lshlrev_b32 v2, 4, v2
v_lshl_add_u32 v2, v1, 10, v2
v_lshlrev_b32 v1, 4, v1
v_add_u32 v1, 4032, v1
s_mov_b64 vcc, 0xffff
v_cndmask_b32 v246, v1, v2, vcc
s_cmp_lt_u32 s32, 4
s_cselect_b32 s50, 0x00ff0000, 0
s_or_b32 s50, s50, 0xff
s_mov_b32 s51, 0
s_sub_u32 s3, s32, 4
s_lshl_b32 s3, s3, 4
s_add_u32 s52, s3, s36
s_mul_i32 s3, s52, 52
s_lshr_b32 s3, s3, 8
s_mul_i32 s3, s3, 27648
s_lshl_b32 s53, s52, 10
s_add_u32 s53, s53, s3
s_add_u32 s53, s53, 3162112
s_mov_b32 s49, 131072
s_mul_i32 s3, s52, 52
s_lshr_b32 s3, s3, 8
s_mul_i32 s0, s3, 5
s_sub_u32 s0, s52, s0
s_mul_i32 s3, s3, 80
s_lshl_b32 s1, s0, 2
s_cmp_eq_u32 s0, 4
s_cselect_b32 s1, 64, s1
s_cselect_b32 s0, 0, 4
s_cselect_b32 s48, 2, 0
s_add_u32 s3, s3, s1
v_bfe_u32 v1, v0, 4, 1
v_lshrrev_b32 v2, 5, v0
v_lshl_add_u32 v1, v1, 1, v2
v_lshlrev_b32 v1, s0, v1
v_and_b32 v2, 3, v0
v_lshlrev_b32 v2, s48, v2
v_add3_u32 v1, v1, v2, s3
v_lshlrev_b32 v128, 1, v1
v_lshlrev_b32 v129, 2, v1
v_lshrrev_b32 v1, 4, v0
v_bfe_u32 v2, v0, 2, 2
v_lshl_add_u32 v1, v1, 3, v2
v_mul_u32_u24 v1, 1280, v1
v_and_b32 v3, 1, v0
v_lshl_add_u32 v1, v3, 3, v1
v_bfe_u32 v2, v0, 2, 3
v_lshlrev_b32 v2, 1, v2
v_bfe_u32 v3, v0, 1, 1
s_mul_i32 s0, s32, 10
s_add_u32 s3, s0, 0
v_add_u32 v236, s3, v3
v_xor_b32 v236, v236, v2
v_lshl_add_u32 v236, v236, 4, v1
s_add_u32 s3, s0, 2
v_add_u32 v237, s3, v3
v_xor_b32 v237, v237, v2
v_lshl_add_u32 v237, v237, 4, v1
s_add_u32 s3, s0, 4
v_add_u32 v238, s3, v3
v_xor_b32 v238, v238, v2
v_lshl_add_u32 v238, v238, 4, v1
s_add_u32 s3, s0, 6
v_add_u32 v239, s3, v3
v_xor_b32 v239, v239, v2
v_lshl_add_u32 v239, v239, 4, v1
s_add_u32 s3, s0, 8
v_add_u32 v240, s3, v3
v_xor_b32 v240, v240, v2
v_lshl_add_u32 v240, v240, 4, v1
s_waitcnt vmcnt(3) lgkmcnt(0)
s_barrier
s_add_u32 s45, s44, 393216
s_add_u32 m0, s61, 84480
s_nop 0
buffer_load_dwordx4 v4, s[4:7], s45 offen lds
s_add_u32 m0, s61, 92672
s_nop 0
buffer_load_dwordx4 v5, s[8:11], s45 offen lds
s_add_u32 s45, s44, 393216
s_add_u32 m0, s62, 100864
s_nop 0
buffer_load_dwordx4 v249, s[28:31], s45 offen lds
v_add_u32 v1, 0, v250
ds_read_b64_tr_b16 v[8:9], v1 offset:0
ds_read_b64_tr_b16 v[10:11], v1 offset:256
ds_read_b64_tr_b16 v[12:13], v1 offset:1024
ds_read_b64_tr_b16 v[14:15], v1 offset:1280
s_cmp_lt_u32 s32, 4
s_cbranch_scc0 L_g0
v_add_u32 v1, 16384, v251
ds_read_b64_tr_b16 v[88:89], v1 offset:0
ds_read_b64_tr_b16 v[90:91], v1 offset:128
ds_read_b64_tr_b16 v[92:93], v1 offset:512
ds_read_b64_tr_b16 v[94:95], v1 offset:640
L_g0:
s_waitcnt vmcnt(3) lgkmcnt(0)
s_barrier
s_add_u32 s45, s44, 589824
s_add_u32 m0, s61, 0
s_nop 0
buffer_load_dwordx4 v4, s[4:7], s45 offen lds
s_add_u32 m0, s61, 8192
s_nop 0
buffer_load_dwordx4 v5, s[8:11], s45 offen lds
s_add_u32 s45, s44, 589824
s_add_u32 m0, s62, 16384
s_nop 0
buffer_load_dwordx4 v249, s[28:31], s45 offen lds
v_add_u32 v1, 42240, v250
ds_read_b64_tr_b16 v[16:17], v1 offset:0
ds_read_b64_tr_b16 v[18:19], v1 offset:256
ds_read_b64_tr_b16 v[20:21], v1 offset:1024
ds_read_b64_tr_b16 v[22:23], v1 offset:1280
s_cmp_lt_u32 s32, 4
s_cbranch_scc0 L_g1
v_add_u32 v1, 58624, v251
ds_read_b64_tr_b16 v[96:97], v1 offset:0
ds_read_b64_tr_b16 v[98:99], v1 offset:128
ds_read_b64_tr_b16 v[100:101], v1 offset:512
ds_read_b64_tr_b16 v[102:103], v1 offset:640
L_g1:
s_waitcnt vmcnt(3) lgkmcnt(0)
s_barrier
s_add_u32 s45, s44, 786432
s_add_u32 m0, s61, 42240
s_nop 0
buffer_load_dwordx4 v4, s[4:7], s45 offen lds
s_add_u32 m0, s61, 50432
s_nop 0
buffer_load_dwordx4 v5, s[8:11], s45 offen lds
s_add_u32 s45, s44, 786432
s_add_u32 m0, s62, 58624
s_nop 0
buffer_load_dwordx4 v249, s[28:31], s45 offen lds
v_add_u32 v1, 84480, v250
ds_read_b64_tr_b16 v[24:25], v1 offset:0
ds_read_b64_tr_b16 v[26:27], v1 offset:256
ds_read_b64_tr_b16 v[28:29], v1 offset:1024
ds_read_b64_tr_b16 v[30:31], v1 offset:1280
s_cmp_lt_u32 s32, 4
s_cbranch_scc0 L_g2
v_add_u32 v1, 100864, v251
ds_read_b64_tr_b16 v[104:105], v1 offset:0
ds_read_b64_tr_b16 v[106:107], v1 offset:128
ds_read_b64_tr_b16 v[108:109], v1 offset:512
ds_read_b64_tr_b16 v[110:111], v1 offset:640
L_g2:
s_waitcnt vmcnt(3) lgkmcnt(0)
s_barrier
s_sub_u32 s45, 983040, s44
s_add_u32 m0, s61, 84480
s_nop 0
buffer_load_dwordx4 v4, s[4:7], s45 offen lds
s_add_u32 m0, s61, 92672
s_nop 0
buffer_load_dwordx4 v5, s[8:11], s45 offen lds
s_sub_u32 s45, 1179648, s44
s_add_u32 m0, s61, 100864
s_nop 0
buffer_load_dwordx4 v4, s[4:7], s45 offen lds
s_add_u32 m0, s61, 109056
s_nop 0
buffer_load_dwordx4 v5, s[8:11], s45 offen lds
v_add_u32 v1, 0, v250
ds_read_b64_tr_b16 v[32:33], v1 offset:0
ds_read_b64_tr_b16 v[34:35], v1 offset:256
ds_read_b64_tr_b16 v[36:37], v1 offset:1024
ds_read_b64_tr_b16 v[38:39], v1 offset:1280
s_cmp_lt_u32 s32, 4
s_cbranch_scc0 L_g3
v_add_u32 v1, 16384, v251
ds_read_b64_tr_b16 v[112:113], v1 offset:0
ds_read_b64_tr_b16 v[114:115], v1 offset:128
ds_read_b64_tr_b16 v[116:117], v1 offset:512
ds_read_b64_tr_b16 v[118:119], v1 offset:640
L_g3:
s_waitcnt vmcnt(4) lgkmcnt(0)
s_barrier
s_sub_u32 s45, 1376256, s44
s_add_u32 m0, s61, 0
s_nop 0
buffer_load_dwordx4 v4, s[4:7], s45 offen lds
s_add_u32 m0, s61, 8192
s_nop 0
buffer_load_dwordx4 v5, s[8:11], s45 offen lds
s_sub_u32 s45, 1572864, s44
s_add_u32 m0, s61, 16384
s_nop 0
buffer_load_dwordx4 v4, s[4:7], s45 offen lds
s_add_u32 m0, s61, 24576
s_nop 0
buffer_load_dwordx4 v5, s[8:11], s45 offen lds
v_add_u32 v1, 42240, v250
ds_read_b64_tr_b16 v[40:41], v1 offset:0
ds_read_b64_tr_b16 v[42:43], v1 offset:256
ds_read_b64_tr_b16 v[44:45], v1 offset:1024
ds_read_b64_tr_b16 v[46:47], v1 offset:1280
s_cmp_lt_u32 s32, 4
s_cbranch_scc0 L_g4
v_add_u32 v1, 58624, v251
ds_read_b64_tr_b16 v[120:121], v1 offset:0
ds_read_b64_tr_b16 v[122:123], v1 offset:128
ds_read_b64_tr_b16 v[124:125], v1 offset:512
ds_read_b64_tr_b16 v[126:127], v1 offset:640
L_g4:
s_waitcnt vmcnt(4) lgkmcnt(0)
s_barrier
s_sub_u32 s45, 1769472, s44
s_add_u32 m0, s61, 42240
s_nop 0
buffer_load_dwordx4 v4, s[4:7], s45 offen lds
s_add_u32 m0, s61, 50432
s_nop 0
buffer_load_dwordx4 v5, s[8:11], s45 offen lds
v_add_u32 v1, 84480, v250
ds_read_b64_tr_b16 v[48:49], v1 offset:0
ds_read_b64_tr_b16 v[50:51], v1 offset:256
ds_read_b64_tr_b16 v[52:53], v1 offset:1024
ds_read_b64_tr_b16 v[54:55], v1 offset:1280
v_add_u32 v1, 100864, v250
ds_read_b64_tr_b16 v[56:57], v1 offset:0
ds_read_b64_tr_b16 v[58:59], v1 offset:256
ds_read_b64_tr_b16 v[60:61], v1 offset:1024
ds_read_b64_tr_b16 v[62:63], v1 offset:1280
v_and_b32 v248, 0xf0, v6
buffer_load_dword v247, v248, s[24:27], 0 offen sc1
s_waitcnt vmcnt(3) lgkmcnt(0)
s_barrier
s_lshl_b32 s3, s32, 6
s_addk_i32 s3, 0
v_add_u32 v1, s3, v0
v_mul_u32_u24 v2, 52429, v1
v_lshrrev_b32 v2, 22, v2
v_and_b32 v3, 3, v2
v_lshlrev_b32 v3, 1, v3
v_and_or_b32 v3, v2, 8, v3
v_xor_b32 v1, v1, v3
v_lshlrev_b32 v1, 4, v1
s_add_u32 m0, s61, 84480
s_add_u32 s3, s46, 0
buffer_load_dwordx4 v1, s[12:15], s3 offen lds
s_lshl_b32 s3, s32, 6
s_addk_i32 s3, 512
v_add_u32 v1, s3, v0
v_mul_u32_u24 v2, 52429, v1
v_lshrrev_b32 v2, 22, v2
v_and_b32 v3, 3, v2
v_lshlrev_b32 v3, 1, v3
v_and_or_b32 v3, v2, 8, v3
v_xor_b32 v1, v1, v3
v_lshlrev_b32 v1, 4, v1
s_add_u32 m0, s61, 92672
s_add_u32 s3, s46, 0
buffer_load_dwordx4 v1, s[12:15], s3 offen lds
s_lshl_b32 s3, s32, 6
s_addk_i32 s3, 1024
v_add_u32 v1, s3, v0
v_mul_u32_u24 v2, 52429, v1
v_lshrrev_b32 v2, 22, v2
v_and_b32 v3, 3, v2
v_lshlrev_b32 v3, 1, v3
v_and_or_b32 v3, v2, 8, v3
v_xor_b32 v1, v1, v3
v_lshlrev_b32 v1, 4, v1
s_add_u32 m0, s61, 100864
s_add_u32 s3, s46, 0
buffer_load_dwordx4 v1, s[12:15], s3 offen lds
s_lshl_b32 s3, s32, 6
s_addk_i32 s3, 1536
v_add_u32 v1, s3, v0
v_mul_u32_u24 v2, 52429, v1
v_lshrrev_b32 v2, 22, v2
v_and_b32 v3, 3, v2
v_lshlrev_b32 v3, 1, v3
v_and_or_b32 v3, v2, 8, v3
v_xor_b32 v1, v1, v3
v_lshlrev_b32 v1, 4, v1
s_add_u32 m0, s61, 109056
s_add_u32 s3, s46, 0
buffer_load_dwordx4 v1, s[12:15], s3 offen lds
s_lshl_b32 s3, s32, 6
s_addk_i32 s3, 2048
v_add_u32 v1, s3, v0
v_mul_u32_u24 v2, 52429, v1
v_lshrrev_b32 v2, 22, v2
v_and_b32 v3, 3, v2
v_lshlrev_b32 v3, 1, v3
v_and_or_b32 v3, v2, 8, v3
v_xor_b32 v1, v1, v3
v_lshlrev_b32 v1, 4, v1
s_add_u32 m0, s61, 117248
s_add_u32 s3, s46, 0
buffer_load_dwordx4 v1, s[12:15], s3 offen lds
v_add_u32 v1, 0, v250
ds_read_b64_tr_b16 v[64:65], v1 offset:0
ds_read_b64_tr_b16 v[66:67], v1 offset:256
ds_read_b64_tr_b16 v[68:69], v1 offset:1024
ds_read_b64_tr_b16 v[70:71], v1 offset:1280
v_add_u32 v1, 16384, v250
ds_read_b64_tr_b16 v[72:73], v1 offset:0
ds_read_b64_tr_b16 v[74:75], v1 offset:256
ds_read_b64_tr_b16 v[76:77], v1 offset:1024
ds_read_b64_tr_b16 v[78:79], v1 offset:1280
s_waitcnt vmcnt(5) lgkmcnt(0)
s_barrier
s_lshl_b32 s3, s32, 6
s_addk_i32 s3, 0
v_add_u32 v1, s3, v0
v_mul_u32_u24 v2, 52429, v1
v_lshrrev_b32 v2, 22, v2
v_and_b32 v3, 3, v2
v_lshlrev_b32 v3, 1, v3
v_and_or_b32 v3, v2, 8, v3
v_xor_b32 v1, v1, v3
v_lshlrev_b32 v1, 4, v1
s_add_u32 m0, s61, 0
s_add_u32 s3, s46, 40960
buffer_load_dwordx4 v1, s[12:15], s3 offen lds
s_lshl_b32 s3, s32, 6
s_addk_i32 s3, 512
v_add_u32 v1, s3, v0
v_mul_u32_u24 v2, 52429, v1
v_lshrrev_b32 v2, 22, v2
v_and_b32 v3, 3, v2
v_lshlrev_b32 v3, 1, v3
v_and_or_b32 v3, v2, 8, v3
v_xor_b32 v1, v1, v3
v_lshlrev_b32 v1, 4, v1
s_add_u32 m0, s61, 8192
s_add_u32 s3, s46, 40960
buffer_load_dwordx4 v1, s[12:15], s3 offen lds
s_lshl_b32 s3, s32, 6
s_addk_i32 s3, 1024
v_add_u32 v1, s3, v0
v_mul_u32_u24 v2, 52429, v1
v_lshrrev_b32 v2, 22, v2
v_and_b32 v3, 3, v2
v_lshlrev_b32 v3, 1, v3
v_and_or_b32 v3, v2, 8, v3
v_xor_b32 v1, v1, v3
v_lshlrev_b32 v1, 4, v1
s_add_u32 m0, s61, 16384
s_add_u32 s3, s46, 40960
buffer_load_dwordx4 v1, s[12:15], s3 offen lds
s_lshl_b32 s3, s32, 6
s_addk_i32 s3, 1536
v_add_u32 v1, s3, v0
v_mul_u32_u24 v2, 52429, v1
v_lshrrev_b32 v2, 22, v2
v_and_b32 v3, 3, v2
v_lshlrev_b32 v3, 1, v3
v_and_or_b32 v3, v2, 8, v3
v_xor_b32 v1, v1, v3
v_lshlrev_b32 v1, 4, v1
s_add_u32 m0, s61, 24576
s_add_u32 s3, s46, 40960
buffer_load_dwordx4 v1, s[12:15], s3 offen lds
s_lshl_b32 s3, s32, 6
s_addk_i32 s3, 2048
v_add_u32 v1, s3, v0
v_mul_u32_u24 v2, 52429, v1
v_lshrrev_b32 v2, 22, v2
v_and_b32 v3, 3, v2
v_lshlrev_b32 v3, 1, v3
v_and_or_b32 v3, v2, 8, v3
v_xor_b32 v1, v1, v3
v_lshlrev_b32 v1, 4, v1
s_add_u32 m0, s61, 32768
s_add_u32 s3, s46, 40960
buffer_load_dwordx4 v1, s[12:15], s3 offen lds
v_add_u32 v1, 42240, v250
ds_read_b64_tr_b16 v[80:81], v1 offset:0
ds_read_b64_tr_b16 v[82:83], v1 offset:256
ds_read_b64_tr_b16 v[84:85], v1 offset:1024
ds_read_b64_tr_b16 v[86:87], v1 offset:1280
s_waitcnt vmcnt(5) lgkmcnt(0)
s_barrier
s_lshl_b32 s3, s32, 6
s_addk_i32 s3, 0
v_add_u32 v1, s3, v0
v_mul_u32_u24 v2, 52429, v1
v_lshrrev_b32 v2, 22, v2
v_and_b32 v3, 3, v2
v_lshlrev_b32 v3, 1, v3
v_and_or_b32 v3, v2, 8, v3
v_xor_b32 v1, v1, v3
v_lshlrev_b32 v1, 4, v1
s_add_u32 m0, s61, 42240
s_add_u32 s3, s46, 81920
buffer_load_dwordx4 v1, s[12:15], s3 offen lds
s_lshl_b32 s3, s32, 6
s_addk_i32 s3, 512
v_add_u32 v1, s3, v0
v_mul_u32_u24 v2, 52429, v1
v_lshrrev_b32 v2, 22, v2
v_and_b32 v3, 3, v2
v_lshlrev_b32 v3, 1, v3
v_and_or_b32 v3, v2, 8, v3
v_xor_b32 v1, v1, v3
v_lshlrev_b32 v1, 4, v1
s_add_u32 m0, s61, 50432
s_add_u32 s3, s46, 81920
buffer_load_dwordx4 v1, s[12:15], s3 offen lds
s_lshl_b32 s3, s32, 6
s_addk_i32 s3, 1024
v_add_u32 v1, s3, v0
v_mul_u32_u24 v2, 52429, v1
v_lshrrev_b32 v2, 22, v2
v_and_b32 v3, 3, v2
v_lshlrev_b32 v3, 1, v3
v_and_or_b32 v3, v2, 8, v3
v_xor_b32 v1, v1, v3
v_lshlrev_b32 v1, 4, v1
s_add_u32 m0, s61, 58624
s_add_u32 s3, s46, 81920
buffer_load_dwordx4 v1, s[12:15], s3 offen lds
s_lshl_b32 s3, s32, 6
s_addk_i32 s3, 1536
v_add_u32 v1, s3, v0
v_mul_u32_u24 v2, 52429, v1
v_lshrrev_b32 v2, 22, v2
v_and_b32 v3, 3, v2
v_lshlrev_b32 v3, 1, v3
v_and_or_b32 v3, v2, 8, v3
v_xor_b32 v1, v1, v3
v_lshlrev_b32 v1, 4, v1
s_add_u32 m0, s61, 66816
s_add_u32 s3, s46, 81920
buffer_load_dwordx4 v1, s[12:15], s3 offen lds
s_lshl_b32 s3, s32, 6
s_addk_i32 s3, 2048
v_add_u32 v1, s3, v0
v_mul_u32_u24 v2, 52429, v1
v_lshrrev_b32 v2, 22, v2
v_and_b32 v3, 3, v2
v_lshlrev_b32 v3, 1, v3
v_and_or_b32 v3, v2, 8, v3
v_xor_b32 v1, v1, v3
v_lshlrev_b32 v1, 4, v1
s_add_u32 m0, s61, 75008
s_add_u32 s3, s46, 81920
buffer_load_dwordx4 v1, s[12:15], s3 offen lds
v_add_u32 v1, 84480, v236
ds_read_b64_tr_b16 v[168:169], v1 offset:0
ds_read_b64_tr_b16 v[170:171], v1 offset:5120
v_add_u32 v1, 84480, v237
ds_read_b64_tr_b16 v[180:181], v1 offset:0
ds_read_b64_tr_b16 v[182:183], v1 offset:5120
v_add_u32 v1, 84480, v238
ds_read_b64_tr_b16 v[192:193], v1 offset:0
ds_read_b64_tr_b16 v[194:195], v1 offset:5120
v_add_u32 v1, 84480, v239
ds_read_b64_tr_b16 v[204:205], v1 offset:0
ds_read_b64_tr_b16 v[206:207], v1 offset:5120
v_add_u32 v1, 84480, v240
ds_read_b64_tr_b16 v[216:217], v1 offset:0
ds_read_b64_tr_b16 v[218:219], v1 offset:5120
s_waitcnt vmcnt(5) lgkmcnt(0)
s_barrier
s_sub_u32 s45, 983040, s44
s_add_u32 m0, s62, 84480
s_nop 0
buffer_load_dwordx4 v249, s[28:31], s45 offen lds
s_sub_u32 s45, 1179648, s44
s_add_u32 m0, s62, 92928
s_nop 0
buffer_load_dwordx4 v249, s[28:31], s45 offen lds
s_sub_u32 s45, 1376256, s44
s_add_u32 m0, s62, 101376
s_nop 0
buffer_load_dwordx4 v249, s[28:31], s45 offen lds
s_sub_u32 s45, 1572864, s44
s_add_u32 m0, s62, 109824
s_nop 0
buffer_load_dwordx4 v249, s[28:31], s45 offen lds
s_sub_u32 s45, 1769472, s44
s_add_u32 m0, s62, 118272
s_nop 0
buffer_load_dwordx4 v249, s[28:31], s45 offen lds
v_add_u32 v1, 0, v236
ds_read_b64_tr_b16 v[172:173], v1 offset:0
ds_read_b64_tr_b16 v[174:175], v1 offset:5120
v_add_u32 v1, 0, v237
ds_read_b64_tr_b16 v[184:185], v1 offset:0
ds_read_b64_tr_b16 v[186:187], v1 offset:5120
v_add_u32 v1, 0, v238
ds_read_b64_tr_b16 v[196:197], v1 offset:0
ds_read_b64_tr_b16 v[198:199], v1 offset:5120
v_add_u32 v1, 0, v239
ds_read_b64_tr_b16 v[208:209], v1 offset:0
ds_read_b64_tr_b16 v[210:211], v1 offset:5120
v_add_u32 v1, 0, v240
ds_read_b64_tr_b16 v[220:221], v1 offset:0
ds_read_b64_tr_b16 v[222:223], v1 offset:5120
s_waitcnt vmcnt(5) lgkmcnt(0)
s_barrier
v_add_u32 v1, 42240, v236
ds_read_b64_tr_b16 v[176:177], v1 offset:0
ds_read_b64_tr_b16 v[178:179], v1 offset:5120
v_add_u32 v1, 42240, v237
ds_read_b64_tr_b16 v[188:189], v1 offset:0
ds_read_b64_tr_b16 v[190:191], v1 offset:5120
v_add_u32 v1, 42240, v238
ds_read_b64_tr_b16 v[200:201], v1 offset:0
ds_read_b64_tr_b16 v[202:203], v1 offset:5120
v_add_u32 v1, 42240, v239
ds_read_b64_tr_b16 v[212:213], v1 offset:0
ds_read_b64_tr_b16 v[214:215], v1 offset:5120
v_add_u32 v1, 42240, v240
ds_read_b64_tr_b16 v[224:225], v1 offset:0
ds_read_b64_tr_b16 v[226:227], v1 offset:5120
s_waitcnt vmcnt(0) lgkmcnt(0)
s_barrier
s_cmp_lt_u32 s32, 4
s_cbranch_scc0 L_g11
v_add_u32 v1, 84480, v251
ds_read_b64_tr_b16 v[128:129], v1 offset:0
ds_read_b64_tr_b16 v[130:131], v1 offset:128
ds_read_b64_tr_b16 v[132:133], v1 offset:512
ds_read_b64_tr_b16 v[134:135], v1 offset:640
v_add_u32 v1, 92928, v251
ds_read_b64_tr_b16 v[136:137], v1 offset:0
ds_read_b64_tr_b16 v[138:139], v1 offset:128
ds_read_b64_tr_b16 v[140:141], v1 offset:512
ds_read_b64_tr_b16 v[142:143], v1 offset:640
v_add_u32 v1, 101376, v251
ds_read_b64_tr_b16 v[144:145], v1 offset:0
ds_read_b64_tr_b16 v[146:147], v1 offset:128
ds_read_b64_tr_b16 v[148:149], v1 offset:512
ds_read_b64_tr_b16 v[150:151], v1 offset:640
v_add_u32 v1, 109824, v251
ds_read_b64_tr_b16 v[152:153], v1 offset:0
ds_read_b64_tr_b16 v[154:155], v1 offset:128
ds_read_b64_tr_b16 v[156:157], v1 offset:512
ds_read_b64_tr_b16 v[158:159], v1 offset:640
v_add_u32 v1, 118272, v251
ds_read_b64_tr_b16 v[160:161], v1 offset:0
ds_read_b64_tr_b16 v[162:163], v1 offset:128
ds_read_b64_tr_b16 v[164:165], v1 offset:512
ds_read_b64_tr_b16 v[166:167], v1 offset:640
L_g11:
s_branch L_pb_26
.p2align 12
L_pb_26:
s_call_b64 s[100:101], L_pad_27
s_call_b64 s[100:101], L_pad_28
s_call_b64 s[100:101], L_pad_29
v_mov_b32 v5, v246
v_mov_b32 v4, 126976
s_cmp_lt_u32 s32, 7
s_cbranch_scc1 L_np
L_rt:
v_cmp_ne_u32 vcc, 1, v247
s_cbranch_vccz L_rtg
buffer_load_dword v247, v248, s[24:27], 0 offen sc1
s_waitcnt vmcnt(0)
s_sub_u32 s40, s40, 1
s_cbranch_scc0 L_rt
s_mov_b32 s40, 0
L_rtg:
v_bfe_u32 v1, v0, 2, 3
v_lshlrev_b32 v1, 15, v1
v_and_b32 v2, 3, v0
v_min_u32 v2, 2, v2
v_mul_u32_u24 v3, 1280, v2
s_mov_b32 s0, 3145728
v_add3_u32 v3, v3, v1, s0
v_lshl_add_u32 v1, v2, 7, v1
s_mul_i32 s0, s36, 384
s_add_u32 s0, s0, 3167232
s_and_b32 s3, s36, 1
s_mul_i32 s3, s3, 640
v_add_u32 v132, s3, v6
v_subrev_u32 v2, 1280, v132
v_min_u32 v132, v132, v2
s_sub_u32 s3, 1024, s3
v_add_u32 v133, s3, v6
s_mov_b32 s54, 0
s_mov_b32 s55, 0x80000000
v_mov_b32 v140, -1
v_mov_b32 v141, -1
v_mov_b32 v142, -1
L_pk:
s_mov_b32 m0, 127232
s_mov_b64 exec, -1
s_nop 0
buffer_load_dwordx4 v132, s[16:19], s55 offen sc1 lds
s_mov_b32 m0, 128256
s_mov_b64 exec, 0xffff
buffer_load_dwordx4 v133, s[16:19], s55 offen sc1 lds
s_mov_b64 exec, 0x77777777
buffer_atomic_umin v140, v1, s[16:19], s0 offen sc0 sc1
s_sleep 2
buffer_atomic_umin v141, v1, s[16:19], s0 offen sc0 sc1
s_sleep 2
L_pl:
buffer_atomic_umin v142, v1, s[16:19], s0 offen sc0 sc1
s_waitcnt vmcnt(2)
v_cmp_lt_u32 vcc, s54, v140
s_cbranch_vccz L_pg
s_nop 0
v_cndmask_b32 v2, -1, v140, vcc
v_cmp_ne_u32 vcc, -1, v2
v_mov_b32 v238, v140
s_cbranch_vccnz L_pn
s_sleep 2
s_mov_b32 m0, 127232
s_mov_b64 exec, -1
buffer_load_dwordx4 v132, s[16:19], s55 offen sc1 lds
s_mov_b32 m0, 128256
s_mov_b64 exec, 0xffff
buffer_load_dwordx4 v133, s[16:19], s55 offen sc1 lds
s_mov_b64 exec, 0x77777777
buffer_atomic_umin v140, v1, s[16:19], s0 offen sc0 sc1
s_waitcnt vmcnt(4)
v_cmp_lt_u32 vcc, s54, v141
s_cbranch_vccz L_pg
s_nop 0
v_cndmask_b32 v2, -1, v141, vcc
v_cmp_ne_u32 vcc, -1, v2
v_mov_b32 v238, v141
s_cbranch_vccnz L_pn
s_sleep 2
buffer_atomic_umin v141, v1, s[16:19], s0 offen sc0 sc1
s_waitcnt vmcnt(4)
v_cmp_lt_u32 vcc, s54, v142
s_cbranch_vccz L_pg
s_nop 0
v_cndmask_b32 v2, -1, v142, vcc
v_cmp_ne_u32 vcc, -1, v2
v_mov_b32 v238, v142
s_cbranch_vccnz L_pn
s_sleep 2
s_sub_u32 s40, s40, 1
s_cbranch_scc0 L_pl
s_mov_b32 s40, 0
s_branch L_pg
L_pn:
v_cmp_eq_u32 s[58:59], -1, v238
s_mov_b64 exec, -1
v_cndmask_b32 v2, 0, v2, vcc
s_nop 1
v_max_u32_dpp v236, v2, v2 row_ror:8 row_mask:0xf bank_mask:0xf
s_nop 1
v_max_u32_dpp v236, v236, v236 row_ror:4 row_mask:0xf bank_mask:0xf
s_nop 1
v_max_u32_dpp v236, v236, v236 row_ror:2 row_mask:0xf bank_mask:0xf
s_nop 1
v_max_u32_dpp v236, v236, v236 row_ror:1 row_mask:0xf bank_mask:0xf
v_mov_b32 v237, v236
s_nop 1
v_permlane16_swap_b32 v236, v237
v_max_u32 v236, v236, v237
s_mov_b32 exec_hi, 0
v_cmpx_eq_u32 vcc, v236, v2
ds_write_b64 v4, v[2:3]
s_cmp_eq_u64 s[58:59], 0
s_nop 1
v_readfirstlane_b32 s55, v3
v_readfirstlane_b32 s54, v2
s_cbranch_scc0 L_pk
L_xf:
s_mov_b32 m0, 127232
s_mov_b64 exec, -1
s_nop 0
buffer_load_dwordx4 v132, s[16:19], s55 offen sc1 lds
s_mov_b32 m0, 128256
s_mov_b64 exec, 0xffff
buffer_load_dwordx4 v133, s[16:19], s55 offen sc1 lds
s_waitcnt vmcnt(0)
L_pg:
s_mov_b64 exec, -1
L_np:
s_waitcnt lgkmcnt(0)
s_barrier
s_cmp_lt_u32 s32, 4
s_cbranch_scc1 L_xh
s_and_b32 s3, s36, 1
s_add_u32 s3, s3, s32
s_cmp_eq_u32 s3, 8
s_cbranch_scc0 L_wb1
buffer_wbl2 sc1
L_wb1:
ds_read_b64 v[2:3], v4
ds_read_b128 v[88:91], v252 offset:0
ds_read_b128 v[92:95], v252 offset:128
ds_read_b128 v[96:99], v252 offset:256
ds_read_b128 v[100:103], v252 offset:384
ds_read_b128 v[104:107], v252 offset:512
ds_read_b128 v[108:111], v252 offset:640
ds_read_b128 v[112:115], v252 offset:768
ds_read_b128 v[116:119], v252 offset:896
ds_read_b128 v[120:123], v252 offset:1024
ds_read_b128 v[124:127], v252 offset:1152
s_waitcnt lgkmcnt(10)
v_readfirstlane_b32 s56, v2
v_readfirstlane_b32 s57, v3
s_waitcnt lgkmcnt(9)
v_smfmac_f32_16x16x64_bf16 v[228:231], v[88:91], v[8:15], v7
s_and_b32 s0, s57, 0x7fff
s_add_u32 s57, s57, s0
s_add_u32 s57, s57, 4096
s_and_b32 s1, s56, 0xfffff800
s_waitcnt lgkmcnt(8)
v_smfmac_f32_16x16x64_bf16 v[228:231], v[92:95], v[16:23], v7
s_ashr_i32 s3, s1, 31
s_not_b32 s3, s3
s_or_b32 s3, s3, 0x80000000
s_xor_b32 s1, s1, s3
s_waitcnt lgkmcnt(7)
v_smfmac_f32_16x16x64_bf16 v[228:231], v[96:99], v[24:31], v7
s_andn2_b32 s56, 2047, s56
s_mul_i32 s56, s56, 1280
v_mov_b32 v130, s1
s_waitcnt lgkmcnt(6)
v_smfmac_f32_16x16x64_bf16 v[228:231], v[100:103], v[32:39], v7
v_mul_f32 v130, 0xbfb8aa3b, v130
s_waitcnt lgkmcnt(5)
v_smfmac_f32_16x16x64_bf16 v[228:231], v[104:107], v[40:47], v7
v_exp_f32 v130, v130
s_waitcnt lgkmcnt(4)
v_smfmac_f32_16x16x64_bf16 v[228:231], v[108:111], v[48:55], v7
v_add_f32 v130, 1.0, v130
s_waitcnt lgkmcnt(3)
v_smfmac_f32_16x16x64_bf16 v[228:231], v[112:115], v[56:63], v7
v_rcp_f32 v130, v130
s_waitcnt lgkmcnt(2)
v_smfmac_f32_16x16x64_bf16 v[228:231], v[116:119], v[64:71], v7
s_waitcnt lgkmcnt(1)
v_smfmac_f32_16x16x64_bf16 v[228:231], v[120:123], v[72:79], v7
s_waitcnt lgkmcnt(0)
v_smfmac_f32_16x16x64_bf16 v[228:231], v[124:127], v[80:87], v7
s_branch L_xj
L_pad_27:
s_setpc_b64 s[100:101]
L_xh:
ds_read_b128 v[236:239], v252 offset:0
ds_read_b128 v[240:243], v252 offset:128
ds_read_b128 v[244:247], v252 offset:256
ds_read_b128 v[248:251], v252 offset:384
s_waitcnt lgkmcnt(3)
v_smfmac_f32_16x16x64_bf16 v[228:231], v[236:239], v[8:15], v7
v_smfmac_f32_16x16x64_bf16 v[232:235], v[236:239], v[88:95], v7
ds_read_b128 v[236:239], v252 offset:512
s_waitcnt lgkmcnt(3)
v_smfmac_f32_16x16x64_bf16 v[228:231], v[240:243], v[16:23], v7
v_smfmac_f32_16x16x64_bf16 v[232:235], v[240:243], v[96:103], v7
ds_read_b128 v[240:243], v252 offset:640
s_waitcnt lgkmcnt(3)
v_smfmac_f32_16x16x64_bf16 v[228:231], v[244:247], v[24:31], v7
v_smfmac_f32_16x16x64_bf16 v[232:235], v[244:247], v[104:111], v7
ds_read_b128 v[244:247], v252 offset:768
s_waitcnt lgkmcnt(3)
v_smfmac_f32_16x16x64_bf16 v[228:231], v[248:251], v[32:39], v7
v_smfmac_f32_16x16x64_bf16 v[232:235], v[248:251], v[112:119], v7
ds_read_b128 v[248:251], v252 offset:896
s_waitcnt lgkmcnt(3)
v_smfmac_f32_16x16x64_bf16 v[228:231], v[236:239], v[40:47], v7
v_smfmac_f32_16x16x64_bf16 v[232:235], v[236:239], v[120:127], v7
ds_read_b128 v[236:239], v252 offset:1024
s_waitcnt lgkmcnt(3)
v_smfmac_f32_16x16x64_bf16 v[228:231], v[240:243], v[48:55], v7
v_smfmac_f32_16x16x64_bf16 v[232:235], v[240:243], v[128:135], v7
ds_read_b128 v[240:243], v252 offset:1152
s_waitcnt lgkmcnt(3)
v_smfmac_f32_16x16x64_bf16 v[228:231], v[244:247], v[56:63], v7
v_smfmac_f32_16x16x64_bf16 v[232:235], v[244:247], v[136:143], v7
s_waitcnt lgkmcnt(2)
v_smfmac_f32_16x16x64_bf16 v[228:231], v[248:251], v[64:71], v7
v_smfmac_f32_16x16x64_bf16 v[232:235], v[248:251], v[144:151], v7
s_waitcnt lgkmcnt(1)
v_smfmac_f32_16x16x64_bf16 v[228:231], v[236:239], v[72:79], v7
v_smfmac_f32_16x16x64_bf16 v[232:235], v[236:239], v[152:159], v7
s_waitcnt lgkmcnt(0)
v_smfmac_f32_16x16x64_bf16 v[228:231], v[240:243], v[80:87], v7
v_smfmac_f32_16x16x64_bf16 v[232:235], v[240:243], v[160:167], v7
L_xj:
s_mov_b64 vcc, 0xffff
s_nop 5
v_add_f32 v1, v228, v229
v_add_f32 v2, v232, v233
v_cndmask_b32 v1, v2, v1, vcc
v_cmp_u_f32 vcc, v1, v1
s_cbranch_vccnz L_xn
L_xnb:
v_mul_f32 v2, 0xbfb8aa3b, v1
v_exp_f32 v2, v2
v_mul_f32_dpp v3, v1, v1 row_ror:8 row_mask:0xf bank_mask:0xf
v_add_f32 v2, 1.0, v2
v_rcp_f32 v2, v2
s_nop 0
v_mul_f32 v1, v2, v3
v_cvt_pk_bf16_f32 v1, v1, v1
s_mov_b64 exec, s[50:51]
ds_write_b16 v253, v1
s_mov_b64 exec, -1
v_mov_b32 v2, 126928
s_waitcnt lgkmcnt(0)
s_barrier
ds_read_b32 v1, v2
ds_read_b128 v[236:239], v255
ds_read_b128 v[240:243], v254
s_waitcnt lgkmcnt(2)
v_cmp_ne_u32 vcc, 0, v1
s_cbranch_vccnz L_xsr
L_xsgo:
s_waitcnt lgkmcnt(1)
v_mfma_f32_16x16x32_bf16 v[24:27], v[236:239], v[224:227], 0
v_mfma_f32_16x16x32_bf16 v[8:11], v[236:239], v[176:179], 0
v_mfma_f32_16x16x32_bf16 v[12:15], v[236:239], v[188:191], 0
v_mfma_f32_16x16x32_bf16 v[16:19], v[236:239], v[200:203], 0
v_mfma_f32_16x16x32_bf16 v[20:23], v[236:239], v[212:215], 0
s_waitcnt lgkmcnt(0)
s_nop 0
v_smfmac_f32_16x16x64_bf16 v[24:27], v[240:243], v[216:223], v7
v_smfmac_f32_16x16x64_bf16 v[8:11], v[240:243], v[168:175], v7
v_smfmac_f32_16x16x64_bf16 v[12:15], v[240:243], v[180:187], v7
v_smfmac_f32_16x16x64_bf16 v[16:19], v[240:243], v[192:199], v7
v_smfmac_f32_16x16x64_bf16 v[20:23], v[240:243], v[204:211], v7
s_nop 3
v_add_f32 v1, v24, v25
v_add_f32 v32, v8, v9
v_add_f32 v33, v12, v13
v_add_f32 v34, v16, v17
v_add_f32 v35, v20, v21
v_mov_b32_dpp v32, v1 quad_perm:[0,0,0,0] row_mask:0x2 bank_mask:0xf
v_mov_b32_dpp v33, v1 quad_perm:[1,1,1,1] row_mask:0x2 bank_mask:0xf
v_mov_b32_dpp v34, v1 quad_perm:[2,2,2,2] row_mask:0x2 bank_mask:0xf
v_mov_b32_dpp v35, v1 quad_perm:[3,3,3,3] row_mask:0x2 bank_mask:0xf
s_mov_b64 exec, 0x1111ffff
buffer_store_dwordx4 v[32:35], v5, s[16:19], s47 offen sc1
s_mov_b64 exec, -1
s_cmp_lt_u32 s52, 40
s_cbranch_scc0 L_mfin
buffer_load_dword v44, v129, s[16:19], s57 offen sc1
buffer_load_dwordx4 v[40:43], v6, s[16:19], s53 offen sc1
L_fd:
buffer_load_dword v52, v129, s[16:19], s57 offen sc1
buffer_load_dwordx4 v[48:51], v6, s[16:19], s53 offen sc1
s_waitcnt vmcnt(2)
v_max3_u32 v1, v40, v42, v44
v_cmp_eq_u32 vcc, -1, v1
s_cbranch_vccz L_fg0
buffer_load_dword v44, v129, s[16:19], s57 offen sc1
buffer_load_dwordx4 v[40:43], v6, s[16:19], s53 offen sc1
s_waitcnt vmcnt(2)
v_max3_u32 v1, v48, v50, v52
v_cmp_eq_u32 vcc, -1, v1
s_cbranch_vccz L_fg1
s_sub_u32 s40, s40, 1
s_cbranch_scc0 L_fd
L_fg1:
v_permlane32_swap_b32 v48, v49
v_permlane32_swap_b32 v50, v51
v_add_f32 v48, v48, v49
v_add_f32 v50, v50, v51
s_nop 1
v_permlane16_swap_b32 v48, v50
v_add_f32 v48, v48, v50
s_nop 1
v_add_f32_dpp v48, v48, v48 row_ror:4 row_mask:0xf bank_mask:0xf
s_nop 1
v_add_f32_dpp v48, v48, v48 row_ror:8 row_mask:0xf bank_mask:0xf
v_fma_f32 v8, v48, v130, v52
v_cvt_pk_bf16_f32 v8, v8, v8
s_mov_b32 exec_lo, 0xf000f
s_mov_b32 exec_hi, 0xf000f
buffer_store_short v8, v128, s[20:23], s56 offen
s_endpgm
L_pad_28:
s_setpc_b64 s[100:101]
L_fg0:
v_permlane32_swap_b32 v40, v41
v_permlane32_swap_b32 v42, v43
v_add_f32 v40, v40, v41
v_add_f32 v42, v42, v43
s_nop 1
v_permlane16_swap_b32 v40, v42
v_add_f32 v40, v40, v42
s_nop 1
v_add_f32_dpp v40, v40, v40 row_ror:4 row_mask:0xf bank_mask:0xf
s_nop 1
v_add_f32_dpp v40, v40, v40 row_ror:8 row_mask:0xf bank_mask:0xf
v_fma_f32 v8, v40, v130, v44
v_cvt_pk_bf16_f32 v8, v8, v8
s_mov_b32 exec_lo, 0xf000f
s_mov_b32 exec_hi, 0xf000f
buffer_store_short v8, v128, s[20:23], s56 offen
L_mfin:
s_endpgm
L_pad_29:
s_setpc_b64 s[100:101]
L_xn:
v_mov_b32 v2, 126928
ds_write_b32 v2, v2
s_branch L_xnb
L_xsr:
s_sub_u32 s49, s49, 1
s_cbranch_scc1 L_xsgo
v_mov_b32 v228, 0
v_mov_b32 v229, 0
v_mov_b32 v230, 0
v_mov_b32 v231, 0
v_mov_b32 v232, 0
v_mov_b32 v233, 0
v_mov_b32 v234, 0
v_mov_b32 v235, 0
s_waitcnt lgkmcnt(0)
s_barrier
s_cmp_eq_u32 s32, 7
s_cbranch_scc0 L_np
ds_write_b32 v2, v228
s_branch L_xf
L_end:
s_endpgm
.section .rodata,"a"
.p2align 6
.amdhsa_kernel sequential_preLN__sliding_local_dilated__moe_arch_mod__prompt_kernel
  .amdhsa_next_free_vgpr 256
  .amdhsa_next_free_sgpr 102
  .amdhsa_accum_offset 256
  .amdhsa_group_segment_fixed_size 0
  .amdhsa_kernarg_size 88
  .amdhsa_user_sgpr_count 2
  .amdhsa_user_sgpr_kernarg_segment_ptr 1
  .amdhsa_system_sgpr_workgroup_id_x 1
  .amdhsa_float_denorm_mode_32 3
.end_amdhsa_kernel
```

```asm
; @launch grid=(256,1,1) block=(512,1,1) lds=163840
.amdgcn_target "amdgcn-amd-amdhsa--gfx950"
.text
.p2align 12
.globl sequential_preLN__sliding_local_dilated__moe_arch_mod__prompt_kernel
.p2align 8
.type sequential_preLN__sliding_local_dilated__moe_arch_mod__prompt_kernel,@function
sequential_preLN__sliding_local_dilated__moe_arch_mod__prompt_kernel:
s_load_dwordx16 s[44:59], s[0:1], 0
s_load_dwordx8 s[60:67], s[0:1], 56
s_lshr_b32 s34, s2, 3
s_and_b32 s33, s2, 7
v_readfirstlane_b32 s32, v0
s_getpc_b64 s[100:101]
L_pc:
s_mul_i32 s3, s34, 8
v_min_u32 v2, 7, v0
v_add_lshl_u32 v2, v2, s3, 7
v_min_u32 v2, L_end-L_pc, v2
s_cmp_ge_u32 s34, 30
s_cbranch_scc1 L_moe
global_load_dword v255, v2, s[100:101]
s_mul_i32 s35, s34, 26
s_lshr_b32 s35, s35, 8
s_mul_i32 s3, s35, 10
s_sub_u32 s36, s34, s3
s_lshr_b32 s32, s32, 6
s_lshl_b32 s3, s33, 2
s_lshr_b32 s3, 0x54327689, s3
s_and_b32 s41, s3, 15
s_add_u32 s3, s36, s41
s_sub_u32 s68, s3, 10
s_cselect_b32 s69, s3, s68
s_mul_i32 s3, s69, 245760
s_lshl_b32 s68, s36, 7
s_add_u32 s3, s3, s68
v_lshrrev_b32 v1, 3, v0
v_lshrrev_b32 v3, 4, v0
v_and_b32 v2, 2, v1
v_and_or_b32 v2, v3, 4, v2
v_xor_b32 v2, v2, v0
v_and_b32 v2, 7, v2
v_mul_u32_u24 v4, 3840, v1
v_lshl_add_u32 v4, v2, 4, v4
v_add_u32 v4, s3, v4
s_mul_i32 s3, s32, 3072
s_add_u32 m0, s3, 20480
v_and_b32 v0, 63, v0
s_and_b32 s38, s32, 3
s_lshr_b32 s3, s33, 1
s_lshl_b32 s3, s3, 9
s_mul_i32 s68, s35, 176
s_add_u32 s3, s3, s68
s_and_b32 s68, s33, 1
s_add_u32 s3, s3, s68
s_mul_i32 s39, s3, 1280
s_sub_u32 s42, s32, 5
s_mul_i32 s3, s42, 81920
s_add_u32 s3, s3, s39
s_sub_u32 s3, s3, 20480
v_lshrrev_b32 v1, 3, v0
v_lshrrev_b32 v3, 4, v0
v_xor_b32 v3, v3, v0
v_and_b32 v3, 7, v3
v_mul_u32_u24 v1, 2560, v1
v_lshl_add_u32 v1, v3, 4, v1
v_add_u32 v24, s3, v1
s_add_u32 s3, s42, s35
s_cmp_eq_u32 s3, 4
s_cselect_b32 s3, 0x80000000, 0
v_xor_b32 v25, 64, v24
v_add_u32 v25, 20480, v25
v_add_u32 v26, 40960, v24
v_add_u32 v27, 40960, v25
v_or_b32 v27, s3, v27
s_mov_b32 s6, 0x280000
s_mov_b32 s7, 0x20000
s_mov_b32 s10, 0x258000
s_mov_b32 s11, 0x20000
s_mov_b32 s14, 0xc8000
s_mov_b32 s15, 0x20000
s_mov_b32 s18, 0x10000000
s_mov_b32 s19, 0x20000
s_mov_b32 s22, 0x280000
s_mov_b32 s23, 0x20000
s_mov_b32 s26, 0x100
s_mov_b32 s27, 0x20000
s_mov_b32 s30, 0x500
s_mov_b32 s31, 0x20000
s_waitcnt lgkmcnt(0)
global_load_lds_dwordx4 v4, s[46:47]
s_addk_i32 m0, -256
s_mov_b64 s[4:5], s[44:45]
global_load_lds_dwordx4 v4, s[46:47] offset:1280
s_addk_i32 m0, -256
s_mov_b64 s[20:21], s[62:63]
global_load_lds_dwordx4 v4, s[46:47] offset:2560
s_mov_b64 s[24:25], s[64:65]
s_mov_b64 s[16:17], s[66:67]
s_mov_b64 s[8:9], s[46:47]
s_mov_b64 s[12:13], s[48:49]
s_mov_b64 s[28:29], s[52:53]
s_cmp_eq_u32 s32, 4
s_cselect_b64 s[96:97], s[54:55], s[58:59]
s_cmp_eq_u32 s32, 5
s_cselect_b64 s[96:97], s[56:57], s[96:97]
s_cmp_lt_u32 s32, 5
s_cbranch_scc1 L_nx
s_lshl_b32 s64, s42, 12
s_cselect_b32 s62, -1, 0xffffff00
s_lshl_b32 s63, s69, 7
s_mov_b32 s61, 8192
s_add_u32 m0, s61, s64
s_mov_b32 exec_lo, s62
buffer_load_dwordx4 v24, s[4:7], s63 offen lds
s_addk_i32 m0, 1024
s_mov_b32 exec_lo, -1
buffer_load_dwordx4 v25, s[4:7], s63 offen lds
s_addk_i32 m0, 1024
s_nop 0
buffer_load_dwordx4 v26, s[4:7], s63 offen lds
s_addk_i32 m0, 1024
s_nop 0
buffer_load_dwordx4 v27, s[4:7], s63 offen lds
L_nx:
v_mov_b32 v254, v4
s_mov_b32 s40, 524288
s_mul_i32 s43, s33, 3
s_add_u32 s43, s43, s35
s_sub_u32 s3, s36, 5
s_cselect_b32 s37, s36, s3
s_lshl_b32 s3, s32, 2
s_lshr_b32 s44, 0x32105454, s3
s_and_b32 s44, s44, 7
s_lshr_b32 s45, s38, 1
s_add_u32 s45, s45, 4
s_cmp_eq_u32 s35, 2
s_cselect_b32 s60, 10, 11
s_sub_u32 s57, 10, s41
v_lshlrev_b32 v233, 4, v0
s_mul_i32 s58, s43, 6
s_add_u32 s58, s58, s44
s_mul_i32 s58, s58, 2560
s_add_u32 s58, s58, 2097152
s_lshl_b32 s59, s33, 15
s_add_u32 s59, s59, 3145728
s_sub_u32 s51, 5, s37
s_add_u32 s1, s37, 1
s_sub_u32 s3, 15, s37
s_cmp_le_u32 s37, 2
s_cselect_b32 s46, 0, s3
s_cselect_b32 s47, s51, s1
s_cselect_b32 s48, s3, 0
s_cselect_b32 s49, s1, s51
s_cselect_b32 s50, 1, 0
v_and_b32 v3, 15, v0
v_add_u32 v3, 8, v3
v_lshrrev_b32 v4, 1, v3
v_lshrrev_b32 v5, 5, v0
v_xor_b32 v4, v4, v5
v_and_b32 v4, 7, v4
v_lshlrev_b32 v4, 4, v4
v_lshl_add_u32 v4, v3, 7, v4
v_bfe_u32 v5, v0, 4, 1
v_lshl_add_u32 v4, v5, 3, v4
s_lshl_b32 s3, s44, 11
v_add_u32 v235, s3, v4
s_cmp_lt_u32 s32, 4
s_cbranch_scc1 L_cons
s_add_u32 s69, s69, 1
s_cmp_eq_u32 s69, 10
s_cselect_b32 s69, 0, s69
s_lshl_b32 s63, s69, 7
s_mov_b32 s61, 45056
v_and_b32 v1, 15, v0
v_lshrrev_b32 v2, 4, v0
v_mov_b32 v7, 1792
s_mul_i32 s0, s44, 2304
s_movk_i32 s1, 144
v_bfe_u32 v3, v0, 2, 1
v_and_b32 v4, 3, v0
v_lshlrev_b32 v4, 1, v4
v_lshl_add_u32 v3, v3, 3, v4
v_bfe_u32 v4, v0, 3, 1
v_add_u32 v3, v3, v4
s_add_u32 s3, s0, 17408
v_mov_b32 v4, s3
v_mad_u32_u24 v3, v3, s1, v4
s_add_u32 s3, s0, 4736
v_mov_b32 v4, s3
v_mad_u32_u24 v4, v1, s1, v4
s_mov_b32 s52, 0xff00ff
s_mov_b32 s53, 0xff00ff
v_add_u32 v5, s51, v2
v_lshl_add_u32 v200, v5, 3, v3
v_lshl_add_u32 v5, v5, 3, v4
v_cndmask_b32 v204, v7, v5, s[52:53]
v_cndmask_b32 v205, v5, v7, s[52:53]
v_add_u32 v5, s46, v2
v_lshl_add_u32 v202, v5, 3, v3
v_lshl_add_u32 v5, v5, 3, v4
v_cmp_gt_u32 vcc, s47, v2
s_nop 1
v_cndmask_b32 v5, v7, v5, vcc
v_cndmask_b32 v206, v7, v5, s[52:53]
v_cndmask_b32 v207, v5, v7, s[52:53]
v_add_u32 v5, s48, v2
v_min_u32 v5, 15, v5
v_lshl_add_u32 v203, v5, 3, v3
v_lshl_add_u32 v5, v5, 3, v4
v_cmp_gt_u32 vcc, s49, v2
s_nop 1
v_cndmask_b32 v5, v7, v5, vcc
v_cndmask_b32 v208, v7, v5, s[52:53]
v_cndmask_b32 v209, v5, v7, s[52:53]
s_sub_u32 s3, s51, 1
v_mad_u32_u24 v5, v2, 5, s3
s_add_u32 s3, s46, 4
v_mov_b32 v6, s3
s_mov_b64 vcc, 0xffff
v_cndmask_b32 v5, v5, v6, vcc
v_min_u32 v5, 15, v5
v_lshl_add_u32 v201, v5, 3, v3
v_lshl_add_u32 v5, v5, 3, v4
s_cmp_eq_u32 s47, 5
s_cselect_b64 vcc, 0xff, 0
v_cndmask_b32 v210, v7, v5, vcc
s_lshl_b64 vcc, vcc, 8
v_cndmask_b32 v211, v7, v5, vcc
s_bfm_b64 vcc, 8, 16
v_cndmask_b32 v212, v7, v5, vcc
s_bfm_b64 vcc, 8, 24
v_cndmask_b32 v213, v7, v5, vcc
s_bfm_b64 vcc, 8, 32
v_cndmask_b32 v214, v7, v5, vcc
s_bfm_b64 vcc, 8, 40
v_cndmask_b32 v215, v7, v5, vcc
s_mul_i32 s0, s44, 2304
s_movk_i32 s1, 144
v_bfe_u32 v3, v0, 2, 3
v_lshrrev_b32 v4, 5, v0
v_lshl_add_u32 v3, v3, 1, v4
s_add_u32 s3, s0, 31232
v_mov_b32 v4, s3
v_mad_u32_u24 v3, v3, s1, v4
v_and_b32 v4, 3, v0
s_mov_b32 s54, 0x11111111
s_mov_b32 s55, 0x11111111
v_add_u32 v5, s51, v4
v_lshl_add_u32 v216, v5, 3, v3
v_add_u32 v7, 32, v216
s_cmp_eq_u32 s50, 1
s_cselect_b32 s3, -1, 12
s_cselect_b32 s56, 2, -1
v_add_u32 v5, s3, v4
v_lshl_add_u32 v5, v5, 3, v3
v_cndmask_b32 v217, v5, v7, s[54:55]
v_add_u32 v7, 40, v7
v_add_u32 v5, s56, v4
v_add_u32 v6, 10, v5
v_cmp_gt_i32 vcc, s51, v5
s_nop 1
v_cndmask_b32 v5, v6, v5, vcc
v_lshl_add_u32 v5, v5, 3, v3
v_cndmask_b32 v218, v5, v7, s[54:55]
s_lshl_b32 s0, s44, 8
v_lshrrev_b32 v4, 5, v0
v_and_or_b32 v3, v0, 8, v4
s_add_u32 s3, s0, 8
v_lshl_add_u32 v222, v3, 4, s3
v_and_b32 v1, 15, v0
s_add_u32 s3, s0, 132
v_lshl_add_u32 v223, v1, 4, s3
s_lshr_b32 s3, s39, 8
s_mul_i32 s3, s3, 52429
s_lshr_b32 s3, s3, 18
s_lshl_b32 s0, s44, 5
s_add_u32 s3, s3, s0
s_sub_u32 s3, 2047, s3
v_mad_i32_i24 v234, v1, -2, s3
v_lshrrev_b32 v2, 4, v0
v_and_or_b32 v3, v0, 8, v2
v_and_b32 v4, 0x70, v233
v_bfrev_b32 v6, 1
s_lshl_b32 s3, s45, 4
v_add_u32 v5, s3, v3
s_lshl_b32 s3, s60, 3
v_cmp_gt_u32 vcc, s3, v5
v_mul_u32_u24 v5, 2560, v5
v_add3_u32 v5, v5, v4, s39
v_cndmask_b32 v236, v6, v5, vcc
s_lshl_b32 s3, s44, 4
v_add_u32 v5, s3, v3
s_lshl_b32 s3, s60, 3
v_cmp_gt_u32 vcc, s3, v5
v_mul_u32_u24 v5, 2560, v5
v_add3_u32 v5, v5, v4, s39
v_cndmask_b32 v227, v6, v5, vcc
s_lshl_b32 s3, s36, 7
v_add_u32 v226, s3, v227
v_bfe_u32 v3, v0, 4, 1
v_cmp_eq_u32 s[54:55], s50, v3
s_cmp_lg_u32 s37, 0
s_cselect_b64 s[0:1], -1, s[54:55]
s_and_b64 vcc, vcc, s[0:1]
s_cmp_lg_u32 s37, 4
s_cselect_b64 s[0:1], 0, s[54:55]
s_andn2_b64 vcc, vcc, s[0:1]
v_cndmask_b32 v225, v6, v226, vcc
s_cmp_le_u32 s37, 3
s_cselect_b32 s3, 2560, 0
s_sub_u32 s3, s3, 128
v_mov_b32 v4, s3
s_cmp_ge_u32 s37, 2
s_cselect_b32 s3, 2560, 0
s_add_u32 s3, s3, 128
v_mov_b32 v5, s3
v_cndmask_b32 v4, v4, v5, s[54:55]
v_mul_u32_u24 v3, 2560, v3
v_sub_u32 v4, v4, v3
v_add_u32 v4, v4, v226
v_cndmask_b32 v224, v6, v4, vcc
v_and_b32 v1, 15, v0
v_bfrev_b32 v6, 1
v_bfe_u32 v3, v0, 4, 1
v_lshrrev_b32 v4, 5, v0
v_lshl_add_u32 v3, v3, 1, v4
s_lshl_b32 s3, s36, 7
v_lshl_add_u32 v4, v3, 4, s3
s_lshl_b32 s3, s44, 4
v_add_u32 v5, s3, v1
s_lshl_b32 s3, s60, 3
v_cmp_gt_u32 vcc, s3, v5
v_mul_u32_u24 v5, 2560, v5
v_add3_u32 v5, v5, v4, s39
v_cndmask_b32 v232, v6, v5, vcc
v_bfe_u32 v3, v0, 3, 2
v_lshlrev_b32 v3, 2, v3
v_and_or_b32 v3, v0, 3, v3
v_lshlrev_b32 v3, 3, v3
v_bfe_u32 v4, v0, 2, 2
v_lshl_add_u32 v3, v4, 7, v3
v_lshrrev_b32 v2, 4, v0
s_and_b32 s3, s32, 1
s_lshl_b32 s3, s3, 12
s_add_u32 s3, s3, 81920
v_lshl_add_u32 v4, v2, 10, v3
v_add_u32 v228, s3, v4
v_xor_b32 v229, 32, v228
v_xor_b32 v230, 64, v228
v_xor_b32 v231, 96, v228
s_mov_b32 s44, 0x0
s_mov_b32 s45, 0x1010101
s_mov_b32 s46, 0x3030303
s_mov_b32 s47, 0x7070707
s_mov_b32 s48, 0xf0f0f0f
s_mov_b32 s49, 0x1f1f1f1f
s_mov_b32 s50, 0x3f3f3f3f
s_mov_b32 s51, 0x7f7f7f7f
s_movk_i32 s54, 10240
s_mov_b32 s55, 0x07060501
s_mov_b32 s56, 0x0706000c
v_mov_b32 v5, 0xffff
v_mov_b32 v6, 0xffff0000
v_cndmask_b32 v1, 0, v5, s[44:45]
v_cndmask_b32 v4, 0, v6, s[46:47]
v_or_b32 v220, v1, v4
v_cndmask_b32 v1, 0, v5, s[48:49]
v_cndmask_b32 v4, 0, v6, s[50:51]
v_or_b32 v221, v1, v4
v_lshrrev_b32 v1, 3, v0
v_and_b32 v2, 2, v1
v_xor_b32 v2, v2, v0
s_lshl_b32 s3, s32, 2
v_xor_b32 v2, s3, v2
v_and_b32 v2, 7, v2
s_lshl_b32 s3, s36, 7
v_lshl_add_u32 v2, v2, 4, s3
v_and_b32 v3, 3, v1
v_mul_u32_u24 v3, 1280, v3
v_add_u32 v2, v3, v2
v_lshrrev_b32 v3, 5, v0
v_mul_u32_u24 v3, 5120, v3
v_sub_u32 v4, 5120, v3
v_mad_u32_u24 v56, v3, 5, v2
v_mad_u32_u24 v57, v3, 3, v2
v_mad_u32_u24 v58, v3, 13, v2
v_mad_u32_u24 v59, v4, 3, v2
v_mad_u32_u24 v60, v4, 13, v2
s_mul_i32 s3, s38, 3
v_lshrrev_b32 v1, 2, v0
v_add_u32 v1, s3, v1
s_add_u32 s3, s3, 3
s_min_u32 s3, s3, s60
v_cmp_gt_u32 vcc, s3, v1
v_and_b32 v2, 3, v0
v_lshl_add_u32 v1, v1, 3, v2
v_mul_u32_u24 v1, 2560, v1
s_lshl_b32 s0, s36, 7
s_add_u32 s3, s0, s39
v_add_u32 v1, s3, v1
v_bfrev_b32 v2, 1
v_cndmask_b32 v61, v2, v1, vcc
s_mul_i32 s3, s38, 3
v_min_u32 v1, 2, v0
v_add_u32 v1, s3, v1
v_lshrrev_b32 v2, 1, v1
v_mul_u32_u24 v2, 2304, v2
v_lshl_add_u32 v1, v1, 7, v2
s_mul_i32 s3, s43, 15360
s_lshl_b32 s0, s36, 8
s_add_u32 s3, s3, s0
s_add_u32 s3, s3, 2097152
v_add_u32 v63, s3, v1
s_mul_i32 s3, s34, 9
v_min_u32 v1, 8, v0
v_add_u32 v1, s3, v1
v_min_u32 v1, 255, v1
v_cmp_le_u32 vcc, 128, v1
v_mul_u32_u24 v1, 3072, v1
s_mul_i32 s3, s33, 384
s_add_u32 s3, s3, 1572864
v_add_u32 v1, s3, v1
v_subrev_u32 v2, 1376000, v1
v_cndmask_b32 v1, v1, v2, vcc
s_mul_i32 s3, s33, 60
s_lshl_b32 s0, s34, 1
s_add_u32 s3, s3, s0
s_and_b32 s0, s32, 1
s_add_u32 s3, s3, s0
s_lshl_b32 s3, s3, 12
v_min_u32 v2, 31, v0
v_lshl_add_u32 v2, v2, 7, s3
s_cmp_ge_u32 s32, 6
s_cselect_b64 vcc, -1, 0
v_cndmask_b32 v84, v1, v2, vcc
v_mov_b32 v176, 0
v_mov_b32 v177, 0
v_mov_b32 v178, 0
v_mov_b32 v179, 0
v_mov_b32 v180, 0
v_mov_b32 v181, 0
v_mov_b32 v182, 0
v_mov_b32 v183, 0
v_mov_b32 v184, 0
v_mov_b32 v185, 0
v_mov_b32 v186, 0
v_mov_b32 v187, 0
v_mov_b32 v188, 0
v_mov_b32 v189, 0
v_mov_b32 v190, 0
v_mov_b32 v191, 0
s_cmp_eq_u32 s32, 4
s_cbranch_scc1 L_h0
v_mov_b32 v4, 0x3f803f80
v_mov_b32 v5, v4
v_lshrrev_b32 v1, 4, v0
v_mul_u32_u24 v1, 36736, v1
v_lshl_add_u32 v1, v0, 3, v1
ds_write_b64 v1, v[4:5] offset:8192
s_sub_u32 s0, s32, 5
s_mul_i32 s3, s43, 3
s_add_u32 s3, s3, s0
s_mul_i32 s3, s3, 2560
s_add_u32 s67, s3, 2621440
s_mul_i32 s3, s35, 1280
s_add_u32 s3, s3, s59
s_add_u32 s66, s3, 12288
v_min_u32 v1, 9, v0
v_lshl_add_u32 v55, v1, 7, s66
s_lshl_b32 s68, s36, 7
s_add_u32 s68, s68, s66
v_and_b32 v1, 15, v0
v_lshrrev_b32 v2, 5, v0
v_lshl_add_u32 v2, v2, 4, v1
s_lshl_b32 s0, s0, 5
v_add_lshl_u32 v52, v2, s0, 4
v_lshrrev_b32 v2, 4, v0
v_lshrrev_b32 v3, 1, v1
v_xor_b32 v3, v3, v2
v_lshlrev_b32 v3, 4, v3
v_lshl_add_u32 v3, v1, 7, v3
v_add_u32 v54, s64, v3
s_cmp_lt_u32 s39, 2560
s_cselect_b32 s3, 128, 0
v_mov_b32 v1, 0xf149f2ca
v_cmp_gt_u32 vcc, s3, v52
s_nop 1
v_cndmask_b32 v53, 0, v1, vcc
s_setprio 1
s_add_u32 m0, s61, s64
s_mov_b32 exec_lo, s62
buffer_load_dwordx4 v24, s[4:7], s63 offen lds
s_addk_i32 m0, 1024
s_mov_b32 exec_lo, -1
buffer_load_dwordx4 v25, s[4:7], s63 offen lds
s_addk_i32 m0, 1024
s_nop 0
buffer_load_dwordx4 v26, s[4:7], s63 offen lds
s_addk_i32 m0, 1024
s_nop 0
buffer_load_dwordx4 v27, s[4:7], s63 offen lds
v_lshrrev_b32 v1, 4, v0
v_lshlrev_b32 v1, 3, v1
s_lshl_b32 s3, s36, 7
buffer_load_dwordx2 v[244:245], v1, s[28:31], s3 offen offset:0
buffer_load_dwordx2 v[246:247], v1, s[28:31], s3 offen offset:32
buffer_load_dwordx2 v[248:249], v1, s[28:31], s3 offen offset:64
buffer_load_dwordx2 v[250:251], v1, s[28:31], s3 offen offset:96
v_mov_b32 v64, 0x3f803f80
v_mov_b32 v65, 0x3f803f80
v_mov_b32 v66, 0x3f803f80
v_mov_b32 v67, 0x3f803f80
s_waitcnt vmcnt(8) lgkmcnt(0)
s_barrier
v_xor_b32 v1, 64, v54
ds_read_b128 v[36:39], v54 offset:8192
ds_read_b128 v[40:43], v1 offset:8192
ds_read_b128 v[44:47], v54 offset:10240
ds_read_b128 v[48:51], v1 offset:10240
s_lshl_b32 s3, s36, 8
s_add_u32 s3, s3, s67
v_and_b32 v2, 0xf0, v233
s_mov_b32 s0, 0xaaaaaaaa
s_mov_b32 s1, s0
s_mov_b32 vcc_lo, 0xcccccccc
s_mov_b32 vcc_hi, 0xcccccccc
s_waitcnt lgkmcnt(3)
v_mfma_f32_16x16x32_bf16 v[96:99], v[36:39], v[36:39], 0
v_mfma_f32_16x16x32_bf16 v[100:103], v[64:67], v[36:39], 0
s_waitcnt lgkmcnt(2)
v_mfma_f32_16x16x32_bf16 v[96:99], v[40:43], v[40:43], v[96:99]
v_mfma_f32_16x16x32_bf16 v[100:103], v[64:67], v[40:43], v[100:103]
s_waitcnt lgkmcnt(1)
v_mfma_f32_16x16x32_bf16 v[104:107], v[44:47], v[44:47], 0
v_mfma_f32_16x16x32_bf16 v[108:111], v[64:67], v[44:47], 0
s_waitcnt lgkmcnt(0)
v_mfma_f32_16x16x32_bf16 v[104:107], v[48:51], v[48:51], v[104:107]
v_mfma_f32_16x16x32_bf16 v[108:111], v[64:67], v[48:51], v[108:111]
s_nop 0
v_cndmask_b32 v96, v96, v97, s[0:1]
v_cndmask_b32 v98, v98, v99, s[0:1]
v_cndmask_b32 v29, v96, v98, vcc
v_mov_b32 v28, v100
s_nop 1
v_cndmask_b32 v104, v104, v105, s[0:1]
v_cndmask_b32 v106, v106, v107, s[0:1]
v_cndmask_b32 v31, v104, v106, vcc
v_mov_b32 v30, v108
s_mov_b32 exec_lo, 0xf0000f
s_mov_b32 exec_hi, 0xf0000f00
buffer_store_dwordx4 v[28:31], v2, s[16:19], s3 offen sc1
s_mov_b64 exec, -1
v_mov_b32 v44, 0
v_mov_b32 v45, 0
v_mov_b32 v46, 0
v_mov_b32 v47, 0
s_add_u32 s69, s69, 1
s_cmp_eq_u32 s69, 10
s_cselect_b32 s69, 0, s69
s_lshl_b32 s63, s69, 7
s_mov_b32 s61, 81920
s_add_u32 m0, s61, s64
s_mov_b32 exec_lo, s62
buffer_load_dwordx4 v24, s[4:7], s63 offen lds
s_addk_i32 m0, 1024
s_mov_b32 exec_lo, -1
buffer_load_dwordx4 v25, s[4:7], s63 offen lds
s_addk_i32 m0, 1024
s_nop 0
buffer_load_dwordx4 v26, s[4:7], s63 offen lds
s_addk_i32 m0, 1024
s_nop 0
buffer_load_dwordx4 v27, s[4:7], s63 offen lds
s_branch L_pb_1
.p2align 12
L_pad_2:
s_setpc_b64 s[100:101]
L_pb_1:
s_waitcnt vmcnt(5) lgkmcnt(0)
s_cmp_eq_u32 s32, 5
s_cbranch_scc0 L_o5a
s_lshl_b32 s0, s33, 5
v_and_b32 v1, 16, v0
buffer_load_dword v32, v1, s[24:27], s0 offen sc1
L_o5a:
s_barrier
s_mul_i32 s3, s2, 3
s_add_u32 s3, s3, s32
s_sub_u32 s3, s3, 5
s_mul_i32 s3, s3, 1152
v_lshlrev_b32 v1, 7, v0
s_mov_b64 exec, 0x1ff
buffer_load_dword v255, v1, s[12:15], s3 offen
s_mov_b64 exec, -1
s_add_u32 s69, s69, 1
s_cmp_eq_u32 s69, 10
s_cselect_b32 s69, 0, s69
s_lshl_b32 s63, s69, 7
s_mov_b32 s61, 118784
s_add_u32 m0, s61, s64
s_mov_b32 exec_lo, s62
buffer_load_dwordx4 v24, s[4:7], s63 offen lds
s_addk_i32 m0, 1024
s_mov_b32 exec_lo, -1
buffer_load_dwordx4 v25, s[4:7], s63 offen lds
s_addk_i32 m0, 1024
s_nop 0
buffer_load_dwordx4 v26, s[4:7], s63 offen lds
s_addk_i32 m0, 1024
s_nop 0
buffer_load_dwordx4 v27, s[4:7], s63 offen lds
s_cmp_eq_u32 s57, 1
s_cbranch_scc0 L_xc1
s_mov_b32 s0, 45056
s_call_b64 s[100:101], L_xcap
L_xc1:
s_cmp_eq_u32 s32, 7
s_cbranch_scc0 L_wm1
s_call_b64 s[100:101], L_pad_8
s_call_b64 s[100:101], L_pad_24
L_wm1:
s_waitcnt vmcnt(5) lgkmcnt(0)
s_barrier
s_cmp_eq_u32 s32, 5
s_cbranch_scc0 L_o5c
s_waitcnt lgkmcnt(0)
v_cmp_ne_u32 vcc, 1, v32
s_cmp_eq_u64 vcc, 0
s_cbranch_scc0 L_era
L_ega:
s_getreg_b32 s0, hwreg(HW_REG_XCC_ID, 0, 4)
v_mov_b32 v1, s0
s_mov_b64 exec, 1
buffer_store_dword v1, off, s[16:19], s68 sc1
s_mov_b64 exec, -1
L_o5c:
s_add_u32 s69, s69, 1
s_cmp_eq_u32 s69, 10
s_cselect_b32 s69, 0, s69
s_lshl_b32 s63, s69, 7
s_mov_b32 s61, 8192
s_add_u32 m0, s61, s64
s_mov_b32 exec_lo, s62
buffer_load_dwordx4 v24, s[4:7], s63 offen lds
s_addk_i32 m0, 1024
s_mov_b32 exec_lo, -1
buffer_load_dwordx4 v25, s[4:7], s63 offen lds
s_addk_i32 m0, 1024
s_nop 0
buffer_load_dwordx4 v26, s[4:7], s63 offen lds
s_addk_i32 m0, 1024
s_nop 0
buffer_load_dwordx4 v27, s[4:7], s63 offen lds
s_cmp_eq_u32 s57, 2
s_cbranch_scc0 L_xc2
s_mov_b32 s0, 81920
s_call_b64 s[100:101], L_xcap
L_xc2:
s_cmp_eq_u32 s32, 7
s_cbranch_scc0 L_wm2
s_call_b64 s[100:101], L_pad_11
s_call_b64 s[100:101], L_pad_25
L_wm2:
s_cmp_eq_u32 s32, 5
s_cbranch_scc1 L_w52
s_waitcnt vmcnt(4)
L_w52:
s_waitcnt vmcnt(5) lgkmcnt(0)
s_barrier
s_add_u32 s69, s69, 1
s_cmp_eq_u32 s69, 10
s_cselect_b32 s69, 0, s69
s_lshl_b32 s63, s69, 7
s_mov_b32 s61, 45056
s_add_u32 m0, s61, s64
s_mov_b32 exec_lo, s62
buffer_load_dwordx4 v24, s[4:7], s63 offen lds
s_addk_i32 m0, 1024
s_mov_b32 exec_lo, -1
buffer_load_dwordx4 v25, s[4:7], s63 offen lds
s_addk_i32 m0, 1024
s_nop 0
buffer_load_dwordx4 v26, s[4:7], s63 offen lds
s_addk_i32 m0, 1024
s_nop 0
buffer_load_dwordx4 v27, s[4:7], s63 offen lds
s_cmp_eq_u32 s57, 3
s_cbranch_scc0 L_xc3
s_mov_b32 s0, 118784
s_call_b64 s[100:101], L_xcap
L_xc3:
s_cmp_eq_u32 s32, 7
s_cbranch_scc0 L_wm3
s_call_b64 s[100:101], L_pad_12
L_wm3:
s_waitcnt vmcnt(4) lgkmcnt(0)
s_barrier
s_add_u32 s69, s69, 1
s_cmp_eq_u32 s69, 10
s_cselect_b32 s69, 0, s69
s_lshl_b32 s63, s69, 7
s_mov_b32 s61, 81920
s_add_u32 m0, s61, s64
s_mov_b32 exec_lo, s62
buffer_load_dwordx4 v24, s[4:7], s63 offen lds
s_addk_i32 m0, 1024
s_mov_b32 exec_lo, -1
buffer_load_dwordx4 v25, s[4:7], s63 offen lds
s_addk_i32 m0, 1024
s_nop 0
buffer_load_dwordx4 v26, s[4:7], s63 offen lds
s_addk_i32 m0, 1024
s_nop 0
buffer_load_dwordx4 v27, s[4:7], s63 offen lds
s_cmp_eq_u32 s57, 4
s_cbranch_scc0 L_xc4
s_mov_b32 s0, 8192
s_call_b64 s[100:101], L_xcap
L_xc4:
s_cmp_eq_u32 s32, 7
s_cbranch_scc0 L_wm4
s_call_b64 s[100:101], L_pad_13
L_wm4:
s_waitcnt vmcnt(4) lgkmcnt(0)
s_cmp_eq_u32 s32, 5
s_cbranch_scc0 L_o5b
s_buffer_load_dword s71, s[16:19], s66 offset:0 glc
s_buffer_load_dword s73, s[16:19], s66 offset:128 glc
s_buffer_load_dword s75, s[16:19], s66 offset:256 glc
s_buffer_load_dword s77, s[16:19], s66 offset:384 glc
s_buffer_load_dword s83, s[16:19], s66 offset:512 glc
s_buffer_load_dword s85, s[16:19], s66 offset:640 glc
s_buffer_load_dword s89, s[16:19], s66 offset:768 glc
s_buffer_load_dword s91, s[16:19], s66 offset:896 glc
s_buffer_load_dword s93, s[16:19], s66 offset:1024 glc
s_buffer_load_dword s95, s[16:19], s66 offset:1152 glc
L_o5b:
s_barrier
s_add_u32 s69, s69, 1
s_cmp_eq_u32 s69, 10
s_cselect_b32 s69, 0, s69
s_lshl_b32 s63, s69, 7
s_mov_b32 s61, 118784
s_add_u32 m0, s61, s64
s_mov_b32 exec_lo, s62
buffer_load_dwordx4 v24, s[4:7], s63 offen lds
s_addk_i32 m0, 1024
s_mov_b32 exec_lo, -1
buffer_load_dwordx4 v25, s[4:7], s63 offen lds
s_addk_i32 m0, 1024
s_nop 0
buffer_load_dwordx4 v26, s[4:7], s63 offen lds
s_addk_i32 m0, 1024
s_nop 0
buffer_load_dwordx4 v27, s[4:7], s63 offen lds
s_cmp_eq_u32 s57, 5
s_cbranch_scc0 L_xc5
s_mov_b32 s0, 45056
s_call_b64 s[100:101], L_xcap
L_xc5:
s_cmp_eq_u32 s32, 5
s_cbranch_scc0 L_o5d
s_waitcnt lgkmcnt(0)
s_max_u32 s0, s71, s73
s_max_u32 s0, s0, s75
s_max_u32 s0, s0, s77
s_max_u32 s0, s0, s83
s_max_u32 s0, s0, s85
s_max_u32 s0, s0, s89
s_max_u32 s0, s0, s91
s_max_u32 s0, s0, s93
s_max_u32 s0, s0, s95
s_cmp_lg_u32 s0, -1
s_cbranch_scc0 L_erb
L_egb:
s_min_u32 s1, s71, s73
s_min_u32 s1, s1, s75
s_min_u32 s1, s1, s77
s_min_u32 s1, s1, s83
s_min_u32 s1, s1, s85
s_min_u32 s1, s1, s89
s_min_u32 s1, s1, s91
s_min_u32 s1, s1, s93
s_min_u32 s1, s1, s95
s_cmp_eq_u32 s0, s1
s_cselect_b32 s0, 1, 0
v_mov_b32 v1, 1728
v_mov_b32 v2, s0
ds_write_b32 v1, v2
L_o5d:
s_cmp_eq_u32 s32, 7
s_cbranch_scc0 L_wm5
s_call_b64 s[100:101], L_pad_14
L_wm5:
s_waitcnt vmcnt(4) lgkmcnt(0)
s_barrier
buffer_load_dwordx4 v[36:39], v233, s[16:19], s67 offen offset:0 sc1
buffer_load_dwordx4 v[40:43], v233, s[16:19], s67 offen offset:1024 sc1
s_mov_b32 exec_hi, 0
buffer_load_dwordx4 v[44:47], v233, s[16:19], s67 offen offset:2048 sc1
s_mov_b32 exec_hi, -1
s_add_u32 s69, s69, 1
s_cmp_eq_u32 s69, 10
s_cselect_b32 s69, 0, s69
s_lshl_b32 s63, s69, 7
s_mov_b32 s61, 8192
s_add_u32 m0, s61, s64
s_mov_b32 exec_lo, s62
buffer_load_dwordx4 v24, s[4:7], s63 offen lds
s_addk_i32 m0, 1024
s_mov_b32 exec_lo, -1
buffer_load_dwordx4 v25, s[4:7], s63 offen lds
s_addk_i32 m0, 1024
s_nop 0
buffer_load_dwordx4 v26, s[4:7], s63 offen lds
s_addk_i32 m0, 1024
s_nop 0
buffer_load_dwordx4 v27, s[4:7], s63 offen lds
s_cmp_eq_u32 s57, 6
s_cbranch_scc0 L_xc6
s_mov_b32 s0, 81920
s_call_b64 s[100:101], L_xcap
L_xc6:
s_cmp_eq_u32 s32, 7
s_cbranch_scc0 L_wm6
s_call_b64 s[100:101], L_pad_21
L_wm6:
s_waitcnt vmcnt(7) lgkmcnt(0)
s_barrier
s_add_u32 s69, s69, 1
s_cmp_eq_u32 s69, 10
s_cselect_b32 s69, 0, s69
s_lshl_b32 s63, s69, 7
s_mov_b32 s61, 45056
s_add_u32 m0, s61, s64
s_mov_b32 exec_lo, s62
buffer_load_dwordx4 v24, s[4:7], s63 offen lds
s_addk_i32 m0, 1024
s_mov_b32 exec_lo, -1
buffer_load_dwordx4 v25, s[4:7], s63 offen lds
s_addk_i32 m0, 1024
s_nop 0
buffer_load_dwordx4 v26, s[4:7], s63 offen lds
s_addk_i32 m0, 1024
s_nop 0
buffer_load_dwordx4 v27, s[4:7], s63 offen lds
s_cmp_eq_u32 s57, 7
s_cbranch_scc0 L_xc7
s_mov_b32 s0, 118784
s_call_b64 s[100:101], L_xcap
L_xc7:
s_waitcnt vmcnt(8)
v_add_f32 v36, v36, v40
v_add_f32 v37, v37, v41
v_add_f32 v38, v38, v42
v_add_f32 v39, v39, v43
v_add_f32 v36, v36, v44
v_add_f32 v37, v37, v45
v_add_f32 v38, v38, v46
v_add_f32 v39, v39, v47
s_nop 0
v_permlane32_swap_b32 v36, v38
v_permlane32_swap_b32 v37, v39
v_add_f32 v36, v36, v38
v_add_f32 v37, v37, v39
v_mov_b32 v38, v36
v_mov_b32 v39, v37
s_mov_b32 s1, 0x3acccccd
v_mov_b32 v1, 0x3727c5ac
v_permlane16_swap_b32 v36, v38
v_permlane16_swap_b32 v37, v39
v_add_f32 v36, v36, v38
v_add_f32 v37, v37, v39
v_mul_f32 v36, 0xbacccccd, v36
v_fma_f32 v2, v37, s1, v1
v_fma_f32 v2, -v36, v36, v2
v_max_f32 v2, v2, v1
v_rsq_f32 v37, v2
v_mov_b32 v39, v53
v_mov_b32 v38, v37
ds_write_b128 v52, v[36:39] offset:0
s_waitcnt vmcnt(4) lgkmcnt(0)
s_barrier
s_cmp_eq_u32 s57, 8
s_cbranch_scc0 L_xc8
s_mov_b32 s0, 8192
s_call_b64 s[100:101], L_xcap
L_xc8:
L_h8:
s_mul_i32 s66, s38, 5120
s_lshl_b32 s3, s38, 10
s_add_u32 m0, s3, 81920
s_add_u32 s3, s66, 25600
buffer_load_dwordx4 v56, s[12:15], s3 offen lds
s_addk_i32 m0, 4096
s_add_u32 s3, s66, 102400
buffer_load_dwordx4 v56, s[12:15], s3 offen lds
s_addk_i32 m0, 4096
s_add_u32 s3, s66, 179200
buffer_load_dwordx4 v56, s[12:15], s3 offen lds
s_addk_i32 m0, 4096
s_add_u32 s3, s66, 256000
buffer_load_dwordx4 v56, s[12:15], s3 offen lds
s_addk_i32 m0, 4096
s_add_u32 s3, s66, 332800
buffer_load_dwordx4 v56, s[12:15], s3 offen lds
s_addk_i32 m0, 4096
s_add_u32 s3, s66, 435200
buffer_load_dwordx4 v56, s[12:15], s3 offen lds
s_addk_i32 m0, 4096
s_add_u32 s3, s66, 512000
buffer_load_dwordx4 v56, s[12:15], s3 offen lds
s_addk_i32 m0, 4096
s_add_u32 s3, s66, 588800
buffer_load_dwordx4 v56, s[12:15], s3 offen lds
v_add_u32 v1, 128, v222
v_cndmask_b32 v2, v1, v222, s[44:45]
ds_read_b64 v[168:169], v2 offset:0
v_cndmask_b32 v2, v1, v222, s[46:47]
ds_read_b64 v[170:171], v2 offset:32
v_cndmask_b32 v2, v1, v222, s[48:49]
ds_read_b64 v[172:173], v2 offset:64
v_cndmask_b32 v2, v1, v222, s[50:51]
ds_read_b64 v[174:175], v2 offset:96
ds_read_b32 v5, v223
v_mov_b32 v1, 1728
ds_read_b32 v1, v1
s_waitcnt lgkmcnt(0)
v_readfirstlane_b32 s41, v1
s_waitcnt vmcnt(8)
s_barrier
s_cmp_eq_u32 s41, 1
s_cbranch_scc0 L_gh_3g
L_gh_3b:
s_addk_i32 m0, 4096
s_add_u32 s3, s66, 665600
buffer_load_dwordx4 v56, s[12:15], s3 offen lds
s_addk_i32 m0, 4096
s_add_u32 s3, s66, 742400
buffer_load_dwordx4 v56, s[12:15], s3 offen lds
buffer_load_dword v62, v61, s[20:23], s54 offen
buffer_load_dword v63, v63, s[16:19], 0 offen
global_load_dword v84, v84, s[96:97]
v_lshlrev_b32 v8, 16, v72
v_and_b32 v9, 0xffff0000, v72
v_lshlrev_b32 v10, 16, v73
v_and_b32 v11, 0xffff0000, v73
v_lshlrev_b32 v12, 16, v74
v_and_b32 v13, 0xffff0000, v74
v_lshlrev_b32 v14, 16, v75
v_and_b32 v15, 0xffff0000, v75
v_lshlrev_b32 v16, 16, v76
v_and_b32 v17, 0xffff0000, v76
v_lshlrev_b32 v18, 16, v77
v_and_b32 v19, 0xffff0000, v77
v_lshlrev_b32 v20, 16, v78
v_and_b32 v21, 0xffff0000, v78
v_lshlrev_b32 v22, 16, v79
v_and_b32 v23, 0xffff0000, v79
s_mov_b32 s3, 0x3f803f80
v_mov_b32 v64, s3
v_mov_b32 v65, s3
v_mov_b32 v66, s3
v_mov_b32 v67, s3
s_mov_b32 exec_lo, 0x11111111
s_mov_b32 exec_hi, 0x11111111
v_mov_b32 v244, s3
v_mov_b32 v245, s3
v_mov_b32 v246, s3
v_mov_b32 v247, s3
v_mov_b32 v248, s3
v_mov_b32 v249, s3
v_mov_b32 v250, s3
v_mov_b32 v251, s3
s_mov_b64 exec, -1
v_mfma_f32_16x16x32_bf16 v[252:255], v[244:247], v[64:67], 0
v_mfma_f32_16x16x32_bf16 v[252:255], v[248:251], v[64:67], v[252:255]
s_and_b32 s3, s32, 1
s_lshl_b32 s61, s3, 7
s_xor_b32 s62, s61, 128
s_add_u32 s63, s62, s54
s_add_u32 s64, s61, s54
s_lshl_b32 s3, s3, 13
s_sub_u32 s65, 4096, s3
s_add_u32 s0, s37, 1
s_sub_u32 s1, 5, s37
s_min_u32 s0, s0, s1
s_lshl_b32 s0, s0, 4
s_sub_u32 s1, 64, s0
s_cmp_le_u32 s37, 2
s_cselect_b32 s1, s1, 16
s_bfm_b64 s[100:101], s0, s1
v_mul_f32 v5, 0x3ea52b5c, v5
s_barrier
ds_read_b64 v[96:97], v202 offset:0
ds_read_b64 v[98:99], v202 offset:1152
ds_read_b64 v[100:101], v203 offset:0
ds_read_b64 v[102:103], v203 offset:1152
ds_read_b64 v[104:105], v201 offset:0
ds_read_b64 v[106:107], v201 offset:1152
ds_read_b64 v[108:109], v200 offset:0
ds_read_b64 v[110:111], v200 offset:1152
ds_read_b64 v[112:113], v200 offset:40
ds_read_b64 v[114:115], v200 offset:1192
s_cmp_eq_u32 s38, 1
s_cbranch_scc1 L_woe1
s_cmp_eq_u32 s38, 2
s_cbranch_scc1 L_woe2
s_cmp_eq_u32 s38, 3
s_cbranch_scc1 L_woe3
s_addk_i32 m0, 4096
s_mov_b32 s3, 46080
buffer_load_dwordx4 v56, s[12:15], s3 offen lds
s_addk_i32 m0, 4096
s_mov_b32 s3, 122880
buffer_load_dwordx4 v56, s[12:15], s3 offen lds
s_addk_i32 m0, 4096
s_mov_b32 s3, 199680
buffer_load_dwordx4 v56, s[12:15], s3 offen lds
s_addk_i32 m0, 4096
s_mov_b32 s3, 276480
buffer_load_dwordx4 v56, s[12:15], s3 offen lds
s_addk_i32 m0, 4096
s_mov_b32 s3, 353280
buffer_load_dwordx4 v56, s[12:15], s3 offen lds
s_addk_i32 m0, 4096
s_mov_b32 s3, 455680
buffer_load_dwordx4 v56, s[12:15], s3 offen lds
s_addk_i32 m0, 4096
s_mov_b32 s3, 532480
buffer_load_dwordx4 v56, s[12:15], s3 offen lds
s_addk_i32 m0, 4096
s_mov_b32 s3, 609280
buffer_load_dwordx4 v56, s[12:15], s3 offen lds
s_addk_i32 m0, 4096
s_mov_b32 s3, 686080
buffer_load_dwordx4 v56, s[12:15], s3 offen lds
s_addk_i32 m0, 4096
s_mov_b32 s3, 762880
buffer_load_dwordx4 v56, s[12:15], s3 offen lds
L_woe:
buffer_load_dword v62, v61, s[20:23], 0 offen
s_setprio 1
s_waitcnt vmcnt(16)
s_barrier
ds_read_b64 v[116:117], v206 offset:0
ds_read_b64 v[118:119], v207 offset:0
ds_read_b64 v[120:121], v208 offset:0
ds_read_b64 v[122:123], v209 offset:0
ds_read_b64 v[124:125], v210 offset:0
ds_read_b64 v[126:127], v211 offset:0
ds_read_b64 v[128:129], v204 offset:0
ds_read_b64 v[130:131], v205 offset:0
ds_read_b64 v[132:133], v204 offset:40
ds_read_b64 v[134:135], v205 offset:40
s_waitcnt lgkmcnt(8)
v_mfma_f32_16x16x32_bf16 v[152:155], v[96:99], v[116:119], 0
ds_read_b64 v[136:137], v212 offset:0
ds_read_b64 v[138:139], v213 offset:0
s_waitcnt lgkmcnt(8)
v_mfma_f32_16x16x32_bf16 v[156:159], v[100:103], v[120:123], 0
ds_read_b64 v[140:141], v214 offset:0
ds_read_b64 v[142:143], v215 offset:0
s_waitcnt lgkmcnt(8)
v_mfma_f32_16x16x32_bf16 v[152:155], v[104:107], v[124:127], v[152:155]
s_waitcnt lgkmcnt(6)
v_mfma_f32_16x16x32_bf16 v[160:163], v[108:111], v[128:131], 0
s_waitcnt lgkmcnt(4)
v_mfma_f32_16x16x32_bf16 v[164:167], v[112:115], v[132:135], 0
s_waitcnt lgkmcnt(2)
v_mfma_f32_16x16x32_bf16 v[160:163], v[104:107], v[136:139], v[160:163]
s_waitcnt lgkmcnt(0)
v_mfma_f32_16x16x32_bf16 v[164:167], v[104:107], v[140:143], v[164:167]
v_permlane16_swap_b32 v152, v156
v_permlane16_swap_b32 v153, v157
v_permlane16_swap_b32 v154, v158
v_permlane16_swap_b32 v155, v159
v_cndmask_b32 v2, v156, v152, s[44:45]
v_cndmask_b32 v3, v157, v153, s[46:47]
v_cndmask_b32 v194, v158, v154, s[48:49]
v_cndmask_b32 v195, v159, v155, s[50:51]
v_or_b32 v192, 0xffff, v2
v_perm_b32 v193, v3, v2, s55
s_cmp_eq_u32 s41, 1
s_cbranch_scc0 L_gl_4g
buffer_store_dwordx4 v[192:195], v224, s[20:23], s54 offen
L_gl_4b:
v_permlane16_swap_b32 v160, v164
v_permlane16_swap_b32 v161, v165
v_permlane16_swap_b32 v162, v166
v_permlane16_swap_b32 v163, v167
v_cndmask_b32 v196, v164, v160, s[44:45]
v_cndmask_b32 v197, v165, v161, s[46:47]
v_cndmask_b32 v198, v166, v162, s[48:49]
v_cndmask_b32 v199, v167, v163, s[50:51]
v_fma_f32 v196, v196, v168, v169
v_fma_f32 v197, v197, v170, v171
v_fma_f32 v198, v198, v172, v173
v_fma_f32 v199, v199, v174, v175
v_max3_f32 v6, v196, v197, v198
v_max_f32 v6, v6, v199
v_mov_b32 v7, v6
s_nop 1
v_permlane32_swap_b32 v6, v7
v_max_f32 v6, v6, v7
v_mul_f32 v6, v6, v5
v_fma_f32 v196, v196, v5, -v6
v_fma_f32 v197, v197, v5, -v6
v_fma_f32 v198, v198, v5, -v6
v_fma_f32 v199, v199, v5, -v6
v_exp_f32 v196, v196
v_exp_f32 v197, v197
v_exp_f32 v198, v198
v_exp_f32 v199, v199
ds_read_b64_tr_b16 v[64:65], v216 offset:0
ds_read_b64_tr_b16 v[66:67], v216 offset:1152
ds_read_b64_tr_b16 v[68:69], v216 offset:40
ds_read_b64_tr_b16 v[70:71], v216 offset:1192
ds_read_b64_tr_b16 v[72:73], v217 offset:0
ds_read_b64_tr_b16 v[74:75], v217 offset:1152
ds_read_b64_tr_b16 v[76:77], v218 offset:0
ds_read_b64_tr_b16 v[78:79], v218 offset:1152
v_add_f32 v6, v196, v197
v_add_f32 v7, v198, v199
v_add_f32 v6, v6, v7
v_mov_b32 v7, v6
v_mul_f32 v196, v196, v168
v_mul_f32 v197, v197, v170
v_permlane32_swap_b32 v6, v7
v_mul_f32 v198, v198, v172
v_add_f32 v6, v6, v7
v_rcp_f32 v6, v6
v_mul_f32 v199, v199, v174
v_mul_f32 v196, v196, v6
v_mul_f32 v197, v197, v6
v_mul_f32 v198, v198, v6
v_mul_f32 v199, v199, v6
v_cvt_pk_bf16_f32 v196, v196, v197
v_cvt_pk_bf16_f32 v197, v198, v199
s_mov_b64 exec, s[52:53]
v_and_b32 v176, v220, v196
v_bfi_b32 v180, v220, 0, v196
v_and_b32 v177, v221, v197
v_bfi_b32 v181, v221, 0, v197
s_not_b64 exec, exec
v_and_b32 v178, v220, v196
v_bfi_b32 v182, v220, 0, v196
v_and_b32 v179, v221, v197
v_bfi_b32 v183, v221, 0, v197
s_mov_b64 exec, -1
v_permlane16_swap_b32 v176, v180
v_permlane16_swap_b32 v177, v181
v_permlane16_swap_b32 v178, v182
v_permlane16_swap_b32 v179, v183
buffer_load_dwordx4 v[92:95], v225, s[20:23], s54 offen sc1
s_waitcnt lgkmcnt(0)
v_mfma_f32_16x16x32_bf16 v[152:155], v[64:67], v[176:179], 0
v_mfma_f32_16x16x32_bf16 v[156:159], v[68:71], v[180:183], 0
v_mfma_f32_16x16x32_bf16 v[160:163], v[72:75], v[176:179], 0
v_mfma_f32_16x16x32_bf16 v[164:167], v[76:79], v[180:183], 0
s_nop 4
v_cvt_pk_bf16_f32 v196, v152, v153
v_cvt_pk_bf16_f32 v197, v154, v155
v_cvt_pk_bf16_f32 v198, v156, v157
v_cvt_pk_bf16_f32 v199, v158, v159
s_cmp_eq_u32 s41, 1
s_cbranch_scc0 L_gl_5g
buffer_store_dwordx4 v[196:199], v226, s[20:23], 0 offen
L_gl_5b:
v_cvt_pk_bf16_f32 v80, v160, v161
v_cvt_pk_bf16_f32 v81, v162, v163
v_cvt_pk_bf16_f32 v82, v164, v165
v_cvt_pk_bf16_f32 v83, v166, v167
ds_read_b64_tr_b16 v[104:105], v228 offset:0
ds_read_b64_tr_b16 v[106:107], v228 offset:512
ds_read_b64_tr_b16 v[108:109], v229 offset:0
ds_read_b64_tr_b16 v[110:111], v229 offset:512
ds_read_b64_tr_b16 v[112:113], v230 offset:0
ds_read_b64_tr_b16 v[114:115], v230 offset:512
ds_read_b64_tr_b16 v[116:117], v231 offset:0
ds_read_b64_tr_b16 v[118:119], v231 offset:512
ds_read_b64_tr_b16 v[120:121], v228 offset:8192
ds_read_b64_tr_b16 v[122:123], v228 offset:8704
ds_read_b64_tr_b16 v[124:125], v229 offset:8192
ds_read_b64_tr_b16 v[126:127], v229 offset:8704
ds_read_b64_tr_b16 v[128:129], v230 offset:8192
ds_read_b64_tr_b16 v[130:131], v230 offset:8704
ds_read_b64_tr_b16 v[132:133], v231 offset:8192
ds_read_b64_tr_b16 v[134:135], v231 offset:8704
ds_read_b64_tr_b16 v[136:137], v228 offset:16384
ds_read_b64_tr_b16 v[138:139], v228 offset:16896
ds_read_b64_tr_b16 v[140:141], v229 offset:16384
ds_read_b64_tr_b16 v[142:143], v229 offset:16896
ds_read_b64_tr_b16 v[144:145], v230 offset:16384
ds_read_b64_tr_b16 v[146:147], v230 offset:16896
ds_read_b64_tr_b16 v[148:149], v231 offset:16384
ds_read_b64_tr_b16 v[150:151], v231 offset:16896
s_waitcnt vmcnt(1)
v_cmp_eq_u32 vcc, -1, v92
s_cbranch_vccnz L_h0rh
L_h0gh:
v_mov_b32 v1, 1744
v_mov_b32 v4, 1
s_mov_b64 exec, 1
ds_add_u32 v1, v4
s_mov_b64 exec, -1
v_perm_b32 v92, v92, v93, s56
v_add_f32 v193, v3, v93
v_add_f32 v194, v194, v94
v_add_f32 v195, v195, v95
v_add_f32 v192, v2, v92
v_fma_f32 v192, v192, v168, v169
v_fma_f32 v193, v193, v170, v171
v_fma_f32 v194, v194, v172, v173
v_fma_f32 v195, v195, v174, v175
v_max3_f32 v6, v192, v193, v194
v_max_f32 v6, v6, v195
v_mov_b32 v7, v6
s_nop 1
v_permlane32_swap_b32 v6, v7
v_max_f32 v6, v6, v7
v_mul_f32 v6, v6, v5
v_fma_f32 v192, v192, v5, -v6
v_fma_f32 v193, v193, v5, -v6
v_fma_f32 v194, v194, v5, -v6
v_fma_f32 v195, v195, v5, -v6
v_exp_f32 v192, v192
v_exp_f32 v193, v193
v_exp_f32 v194, v194
v_exp_f32 v195, v195
buffer_load_dwordx4 v[24:27], v227, s[20:23], s61 offen offset:0 sc1
buffer_load_dwordx4 v[28:31], v227, s[20:23], s61 offen offset:256 sc1
buffer_load_dwordx4 v[32:35], v227, s[20:23], s61 offen offset:512 sc1
buffer_load_dwordx4 v[36:39], v227, s[20:23], s61 offen offset:768 sc1
buffer_load_dwordx4 v[40:43], v227, s[20:23], s61 offen offset:1024 sc1
buffer_load_dwordx4 v[44:47], v227, s[20:23], s62 offen offset:0 sc1
v_add_f32 v6, v192, v193
v_add_f32 v7, v194, v195
v_add_f32 v6, v6, v7
v_mov_b32 v7, v6
v_mul_f32 v192, v192, v168
v_mul_f32 v193, v193, v170
v_permlane32_swap_b32 v6, v7
v_mul_f32 v194, v194, v172
v_add_f32 v6, v6, v7
v_rcp_f32 v6, v6
v_mul_f32 v195, v195, v174
v_mul_f32 v192, v192, v6
v_mul_f32 v193, v193, v6
v_mul_f32 v194, v194, v6
v_mul_f32 v195, v195, v6
v_cvt_pk_bf16_f32 v192, v192, v193
v_cvt_pk_bf16_f32 v193, v194, v195
s_mov_b64 exec, s[52:53]
v_and_b32 v184, v220, v192
v_bfi_b32 v188, v220, 0, v192
v_and_b32 v185, v221, v193
v_bfi_b32 v189, v221, 0, v193
s_not_b64 exec, exec
v_and_b32 v186, v220, v192
v_bfi_b32 v190, v220, 0, v192
v_and_b32 v187, v221, v193
v_bfi_b32 v191, v221, 0, v193
s_mov_b64 exec, -1
v_permlane16_swap_b32 v184, v188
v_permlane16_swap_b32 v185, v189
v_permlane16_swap_b32 v186, v190
v_permlane16_swap_b32 v187, v191
s_nop 1
v_mfma_f32_16x16x32_bf16 v[152:155], v[72:75], v[184:187], 0
v_mfma_f32_16x16x32_bf16 v[156:159], v[76:79], v[184:187], 0
v_mfma_f32_16x16x32_bf16 v[160:163], v[76:79], v[188:191], 0
ds_read_b32 v1, v1
s_mov_b32 exec_lo, 0xffff0000
s_nop 3
v_cvt_pk_bf16_f32 v80, v152, v153
v_cvt_pk_bf16_f32 v81, v154, v155
v_cvt_pk_bf16_f32 v82, v156, v157
v_cvt_pk_bf16_f32 v83, v158, v159
s_mov_b64 exec, s[100:101]
v_cvt_pk_bf16_f32 v82, v160, v161
v_cvt_pk_bf16_f32 v83, v162, v163
s_mov_b64 exec, -1
s_cmp_eq_u32 s41, 1
s_cbranch_scc0 L_gl_6g
buffer_store_dwordx4 v[80:83], v226, s[20:23], s54 offen
L_gl_6b:
s_branch L_pb_7
.p2align 12
L_pad_8:
s_setpc_b64 s[100:101]
L_pb_7:
s_lshl_b32 s0, s38, 12
s_add_u32 s0, s0, 57344
v_add_u32 v4, s0, v233
s_and_b32 s0, s38, 2
s_lshl_b32 s0, s0, 1
s_add_u32 s0, s0, 1760
v_mov_b32 v3, s0
v_mov_b32 v5, 1
s_waitcnt lgkmcnt(0)
v_cmp_ne_u32 vcc, 4, v1
s_cbranch_vccnz L_spw
L_sbw:
s_waitcnt vmcnt(5)
v_max_u16 v2, v24, v28
v_cmp_eq_u16 vcc, -1, v2
s_cbranch_vccnz L_st0
L_go0:
v_mfma_f32_16x16x32_bf16 v[8:11], v[104:107], v[24:27], v[8:11]
buffer_load_dwordx4 v[48:51], v236, s[20:23], s62 offen offset:0 sc1
ds_read_b64_tr_b16 v[152:153], v228 offset:24576
v_mfma_f32_16x16x32_bf16 v[12:15], v[108:111], v[24:27], v[12:15]
ds_read_b64_tr_b16 v[154:155], v228 offset:25088
ds_read_b64_tr_b16 v[156:157], v229 offset:24576
v_mfma_f32_16x16x32_bf16 v[16:19], v[112:115], v[24:27], v[16:19]
ds_read_b64_tr_b16 v[158:159], v229 offset:25088
ds_read_b64_tr_b16 v[160:161], v230 offset:24576
v_mfma_f32_16x16x32_bf16 v[20:23], v[116:119], v[24:27], v[20:23]
ds_read_b64_tr_b16 v[162:163], v230 offset:25088
ds_read_b64_tr_b16 v[164:165], v231 offset:24576
v_mfma_f32_16x16x32_bf16 v[8:11], v[120:123], v[28:31], v[8:11]
buffer_load_dwordx4 v[52:55], v227, s[20:23], s62 offen offset:256 sc1
ds_read_b64_tr_b16 v[166:167], v231 offset:25088
v_mfma_f32_16x16x32_bf16 v[12:15], v[124:127], v[28:31], v[12:15]
ds_read_b64_tr_b16 v[168:169], v228 offset:32768
s_waitcnt vmcnt(5)
v_max_u16 v2, v32, v36
v_cmp_eq_u16 vcc, -1, v2
v_mfma_f32_16x16x32_bf16 v[16:19], v[128:131], v[28:31], v[16:19]
ds_read_b64_tr_b16 v[170:171], v228 offset:33280
s_cbranch_vccnz L_st1
L_go1:
v_mfma_f32_16x16x32_bf16 v[20:23], v[132:135], v[28:31], v[20:23]
ds_read_b64_tr_b16 v[172:173], v229 offset:32768
v_mfma_f32_16x16x32_bf16 v[8:11], v[136:139], v[32:35], v[8:11]
buffer_load_dwordx4 v[56:59], v236, s[20:23], s62 offen offset:256 sc1
ds_read_b64_tr_b16 v[174:175], v229 offset:33280
v_mfma_f32_16x16x32_bf16 v[12:15], v[140:143], v[32:35], v[12:15]
ds_read_b64_tr_b16 v[176:177], v230 offset:32768
ds_read_b64_tr_b16 v[178:179], v230 offset:33280
v_mfma_f32_16x16x32_bf16 v[16:19], v[144:147], v[32:35], v[16:19]
ds_read_b64_tr_b16 v[180:181], v231 offset:32768
ds_read_b64_tr_b16 v[182:183], v231 offset:33280
v_mfma_f32_16x16x32_bf16 v[20:23], v[148:151], v[32:35], v[20:23]
v_add_u32 v228, s65, v228
ds_read_b64_tr_b16 v[184:185], v228 offset:0
ds_read_b64_tr_b16 v[186:187], v228 offset:512
s_waitcnt lgkmcnt(10)
v_mfma_f32_16x16x32_bf16 v[8:11], v[152:155], v[36:39], v[8:11]
buffer_load_dwordx4 v[60:63], v227, s[20:23], s62 offen offset:512 sc1
v_add_u32 v229, s65, v229
ds_read_b64_tr_b16 v[188:189], v229 offset:0
v_mfma_f32_16x16x32_bf16 v[12:15], v[156:159], v[36:39], v[12:15]
buffer_load_dwordx4 v[64:67], v236, s[20:23], s62 offen offset:512 sc1
ds_read_b64_tr_b16 v[190:191], v229 offset:512
s_waitcnt vmcnt(7)
v_cmp_eq_u16 vcc, -1, v40
v_mfma_f32_16x16x32_bf16 v[16:19], v[160:163], v[36:39], v[16:19]
v_add_u32 v230, s65, v230
ds_read_b64_tr_b16 v[192:193], v230 offset:0
s_cbranch_vccnz L_st2
L_go2:
v_mfma_f32_16x16x32_bf16 v[20:23], v[164:167], v[36:39], v[20:23]
ds_read_b64_tr_b16 v[194:195], v230 offset:512
s_waitcnt lgkmcnt(6)
v_mfma_f32_16x16x32_bf16 v[8:11], v[168:171], v[40:43], v[8:11]
buffer_load_dwordx4 v[68:71], v227, s[20:23], s62 offen offset:768 sc1
v_add_u32 v231, s65, v231
ds_read_b64_tr_b16 v[196:197], v231 offset:0
v_mfma_f32_16x16x32_bf16 v[12:15], v[172:175], v[40:43], v[12:15]
buffer_load_dwordx4 v[72:75], v236, s[20:23], s62 offen offset:768 sc1
ds_read_b64_tr_b16 v[198:199], v231 offset:512
s_waitcnt vmcnt(6)
v_max_u16 v2, v44, v48
v_cmp_eq_u16 vcc, -1, v2
v_mfma_f32_16x16x32_bf16 v[16:19], v[176:179], v[40:43], v[16:19]
ds_read_b64_tr_b16 v[104:105], v228 offset:8192
s_cbranch_vccnz L_st3
L_go3:
v_mfma_f32_16x16x32_bf16 v[20:23], v[180:183], v[40:43], v[20:23]
ds_read_b64_tr_b16 v[106:107], v228 offset:8704
s_waitcnt lgkmcnt(8)
v_mfma_f32_16x16x32_bf16 v[8:11], v[184:187], v[44:47], v[8:11]
buffer_load_dwordx4 v[76:79], v227, s[20:23], s62 offen offset:1024 sc1
ds_read_b64_tr_b16 v[108:109], v229 offset:8192
v_mfma_f32_16x16x32_bf16 v[200:203], v[184:187], v[48:51], 0
ds_read_b64_tr_b16 v[110:111], v229 offset:8704
ds_read_b64_tr_b16 v[112:113], v230 offset:8192
s_waitcnt lgkmcnt(9)
v_mfma_f32_16x16x32_bf16 v[12:15], v[188:191], v[44:47], v[12:15]
ds_read_b64_tr_b16 v[114:115], v230 offset:8704
ds_read_b64_tr_b16 v[116:117], v231 offset:8192
v_mfma_f32_16x16x32_bf16 v[204:207], v[188:191], v[48:51], 0
ds_read_b64_tr_b16 v[118:119], v231 offset:8704
ds_read_b64_tr_b16 v[120:121], v228 offset:16384
s_waitcnt lgkmcnt(11)
v_mfma_f32_16x16x32_bf16 v[16:19], v[192:195], v[44:47], v[16:19]
buffer_load_dwordx4 v[80:83], v236, s[20:23], s62 offen offset:1024 sc1
ds_read_b64_tr_b16 v[122:123], v228 offset:16896
v_mfma_f32_16x16x32_bf16 v[208:211], v[192:195], v[48:51], 0
ds_read_b64_tr_b16 v[124:125], v229 offset:16384
s_waitcnt vmcnt(6)
v_max_u16 v2, v52, v56
v_cmp_eq_u16 vcc, -1, v2
s_waitcnt lgkmcnt(11)
v_mfma_f32_16x16x32_bf16 v[20:23], v[196:199], v[44:47], v[20:23]
ds_read_b64_tr_b16 v[126:127], v229 offset:16896
s_cbranch_vccnz L_st4
L_go4:
v_mfma_f32_16x16x32_bf16 v[212:215], v[196:199], v[48:51], 0
ds_read_b64_tr_b16 v[128:129], v230 offset:16384
s_waitcnt lgkmcnt(11)
v_mfma_f32_16x16x32_bf16 v[8:11], v[104:107], v[52:55], v[8:11]
buffer_load_dwordx4 v[84:87], v227, s[20:23], s63 offen offset:0 sc1
ds_read_b64_tr_b16 v[130:131], v230 offset:16896
s_waitcnt lgkmcnt(6)
v_mfma_f32_16x16x32_bf16 v[200:203], v[104:107], v[56:59], v[200:203]
ds_read_b64_tr_b16 v[132:133], v231 offset:16384
ds_read_b64_tr_b16 v[134:135], v231 offset:16896
v_mfma_f32_16x16x32_bf16 v[12:15], v[108:111], v[52:55], v[12:15]
ds_read_b64_tr_b16 v[136:137], v228 offset:24576
ds_read_b64_tr_b16 v[138:139], v228 offset:25088
v_mfma_f32_16x16x32_bf16 v[204:207], v[108:111], v[56:59], v[204:207]
ds_read_b64_tr_b16 v[140:141], v229 offset:24576
ds_read_b64_tr_b16 v[142:143], v229 offset:25088
v_mfma_f32_16x16x32_bf16 v[16:19], v[112:115], v[52:55], v[16:19]
buffer_load_dwordx4 v[88:91], v236, s[20:23], s63 offen offset:0 sc1
ds_read_b64_tr_b16 v[144:145], v230 offset:24576
v_mfma_f32_16x16x32_bf16 v[208:211], v[112:115], v[56:59], v[208:211]
ds_read_b64_tr_b16 v[146:147], v230 offset:25088
s_waitcnt vmcnt(6)
v_max_u16 v2, v60, v64
v_cmp_eq_u16 vcc, -1, v2
v_mfma_f32_16x16x32_bf16 v[20:23], v[116:119], v[52:55], v[20:23]
ds_read_b64_tr_b16 v[148:149], v231 offset:24576
s_cbranch_vccnz L_st5
L_go5:
v_mfma_f32_16x16x32_bf16 v[212:215], v[116:119], v[56:59], v[212:215]
ds_read_b64_tr_b16 v[150:151], v231 offset:25088
s_waitcnt lgkmcnt(8)
v_mfma_f32_16x16x32_bf16 v[8:11], v[120:123], v[60:63], v[8:11]
buffer_load_dwordx4 v[92:95], v227, s[20:23], s63 offen offset:256 sc1
ds_read_b64_tr_b16 v[152:153], v228 offset:32768
v_mfma_f32_16x16x32_bf16 v[200:203], v[120:123], v[64:67], v[200:203]
ds_read_b64_tr_b16 v[154:155], v228 offset:33280
ds_read_b64_tr_b16 v[156:157], v229 offset:32768
v_mfma_f32_16x16x32_bf16 v[12:15], v[124:127], v[60:63], v[12:15]
ds_read_b64_tr_b16 v[158:159], v229 offset:33280
ds_read_b64_tr_b16 v[160:161], v230 offset:32768
v_mfma_f32_16x16x32_bf16 v[204:207], v[124:127], v[64:67], v[204:207]
ds_read_b64_tr_b16 v[162:163], v230 offset:33280
ds_read_b64_tr_b16 v[164:165], v231 offset:32768
v_mfma_f32_16x16x32_bf16 v[16:19], v[128:131], v[60:63], v[16:19]
buffer_load_dwordx4 v[96:99], v236, s[20:23], s63 offen offset:256 sc1
ds_read_b64_tr_b16 v[166:167], v231 offset:33280
v_mfma_f32_16x16x32_bf16 v[208:211], v[128:131], v[64:67], v[208:211]
v_add_u32 v228, 40960, v228
ds_read_b64_tr_b16 v[168:169], v228 offset:0
s_waitcnt vmcnt(6)
v_max_u16 v2, v68, v72
v_cmp_eq_u16 vcc, -1, v2
v_mfma_f32_16x16x32_bf16 v[20:23], v[132:135], v[60:63], v[20:23]
ds_read_b64_tr_b16 v[170:171], v228 offset:512
s_cbranch_vccnz L_st6
L_go6:
v_mfma_f32_16x16x32_bf16 v[212:215], v[132:135], v[64:67], v[212:215]
v_add_u32 v229, 40960, v229
ds_read_b64_tr_b16 v[172:173], v229 offset:0
s_waitcnt lgkmcnt(11)
v_mfma_f32_16x16x32_bf16 v[8:11], v[136:139], v[68:71], v[8:11]
buffer_load_dwordx4 v[100:103], v227, s[20:23], s63 offen offset:512 sc1
ds_read_b64_tr_b16 v[174:175], v229 offset:512
v_mfma_f32_16x16x32_bf16 v[200:203], v[136:139], v[72:75], v[200:203]
v_add_u32 v230, 40960, v230
ds_read_b64_tr_b16 v[176:177], v230 offset:0
ds_read_b64_tr_b16 v[178:179], v230 offset:512
v_mfma_f32_16x16x32_bf16 v[12:15], v[140:143], v[68:71], v[12:15]
v_add_u32 v231, 40960, v231
ds_read_b64_tr_b16 v[180:181], v231 offset:0
ds_read_b64_tr_b16 v[182:183], v231 offset:512
v_mfma_f32_16x16x32_bf16 v[204:207], v[140:143], v[72:75], v[204:207]
ds_read_b64_tr_b16 v[184:185], v228 offset:8192
ds_read_b64_tr_b16 v[186:187], v228 offset:8704
v_mfma_f32_16x16x32_bf16 v[16:19], v[144:147], v[68:71], v[16:19]
buffer_load_dwordx4 v[24:27], v236, s[20:23], s63 offen offset:512 sc1
ds_read_b64_tr_b16 v[188:189], v229 offset:8192
v_mfma_f32_16x16x32_bf16 v[208:211], v[144:147], v[72:75], v[208:211]
ds_read_b64_tr_b16 v[190:191], v229 offset:8704
s_waitcnt vmcnt(6)
v_max_u16 v2, v76, v80
v_cmp_eq_u16 vcc, -1, v2
v_mfma_f32_16x16x32_bf16 v[20:23], v[148:151], v[68:71], v[20:23]
ds_read_b64_tr_b16 v[192:193], v230 offset:8192
s_cbranch_vccnz L_st7
L_go7:
v_mfma_f32_16x16x32_bf16 v[212:215], v[148:151], v[72:75], v[212:215]
ds_read_b64_tr_b16 v[194:195], v230 offset:8704
s_waitcnt lgkmcnt(14)
v_mfma_f32_16x16x32_bf16 v[8:11], v[152:155], v[76:79], v[8:11]
buffer_load_dwordx4 v[28:31], v236, s[20:23], s63 offen offset:768 sc1
ds_read_b64_tr_b16 v[196:197], v231 offset:8192
v_mfma_f32_16x16x32_bf16 v[200:203], v[152:155], v[80:83], v[200:203]
ds_read_b64_tr_b16 v[198:199], v231 offset:8704
ds_read_b64_tr_b16 v[104:105], v228 offset:16384
v_mfma_f32_16x16x32_bf16 v[12:15], v[156:159], v[76:79], v[12:15]
ds_read_b64_tr_b16 v[106:107], v228 offset:16896
ds_read_b64_tr_b16 v[108:109], v229 offset:16384
v_mfma_f32_16x16x32_bf16 v[204:207], v[156:159], v[80:83], v[204:207]
ds_read_b64_tr_b16 v[110:111], v229 offset:16896
ds_read_b64_tr_b16 v[112:113], v230 offset:16384
v_mfma_f32_16x16x32_bf16 v[16:19], v[160:163], v[76:79], v[16:19]
buffer_load_dwordx4 v[32:35], v236, s[20:23], s63 offen offset:1024 sc1
ds_read_b64_tr_b16 v[114:115], v230 offset:16896
v_mfma_f32_16x16x32_bf16 v[208:211], v[160:163], v[80:83], v[208:211]
ds_read_b64_tr_b16 v[116:117], v231 offset:16384
s_waitcnt vmcnt(6)
v_max_u16 v2, v84, v88
v_cmp_eq_u16 vcc, -1, v2
v_mfma_f32_16x16x32_bf16 v[20:23], v[164:167], v[76:79], v[20:23]
ds_read_b64_tr_b16 v[118:119], v231 offset:16896
s_cbranch_vccnz L_st8
L_go8:
v_mfma_f32_16x16x32_bf16 v[212:215], v[164:167], v[80:83], v[212:215]
ds_read_b64_tr_b16 v[120:121], v228 offset:24576
s_waitcnt lgkmcnt(15)
v_mfma_f32_16x16x32_bf16 v[8:11], v[168:171], v[84:87], v[8:11]
buffer_load_dwordx4 v[36:39], v227, s[20:23], s63 offen offset:768 sc1
ds_read_b64_tr_b16 v[122:123], v228 offset:25088
v_mfma_f32_16x16x32_bf16 v[200:203], v[168:171], v[88:91], v[200:203]
ds_read_b64_tr_b16 v[124:125], v229 offset:24576
ds_read_b64_tr_b16 v[126:127], v229 offset:25088
v_mfma_f32_16x16x32_bf16 v[12:15], v[172:175], v[84:87], v[12:15]
ds_read_b64_tr_b16 v[128:129], v230 offset:24576
ds_read_b64_tr_b16 v[130:131], v230 offset:25088
v_mfma_f32_16x16x32_bf16 v[204:207], v[172:175], v[88:91], v[204:207]
ds_read_b64_tr_b16 v[132:133], v231 offset:24576
ds_read_b64_tr_b16 v[134:135], v231 offset:25088
v_mfma_f32_16x16x32_bf16 v[16:19], v[176:179], v[84:87], v[16:19]
buffer_load_dwordx4 v[40:43], v227, s[20:23], s63 offen offset:1024 sc1
ds_read_b64_tr_b16 v[136:137], v228 offset:32768
v_mfma_f32_16x16x32_bf16 v[208:211], v[176:179], v[88:91], v[208:211]
ds_read_b64_tr_b16 v[138:139], v228 offset:33280
s_waitcnt vmcnt(6)
v_max_u16 v2, v92, v96
v_cmp_eq_u16 vcc, -1, v2
v_mfma_f32_16x16x32_bf16 v[20:23], v[180:183], v[84:87], v[20:23]
ds_read_b64_tr_b16 v[140:141], v229 offset:32768
s_cbranch_vccnz L_st9
L_go9:
v_mfma_f32_16x16x32_bf16 v[212:215], v[180:183], v[88:91], v[212:215]
ds_read_b64_tr_b16 v[142:143], v229 offset:33280
s_waitcnt lgkmcnt(15)
v_mfma_f32_16x16x32_bf16 v[8:11], v[184:187], v[92:95], v[8:11]
buffer_load_dwordx4 v[44:47], v227, s[20:23], s64 offen offset:0 sc1
ds_read_b64_tr_b16 v[144:145], v230 offset:32768
v_mfma_f32_16x16x32_bf16 v[200:203], v[184:187], v[96:99], v[200:203]
ds_read_b64_tr_b16 v[146:147], v230 offset:33280
ds_read_b64_tr_b16 v[148:149], v231 offset:32768
v_mfma_f32_16x16x32_bf16 v[12:15], v[188:191], v[92:95], v[12:15]
ds_read_b64_tr_b16 v[150:151], v231 offset:33280
v_subrev_u32 v228, s65, v228
ds_read_b64_tr_b16 v[152:153], v228 offset:0
v_mfma_f32_16x16x32_bf16 v[204:207], v[188:191], v[96:99], v[204:207]
ds_read_b64_tr_b16 v[154:155], v228 offset:512
v_subrev_u32 v229, s65, v229
ds_read_b64_tr_b16 v[156:157], v229 offset:0
v_mfma_f32_16x16x32_bf16 v[16:19], v[192:195], v[92:95], v[16:19]
buffer_load_dwordx4 v[48:51], v227, s[20:23], s64 offen offset:256 sc1
ds_read_b64_tr_b16 v[158:159], v229 offset:512
v_mfma_f32_16x16x32_bf16 v[208:211], v[192:195], v[96:99], v[208:211]
v_subrev_u32 v230, s65, v230
ds_read_b64_tr_b16 v[160:161], v230 offset:0
s_waitcnt vmcnt(6)
v_max_u16 v2, v100, v24
v_cmp_eq_u16 vcc, -1, v2
v_mfma_f32_16x16x32_bf16 v[20:23], v[196:199], v[92:95], v[20:23]
ds_read_b64_tr_b16 v[162:163], v230 offset:512
s_cbranch_vccnz L_st10
L_go10:
v_mfma_f32_16x16x32_bf16 v[212:215], v[196:199], v[96:99], v[212:215]
v_subrev_u32 v231, s65, v231
ds_read_b64_tr_b16 v[164:165], v231 offset:0
s_waitcnt lgkmcnt(15)
v_mfma_f32_16x16x32_bf16 v[8:11], v[104:107], v[100:103], v[8:11]
buffer_load_dwordx4 v[52:55], v227, s[20:23], s64 offen offset:512 sc1
ds_read_b64_tr_b16 v[166:167], v231 offset:512
v_mfma_f32_16x16x32_bf16 v[200:203], v[104:107], v[24:27], v[200:203]
ds_read_b64_tr_b16 v[168:169], v228 offset:8192
ds_read_b64_tr_b16 v[170:171], v228 offset:8704
v_mfma_f32_16x16x32_bf16 v[12:15], v[108:111], v[100:103], v[12:15]
ds_read_b64_tr_b16 v[172:173], v229 offset:8192
ds_read_b64_tr_b16 v[174:175], v229 offset:8704
v_mfma_f32_16x16x32_bf16 v[204:207], v[108:111], v[24:27], v[204:207]
ds_read_b64_tr_b16 v[176:177], v230 offset:8192
ds_read_b64_tr_b16 v[178:179], v230 offset:8704
v_mfma_f32_16x16x32_bf16 v[16:19], v[112:115], v[100:103], v[16:19]
buffer_load_dwordx4 v[56:59], v227, s[20:23], s64 offen offset:768 sc1
ds_read_b64_tr_b16 v[180:181], v231 offset:8192
v_mfma_f32_16x16x32_bf16 v[208:211], v[112:115], v[24:27], v[208:211]
ds_read_b64_tr_b16 v[182:183], v231 offset:8704
s_waitcnt vmcnt(6)
v_max_u16 v2, v28, v32
v_cmp_eq_u16 vcc, -1, v2
v_mfma_f32_16x16x32_bf16 v[20:23], v[116:119], v[100:103], v[20:23]
ds_read_b64_tr_b16 v[184:185], v228 offset:16384
s_cbranch_vccnz L_st11
L_go11:
v_mfma_f32_16x16x32_bf16 v[212:215], v[116:119], v[24:27], v[212:215]
ds_read_b64_tr_b16 v[186:187], v228 offset:16896
v_mfma_f32_16x16x32_bf16 v[200:203], v[120:123], v[28:31], v[200:203]
buffer_load_dwordx4 v[60:63], v227, s[20:23], s64 offen offset:1024 sc1
ds_read_b64_tr_b16 v[188:189], v229 offset:16384
v_mfma_f32_16x16x32_bf16 v[204:207], v[124:127], v[28:31], v[204:207]
ds_read_b64_tr_b16 v[190:191], v229 offset:16896
ds_read_b64_tr_b16 v[192:193], v230 offset:16384
v_mfma_f32_16x16x32_bf16 v[208:211], v[128:131], v[28:31], v[208:211]
ds_read_b64_tr_b16 v[194:195], v230 offset:16896
ds_read_b64_tr_b16 v[196:197], v231 offset:16384
v_mfma_f32_16x16x32_bf16 v[212:215], v[132:135], v[28:31], v[212:215]
ds_read_b64_tr_b16 v[198:199], v231 offset:16896
ds_read_b64_tr_b16 v[104:105], v228 offset:24576
s_waitcnt lgkmcnt(15)
v_mfma_f32_16x16x32_bf16 v[200:203], v[136:139], v[32:35], v[200:203]
ds_read_b64_tr_b16 v[106:107], v228 offset:25088
ds_read_b64_tr_b16 v[108:109], v229 offset:24576
v_mfma_f32_16x16x32_bf16 v[204:207], v[140:143], v[32:35], v[204:207]
ds_read_b64_tr_b16 v[110:111], v229 offset:25088
s_waitcnt vmcnt(5)
v_max_u16 v2, v36, v40
v_cmp_eq_u16 vcc, -1, v2
v_mfma_f32_16x16x32_bf16 v[208:211], v[144:147], v[32:35], v[208:211]
ds_read_b64_tr_b16 v[112:113], v230 offset:24576
s_cbranch_vccnz L_st12
L_go12:
v_mfma_f32_16x16x32_bf16 v[212:215], v[148:151], v[32:35], v[212:215]
ds_read_b64_tr_b16 v[114:115], v230 offset:25088
v_mfma_f32_16x16x32_bf16 v[8:11], v[120:123], v[36:39], v[8:11]
ds_read_b64_tr_b16 v[116:117], v231 offset:24576
ds_read_b64_tr_b16 v[118:119], v231 offset:25088
v_mfma_f32_16x16x32_bf16 v[12:15], v[124:127], v[36:39], v[12:15]
ds_write_b128 v4, v[200:203] offset:0
v_mfma_f32_16x16x32_bf16 v[16:19], v[128:131], v[36:39], v[16:19]
ds_write_b128 v4, v[204:207] offset:1024
v_mfma_f32_16x16x32_bf16 v[20:23], v[132:135], v[36:39], v[20:23]
ds_write_b128 v4, v[208:211] offset:2048
v_mfma_f32_16x16x32_bf16 v[8:11], v[136:139], v[40:43], v[8:11]
ds_read_b64_tr_b16 v[120:121], v228 offset:32768
ds_read_b64_tr_b16 v[122:123], v228 offset:33280
v_mfma_f32_16x16x32_bf16 v[12:15], v[140:143], v[40:43], v[12:15]
ds_read_b64_tr_b16 v[124:125], v229 offset:32768
s_waitcnt vmcnt(3)
v_max_u16 v2, v44, v48
v_cmp_eq_u16 vcc, -1, v2
v_mfma_f32_16x16x32_bf16 v[16:19], v[144:147], v[40:43], v[16:19]
ds_write_b128 v4, v[212:215] offset:3072
s_cbranch_vccnz L_st13
L_go13:
v_mfma_f32_16x16x32_bf16 v[20:23], v[148:151], v[40:43], v[20:23]
s_mov_b64 exec, 1
ds_add_u32 v3, v5
s_mov_b64 exec, -1
v_mfma_f32_16x16x32_bf16 v[8:11], v[152:155], v[44:47], v[8:11]
ds_read_b64_tr_b16 v[126:127], v229 offset:33280
ds_read_b64_tr_b16 v[128:129], v230 offset:32768
v_mfma_f32_16x16x32_bf16 v[12:15], v[156:159], v[44:47], v[12:15]
ds_read_b64_tr_b16 v[130:131], v230 offset:33280
ds_read_b64_tr_b16 v[132:133], v231 offset:32768
v_mfma_f32_16x16x32_bf16 v[16:19], v[160:163], v[44:47], v[16:19]
ds_read_b64_tr_b16 v[134:135], v231 offset:33280
v_mfma_f32_16x16x32_bf16 v[20:23], v[164:167], v[44:47], v[20:23]
s_waitcnt lgkmcnt(15)
v_mfma_f32_16x16x32_bf16 v[8:11], v[168:171], v[48:51], v[8:11]
v_mfma_f32_16x16x32_bf16 v[12:15], v[172:175], v[48:51], v[12:15]
s_waitcnt vmcnt(1)
v_max_u16 v2, v52, v56
v_cmp_eq_u16 vcc, -1, v2
v_mfma_f32_16x16x32_bf16 v[16:19], v[176:179], v[48:51], v[16:19]
s_cbranch_vccnz L_st14
L_go14:
v_mfma_f32_16x16x32_bf16 v[20:23], v[180:183], v[48:51], v[20:23]
v_mfma_f32_16x16x32_bf16 v[8:11], v[184:187], v[52:55], v[8:11]
v_mfma_f32_16x16x32_bf16 v[12:15], v[188:191], v[52:55], v[12:15]
v_mfma_f32_16x16x32_bf16 v[16:19], v[192:195], v[52:55], v[16:19]
v_mfma_f32_16x16x32_bf16 v[20:23], v[196:199], v[52:55], v[20:23]
s_waitcnt lgkmcnt(13)
v_mfma_f32_16x16x32_bf16 v[8:11], v[104:107], v[56:59], v[8:11]
v_mfma_f32_16x16x32_bf16 v[12:15], v[108:111], v[56:59], v[12:15]
s_waitcnt vmcnt(0)
v_cmp_eq_u16 vcc, -1, v60
v_mfma_f32_16x16x32_bf16 v[16:19], v[112:115], v[56:59], v[16:19]
s_cbranch_vccnz L_st15
L_go15:
v_mfma_f32_16x16x32_bf16 v[20:23], v[116:119], v[56:59], v[20:23]
s_waitcnt lgkmcnt(8)
v_mfma_f32_16x16x32_bf16 v[8:11], v[120:123], v[60:63], v[8:11]
s_waitcnt lgkmcnt(4)
v_mfma_f32_16x16x32_bf16 v[12:15], v[124:127], v[60:63], v[12:15]
s_waitcnt lgkmcnt(2)
v_mfma_f32_16x16x32_bf16 v[16:19], v[128:131], v[60:63], v[16:19]
s_waitcnt lgkmcnt(0)
v_mfma_f32_16x16x32_bf16 v[20:23], v[132:135], v[60:63], v[20:23]
L_tail:
s_nop 1
v_cvt_pk_bf16_f32 v24, v8, v9
v_cvt_pk_bf16_f32 v25, v10, v11
v_cvt_pk_bf16_f32 v26, v12, v13
v_cvt_pk_bf16_f32 v27, v14, v15
v_cvt_pk_bf16_f32 v28, v16, v17
v_cvt_pk_bf16_f32 v29, v18, v19
v_cvt_pk_bf16_f32 v30, v20, v21
v_cvt_pk_bf16_f32 v31, v22, v23
v_mfma_f32_16x16x32_bf16 v[36:39], v[24:27], v[24:27], 0
v_mfma_f32_16x16x32_bf16 v[32:35], v[244:247], v[24:27], 0
v_mfma_f32_16x16x32_bf16 v[36:39], v[28:31], v[28:31], v[36:39]
v_mfma_f32_16x16x32_bf16 v[32:35], v[248:251], v[28:31], v[32:35]
s_mov_b32 s0, 0x22222222
s_mov_b32 s1, s0
s_mov_b32 s44, 0x44444444
s_mov_b32 s45, s44
s_mov_b32 vcc_lo, 0x88888888
s_mov_b32 vcc_hi, 0x88888888
s_lshl_b32 s3, s36, 8
s_add_u32 s3, s3, s58
v_and_b32 v1, 0xf0, v233
v_cndmask_b32 v36, v36, v37, s[0:1]
v_cndmask_b32 v38, v38, v39, vcc
s_or_b64 vcc, vcc, s[44:45]
v_cndmask_b32 v34, v36, v38, vcc
v_mov_b32 v35, v253
s_mov_b32 exec_lo, 0xf0000f
s_mov_b32 exec_hi, 0xf0000f00
s_cmp_eq_u32 s41, 1
s_cbranch_scc0 L_gl_9g
buffer_store_dwordx4 v[32:35], v1, s[16:19], s3 offen
L_gl_9b:
s_mov_b64 exec, -1
v_mov_b32 v48, 0
v_mov_b32 v49, 0
v_mov_b32 v50, 0
v_mov_b32 v51, 0
v_mov_b32 v4, 1.0
s_mov_b32 s0, 0xbacccccd
s_mov_b32 s1, 0x3acccccd
v_mov_b32 v5, 0x3727c5ac
s_mov_b32 s44, 0xfffff800
v_mov_b32 v1, 1732
v_cmp_le_i32 s[46:47], 0, v232
s_mul_i32 s48, s35, 1280
s_lshl_b32 s3, s36, 7
s_add_u32 s48, s48, s3
s_lshl_b32 s49, s48, 1
s_add_u32 s48, s48, s59
s_add_u32 s49, s49, s59
s_add_u32 s49, s49, 4096
s_lshl_b32 s3, s35, 7
s_add_u32 s3, s3, s59
s_add_u32 s3, s3, 21504
s_and_b32 s45, s36, 15
s_lshl_b32 s45, s45, 3
s_add_u32 s45, s45, s32
v_mul_u32_u24 v70, 384, v0
v_and_b32 v69, 48, v0
v_lshlrev_b32 v68, 1, v69
L_e2:
buffer_load_dwordx4 v[40:43], v233, s[16:19], s58 offen sc1
buffer_load_dwordx4 v[44:47], v233, s[16:19], s58 offen offset:1024 sc1
s_mov_b32 exec_hi, 0
buffer_load_dwordx4 v[48:51], v233, s[16:19], s58 offen offset:2048 sc1
s_mov_b32 exec_hi, -1
s_sub_u32 s40, s40, 1
s_waitcnt vmcnt(1)
v_pk_add_f32 v[40:41], v[40:41], v[44:45]
v_pk_add_f32 v[42:43], v[42:43], v[46:47]
s_waitcnt vmcnt(0)
v_pk_add_f32 v[40:41], v[40:41], v[48:49]
v_pk_add_f32 v[42:43], v[42:43], v[50:51]
v_cmp_u_f32 vcc, v40, v40
s_cbranch_scc1 L_e2go
s_cbranch_vccnz L_e2
L_e2go:
v_mfma_f32_16x16x4_f32 v[52:55], v4, v40, 0
v_mfma_f32_16x16x4_f32 v[60:63], v4, v42, 0
v_mfma_f32_16x16x4_f32 v[64:67], v4, v43, 0
v_mfma_f32_16x16x4_f32 v[56:59], v4, v41, 0
s_nop 6
v_mul_f32 v6, s0, v52
v_fma_f32 v7, v60, s1, v5
v_fma_f32 v7, -v6, v6, v7
v_max_f32 v7, v7, v5
v_rsq_f32 v2, v7
v_fma_f32 v7, v6, v64, v56
v_mul_f32 v7, v7, v2
v_mul_f32 v3, v6, v2
v_ashrrev_i32 v6, 31, v7
v_or_b32 v6, 0x80000000, v6
v_xor_b32 v7, v7, v6
v_and_or_b32 v7, v7, s44, v234
v_cndmask_b32 v7, 0, v7, s[46:47]
v_pk_fma_f32 v[72:73], v[8:9], v[2:3], v[2:3] op_sel:[0,0,1] op_sel_hi:[1,0,1]
v_pk_fma_f32 v[74:75], v[10:11], v[2:3], v[2:3] op_sel:[0,0,1] op_sel_hi:[1,0,1]
v_max_u32_dpp v6, v7, v7 row_ror:8 row_mask:0xf bank_mask:0xf
v_pk_fma_f32 v[76:77], v[12:13], v[2:3], v[2:3] op_sel:[0,0,1] op_sel_hi:[1,0,1]
v_pk_fma_f32 v[78:79], v[14:15], v[2:3], v[2:3] op_sel:[0,0,1] op_sel_hi:[1,0,1]
v_max_u32_dpp v6, v6, v6 row_ror:4 row_mask:0xf bank_mask:0xf
s_mov_b64 exec, 15
ds_max_u32 v1, v6
s_mov_b64 exec, -1
v_pk_fma_f32 v[80:81], v[16:17], v[2:3], v[2:3] op_sel:[0,0,1] op_sel_hi:[1,0,1]
v_pk_fma_f32 v[82:83], v[18:19], v[2:3], v[2:3] op_sel:[0,0,1] op_sel_hi:[1,0,1]
v_pk_fma_f32 v[84:85], v[20:21], v[2:3], v[2:3] op_sel:[0,0,1] op_sel_hi:[1,0,1]
v_pk_fma_f32 v[86:87], v[22:23], v[2:3], v[2:3] op_sel:[0,0,1] op_sel_hi:[1,0,1]
v_cvt_pk_bf16_f32 v88, v72, v73
v_cvt_pk_bf16_f32 v89, v74, v75
v_cvt_pk_bf16_f32 v90, v76, v77
v_cvt_pk_bf16_f32 v91, v78, v79
s_waitcnt lgkmcnt(0)
s_barrier
ds_read_b32 v1, v1
v_cvt_pk_bf16_f32 v92, v80, v81
v_cvt_pk_bf16_f32 v93, v82, v83
v_cvt_pk_bf16_f32 v94, v84, v85
v_cvt_pk_bf16_f32 v95, v86, v87
v_pk_add_f32 v[72:73], v[72:73], v[8:9]
v_pk_add_f32 v[74:75], v[74:75], v[10:11]
v_pk_add_f32 v[76:77], v[76:77], v[12:13]
v_pk_add_f32 v[78:79], v[78:79], v[14:15]
v_pk_add_f32 v[80:81], v[80:81], v[16:17]
v_pk_add_f32 v[82:83], v[82:83], v[18:19]
v_pk_add_f32 v[84:85], v[84:85], v[20:21]
v_pk_add_f32 v[86:87], v[86:87], v[22:23]
s_cmp_eq_u32 s45, 4
s_waitcnt lgkmcnt(0)
v_cmp_eq_u32 s[46:47], v1, v7
s_cbranch_scc0 L_nk
s_mov_b64 exec, 0xffff
buffer_store_dword v1, v70, s[16:19], s3 offen sc1
L_nk:
s_and_b64 exec, s[46:47], -1
s_cbranch_scc0 L_nc
buffer_store_dwordx4 v[88:91], v68, s[16:19], s48 offen sc1
buffer_store_dwordx4 v[92:95], v68, s[16:19], s48 offen offset:16 sc1
L_nc:
s_mov_b64 exec, -1
v_cvt_pk_bf16_f32 v96, v72, v73
v_cvt_pk_bf16_f32 v97, v74, v75
v_cvt_pk_bf16_f32 v98, v76, v77
v_cvt_pk_bf16_f32 v99, v78, v79
v_cvt_pk_bf16_f32 v100, v80, v81
v_cvt_pk_bf16_f32 v101, v82, v83
v_cvt_pk_bf16_f32 v102, v84, v85
v_cvt_pk_bf16_f32 v103, v86, v87
v_permlane16_swap_b32 v96, v98
v_permlane16_swap_b32 v97, v99
v_permlane16_swap_b32 v100, v102
v_permlane16_swap_b32 v101, v103
s_not_b64 exec, s[46:47]
buffer_store_dwordx4 v[96:99], v232, s[20:23], 0 offen offset:0
buffer_store_dwordx4 v[100:103], v232, s[20:23], 0 offen offset:64
s_and_b64 exec, s[46:47], -1
s_cbranch_scc0 L_fin
buffer_store_dwordx4 v[96:99], v232, s[20:23], 0 offen offset:0 sc1
buffer_store_dwordx4 v[100:103], v232, s[20:23], 0 offen offset:64 sc1
s_waitcnt vmcnt(0)
buffer_store_dwordx4 v[72:75], v69, s[16:19], s49 offen offset:0 sc1
buffer_store_dwordx4 v[76:79], v69, s[16:19], s49 offen offset:64 sc1
buffer_store_dwordx4 v[80:83], v69, s[16:19], s49 offen offset:128 sc1
buffer_store_dwordx4 v[84:87], v69, s[16:19], s49 offen offset:192 sc1
L_fin:
s_endpgm
.p2align 12
L_pb_10:
L_pad_11:
s_setpc_b64 s[100:101]
L_era:
s_sub_u32 s40, s40, 1
s_cbranch_scc1 L_exa
s_lshl_b32 s0, s33, 5
v_and_b32 v1, 16, v0
buffer_load_dword v32, v1, s[24:27], s0 offen sc1
s_waitcnt vmcnt(0)
s_waitcnt lgkmcnt(0)
v_cmp_ne_u32 vcc, 1, v32
s_cmp_eq_u64 vcc, 0
s_cbranch_scc0 L_era
s_branch L_ega
L_exa:
s_mov_b32 s40, 0
s_branch L_ega
L_erb:
s_sub_u32 s40, s40, 1
s_cbranch_scc1 L_exb
s_buffer_load_dword s71, s[16:19], s66 offset:0 glc
s_buffer_load_dword s73, s[16:19], s66 offset:128 glc
s_buffer_load_dword s75, s[16:19], s66 offset:256 glc
s_buffer_load_dword s77, s[16:19], s66 offset:384 glc
s_buffer_load_dword s83, s[16:19], s66 offset:512 glc
s_buffer_load_dword s85, s[16:19], s66 offset:640 glc
s_buffer_load_dword s89, s[16:19], s66 offset:768 glc
s_buffer_load_dword s91, s[16:19], s66 offset:896 glc
s_buffer_load_dword s93, s[16:19], s66 offset:1024 glc
s_buffer_load_dword s95, s[16:19], s66 offset:1152 glc
s_waitcnt lgkmcnt(0)
s_max_u32 s0, s71, s73
s_max_u32 s0, s0, s75
s_max_u32 s0, s0, s77
s_max_u32 s0, s0, s83
s_max_u32 s0, s0, s85
s_max_u32 s0, s0, s89
s_max_u32 s0, s0, s91
s_max_u32 s0, s0, s93
s_max_u32 s0, s0, s95
s_cmp_lg_u32 s0, -1
s_cbranch_scc0 L_erb
s_branch L_egb
L_exb:
s_mov_b32 s40, 0
s_branch L_egb
L_gh_3g:
s_barrier
s_cmp_eq_u32 s32, 5
s_cbranch_scc0 L_gh_3e
v_mov_b32 v1, 1
s_mov_b64 exec, 1
buffer_store_dword v1, off, s[16:19], s68 offset:64 sc1
s_mov_b64 exec, -1
L_gh_3p:
buffer_load_dword v1, v55, s[16:19], 0 offen offset:64 sc1
s_waitcnt vmcnt(0)
v_cmp_ne_u32 vcc, 1, v1
s_cbranch_vccz L_gh_3e
s_sub_u32 s40, s40, 1
s_cbranch_scc0 L_gh_3p
s_mov_b32 s40, 0
L_gh_3e:
s_barrier
s_branch L_gh_3b
L_xcap:
v_add_u32 v1, s0, v235
ds_read_b64 v[72:73], v1
v_xor_b32 v2, 32, v1
ds_read_b64 v[74:75], v2
v_xor_b32 v3, 64, v1
ds_read_b64 v[76:77], v3
v_xor_b32 v4, 96, v1
ds_read_b64 v[78:79], v4
s_setpc_b64 s[100:101]
L_woe1:
s_addk_i32 m0, 4096
s_mov_b32 s3, 0
buffer_load_dwordx4 v57, s[12:15], s3 offen lds
s_addk_i32 m0, 4096
s_mov_b32 s3, 81920
buffer_load_dwordx4 v57, s[12:15], s3 offen lds
s_addk_i32 m0, 4096
s_mov_b32 s3, 163840
buffer_load_dwordx4 v58, s[12:15], s3 offen lds
s_addk_i32 m0, 4096
s_mov_b32 s3, 245760
buffer_load_dwordx4 v60, s[12:15], s3 offen lds
s_addk_i32 m0, 4096
s_mov_b32 s3, 327680
buffer_load_dwordx4 v60, s[12:15], s3 offen lds
s_addk_i32 m0, 4096
s_mov_b32 s3, 409600
buffer_load_dwordx4 v57, s[12:15], s3 offen lds
s_addk_i32 m0, 4096
s_mov_b32 s3, 491520
buffer_load_dwordx4 v57, s[12:15], s3 offen lds
s_addk_i32 m0, 4096
s_mov_b32 s3, 573440
buffer_load_dwordx4 v58, s[12:15], s3 offen lds
s_addk_i32 m0, 4096
s_mov_b32 s3, 655360
buffer_load_dwordx4 v60, s[12:15], s3 offen lds
s_addk_i32 m0, 4096
s_mov_b32 s3, 737280
buffer_load_dwordx4 v60, s[12:15], s3 offen lds
s_branch L_woe
L_woe2:
s_addk_i32 m0, 4096
s_mov_b32 s3, 5120
buffer_load_dwordx4 v57, s[12:15], s3 offen lds
s_addk_i32 m0, 4096
s_mov_b32 s3, 87040
buffer_load_dwordx4 v58, s[12:15], s3 offen lds
s_addk_i32 m0, 4096
s_mov_b32 s3, 168960
buffer_load_dwordx4 v58, s[12:15], s3 offen lds
s_addk_i32 m0, 4096
s_mov_b32 s3, 250880
buffer_load_dwordx4 v60, s[12:15], s3 offen lds
s_addk_i32 m0, 4096
s_mov_b32 s3, 384000
buffer_load_dwordx4 v59, s[12:15], s3 offen lds
s_addk_i32 m0, 4096
s_mov_b32 s3, 414720
buffer_load_dwordx4 v57, s[12:15], s3 offen lds
s_addk_i32 m0, 4096
s_mov_b32 s3, 496640
buffer_load_dwordx4 v58, s[12:15], s3 offen lds
s_addk_i32 m0, 4096
s_mov_b32 s3, 578560
buffer_load_dwordx4 v58, s[12:15], s3 offen lds
s_addk_i32 m0, 4096
s_mov_b32 s3, 660480
buffer_load_dwordx4 v60, s[12:15], s3 offen lds
s_addk_i32 m0, 4096
s_mov_b32 s3, 793600
buffer_load_dwordx4 v59, s[12:15], s3 offen lds
s_branch L_woe
L_pad_12:
s_setpc_b64 s[100:101]
L_woe3:
s_addk_i32 m0, 4096
s_mov_b32 s3, 10240
buffer_load_dwordx4 v58, s[12:15], s3 offen lds
s_addk_i32 m0, 4096
s_mov_b32 s3, 92160
buffer_load_dwordx4 v58, s[12:15], s3 offen lds
s_addk_i32 m0, 4096
s_mov_b32 s3, 174080
buffer_load_dwordx4 v58, s[12:15], s3 offen lds
s_addk_i32 m0, 4096
s_mov_b32 s3, 307200
buffer_load_dwordx4 v59, s[12:15], s3 offen lds
s_addk_i32 m0, 4096
s_mov_b32 s3, 389120
buffer_load_dwordx4 v59, s[12:15], s3 offen lds
s_addk_i32 m0, 4096
s_mov_b32 s3, 419840
buffer_load_dwordx4 v58, s[12:15], s3 offen lds
s_addk_i32 m0, 4096
s_mov_b32 s3, 501760
buffer_load_dwordx4 v58, s[12:15], s3 offen lds
s_addk_i32 m0, 4096
s_mov_b32 s3, 583680
buffer_load_dwordx4 v58, s[12:15], s3 offen lds
s_addk_i32 m0, 4096
s_mov_b32 s3, 716800
buffer_load_dwordx4 v59, s[12:15], s3 offen lds
s_addk_i32 m0, 4096
s_mov_b32 s3, 798720
buffer_load_dwordx4 v59, s[12:15], s3 offen lds
s_branch L_woe
L_gl_4g:
buffer_store_dwordx4 v[192:195], v224, s[20:23], s54 offen sc1
s_branch L_gl_4b
L_gl_5g:
buffer_store_dwordx4 v[196:199], v226, s[20:23], 0 offen sc1
s_branch L_gl_5b
L_h0rh:
s_sub_u32 s40, s40, 1
s_cbranch_scc1 L_h0xh
buffer_load_dwordx4 v[92:95], v225, s[20:23], s54 offen sc1
s_waitcnt vmcnt(0)
v_cmp_eq_u32 vcc, -1, v92
s_cbranch_vccnz L_h0rh
s_branch L_h0gh
L_h0xh:
s_mov_b32 s40, 0
s_branch L_h0gh
L_gl_6g:
buffer_store_dwordx4 v[80:83], v226, s[20:23], s54 offen sc1
s_branch L_gl_6b
L_spw:
v_mov_b32 v1, 1744
ds_read_b32 v1, v1
s_waitcnt lgkmcnt(0)
v_cmp_ne_u32 vcc, 4, v1
s_cbranch_vccnz L_spw
s_branch L_sbw
L_st0:
s_sub_u32 s40, s40, 1
s_cbranch_scc1 L_sx0
buffer_load_dwordx4 v[24:27], v227, s[20:23], s61 offen offset:0 sc1
buffer_load_dwordx4 v[28:31], v227, s[20:23], s61 offen offset:256 sc1
s_waitcnt vmcnt(0)
v_max_u16 v2, v24, v28
v_cmp_eq_u16 vcc, -1, v2
s_cbranch_vccnz L_st0
s_branch L_go0
L_sx0:
s_mov_b32 s40, 0
s_branch L_go0
L_st1:
s_sub_u32 s40, s40, 1
s_cbranch_scc1 L_sx1
buffer_load_dwordx4 v[32:35], v227, s[20:23], s61 offen offset:512 sc1
buffer_load_dwordx4 v[36:39], v227, s[20:23], s61 offen offset:768 sc1
s_waitcnt vmcnt(0)
v_max_u16 v2, v32, v36
v_cmp_eq_u16 vcc, -1, v2
s_cbranch_vccnz L_st1
s_branch L_go1
L_sx1:
s_mov_b32 s40, 0
s_branch L_go1
L_st2:
s_sub_u32 s40, s40, 1
s_cbranch_scc1 L_sx2
buffer_load_dwordx4 v[40:43], v227, s[20:23], s61 offen offset:1024 sc1
s_waitcnt vmcnt(0)
v_cmp_eq_u16 vcc, -1, v40
s_cbranch_vccnz L_st2
s_branch L_go2
L_sx2:
s_mov_b32 s40, 0
s_branch L_go2
L_st3:
s_sub_u32 s40, s40, 1
s_cbranch_scc1 L_sx3
buffer_load_dwordx4 v[44:47], v227, s[20:23], s62 offen offset:0 sc1
buffer_load_dwordx4 v[48:51], v236, s[20:23], s62 offen offset:0 sc1
s_waitcnt vmcnt(0)
v_max_u16 v2, v44, v48
v_cmp_eq_u16 vcc, -1, v2
s_cbranch_vccnz L_st3
s_branch L_go3
L_sx3:
s_mov_b32 s40, 0
s_branch L_go3
L_st4:
s_sub_u32 s40, s40, 1
s_cbranch_scc1 L_sx4
buffer_load_dwordx4 v[52:55], v227, s[20:23], s62 offen offset:256 sc1
buffer_load_dwordx4 v[56:59], v236, s[20:23], s62 offen offset:256 sc1
s_waitcnt vmcnt(0)
v_max_u16 v2, v52, v56
v_cmp_eq_u16 vcc, -1, v2
s_cbranch_vccnz L_st4
s_branch L_go4
L_sx4:
s_mov_b32 s40, 0
s_branch L_go4
L_pad_13:
s_setpc_b64 s[100:101]
L_st5:
s_sub_u32 s40, s40, 1
s_cbranch_scc1 L_sx5
buffer_load_dwordx4 v[60:63], v227, s[20:23], s62 offen offset:512 sc1
buffer_load_dwordx4 v[64:67], v236, s[20:23], s62 offen offset:512 sc1
s_waitcnt vmcnt(0)
v_max_u16 v2, v60, v64
v_cmp_eq_u16 vcc, -1, v2
s_cbranch_vccnz L_st5
s_branch L_go5
L_sx5:
s_mov_b32 s40, 0
s_branch L_go5
L_st6:
s_sub_u32 s40, s40, 1
s_cbranch_scc1 L_sx6
buffer_load_dwordx4 v[68:71], v227, s[20:23], s62 offen offset:768 sc1
buffer_load_dwordx4 v[72:75], v236, s[20:23], s62 offen offset:768 sc1
s_waitcnt vmcnt(0)
v_max_u16 v2, v68, v72
v_cmp_eq_u16 vcc, -1, v2
s_cbranch_vccnz L_st6
s_branch L_go6
L_sx6:
s_mov_b32 s40, 0
s_branch L_go6
L_st7:
s_sub_u32 s40, s40, 1
s_cbranch_scc1 L_sx7
buffer_load_dwordx4 v[76:79], v227, s[20:23], s62 offen offset:1024 sc1
buffer_load_dwordx4 v[80:83], v236, s[20:23], s62 offen offset:1024 sc1
s_waitcnt vmcnt(0)
v_max_u16 v2, v76, v80
v_cmp_eq_u16 vcc, -1, v2
s_cbranch_vccnz L_st7
s_branch L_go7
L_sx7:
s_mov_b32 s40, 0
s_branch L_go7
L_st8:
s_sub_u32 s40, s40, 1
s_cbranch_scc1 L_sx8
buffer_load_dwordx4 v[84:87], v227, s[20:23], s63 offen offset:0 sc1
buffer_load_dwordx4 v[88:91], v236, s[20:23], s63 offen offset:0 sc1
s_waitcnt vmcnt(0)
v_max_u16 v2, v84, v88
v_cmp_eq_u16 vcc, -1, v2
s_cbranch_vccnz L_st8
s_branch L_go8
L_sx8:
s_mov_b32 s40, 0
s_branch L_go8
L_st9:
s_sub_u32 s40, s40, 1
s_cbranch_scc1 L_sx9
buffer_load_dwordx4 v[92:95], v227, s[20:23], s63 offen offset:256 sc1
buffer_load_dwordx4 v[96:99], v236, s[20:23], s63 offen offset:256 sc1
s_waitcnt vmcnt(0)
v_max_u16 v2, v92, v96
v_cmp_eq_u16 vcc, -1, v2
s_cbranch_vccnz L_st9
s_branch L_go9
L_sx9:
s_mov_b32 s40, 0
s_branch L_go9
L_st10:
s_sub_u32 s40, s40, 1
s_cbranch_scc1 L_sx10
buffer_load_dwordx4 v[100:103], v227, s[20:23], s63 offen offset:512 sc1
buffer_load_dwordx4 v[24:27], v236, s[20:23], s63 offen offset:512 sc1
s_waitcnt vmcnt(0)
v_max_u16 v2, v100, v24
v_cmp_eq_u16 vcc, -1, v2
s_cbranch_vccnz L_st10
s_branch L_go10
L_sx10:
s_mov_b32 s40, 0
s_branch L_go10
L_st11:
s_sub_u32 s40, s40, 1
s_cbranch_scc1 L_sx11
buffer_load_dwordx4 v[28:31], v236, s[20:23], s63 offen offset:768 sc1
buffer_load_dwordx4 v[32:35], v236, s[20:23], s63 offen offset:1024 sc1
s_waitcnt vmcnt(0)
v_max_u16 v2, v28, v32
v_cmp_eq_u16 vcc, -1, v2
s_cbranch_vccnz L_st11
s_branch L_go11
L_sx11:
s_mov_b32 s40, 0
s_branch L_go11
L_st12:
s_sub_u32 s40, s40, 1
s_cbranch_scc1 L_sx12
buffer_load_dwordx4 v[36:39], v227, s[20:23], s63 offen offset:768 sc1
buffer_load_dwordx4 v[40:43], v227, s[20:23], s63 offen offset:1024 sc1
s_waitcnt vmcnt(0)
v_max_u16 v2, v36, v40
v_cmp_eq_u16 vcc, -1, v2
s_cbranch_vccnz L_st12
s_branch L_go12
L_sx12:
s_mov_b32 s40, 0
s_branch L_go12
L_st13:
s_sub_u32 s40, s40, 1
s_cbranch_scc1 L_sx13
buffer_load_dwordx4 v[44:47], v227, s[20:23], s64 offen offset:0 sc1
buffer_load_dwordx4 v[48:51], v227, s[20:23], s64 offen offset:256 sc1
s_waitcnt vmcnt(0)
v_max_u16 v2, v44, v48
v_cmp_eq_u16 vcc, -1, v2
s_cbranch_vccnz L_st13
s_branch L_go13
L_sx13:
s_mov_b32 s40, 0
s_branch L_go13
L_pad_14:
s_setpc_b64 s[100:101]
L_st14:
s_sub_u32 s40, s40, 1
s_cbranch_scc1 L_sx14
buffer_load_dwordx4 v[52:55], v227, s[20:23], s64 offen offset:512 sc1
buffer_load_dwordx4 v[56:59], v227, s[20:23], s64 offen offset:768 sc1
s_waitcnt vmcnt(0)
v_max_u16 v2, v52, v56
v_cmp_eq_u16 vcc, -1, v2
s_cbranch_vccnz L_st14
s_branch L_go14
L_sx14:
s_mov_b32 s40, 0
s_branch L_go14
L_st15:
s_sub_u32 s40, s40, 1
s_cbranch_scc1 L_sx15
buffer_load_dwordx4 v[60:63], v227, s[20:23], s64 offen offset:1024 sc1
s_waitcnt vmcnt(0)
v_cmp_eq_u16 vcc, -1, v60
s_cbranch_vccnz L_st15
s_branch L_go15
L_sx15:
s_mov_b32 s40, 0
s_branch L_go15
L_gl_9g:
buffer_store_dwordx4 v[32:35], v1, s[16:19], s3 offen sc1
s_branch L_gl_9b
L_pad_15:
s_setpc_b64 s[100:101]
L_h0:
s_setprio 2
v_lshrrev_b32 v1, 3, v0
v_and_b32 v2, 2, v1
v_xor_b32 v2, v2, v0
v_and_b32 v2, 7, v2
s_lshl_b32 s3, s36, 7
v_lshl_add_u32 v2, v2, 4, s3
v_mul_u32_u24 v3, 3840, v1
v_add_u32 v24, v3, v2
v_xor_b32 v27, 64, v24
v_add_u32 v27, 30720, v27
v_mov_b32 v55, 0
v_add_u32 v25, 256, v24
v_add_u32 v26, 512, v24
v_add_u32 v28, 256, v27
v_add_u32 v29, 512, v27
v_lshrrev_b32 v1, 4, v0
v_lshlrev_b32 v1, 3, v1
s_lshl_b32 s3, s36, 7
buffer_load_dwordx2 v[244:245], v1, s[28:31], s3 offen offset:0
buffer_load_dwordx2 v[246:247], v1, s[28:31], s3 offen offset:32
buffer_load_dwordx2 v[248:249], v1, s[28:31], s3 offen offset:64
buffer_load_dwordx2 v[250:251], v1, s[28:31], s3 offen offset:96
s_waitcnt vmcnt(4)
s_barrier
s_mov_b32 s42, 1
s_mov_b32 s65, 45056
L_wl:
s_add_u32 s69, s69, 1
s_cmp_eq_u32 s69, 10
s_cselect_b32 s69, 0, s69
s_add_u32 s61, s61, 36864
s_cmp_eq_u32 s61, 155648
s_cselect_b32 s61, 8192, s61
s_mul_i32 s63, s69, 245760
s_add_u32 m0, s61, 12288
s_nop 0
buffer_load_dwordx4 v24, s[8:11], s63 offen offset:0 lds
buffer_load_dwordx4 v25, s[8:11], s63 offen offset:1024 lds
buffer_load_dwordx4 v26, s[8:11], s63 offen offset:2048 lds
s_addk_i32 m0, 3072
s_nop 0
buffer_load_dwordx4 v27, s[8:11], s63 offen offset:0 lds
buffer_load_dwordx4 v28, s[8:11], s63 offen offset:1024 lds
buffer_load_dwordx4 v29, s[8:11], s63 offen offset:2048 lds
s_addk_i32 m0, 3072
s_add_u32 s63, s63, 61440
buffer_load_dwordx4 v24, s[8:11], s63 offen offset:0 lds
buffer_load_dwordx4 v25, s[8:11], s63 offen offset:1024 lds
buffer_load_dwordx4 v26, s[8:11], s63 offen offset:2048 lds
s_addk_i32 m0, 3072
s_nop 0
buffer_load_dwordx4 v27, s[8:11], s63 offen offset:0 lds
buffer_load_dwordx4 v28, s[8:11], s63 offen offset:1024 lds
buffer_load_dwordx4 v29, s[8:11], s63 offen offset:2048 lds
s_addk_i32 m0, 3072
s_add_u32 s63, s63, 61440
buffer_load_dwordx4 v24, s[8:11], s63 offen offset:0 lds
buffer_load_dwordx4 v25, s[8:11], s63 offen offset:1024 lds
buffer_load_dwordx4 v26, s[8:11], s63 offen offset:2048 lds
s_addk_i32 m0, 3072
s_nop 0
buffer_load_dwordx4 v27, s[8:11], s63 offen offset:0 lds
buffer_load_dwordx4 v28, s[8:11], s63 offen offset:1024 lds
buffer_load_dwordx4 v29, s[8:11], s63 offen offset:2048 lds
s_addk_i32 m0, 3072
s_add_u32 s63, s63, 61440
buffer_load_dwordx4 v24, s[8:11], s63 offen offset:0 lds
buffer_load_dwordx4 v25, s[8:11], s63 offen offset:1024 lds
buffer_load_dwordx4 v26, s[8:11], s63 offen offset:2048 lds
s_addk_i32 m0, 3072
s_nop 0
buffer_load_dwordx4 v27, s[8:11], s63 offen offset:0 lds
buffer_load_dwordx4 v28, s[8:11], s63 offen offset:1024 lds
buffer_load_dwordx4 v29, s[8:11], s63 offen offset:2048 lds
s_mov_b32 s0, s65
s_mov_b32 s65, s61
s_cmp_eq_u32 s57, s42
s_waitcnt vmcnt(24) lgkmcnt(0)
s_barrier
s_cbranch_scc0 L_wc
s_call_b64 s[100:101], L_xcap
L_wc:
s_add_u32 s42, s42, 1
s_cmp_lt_u32 s42, 9
s_cbranch_scc1 L_wl
s_branch L_h8
L_pad_21:
s_setpc_b64 s[100:101]
L_c23:
ds_read_b64 v[96:97], v202 offset:0
ds_read_b64 v[98:99], v202 offset:1152
ds_read_b64 v[116:117], v206 offset:0
ds_read_b64 v[118:119], v207 offset:0
ds_read_b64 v[100:101], v203 offset:0
ds_read_b64 v[102:103], v203 offset:1152
ds_read_b64 v[120:121], v208 offset:0
ds_read_b64 v[122:123], v209 offset:0
ds_read_b64 v[104:105], v201 offset:0
ds_read_b64 v[106:107], v201 offset:1152
ds_read_b64 v[124:125], v210 offset:0
ds_read_b64 v[126:127], v211 offset:0
s_add_u32 s0, s37, 1
s_sub_u32 s1, 5, s37
s_min_u32 s0, s0, s1
s_lshl_b32 s0, s0, 4
s_sub_u32 s1, 64, s0
s_cmp_le_u32 s37, 2
s_cselect_b32 s1, s1, 16
s_bfm_b64 s[100:101], s0, s1
s_waitcnt lgkmcnt(8)
v_mfma_f32_16x16x32_bf16 v[152:155], v[96:99], v[116:119], 0
s_waitcnt lgkmcnt(4)
v_mfma_f32_16x16x32_bf16 v[156:159], v[100:103], v[120:123], 0
s_waitcnt lgkmcnt(0)
v_mfma_f32_16x16x32_bf16 v[152:155], v[104:107], v[124:127], v[152:155]
v_add_u32 v1, 128, v222
v_cndmask_b32 v2, v1, v222, s[44:45]
ds_read_b64 v[168:169], v2 offset:0
v_cndmask_b32 v2, v1, v222, s[46:47]
ds_read_b64 v[170:171], v2 offset:32
v_cndmask_b32 v2, v1, v222, s[48:49]
ds_read_b64 v[172:173], v2 offset:64
v_cndmask_b32 v2, v1, v222, s[50:51]
ds_read_b64 v[174:175], v2 offset:96
ds_read_b32 v5, v223
v_permlane16_swap_b32 v152, v156
v_permlane16_swap_b32 v153, v157
v_permlane16_swap_b32 v154, v158
v_permlane16_swap_b32 v155, v159
v_cndmask_b32 v2, v156, v152, s[44:45]
v_cndmask_b32 v3, v157, v153, s[46:47]
v_cndmask_b32 v194, v158, v154, s[48:49]
v_cndmask_b32 v195, v159, v155, s[50:51]
v_or_b32 v192, 0xffff, v2
v_perm_b32 v193, v3, v2, s55
s_cmp_eq_u32 s41, 1
s_cbranch_scc0 L_gl_22g
buffer_store_dwordx4 v[192:195], v224, s[20:23], s54 offen
L_gl_22b:
v_mov_b32 v184, 0
v_mov_b32 v185, 0
v_mov_b32 v186, 0
v_mov_b32 v187, 0
v_mov_b32 v188, 0
v_mov_b32 v189, 0
v_mov_b32 v190, 0
v_mov_b32 v191, 0
ds_read_b64_tr_b16 v[72:73], v217 offset:0
ds_read_b64_tr_b16 v[74:75], v217 offset:1152
ds_read_b64_tr_b16 v[76:77], v218 offset:0
ds_read_b64_tr_b16 v[78:79], v218 offset:1152
s_waitcnt lgkmcnt(0)
v_mul_f32 v5, 0x3ea52b5c, v5
buffer_load_dwordx4 v[92:95], v225, s[20:23], s54 offen sc1
s_waitcnt vmcnt(0)
v_cmp_eq_u32 vcc, -1, v92
s_cbranch_vccnz L_h0rl
L_h0gl:
s_lshl_b32 s0, s32, 2
s_add_u32 s0, s0, 1744
v_mov_b32 v1, s0
ds_write_b32 v1, v1
v_perm_b32 v92, v92, v93, s56
v_add_f32 v193, v3, v93
v_add_f32 v194, v194, v94
v_add_f32 v195, v195, v95
v_add_f32 v192, v2, v92
v_fma_f32 v192, v192, v168, v169
v_fma_f32 v193, v193, v170, v171
v_fma_f32 v194, v194, v172, v173
v_fma_f32 v195, v195, v174, v175
v_max3_f32 v6, v192, v193, v194
v_max_f32 v6, v6, v195
v_mov_b32 v7, v6
s_nop 1
v_permlane32_swap_b32 v6, v7
v_max_f32 v6, v6, v7
v_mul_f32 v6, v6, v5
v_fma_f32 v192, v192, v5, -v6
v_fma_f32 v193, v193, v5, -v6
v_fma_f32 v194, v194, v5, -v6
v_fma_f32 v195, v195, v5, -v6
v_exp_f32 v192, v192
v_exp_f32 v193, v193
v_exp_f32 v194, v194
v_exp_f32 v195, v195
v_add_f32 v6, v192, v193
v_add_f32 v7, v194, v195
v_add_f32 v6, v6, v7
v_mov_b32 v7, v6
v_mul_f32 v192, v192, v168
v_mul_f32 v193, v193, v170
v_permlane32_swap_b32 v6, v7
v_mul_f32 v194, v194, v172
v_add_f32 v6, v6, v7
v_rcp_f32 v6, v6
v_mul_f32 v195, v195, v174
v_mul_f32 v192, v192, v6
v_mul_f32 v193, v193, v6
v_mul_f32 v194, v194, v6
v_mul_f32 v195, v195, v6
v_cvt_pk_bf16_f32 v192, v192, v193
v_cvt_pk_bf16_f32 v193, v194, v195
s_mov_b64 exec, s[52:53]
v_and_b32 v184, v220, v192
v_bfi_b32 v188, v220, 0, v192
v_and_b32 v185, v221, v193
v_bfi_b32 v189, v221, 0, v193
s_not_b64 exec, exec
v_and_b32 v186, v220, v192
v_bfi_b32 v190, v220, 0, v192
v_and_b32 v187, v221, v193
v_bfi_b32 v191, v221, 0, v193
s_mov_b64 exec, -1
v_permlane16_swap_b32 v184, v188
v_permlane16_swap_b32 v185, v189
v_permlane16_swap_b32 v186, v190
v_permlane16_swap_b32 v187, v191
s_nop 1
v_mfma_f32_16x16x32_bf16 v[152:155], v[72:75], v[184:187], 0
v_mfma_f32_16x16x32_bf16 v[156:159], v[76:79], v[184:187], 0
v_mfma_f32_16x16x32_bf16 v[160:163], v[76:79], v[188:191], 0
s_mov_b32 exec_lo, 0xffff0000
s_nop 4
v_cvt_pk_bf16_f32 v80, v152, v153
v_cvt_pk_bf16_f32 v81, v154, v155
v_cvt_pk_bf16_f32 v82, v156, v157
v_cvt_pk_bf16_f32 v83, v158, v159
s_mov_b64 exec, s[100:101]
v_cvt_pk_bf16_f32 v82, v160, v161
v_cvt_pk_bf16_f32 v83, v162, v163
s_mov_b32 exec_lo, 0xffff0000
s_mov_b32 exec_hi, 0xffffffff
s_cmp_eq_u32 s41, 1
s_cbranch_scc0 L_gl_23g
buffer_store_dwordx4 v[80:83], v226, s[20:23], s54 offen
L_gl_23b:
s_endpgm
L_pad_24:
s_setpc_b64 s[100:101]
L_gl_22g:
buffer_store_dwordx4 v[192:195], v224, s[20:23], s54 offen sc1
s_branch L_gl_22b
L_h0rl:
s_sub_u32 s40, s40, 1
s_cbranch_scc1 L_h0xl
buffer_load_dwordx4 v[92:95], v225, s[20:23], s54 offen sc1
s_waitcnt vmcnt(0)
v_cmp_eq_u32 vcc, -1, v92
s_cbranch_vccnz L_h0rl
s_branch L_h0gl
L_h0xl:
s_mov_b32 s40, 0
s_branch L_h0gl
L_gl_23g:
buffer_store_dwordx4 v[80:83], v226, s[20:23], s54 offen sc1
s_branch L_gl_23b
.p2align 12
L_pb_16:
L_cons:
v_and_b32 v1, 15, v0
v_lshrrev_b32 v2, 4, v0
v_mov_b32 v7, 1792
s_mul_i32 s0, s44, 2304
s_movk_i32 s1, 144
v_bfe_u32 v3, v0, 2, 1
v_and_b32 v4, 3, v0
v_lshlrev_b32 v4, 1, v4
v_lshl_add_u32 v3, v3, 3, v4
v_bfe_u32 v4, v0, 3, 1
v_add_u32 v3, v3, v4
s_add_u32 s3, s0, 17408
v_mov_b32 v4, s3
v_mad_u32_u24 v3, v3, s1, v4
s_add_u32 s3, s0, 4736
v_mov_b32 v4, s3
v_mad_u32_u24 v4, v1, s1, v4
s_mov_b32 s52, 0xff00ff
s_mov_b32 s53, 0xff00ff
v_add_u32 v5, s51, v2
v_lshl_add_u32 v200, v5, 3, v3
v_lshl_add_u32 v5, v5, 3, v4
v_cndmask_b32 v204, v7, v5, s[52:53]
v_cndmask_b32 v205, v5, v7, s[52:53]
v_add_u32 v5, s46, v2
v_lshl_add_u32 v202, v5, 3, v3
v_lshl_add_u32 v5, v5, 3, v4
v_cmp_gt_u32 vcc, s47, v2
s_nop 1
v_cndmask_b32 v5, v7, v5, vcc
v_cndmask_b32 v206, v7, v5, s[52:53]
v_cndmask_b32 v207, v5, v7, s[52:53]
v_add_u32 v5, s48, v2
v_min_u32 v5, 15, v5
v_lshl_add_u32 v203, v5, 3, v3
v_lshl_add_u32 v5, v5, 3, v4
v_cmp_gt_u32 vcc, s49, v2
s_nop 1
v_cndmask_b32 v5, v7, v5, vcc
v_cndmask_b32 v208, v7, v5, s[52:53]
v_cndmask_b32 v209, v5, v7, s[52:53]
s_sub_u32 s3, s51, 1
v_mad_u32_u24 v5, v2, 5, s3
s_add_u32 s3, s46, 4
v_mov_b32 v6, s3
s_mov_b64 vcc, 0xffff
v_cndmask_b32 v5, v5, v6, vcc
v_min_u32 v5, 15, v5
v_lshl_add_u32 v201, v5, 3, v3
v_lshl_add_u32 v5, v5, 3, v4
s_cmp_eq_u32 s47, 5
s_cselect_b64 vcc, 0xff, 0
v_cndmask_b32 v210, v7, v5, vcc
s_lshl_b64 vcc, vcc, 8
v_cndmask_b32 v211, v7, v5, vcc
s_bfm_b64 vcc, 8, 16
v_cndmask_b32 v212, v7, v5, vcc
s_bfm_b64 vcc, 8, 24
v_cndmask_b32 v213, v7, v5, vcc
s_bfm_b64 vcc, 8, 32
v_cndmask_b32 v214, v7, v5, vcc
s_bfm_b64 vcc, 8, 40
v_cndmask_b32 v215, v7, v5, vcc
s_mul_i32 s0, s44, 2304
s_movk_i32 s1, 144
v_bfe_u32 v3, v0, 2, 3
v_lshrrev_b32 v4, 5, v0
v_lshl_add_u32 v3, v3, 1, v4
s_add_u32 s3, s0, 31232
v_mov_b32 v4, s3
v_mad_u32_u24 v3, v3, s1, v4
v_and_b32 v4, 3, v0
s_mov_b32 s54, 0x11111111
s_mov_b32 s55, 0x11111111
v_add_u32 v5, s51, v4
v_lshl_add_u32 v216, v5, 3, v3
v_add_u32 v7, 32, v216
s_cmp_eq_u32 s50, 1
s_cselect_b32 s3, -1, 12
s_cselect_b32 s56, 2, -1
v_add_u32 v5, s3, v4
v_lshl_add_u32 v5, v5, 3, v3
v_cndmask_b32 v217, v5, v7, s[54:55]
v_add_u32 v7, 40, v7
v_add_u32 v5, s56, v4
v_add_u32 v6, 10, v5
v_cmp_gt_i32 vcc, s51, v5
s_nop 1
v_cndmask_b32 v5, v6, v5, vcc
v_lshl_add_u32 v5, v5, 3, v3
v_cndmask_b32 v218, v5, v7, s[54:55]
s_lshl_b32 s0, s44, 8
v_lshrrev_b32 v4, 5, v0
v_and_or_b32 v3, v0, 8, v4
s_add_u32 s3, s0, 8
v_lshl_add_u32 v222, v3, 4, s3
v_and_b32 v1, 15, v0
s_add_u32 s3, s0, 132
v_lshl_add_u32 v223, v1, 4, s3
s_lshr_b32 s3, s39, 8
s_mul_i32 s3, s3, 52429
s_lshr_b32 s3, s3, 18
s_lshl_b32 s0, s44, 5
s_add_u32 s3, s3, s0
s_sub_u32 s3, 2047, s3
v_mad_i32_i24 v234, v1, -2, s3
v_lshrrev_b32 v2, 4, v0
v_and_or_b32 v3, v0, 8, v2
v_and_b32 v4, 0x70, v233
v_bfrev_b32 v6, 1
s_lshl_b32 s3, s44, 4
v_add_u32 v5, s3, v3
s_lshl_b32 s3, s60, 3
v_cmp_gt_u32 vcc, s3, v5
v_mul_u32_u24 v5, 2560, v5
v_add3_u32 v5, v5, v4, s39
v_cndmask_b32 v227, v6, v5, vcc
s_lshl_b32 s3, s36, 7
v_add_u32 v226, s3, v227
v_bfe_u32 v3, v0, 4, 1
v_cmp_eq_u32 s[54:55], s50, v3
s_cmp_lg_u32 s37, 0
s_cselect_b64 s[0:1], -1, s[54:55]
s_and_b64 vcc, vcc, s[0:1]
s_cmp_lg_u32 s37, 4
s_cselect_b64 s[0:1], 0, s[54:55]
s_andn2_b64 vcc, vcc, s[0:1]
v_cndmask_b32 v225, v6, v226, vcc
s_cmp_le_u32 s37, 3
s_cselect_b32 s3, 2560, 0
s_sub_u32 s3, s3, 128
v_mov_b32 v4, s3
s_cmp_ge_u32 s37, 2
s_cselect_b32 s3, 2560, 0
s_add_u32 s3, s3, 128
v_mov_b32 v5, s3
v_cndmask_b32 v4, v4, v5, s[54:55]
v_mul_u32_u24 v3, 2560, v3
v_sub_u32 v4, v4, v3
v_add_u32 v4, v4, v226
v_cndmask_b32 v224, v6, v4, vcc
v_and_b32 v1, 15, v0
v_bfrev_b32 v6, 1
v_bfe_u32 v3, v0, 4, 1
v_lshrrev_b32 v4, 5, v0
v_lshl_add_u32 v3, v3, 1, v4
s_lshl_b32 s3, s36, 7
v_lshl_add_u32 v4, v3, 4, s3
s_lshl_b32 s3, s44, 4
v_add_u32 v5, s3, v1
s_lshl_b32 s3, s60, 3
v_cmp_gt_u32 vcc, s3, v5
v_mul_u32_u24 v5, 2560, v5
v_add3_u32 v5, v5, v4, s39
v_cndmask_b32 v232, v6, v5, vcc
v_bfe_u32 v3, v0, 3, 2
v_lshlrev_b32 v3, 2, v3
v_and_or_b32 v3, v0, 3, v3
v_lshlrev_b32 v3, 3, v3
v_bfe_u32 v4, v0, 2, 2
v_lshl_add_u32 v3, v4, 7, v3
v_lshrrev_b32 v2, 4, v0
s_mov_b32 s44, 0x0
s_mov_b32 s45, 0x1010101
s_mov_b32 s46, 0x3030303
s_mov_b32 s47, 0x7070707
s_mov_b32 s48, 0xf0f0f0f
s_mov_b32 s49, 0x1f1f1f1f
s_mov_b32 s50, 0x3f3f3f3f
s_mov_b32 s51, 0x7f7f7f7f
s_movk_i32 s54, 10240
s_mov_b32 s55, 0x07060501
s_mov_b32 s56, 0x0706000c
v_mov_b32 v5, 0xffff
v_mov_b32 v6, 0xffff0000
v_cndmask_b32 v1, 0, v5, s[44:45]
v_cndmask_b32 v4, 0, v6, s[46:47]
v_or_b32 v220, v1, v4
v_cndmask_b32 v1, 0, v5, s[48:49]
v_cndmask_b32 v4, 0, v6, s[50:51]
v_or_b32 v221, v1, v4
s_lshl_b32 s3, s38, 5
v_xor_b32 v3, s3, v3
v_mul_u32_u24 v4, 3072, v2
v_add_u32 v3, v3, v4
v_add_u32 v244, 20480, v3
s_mov_b32 s42, 0
v_mov_b32 v3, 0
v_lshlrev_b32 v2, 2, v0
s_mov_b32 exec_hi, 0
ds_write_b32 v2, v3 offset:1728
ds_write_b32 v2, v3 offset:2880
s_mov_b64 exec, -1
v_and_b32 v1, 15, v0
v_lshrrev_b32 v2, 4, v0
v_lshrrev_b32 v3, 1, v1
v_xor_b32 v3, v3, v2
v_lshlrev_b32 v3, 4, v3
v_lshl_add_u32 v3, v1, 7, v3
v_add_u32 v245, 8192, v3
v_xor_b32 v246, 64, v245
v_mul_u32_u24 v3, 144, v1
v_lshl_add_u32 v3, v2, 3, v3
s_lshl_b32 s3, s38, 5
s_add_u32 s3, s3, 3584
v_add_u32 v247, s3, v3
v_lshlrev_b32 v248, 4, v1
s_cmp_eq_u32 s32, 0
s_cbranch_scc0 L_cw0
s_call_b64 s[100:101], L_pad_2
L_cw0:
s_cmp_eq_u32 s32, 1
s_cbranch_scc0 L_cw1
s_call_b64 s[100:101], L_pad_15
L_cw1:
s_cmp_eq_u32 s32, 2
s_cbranch_scc0 L_cw2
s_call_b64 s[100:101], L_pad_18
L_cw2:
s_cmp_eq_u32 s32, 3
s_cbranch_scc0 L_cw3
L_cw3:
s_cmp_eq_u32 s69, 9
s_cselect_b32 s3, -2457600, 0
s_add_u32 s3, s3, 245760
v_add_u32 v254, s3, v254
s_mul_i32 s3, s38, 3072
s_add_u32 m0, s3, 57344
s_mov_b32 s0, 122880
buffer_load_dwordx4 v254, s[8:11], 0 offen offset:0 lds
s_addk_i32 m0, -256
s_nop 0
buffer_load_dwordx4 v254, s[8:11], 0 offen offset:1280 lds
s_addk_i32 m0, -256
s_nop 0
buffer_load_dwordx4 v254, s[8:11], 0 offen offset:2560 lds
s_addk_i32 m0, 12800
s_nop 0
buffer_load_dwordx4 v254, s[8:11], s0 offen offset:0 lds
s_addk_i32 m0, -256
s_nop 0
buffer_load_dwordx4 v254, s[8:11], s0 offen offset:1280 lds
s_addk_i32 m0, -256
s_nop 0
buffer_load_dwordx4 v254, s[8:11], s0 offen offset:2560 lds
v_mov_b32 v4, -1
v_mov_b32 v5, -1
v_mov_b32 v6, -1
v_mov_b32 v7, -1
v_lshrrev_b32 v1, 3, v0
v_mul_u32_u24 v1, 2560, v1
v_and_b32 v2, 0x70, v233
s_lshl_b32 s3, s36, 7
s_add_u32 s3, s3, s39
v_add3_u32 v1, v1, v2, s3
s_mul_i32 s0, s38, 20480
s_add_u32 s1, s0, 81920
s_add_u32 s3, s38, 8
s_cmp_lt_u32 s3, s60
s_cselect_b32 s3, s1, 0x80000000
s_add_u32 s3, s3, 81920
buffer_store_dwordx4 v[4:7], v1, s[20:23], s0 offen
buffer_store_dwordx4 v[4:7], v1, s[20:23], s1 offen
buffer_store_dwordx4 v[4:7], v1, s[20:23], s3 offen
v_lshrrev_b32 v1, 4, v0
v_mul_u32_u24 v1, 2304, v1
v_add_u32 v1, v1, v233
s_mul_i32 s1, s43, 15360
s_lshl_b32 s3, s36, 8
s_add_u32 s1, s1, s3
s_and_b32 s3, s38, 1
s_mul_i32 s3, s3, 7680
s_add_u32 s1, s1, s3
s_add_u32 s1, s1, 2097152
s_cmp_lt_u32 s38, 2
s_cselect_b32 s1, s1, 0x80000000
s_mov_b32 exec_hi, 0xffff
buffer_store_dwordx4 v[4:7], v1, s[16:19], s1 offen
s_mov_b64 exec, -1
s_cmp_lt_u32 s32, 2
s_cselect_b32 s57, s57, 99
s_mov_b32 s65, 8192
s_min_u32 s62, s57, 1
s_waitcnt vmcnt(10) lgkmcnt(0)
s_barrier
ds_read_b64_tr_b16 v[156:157], v244 offset:1024
ds_read_b64_tr_b16 v[158:159], v244 offset:1536
ds_read_b128 v[80:83], v245 offset:0
ds_read_b128 v[84:87], v245 offset:2048
ds_read_b128 v[88:91], v245 offset:4096
ds_read_b128 v[92:95], v245 offset:6144
ds_read_b128 v[96:99], v245 offset:8192
ds_read_b128 v[100:103], v245 offset:10240
ds_read_b64_tr_b16 v[160:161], v244 offset:2048
ds_read_b64_tr_b16 v[162:163], v244 offset:2560
ds_read_b64_tr_b16 v[152:153], v244 offset:0
ds_read_b64_tr_b16 v[154:155], v244 offset:512
s_waitcnt lgkmcnt(4)
v_mfma_f32_16x16x32_bf16 v[32:35], v[156:159], v[80:83], 0
ds_read_b64_tr_b16 v[168:169], v244 offset:13312
v_mfma_f32_16x16x32_bf16 v[36:39], v[156:159], v[84:87], 0
ds_read_b64_tr_b16 v[170:171], v244 offset:13824
v_mfma_f32_16x16x32_bf16 v[40:43], v[156:159], v[88:91], 0
ds_read_b128 v[104:107], v246 offset:0
v_mfma_f32_16x16x32_bf16 v[44:47], v[156:159], v[92:95], 0
ds_read_b128 v[108:111], v246 offset:2048
v_mfma_f32_16x16x32_bf16 v[48:51], v[156:159], v[96:99], 0
ds_read_b128 v[112:115], v246 offset:4096
v_mfma_f32_16x16x32_bf16 v[52:55], v[156:159], v[100:103], 0
ds_read_b128 v[116:119], v246 offset:6144
s_waitcnt lgkmcnt(8)
v_mfma_f32_16x16x32_bf16 v[56:59], v[160:163], v[80:83], 0
ds_read_b128 v[120:123], v246 offset:8192
v_mfma_f32_16x16x32_bf16 v[60:63], v[160:163], v[84:87], 0
ds_read_b128 v[124:127], v246 offset:10240
v_mfma_f32_16x16x32_bf16 v[64:67], v[160:163], v[88:91], 0
ds_read_b64_tr_b16 v[172:173], v244 offset:14336
v_mfma_f32_16x16x32_bf16 v[68:71], v[160:163], v[92:95], 0
ds_read_b64_tr_b16 v[174:175], v244 offset:14848
v_mfma_f32_16x16x32_bf16 v[72:75], v[160:163], v[96:99], 0
ds_read_b64_tr_b16 v[164:165], v244 offset:12288
v_mfma_f32_16x16x32_bf16 v[76:79], v[160:163], v[100:103], 0
ds_read_b64_tr_b16 v[166:167], v244 offset:12800
s_waitcnt lgkmcnt(12)
v_mfma_f32_16x16x32_bf16 v[8:11], v[152:155], v[80:83], 0
s_add_u32 s3, s65, 36864
s_cmp_eq_u32 s3, 155648
v_mfma_f32_16x16x32_bf16 v[12:15], v[152:155], v[84:87], 0
s_cselect_b32 s3, 8192, s3
s_sub_u32 s63, s3, s65
v_mfma_f32_16x16x32_bf16 v[16:19], v[152:155], v[88:91], 0
s_mov_b32 s65, s3
v_add_u32 v245, s63, v245
v_mfma_f32_16x16x32_bf16 v[20:23], v[152:155], v[92:95], 0
v_add_u32 v244, s63, v244
v_add_u32 v246, s63, v246
v_mfma_f32_16x16x32_bf16 v[24:27], v[152:155], v[96:99], 0
v_mfma_f32_16x16x32_bf16 v[28:31], v[152:155], v[100:103], 0
s_add_u32 s42, s42, 1
s_cmp_lt_u32 s42, 9
s_waitcnt lgkmcnt(4)
v_mfma_f32_16x16x32_bf16 v[32:35], v[168:171], v[104:107], v[32:35]
v_mfma_f32_16x16x32_bf16 v[36:39], v[168:171], v[108:111], v[36:39]
v_mfma_f32_16x16x32_bf16 v[40:43], v[168:171], v[112:115], v[40:43]
v_mfma_f32_16x16x32_bf16 v[44:47], v[168:171], v[116:119], v[44:47]
v_mfma_f32_16x16x32_bf16 v[48:51], v[168:171], v[120:123], v[48:51]
v_mfma_f32_16x16x32_bf16 v[52:55], v[168:171], v[124:127], v[52:55]
s_waitcnt lgkmcnt(2)
v_mfma_f32_16x16x32_bf16 v[56:59], v[172:175], v[104:107], v[56:59]
v_mfma_f32_16x16x32_bf16 v[60:63], v[172:175], v[108:111], v[60:63]
v_mfma_f32_16x16x32_bf16 v[64:67], v[172:175], v[112:115], v[64:67]
v_mfma_f32_16x16x32_bf16 v[68:71], v[172:175], v[116:119], v[68:71]
v_mfma_f32_16x16x32_bf16 v[72:75], v[172:175], v[120:123], v[72:75]
s_waitcnt vmcnt(4) lgkmcnt(0)
v_mfma_f32_16x16x32_bf16 v[76:79], v[172:175], v[124:127], v[76:79]
s_branch L_pb_17
L_pad_25:
s_setpc_b64 s[100:101]
L_ev:
s_cmp_eq_u32 s42, 1
s_cbranch_scc0 L_ev1
s_waitcnt vmcnt(0)
L_ev1:
s_max_u32 s62, s57, 1
s_cmp_eq_u32 s42, s57
s_cbranch_scc0 L_evb
s_sub_u32 s0, s65, s63
v_add_u32 v1, s0, v235
ds_read_b64 v[236:237], v1
v_xor_b32 v2, 32, v1
ds_read_b64 v[238:239], v2
v_xor_b32 v3, 64, v1
ds_read_b64 v[240:241], v3
v_xor_b32 v4, 96, v1
ds_read_b64 v[242:243], v4
s_branch L_evb
L_gs:
v_mov_b32 v4, -1
v_mov_b32 v5, -1
v_mov_b32 v6, -1
v_mov_b32 v7, -1
v_lshrrev_b32 v1, 3, v0
v_mul_u32_u24 v1, 2560, v1
v_and_b32 v2, 0x70, v233
s_lshl_b32 s3, s36, 7
s_add_u32 s3, s3, s39
v_add3_u32 v1, v1, v2, s3
s_mul_i32 s0, s38, 20480
s_add_u32 s1, s0, 81920
s_add_u32 s3, s38, 8
s_cmp_lt_u32 s3, s60
s_cselect_b32 s3, s1, 0x80000000
s_add_u32 s3, s3, 81920
buffer_store_dwordx4 v[4:7], v1, s[20:23], s0 offen sc1
buffer_store_dwordx4 v[4:7], v1, s[20:23], s1 offen sc1
buffer_store_dwordx4 v[4:7], v1, s[20:23], s3 offen sc1
v_lshrrev_b32 v1, 4, v0
v_mul_u32_u24 v1, 2304, v1
v_add_u32 v1, v1, v233
s_mul_i32 s1, s43, 15360
s_lshl_b32 s3, s36, 8
s_add_u32 s1, s1, s3
s_and_b32 s3, s38, 1
s_mul_i32 s3, s3, 7680
s_add_u32 s1, s1, s3
s_add_u32 s1, s1, 2097152
s_cmp_lt_u32 s38, 2
s_cselect_b32 s1, s1, 0x80000000
s_mov_b32 exec_hi, 0xffff
buffer_store_dwordx4 v[4:7], v1, s[16:19], s1 offen sc1
s_mov_b64 exec, -1
s_waitcnt vmcnt(0)
s_barrier
s_barrier
s_branch L_gsb
.p2align 12
L_pad_18:
s_setpc_b64 s[100:101]
L_pb_17:
L_cloop:
s_barrier
ds_read_b64_tr_b16 v[156:157], v244 offset:1024
ds_read_b64_tr_b16 v[158:159], v244 offset:1536
v_mfma_f32_16x16x32_bf16 v[8:11], v[164:167], v[104:107], v[8:11]
ds_read_b128 v[80:83], v245 offset:0
v_mfma_f32_16x16x32_bf16 v[12:15], v[164:167], v[108:111], v[12:15]
ds_read_b128 v[84:87], v245 offset:2048
v_mfma_f32_16x16x32_bf16 v[16:19], v[164:167], v[112:115], v[16:19]
ds_read_b128 v[88:91], v245 offset:4096
v_mfma_f32_16x16x32_bf16 v[20:23], v[164:167], v[116:119], v[20:23]
ds_read_b128 v[92:95], v245 offset:6144
v_mfma_f32_16x16x32_bf16 v[24:27], v[164:167], v[120:123], v[24:27]
ds_read_b128 v[96:99], v245 offset:8192
v_mfma_f32_16x16x32_bf16 v[28:31], v[164:167], v[124:127], v[28:31]
ds_read_b128 v[100:103], v245 offset:10240
s_waitcnt lgkmcnt(5)
v_mfma_f32_16x16x32_bf16 v[32:35], v[156:159], v[80:83], v[32:35]
ds_read_b64_tr_b16 v[160:161], v244 offset:2048
s_waitcnt lgkmcnt(5)
v_mfma_f32_16x16x32_bf16 v[36:39], v[156:159], v[84:87], v[36:39]
ds_read_b64_tr_b16 v[162:163], v244 offset:2560
s_waitcnt lgkmcnt(5)
v_mfma_f32_16x16x32_bf16 v[40:43], v[156:159], v[88:91], v[40:43]
ds_read_b64_tr_b16 v[152:153], v244 offset:0
s_waitcnt lgkmcnt(5)
v_mfma_f32_16x16x32_bf16 v[44:47], v[156:159], v[92:95], v[44:47]
ds_read_b64_tr_b16 v[154:155], v244 offset:512
s_waitcnt lgkmcnt(5)
v_mfma_f32_16x16x32_bf16 v[48:51], v[156:159], v[96:99], v[48:51]
ds_read_b64_tr_b16 v[168:169], v244 offset:13312
s_waitcnt lgkmcnt(5)
v_mfma_f32_16x16x32_bf16 v[52:55], v[156:159], v[100:103], v[52:55]
ds_read_b64_tr_b16 v[170:171], v244 offset:13824
s_waitcnt lgkmcnt(4)
v_mfma_f32_16x16x32_bf16 v[56:59], v[160:163], v[80:83], v[56:59]
ds_read_b128 v[104:107], v246 offset:0
v_mfma_f32_16x16x32_bf16 v[60:63], v[160:163], v[84:87], v[60:63]
ds_read_b128 v[108:111], v246 offset:2048
v_mfma_f32_16x16x32_bf16 v[64:67], v[160:163], v[88:91], v[64:67]
ds_read_b128 v[112:115], v246 offset:4096
v_mfma_f32_16x16x32_bf16 v[68:71], v[160:163], v[92:95], v[68:71]
ds_read_b128 v[116:119], v246 offset:6144
v_mfma_f32_16x16x32_bf16 v[72:75], v[160:163], v[96:99], v[72:75]
ds_read_b128 v[120:123], v246 offset:8192
v_mfma_f32_16x16x32_bf16 v[76:79], v[160:163], v[100:103], v[76:79]
ds_read_b128 v[124:127], v246 offset:10240
s_waitcnt lgkmcnt(8)
v_mfma_f32_16x16x32_bf16 v[8:11], v[152:155], v[80:83], v[8:11]
ds_read_b64_tr_b16 v[172:173], v244 offset:14336
v_mfma_f32_16x16x32_bf16 v[12:15], v[152:155], v[84:87], v[12:15]
ds_read_b64_tr_b16 v[174:175], v244 offset:14848
v_mfma_f32_16x16x32_bf16 v[16:19], v[152:155], v[88:91], v[16:19]
ds_read_b64_tr_b16 v[164:165], v244 offset:12288
v_mfma_f32_16x16x32_bf16 v[20:23], v[152:155], v[92:95], v[20:23]
ds_read_b64_tr_b16 v[166:167], v244 offset:12800
v_mfma_f32_16x16x32_bf16 v[24:27], v[152:155], v[96:99], v[24:27]
s_add_u32 s3, s65, 36864
s_cmp_eq_u32 s3, 155648
v_mfma_f32_16x16x32_bf16 v[28:31], v[152:155], v[100:103], v[28:31]
s_cselect_b32 s3, 8192, s3
s_sub_u32 s63, s3, s65
s_waitcnt lgkmcnt(4)
v_mfma_f32_16x16x32_bf16 v[32:35], v[168:171], v[104:107], v[32:35]
s_mov_b32 s65, s3
v_add_u32 v245, s63, v245
v_mfma_f32_16x16x32_bf16 v[36:39], v[168:171], v[108:111], v[36:39]
v_add_u32 v244, s63, v244
v_add_u32 v246, s63, v246
v_mfma_f32_16x16x32_bf16 v[40:43], v[168:171], v[112:115], v[40:43]
s_cmp_eq_u32 s42, s62
s_cbranch_scc1 L_ev
L_evb:
v_mfma_f32_16x16x32_bf16 v[44:47], v[168:171], v[116:119], v[44:47]
v_mfma_f32_16x16x32_bf16 v[48:51], v[168:171], v[120:123], v[48:51]
s_add_u32 s42, s42, 1
s_cmp_lt_u32 s42, 9
v_mfma_f32_16x16x32_bf16 v[52:55], v[168:171], v[124:127], v[52:55]
s_waitcnt lgkmcnt(2)
v_mfma_f32_16x16x32_bf16 v[56:59], v[172:175], v[104:107], v[56:59]
v_mfma_f32_16x16x32_bf16 v[60:63], v[172:175], v[108:111], v[60:63]
v_mfma_f32_16x16x32_bf16 v[64:67], v[172:175], v[112:115], v[64:67]
v_mfma_f32_16x16x32_bf16 v[68:71], v[172:175], v[116:119], v[68:71]
v_mfma_f32_16x16x32_bf16 v[72:75], v[172:175], v[120:123], v[72:75]
s_waitcnt lgkmcnt(0)
v_mfma_f32_16x16x32_bf16 v[76:79], v[172:175], v[124:127], v[76:79]
s_cbranch_scc1 L_cloop
v_mov_b32 v1, 1728
ds_read_b32 v1, v1
ds_read2_b64 v[180:183], v248 offset0:0 offset1:32
ds_read2_b64 v[184:187], v248 offset0:64 offset1:96
ds_read2_b64 v[188:191], v248 offset0:128 offset1:160
s_waitcnt lgkmcnt(0)
v_readfirstlane_b32 s41, v1
s_barrier
s_cmp_eq_u32 s41, 1
s_cbranch_scc0 L_gs
L_gsb:
ds_read_b64_tr_b16 v[156:157], v244 offset:1024
ds_read_b64_tr_b16 v[158:159], v244 offset:1536
v_mfma_f32_16x16x32_bf16 v[8:11], v[164:167], v[104:107], v[8:11]
ds_read_b128 v[80:83], v245 offset:0
v_mfma_f32_16x16x32_bf16 v[12:15], v[164:167], v[108:111], v[12:15]
ds_read_b128 v[84:87], v245 offset:2048
v_mfma_f32_16x16x32_bf16 v[16:19], v[164:167], v[112:115], v[16:19]
ds_read_b128 v[88:91], v245 offset:4096
v_mfma_f32_16x16x32_bf16 v[20:23], v[164:167], v[116:119], v[20:23]
ds_read_b128 v[92:95], v245 offset:6144
v_mfma_f32_16x16x32_bf16 v[24:27], v[164:167], v[120:123], v[24:27]
ds_read_b128 v[96:99], v245 offset:8192
v_mfma_f32_16x16x32_bf16 v[28:31], v[164:167], v[124:127], v[28:31]
ds_read_b128 v[100:103], v245 offset:10240
ds_read_b64_tr_b16 v[176:177], v244 offset:13312
ds_read_b64_tr_b16 v[178:179], v244 offset:13824
s_waitcnt lgkmcnt(7)
v_mfma_f32_16x16x32_bf16 v[32:35], v[156:159], v[80:83], v[32:35]
ds_read_b128 v[128:131], v246 offset:0
s_waitcnt lgkmcnt(7)
v_mfma_f32_16x16x32_bf16 v[36:39], v[156:159], v[84:87], v[36:39]
ds_read_b128 v[132:135], v246 offset:2048
s_waitcnt lgkmcnt(7)
v_mfma_f32_16x16x32_bf16 v[40:43], v[156:159], v[88:91], v[40:43]
ds_read_b128 v[136:139], v246 offset:4096
s_waitcnt lgkmcnt(7)
v_mfma_f32_16x16x32_bf16 v[44:47], v[156:159], v[92:95], v[44:47]
ds_read_b128 v[140:143], v246 offset:6144
s_waitcnt lgkmcnt(7)
v_mfma_f32_16x16x32_bf16 v[48:51], v[156:159], v[96:99], v[48:51]
ds_read_b128 v[144:147], v246 offset:8192
s_waitcnt lgkmcnt(7)
v_mfma_f32_16x16x32_bf16 v[52:55], v[156:159], v[100:103], v[52:55]
ds_read_b128 v[148:151], v246 offset:10240
s_waitcnt lgkmcnt(5)
v_mfma_f32_16x16x32_bf16 v[32:35], v[176:179], v[128:131], v[32:35]
ds_read_b64_tr_b16 v[160:161], v244 offset:2048
s_waitcnt lgkmcnt(5)
v_mfma_f32_16x16x32_bf16 v[36:39], v[176:179], v[132:135], v[36:39]
ds_read_b64_tr_b16 v[162:163], v244 offset:2560
s_waitcnt lgkmcnt(5)
v_mfma_f32_16x16x32_bf16 v[40:43], v[176:179], v[136:139], v[40:43]
ds_read_b64_tr_b16 v[152:153], v244 offset:0
s_waitcnt lgkmcnt(5)
v_mfma_f32_16x16x32_bf16 v[44:47], v[176:179], v[140:143], v[44:47]
ds_read_b64_tr_b16 v[154:155], v244 offset:512
s_waitcnt lgkmcnt(5)
v_mfma_f32_16x16x32_bf16 v[48:51], v[176:179], v[144:147], v[48:51]
ds_read_b64_tr_b16 v[172:173], v244 offset:14336
s_waitcnt lgkmcnt(5)
v_mfma_f32_16x16x32_bf16 v[52:55], v[176:179], v[148:151], v[52:55]
ds_read_b64_tr_b16 v[174:175], v244 offset:14848
s_waitcnt lgkmcnt(4)
v_mfma_f32_16x16x32_bf16 v[56:59], v[160:163], v[80:83], v[56:59]
ds_read_b64_tr_b16 v[164:165], v244 offset:12288
ds_read_b64_tr_b16 v[166:167], v244 offset:12800
v_mov_b32_dpp v192, v32 row_newbcast:0 row_mask:0xf bank_mask:0xf
v_mov_b32_dpp v193, v33 row_newbcast:0 row_mask:0xf bank_mask:0xf
v_mov_b32_dpp v194, v34 row_newbcast:0 row_mask:0xf bank_mask:0xf
v_mov_b32_dpp v195, v35 row_newbcast:0 row_mask:0xf bank_mask:0xf
v_fmac_f32 v32, v192, v180
v_fmac_f32 v33, v193, v180
v_fmac_f32 v34, v194, v180
v_mfma_f32_16x16x32_bf16 v[60:63], v[160:163], v[84:87], v[60:63]
v_fmac_f32 v35, v195, v180
v_cvt_pk_bf16_f32 v32, v32, v33
v_cvt_pk_bf16_f32 v33, v34, v35
v_mfma_f32_16x16x32_bf16 v[64:67], v[160:163], v[88:91], v[64:67]
ds_write_b64 v247, v[32:33] offset:13824
v_fmac_f32 v36, v192, v182
v_fmac_f32 v37, v193, v182
v_fmac_f32 v38, v194, v182
v_mfma_f32_16x16x32_bf16 v[68:71], v[160:163], v[92:95], v[68:71]
v_fmac_f32 v39, v195, v182
v_cvt_pk_bf16_f32 v36, v36, v37
v_cvt_pk_bf16_f32 v37, v38, v39
v_mfma_f32_16x16x32_bf16 v[72:75], v[160:163], v[96:99], v[72:75]
ds_write_b64 v247, v[36:37] offset:16128
v_fmac_f32 v40, v192, v184
v_fmac_f32 v41, v193, v184
v_fmac_f32 v42, v194, v184
v_mfma_f32_16x16x32_bf16 v[76:79], v[160:163], v[100:103], v[76:79]
v_fmac_f32 v43, v195, v184
v_cvt_pk_bf16_f32 v40, v40, v41
v_cvt_pk_bf16_f32 v41, v42, v43
s_waitcnt lgkmcnt(4)
v_mfma_f32_16x16x32_bf16 v[56:59], v[172:175], v[128:131], v[56:59]
ds_write_b64 v247, v[40:41] offset:18432
v_fmac_f32 v44, v192, v186
v_fmac_f32 v45, v193, v186
v_fmac_f32 v46, v194, v186
v_mfma_f32_16x16x32_bf16 v[60:63], v[172:175], v[132:135], v[60:63]
v_fmac_f32 v47, v195, v186
v_cvt_pk_bf16_f32 v44, v44, v45
v_cvt_pk_bf16_f32 v45, v46, v47
v_mfma_f32_16x16x32_bf16 v[64:67], v[172:175], v[136:139], v[64:67]
ds_write_b64 v247, v[44:45] offset:20736
v_fmac_f32 v48, v192, v188
v_fmac_f32 v49, v193, v188
v_fmac_f32 v50, v194, v188
v_mfma_f32_16x16x32_bf16 v[68:71], v[172:175], v[140:143], v[68:71]
v_fmac_f32 v51, v195, v188
v_cvt_pk_bf16_f32 v48, v48, v49
v_cvt_pk_bf16_f32 v49, v50, v51
v_mfma_f32_16x16x32_bf16 v[72:75], v[172:175], v[144:147], v[72:75]
ds_write_b64 v247, v[48:49] offset:23040
v_fmac_f32 v52, v192, v190
v_fmac_f32 v53, v193, v190
v_fmac_f32 v54, v194, v190
v_mfma_f32_16x16x32_bf16 v[76:79], v[172:175], v[148:151], v[76:79]
v_fmac_f32 v55, v195, v190
v_cvt_pk_bf16_f32 v52, v52, v53
v_cvt_pk_bf16_f32 v53, v54, v55
ds_write_b64 v247, v[52:53] offset:25344
v_mfma_f32_16x16x32_bf16 v[8:11], v[152:155], v[80:83], v[8:11]
v_mov_b32_dpp v192, v56 row_newbcast:0 row_mask:0xf bank_mask:0xf
v_mov_b32_dpp v193, v57 row_newbcast:0 row_mask:0xf bank_mask:0xf
v_mov_b32_dpp v194, v58 row_newbcast:0 row_mask:0xf bank_mask:0xf
v_mov_b32_dpp v195, v59 row_newbcast:0 row_mask:0xf bank_mask:0xf
v_fmac_f32 v56, v192, v180
v_fmac_f32 v57, v193, v180
v_fmac_f32 v58, v194, v180
v_mfma_f32_16x16x32_bf16 v[12:15], v[152:155], v[84:87], v[12:15]
v_fmac_f32 v59, v195, v180
v_cvt_pk_bf16_f32 v56, v56, v57
v_cvt_pk_bf16_f32 v57, v58, v59
v_mfma_f32_16x16x32_bf16 v[16:19], v[152:155], v[88:91], v[16:19]
s_waitcnt lgkmcnt(0)
s_barrier
ds_write_b64 v247, v[56:57] offset:27648
v_fmac_f32 v60, v192, v182
v_fmac_f32 v61, v193, v182
v_fmac_f32 v62, v194, v182
v_mfma_f32_16x16x32_bf16 v[20:23], v[152:155], v[92:95], v[20:23]
v_fmac_f32 v63, v195, v182
v_cvt_pk_bf16_f32 v60, v60, v61
v_cvt_pk_bf16_f32 v61, v62, v63
v_mfma_f32_16x16x32_bf16 v[24:27], v[152:155], v[96:99], v[24:27]
ds_write_b64 v247, v[60:61] offset:29952
v_fmac_f32 v64, v192, v184
v_fmac_f32 v65, v193, v184
v_fmac_f32 v66, v194, v184
v_mfma_f32_16x16x32_bf16 v[28:31], v[152:155], v[100:103], v[28:31]
v_fmac_f32 v67, v195, v184
v_cvt_pk_bf16_f32 v64, v64, v65
v_cvt_pk_bf16_f32 v65, v66, v67
v_mfma_f32_16x16x32_bf16 v[8:11], v[164:167], v[128:131], v[8:11]
ds_write_b64 v247, v[64:65] offset:32256
v_fmac_f32 v68, v192, v186
v_fmac_f32 v69, v193, v186
v_fmac_f32 v70, v194, v186
v_mfma_f32_16x16x32_bf16 v[12:15], v[164:167], v[132:135], v[12:15]
v_fmac_f32 v71, v195, v186
v_cvt_pk_bf16_f32 v68, v68, v69
v_cvt_pk_bf16_f32 v69, v70, v71
v_mfma_f32_16x16x32_bf16 v[16:19], v[164:167], v[136:139], v[16:19]
ds_write_b64 v247, v[68:69] offset:34560
v_fmac_f32 v72, v192, v188
v_fmac_f32 v73, v193, v188
v_fmac_f32 v74, v194, v188
v_mfma_f32_16x16x32_bf16 v[20:23], v[164:167], v[140:143], v[20:23]
v_fmac_f32 v75, v195, v188
v_cvt_pk_bf16_f32 v72, v72, v73
v_cvt_pk_bf16_f32 v73, v74, v75
v_mfma_f32_16x16x32_bf16 v[24:27], v[164:167], v[144:147], v[24:27]
ds_write_b64 v247, v[72:73] offset:36864
v_fmac_f32 v76, v192, v190
v_fmac_f32 v77, v193, v190
v_fmac_f32 v78, v194, v190
v_mfma_f32_16x16x32_bf16 v[28:31], v[164:167], v[148:151], v[28:31]
v_fmac_f32 v79, v195, v190
v_cvt_pk_bf16_f32 v76, v76, v77
v_cvt_pk_bf16_f32 v77, v78, v79
ds_write_b64 v247, v[76:77] offset:39168
v_mov_b32_dpp v192, v8 row_newbcast:0 row_mask:0xf bank_mask:0xf
v_mov_b32_dpp v193, v9 row_newbcast:0 row_mask:0xf bank_mask:0xf
v_mov_b32_dpp v194, v10 row_newbcast:0 row_mask:0xf bank_mask:0xf
v_mov_b32_dpp v195, v11 row_newbcast:0 row_mask:0xf bank_mask:0xf
v_pk_fma_f32 v[8:9], v[192:193], v[180:181], v[8:9] op_sel_hi:[1,0,1]
v_pk_fma_f32 v[10:11], v[194:195], v[180:181], v[10:11] op_sel_hi:[1,0,1]
v_cvt_pk_bf16_f32 v8, v8, v9
v_cvt_pk_bf16_f32 v9, v10, v11
ds_write_b64 v247, v[8:9] offset:0
v_pk_fma_f32 v[12:13], v[192:193], v[182:183], v[12:13] op_sel_hi:[1,0,1]
v_pk_fma_f32 v[14:15], v[194:195], v[182:183], v[14:15] op_sel_hi:[1,0,1]
v_cvt_pk_bf16_f32 v12, v12, v13
v_cvt_pk_bf16_f32 v13, v14, v15
ds_write_b64 v247, v[12:13] offset:2304
v_pk_fma_f32 v[16:17], v[192:193], v[184:185], v[16:17] op_sel_hi:[1,0,1]
v_pk_fma_f32 v[18:19], v[194:195], v[184:185], v[18:19] op_sel_hi:[1,0,1]
v_cvt_pk_bf16_f32 v16, v16, v17
v_cvt_pk_bf16_f32 v17, v18, v19
ds_write_b64 v247, v[16:17] offset:4608
v_pk_fma_f32 v[20:21], v[192:193], v[186:187], v[20:21] op_sel_hi:[1,0,1]
v_pk_fma_f32 v[22:23], v[194:195], v[186:187], v[22:23] op_sel_hi:[1,0,1]
v_cvt_pk_bf16_f32 v20, v20, v21
v_cvt_pk_bf16_f32 v21, v22, v23
ds_write_b64 v247, v[20:21] offset:6912
v_pk_fma_f32 v[24:25], v[192:193], v[188:189], v[24:25] op_sel_hi:[1,0,1]
v_pk_fma_f32 v[26:27], v[194:195], v[188:189], v[26:27] op_sel_hi:[1,0,1]
v_cvt_pk_bf16_f32 v24, v24, v25
v_cvt_pk_bf16_f32 v25, v26, v27
ds_write_b64 v247, v[24:25] offset:9216
v_pk_fma_f32 v[28:29], v[192:193], v[190:191], v[28:29] op_sel_hi:[1,0,1]
v_pk_fma_f32 v[30:31], v[194:195], v[190:191], v[30:31] op_sel_hi:[1,0,1]
v_cvt_pk_bf16_f32 v28, v28, v29
v_cvt_pk_bf16_f32 v29, v30, v31
ds_write_b64 v247, v[28:29] offset:11520
s_waitcnt lgkmcnt(0)
s_barrier
s_cmp_lt_u32 s32, 2
s_cbranch_scc0 L_c23
ds_read_b64 v[108:109], v200 offset:0
ds_read_b64 v[110:111], v200 offset:1152
ds_read_b64 v[128:129], v204 offset:0
ds_read_b64 v[130:131], v205 offset:0
ds_read_b64 v[112:113], v200 offset:40
ds_read_b64 v[114:115], v200 offset:1192
ds_read_b64 v[132:133], v204 offset:40
ds_read_b64 v[134:135], v205 offset:40
ds_read_b64 v[104:105], v201 offset:0
ds_read_b64 v[106:107], v201 offset:1152
ds_read_b64 v[136:137], v212 offset:0
ds_read_b64 v[138:139], v213 offset:0
ds_read_b64 v[140:141], v214 offset:0
ds_read_b64 v[142:143], v215 offset:0
v_mov_b32 v176, 0
v_mov_b32 v177, 0
v_mov_b32 v178, 0
v_mov_b32 v179, 0
v_mov_b32 v180, 0
v_mov_b32 v181, 0
v_mov_b32 v182, 0
v_mov_b32 v183, 0
s_waitcnt lgkmcnt(10)
v_mfma_f32_16x16x32_bf16 v[160:163], v[108:111], v[128:131], 0
s_waitcnt lgkmcnt(6)
v_mfma_f32_16x16x32_bf16 v[164:167], v[112:115], v[132:135], 0
v_add_u32 v1, 128, v222
v_cndmask_b32 v2, v1, v222, s[44:45]
ds_read_b64 v[168:169], v2 offset:0
v_cndmask_b32 v2, v1, v222, s[46:47]
ds_read_b64 v[170:171], v2 offset:32
v_cndmask_b32 v2, v1, v222, s[48:49]
ds_read_b64 v[172:173], v2 offset:64
v_cndmask_b32 v2, v1, v222, s[50:51]
ds_read_b64 v[174:175], v2 offset:96
ds_read_b32 v5, v223
s_waitcnt lgkmcnt(7)
v_mfma_f32_16x16x32_bf16 v[160:163], v[104:107], v[136:139], v[160:163]
s_waitcnt lgkmcnt(5)
v_mfma_f32_16x16x32_bf16 v[164:167], v[104:107], v[140:143], v[164:167]
s_nop 7
v_permlane16_swap_b32 v160, v164
v_permlane16_swap_b32 v161, v165
v_permlane16_swap_b32 v162, v166
v_permlane16_swap_b32 v163, v167
v_cndmask_b32 v196, v164, v160, s[44:45]
v_cndmask_b32 v197, v165, v161, s[46:47]
v_cndmask_b32 v198, v166, v162, s[48:49]
v_cndmask_b32 v199, v167, v163, s[50:51]
s_waitcnt lgkmcnt(0)
v_mul_f32 v5, 0x3ea52b5c, v5
v_fma_f32 v196, v196, v168, v169
v_fma_f32 v197, v197, v170, v171
v_fma_f32 v198, v198, v172, v173
v_fma_f32 v199, v199, v174, v175
v_max3_f32 v6, v196, v197, v198
v_max_f32 v6, v6, v199
v_mov_b32 v7, v6
s_nop 1
v_permlane32_swap_b32 v6, v7
v_max_f32 v6, v6, v7
v_mul_f32 v6, v6, v5
v_fma_f32 v196, v196, v5, -v6
v_fma_f32 v197, v197, v5, -v6
v_fma_f32 v198, v198, v5, -v6
v_fma_f32 v199, v199, v5, -v6
v_exp_f32 v196, v196
v_exp_f32 v197, v197
v_exp_f32 v198, v198
v_exp_f32 v199, v199
ds_read_b64_tr_b16 v[64:65], v216 offset:0
ds_read_b64_tr_b16 v[66:67], v216 offset:1152
ds_read_b64_tr_b16 v[68:69], v216 offset:40
ds_read_b64_tr_b16 v[70:71], v216 offset:1192
ds_read_b64_tr_b16 v[72:73], v217 offset:0
ds_read_b64_tr_b16 v[74:75], v217 offset:1152
ds_read_b64_tr_b16 v[76:77], v218 offset:0
ds_read_b64_tr_b16 v[78:79], v218 offset:1152
v_add_f32 v6, v196, v197
v_add_f32 v7, v198, v199
v_add_f32 v6, v6, v7
v_mov_b32 v7, v6
v_mul_f32 v196, v196, v168
v_mul_f32 v197, v197, v170
v_permlane32_swap_b32 v6, v7
v_mul_f32 v198, v198, v172
v_add_f32 v6, v6, v7
v_rcp_f32 v6, v6
v_mul_f32 v199, v199, v174
v_mul_f32 v196, v196, v6
v_mul_f32 v197, v197, v6
v_mul_f32 v198, v198, v6
v_mul_f32 v199, v199, v6
v_cvt_pk_bf16_f32 v196, v196, v197
v_cvt_pk_bf16_f32 v197, v198, v199
s_mov_b64 exec, s[52:53]
v_and_b32 v176, v220, v196
v_bfi_b32 v180, v220, 0, v196
v_and_b32 v177, v221, v197
v_bfi_b32 v181, v221, 0, v197
s_not_b64 exec, exec
v_and_b32 v178, v220, v196
v_bfi_b32 v182, v220, 0, v196
v_and_b32 v179, v221, v197
v_bfi_b32 v183, v221, 0, v197
s_mov_b64 exec, -1
v_permlane16_swap_b32 v176, v180
v_permlane16_swap_b32 v177, v181
v_permlane16_swap_b32 v178, v182
v_permlane16_swap_b32 v179, v183
s_waitcnt lgkmcnt(0)
s_nop 0
v_mfma_f32_16x16x32_bf16 v[152:155], v[64:67], v[176:179], 0
v_mfma_f32_16x16x32_bf16 v[156:159], v[68:71], v[180:183], 0
v_mfma_f32_16x16x32_bf16 v[160:163], v[72:75], v[176:179], 0
v_mfma_f32_16x16x32_bf16 v[164:167], v[76:79], v[180:183], 0
s_nop 4
v_cvt_pk_bf16_f32 v196, v152, v153
v_cvt_pk_bf16_f32 v197, v154, v155
v_cvt_pk_bf16_f32 v198, v156, v157
v_cvt_pk_bf16_f32 v199, v158, v159
s_cmp_eq_u32 s41, 1
s_cbranch_scc0 L_gl_19g
buffer_store_dwordx4 v[196:199], v226, s[20:23], 0 offen
L_gl_19b:
s_lshl_b32 s0, s32, 2
s_add_u32 s0, s0, 1752
v_mov_b32 v1, s0
ds_read_b32 v1, v1
v_cvt_pk_bf16_f32 v80, v160, v161
v_cvt_pk_bf16_f32 v81, v162, v163
v_cvt_pk_bf16_f32 v82, v164, v165
v_cvt_pk_bf16_f32 v83, v166, v167
s_waitcnt lgkmcnt(0)
v_cmp_eq_u32 vcc, 0, v1
s_cbranch_vccnz L_spr
L_sbr:
s_mov_b64 exec, 0xffff
s_cmp_eq_u32 s41, 1
s_cbranch_scc0 L_gl_20g
buffer_store_dwordx4 v[80:83], v226, s[20:23], s54 offen
L_gl_20b:
s_mov_b64 exec, -1
v_lshrrev_b32 v1, 4, v0
v_lshlrev_b32 v1, 3, v1
s_lshl_b32 s3, s36, 7
buffer_load_dwordx2 v[244:245], v1, s[28:31], s3 offen offset:0
buffer_load_dwordx2 v[246:247], v1, s[28:31], s3 offen offset:32
buffer_load_dwordx2 v[248:249], v1, s[28:31], s3 offen offset:64
buffer_load_dwordx2 v[250:251], v1, s[28:31], s3 offen offset:96
v_lshlrev_b32 v8, 16, v236
v_and_b32 v9, 0xffff0000, v236
v_lshlrev_b32 v10, 16, v237
v_and_b32 v11, 0xffff0000, v237
v_lshlrev_b32 v12, 16, v238
v_and_b32 v13, 0xffff0000, v238
v_lshlrev_b32 v14, 16, v239
v_and_b32 v15, 0xffff0000, v239
v_lshlrev_b32 v16, 16, v240
v_and_b32 v17, 0xffff0000, v240
v_lshlrev_b32 v18, 16, v241
v_and_b32 v19, 0xffff0000, v241
v_lshlrev_b32 v20, 16, v242
v_and_b32 v21, 0xffff0000, v242
v_lshlrev_b32 v22, 16, v243
v_and_b32 v23, 0xffff0000, v243
s_lshl_b32 s0, s32, 13
s_add_u32 s0, s0, 57344
v_add_u32 v4, s0, v233
s_lshl_b32 s0, s32, 2
s_add_u32 s0, s0, 1760
s_waitcnt vmcnt(0)
s_mov_b32 s3, 0x3f803f80
v_mov_b32 v236, s3
v_mov_b32 v237, s3
v_mov_b32 v238, s3
v_mov_b32 v239, s3
s_mov_b32 exec_lo, 0x11111111
s_mov_b32 exec_hi, 0x11111111
v_mov_b32 v244, s3
v_mov_b32 v245, s3
v_mov_b32 v246, s3
v_mov_b32 v247, s3
v_mov_b32 v248, s3
v_mov_b32 v249, s3
v_mov_b32 v250, s3
v_mov_b32 v251, s3
s_mov_b64 exec, -1
v_mfma_f32_16x16x32_bf16 v[252:255], v[244:247], v[236:239], 0
v_mfma_f32_16x16x32_bf16 v[252:255], v[248:251], v[236:239], v[252:255]
v_mov_b32 v2, s0
L_fx:
s_sleep 1
ds_read_b32 v1, v2
s_waitcnt lgkmcnt(0)
v_cmp_ne_u32 vcc, 2, v1
s_cbranch_vccnz L_fx
s_setprio 2
ds_read_b128 v[24:27], v4 offset:0
ds_read_b128 v[28:31], v4 offset:1024
ds_read_b128 v[32:35], v4 offset:2048
ds_read_b128 v[36:39], v4 offset:3072
ds_read_b128 v[40:43], v4 offset:4096
ds_read_b128 v[44:47], v4 offset:5120
ds_read_b128 v[48:51], v4 offset:6144
ds_read_b128 v[52:55], v4 offset:7168
s_waitcnt lgkmcnt(7)
v_add_f32 v8, v8, v24
v_add_f32 v9, v9, v25
v_add_f32 v10, v10, v26
v_add_f32 v11, v11, v27
s_waitcnt lgkmcnt(6)
v_add_f32 v12, v12, v28
v_add_f32 v13, v13, v29
v_add_f32 v14, v14, v30
v_add_f32 v15, v15, v31
s_waitcnt lgkmcnt(5)
v_add_f32 v16, v16, v32
v_add_f32 v17, v17, v33
v_add_f32 v18, v18, v34
v_add_f32 v19, v19, v35
s_waitcnt lgkmcnt(4)
v_add_f32 v20, v20, v36
v_add_f32 v21, v21, v37
v_add_f32 v22, v22, v38
v_add_f32 v23, v23, v39
s_waitcnt lgkmcnt(3)
v_add_f32 v8, v8, v40
v_add_f32 v9, v9, v41
v_add_f32 v10, v10, v42
v_add_f32 v11, v11, v43
s_waitcnt lgkmcnt(2)
v_add_f32 v12, v12, v44
v_add_f32 v13, v13, v45
v_add_f32 v14, v14, v46
v_add_f32 v15, v15, v47
s_waitcnt lgkmcnt(1)
v_add_f32 v16, v16, v48
v_add_f32 v17, v17, v49
v_add_f32 v18, v18, v50
v_add_f32 v19, v19, v51
s_waitcnt lgkmcnt(0)
v_add_f32 v20, v20, v52
v_add_f32 v21, v21, v53
v_add_f32 v22, v22, v54
v_add_f32 v23, v23, v55
s_branch L_tail
L_gl_19g:
buffer_store_dwordx4 v[196:199], v226, s[20:23], 0 offen sc1
s_branch L_gl_19b
L_spr:
s_sleep 1
v_mov_b32 v1, s0
ds_read_b32 v1, v1
s_waitcnt lgkmcnt(0)
v_cmp_eq_u32 vcc, 0, v1
s_cbranch_vccnz L_spr
s_branch L_sbr
L_gl_20g:
buffer_store_dwordx4 v[80:83], v226, s[20:23], s54 offen sc1
s_branch L_gl_20b
L_moe:
s_cmp_ge_u32 s34, 32
s_cbranch_scc1 L_end
s_lshr_b32 s32, s32, 6
v_and_b32 v0, 63, v0
s_lshl_b32 s36, s33, 1
s_add_u32 s36, s36, s34
s_sub_u32 s36, s36, 30
s_mov_b32 s40, 524288
v_lshlrev_b32 v6, 4, v0
v_mov_b32 v132, 0
v_mov_b32 v133, 0
s_waitcnt lgkmcnt(0)
s_mov_b64 s[16:17], s[66:67]
s_mov_b32 s18, 0x10000000
s_mov_b32 s19, 0x20000
s_mov_b64 s[24:25], s[64:65]
s_mov_b32 s26, 0x100
s_mov_b32 s27, 0x20000
s_mov_b64 s[4:5], s[54:55]
s_mov_b32 s6, 0x1e0000
s_mov_b32 s7, 0x20000
s_mov_b64 s[8:9], s[56:57]
s_mov_b32 s10, 0x1e0000
s_mov_b32 s11, 0x20000
s_mov_b64 s[12:13], s[60:61]
s_mov_b32 s14, 0x1e0000
s_mov_b32 s15, 0x20000
s_mov_b64 s[20:21], s[62:63]
s_mov_b32 s22, 0x280000
s_mov_b32 s23, 0x20000
v_mov_b32 v8, -1
v_mov_b32 v9, -1
v_mov_b32 v10, -1
v_mov_b32 v11, -1
s_lshl_b32 s0, s36, 14
s_lshl_b32 s3, s32, 11
s_add_u32 s0, s0, s3
s_add_u32 s0, s0, 3145728
buffer_store_dwordx4 v[8:11], v6, s[16:19], s0 offen offset:0 sc1
buffer_store_dwordx4 v[8:11], v6, s[16:19], s0 offen offset:1024 sc1
s_and_b32 s44, s36, 1
s_mul_i32 s0, s33, 384
s_lshl_b32 s1, s44, 8
s_add_u32 s1, s1, s0
s_mul_i32 s3, s32, 24576
s_add_u32 s1, s1, s3
v_lshrrev_b32 v1, 3, v0
v_mul_u32_u24 v1, 3072, v1
s_lshr_b32 s3, s32, 1
v_xor_b32 v2, s3, v0
v_and_b32 v2, 7, v2
v_lshl_add_u32 v1, v2, 4, v1
v_add_u32 v4, s1, v1
v_xor_b32 v5, 64, v4
s_lshl_b32 s1, s44, 6
s_add_u32 s0, s0, s1
s_and_b32 s3, s32, 3
s_mul_i32 s1, s3, 49152
s_add_u32 s0, s0, s1
s_add_u32 s0, s0, 128
v_lshrrev_b32 v1, 2, v0
v_mul_u32_u24 v1, 3072, v1
v_xor_b32 v2, s3, v0
v_and_b32 v2, 3, v2
v_lshl_add_u32 v1, v2, 4, v1
v_add_u32 v249, s0, v1
s_cmp_lt_u32 s32, 4
s_cselect_b64 s[28:29], s[4:5], s[8:9]
s_cselect_b32 s62, 0, 128
s_mov_b32 s30, 0x1e0000
s_mov_b32 s31, 0x20000
s_lshl_b32 s61, s32, 10
s_add_u32 s62, s62, s61
s_mul_i32 s44, s44, 983040
s_mul_i32 s46, s36, 122880
s_cmp_lt_u32 s32, 5
s_cbranch_scc1 L_r0
s_add_u32 s45, s44, 0
s_add_u32 m0, s61, 0
s_nop 0
buffer_load_dwordx4 v4, s[4:7], s45 offen lds
s_add_u32 m0, s61, 8192
s_nop 0
buffer_load_dwordx4 v5, s[8:11], s45 offen lds
s_add_u32 s45, s44, 0
s_add_u32 m0, s62, 16384
s_nop 0
buffer_load_dwordx4 v249, s[28:31], s45 offen lds
s_waitcnt vmcnt(3)
s_barrier
s_branch L_r1
L_r0:
s_waitcnt vmcnt(0)
s_barrier
s_cmp_eq_u32 s32, 0
s_cbranch_scc0 L_nroot
s_lshl_b32 s0, s36, 4
v_mov_b32 v8, 1
s_mov_b64 exec, 1
buffer_store_dword v8, off, s[24:27], s0 sc1
s_mov_b64 exec, -1
L_nroot:
s_add_u32 s45, s44, 0
s_add_u32 m0, s61, 0
s_nop 0
buffer_load_dwordx4 v4, s[4:7], s45 offen lds
s_add_u32 m0, s61, 8192
s_nop 0
buffer_load_dwordx4 v5, s[8:11], s45 offen lds
s_add_u32 s45, s44, 0
s_add_u32 m0, s62, 16384
s_nop 0
buffer_load_dwordx4 v249, s[28:31], s45 offen lds
L_r1:
s_add_u32 s45, s44, 196608
s_add_u32 m0, s61, 42240
s_nop 0
buffer_load_dwordx4 v4, s[4:7], s45 offen lds
s_add_u32 m0, s61, 50432
s_nop 0
buffer_load_dwordx4 v5, s[8:11], s45 offen lds
s_add_u32 s45, s44, 196608
s_add_u32 m0, s62, 58624
s_nop 0
buffer_load_dwordx4 v249, s[28:31], s45 offen lds
v_lshrrev_b32 v1, 5, v0
v_bfe_u32 v2, v0, 2, 1
v_lshl_add_u32 v1, v1, 2, v2
v_bfe_u32 v2, v0, 4, 1
v_bfe_u32 v3, v0, 3, 1
v_lshl_add_u32 v3, v3, 1, v2
v_lshl_add_u32 v1, v3, 4, v1
v_xor_b32 v3, s32, v3
v_and_b32 v2, 1, v0
v_lshlrev_b32 v2, 3, v2
v_lshl_add_u32 v2, v3, 4, v2
v_bfe_u32 v3, v0, 1, 1
v_lshl_add_u32 v251, v1, 6, v2
v_mul_u32_u24 v8, 4224, v3
v_add_u32 v251, v251, v8
v_lshl_add_u32 v250, v1, 7, v2
v_mul_u32_u24 v8, 8256, v3
v_xor_b32 v250, v250, v8
v_mov_b32 v228, 0
v_mov_b32 v229, 0
v_mov_b32 v230, 0
v_mov_b32 v231, 0
v_mov_b32 v232, 0
v_mov_b32 v233, 0
v_mov_b32 v234, 0
v_mov_b32 v235, 0
v_mov_b32 v1, 0x4444
v_mov_b32 v2, 0xeeee
s_mov_b32 vcc_lo, 0xaaaaaaaa
s_mov_b32 vcc_hi, 0xaaaaaaaa
v_cndmask_b32 v7, v1, v2, vcc
v_and_b32 v1, 48, v0
v_and_b32 v2, 1, v0
v_lshlrev_b32 v2, 4, v2
v_lshl_add_u32 v252, v1, 1, v2
v_add_u32 v254, 126720, v252
v_add_u32 v252, 127232, v252
v_add_u32 v1, 126848, v1
v_mov_b32 v2, 126912
v_cndmask_b32 v255, v1, v2, vcc
v_mov_b32 v3, 0
v_lshl_add_u32 v2, v0, 2, v2
s_mov_b32 exec_hi, 0
ds_write_b32 v2, v3
s_mov_b64 exec, -1
s_and_b32 s3, s36, 1
s_cselect_b32 s0, 4, 0
s_cselect_b32 s1, -4, 8
s_add_u32 s0, s0, s32
v_bfe_u32 v1, v0, 4, 1
v_mul_i32_i24 v1, s1, v1
v_add_u32 v1, s0, v1
v_lshrrev_b32 v2, 1, v1
v_lshlrev_b32 v2, 2, v2
v_and_or_b32 v2, v1, 1, v2
v_and_or_b32 v2, v0, 2, v2
v_bfe_u32 v3, v0, 2, 1
v_lshl_add_u32 v2, v2, 1, v3
v_and_b32 v3, 1, v0
v_lshl_add_u32 v2, v2, 1, v3
v_and_b32 v3, 7, v0
v_lshl_add_u32 v3, v1, 3, v3
v_cmp_gt_u32 vcc, 8, v1
s_nop 1
v_cndmask_b32 v2, v3, v2, vcc
v_lshlrev_b32 v2, 1, v2
v_add_u32 v253, 126720, v2
s_lshl_b32 s47, s32, 15
s_lshl_b32 s3, s36, 6
s_add_u32 s47, s47, s3
s_add_u32 s47, s47, 3162112
v_lshrrev_b32 v1, 2, v0
v_and_b32 v2, 3, v0
v_lshlrev_b32 v2, 4, v2
v_lshl_add_u32 v2, v1, 10, v2
v_lshlrev_b32 v1, 4, v1
v_add_u32 v1, 4032, v1
s_mov_b64 vcc, 0xffff
v_cndmask_b32 v246, v1, v2, vcc
s_cmp_lt_u32 s32, 4
s_cselect_b32 s50, 0x00ff0000, 0
s_or_b32 s50, s50, 0xff
s_mov_b32 s51, 0
s_sub_u32 s3, s32, 4
s_lshl_b32 s3, s3, 4
s_add_u32 s52, s3, s36
s_mul_i32 s3, s52, 52
s_lshr_b32 s3, s3, 8
s_mul_i32 s3, s3, 27648
s_lshl_b32 s53, s52, 10
s_add_u32 s53, s53, s3
s_add_u32 s53, s53, 3162112
s_mov_b32 s49, 131072
s_mov_b32 s63, 0
s_mul_i32 s3, s52, 52
s_lshr_b32 s3, s3, 8
s_mul_i32 s0, s3, 5
s_sub_u32 s0, s52, s0
s_mul_i32 s3, s3, 80
s_lshl_b32 s1, s0, 2
s_cmp_eq_u32 s0, 4
s_cselect_b32 s1, 64, s1
s_cselect_b32 s0, 0, 4
s_cselect_b32 s48, 2, 0
s_add_u32 s3, s3, s1
v_bfe_u32 v1, v0, 4, 1
v_lshrrev_b32 v2, 5, v0
v_lshl_add_u32 v1, v1, 1, v2
v_lshlrev_b32 v1, s0, v1
v_and_b32 v2, 3, v0
v_lshlrev_b32 v2, s48, v2
v_add3_u32 v1, v1, v2, s3
v_lshlrev_b32 v128, 1, v1
v_lshlrev_b32 v129, 2, v1
v_lshrrev_b32 v1, 4, v0
v_bfe_u32 v2, v0, 2, 2
v_lshl_add_u32 v1, v1, 3, v2
v_mul_u32_u24 v1, 1280, v1
v_and_b32 v3, 1, v0
v_lshl_add_u32 v1, v3, 3, v1
v_bfe_u32 v2, v0, 2, 3
v_lshlrev_b32 v2, 1, v2
v_bfe_u32 v3, v0, 1, 1
s_mul_i32 s0, s32, 10
s_add_u32 s3, s0, 0
v_add_u32 v236, s3, v3
v_xor_b32 v236, v236, v2
v_lshl_add_u32 v236, v236, 4, v1
s_add_u32 s3, s0, 2
v_add_u32 v237, s3, v3
v_xor_b32 v237, v237, v2
v_lshl_add_u32 v237, v237, 4, v1
s_add_u32 s3, s0, 4
v_add_u32 v238, s3, v3
v_xor_b32 v238, v238, v2
v_lshl_add_u32 v238, v238, 4, v1
s_add_u32 s3, s0, 6
v_add_u32 v239, s3, v3
v_xor_b32 v239, v239, v2
v_lshl_add_u32 v239, v239, 4, v1
s_add_u32 s3, s0, 8
v_add_u32 v240, s3, v3
v_xor_b32 v240, v240, v2
v_lshl_add_u32 v240, v240, 4, v1
s_waitcnt vmcnt(3) lgkmcnt(0)
s_barrier
s_add_u32 s45, s44, 393216
s_add_u32 m0, s61, 84480
s_nop 0
buffer_load_dwordx4 v4, s[4:7], s45 offen lds
s_add_u32 m0, s61, 92672
s_nop 0
buffer_load_dwordx4 v5, s[8:11], s45 offen lds
s_add_u32 s45, s44, 393216
s_add_u32 m0, s62, 100864
s_nop 0
buffer_load_dwordx4 v249, s[28:31], s45 offen lds
v_add_u32 v1, 0, v250
ds_read_b64_tr_b16 v[8:9], v1 offset:0
ds_read_b64_tr_b16 v[10:11], v1 offset:256
ds_read_b64_tr_b16 v[12:13], v1 offset:1024
ds_read_b64_tr_b16 v[14:15], v1 offset:1280
s_cmp_lt_u32 s32, 4
s_cbranch_scc0 L_g0
v_add_u32 v1, 16384, v251
ds_read_b64_tr_b16 v[88:89], v1 offset:0
ds_read_b64_tr_b16 v[90:91], v1 offset:128
ds_read_b64_tr_b16 v[92:93], v1 offset:512
ds_read_b64_tr_b16 v[94:95], v1 offset:640
L_g0:
s_waitcnt vmcnt(3) lgkmcnt(0)
s_barrier
s_add_u32 s45, s44, 589824
s_add_u32 m0, s61, 0
s_nop 0
buffer_load_dwordx4 v4, s[4:7], s45 offen lds
s_add_u32 m0, s61, 8192
s_nop 0
buffer_load_dwordx4 v5, s[8:11], s45 offen lds
s_add_u32 s45, s44, 589824
s_add_u32 m0, s62, 16384
s_nop 0
buffer_load_dwordx4 v249, s[28:31], s45 offen lds
v_add_u32 v1, 42240, v250
ds_read_b64_tr_b16 v[16:17], v1 offset:0
ds_read_b64_tr_b16 v[18:19], v1 offset:256
ds_read_b64_tr_b16 v[20:21], v1 offset:1024
ds_read_b64_tr_b16 v[22:23], v1 offset:1280
s_cmp_lt_u32 s32, 4
s_cbranch_scc0 L_g1
v_add_u32 v1, 58624, v251
ds_read_b64_tr_b16 v[96:97], v1 offset:0
ds_read_b64_tr_b16 v[98:99], v1 offset:128
ds_read_b64_tr_b16 v[100:101], v1 offset:512
ds_read_b64_tr_b16 v[102:103], v1 offset:640
L_g1:
s_waitcnt vmcnt(3) lgkmcnt(0)
s_barrier
s_add_u32 s45, s44, 786432
s_add_u32 m0, s61, 42240
s_nop 0
buffer_load_dwordx4 v4, s[4:7], s45 offen lds
s_add_u32 m0, s61, 50432
s_nop 0
buffer_load_dwordx4 v5, s[8:11], s45 offen lds
s_add_u32 s45, s44, 786432
s_add_u32 m0, s62, 58624
s_nop 0
buffer_load_dwordx4 v249, s[28:31], s45 offen lds
v_add_u32 v1, 84480, v250
ds_read_b64_tr_b16 v[24:25], v1 offset:0
ds_read_b64_tr_b16 v[26:27], v1 offset:256
ds_read_b64_tr_b16 v[28:29], v1 offset:1024
ds_read_b64_tr_b16 v[30:31], v1 offset:1280
s_cmp_lt_u32 s32, 4
s_cbranch_scc0 L_g2
v_add_u32 v1, 100864, v251
ds_read_b64_tr_b16 v[104:105], v1 offset:0
ds_read_b64_tr_b16 v[106:107], v1 offset:128
ds_read_b64_tr_b16 v[108:109], v1 offset:512
ds_read_b64_tr_b16 v[110:111], v1 offset:640
L_g2:
s_waitcnt vmcnt(3) lgkmcnt(0)
s_barrier
s_sub_u32 s45, 983040, s44
s_add_u32 m0, s61, 84480
s_nop 0
buffer_load_dwordx4 v4, s[4:7], s45 offen lds
s_add_u32 m0, s61, 92672
s_nop 0
buffer_load_dwordx4 v5, s[8:11], s45 offen lds
s_sub_u32 s45, 1179648, s44
s_add_u32 m0, s61, 100864
s_nop 0
buffer_load_dwordx4 v4, s[4:7], s45 offen lds
s_add_u32 m0, s61, 109056
s_nop 0
buffer_load_dwordx4 v5, s[8:11], s45 offen lds
v_add_u32 v1, 0, v250
ds_read_b64_tr_b16 v[32:33], v1 offset:0
ds_read_b64_tr_b16 v[34:35], v1 offset:256
ds_read_b64_tr_b16 v[36:37], v1 offset:1024
ds_read_b64_tr_b16 v[38:39], v1 offset:1280
s_cmp_lt_u32 s32, 4
s_cbranch_scc0 L_g3
v_add_u32 v1, 16384, v251
ds_read_b64_tr_b16 v[112:113], v1 offset:0
ds_read_b64_tr_b16 v[114:115], v1 offset:128
ds_read_b64_tr_b16 v[116:117], v1 offset:512
ds_read_b64_tr_b16 v[118:119], v1 offset:640
L_g3:
s_waitcnt vmcnt(4) lgkmcnt(0)
s_barrier
s_sub_u32 s45, 1376256, s44
s_add_u32 m0, s61, 0
s_nop 0
buffer_load_dwordx4 v4, s[4:7], s45 offen lds
s_add_u32 m0, s61, 8192
s_nop 0
buffer_load_dwordx4 v5, s[8:11], s45 offen lds
s_sub_u32 s45, 1572864, s44
s_add_u32 m0, s61, 16384
s_nop 0
buffer_load_dwordx4 v4, s[4:7], s45 offen lds
s_add_u32 m0, s61, 24576
s_nop 0
buffer_load_dwordx4 v5, s[8:11], s45 offen lds
v_add_u32 v1, 42240, v250
ds_read_b64_tr_b16 v[40:41], v1 offset:0
ds_read_b64_tr_b16 v[42:43], v1 offset:256
ds_read_b64_tr_b16 v[44:45], v1 offset:1024
ds_read_b64_tr_b16 v[46:47], v1 offset:1280
s_cmp_lt_u32 s32, 4
s_cbranch_scc0 L_g4
v_add_u32 v1, 58624, v251
ds_read_b64_tr_b16 v[120:121], v1 offset:0
ds_read_b64_tr_b16 v[122:123], v1 offset:128
ds_read_b64_tr_b16 v[124:125], v1 offset:512
ds_read_b64_tr_b16 v[126:127], v1 offset:640
L_g4:
s_waitcnt vmcnt(4) lgkmcnt(0)
s_barrier
s_sub_u32 s45, 1769472, s44
s_add_u32 m0, s61, 42240
s_nop 0
buffer_load_dwordx4 v4, s[4:7], s45 offen lds
s_add_u32 m0, s61, 50432
s_nop 0
buffer_load_dwordx4 v5, s[8:11], s45 offen lds
v_add_u32 v1, 84480, v250
ds_read_b64_tr_b16 v[48:49], v1 offset:0
ds_read_b64_tr_b16 v[50:51], v1 offset:256
ds_read_b64_tr_b16 v[52:53], v1 offset:1024
ds_read_b64_tr_b16 v[54:55], v1 offset:1280
v_add_u32 v1, 100864, v250
ds_read_b64_tr_b16 v[56:57], v1 offset:0
ds_read_b64_tr_b16 v[58:59], v1 offset:256
ds_read_b64_tr_b16 v[60:61], v1 offset:1024
ds_read_b64_tr_b16 v[62:63], v1 offset:1280
v_and_b32 v248, 0xf0, v6
buffer_load_dword v247, v248, s[24:27], 0 offen sc1
s_waitcnt vmcnt(3) lgkmcnt(0)
s_barrier
s_lshl_b32 s3, s32, 6
s_addk_i32 s3, 0
v_add_u32 v1, s3, v0
v_mul_u32_u24 v2, 52429, v1
v_lshrrev_b32 v2, 22, v2
v_and_b32 v3, 3, v2
v_lshlrev_b32 v3, 1, v3
v_and_or_b32 v3, v2, 8, v3
v_xor_b32 v1, v1, v3
v_lshlrev_b32 v1, 4, v1
s_add_u32 m0, s61, 84480
s_add_u32 s3, s46, 0
buffer_load_dwordx4 v1, s[12:15], s3 offen lds
s_lshl_b32 s3, s32, 6
s_addk_i32 s3, 512
v_add_u32 v1, s3, v0
v_mul_u32_u24 v2, 52429, v1
v_lshrrev_b32 v2, 22, v2
v_and_b32 v3, 3, v2
v_lshlrev_b32 v3, 1, v3
v_and_or_b32 v3, v2, 8, v3
v_xor_b32 v1, v1, v3
v_lshlrev_b32 v1, 4, v1
s_add_u32 m0, s61, 92672
s_add_u32 s3, s46, 0
buffer_load_dwordx4 v1, s[12:15], s3 offen lds
s_lshl_b32 s3, s32, 6
s_addk_i32 s3, 1024
v_add_u32 v1, s3, v0
v_mul_u32_u24 v2, 52429, v1
v_lshrrev_b32 v2, 22, v2
v_and_b32 v3, 3, v2
v_lshlrev_b32 v3, 1, v3
v_and_or_b32 v3, v2, 8, v3
v_xor_b32 v1, v1, v3
v_lshlrev_b32 v1, 4, v1
s_add_u32 m0, s61, 100864
s_add_u32 s3, s46, 0
buffer_load_dwordx4 v1, s[12:15], s3 offen lds
s_lshl_b32 s3, s32, 6
s_addk_i32 s3, 1536
v_add_u32 v1, s3, v0
v_mul_u32_u24 v2, 52429, v1
v_lshrrev_b32 v2, 22, v2
v_and_b32 v3, 3, v2
v_lshlrev_b32 v3, 1, v3
v_and_or_b32 v3, v2, 8, v3
v_xor_b32 v1, v1, v3
v_lshlrev_b32 v1, 4, v1
s_add_u32 m0, s61, 109056
s_add_u32 s3, s46, 0
buffer_load_dwordx4 v1, s[12:15], s3 offen lds
s_lshl_b32 s3, s32, 6
s_addk_i32 s3, 2048
v_add_u32 v1, s3, v0
v_mul_u32_u24 v2, 52429, v1
v_lshrrev_b32 v2, 22, v2
v_and_b32 v3, 3, v2
v_lshlrev_b32 v3, 1, v3
v_and_or_b32 v3, v2, 8, v3
v_xor_b32 v1, v1, v3
v_lshlrev_b32 v1, 4, v1
s_add_u32 m0, s61, 117248
s_add_u32 s3, s46, 0
buffer_load_dwordx4 v1, s[12:15], s3 offen lds
v_add_u32 v1, 0, v250
ds_read_b64_tr_b16 v[64:65], v1 offset:0
ds_read_b64_tr_b16 v[66:67], v1 offset:256
ds_read_b64_tr_b16 v[68:69], v1 offset:1024
ds_read_b64_tr_b16 v[70:71], v1 offset:1280
v_add_u32 v1, 16384, v250
ds_read_b64_tr_b16 v[72:73], v1 offset:0
ds_read_b64_tr_b16 v[74:75], v1 offset:256
ds_read_b64_tr_b16 v[76:77], v1 offset:1024
ds_read_b64_tr_b16 v[78:79], v1 offset:1280
s_waitcnt vmcnt(5) lgkmcnt(0)
s_barrier
s_lshl_b32 s3, s32, 6
s_addk_i32 s3, 0
v_add_u32 v1, s3, v0
v_mul_u32_u24 v2, 52429, v1
v_lshrrev_b32 v2, 22, v2
v_and_b32 v3, 3, v2
v_lshlrev_b32 v3, 1, v3
v_and_or_b32 v3, v2, 8, v3
v_xor_b32 v1, v1, v3
v_lshlrev_b32 v1, 4, v1
s_add_u32 m0, s61, 0
s_add_u32 s3, s46, 40960
buffer_load_dwordx4 v1, s[12:15], s3 offen lds
s_lshl_b32 s3, s32, 6
s_addk_i32 s3, 512
v_add_u32 v1, s3, v0
v_mul_u32_u24 v2, 52429, v1
v_lshrrev_b32 v2, 22, v2
v_and_b32 v3, 3, v2
v_lshlrev_b32 v3, 1, v3
v_and_or_b32 v3, v2, 8, v3
v_xor_b32 v1, v1, v3
v_lshlrev_b32 v1, 4, v1
s_add_u32 m0, s61, 8192
s_add_u32 s3, s46, 40960
buffer_load_dwordx4 v1, s[12:15], s3 offen lds
s_lshl_b32 s3, s32, 6
s_addk_i32 s3, 1024
v_add_u32 v1, s3, v0
v_mul_u32_u24 v2, 52429, v1
v_lshrrev_b32 v2, 22, v2
v_and_b32 v3, 3, v2
v_lshlrev_b32 v3, 1, v3
v_and_or_b32 v3, v2, 8, v3
v_xor_b32 v1, v1, v3
v_lshlrev_b32 v1, 4, v1
s_add_u32 m0, s61, 16384
s_add_u32 s3, s46, 40960
buffer_load_dwordx4 v1, s[12:15], s3 offen lds
s_lshl_b32 s3, s32, 6
s_addk_i32 s3, 1536
v_add_u32 v1, s3, v0
v_mul_u32_u24 v2, 52429, v1
v_lshrrev_b32 v2, 22, v2
v_and_b32 v3, 3, v2
v_lshlrev_b32 v3, 1, v3
v_and_or_b32 v3, v2, 8, v3
v_xor_b32 v1, v1, v3
v_lshlrev_b32 v1, 4, v1
s_add_u32 m0, s61, 24576
s_add_u32 s3, s46, 40960
buffer_load_dwordx4 v1, s[12:15], s3 offen lds
s_lshl_b32 s3, s32, 6
s_addk_i32 s3, 2048
v_add_u32 v1, s3, v0
v_mul_u32_u24 v2, 52429, v1
v_lshrrev_b32 v2, 22, v2
v_and_b32 v3, 3, v2
v_lshlrev_b32 v3, 1, v3
v_and_or_b32 v3, v2, 8, v3
v_xor_b32 v1, v1, v3
v_lshlrev_b32 v1, 4, v1
s_add_u32 m0, s61, 32768
s_add_u32 s3, s46, 40960
buffer_load_dwordx4 v1, s[12:15], s3 offen lds
v_add_u32 v1, 42240, v250
ds_read_b64_tr_b16 v[80:81], v1 offset:0
ds_read_b64_tr_b16 v[82:83], v1 offset:256
ds_read_b64_tr_b16 v[84:85], v1 offset:1024
ds_read_b64_tr_b16 v[86:87], v1 offset:1280
s_waitcnt vmcnt(5) lgkmcnt(0)
s_barrier
s_lshl_b32 s3, s32, 6
s_addk_i32 s3, 0
v_add_u32 v1, s3, v0
v_mul_u32_u24 v2, 52429, v1
v_lshrrev_b32 v2, 22, v2
v_and_b32 v3, 3, v2
v_lshlrev_b32 v3, 1, v3
v_and_or_b32 v3, v2, 8, v3
v_xor_b32 v1, v1, v3
v_lshlrev_b32 v1, 4, v1
s_add_u32 m0, s61, 42240
s_add_u32 s3, s46, 81920
buffer_load_dwordx4 v1, s[12:15], s3 offen lds
s_lshl_b32 s3, s32, 6
s_addk_i32 s3, 512
v_add_u32 v1, s3, v0
v_mul_u32_u24 v2, 52429, v1
v_lshrrev_b32 v2, 22, v2
v_and_b32 v3, 3, v2
v_lshlrev_b32 v3, 1, v3
v_and_or_b32 v3, v2, 8, v3
v_xor_b32 v1, v1, v3
v_lshlrev_b32 v1, 4, v1
s_add_u32 m0, s61, 50432
s_add_u32 s3, s46, 81920
buffer_load_dwordx4 v1, s[12:15], s3 offen lds
s_lshl_b32 s3, s32, 6
s_addk_i32 s3, 1024
v_add_u32 v1, s3, v0
v_mul_u32_u24 v2, 52429, v1
v_lshrrev_b32 v2, 22, v2
v_and_b32 v3, 3, v2
v_lshlrev_b32 v3, 1, v3
v_and_or_b32 v3, v2, 8, v3
v_xor_b32 v1, v1, v3
v_lshlrev_b32 v1, 4, v1
s_add_u32 m0, s61, 58624
s_add_u32 s3, s46, 81920
buffer_load_dwordx4 v1, s[12:15], s3 offen lds
s_lshl_b32 s3, s32, 6
s_addk_i32 s3, 1536
v_add_u32 v1, s3, v0
v_mul_u32_u24 v2, 52429, v1
v_lshrrev_b32 v2, 22, v2
v_and_b32 v3, 3, v2
v_lshlrev_b32 v3, 1, v3
v_and_or_b32 v3, v2, 8, v3
v_xor_b32 v1, v1, v3
v_lshlrev_b32 v1, 4, v1
s_add_u32 m0, s61, 66816
s_add_u32 s3, s46, 81920
buffer_load_dwordx4 v1, s[12:15], s3 offen lds
s_lshl_b32 s3, s32, 6
s_addk_i32 s3, 2048
v_add_u32 v1, s3, v0
v_mul_u32_u24 v2, 52429, v1
v_lshrrev_b32 v2, 22, v2
v_and_b32 v3, 3, v2
v_lshlrev_b32 v3, 1, v3
v_and_or_b32 v3, v2, 8, v3
v_xor_b32 v1, v1, v3
v_lshlrev_b32 v1, 4, v1
s_add_u32 m0, s61, 75008
s_add_u32 s3, s46, 81920
buffer_load_dwordx4 v1, s[12:15], s3 offen lds
v_add_u32 v1, 84480, v236
ds_read_b64_tr_b16 v[168:169], v1 offset:0
ds_read_b64_tr_b16 v[170:171], v1 offset:5120
v_add_u32 v1, 84480, v237
ds_read_b64_tr_b16 v[180:181], v1 offset:0
ds_read_b64_tr_b16 v[182:183], v1 offset:5120
v_add_u32 v1, 84480, v238
ds_read_b64_tr_b16 v[192:193], v1 offset:0
ds_read_b64_tr_b16 v[194:195], v1 offset:5120
v_add_u32 v1, 84480, v239
ds_read_b64_tr_b16 v[204:205], v1 offset:0
ds_read_b64_tr_b16 v[206:207], v1 offset:5120
v_add_u32 v1, 84480, v240
ds_read_b64_tr_b16 v[216:217], v1 offset:0
ds_read_b64_tr_b16 v[218:219], v1 offset:5120
s_waitcnt vmcnt(5) lgkmcnt(0)
s_barrier
s_sub_u32 s45, 983040, s44
s_add_u32 m0, s62, 84480
s_nop 0
buffer_load_dwordx4 v249, s[28:31], s45 offen lds
s_sub_u32 s45, 1179648, s44
s_add_u32 m0, s62, 92928
s_nop 0
buffer_load_dwordx4 v249, s[28:31], s45 offen lds
s_sub_u32 s45, 1376256, s44
s_add_u32 m0, s62, 101376
s_nop 0
buffer_load_dwordx4 v249, s[28:31], s45 offen lds
s_sub_u32 s45, 1572864, s44
s_add_u32 m0, s62, 109824
s_nop 0
buffer_load_dwordx4 v249, s[28:31], s45 offen lds
s_sub_u32 s45, 1769472, s44
s_add_u32 m0, s62, 118272
s_nop 0
buffer_load_dwordx4 v249, s[28:31], s45 offen lds
v_add_u32 v1, 0, v236
ds_read_b64_tr_b16 v[172:173], v1 offset:0
ds_read_b64_tr_b16 v[174:175], v1 offset:5120
v_add_u32 v1, 0, v237
ds_read_b64_tr_b16 v[184:185], v1 offset:0
ds_read_b64_tr_b16 v[186:187], v1 offset:5120
v_add_u32 v1, 0, v238
ds_read_b64_tr_b16 v[196:197], v1 offset:0
ds_read_b64_tr_b16 v[198:199], v1 offset:5120
v_add_u32 v1, 0, v239
ds_read_b64_tr_b16 v[208:209], v1 offset:0
ds_read_b64_tr_b16 v[210:211], v1 offset:5120
v_add_u32 v1, 0, v240
ds_read_b64_tr_b16 v[220:221], v1 offset:0
ds_read_b64_tr_b16 v[222:223], v1 offset:5120
s_waitcnt vmcnt(5) lgkmcnt(0)
s_barrier
v_add_u32 v1, 42240, v236
ds_read_b64_tr_b16 v[176:177], v1 offset:0
ds_read_b64_tr_b16 v[178:179], v1 offset:5120
v_add_u32 v1, 42240, v237
ds_read_b64_tr_b16 v[188:189], v1 offset:0
ds_read_b64_tr_b16 v[190:191], v1 offset:5120
v_add_u32 v1, 42240, v238
ds_read_b64_tr_b16 v[200:201], v1 offset:0
ds_read_b64_tr_b16 v[202:203], v1 offset:5120
v_add_u32 v1, 42240, v239
ds_read_b64_tr_b16 v[212:213], v1 offset:0
ds_read_b64_tr_b16 v[214:215], v1 offset:5120
v_add_u32 v1, 42240, v240
ds_read_b64_tr_b16 v[224:225], v1 offset:0
ds_read_b64_tr_b16 v[226:227], v1 offset:5120
s_waitcnt vmcnt(0) lgkmcnt(0)
s_barrier
s_cmp_lt_u32 s32, 4
s_cbranch_scc0 L_g11
v_add_u32 v1, 84480, v251
ds_read_b64_tr_b16 v[128:129], v1 offset:0
ds_read_b64_tr_b16 v[130:131], v1 offset:128
ds_read_b64_tr_b16 v[132:133], v1 offset:512
ds_read_b64_tr_b16 v[134:135], v1 offset:640
v_add_u32 v1, 92928, v251
ds_read_b64_tr_b16 v[136:137], v1 offset:0
ds_read_b64_tr_b16 v[138:139], v1 offset:128
ds_read_b64_tr_b16 v[140:141], v1 offset:512
ds_read_b64_tr_b16 v[142:143], v1 offset:640
v_add_u32 v1, 101376, v251
ds_read_b64_tr_b16 v[144:145], v1 offset:0
ds_read_b64_tr_b16 v[146:147], v1 offset:128
ds_read_b64_tr_b16 v[148:149], v1 offset:512
ds_read_b64_tr_b16 v[150:151], v1 offset:640
v_add_u32 v1, 109824, v251
ds_read_b64_tr_b16 v[152:153], v1 offset:0
ds_read_b64_tr_b16 v[154:155], v1 offset:128
ds_read_b64_tr_b16 v[156:157], v1 offset:512
ds_read_b64_tr_b16 v[158:159], v1 offset:640
v_add_u32 v1, 118272, v251
ds_read_b64_tr_b16 v[160:161], v1 offset:0
ds_read_b64_tr_b16 v[162:163], v1 offset:128
ds_read_b64_tr_b16 v[164:165], v1 offset:512
ds_read_b64_tr_b16 v[166:167], v1 offset:640
L_g11:
s_branch L_pb_26
.p2align 12
L_pb_26:
s_call_b64 s[100:101], L_pad_27
s_call_b64 s[100:101], L_pad_28
s_call_b64 s[100:101], L_pad_29
v_mov_b32 v5, v246
v_mov_b32 v4, 126976
s_cmp_lt_u32 s32, 7
s_cbranch_scc1 L_np
L_rt:
v_cmp_ne_u32 vcc, 1, v247
s_cbranch_vccz L_rtg
buffer_load_dword v247, v248, s[24:27], 0 offen sc1
s_waitcnt vmcnt(0)
s_sub_u32 s40, s40, 1
s_cbranch_scc0 L_rt
s_mov_b32 s40, 0
L_rtg:
v_bfe_u32 v1, v0, 2, 3
v_lshlrev_b32 v1, 15, v1
v_and_b32 v2, 3, v0
v_min_u32 v2, 2, v2
v_mul_u32_u24 v3, 1280, v2
s_mov_b32 s0, 3145728
v_add3_u32 v3, v3, v1, s0
v_lshl_add_u32 v1, v2, 7, v1
s_mul_i32 s0, s36, 384
s_add_u32 s0, s0, 3167232
s_and_b32 s3, s36, 1
s_mul_i32 s3, s3, 640
v_add_u32 v132, s3, v6
v_subrev_u32 v2, 1280, v132
v_min_u32 v132, v132, v2
s_sub_u32 s3, 1024, s3
v_add_u32 v133, s3, v6
s_mov_b32 s54, 0
s_mov_b32 s55, 0x80000000
v_mov_b32 v140, -1
v_mov_b32 v141, -1
v_mov_b32 v142, -1
s_mov_b32 s60, 0
s_mov_b32 m0, 127232
s_mov_b64 exec, -1
buffer_load_dwordx4 v132, s[16:19], s55 offen sc1 lds
s_mov_b32 m0, 128256
s_mov_b64 exec, 0xffff
buffer_load_dwordx4 v133, s[16:19], s55 offen sc1 lds
s_mov_b64 exec, 0x77777777
buffer_atomic_umin v140, v1, s[16:19], s0 offen sc0 sc1
s_sleep 2
s_mov_b32 m0, 127232
s_mov_b64 exec, -1
buffer_load_dwordx4 v132, s[16:19], s55 offen sc1 lds
s_mov_b32 m0, 128256
s_mov_b64 exec, 0xffff
buffer_load_dwordx4 v133, s[16:19], s55 offen sc1 lds
s_mov_b64 exec, 0x77777777
buffer_atomic_umin v141, v1, s[16:19], s0 offen sc0 sc1
s_sleep 2
L_pl0:
s_mov_b32 m0, 127232
s_mov_b64 exec, -1
buffer_load_dwordx4 v132, s[16:19], s55 offen sc1 lds
s_mov_b32 m0, 128256
s_mov_b64 exec, 0xffff
buffer_load_dwordx4 v133, s[16:19], s55 offen sc1 lds
s_mov_b64 exec, 0x77777777
buffer_atomic_umin v142, v1, s[16:19], s0 offen sc0 sc1
s_waitcnt vmcnt(6)
v_cmp_lt_u32 vcc, s54, v140
s_sub_u32 s60, s60, 1
s_cbranch_vccnz L_pm0
s_cbranch_scc1 L_pg
s_branch L_pw
L_pm0:
s_max_i32 s60, s60, 0
v_cmp_eq_u32 s[58:59], -1, v140
v_mov_b32 v2, v140
s_andn2_b64 vcc, vcc, s[58:59]
s_cbranch_scc0 L_pq0
s_mov_b64 exec, -1
v_cndmask_b32 v2, 0, v2, vcc
s_nop 1
v_max_u32_dpp v236, v2, v2 row_ror:8 row_mask:0xf bank_mask:0xf
s_nop 1
v_max_u32_dpp v236, v236, v236 row_ror:4 row_mask:0xf bank_mask:0xf
s_nop 1
v_max_u32_dpp v236, v236, v236 row_ror:2 row_mask:0xf bank_mask:0xf
s_nop 1
v_max_u32_dpp v236, v236, v236 row_ror:1 row_mask:0xf bank_mask:0xf
v_mov_b32 v237, v236
s_mov_b32 s60, 2
s_nop 0
v_permlane16_swap_b32 v236, v237
v_max_u32 v236, v236, v237
s_mov_b32 exec_hi, 0
v_cmpx_eq_u32 vcc, v236, v2
ds_write_b64 v4, v[2:3]
s_cmp_eq_u64 s[58:59], 0
s_nop 1
v_readfirstlane_b32 s55, v3
v_readfirstlane_b32 s54, v2
s_cbranch_scc1 L_xf
s_branch L_pl1
L_pq0:
s_sleep 2
L_pl1:
s_mov_b32 m0, 127232
s_mov_b64 exec, -1
buffer_load_dwordx4 v132, s[16:19], s55 offen sc1 lds
s_mov_b32 m0, 128256
s_mov_b64 exec, 0xffff
buffer_load_dwordx4 v133, s[16:19], s55 offen sc1 lds
s_mov_b64 exec, 0x77777777
buffer_atomic_umin v140, v1, s[16:19], s0 offen sc0 sc1
s_waitcnt vmcnt(6)
v_cmp_lt_u32 vcc, s54, v141
s_sub_u32 s60, s60, 1
s_cbranch_vccnz L_pm1
s_cbranch_scc1 L_pg
s_branch L_pw
L_pm1:
s_max_i32 s60, s60, 0
v_cmp_eq_u32 s[58:59], -1, v141
v_mov_b32 v2, v141
s_andn2_b64 vcc, vcc, s[58:59]
s_cbranch_scc0 L_pq1
s_mov_b64 exec, -1
v_cndmask_b32 v2, 0, v2, vcc
s_nop 1
v_max_u32_dpp v236, v2, v2 row_ror:8 row_mask:0xf bank_mask:0xf
s_nop 1
v_max_u32_dpp v236, v236, v236 row_ror:4 row_mask:0xf bank_mask:0xf
s_nop 1
v_max_u32_dpp v236, v236, v236 row_ror:2 row_mask:0xf bank_mask:0xf
s_nop 1
v_max_u32_dpp v236, v236, v236 row_ror:1 row_mask:0xf bank_mask:0xf
v_mov_b32 v237, v236
s_mov_b32 s60, 2
s_nop 0
v_permlane16_swap_b32 v236, v237
v_max_u32 v236, v236, v237
s_mov_b32 exec_hi, 0
v_cmpx_eq_u32 vcc, v236, v2
ds_write_b64 v4, v[2:3]
s_cmp_eq_u64 s[58:59], 0
s_nop 1
v_readfirstlane_b32 s55, v3
v_readfirstlane_b32 s54, v2
s_cbranch_scc1 L_xf
s_branch L_pl2
L_pq1:
s_sleep 2
L_pl2:
s_mov_b32 m0, 127232
s_mov_b64 exec, -1
buffer_load_dwordx4 v132, s[16:19], s55 offen sc1 lds
s_mov_b32 m0, 128256
s_mov_b64 exec, 0xffff
buffer_load_dwordx4 v133, s[16:19], s55 offen sc1 lds
s_mov_b64 exec, 0x77777777
buffer_atomic_umin v141, v1, s[16:19], s0 offen sc0 sc1
s_waitcnt vmcnt(6)
v_cmp_lt_u32 vcc, s54, v142
s_sub_u32 s60, s60, 1
s_cbranch_vccnz L_pm2
s_cbranch_scc1 L_pg
s_branch L_pw
L_pm2:
s_max_i32 s60, s60, 0
v_cmp_eq_u32 s[58:59], -1, v142
v_mov_b32 v2, v142
s_andn2_b64 vcc, vcc, s[58:59]
s_cbranch_scc0 L_pq2
s_mov_b64 exec, -1
v_cndmask_b32 v2, 0, v2, vcc
s_nop 1
v_max_u32_dpp v236, v2, v2 row_ror:8 row_mask:0xf bank_mask:0xf
s_nop 1
v_max_u32_dpp v236, v236, v236 row_ror:4 row_mask:0xf bank_mask:0xf
s_nop 1
v_max_u32_dpp v236, v236, v236 row_ror:2 row_mask:0xf bank_mask:0xf
s_nop 1
v_max_u32_dpp v236, v236, v236 row_ror:1 row_mask:0xf bank_mask:0xf
v_mov_b32 v237, v236
s_mov_b32 s60, 2
s_nop 0
v_permlane16_swap_b32 v236, v237
v_max_u32 v236, v236, v237
s_mov_b32 exec_hi, 0
v_cmpx_eq_u32 vcc, v236, v2
ds_write_b64 v4, v[2:3]
s_cmp_eq_u64 s[58:59], 0
s_nop 1
v_readfirstlane_b32 s55, v3
v_readfirstlane_b32 s54, v2
s_cbranch_scc1 L_xf
s_branch L_pl0
L_pq2:
s_sleep 2
s_sub_u32 s40, s40, 1
s_cbranch_scc0 L_pl0
s_mov_b32 s40, 0
s_branch L_xf
L_pw:
s_cmp_eq_u32 s60, 0
s_waitcnt vmcnt(4)
s_cbranch_scc1 L_pg
s_cmp_eq_u32 s60, 1
s_waitcnt vmcnt(1)
s_branch L_pg
L_xf:
s_mov_b32 m0, 127232
s_mov_b64 exec, -1
s_nop 0
buffer_load_dwordx4 v132, s[16:19], s55 offen sc1 lds
s_mov_b32 m0, 128256
s_mov_b64 exec, 0xffff
buffer_load_dwordx4 v133, s[16:19], s55 offen sc1 lds
s_waitcnt vmcnt(0)
L_pg:
s_mov_b64 exec, -1
L_np:
s_waitcnt lgkmcnt(0)
s_barrier
s_cmp_lt_u32 s32, 4
s_cbranch_scc1 L_xh
s_and_b32 s3, s36, 1
s_add_u32 s3, s3, s32
s_cmp_eq_u32 s3, 8
s_cbranch_scc0 L_wb1
buffer_wbl2 sc1
L_wb1:
ds_read_b64 v[2:3], v4
ds_read_b128 v[88:91], v252 offset:0
ds_read_b128 v[92:95], v252 offset:128
ds_read_b128 v[96:99], v252 offset:256
ds_read_b128 v[100:103], v252 offset:384
ds_read_b128 v[104:107], v252 offset:512
ds_read_b128 v[108:111], v252 offset:640
ds_read_b128 v[112:115], v252 offset:768
ds_read_b128 v[116:119], v252 offset:896
ds_read_b128 v[120:123], v252 offset:1024
ds_read_b128 v[124:127], v252 offset:1152
s_waitcnt lgkmcnt(10)
v_readfirstlane_b32 s56, v2
v_readfirstlane_b32 s57, v3
s_waitcnt lgkmcnt(9)
v_smfmac_f32_16x16x64_bf16 v[228:231], v[88:91], v[8:15], v7
s_and_b32 s0, s57, 0x7fff
s_add_u32 s57, s57, s0
s_add_u32 s57, s57, 4096
s_and_b32 s1, s56, 0xfffff800
s_waitcnt lgkmcnt(8)
v_smfmac_f32_16x16x64_bf16 v[228:231], v[92:95], v[16:23], v7
s_ashr_i32 s3, s1, 31
s_not_b32 s3, s3
s_or_b32 s3, s3, 0x80000000
s_xor_b32 s1, s1, s3
s_waitcnt lgkmcnt(7)
v_smfmac_f32_16x16x64_bf16 v[228:231], v[96:99], v[24:31], v7
s_andn2_b32 s56, 2047, s56
s_mul_i32 s56, s56, 1280
v_mov_b32 v130, s1
s_waitcnt lgkmcnt(6)
v_smfmac_f32_16x16x64_bf16 v[228:231], v[100:103], v[32:39], v7
v_mul_f32 v130, 0xbfb8aa3b, v130
s_waitcnt lgkmcnt(5)
v_smfmac_f32_16x16x64_bf16 v[228:231], v[104:107], v[40:47], v7
v_exp_f32 v130, v130
s_waitcnt lgkmcnt(4)
v_smfmac_f32_16x16x64_bf16 v[228:231], v[108:111], v[48:55], v7
v_add_f32 v130, 1.0, v130
s_waitcnt lgkmcnt(3)
v_smfmac_f32_16x16x64_bf16 v[228:231], v[112:115], v[56:63], v7
v_rcp_f32 v130, v130
s_waitcnt lgkmcnt(2)
v_smfmac_f32_16x16x64_bf16 v[228:231], v[116:119], v[64:71], v7
s_waitcnt lgkmcnt(1)
v_smfmac_f32_16x16x64_bf16 v[228:231], v[120:123], v[72:79], v7
s_waitcnt lgkmcnt(0)
v_smfmac_f32_16x16x64_bf16 v[228:231], v[124:127], v[80:87], v7
s_branch L_xj
L_pad_27:
s_setpc_b64 s[100:101]
L_xh:
ds_read_b128 v[236:239], v252 offset:0
ds_read_b128 v[240:243], v252 offset:128
ds_read_b128 v[244:247], v252 offset:256
ds_read_b128 v[248:251], v252 offset:384
s_waitcnt lgkmcnt(3)
v_smfmac_f32_16x16x64_bf16 v[228:231], v[236:239], v[8:15], v7
v_smfmac_f32_16x16x64_bf16 v[232:235], v[236:239], v[88:95], v7
ds_read_b128 v[236:239], v252 offset:512
s_waitcnt lgkmcnt(3)
v_smfmac_f32_16x16x64_bf16 v[228:231], v[240:243], v[16:23], v7
v_smfmac_f32_16x16x64_bf16 v[232:235], v[240:243], v[96:103], v7
ds_read_b128 v[240:243], v252 offset:640
s_waitcnt lgkmcnt(3)
v_smfmac_f32_16x16x64_bf16 v[228:231], v[244:247], v[24:31], v7
v_smfmac_f32_16x16x64_bf16 v[232:235], v[244:247], v[104:111], v7
ds_read_b128 v[244:247], v252 offset:768
s_waitcnt lgkmcnt(3)
v_smfmac_f32_16x16x64_bf16 v[228:231], v[248:251], v[32:39], v7
v_smfmac_f32_16x16x64_bf16 v[232:235], v[248:251], v[112:119], v7
ds_read_b128 v[248:251], v252 offset:896
s_waitcnt lgkmcnt(3)
v_smfmac_f32_16x16x64_bf16 v[228:231], v[236:239], v[40:47], v7
v_smfmac_f32_16x16x64_bf16 v[232:235], v[236:239], v[120:127], v7
ds_read_b128 v[236:239], v252 offset:1024
s_waitcnt lgkmcnt(3)
v_smfmac_f32_16x16x64_bf16 v[228:231], v[240:243], v[48:55], v7
v_smfmac_f32_16x16x64_bf16 v[232:235], v[240:243], v[128:135], v7
ds_read_b128 v[240:243], v252 offset:1152
s_waitcnt lgkmcnt(3)
v_smfmac_f32_16x16x64_bf16 v[228:231], v[244:247], v[56:63], v7
v_smfmac_f32_16x16x64_bf16 v[232:235], v[244:247], v[136:143], v7
s_waitcnt lgkmcnt(2)
v_smfmac_f32_16x16x64_bf16 v[228:231], v[248:251], v[64:71], v7
v_smfmac_f32_16x16x64_bf16 v[232:235], v[248:251], v[144:151], v7
s_waitcnt lgkmcnt(1)
v_smfmac_f32_16x16x64_bf16 v[228:231], v[236:239], v[72:79], v7
v_smfmac_f32_16x16x64_bf16 v[232:235], v[236:239], v[152:159], v7
s_waitcnt lgkmcnt(0)
v_smfmac_f32_16x16x64_bf16 v[228:231], v[240:243], v[80:87], v7
v_smfmac_f32_16x16x64_bf16 v[232:235], v[240:243], v[160:167], v7
L_xj:
s_mov_b64 vcc, 0xffff
s_nop 5
v_add_f32 v1, v228, v229
v_add_f32 v2, v232, v233
v_cndmask_b32 v1, v2, v1, vcc
v_cmp_u_f32 vcc, v1, v1
s_cbranch_vccnz L_xn
L_xnb:
v_mul_f32 v2, 0xbfb8aa3b, v1
v_exp_f32 v2, v2
v_mul_f32_dpp v3, v1, v1 row_ror:8 row_mask:0xf bank_mask:0xf
v_add_f32 v2, 1.0, v2
v_rcp_f32 v2, v2
s_nop 0
v_mul_f32 v1, v2, v3
v_cvt_pk_bf16_f32 v1, v1, v1
s_mov_b64 exec, s[50:51]
ds_write_b16 v253, v1
s_mov_b64 exec, -1
v_mov_b32 v2, 126928
s_waitcnt lgkmcnt(0)
s_barrier
ds_read_b32 v1, v2
ds_read_b128 v[236:239], v255
ds_read_b128 v[240:243], v254
s_waitcnt lgkmcnt(2)
v_cmp_ne_u32 vcc, 0, v1
s_cbranch_vccnz L_xsr
L_xsgo:
s_waitcnt lgkmcnt(1)
v_mfma_f32_16x16x32_bf16 v[24:27], v[236:239], v[224:227], 0
v_mfma_f32_16x16x32_bf16 v[8:11], v[236:239], v[176:179], 0
v_mfma_f32_16x16x32_bf16 v[12:15], v[236:239], v[188:191], 0
v_mfma_f32_16x16x32_bf16 v[16:19], v[236:239], v[200:203], 0
v_mfma_f32_16x16x32_bf16 v[20:23], v[236:239], v[212:215], 0
s_waitcnt lgkmcnt(0)
s_nop 0
v_smfmac_f32_16x16x64_bf16 v[24:27], v[240:243], v[216:223], v7
v_smfmac_f32_16x16x64_bf16 v[8:11], v[240:243], v[168:175], v7
v_smfmac_f32_16x16x64_bf16 v[12:15], v[240:243], v[180:187], v7
v_smfmac_f32_16x16x64_bf16 v[16:19], v[240:243], v[192:199], v7
v_smfmac_f32_16x16x64_bf16 v[20:23], v[240:243], v[204:211], v7
s_nop 3
v_add_f32 v1, v24, v25
v_add_f32 v32, v8, v9
v_add_f32 v33, v12, v13
v_add_f32 v34, v16, v17
v_add_f32 v35, v20, v21
v_mov_b32_dpp v32, v1 quad_perm:[0,0,0,0] row_mask:0x2 bank_mask:0xf
v_mov_b32_dpp v33, v1 quad_perm:[1,1,1,1] row_mask:0x2 bank_mask:0xf
v_mov_b32_dpp v34, v1 quad_perm:[2,2,2,2] row_mask:0x2 bank_mask:0xf
v_mov_b32_dpp v35, v1 quad_perm:[3,3,3,3] row_mask:0x2 bank_mask:0xf
s_mov_b64 exec, 0x1111ffff
buffer_store_dwordx4 v[32:35], v5, s[16:19], s47 offen sc1
s_mov_b64 exec, -1
s_cmp_lt_u32 s52, 40
s_cbranch_scc0 L_mfin
buffer_load_dword v44, v129, s[16:19], s57 offen sc1
buffer_load_dwordx4 v[40:43], v6, s[16:19], s53 offen sc1
L_fd:
buffer_load_dword v52, v129, s[16:19], s57 offen sc1
buffer_load_dwordx4 v[48:51], v6, s[16:19], s53 offen sc1
s_waitcnt vmcnt(2)
v_max3_u32 v1, v40, v42, v44
v_cmp_eq_u32 vcc, -1, v1
s_cbranch_vccz L_fg0
buffer_load_dword v44, v129, s[16:19], s57 offen sc1
buffer_load_dwordx4 v[40:43], v6, s[16:19], s53 offen sc1
s_waitcnt vmcnt(2)
v_max3_u32 v1, v48, v50, v52
v_cmp_eq_u32 vcc, -1, v1
s_cbranch_vccz L_fg1
s_sub_u32 s40, s40, 1
s_cbranch_scc0 L_fd
L_fg1:
v_permlane32_swap_b32 v48, v49
v_permlane32_swap_b32 v50, v51
v_add_f32 v48, v48, v49
v_add_f32 v50, v50, v51
s_nop 1
v_permlane16_swap_b32 v48, v50
v_add_f32 v48, v48, v50
s_nop 1
v_add_f32_dpp v48, v48, v48 row_ror:4 row_mask:0xf bank_mask:0xf
s_nop 1
v_add_f32_dpp v48, v48, v48 row_ror:8 row_mask:0xf bank_mask:0xf
v_fma_f32 v8, v48, v130, v52
v_cvt_pk_bf16_f32 v8, v8, v8
s_mov_b32 exec_lo, 0xf000f
s_mov_b32 exec_hi, 0xf000f
buffer_store_short v8, v128, s[20:23], s56 offen
s_endpgm
L_pad_28:
s_setpc_b64 s[100:101]
L_fg0:
v_permlane32_swap_b32 v40, v41
v_permlane32_swap_b32 v42, v43
v_add_f32 v40, v40, v41
v_add_f32 v42, v42, v43
s_nop 1
v_permlane16_swap_b32 v40, v42
v_add_f32 v40, v40, v42
s_nop 1
v_add_f32_dpp v40, v40, v40 row_ror:4 row_mask:0xf bank_mask:0xf
s_nop 1
v_add_f32_dpp v40, v40, v40 row_ror:8 row_mask:0xf bank_mask:0xf
v_fma_f32 v8, v40, v130, v44
v_cvt_pk_bf16_f32 v8, v8, v8
s_mov_b32 exec_lo, 0xf000f
s_mov_b32 exec_hi, 0xf000f
buffer_store_short v8, v128, s[20:23], s56 offen
L_mfin:
s_endpgm
L_pad_29:
s_setpc_b64 s[100:101]
L_xn:
v_mov_b32 v2, 126928
ds_write_b32 v2, v2
s_branch L_xnb
L_xsr:
s_sub_u32 s49, s49, 1
s_cbranch_scc1 L_xsgo
v_mov_b32 v228, 0
v_mov_b32 v229, 0
v_mov_b32 v230, 0
v_mov_b32 v231, 0
v_mov_b32 v232, 0
v_mov_b32 v233, 0
v_mov_b32 v234, 0
v_mov_b32 v235, 0
s_waitcnt lgkmcnt(0)
s_barrier
s_cmp_eq_u32 s32, 7
s_cbranch_scc0 L_np
ds_write_b32 v2, v228
s_branch L_xf
L_end:
s_endpgm
.section .rodata,"a"
.p2align 6
.amdhsa_kernel sequential_preLN__sliding_local_dilated__moe_arch_mod__prompt_kernel
  .amdhsa_next_free_vgpr 256
  .amdhsa_next_free_sgpr 102
  .amdhsa_accum_offset 256
  .amdhsa_group_segment_fixed_size 0
  .amdhsa_kernarg_size 88
  .amdhsa_user_sgpr_count 2
  .amdhsa_user_sgpr_kernarg_segment_ptr 1
  .amdhsa_system_sgpr_workgroup_id_x 1
  .amdhsa_float_denorm_mode_32 3
.end_amdhsa_kernel
```

```asm
; @launch grid=(256,1,1) block=(512,1,1) lds=163840
.amdgcn_target "amdgcn-amd-amdhsa--gfx950"
.text
.p2align 12
.globl sequential_preLN__sliding_local_dilated__moe_arch_mod__prompt_kernel
.p2align 8
.type sequential_preLN__sliding_local_dilated__moe_arch_mod__prompt_kernel,@function
sequential_preLN__sliding_local_dilated__moe_arch_mod__prompt_kernel:
s_load_dwordx16 s[44:59], s[0:1], 0
s_load_dwordx8 s[60:67], s[0:1], 56
s_lshr_b32 s34, s2, 3
s_and_b32 s33, s2, 7
v_readfirstlane_b32 s32, v0
s_getpc_b64 s[100:101]
L_pc:
s_mul_i32 s3, s34, 9
v_min_u32 v2, 8, v0
v_add_lshl_u32 v2, v2, s3, 7
v_min_u32 v2, L_end-L_pc, v2
s_cmp_ge_u32 s34, 30
s_cbranch_scc1 L_moe
global_load_dword v255, v2, s[100:101]
s_mul_i32 s35, s34, 26
s_lshr_b32 s35, s35, 8
s_mul_i32 s3, s35, 10
s_sub_u32 s36, s34, s3
s_lshr_b32 s32, s32, 6
s_lshl_b32 s3, s33, 2
s_lshr_b32 s3, 0x54327689, s3
s_and_b32 s41, s3, 15
s_add_u32 s3, s36, s41
s_sub_u32 s68, s3, 10
s_cselect_b32 s69, s3, s68
s_mul_i32 s3, s69, 245760
s_lshl_b32 s68, s36, 7
s_add_u32 s3, s3, s68
v_lshrrev_b32 v1, 3, v0
v_lshrrev_b32 v3, 4, v0
v_and_b32 v2, 2, v1
v_and_or_b32 v2, v3, 4, v2
v_xor_b32 v2, v2, v0
v_and_b32 v2, 7, v2
v_mul_u32_u24 v4, 3840, v1
v_lshl_add_u32 v4, v2, 4, v4
v_add_u32 v4, s3, v4
s_mul_i32 s3, s32, 3072
s_add_u32 m0, s3, 20480
v_and_b32 v0, 63, v0
s_and_b32 s38, s32, 3
s_lshr_b32 s3, s33, 1
s_lshl_b32 s3, s3, 9
s_mul_i32 s68, s35, 176
s_add_u32 s3, s3, s68
s_and_b32 s68, s33, 1
s_add_u32 s3, s3, s68
s_mul_i32 s39, s3, 1280
s_sub_u32 s42, s32, 5
s_mul_i32 s3, s42, 81920
s_add_u32 s3, s3, s39
s_sub_u32 s3, s3, 20480
v_lshrrev_b32 v1, 3, v0
v_lshrrev_b32 v3, 4, v0
v_xor_b32 v3, v3, v0
v_and_b32 v3, 7, v3
v_mul_u32_u24 v1, 2560, v1
v_lshl_add_u32 v1, v3, 4, v1
v_add_u32 v24, s3, v1
s_add_u32 s3, s42, s35
s_cmp_eq_u32 s3, 4
s_cselect_b32 s3, 0x80000000, 0
v_xor_b32 v25, 64, v24
v_add_u32 v25, 20480, v25
v_add_u32 v26, 40960, v24
v_add_u32 v27, 40960, v25
v_or_b32 v27, s3, v27
s_mov_b32 s6, 0x280000
s_mov_b32 s7, 0x20000
s_mov_b32 s10, 0x258000
s_mov_b32 s11, 0x20000
s_mov_b32 s14, 0xc8000
s_mov_b32 s15, 0x20000
s_mov_b32 s18, 0x10000000
s_mov_b32 s19, 0x20000
s_mov_b32 s22, 0x280000
s_mov_b32 s23, 0x20000
s_mov_b32 s26, 0x100
s_mov_b32 s27, 0x20000
s_mov_b32 s30, 0x500
s_mov_b32 s31, 0x20000
s_waitcnt lgkmcnt(0)
global_load_lds_dwordx4 v4, s[46:47]
s_addk_i32 m0, -256
s_mov_b64 s[4:5], s[44:45]
global_load_lds_dwordx4 v4, s[46:47] offset:1280
s_addk_i32 m0, -256
s_mov_b64 s[20:21], s[62:63]
global_load_lds_dwordx4 v4, s[46:47] offset:2560
s_mov_b64 s[24:25], s[64:65]
s_mov_b64 s[16:17], s[66:67]
s_mov_b64 s[8:9], s[46:47]
s_mov_b64 s[12:13], s[48:49]
s_mov_b64 s[28:29], s[52:53]
s_cmp_eq_u32 s32, 4
s_cselect_b64 s[96:97], s[54:55], s[58:59]
s_cmp_eq_u32 s32, 5
s_cselect_b64 s[96:97], s[56:57], s[96:97]
s_cmp_lt_u32 s32, 5
s_cbranch_scc1 L_nx
s_lshl_b32 s64, s42, 12
s_cselect_b32 s62, -1, 0xffffff00
s_lshl_b32 s63, s69, 7
s_mov_b32 s61, 8192
s_add_u32 m0, s61, s64
s_mov_b32 exec_lo, s62
buffer_load_dwordx4 v24, s[4:7], s63 offen lds
s_addk_i32 m0, 1024
s_mov_b32 exec_lo, -1
buffer_load_dwordx4 v25, s[4:7], s63 offen lds
s_addk_i32 m0, 1024
s_nop 0
buffer_load_dwordx4 v26, s[4:7], s63 offen lds
s_addk_i32 m0, 1024
s_nop 0
buffer_load_dwordx4 v27, s[4:7], s63 offen lds
L_nx:
v_mov_b32 v254, v4
s_mov_b32 s40, 524288
s_mul_i32 s43, s33, 3
s_add_u32 s43, s43, s35
s_sub_u32 s3, s36, 5
s_cselect_b32 s37, s36, s3
s_lshl_b32 s3, s32, 2
s_lshr_b32 s44, 0x32105454, s3
s_and_b32 s44, s44, 7
s_lshr_b32 s45, s38, 1
s_add_u32 s45, s45, 4
s_cmp_eq_u32 s35, 2
s_cselect_b32 s60, 10, 11
s_sub_u32 s57, 10, s41
v_lshlrev_b32 v233, 4, v0
s_mul_i32 s58, s43, 6
s_add_u32 s58, s58, s44
s_mul_i32 s58, s58, 2560
s_add_u32 s58, s58, 2097152
s_lshl_b32 s59, s33, 15
s_add_u32 s59, s59, 3145728
s_sub_u32 s51, 5, s37
s_add_u32 s1, s37, 1
s_sub_u32 s3, 15, s37
s_cmp_le_u32 s37, 2
s_cselect_b32 s46, 0, s3
s_cselect_b32 s47, s51, s1
s_cselect_b32 s48, s3, 0
s_cselect_b32 s49, s1, s51
s_cselect_b32 s50, 1, 0
v_and_b32 v3, 15, v0
v_add_u32 v3, 8, v3
v_lshrrev_b32 v4, 1, v3
v_lshrrev_b32 v5, 5, v0
v_xor_b32 v4, v4, v5
v_and_b32 v4, 7, v4
v_lshlrev_b32 v4, 4, v4
v_lshl_add_u32 v4, v3, 7, v4
v_bfe_u32 v5, v0, 4, 1
v_lshl_add_u32 v4, v5, 3, v4
s_lshl_b32 s3, s44, 11
v_add_u32 v235, s3, v4
s_cmp_lt_u32 s32, 4
s_cbranch_scc1 L_cons
s_add_u32 s69, s69, 1
s_cmp_eq_u32 s69, 10
s_cselect_b32 s69, 0, s69
s_lshl_b32 s63, s69, 7
s_mov_b32 s61, 45056
v_and_b32 v1, 15, v0
v_lshrrev_b32 v2, 4, v0
v_mov_b32 v7, 1792
s_mul_i32 s0, s44, 2304
s_movk_i32 s1, 144
v_bfe_u32 v3, v0, 2, 1
v_and_b32 v4, 3, v0
v_lshlrev_b32 v4, 1, v4
v_lshl_add_u32 v3, v3, 3, v4
v_bfe_u32 v4, v0, 3, 1
v_add_u32 v3, v3, v4
s_add_u32 s3, s0, 17408
v_mov_b32 v4, s3
v_mad_u32_u24 v3, v3, s1, v4
s_add_u32 s3, s0, 4736
v_mov_b32 v4, s3
v_mad_u32_u24 v4, v1, s1, v4
s_mov_b32 s52, 0xff00ff
s_mov_b32 s53, 0xff00ff
v_add_u32 v5, s51, v2
v_lshl_add_u32 v200, v5, 3, v3
v_lshl_add_u32 v5, v5, 3, v4
v_cndmask_b32 v204, v7, v5, s[52:53]
v_cndmask_b32 v205, v5, v7, s[52:53]
v_add_u32 v5, s46, v2
v_lshl_add_u32 v202, v5, 3, v3
v_lshl_add_u32 v5, v5, 3, v4
v_cmp_gt_u32 vcc, s47, v2
s_nop 1
v_cndmask_b32 v5, v7, v5, vcc
v_cndmask_b32 v206, v7, v5, s[52:53]
v_cndmask_b32 v207, v5, v7, s[52:53]
v_add_u32 v5, s48, v2
v_min_u32 v5, 15, v5
v_lshl_add_u32 v203, v5, 3, v3
v_lshl_add_u32 v5, v5, 3, v4
v_cmp_gt_u32 vcc, s49, v2
s_nop 1
v_cndmask_b32 v5, v7, v5, vcc
v_cndmask_b32 v208, v7, v5, s[52:53]
v_cndmask_b32 v209, v5, v7, s[52:53]
s_sub_u32 s3, s51, 1
v_mad_u32_u24 v5, v2, 5, s3
s_add_u32 s3, s46, 4
v_mov_b32 v6, s3
s_mov_b64 vcc, 0xffff
v_cndmask_b32 v5, v5, v6, vcc
v_min_u32 v5, 15, v5
v_lshl_add_u32 v201, v5, 3, v3
v_lshl_add_u32 v5, v5, 3, v4
s_cmp_eq_u32 s47, 5
s_cselect_b64 vcc, 0xff, 0
v_cndmask_b32 v210, v7, v5, vcc
s_lshl_b64 vcc, vcc, 8
v_cndmask_b32 v211, v7, v5, vcc
s_bfm_b64 vcc, 8, 16
v_cndmask_b32 v212, v7, v5, vcc
s_bfm_b64 vcc, 8, 24
v_cndmask_b32 v213, v7, v5, vcc
s_bfm_b64 vcc, 8, 32
v_cndmask_b32 v214, v7, v5, vcc
s_bfm_b64 vcc, 8, 40
v_cndmask_b32 v215, v7, v5, vcc
s_mul_i32 s0, s44, 2304
s_movk_i32 s1, 144
v_bfe_u32 v3, v0, 2, 3
v_lshrrev_b32 v4, 5, v0
v_lshl_add_u32 v3, v3, 1, v4
s_add_u32 s3, s0, 31232
v_mov_b32 v4, s3
v_mad_u32_u24 v3, v3, s1, v4
v_and_b32 v4, 3, v0
s_mov_b32 s54, 0x11111111
s_mov_b32 s55, 0x11111111
v_add_u32 v5, s51, v4
v_lshl_add_u32 v216, v5, 3, v3
v_add_u32 v7, 32, v216
s_cmp_eq_u32 s50, 1
s_cselect_b32 s3, -1, 12
s_cselect_b32 s56, 2, -1
v_add_u32 v5, s3, v4
v_lshl_add_u32 v5, v5, 3, v3
v_cndmask_b32 v217, v5, v7, s[54:55]
v_add_u32 v7, 40, v7
v_add_u32 v5, s56, v4
v_add_u32 v6, 10, v5
v_cmp_gt_i32 vcc, s51, v5
s_nop 1
v_cndmask_b32 v5, v6, v5, vcc
v_lshl_add_u32 v5, v5, 3, v3
v_cndmask_b32 v218, v5, v7, s[54:55]
s_lshl_b32 s0, s44, 8
v_lshrrev_b32 v4, 5, v0
v_and_or_b32 v3, v0, 8, v4
s_add_u32 s3, s0, 8
v_lshl_add_u32 v222, v3, 4, s3
v_and_b32 v1, 15, v0
s_add_u32 s3, s0, 132
v_lshl_add_u32 v223, v1, 4, s3
s_lshr_b32 s3, s39, 8
s_mul_i32 s3, s3, 52429
s_lshr_b32 s3, s3, 18
s_lshl_b32 s0, s44, 5
s_add_u32 s3, s3, s0
s_sub_u32 s3, 2047, s3
v_mad_i32_i24 v234, v1, -2, s3
v_lshrrev_b32 v2, 4, v0
v_and_or_b32 v3, v0, 8, v2
v_and_b32 v4, 0x70, v233
v_bfrev_b32 v6, 1
s_lshl_b32 s3, s45, 4
v_add_u32 v5, s3, v3
s_lshl_b32 s3, s60, 3
v_cmp_gt_u32 vcc, s3, v5
v_mul_u32_u24 v5, 2560, v5
v_add3_u32 v5, v5, v4, s39
v_cndmask_b32 v236, v6, v5, vcc
s_lshl_b32 s3, s44, 4
v_add_u32 v5, s3, v3
s_lshl_b32 s3, s60, 3
v_cmp_gt_u32 vcc, s3, v5
v_mul_u32_u24 v5, 2560, v5
v_add3_u32 v5, v5, v4, s39
v_cndmask_b32 v227, v6, v5, vcc
s_lshl_b32 s3, s36, 7
v_add_u32 v226, s3, v227
v_bfe_u32 v3, v0, 4, 1
v_cmp_eq_u32 s[54:55], s50, v3
s_cmp_lg_u32 s37, 0
s_cselect_b64 s[0:1], -1, s[54:55]
s_and_b64 vcc, vcc, s[0:1]
s_cmp_lg_u32 s37, 4
s_cselect_b64 s[0:1], 0, s[54:55]
s_andn2_b64 vcc, vcc, s[0:1]
v_cndmask_b32 v225, v6, v226, vcc
s_cmp_le_u32 s37, 3
s_cselect_b32 s3, 2560, 0
s_sub_u32 s3, s3, 128
v_mov_b32 v4, s3
s_cmp_ge_u32 s37, 2
s_cselect_b32 s3, 2560, 0
s_add_u32 s3, s3, 128
v_mov_b32 v5, s3
v_cndmask_b32 v4, v4, v5, s[54:55]
v_mul_u32_u24 v3, 2560, v3
v_sub_u32 v4, v4, v3
v_add_u32 v4, v4, v226
v_cndmask_b32 v224, v6, v4, vcc
v_and_b32 v1, 15, v0
v_bfrev_b32 v6, 1
v_bfe_u32 v3, v0, 4, 1
v_lshrrev_b32 v4, 5, v0
v_lshl_add_u32 v3, v3, 1, v4
s_lshl_b32 s3, s36, 7
v_lshl_add_u32 v4, v3, 4, s3
s_lshl_b32 s3, s44, 4
v_add_u32 v5, s3, v1
s_lshl_b32 s3, s60, 3
v_cmp_gt_u32 vcc, s3, v5
v_mul_u32_u24 v5, 2560, v5
v_add3_u32 v5, v5, v4, s39
v_cndmask_b32 v232, v6, v5, vcc
v_bfe_u32 v3, v0, 3, 2
v_lshlrev_b32 v3, 2, v3
v_and_or_b32 v3, v0, 3, v3
v_lshlrev_b32 v3, 3, v3
v_bfe_u32 v4, v0, 2, 2
v_lshl_add_u32 v3, v4, 7, v3
v_lshrrev_b32 v2, 4, v0
s_and_b32 s3, s32, 1
s_lshl_b32 s3, s3, 12
s_add_u32 s3, s3, 81920
v_lshl_add_u32 v4, v2, 10, v3
v_add_u32 v228, s3, v4
v_xor_b32 v229, 32, v228
v_xor_b32 v230, 64, v228
v_xor_b32 v231, 96, v228
s_mov_b32 s44, 0x0
s_mov_b32 s45, 0x1010101
s_mov_b32 s46, 0x3030303
s_mov_b32 s47, 0x7070707
s_mov_b32 s48, 0xf0f0f0f
s_mov_b32 s49, 0x1f1f1f1f
s_mov_b32 s50, 0x3f3f3f3f
s_mov_b32 s51, 0x7f7f7f7f
s_movk_i32 s54, 10240
s_mov_b32 s55, 0x07060501
s_mov_b32 s56, 0x0706000c
v_mov_b32 v5, 0xffff
v_mov_b32 v6, 0xffff0000
v_cndmask_b32 v1, 0, v5, s[44:45]
v_cndmask_b32 v4, 0, v6, s[46:47]
v_or_b32 v220, v1, v4
v_cndmask_b32 v1, 0, v5, s[48:49]
v_cndmask_b32 v4, 0, v6, s[50:51]
v_or_b32 v221, v1, v4
v_lshrrev_b32 v1, 3, v0
v_and_b32 v2, 2, v1
v_xor_b32 v2, v2, v0
s_lshl_b32 s3, s32, 2
v_xor_b32 v2, s3, v2
v_and_b32 v2, 7, v2
s_lshl_b32 s3, s36, 7
v_lshl_add_u32 v2, v2, 4, s3
v_and_b32 v3, 3, v1
v_mul_u32_u24 v3, 1280, v3
v_add_u32 v2, v3, v2
v_lshrrev_b32 v3, 5, v0
v_mul_u32_u24 v3, 5120, v3
v_sub_u32 v4, 5120, v3
v_mad_u32_u24 v56, v3, 5, v2
v_mad_u32_u24 v57, v3, 3, v2
v_mad_u32_u24 v58, v3, 13, v2
v_mad_u32_u24 v59, v4, 3, v2
v_mad_u32_u24 v60, v4, 13, v2
s_mul_i32 s3, s38, 3
v_lshrrev_b32 v1, 2, v0
v_add_u32 v1, s3, v1
s_add_u32 s3, s3, 3
s_min_u32 s3, s3, s60
v_cmp_gt_u32 vcc, s3, v1
v_and_b32 v2, 3, v0
v_lshl_add_u32 v1, v1, 3, v2
v_mul_u32_u24 v1, 2560, v1
s_lshl_b32 s0, s36, 7
s_add_u32 s3, s0, s39
v_add_u32 v1, s3, v1
v_bfrev_b32 v2, 1
v_cndmask_b32 v61, v2, v1, vcc
s_mul_i32 s3, s38, 3
v_min_u32 v1, 2, v0
v_add_u32 v1, s3, v1
v_lshrrev_b32 v2, 1, v1
v_mul_u32_u24 v2, 2304, v2
v_lshl_add_u32 v1, v1, 7, v2
s_mul_i32 s3, s43, 15360
s_lshl_b32 s0, s36, 8
s_add_u32 s3, s3, s0
s_add_u32 s3, s3, 2097152
v_add_u32 v63, s3, v1
s_mul_i32 s3, s34, 9
v_min_u32 v1, 8, v0
v_add_u32 v1, s3, v1
v_min_u32 v1, 255, v1
v_cmp_le_u32 vcc, 128, v1
v_mul_u32_u24 v1, 3072, v1
s_mul_i32 s3, s33, 384
s_add_u32 s3, s3, 1572864
v_add_u32 v1, s3, v1
v_subrev_u32 v2, 1376000, v1
v_cndmask_b32 v1, v1, v2, vcc
s_mul_i32 s3, s33, 60
s_lshl_b32 s0, s34, 1
s_add_u32 s3, s3, s0
s_and_b32 s0, s32, 1
s_add_u32 s3, s3, s0
s_lshl_b32 s3, s3, 12
v_min_u32 v2, 31, v0
v_lshl_add_u32 v2, v2, 7, s3
s_cmp_ge_u32 s32, 6
s_cselect_b64 vcc, -1, 0
v_cndmask_b32 v84, v1, v2, vcc
v_mov_b32 v176, 0
v_mov_b32 v177, 0
v_mov_b32 v178, 0
v_mov_b32 v179, 0
v_mov_b32 v180, 0
v_mov_b32 v181, 0
v_mov_b32 v182, 0
v_mov_b32 v183, 0
v_mov_b32 v184, 0
v_mov_b32 v185, 0
v_mov_b32 v186, 0
v_mov_b32 v187, 0
v_mov_b32 v188, 0
v_mov_b32 v189, 0
v_mov_b32 v190, 0
v_mov_b32 v191, 0
s_cmp_eq_u32 s32, 4
s_cbranch_scc1 L_h0
v_mov_b32 v4, 0x3f803f80
v_mov_b32 v5, v4
v_lshrrev_b32 v1, 4, v0
v_mul_u32_u24 v1, 36736, v1
v_lshl_add_u32 v1, v0, 3, v1
ds_write_b64 v1, v[4:5] offset:8192
s_sub_u32 s0, s32, 5
s_mul_i32 s3, s43, 3
s_add_u32 s3, s3, s0
s_mul_i32 s3, s3, 2560
s_add_u32 s67, s3, 2621440
s_mul_i32 s3, s35, 1280
s_add_u32 s3, s3, s59
s_add_u32 s66, s3, 12288
v_min_u32 v1, 9, v0
v_lshl_add_u32 v55, v1, 7, s66
s_lshl_b32 s68, s36, 7
s_add_u32 s68, s68, s66
v_and_b32 v1, 15, v0
v_lshrrev_b32 v2, 5, v0
v_lshl_add_u32 v2, v2, 4, v1
s_lshl_b32 s0, s0, 5
v_add_lshl_u32 v52, v2, s0, 4
v_lshrrev_b32 v2, 4, v0
v_lshrrev_b32 v3, 1, v1
v_xor_b32 v3, v3, v2
v_lshlrev_b32 v3, 4, v3
v_lshl_add_u32 v3, v1, 7, v3
v_add_u32 v54, s64, v3
s_cmp_lt_u32 s39, 2560
s_cselect_b32 s3, 128, 0
v_mov_b32 v1, 0xf149f2ca
v_cmp_gt_u32 vcc, s3, v52
s_nop 1
v_cndmask_b32 v53, 0, v1, vcc
s_setprio 1
s_add_u32 m0, s61, s64
s_mov_b32 exec_lo, s62
buffer_load_dwordx4 v24, s[4:7], s63 offen lds
s_addk_i32 m0, 1024
s_mov_b32 exec_lo, -1
buffer_load_dwordx4 v25, s[4:7], s63 offen lds
s_addk_i32 m0, 1024
s_nop 0
buffer_load_dwordx4 v26, s[4:7], s63 offen lds
s_addk_i32 m0, 1024
s_nop 0
buffer_load_dwordx4 v27, s[4:7], s63 offen lds
v_lshrrev_b32 v1, 4, v0
v_lshlrev_b32 v1, 3, v1
s_lshl_b32 s3, s36, 7
buffer_load_dwordx2 v[244:245], v1, s[28:31], s3 offen offset:0
buffer_load_dwordx2 v[246:247], v1, s[28:31], s3 offen offset:32
buffer_load_dwordx2 v[248:249], v1, s[28:31], s3 offen offset:64
buffer_load_dwordx2 v[250:251], v1, s[28:31], s3 offen offset:96
v_mov_b32 v64, 0x3f803f80
v_mov_b32 v65, 0x3f803f80
v_mov_b32 v66, 0x3f803f80
v_mov_b32 v67, 0x3f803f80
s_waitcnt vmcnt(8) lgkmcnt(0)
s_barrier
v_xor_b32 v1, 64, v54
ds_read_b128 v[36:39], v54 offset:8192
ds_read_b128 v[40:43], v1 offset:8192
ds_read_b128 v[44:47], v54 offset:10240
ds_read_b128 v[48:51], v1 offset:10240
s_lshl_b32 s3, s36, 8
s_add_u32 s3, s3, s67
v_and_b32 v2, 0xf0, v233
s_mov_b32 s0, 0xaaaaaaaa
s_mov_b32 s1, s0
s_mov_b32 vcc_lo, 0xcccccccc
s_mov_b32 vcc_hi, 0xcccccccc
s_waitcnt lgkmcnt(3)
v_mfma_f32_16x16x32_bf16 v[96:99], v[36:39], v[36:39], 0
v_mfma_f32_16x16x32_bf16 v[100:103], v[64:67], v[36:39], 0
s_waitcnt lgkmcnt(2)
v_mfma_f32_16x16x32_bf16 v[96:99], v[40:43], v[40:43], v[96:99]
v_mfma_f32_16x16x32_bf16 v[100:103], v[64:67], v[40:43], v[100:103]
s_waitcnt lgkmcnt(1)
v_mfma_f32_16x16x32_bf16 v[104:107], v[44:47], v[44:47], 0
v_mfma_f32_16x16x32_bf16 v[108:111], v[64:67], v[44:47], 0
s_waitcnt lgkmcnt(0)
v_mfma_f32_16x16x32_bf16 v[104:107], v[48:51], v[48:51], v[104:107]
v_mfma_f32_16x16x32_bf16 v[108:111], v[64:67], v[48:51], v[108:111]
s_nop 0
v_cndmask_b32 v96, v96, v97, s[0:1]
v_cndmask_b32 v98, v98, v99, s[0:1]
v_cndmask_b32 v29, v96, v98, vcc
v_mov_b32 v28, v100
s_nop 1
v_cndmask_b32 v104, v104, v105, s[0:1]
v_cndmask_b32 v106, v106, v107, s[0:1]
v_cndmask_b32 v31, v104, v106, vcc
v_mov_b32 v30, v108
s_mov_b32 exec_lo, 0xf0000f
s_mov_b32 exec_hi, 0xf0000f00
buffer_store_dwordx4 v[28:31], v2, s[16:19], s3 offen sc1
s_mov_b64 exec, -1
v_mov_b32 v44, 0
v_mov_b32 v45, 0
v_mov_b32 v46, 0
v_mov_b32 v47, 0
s_add_u32 s69, s69, 1
s_cmp_eq_u32 s69, 10
s_cselect_b32 s69, 0, s69
s_lshl_b32 s63, s69, 7
s_mov_b32 s61, 81920
s_add_u32 m0, s61, s64
s_mov_b32 exec_lo, s62
buffer_load_dwordx4 v24, s[4:7], s63 offen lds
s_addk_i32 m0, 1024
s_mov_b32 exec_lo, -1
buffer_load_dwordx4 v25, s[4:7], s63 offen lds
s_addk_i32 m0, 1024
s_nop 0
buffer_load_dwordx4 v26, s[4:7], s63 offen lds
s_addk_i32 m0, 1024
s_nop 0
buffer_load_dwordx4 v27, s[4:7], s63 offen lds
s_branch L_pb_1
.p2align 12
L_pad_2:
s_setpc_b64 s[100:101]
L_pb_1:
s_waitcnt vmcnt(5) lgkmcnt(0)
s_cmp_eq_u32 s32, 5
s_cbranch_scc0 L_o5a
s_lshl_b32 s0, s33, 5
v_and_b32 v1, 16, v0
buffer_load_dword v32, v1, s[24:27], s0 offen sc1
L_o5a:
s_barrier
s_mul_i32 s3, s2, 3
s_add_u32 s3, s3, s32
s_sub_u32 s3, s3, 5
s_mul_i32 s3, s3, 1152
v_lshlrev_b32 v1, 7, v0
s_mov_b64 exec, 0x1ff
buffer_load_dword v255, v1, s[12:15], s3 offen
s_mov_b64 exec, -1
s_add_u32 s69, s69, 1
s_cmp_eq_u32 s69, 10
s_cselect_b32 s69, 0, s69
s_lshl_b32 s63, s69, 7
s_mov_b32 s61, 118784
s_add_u32 m0, s61, s64
s_mov_b32 exec_lo, s62
buffer_load_dwordx4 v24, s[4:7], s63 offen lds
s_addk_i32 m0, 1024
s_mov_b32 exec_lo, -1
buffer_load_dwordx4 v25, s[4:7], s63 offen lds
s_addk_i32 m0, 1024
s_nop 0
buffer_load_dwordx4 v26, s[4:7], s63 offen lds
s_addk_i32 m0, 1024
s_nop 0
buffer_load_dwordx4 v27, s[4:7], s63 offen lds
s_cmp_eq_u32 s57, 1
s_cbranch_scc0 L_xc1
s_mov_b32 s0, 45056
s_call_b64 s[100:101], L_xcap
L_xc1:
s_cmp_eq_u32 s32, 7
s_cbranch_scc0 L_wm1
s_call_b64 s[100:101], L_pad_8
s_call_b64 s[100:101], L_pad_24
L_wm1:
s_waitcnt vmcnt(5) lgkmcnt(0)
s_barrier
s_cmp_eq_u32 s32, 5
s_cbranch_scc0 L_o5c
s_waitcnt lgkmcnt(0)
v_cmp_ne_u32 vcc, 1, v32
s_cmp_eq_u64 vcc, 0
s_cbranch_scc0 L_era
L_ega:
s_getreg_b32 s0, hwreg(HW_REG_XCC_ID, 0, 4)
v_mov_b32 v1, s0
s_mov_b64 exec, 1
buffer_store_dword v1, off, s[16:19], s68 sc1
s_mov_b64 exec, -1
L_o5c:
s_add_u32 s69, s69, 1
s_cmp_eq_u32 s69, 10
s_cselect_b32 s69, 0, s69
s_lshl_b32 s63, s69, 7
s_mov_b32 s61, 8192
s_add_u32 m0, s61, s64
s_mov_b32 exec_lo, s62
buffer_load_dwordx4 v24, s[4:7], s63 offen lds
s_addk_i32 m0, 1024
s_mov_b32 exec_lo, -1
buffer_load_dwordx4 v25, s[4:7], s63 offen lds
s_addk_i32 m0, 1024
s_nop 0
buffer_load_dwordx4 v26, s[4:7], s63 offen lds
s_addk_i32 m0, 1024
s_nop 0
buffer_load_dwordx4 v27, s[4:7], s63 offen lds
s_cmp_eq_u32 s57, 2
s_cbranch_scc0 L_xc2
s_mov_b32 s0, 81920
s_call_b64 s[100:101], L_xcap
L_xc2:
s_cmp_eq_u32 s32, 7
s_cbranch_scc0 L_wm2
s_call_b64 s[100:101], L_pad_11
s_call_b64 s[100:101], L_pad_25
L_wm2:
s_cmp_eq_u32 s32, 5
s_cbranch_scc1 L_w52
s_waitcnt vmcnt(4)
L_w52:
s_waitcnt vmcnt(5) lgkmcnt(0)
s_barrier
s_add_u32 s69, s69, 1
s_cmp_eq_u32 s69, 10
s_cselect_b32 s69, 0, s69
s_lshl_b32 s63, s69, 7
s_mov_b32 s61, 45056
s_add_u32 m0, s61, s64
s_mov_b32 exec_lo, s62
buffer_load_dwordx4 v24, s[4:7], s63 offen lds
s_addk_i32 m0, 1024
s_mov_b32 exec_lo, -1
buffer_load_dwordx4 v25, s[4:7], s63 offen lds
s_addk_i32 m0, 1024
s_nop 0
buffer_load_dwordx4 v26, s[4:7], s63 offen lds
s_addk_i32 m0, 1024
s_nop 0
buffer_load_dwordx4 v27, s[4:7], s63 offen lds
s_cmp_eq_u32 s57, 3
s_cbranch_scc0 L_xc3
s_mov_b32 s0, 118784
s_call_b64 s[100:101], L_xcap
L_xc3:
s_cmp_eq_u32 s32, 7
s_cbranch_scc0 L_wm3
s_call_b64 s[100:101], L_pad_12
L_wm3:
s_waitcnt vmcnt(4) lgkmcnt(0)
s_barrier
s_add_u32 s69, s69, 1
s_cmp_eq_u32 s69, 10
s_cselect_b32 s69, 0, s69
s_lshl_b32 s63, s69, 7
s_mov_b32 s61, 81920
s_add_u32 m0, s61, s64
s_mov_b32 exec_lo, s62
buffer_load_dwordx4 v24, s[4:7], s63 offen lds
s_addk_i32 m0, 1024
s_mov_b32 exec_lo, -1
buffer_load_dwordx4 v25, s[4:7], s63 offen lds
s_addk_i32 m0, 1024
s_nop 0
buffer_load_dwordx4 v26, s[4:7], s63 offen lds
s_addk_i32 m0, 1024
s_nop 0
buffer_load_dwordx4 v27, s[4:7], s63 offen lds
s_cmp_eq_u32 s57, 4
s_cbranch_scc0 L_xc4
s_mov_b32 s0, 8192
s_call_b64 s[100:101], L_xcap
L_xc4:
s_cmp_eq_u32 s32, 7
s_cbranch_scc0 L_wm4
s_call_b64 s[100:101], L_pad_13
L_wm4:
s_waitcnt vmcnt(4) lgkmcnt(0)
s_cmp_eq_u32 s32, 5
s_cbranch_scc0 L_o5b
s_buffer_load_dword s71, s[16:19], s66 offset:0 glc
s_buffer_load_dword s73, s[16:19], s66 offset:128 glc
s_buffer_load_dword s75, s[16:19], s66 offset:256 glc
s_buffer_load_dword s77, s[16:19], s66 offset:384 glc
s_buffer_load_dword s83, s[16:19], s66 offset:512 glc
s_buffer_load_dword s85, s[16:19], s66 offset:640 glc
s_buffer_load_dword s89, s[16:19], s66 offset:768 glc
s_buffer_load_dword s91, s[16:19], s66 offset:896 glc
s_buffer_load_dword s93, s[16:19], s66 offset:1024 glc
s_buffer_load_dword s95, s[16:19], s66 offset:1152 glc
L_o5b:
s_barrier
s_add_u32 s69, s69, 1
s_cmp_eq_u32 s69, 10
s_cselect_b32 s69, 0, s69
s_lshl_b32 s63, s69, 7
s_mov_b32 s61, 118784
s_add_u32 m0, s61, s64
s_mov_b32 exec_lo, s62
buffer_load_dwordx4 v24, s[4:7], s63 offen lds
s_addk_i32 m0, 1024
s_mov_b32 exec_lo, -1
buffer_load_dwordx4 v25, s[4:7], s63 offen lds
s_addk_i32 m0, 1024
s_nop 0
buffer_load_dwordx4 v26, s[4:7], s63 offen lds
s_addk_i32 m0, 1024
s_nop 0
buffer_load_dwordx4 v27, s[4:7], s63 offen lds
s_cmp_eq_u32 s57, 5
s_cbranch_scc0 L_xc5
s_mov_b32 s0, 45056
s_call_b64 s[100:101], L_xcap
L_xc5:
s_cmp_eq_u32 s32, 5
s_cbranch_scc0 L_o5d
s_waitcnt lgkmcnt(0)
s_max_u32 s0, s71, s73
s_max_u32 s0, s0, s75
s_max_u32 s0, s0, s77
s_max_u32 s0, s0, s83
s_max_u32 s0, s0, s85
s_max_u32 s0, s0, s89
s_max_u32 s0, s0, s91
s_max_u32 s0, s0, s93
s_max_u32 s0, s0, s95
s_cmp_lg_u32 s0, -1
s_cbranch_scc0 L_erb
L_egb:
s_min_u32 s1, s71, s73
s_min_u32 s1, s1, s75
s_min_u32 s1, s1, s77
s_min_u32 s1, s1, s83
s_min_u32 s1, s1, s85
s_min_u32 s1, s1, s89
s_min_u32 s1, s1, s91
s_min_u32 s1, s1, s93
s_min_u32 s1, s1, s95
s_cmp_eq_u32 s0, s1
s_cselect_b32 s0, 1, 0
v_mov_b32 v1, 1728
v_mov_b32 v2, s0
ds_write_b32 v1, v2
L_o5d:
s_cmp_eq_u32 s32, 7
s_cbranch_scc0 L_wm5
s_call_b64 s[100:101], L_pad_14
L_wm5:
s_waitcnt vmcnt(4) lgkmcnt(0)
s_barrier
buffer_load_dwordx4 v[36:39], v233, s[16:19], s67 offen offset:0 sc1
buffer_load_dwordx4 v[40:43], v233, s[16:19], s67 offen offset:1024 sc1
s_mov_b32 exec_hi, 0
buffer_load_dwordx4 v[44:47], v233, s[16:19], s67 offen offset:2048 sc1
s_mov_b32 exec_hi, -1
s_add_u32 s69, s69, 1
s_cmp_eq_u32 s69, 10
s_cselect_b32 s69, 0, s69
s_lshl_b32 s63, s69, 7
s_mov_b32 s61, 8192
s_add_u32 m0, s61, s64
s_mov_b32 exec_lo, s62
buffer_load_dwordx4 v24, s[4:7], s63 offen lds
s_addk_i32 m0, 1024
s_mov_b32 exec_lo, -1
buffer_load_dwordx4 v25, s[4:7], s63 offen lds
s_addk_i32 m0, 1024
s_nop 0
buffer_load_dwordx4 v26, s[4:7], s63 offen lds
s_addk_i32 m0, 1024
s_nop 0
buffer_load_dwordx4 v27, s[4:7], s63 offen lds
s_cmp_eq_u32 s57, 6
s_cbranch_scc0 L_xc6
s_mov_b32 s0, 81920
s_call_b64 s[100:101], L_xcap
L_xc6:
s_cmp_eq_u32 s32, 7
s_cbranch_scc0 L_wm6
s_call_b64 s[100:101], L_pad_21
L_wm6:
s_waitcnt vmcnt(7) lgkmcnt(0)
s_barrier
s_add_u32 s69, s69, 1
s_cmp_eq_u32 s69, 10
s_cselect_b32 s69, 0, s69
s_lshl_b32 s63, s69, 7
s_mov_b32 s61, 45056
s_add_u32 m0, s61, s64
s_mov_b32 exec_lo, s62
buffer_load_dwordx4 v24, s[4:7], s63 offen lds
s_addk_i32 m0, 1024
s_mov_b32 exec_lo, -1
buffer_load_dwordx4 v25, s[4:7], s63 offen lds
s_addk_i32 m0, 1024
s_nop 0
buffer_load_dwordx4 v26, s[4:7], s63 offen lds
s_addk_i32 m0, 1024
s_nop 0
buffer_load_dwordx4 v27, s[4:7], s63 offen lds
s_cmp_eq_u32 s57, 7
s_cbranch_scc0 L_xc7
s_mov_b32 s0, 118784
s_call_b64 s[100:101], L_xcap
L_xc7:
s_waitcnt vmcnt(8)
v_add_f32 v36, v36, v40
v_add_f32 v37, v37, v41
v_add_f32 v38, v38, v42
v_add_f32 v39, v39, v43
v_add_f32 v36, v36, v44
v_add_f32 v37, v37, v45
v_add_f32 v38, v38, v46
v_add_f32 v39, v39, v47
s_nop 0
v_permlane32_swap_b32 v36, v38
v_permlane32_swap_b32 v37, v39
v_add_f32 v36, v36, v38
v_add_f32 v37, v37, v39
v_mov_b32 v38, v36
v_mov_b32 v39, v37
s_mov_b32 s1, 0x3acccccd
v_mov_b32 v1, 0x3727c5ac
v_permlane16_swap_b32 v36, v38
v_permlane16_swap_b32 v37, v39
v_add_f32 v36, v36, v38
v_add_f32 v37, v37, v39
v_mul_f32 v36, 0xbacccccd, v36
v_fma_f32 v2, v37, s1, v1
v_fma_f32 v2, -v36, v36, v2
v_max_f32 v2, v2, v1
v_rsq_f32 v37, v2
v_mov_b32 v39, v53
v_mov_b32 v38, v37
ds_write_b128 v52, v[36:39] offset:0
s_waitcnt vmcnt(4) lgkmcnt(0)
s_barrier
s_cmp_eq_u32 s57, 8
s_cbranch_scc0 L_xc8
s_mov_b32 s0, 8192
s_call_b64 s[100:101], L_xcap
L_xc8:
L_h8:
s_mul_i32 s66, s38, 5120
s_lshl_b32 s3, s38, 10
s_add_u32 m0, s3, 81920
s_add_u32 s3, s66, 25600
buffer_load_dwordx4 v56, s[12:15], s3 offen lds
s_addk_i32 m0, 4096
s_add_u32 s3, s66, 102400
buffer_load_dwordx4 v56, s[12:15], s3 offen lds
s_addk_i32 m0, 4096
s_add_u32 s3, s66, 179200
buffer_load_dwordx4 v56, s[12:15], s3 offen lds
s_addk_i32 m0, 4096
s_add_u32 s3, s66, 256000
buffer_load_dwordx4 v56, s[12:15], s3 offen lds
s_addk_i32 m0, 4096
s_add_u32 s3, s66, 332800
buffer_load_dwordx4 v56, s[12:15], s3 offen lds
s_addk_i32 m0, 4096
s_add_u32 s3, s66, 435200
buffer_load_dwordx4 v56, s[12:15], s3 offen lds
s_addk_i32 m0, 4096
s_add_u32 s3, s66, 512000
buffer_load_dwordx4 v56, s[12:15], s3 offen lds
s_addk_i32 m0, 4096
s_add_u32 s3, s66, 588800
buffer_load_dwordx4 v56, s[12:15], s3 offen lds
v_add_u32 v1, 128, v222
v_cndmask_b32 v2, v1, v222, s[44:45]
ds_read_b64 v[168:169], v2 offset:0
v_cndmask_b32 v2, v1, v222, s[46:47]
ds_read_b64 v[170:171], v2 offset:32
v_cndmask_b32 v2, v1, v222, s[48:49]
ds_read_b64 v[172:173], v2 offset:64
v_cndmask_b32 v2, v1, v222, s[50:51]
ds_read_b64 v[174:175], v2 offset:96
ds_read_b32 v5, v223
v_mov_b32 v1, 1728
ds_read_b32 v1, v1
s_waitcnt lgkmcnt(0)
v_readfirstlane_b32 s41, v1
s_waitcnt vmcnt(8)
s_barrier
s_cmp_eq_u32 s41, 1
s_cbranch_scc0 L_gh_3g
L_gh_3b:
s_addk_i32 m0, 4096
s_add_u32 s3, s66, 665600
buffer_load_dwordx4 v56, s[12:15], s3 offen lds
s_addk_i32 m0, 4096
s_add_u32 s3, s66, 742400
buffer_load_dwordx4 v56, s[12:15], s3 offen lds
buffer_load_dword v62, v61, s[20:23], s54 offen
buffer_load_dword v63, v63, s[16:19], 0 offen
global_load_dword v84, v84, s[96:97]
v_lshlrev_b32 v8, 16, v72
v_and_b32 v9, 0xffff0000, v72
v_lshlrev_b32 v10, 16, v73
v_and_b32 v11, 0xffff0000, v73
v_lshlrev_b32 v12, 16, v74
v_and_b32 v13, 0xffff0000, v74
v_lshlrev_b32 v14, 16, v75
v_and_b32 v15, 0xffff0000, v75
v_lshlrev_b32 v16, 16, v76
v_and_b32 v17, 0xffff0000, v76
v_lshlrev_b32 v18, 16, v77
v_and_b32 v19, 0xffff0000, v77
v_lshlrev_b32 v20, 16, v78
v_and_b32 v21, 0xffff0000, v78
v_lshlrev_b32 v22, 16, v79
v_and_b32 v23, 0xffff0000, v79
s_mov_b32 s3, 0x3f803f80
v_mov_b32 v64, s3
v_mov_b32 v65, s3
v_mov_b32 v66, s3
v_mov_b32 v67, s3
s_mov_b32 exec_lo, 0x11111111
s_mov_b32 exec_hi, 0x11111111
v_mov_b32 v244, s3
v_mov_b32 v245, s3
v_mov_b32 v246, s3
v_mov_b32 v247, s3
v_mov_b32 v248, s3
v_mov_b32 v249, s3
v_mov_b32 v250, s3
v_mov_b32 v251, s3
s_mov_b64 exec, -1
v_mfma_f32_16x16x32_bf16 v[252:255], v[244:247], v[64:67], 0
v_mfma_f32_16x16x32_bf16 v[252:255], v[248:251], v[64:67], v[252:255]
s_and_b32 s3, s32, 1
s_lshl_b32 s61, s3, 7
s_xor_b32 s62, s61, 128
s_add_u32 s63, s62, s54
s_add_u32 s64, s61, s54
s_lshl_b32 s3, s3, 13
s_sub_u32 s65, 4096, s3
s_add_u32 s0, s37, 1
s_sub_u32 s1, 5, s37
s_min_u32 s0, s0, s1
s_lshl_b32 s0, s0, 4
s_sub_u32 s1, 64, s0
s_cmp_le_u32 s37, 2
s_cselect_b32 s1, s1, 16
s_bfm_b64 s[100:101], s0, s1
v_mul_f32 v5, 0x3ea52b5c, v5
s_barrier
ds_read_b64 v[96:97], v202 offset:0
ds_read_b64 v[98:99], v202 offset:1152
ds_read_b64 v[100:101], v203 offset:0
ds_read_b64 v[102:103], v203 offset:1152
ds_read_b64 v[104:105], v201 offset:0
ds_read_b64 v[106:107], v201 offset:1152
ds_read_b64 v[108:109], v200 offset:0
ds_read_b64 v[110:111], v200 offset:1152
ds_read_b64 v[112:113], v200 offset:40
ds_read_b64 v[114:115], v200 offset:1192
s_cmp_eq_u32 s38, 1
s_cbranch_scc1 L_woe1
s_cmp_eq_u32 s38, 2
s_cbranch_scc1 L_woe2
s_cmp_eq_u32 s38, 3
s_cbranch_scc1 L_woe3
s_addk_i32 m0, 4096
s_mov_b32 s3, 46080
buffer_load_dwordx4 v56, s[12:15], s3 offen lds
s_addk_i32 m0, 4096
s_mov_b32 s3, 122880
buffer_load_dwordx4 v56, s[12:15], s3 offen lds
s_addk_i32 m0, 4096
s_mov_b32 s3, 199680
buffer_load_dwordx4 v56, s[12:15], s3 offen lds
s_addk_i32 m0, 4096
s_mov_b32 s3, 276480
buffer_load_dwordx4 v56, s[12:15], s3 offen lds
s_addk_i32 m0, 4096
s_mov_b32 s3, 353280
buffer_load_dwordx4 v56, s[12:15], s3 offen lds
s_addk_i32 m0, 4096
s_mov_b32 s3, 455680
buffer_load_dwordx4 v56, s[12:15], s3 offen lds
s_addk_i32 m0, 4096
s_mov_b32 s3, 532480
buffer_load_dwordx4 v56, s[12:15], s3 offen lds
s_addk_i32 m0, 4096
s_mov_b32 s3, 609280
buffer_load_dwordx4 v56, s[12:15], s3 offen lds
s_addk_i32 m0, 4096
s_mov_b32 s3, 686080
buffer_load_dwordx4 v56, s[12:15], s3 offen lds
s_addk_i32 m0, 4096
s_mov_b32 s3, 762880
buffer_load_dwordx4 v56, s[12:15], s3 offen lds
L_woe:
buffer_load_dword v62, v61, s[20:23], 0 offen
s_setprio 1
s_waitcnt vmcnt(16)
s_barrier
ds_read_b64 v[116:117], v206 offset:0
ds_read_b64 v[118:119], v207 offset:0
ds_read_b64 v[120:121], v208 offset:0
ds_read_b64 v[122:123], v209 offset:0
ds_read_b64 v[124:125], v210 offset:0
ds_read_b64 v[126:127], v211 offset:0
ds_read_b64 v[128:129], v204 offset:0
ds_read_b64 v[130:131], v205 offset:0
ds_read_b64 v[132:133], v204 offset:40
ds_read_b64 v[134:135], v205 offset:40
s_waitcnt lgkmcnt(8)
v_mfma_f32_16x16x32_bf16 v[152:155], v[96:99], v[116:119], 0
ds_read_b64 v[136:137], v212 offset:0
ds_read_b64 v[138:139], v213 offset:0
s_waitcnt lgkmcnt(8)
v_mfma_f32_16x16x32_bf16 v[156:159], v[100:103], v[120:123], 0
ds_read_b64 v[140:141], v214 offset:0
ds_read_b64 v[142:143], v215 offset:0
s_waitcnt lgkmcnt(8)
v_mfma_f32_16x16x32_bf16 v[152:155], v[104:107], v[124:127], v[152:155]
s_waitcnt lgkmcnt(6)
v_mfma_f32_16x16x32_bf16 v[160:163], v[108:111], v[128:131], 0
s_waitcnt lgkmcnt(4)
v_mfma_f32_16x16x32_bf16 v[164:167], v[112:115], v[132:135], 0
s_waitcnt lgkmcnt(2)
v_mfma_f32_16x16x32_bf16 v[160:163], v[104:107], v[136:139], v[160:163]
s_waitcnt lgkmcnt(0)
v_mfma_f32_16x16x32_bf16 v[164:167], v[104:107], v[140:143], v[164:167]
v_permlane16_swap_b32 v152, v156
v_permlane16_swap_b32 v153, v157
v_permlane16_swap_b32 v154, v158
v_permlane16_swap_b32 v155, v159
v_cndmask_b32 v2, v156, v152, s[44:45]
v_cndmask_b32 v3, v157, v153, s[46:47]
v_cndmask_b32 v194, v158, v154, s[48:49]
v_cndmask_b32 v195, v159, v155, s[50:51]
v_or_b32 v192, 0xffff, v2
v_perm_b32 v193, v3, v2, s55
s_cmp_eq_u32 s41, 1
s_cbranch_scc0 L_gl_4g
buffer_store_dwordx4 v[192:195], v224, s[20:23], s54 offen
L_gl_4b:
v_permlane16_swap_b32 v160, v164
v_permlane16_swap_b32 v161, v165
v_permlane16_swap_b32 v162, v166
v_permlane16_swap_b32 v163, v167
v_cndmask_b32 v196, v164, v160, s[44:45]
v_cndmask_b32 v197, v165, v161, s[46:47]
v_cndmask_b32 v198, v166, v162, s[48:49]
v_cndmask_b32 v199, v167, v163, s[50:51]
v_fma_f32 v196, v196, v168, v169
v_fma_f32 v197, v197, v170, v171
v_fma_f32 v198, v198, v172, v173
v_fma_f32 v199, v199, v174, v175
v_max3_f32 v6, v196, v197, v198
v_max_f32 v6, v6, v199
v_mov_b32 v7, v6
s_nop 1
v_permlane32_swap_b32 v6, v7
v_max_f32 v6, v6, v7
v_mul_f32 v6, v6, v5
v_fma_f32 v196, v196, v5, -v6
v_fma_f32 v197, v197, v5, -v6
v_fma_f32 v198, v198, v5, -v6
v_fma_f32 v199, v199, v5, -v6
v_exp_f32 v196, v196
v_exp_f32 v197, v197
v_exp_f32 v198, v198
v_exp_f32 v199, v199
ds_read_b64_tr_b16 v[64:65], v216 offset:0
ds_read_b64_tr_b16 v[66:67], v216 offset:1152
ds_read_b64_tr_b16 v[68:69], v216 offset:40
ds_read_b64_tr_b16 v[70:71], v216 offset:1192
ds_read_b64_tr_b16 v[72:73], v217 offset:0
ds_read_b64_tr_b16 v[74:75], v217 offset:1152
ds_read_b64_tr_b16 v[76:77], v218 offset:0
ds_read_b64_tr_b16 v[78:79], v218 offset:1152
v_add_f32 v6, v196, v197
v_add_f32 v7, v198, v199
v_add_f32 v6, v6, v7
v_mov_b32 v7, v6
v_mul_f32 v196, v196, v168
v_mul_f32 v197, v197, v170
v_permlane32_swap_b32 v6, v7
v_mul_f32 v198, v198, v172
v_add_f32 v6, v6, v7
v_rcp_f32 v6, v6
v_mul_f32 v199, v199, v174
v_mul_f32 v196, v196, v6
v_mul_f32 v197, v197, v6
v_mul_f32 v198, v198, v6
v_mul_f32 v199, v199, v6
v_cvt_pk_bf16_f32 v196, v196, v197
v_cvt_pk_bf16_f32 v197, v198, v199
s_mov_b64 exec, s[52:53]
v_and_b32 v176, v220, v196
v_bfi_b32 v180, v220, 0, v196
v_and_b32 v177, v221, v197
v_bfi_b32 v181, v221, 0, v197
s_not_b64 exec, exec
v_and_b32 v178, v220, v196
v_bfi_b32 v182, v220, 0, v196
v_and_b32 v179, v221, v197
v_bfi_b32 v183, v221, 0, v197
s_mov_b64 exec, -1
v_permlane16_swap_b32 v176, v180
v_permlane16_swap_b32 v177, v181
v_permlane16_swap_b32 v178, v182
v_permlane16_swap_b32 v179, v183
buffer_load_dwordx4 v[92:95], v225, s[20:23], s54 offen sc1
s_waitcnt lgkmcnt(0)
v_mfma_f32_16x16x32_bf16 v[152:155], v[64:67], v[176:179], 0
v_mfma_f32_16x16x32_bf16 v[156:159], v[68:71], v[180:183], 0
v_mfma_f32_16x16x32_bf16 v[160:163], v[72:75], v[176:179], 0
v_mfma_f32_16x16x32_bf16 v[164:167], v[76:79], v[180:183], 0
s_nop 4
v_cvt_pk_bf16_f32 v196, v152, v153
v_cvt_pk_bf16_f32 v197, v154, v155
v_cvt_pk_bf16_f32 v198, v156, v157
v_cvt_pk_bf16_f32 v199, v158, v159
s_cmp_eq_u32 s41, 1
s_cbranch_scc0 L_gl_5g
buffer_store_dwordx4 v[196:199], v226, s[20:23], 0 offen
L_gl_5b:
v_cvt_pk_bf16_f32 v80, v160, v161
v_cvt_pk_bf16_f32 v81, v162, v163
v_cvt_pk_bf16_f32 v82, v164, v165
v_cvt_pk_bf16_f32 v83, v166, v167
ds_read_b64_tr_b16 v[104:105], v228 offset:0
ds_read_b64_tr_b16 v[106:107], v228 offset:512
ds_read_b64_tr_b16 v[108:109], v229 offset:0
ds_read_b64_tr_b16 v[110:111], v229 offset:512
ds_read_b64_tr_b16 v[112:113], v230 offset:0
ds_read_b64_tr_b16 v[114:115], v230 offset:512
ds_read_b64_tr_b16 v[116:117], v231 offset:0
ds_read_b64_tr_b16 v[118:119], v231 offset:512
ds_read_b64_tr_b16 v[120:121], v228 offset:8192
ds_read_b64_tr_b16 v[122:123], v228 offset:8704
ds_read_b64_tr_b16 v[124:125], v229 offset:8192
ds_read_b64_tr_b16 v[126:127], v229 offset:8704
ds_read_b64_tr_b16 v[128:129], v230 offset:8192
ds_read_b64_tr_b16 v[130:131], v230 offset:8704
ds_read_b64_tr_b16 v[132:133], v231 offset:8192
ds_read_b64_tr_b16 v[134:135], v231 offset:8704
ds_read_b64_tr_b16 v[136:137], v228 offset:16384
ds_read_b64_tr_b16 v[138:139], v228 offset:16896
ds_read_b64_tr_b16 v[140:141], v229 offset:16384
ds_read_b64_tr_b16 v[142:143], v229 offset:16896
ds_read_b64_tr_b16 v[144:145], v230 offset:16384
ds_read_b64_tr_b16 v[146:147], v230 offset:16896
ds_read_b64_tr_b16 v[148:149], v231 offset:16384
ds_read_b64_tr_b16 v[150:151], v231 offset:16896
s_waitcnt vmcnt(1)
v_cmp_eq_u32 vcc, -1, v92
s_cbranch_vccnz L_h0rh
L_h0gh:
v_mov_b32 v1, 1744
v_mov_b32 v4, 1
s_mov_b64 exec, 1
ds_add_u32 v1, v4
s_mov_b64 exec, -1
v_perm_b32 v92, v92, v93, s56
v_add_f32 v193, v3, v93
v_add_f32 v194, v194, v94
v_add_f32 v195, v195, v95
v_add_f32 v192, v2, v92
v_fma_f32 v192, v192, v168, v169
v_fma_f32 v193, v193, v170, v171
v_fma_f32 v194, v194, v172, v173
v_fma_f32 v195, v195, v174, v175
v_max3_f32 v6, v192, v193, v194
v_max_f32 v6, v6, v195
v_mov_b32 v7, v6
s_nop 1
v_permlane32_swap_b32 v6, v7
v_max_f32 v6, v6, v7
v_mul_f32 v6, v6, v5
v_fma_f32 v192, v192, v5, -v6
v_fma_f32 v193, v193, v5, -v6
v_fma_f32 v194, v194, v5, -v6
v_fma_f32 v195, v195, v5, -v6
v_exp_f32 v192, v192
v_exp_f32 v193, v193
v_exp_f32 v194, v194
v_exp_f32 v195, v195
buffer_load_dwordx4 v[24:27], v227, s[20:23], s61 offen offset:0 sc1
buffer_load_dwordx4 v[28:31], v227, s[20:23], s61 offen offset:256 sc1
buffer_load_dwordx4 v[32:35], v227, s[20:23], s61 offen offset:512 sc1
buffer_load_dwordx4 v[36:39], v227, s[20:23], s61 offen offset:768 sc1
buffer_load_dwordx4 v[40:43], v227, s[20:23], s61 offen offset:1024 sc1
buffer_load_dwordx4 v[44:47], v227, s[20:23], s62 offen offset:0 sc1
v_add_f32 v6, v192, v193
v_add_f32 v7, v194, v195
v_add_f32 v6, v6, v7
v_mov_b32 v7, v6
v_mul_f32 v192, v192, v168
v_mul_f32 v193, v193, v170
v_permlane32_swap_b32 v6, v7
v_mul_f32 v194, v194, v172
v_add_f32 v6, v6, v7
v_rcp_f32 v6, v6
v_mul_f32 v195, v195, v174
v_mul_f32 v192, v192, v6
v_mul_f32 v193, v193, v6
v_mul_f32 v194, v194, v6
v_mul_f32 v195, v195, v6
v_cvt_pk_bf16_f32 v192, v192, v193
v_cvt_pk_bf16_f32 v193, v194, v195
s_mov_b64 exec, s[52:53]
v_and_b32 v184, v220, v192
v_bfi_b32 v188, v220, 0, v192
v_and_b32 v185, v221, v193
v_bfi_b32 v189, v221, 0, v193
s_not_b64 exec, exec
v_and_b32 v186, v220, v192
v_bfi_b32 v190, v220, 0, v192
v_and_b32 v187, v221, v193
v_bfi_b32 v191, v221, 0, v193
s_mov_b64 exec, -1
v_permlane16_swap_b32 v184, v188
v_permlane16_swap_b32 v185, v189
v_permlane16_swap_b32 v186, v190
v_permlane16_swap_b32 v187, v191
s_nop 1
v_mfma_f32_16x16x32_bf16 v[152:155], v[72:75], v[184:187], 0
v_mfma_f32_16x16x32_bf16 v[156:159], v[76:79], v[184:187], 0
v_mfma_f32_16x16x32_bf16 v[160:163], v[76:79], v[188:191], 0
ds_read_b32 v1, v1
s_mov_b32 exec_lo, 0xffff0000
s_nop 3
v_cvt_pk_bf16_f32 v80, v152, v153
v_cvt_pk_bf16_f32 v81, v154, v155
v_cvt_pk_bf16_f32 v82, v156, v157
v_cvt_pk_bf16_f32 v83, v158, v159
s_mov_b64 exec, s[100:101]
v_cvt_pk_bf16_f32 v82, v160, v161
v_cvt_pk_bf16_f32 v83, v162, v163
s_mov_b64 exec, -1
s_cmp_eq_u32 s41, 1
s_cbranch_scc0 L_gl_6g
buffer_store_dwordx4 v[80:83], v226, s[20:23], s54 offen
L_gl_6b:
s_branch L_pb_7
.p2align 12
L_pad_8:
s_setpc_b64 s[100:101]
L_pb_7:
s_lshl_b32 s0, s38, 12
s_add_u32 s0, s0, 57344
v_add_u32 v4, s0, v233
s_and_b32 s0, s38, 2
s_lshl_b32 s0, s0, 1
s_add_u32 s0, s0, 1760
v_mov_b32 v3, s0
v_mov_b32 v5, 1
s_waitcnt lgkmcnt(0)
v_cmp_ne_u32 vcc, 4, v1
s_cbranch_vccnz L_spw
L_sbw:
s_waitcnt vmcnt(5)
v_max_u16 v2, v24, v28
v_cmp_eq_u16 vcc, -1, v2
s_cbranch_vccnz L_st0
L_go0:
v_mfma_f32_16x16x32_bf16 v[8:11], v[104:107], v[24:27], v[8:11]
buffer_load_dwordx4 v[48:51], v236, s[20:23], s62 offen offset:0 sc1
ds_read_b64_tr_b16 v[152:153], v228 offset:24576
v_mfma_f32_16x16x32_bf16 v[12:15], v[108:111], v[24:27], v[12:15]
ds_read_b64_tr_b16 v[154:155], v228 offset:25088
ds_read_b64_tr_b16 v[156:157], v229 offset:24576
v_mfma_f32_16x16x32_bf16 v[16:19], v[112:115], v[24:27], v[16:19]
ds_read_b64_tr_b16 v[158:159], v229 offset:25088
ds_read_b64_tr_b16 v[160:161], v230 offset:24576
v_mfma_f32_16x16x32_bf16 v[20:23], v[116:119], v[24:27], v[20:23]
ds_read_b64_tr_b16 v[162:163], v230 offset:25088
ds_read_b64_tr_b16 v[164:165], v231 offset:24576
v_mfma_f32_16x16x32_bf16 v[8:11], v[120:123], v[28:31], v[8:11]
buffer_load_dwordx4 v[52:55], v227, s[20:23], s62 offen offset:256 sc1
ds_read_b64_tr_b16 v[166:167], v231 offset:25088
v_mfma_f32_16x16x32_bf16 v[12:15], v[124:127], v[28:31], v[12:15]
ds_read_b64_tr_b16 v[168:169], v228 offset:32768
s_waitcnt vmcnt(5)
v_max_u16 v2, v32, v36
v_cmp_eq_u16 vcc, -1, v2
v_mfma_f32_16x16x32_bf16 v[16:19], v[128:131], v[28:31], v[16:19]
ds_read_b64_tr_b16 v[170:171], v228 offset:33280
s_cbranch_vccnz L_st1
L_go1:
v_mfma_f32_16x16x32_bf16 v[20:23], v[132:135], v[28:31], v[20:23]
ds_read_b64_tr_b16 v[172:173], v229 offset:32768
v_mfma_f32_16x16x32_bf16 v[8:11], v[136:139], v[32:35], v[8:11]
buffer_load_dwordx4 v[56:59], v236, s[20:23], s62 offen offset:256 sc1
ds_read_b64_tr_b16 v[174:175], v229 offset:33280
v_mfma_f32_16x16x32_bf16 v[12:15], v[140:143], v[32:35], v[12:15]
ds_read_b64_tr_b16 v[176:177], v230 offset:32768
ds_read_b64_tr_b16 v[178:179], v230 offset:33280
v_mfma_f32_16x16x32_bf16 v[16:19], v[144:147], v[32:35], v[16:19]
ds_read_b64_tr_b16 v[180:181], v231 offset:32768
ds_read_b64_tr_b16 v[182:183], v231 offset:33280
v_mfma_f32_16x16x32_bf16 v[20:23], v[148:151], v[32:35], v[20:23]
v_add_u32 v228, s65, v228
ds_read_b64_tr_b16 v[184:185], v228 offset:0
ds_read_b64_tr_b16 v[186:187], v228 offset:512
s_waitcnt lgkmcnt(10)
v_mfma_f32_16x16x32_bf16 v[8:11], v[152:155], v[36:39], v[8:11]
buffer_load_dwordx4 v[60:63], v227, s[20:23], s62 offen offset:512 sc1
v_add_u32 v229, s65, v229
ds_read_b64_tr_b16 v[188:189], v229 offset:0
v_mfma_f32_16x16x32_bf16 v[12:15], v[156:159], v[36:39], v[12:15]
buffer_load_dwordx4 v[64:67], v236, s[20:23], s62 offen offset:512 sc1
ds_read_b64_tr_b16 v[190:191], v229 offset:512
s_waitcnt vmcnt(7)
v_cmp_eq_u16 vcc, -1, v40
v_mfma_f32_16x16x32_bf16 v[16:19], v[160:163], v[36:39], v[16:19]
v_add_u32 v230, s65, v230
ds_read_b64_tr_b16 v[192:193], v230 offset:0
s_cbranch_vccnz L_st2
L_go2:
v_mfma_f32_16x16x32_bf16 v[20:23], v[164:167], v[36:39], v[20:23]
ds_read_b64_tr_b16 v[194:195], v230 offset:512
s_waitcnt lgkmcnt(6)
v_mfma_f32_16x16x32_bf16 v[8:11], v[168:171], v[40:43], v[8:11]
buffer_load_dwordx4 v[68:71], v227, s[20:23], s62 offen offset:768 sc1
v_add_u32 v231, s65, v231
ds_read_b64_tr_b16 v[196:197], v231 offset:0
v_mfma_f32_16x16x32_bf16 v[12:15], v[172:175], v[40:43], v[12:15]
buffer_load_dwordx4 v[72:75], v236, s[20:23], s62 offen offset:768 sc1
ds_read_b64_tr_b16 v[198:199], v231 offset:512
s_waitcnt vmcnt(6)
v_max_u16 v2, v44, v48
v_cmp_eq_u16 vcc, -1, v2
v_mfma_f32_16x16x32_bf16 v[16:19], v[176:179], v[40:43], v[16:19]
ds_read_b64_tr_b16 v[104:105], v228 offset:8192
s_cbranch_vccnz L_st3
L_go3:
v_mfma_f32_16x16x32_bf16 v[20:23], v[180:183], v[40:43], v[20:23]
ds_read_b64_tr_b16 v[106:107], v228 offset:8704
s_waitcnt lgkmcnt(8)
v_mfma_f32_16x16x32_bf16 v[8:11], v[184:187], v[44:47], v[8:11]
buffer_load_dwordx4 v[76:79], v227, s[20:23], s62 offen offset:1024 sc1
ds_read_b64_tr_b16 v[108:109], v229 offset:8192
v_mfma_f32_16x16x32_bf16 v[200:203], v[184:187], v[48:51], 0
ds_read_b64_tr_b16 v[110:111], v229 offset:8704
ds_read_b64_tr_b16 v[112:113], v230 offset:8192
s_waitcnt lgkmcnt(9)
v_mfma_f32_16x16x32_bf16 v[12:15], v[188:191], v[44:47], v[12:15]
ds_read_b64_tr_b16 v[114:115], v230 offset:8704
ds_read_b64_tr_b16 v[116:117], v231 offset:8192
v_mfma_f32_16x16x32_bf16 v[204:207], v[188:191], v[48:51], 0
ds_read_b64_tr_b16 v[118:119], v231 offset:8704
ds_read_b64_tr_b16 v[120:121], v228 offset:16384
s_waitcnt lgkmcnt(11)
v_mfma_f32_16x16x32_bf16 v[16:19], v[192:195], v[44:47], v[16:19]
buffer_load_dwordx4 v[80:83], v236, s[20:23], s62 offen offset:1024 sc1
ds_read_b64_tr_b16 v[122:123], v228 offset:16896
v_mfma_f32_16x16x32_bf16 v[208:211], v[192:195], v[48:51], 0
ds_read_b64_tr_b16 v[124:125], v229 offset:16384
s_waitcnt vmcnt(6)
v_max_u16 v2, v52, v56
v_cmp_eq_u16 vcc, -1, v2
s_waitcnt lgkmcnt(11)
v_mfma_f32_16x16x32_bf16 v[20:23], v[196:199], v[44:47], v[20:23]
ds_read_b64_tr_b16 v[126:127], v229 offset:16896
s_cbranch_vccnz L_st4
L_go4:
v_mfma_f32_16x16x32_bf16 v[212:215], v[196:199], v[48:51], 0
ds_read_b64_tr_b16 v[128:129], v230 offset:16384
s_waitcnt lgkmcnt(11)
v_mfma_f32_16x16x32_bf16 v[8:11], v[104:107], v[52:55], v[8:11]
buffer_load_dwordx4 v[84:87], v227, s[20:23], s63 offen offset:0 sc1
ds_read_b64_tr_b16 v[130:131], v230 offset:16896
s_waitcnt lgkmcnt(6)
v_mfma_f32_16x16x32_bf16 v[200:203], v[104:107], v[56:59], v[200:203]
ds_read_b64_tr_b16 v[132:133], v231 offset:16384
ds_read_b64_tr_b16 v[134:135], v231 offset:16896
v_mfma_f32_16x16x32_bf16 v[12:15], v[108:111], v[52:55], v[12:15]
ds_read_b64_tr_b16 v[136:137], v228 offset:24576
ds_read_b64_tr_b16 v[138:139], v228 offset:25088
v_mfma_f32_16x16x32_bf16 v[204:207], v[108:111], v[56:59], v[204:207]
ds_read_b64_tr_b16 v[140:141], v229 offset:24576
ds_read_b64_tr_b16 v[142:143], v229 offset:25088
v_mfma_f32_16x16x32_bf16 v[16:19], v[112:115], v[52:55], v[16:19]
buffer_load_dwordx4 v[88:91], v236, s[20:23], s63 offen offset:0 sc1
ds_read_b64_tr_b16 v[144:145], v230 offset:24576
v_mfma_f32_16x16x32_bf16 v[208:211], v[112:115], v[56:59], v[208:211]
ds_read_b64_tr_b16 v[146:147], v230 offset:25088
s_waitcnt vmcnt(6)
v_max_u16 v2, v60, v64
v_cmp_eq_u16 vcc, -1, v2
v_mfma_f32_16x16x32_bf16 v[20:23], v[116:119], v[52:55], v[20:23]
ds_read_b64_tr_b16 v[148:149], v231 offset:24576
s_cbranch_vccnz L_st5
L_go5:
v_mfma_f32_16x16x32_bf16 v[212:215], v[116:119], v[56:59], v[212:215]
ds_read_b64_tr_b16 v[150:151], v231 offset:25088
s_waitcnt lgkmcnt(8)
v_mfma_f32_16x16x32_bf16 v[8:11], v[120:123], v[60:63], v[8:11]
buffer_load_dwordx4 v[92:95], v227, s[20:23], s63 offen offset:256 sc1
ds_read_b64_tr_b16 v[152:153], v228 offset:32768
v_mfma_f32_16x16x32_bf16 v[200:203], v[120:123], v[64:67], v[200:203]
ds_read_b64_tr_b16 v[154:155], v228 offset:33280
ds_read_b64_tr_b16 v[156:157], v229 offset:32768
v_mfma_f32_16x16x32_bf16 v[12:15], v[124:127], v[60:63], v[12:15]
ds_read_b64_tr_b16 v[158:159], v229 offset:33280
ds_read_b64_tr_b16 v[160:161], v230 offset:32768
v_mfma_f32_16x16x32_bf16 v[204:207], v[124:127], v[64:67], v[204:207]
ds_read_b64_tr_b16 v[162:163], v230 offset:33280
ds_read_b64_tr_b16 v[164:165], v231 offset:32768
v_mfma_f32_16x16x32_bf16 v[16:19], v[128:131], v[60:63], v[16:19]
buffer_load_dwordx4 v[96:99], v236, s[20:23], s63 offen offset:256 sc1
ds_read_b64_tr_b16 v[166:167], v231 offset:33280
v_mfma_f32_16x16x32_bf16 v[208:211], v[128:131], v[64:67], v[208:211]
v_add_u32 v228, 40960, v228
ds_read_b64_tr_b16 v[168:169], v228 offset:0
s_waitcnt vmcnt(6)
v_max_u16 v2, v68, v72
v_cmp_eq_u16 vcc, -1, v2
v_mfma_f32_16x16x32_bf16 v[20:23], v[132:135], v[60:63], v[20:23]
ds_read_b64_tr_b16 v[170:171], v228 offset:512
s_cbranch_vccnz L_st6
L_go6:
v_mfma_f32_16x16x32_bf16 v[212:215], v[132:135], v[64:67], v[212:215]
v_add_u32 v229, 40960, v229
ds_read_b64_tr_b16 v[172:173], v229 offset:0
s_waitcnt lgkmcnt(11)
v_mfma_f32_16x16x32_bf16 v[8:11], v[136:139], v[68:71], v[8:11]
buffer_load_dwordx4 v[100:103], v227, s[20:23], s63 offen offset:512 sc1
ds_read_b64_tr_b16 v[174:175], v229 offset:512
v_mfma_f32_16x16x32_bf16 v[200:203], v[136:139], v[72:75], v[200:203]
v_add_u32 v230, 40960, v230
ds_read_b64_tr_b16 v[176:177], v230 offset:0
ds_read_b64_tr_b16 v[178:179], v230 offset:512
v_mfma_f32_16x16x32_bf16 v[12:15], v[140:143], v[68:71], v[12:15]
v_add_u32 v231, 40960, v231
ds_read_b64_tr_b16 v[180:181], v231 offset:0
ds_read_b64_tr_b16 v[182:183], v231 offset:512
v_mfma_f32_16x16x32_bf16 v[204:207], v[140:143], v[72:75], v[204:207]
ds_read_b64_tr_b16 v[184:185], v228 offset:8192
ds_read_b64_tr_b16 v[186:187], v228 offset:8704
v_mfma_f32_16x16x32_bf16 v[16:19], v[144:147], v[68:71], v[16:19]
buffer_load_dwordx4 v[24:27], v236, s[20:23], s63 offen offset:512 sc1
ds_read_b64_tr_b16 v[188:189], v229 offset:8192
v_mfma_f32_16x16x32_bf16 v[208:211], v[144:147], v[72:75], v[208:211]
ds_read_b64_tr_b16 v[190:191], v229 offset:8704
s_waitcnt vmcnt(6)
v_max_u16 v2, v76, v80
v_cmp_eq_u16 vcc, -1, v2
v_mfma_f32_16x16x32_bf16 v[20:23], v[148:151], v[68:71], v[20:23]
ds_read_b64_tr_b16 v[192:193], v230 offset:8192
s_cbranch_vccnz L_st7
L_go7:
v_mfma_f32_16x16x32_bf16 v[212:215], v[148:151], v[72:75], v[212:215]
ds_read_b64_tr_b16 v[194:195], v230 offset:8704
s_waitcnt lgkmcnt(14)
v_mfma_f32_16x16x32_bf16 v[8:11], v[152:155], v[76:79], v[8:11]
buffer_load_dwordx4 v[28:31], v236, s[20:23], s63 offen offset:768 sc1
ds_read_b64_tr_b16 v[196:197], v231 offset:8192
v_mfma_f32_16x16x32_bf16 v[200:203], v[152:155], v[80:83], v[200:203]
ds_read_b64_tr_b16 v[198:199], v231 offset:8704
ds_read_b64_tr_b16 v[104:105], v228 offset:16384
v_mfma_f32_16x16x32_bf16 v[12:15], v[156:159], v[76:79], v[12:15]
ds_read_b64_tr_b16 v[106:107], v228 offset:16896
ds_read_b64_tr_b16 v[108:109], v229 offset:16384
v_mfma_f32_16x16x32_bf16 v[204:207], v[156:159], v[80:83], v[204:207]
ds_read_b64_tr_b16 v[110:111], v229 offset:16896
ds_read_b64_tr_b16 v[112:113], v230 offset:16384
v_mfma_f32_16x16x32_bf16 v[16:19], v[160:163], v[76:79], v[16:19]
buffer_load_dwordx4 v[32:35], v236, s[20:23], s63 offen offset:1024 sc1
ds_read_b64_tr_b16 v[114:115], v230 offset:16896
v_mfma_f32_16x16x32_bf16 v[208:211], v[160:163], v[80:83], v[208:211]
ds_read_b64_tr_b16 v[116:117], v231 offset:16384
s_waitcnt vmcnt(6)
v_max_u16 v2, v84, v88
v_cmp_eq_u16 vcc, -1, v2
v_mfma_f32_16x16x32_bf16 v[20:23], v[164:167], v[76:79], v[20:23]
ds_read_b64_tr_b16 v[118:119], v231 offset:16896
s_cbranch_vccnz L_st8
L_go8:
v_mfma_f32_16x16x32_bf16 v[212:215], v[164:167], v[80:83], v[212:215]
ds_read_b64_tr_b16 v[120:121], v228 offset:24576
s_waitcnt lgkmcnt(15)
v_mfma_f32_16x16x32_bf16 v[8:11], v[168:171], v[84:87], v[8:11]
buffer_load_dwordx4 v[36:39], v227, s[20:23], s63 offen offset:768 sc1
ds_read_b64_tr_b16 v[122:123], v228 offset:25088
v_mfma_f32_16x16x32_bf16 v[200:203], v[168:171], v[88:91], v[200:203]
ds_read_b64_tr_b16 v[124:125], v229 offset:24576
ds_read_b64_tr_b16 v[126:127], v229 offset:25088
v_mfma_f32_16x16x32_bf16 v[12:15], v[172:175], v[84:87], v[12:15]
ds_read_b64_tr_b16 v[128:129], v230 offset:24576
ds_read_b64_tr_b16 v[130:131], v230 offset:25088
v_mfma_f32_16x16x32_bf16 v[204:207], v[172:175], v[88:91], v[204:207]
ds_read_b64_tr_b16 v[132:133], v231 offset:24576
ds_read_b64_tr_b16 v[134:135], v231 offset:25088
v_mfma_f32_16x16x32_bf16 v[16:19], v[176:179], v[84:87], v[16:19]
buffer_load_dwordx4 v[40:43], v227, s[20:23], s63 offen offset:1024 sc1
ds_read_b64_tr_b16 v[136:137], v228 offset:32768
v_mfma_f32_16x16x32_bf16 v[208:211], v[176:179], v[88:91], v[208:211]
ds_read_b64_tr_b16 v[138:139], v228 offset:33280
s_waitcnt vmcnt(6)
v_max_u16 v2, v92, v96
v_cmp_eq_u16 vcc, -1, v2
v_mfma_f32_16x16x32_bf16 v[20:23], v[180:183], v[84:87], v[20:23]
ds_read_b64_tr_b16 v[140:141], v229 offset:32768
s_cbranch_vccnz L_st9
L_go9:
v_mfma_f32_16x16x32_bf16 v[212:215], v[180:183], v[88:91], v[212:215]
ds_read_b64_tr_b16 v[142:143], v229 offset:33280
s_waitcnt lgkmcnt(15)
v_mfma_f32_16x16x32_bf16 v[8:11], v[184:187], v[92:95], v[8:11]
buffer_load_dwordx4 v[44:47], v227, s[20:23], s64 offen offset:0 sc1
ds_read_b64_tr_b16 v[144:145], v230 offset:32768
v_mfma_f32_16x16x32_bf16 v[200:203], v[184:187], v[96:99], v[200:203]
ds_read_b64_tr_b16 v[146:147], v230 offset:33280
ds_read_b64_tr_b16 v[148:149], v231 offset:32768
v_mfma_f32_16x16x32_bf16 v[12:15], v[188:191], v[92:95], v[12:15]
ds_read_b64_tr_b16 v[150:151], v231 offset:33280
v_subrev_u32 v228, s65, v228
ds_read_b64_tr_b16 v[152:153], v228 offset:0
v_mfma_f32_16x16x32_bf16 v[204:207], v[188:191], v[96:99], v[204:207]
ds_read_b64_tr_b16 v[154:155], v228 offset:512
v_subrev_u32 v229, s65, v229
ds_read_b64_tr_b16 v[156:157], v229 offset:0
v_mfma_f32_16x16x32_bf16 v[16:19], v[192:195], v[92:95], v[16:19]
buffer_load_dwordx4 v[48:51], v227, s[20:23], s64 offen offset:256 sc1
ds_read_b64_tr_b16 v[158:159], v229 offset:512
v_mfma_f32_16x16x32_bf16 v[208:211], v[192:195], v[96:99], v[208:211]
v_subrev_u32 v230, s65, v230
ds_read_b64_tr_b16 v[160:161], v230 offset:0
s_waitcnt vmcnt(6)
v_max_u16 v2, v100, v24
v_cmp_eq_u16 vcc, -1, v2
v_mfma_f32_16x16x32_bf16 v[20:23], v[196:199], v[92:95], v[20:23]
ds_read_b64_tr_b16 v[162:163], v230 offset:512
s_cbranch_vccnz L_st10
L_go10:
v_mfma_f32_16x16x32_bf16 v[212:215], v[196:199], v[96:99], v[212:215]
v_subrev_u32 v231, s65, v231
ds_read_b64_tr_b16 v[164:165], v231 offset:0
s_waitcnt lgkmcnt(15)
v_mfma_f32_16x16x32_bf16 v[8:11], v[104:107], v[100:103], v[8:11]
buffer_load_dwordx4 v[52:55], v227, s[20:23], s64 offen offset:512 sc1
ds_read_b64_tr_b16 v[166:167], v231 offset:512
v_mfma_f32_16x16x32_bf16 v[200:203], v[104:107], v[24:27], v[200:203]
ds_read_b64_tr_b16 v[168:169], v228 offset:8192
ds_read_b64_tr_b16 v[170:171], v228 offset:8704
v_mfma_f32_16x16x32_bf16 v[12:15], v[108:111], v[100:103], v[12:15]
ds_read_b64_tr_b16 v[172:173], v229 offset:8192
ds_read_b64_tr_b16 v[174:175], v229 offset:8704
v_mfma_f32_16x16x32_bf16 v[204:207], v[108:111], v[24:27], v[204:207]
ds_read_b64_tr_b16 v[176:177], v230 offset:8192
ds_read_b64_tr_b16 v[178:179], v230 offset:8704
v_mfma_f32_16x16x32_bf16 v[16:19], v[112:115], v[100:103], v[16:19]
buffer_load_dwordx4 v[56:59], v227, s[20:23], s64 offen offset:768 sc1
ds_read_b64_tr_b16 v[180:181], v231 offset:8192
v_mfma_f32_16x16x32_bf16 v[208:211], v[112:115], v[24:27], v[208:211]
ds_read_b64_tr_b16 v[182:183], v231 offset:8704
s_waitcnt vmcnt(6)
v_max_u16 v2, v28, v32
v_cmp_eq_u16 vcc, -1, v2
v_mfma_f32_16x16x32_bf16 v[20:23], v[116:119], v[100:103], v[20:23]
ds_read_b64_tr_b16 v[184:185], v228 offset:16384
s_cbranch_vccnz L_st11
L_go11:
v_mfma_f32_16x16x32_bf16 v[212:215], v[116:119], v[24:27], v[212:215]
ds_read_b64_tr_b16 v[186:187], v228 offset:16896
v_mfma_f32_16x16x32_bf16 v[200:203], v[120:123], v[28:31], v[200:203]
buffer_load_dwordx4 v[60:63], v227, s[20:23], s64 offen offset:1024 sc1
ds_read_b64_tr_b16 v[188:189], v229 offset:16384
v_mfma_f32_16x16x32_bf16 v[204:207], v[124:127], v[28:31], v[204:207]
ds_read_b64_tr_b16 v[190:191], v229 offset:16896
ds_read_b64_tr_b16 v[192:193], v230 offset:16384
v_mfma_f32_16x16x32_bf16 v[208:211], v[128:131], v[28:31], v[208:211]
ds_read_b64_tr_b16 v[194:195], v230 offset:16896
ds_read_b64_tr_b16 v[196:197], v231 offset:16384
v_mfma_f32_16x16x32_bf16 v[212:215], v[132:135], v[28:31], v[212:215]
ds_read_b64_tr_b16 v[198:199], v231 offset:16896
ds_read_b64_tr_b16 v[104:105], v228 offset:24576
s_waitcnt lgkmcnt(15)
v_mfma_f32_16x16x32_bf16 v[200:203], v[136:139], v[32:35], v[200:203]
ds_read_b64_tr_b16 v[106:107], v228 offset:25088
ds_read_b64_tr_b16 v[108:109], v229 offset:24576
v_mfma_f32_16x16x32_bf16 v[204:207], v[140:143], v[32:35], v[204:207]
ds_read_b64_tr_b16 v[110:111], v229 offset:25088
s_waitcnt vmcnt(5)
v_max_u16 v2, v36, v40
v_cmp_eq_u16 vcc, -1, v2
v_mfma_f32_16x16x32_bf16 v[208:211], v[144:147], v[32:35], v[208:211]
ds_read_b64_tr_b16 v[112:113], v230 offset:24576
s_cbranch_vccnz L_st12
L_go12:
v_mfma_f32_16x16x32_bf16 v[212:215], v[148:151], v[32:35], v[212:215]
ds_read_b64_tr_b16 v[114:115], v230 offset:25088
v_mfma_f32_16x16x32_bf16 v[8:11], v[120:123], v[36:39], v[8:11]
ds_read_b64_tr_b16 v[116:117], v231 offset:24576
ds_read_b64_tr_b16 v[118:119], v231 offset:25088
v_mfma_f32_16x16x32_bf16 v[12:15], v[124:127], v[36:39], v[12:15]
ds_write_b128 v4, v[200:203] offset:0
v_mfma_f32_16x16x32_bf16 v[16:19], v[128:131], v[36:39], v[16:19]
ds_write_b128 v4, v[204:207] offset:1024
v_mfma_f32_16x16x32_bf16 v[20:23], v[132:135], v[36:39], v[20:23]
ds_write_b128 v4, v[208:211] offset:2048
v_mfma_f32_16x16x32_bf16 v[8:11], v[136:139], v[40:43], v[8:11]
ds_read_b64_tr_b16 v[120:121], v228 offset:32768
ds_read_b64_tr_b16 v[122:123], v228 offset:33280
v_mfma_f32_16x16x32_bf16 v[12:15], v[140:143], v[40:43], v[12:15]
ds_read_b64_tr_b16 v[124:125], v229 offset:32768
s_waitcnt vmcnt(3)
v_max_u16 v2, v44, v48
v_cmp_eq_u16 vcc, -1, v2
v_mfma_f32_16x16x32_bf16 v[16:19], v[144:147], v[40:43], v[16:19]
ds_write_b128 v4, v[212:215] offset:3072
s_cbranch_vccnz L_st13
L_go13:
v_mfma_f32_16x16x32_bf16 v[20:23], v[148:151], v[40:43], v[20:23]
s_mov_b64 exec, 1
ds_add_u32 v3, v5
s_mov_b64 exec, -1
v_mfma_f32_16x16x32_bf16 v[8:11], v[152:155], v[44:47], v[8:11]
ds_read_b64_tr_b16 v[126:127], v229 offset:33280
ds_read_b64_tr_b16 v[128:129], v230 offset:32768
v_mfma_f32_16x16x32_bf16 v[12:15], v[156:159], v[44:47], v[12:15]
ds_read_b64_tr_b16 v[130:131], v230 offset:33280
ds_read_b64_tr_b16 v[132:133], v231 offset:32768
v_mfma_f32_16x16x32_bf16 v[16:19], v[160:163], v[44:47], v[16:19]
ds_read_b64_tr_b16 v[134:135], v231 offset:33280
v_mfma_f32_16x16x32_bf16 v[20:23], v[164:167], v[44:47], v[20:23]
s_waitcnt lgkmcnt(15)
v_mfma_f32_16x16x32_bf16 v[8:11], v[168:171], v[48:51], v[8:11]
v_mfma_f32_16x16x32_bf16 v[12:15], v[172:175], v[48:51], v[12:15]
s_waitcnt vmcnt(1)
v_max_u16 v2, v52, v56
v_cmp_eq_u16 vcc, -1, v2
v_mfma_f32_16x16x32_bf16 v[16:19], v[176:179], v[48:51], v[16:19]
s_cbranch_vccnz L_st14
L_go14:
v_mfma_f32_16x16x32_bf16 v[20:23], v[180:183], v[48:51], v[20:23]
v_mfma_f32_16x16x32_bf16 v[8:11], v[184:187], v[52:55], v[8:11]
v_mfma_f32_16x16x32_bf16 v[12:15], v[188:191], v[52:55], v[12:15]
v_mfma_f32_16x16x32_bf16 v[16:19], v[192:195], v[52:55], v[16:19]
v_mfma_f32_16x16x32_bf16 v[20:23], v[196:199], v[52:55], v[20:23]
s_waitcnt lgkmcnt(13)
v_mfma_f32_16x16x32_bf16 v[8:11], v[104:107], v[56:59], v[8:11]
v_mfma_f32_16x16x32_bf16 v[12:15], v[108:111], v[56:59], v[12:15]
s_waitcnt vmcnt(0)
v_cmp_eq_u16 vcc, -1, v60
v_mfma_f32_16x16x32_bf16 v[16:19], v[112:115], v[56:59], v[16:19]
s_cbranch_vccnz L_st15
L_go15:
v_mfma_f32_16x16x32_bf16 v[20:23], v[116:119], v[56:59], v[20:23]
s_waitcnt lgkmcnt(8)
v_mfma_f32_16x16x32_bf16 v[8:11], v[120:123], v[60:63], v[8:11]
s_waitcnt lgkmcnt(4)
v_mfma_f32_16x16x32_bf16 v[12:15], v[124:127], v[60:63], v[12:15]
s_waitcnt lgkmcnt(2)
v_mfma_f32_16x16x32_bf16 v[16:19], v[128:131], v[60:63], v[16:19]
s_waitcnt lgkmcnt(0)
v_mfma_f32_16x16x32_bf16 v[20:23], v[132:135], v[60:63], v[20:23]
L_tail:
s_nop 1
v_cvt_pk_bf16_f32 v24, v8, v9
v_cvt_pk_bf16_f32 v25, v10, v11
v_cvt_pk_bf16_f32 v26, v12, v13
v_cvt_pk_bf16_f32 v27, v14, v15
v_cvt_pk_bf16_f32 v28, v16, v17
v_cvt_pk_bf16_f32 v29, v18, v19
v_cvt_pk_bf16_f32 v30, v20, v21
v_cvt_pk_bf16_f32 v31, v22, v23
v_mfma_f32_16x16x32_bf16 v[36:39], v[24:27], v[24:27], 0
v_mfma_f32_16x16x32_bf16 v[32:35], v[244:247], v[24:27], 0
v_mfma_f32_16x16x32_bf16 v[36:39], v[28:31], v[28:31], v[36:39]
v_mfma_f32_16x16x32_bf16 v[32:35], v[248:251], v[28:31], v[32:35]
s_mov_b32 s0, 0x22222222
s_mov_b32 s1, s0
s_mov_b32 s44, 0x44444444
s_mov_b32 s45, s44
s_mov_b32 vcc_lo, 0x88888888
s_mov_b32 vcc_hi, 0x88888888
s_lshl_b32 s3, s36, 8
s_add_u32 s3, s3, s58
v_and_b32 v1, 0xf0, v233
v_cndmask_b32 v36, v36, v37, s[0:1]
v_cndmask_b32 v38, v38, v39, vcc
s_or_b64 vcc, vcc, s[44:45]
v_cndmask_b32 v34, v36, v38, vcc
v_mov_b32 v35, v253
s_mov_b32 exec_lo, 0xf0000f
s_mov_b32 exec_hi, 0xf0000f00
s_cmp_eq_u32 s41, 1
s_cbranch_scc0 L_gl_9g
buffer_store_dwordx4 v[32:35], v1, s[16:19], s3 offen
L_gl_9b:
s_mov_b64 exec, -1
v_mov_b32 v48, 0
v_mov_b32 v49, 0
v_mov_b32 v50, 0
v_mov_b32 v51, 0
v_mov_b32 v4, 1.0
s_mov_b32 s0, 0xbacccccd
s_mov_b32 s1, 0x3acccccd
v_mov_b32 v5, 0x3727c5ac
s_mov_b32 s44, 0xfffff800
v_mov_b32 v1, 1732
v_cmp_le_i32 s[46:47], 0, v232
s_mul_i32 s48, s35, 1280
s_lshl_b32 s3, s36, 7
s_add_u32 s48, s48, s3
s_lshl_b32 s49, s48, 1
s_add_u32 s48, s48, s59
s_add_u32 s49, s49, s59
s_add_u32 s49, s49, 4096
s_lshl_b32 s3, s35, 7
s_add_u32 s3, s3, s59
s_add_u32 s3, s3, 21504
s_and_b32 s45, s36, 15
s_lshl_b32 s45, s45, 3
s_add_u32 s45, s45, s32
v_mul_u32_u24 v70, 384, v0
v_and_b32 v69, 48, v0
v_lshlrev_b32 v68, 1, v69
L_e2:
buffer_load_dwordx4 v[40:43], v233, s[16:19], s58 offen sc1
buffer_load_dwordx4 v[44:47], v233, s[16:19], s58 offen offset:1024 sc1
s_mov_b32 exec_hi, 0
buffer_load_dwordx4 v[48:51], v233, s[16:19], s58 offen offset:2048 sc1
s_mov_b32 exec_hi, -1
s_sub_u32 s40, s40, 1
s_waitcnt vmcnt(1)
v_pk_add_f32 v[40:41], v[40:41], v[44:45]
v_pk_add_f32 v[42:43], v[42:43], v[46:47]
s_waitcnt vmcnt(0)
v_pk_add_f32 v[40:41], v[40:41], v[48:49]
v_pk_add_f32 v[42:43], v[42:43], v[50:51]
v_cmp_u_f32 vcc, v40, v40
s_cbranch_scc1 L_e2go
s_cbranch_vccnz L_e2
L_e2go:
v_mfma_f32_16x16x4_f32 v[52:55], v4, v40, 0
v_mfma_f32_16x16x4_f32 v[60:63], v4, v42, 0
v_mfma_f32_16x16x4_f32 v[64:67], v4, v43, 0
v_mfma_f32_16x16x4_f32 v[56:59], v4, v41, 0
s_nop 6
v_mul_f32 v6, s0, v52
v_fma_f32 v7, v60, s1, v5
v_fma_f32 v7, -v6, v6, v7
v_max_f32 v7, v7, v5
v_rsq_f32 v2, v7
v_fma_f32 v7, v6, v64, v56
v_mul_f32 v7, v7, v2
v_mul_f32 v3, v6, v2
v_ashrrev_i32 v6, 31, v7
v_or_b32 v6, 0x80000000, v6
v_xor_b32 v7, v7, v6
v_and_or_b32 v7, v7, s44, v234
v_cndmask_b32 v7, 0, v7, s[46:47]
v_pk_fma_f32 v[72:73], v[8:9], v[2:3], v[2:3] op_sel:[0,0,1] op_sel_hi:[1,0,1]
v_pk_fma_f32 v[74:75], v[10:11], v[2:3], v[2:3] op_sel:[0,0,1] op_sel_hi:[1,0,1]
v_max_u32_dpp v6, v7, v7 row_ror:8 row_mask:0xf bank_mask:0xf
v_pk_fma_f32 v[76:77], v[12:13], v[2:3], v[2:3] op_sel:[0,0,1] op_sel_hi:[1,0,1]
v_pk_fma_f32 v[78:79], v[14:15], v[2:3], v[2:3] op_sel:[0,0,1] op_sel_hi:[1,0,1]
v_max_u32_dpp v6, v6, v6 row_ror:4 row_mask:0xf bank_mask:0xf
s_mov_b64 exec, 15
ds_max_u32 v1, v6
s_mov_b64 exec, -1
v_pk_fma_f32 v[80:81], v[16:17], v[2:3], v[2:3] op_sel:[0,0,1] op_sel_hi:[1,0,1]
v_pk_fma_f32 v[82:83], v[18:19], v[2:3], v[2:3] op_sel:[0,0,1] op_sel_hi:[1,0,1]
v_pk_fma_f32 v[84:85], v[20:21], v[2:3], v[2:3] op_sel:[0,0,1] op_sel_hi:[1,0,1]
v_pk_fma_f32 v[86:87], v[22:23], v[2:3], v[2:3] op_sel:[0,0,1] op_sel_hi:[1,0,1]
v_cvt_pk_bf16_f32 v88, v72, v73
v_cvt_pk_bf16_f32 v89, v74, v75
v_cvt_pk_bf16_f32 v90, v76, v77
v_cvt_pk_bf16_f32 v91, v78, v79
s_waitcnt lgkmcnt(0)
s_barrier
ds_read_b32 v1, v1
v_cvt_pk_bf16_f32 v92, v80, v81
v_cvt_pk_bf16_f32 v93, v82, v83
v_cvt_pk_bf16_f32 v94, v84, v85
v_cvt_pk_bf16_f32 v95, v86, v87
v_pk_add_f32 v[72:73], v[72:73], v[8:9]
v_pk_add_f32 v[74:75], v[74:75], v[10:11]
v_pk_add_f32 v[76:77], v[76:77], v[12:13]
v_pk_add_f32 v[78:79], v[78:79], v[14:15]
v_pk_add_f32 v[80:81], v[80:81], v[16:17]
v_pk_add_f32 v[82:83], v[82:83], v[18:19]
v_pk_add_f32 v[84:85], v[84:85], v[20:21]
v_pk_add_f32 v[86:87], v[86:87], v[22:23]
s_cmp_eq_u32 s45, 4
s_waitcnt lgkmcnt(0)
v_cmp_eq_u32 s[46:47], v1, v7
s_cbranch_scc0 L_nk
s_mov_b64 exec, 0xffff
buffer_store_dword v1, v70, s[16:19], s3 offen sc1
L_nk:
s_and_b64 exec, s[46:47], -1
s_cbranch_scc0 L_nc
buffer_store_dwordx4 v[88:91], v68, s[16:19], s48 offen sc1
buffer_store_dwordx4 v[92:95], v68, s[16:19], s48 offen offset:16 sc1
L_nc:
s_mov_b64 exec, -1
v_cvt_pk_bf16_f32 v96, v72, v73
v_cvt_pk_bf16_f32 v97, v74, v75
v_cvt_pk_bf16_f32 v98, v76, v77
v_cvt_pk_bf16_f32 v99, v78, v79
v_cvt_pk_bf16_f32 v100, v80, v81
v_cvt_pk_bf16_f32 v101, v82, v83
v_cvt_pk_bf16_f32 v102, v84, v85
v_cvt_pk_bf16_f32 v103, v86, v87
v_permlane16_swap_b32 v96, v98
v_permlane16_swap_b32 v97, v99
v_permlane16_swap_b32 v100, v102
v_permlane16_swap_b32 v101, v103
s_not_b64 exec, s[46:47]
buffer_store_dwordx4 v[96:99], v232, s[20:23], 0 offen offset:0
buffer_store_dwordx4 v[100:103], v232, s[20:23], 0 offen offset:64
s_and_b64 exec, s[46:47], -1
s_cbranch_scc0 L_fin
buffer_store_dwordx4 v[96:99], v232, s[20:23], 0 offen offset:0 sc1
buffer_store_dwordx4 v[100:103], v232, s[20:23], 0 offen offset:64 sc1
s_waitcnt vmcnt(0)
buffer_store_dwordx4 v[72:75], v69, s[16:19], s49 offen offset:0 sc1
buffer_store_dwordx4 v[76:79], v69, s[16:19], s49 offen offset:64 sc1
buffer_store_dwordx4 v[80:83], v69, s[16:19], s49 offen offset:128 sc1
buffer_store_dwordx4 v[84:87], v69, s[16:19], s49 offen offset:192 sc1
L_fin:
s_endpgm
.p2align 12
L_pb_10:
L_pad_11:
s_setpc_b64 s[100:101]
L_era:
s_sub_u32 s40, s40, 1
s_cbranch_scc1 L_exa
s_lshl_b32 s0, s33, 5
v_and_b32 v1, 16, v0
buffer_load_dword v32, v1, s[24:27], s0 offen sc1
s_waitcnt vmcnt(0)
s_waitcnt lgkmcnt(0)
v_cmp_ne_u32 vcc, 1, v32
s_cmp_eq_u64 vcc, 0
s_cbranch_scc0 L_era
s_branch L_ega
L_exa:
s_mov_b32 s40, 0
s_branch L_ega
L_erb:
s_sub_u32 s40, s40, 1
s_cbranch_scc1 L_exb
s_buffer_load_dword s71, s[16:19], s66 offset:0 glc
s_buffer_load_dword s73, s[16:19], s66 offset:128 glc
s_buffer_load_dword s75, s[16:19], s66 offset:256 glc
s_buffer_load_dword s77, s[16:19], s66 offset:384 glc
s_buffer_load_dword s83, s[16:19], s66 offset:512 glc
s_buffer_load_dword s85, s[16:19], s66 offset:640 glc
s_buffer_load_dword s89, s[16:19], s66 offset:768 glc
s_buffer_load_dword s91, s[16:19], s66 offset:896 glc
s_buffer_load_dword s93, s[16:19], s66 offset:1024 glc
s_buffer_load_dword s95, s[16:19], s66 offset:1152 glc
s_waitcnt lgkmcnt(0)
s_max_u32 s0, s71, s73
s_max_u32 s0, s0, s75
s_max_u32 s0, s0, s77
s_max_u32 s0, s0, s83
s_max_u32 s0, s0, s85
s_max_u32 s0, s0, s89
s_max_u32 s0, s0, s91
s_max_u32 s0, s0, s93
s_max_u32 s0, s0, s95
s_cmp_lg_u32 s0, -1
s_cbranch_scc0 L_erb
s_branch L_egb
L_exb:
s_mov_b32 s40, 0
s_branch L_egb
L_gh_3g:
s_barrier
s_cmp_eq_u32 s32, 5
s_cbranch_scc0 L_gh_3e
v_mov_b32 v1, 1
s_mov_b64 exec, 1
buffer_store_dword v1, off, s[16:19], s68 offset:64 sc1
s_mov_b64 exec, -1
L_gh_3p:
buffer_load_dword v1, v55, s[16:19], 0 offen offset:64 sc1
s_waitcnt vmcnt(0)
v_cmp_ne_u32 vcc, 1, v1
s_cbranch_vccz L_gh_3e
s_sub_u32 s40, s40, 1
s_cbranch_scc0 L_gh_3p
s_mov_b32 s40, 0
L_gh_3e:
s_barrier
s_branch L_gh_3b
L_xcap:
v_add_u32 v1, s0, v235
ds_read_b64 v[72:73], v1
v_xor_b32 v2, 32, v1
ds_read_b64 v[74:75], v2
v_xor_b32 v3, 64, v1
ds_read_b64 v[76:77], v3
v_xor_b32 v4, 96, v1
ds_read_b64 v[78:79], v4
s_setpc_b64 s[100:101]
L_woe1:
s_addk_i32 m0, 4096
s_mov_b32 s3, 0
buffer_load_dwordx4 v57, s[12:15], s3 offen lds
s_addk_i32 m0, 4096
s_mov_b32 s3, 81920
buffer_load_dwordx4 v57, s[12:15], s3 offen lds
s_addk_i32 m0, 4096
s_mov_b32 s3, 163840
buffer_load_dwordx4 v58, s[12:15], s3 offen lds
s_addk_i32 m0, 4096
s_mov_b32 s3, 245760
buffer_load_dwordx4 v60, s[12:15], s3 offen lds
s_addk_i32 m0, 4096
s_mov_b32 s3, 327680
buffer_load_dwordx4 v60, s[12:15], s3 offen lds
s_addk_i32 m0, 4096
s_mov_b32 s3, 409600
buffer_load_dwordx4 v57, s[12:15], s3 offen lds
s_addk_i32 m0, 4096
s_mov_b32 s3, 491520
buffer_load_dwordx4 v57, s[12:15], s3 offen lds
s_addk_i32 m0, 4096
s_mov_b32 s3, 573440
buffer_load_dwordx4 v58, s[12:15], s3 offen lds
s_addk_i32 m0, 4096
s_mov_b32 s3, 655360
buffer_load_dwordx4 v60, s[12:15], s3 offen lds
s_addk_i32 m0, 4096
s_mov_b32 s3, 737280
buffer_load_dwordx4 v60, s[12:15], s3 offen lds
s_branch L_woe
L_woe2:
s_addk_i32 m0, 4096
s_mov_b32 s3, 5120
buffer_load_dwordx4 v57, s[12:15], s3 offen lds
s_addk_i32 m0, 4096
s_mov_b32 s3, 87040
buffer_load_dwordx4 v58, s[12:15], s3 offen lds
s_addk_i32 m0, 4096
s_mov_b32 s3, 168960
buffer_load_dwordx4 v58, s[12:15], s3 offen lds
s_addk_i32 m0, 4096
s_mov_b32 s3, 250880
buffer_load_dwordx4 v60, s[12:15], s3 offen lds
s_addk_i32 m0, 4096
s_mov_b32 s3, 384000
buffer_load_dwordx4 v59, s[12:15], s3 offen lds
s_addk_i32 m0, 4096
s_mov_b32 s3, 414720
buffer_load_dwordx4 v57, s[12:15], s3 offen lds
s_addk_i32 m0, 4096
s_mov_b32 s3, 496640
buffer_load_dwordx4 v58, s[12:15], s3 offen lds
s_addk_i32 m0, 4096
s_mov_b32 s3, 578560
buffer_load_dwordx4 v58, s[12:15], s3 offen lds
s_addk_i32 m0, 4096
s_mov_b32 s3, 660480
buffer_load_dwordx4 v60, s[12:15], s3 offen lds
s_addk_i32 m0, 4096
s_mov_b32 s3, 793600
buffer_load_dwordx4 v59, s[12:15], s3 offen lds
s_branch L_woe
L_pad_12:
s_setpc_b64 s[100:101]
L_woe3:
s_addk_i32 m0, 4096
s_mov_b32 s3, 10240
buffer_load_dwordx4 v58, s[12:15], s3 offen lds
s_addk_i32 m0, 4096
s_mov_b32 s3, 92160
buffer_load_dwordx4 v58, s[12:15], s3 offen lds
s_addk_i32 m0, 4096
s_mov_b32 s3, 174080
buffer_load_dwordx4 v58, s[12:15], s3 offen lds
s_addk_i32 m0, 4096
s_mov_b32 s3, 307200
buffer_load_dwordx4 v59, s[12:15], s3 offen lds
s_addk_i32 m0, 4096
s_mov_b32 s3, 389120
buffer_load_dwordx4 v59, s[12:15], s3 offen lds
s_addk_i32 m0, 4096
s_mov_b32 s3, 419840
buffer_load_dwordx4 v58, s[12:15], s3 offen lds
s_addk_i32 m0, 4096
s_mov_b32 s3, 501760
buffer_load_dwordx4 v58, s[12:15], s3 offen lds
s_addk_i32 m0, 4096
s_mov_b32 s3, 583680
buffer_load_dwordx4 v58, s[12:15], s3 offen lds
s_addk_i32 m0, 4096
s_mov_b32 s3, 716800
buffer_load_dwordx4 v59, s[12:15], s3 offen lds
s_addk_i32 m0, 4096
s_mov_b32 s3, 798720
buffer_load_dwordx4 v59, s[12:15], s3 offen lds
s_branch L_woe
L_gl_4g:
buffer_store_dwordx4 v[192:195], v224, s[20:23], s54 offen sc1
s_branch L_gl_4b
L_gl_5g:
buffer_store_dwordx4 v[196:199], v226, s[20:23], 0 offen sc1
s_branch L_gl_5b
L_h0rh:
s_sub_u32 s40, s40, 1
s_cbranch_scc1 L_h0xh
buffer_load_dwordx4 v[92:95], v225, s[20:23], s54 offen sc1
s_waitcnt vmcnt(0)
v_cmp_eq_u32 vcc, -1, v92
s_cbranch_vccnz L_h0rh
s_branch L_h0gh
L_h0xh:
s_mov_b32 s40, 0
s_branch L_h0gh
L_gl_6g:
buffer_store_dwordx4 v[80:83], v226, s[20:23], s54 offen sc1
s_branch L_gl_6b
L_spw:
v_mov_b32 v1, 1744
ds_read_b32 v1, v1
s_waitcnt lgkmcnt(0)
v_cmp_ne_u32 vcc, 4, v1
s_cbranch_vccnz L_spw
s_branch L_sbw
L_st0:
s_sub_u32 s40, s40, 1
s_cbranch_scc1 L_sx0
buffer_load_dwordx4 v[24:27], v227, s[20:23], s61 offen offset:0 sc1
buffer_load_dwordx4 v[28:31], v227, s[20:23], s61 offen offset:256 sc1
s_waitcnt vmcnt(0)
v_max_u16 v2, v24, v28
v_cmp_eq_u16 vcc, -1, v2
s_cbranch_vccnz L_st0
s_branch L_go0
L_sx0:
s_mov_b32 s40, 0
s_branch L_go0
L_st1:
s_sub_u32 s40, s40, 1
s_cbranch_scc1 L_sx1
buffer_load_dwordx4 v[32:35], v227, s[20:23], s61 offen offset:512 sc1
buffer_load_dwordx4 v[36:39], v227, s[20:23], s61 offen offset:768 sc1
s_waitcnt vmcnt(0)
v_max_u16 v2, v32, v36
v_cmp_eq_u16 vcc, -1, v2
s_cbranch_vccnz L_st1
s_branch L_go1
L_sx1:
s_mov_b32 s40, 0
s_branch L_go1
L_st2:
s_sub_u32 s40, s40, 1
s_cbranch_scc1 L_sx2
buffer_load_dwordx4 v[40:43], v227, s[20:23], s61 offen offset:1024 sc1
s_waitcnt vmcnt(0)
v_cmp_eq_u16 vcc, -1, v40
s_cbranch_vccnz L_st2
s_branch L_go2
L_sx2:
s_mov_b32 s40, 0
s_branch L_go2
L_st3:
s_sub_u32 s40, s40, 1
s_cbranch_scc1 L_sx3
buffer_load_dwordx4 v[44:47], v227, s[20:23], s62 offen offset:0 sc1
buffer_load_dwordx4 v[48:51], v236, s[20:23], s62 offen offset:0 sc1
s_waitcnt vmcnt(0)
v_max_u16 v2, v44, v48
v_cmp_eq_u16 vcc, -1, v2
s_cbranch_vccnz L_st3
s_branch L_go3
L_sx3:
s_mov_b32 s40, 0
s_branch L_go3
L_st4:
s_sub_u32 s40, s40, 1
s_cbranch_scc1 L_sx4
buffer_load_dwordx4 v[52:55], v227, s[20:23], s62 offen offset:256 sc1
buffer_load_dwordx4 v[56:59], v236, s[20:23], s62 offen offset:256 sc1
s_waitcnt vmcnt(0)
v_max_u16 v2, v52, v56
v_cmp_eq_u16 vcc, -1, v2
s_cbranch_vccnz L_st4
s_branch L_go4
L_sx4:
s_mov_b32 s40, 0
s_branch L_go4
L_pad_13:
s_setpc_b64 s[100:101]
L_st5:
s_sub_u32 s40, s40, 1
s_cbranch_scc1 L_sx5
buffer_load_dwordx4 v[60:63], v227, s[20:23], s62 offen offset:512 sc1
buffer_load_dwordx4 v[64:67], v236, s[20:23], s62 offen offset:512 sc1
s_waitcnt vmcnt(0)
v_max_u16 v2, v60, v64
v_cmp_eq_u16 vcc, -1, v2
s_cbranch_vccnz L_st5
s_branch L_go5
L_sx5:
s_mov_b32 s40, 0
s_branch L_go5
L_st6:
s_sub_u32 s40, s40, 1
s_cbranch_scc1 L_sx6
buffer_load_dwordx4 v[68:71], v227, s[20:23], s62 offen offset:768 sc1
buffer_load_dwordx4 v[72:75], v236, s[20:23], s62 offen offset:768 sc1
s_waitcnt vmcnt(0)
v_max_u16 v2, v68, v72
v_cmp_eq_u16 vcc, -1, v2
s_cbranch_vccnz L_st6
s_branch L_go6
L_sx6:
s_mov_b32 s40, 0
s_branch L_go6
L_st7:
s_sub_u32 s40, s40, 1
s_cbranch_scc1 L_sx7
buffer_load_dwordx4 v[76:79], v227, s[20:23], s62 offen offset:1024 sc1
buffer_load_dwordx4 v[80:83], v236, s[20:23], s62 offen offset:1024 sc1
s_waitcnt vmcnt(0)
v_max_u16 v2, v76, v80
v_cmp_eq_u16 vcc, -1, v2
s_cbranch_vccnz L_st7
s_branch L_go7
L_sx7:
s_mov_b32 s40, 0
s_branch L_go7
L_st8:
s_sub_u32 s40, s40, 1
s_cbranch_scc1 L_sx8
buffer_load_dwordx4 v[84:87], v227, s[20:23], s63 offen offset:0 sc1
buffer_load_dwordx4 v[88:91], v236, s[20:23], s63 offen offset:0 sc1
s_waitcnt vmcnt(0)
v_max_u16 v2, v84, v88
v_cmp_eq_u16 vcc, -1, v2
s_cbranch_vccnz L_st8
s_branch L_go8
L_sx8:
s_mov_b32 s40, 0
s_branch L_go8
L_st9:
s_sub_u32 s40, s40, 1
s_cbranch_scc1 L_sx9
buffer_load_dwordx4 v[92:95], v227, s[20:23], s63 offen offset:256 sc1
buffer_load_dwordx4 v[96:99], v236, s[20:23], s63 offen offset:256 sc1
s_waitcnt vmcnt(0)
v_max_u16 v2, v92, v96
v_cmp_eq_u16 vcc, -1, v2
s_cbranch_vccnz L_st9
s_branch L_go9
L_sx9:
s_mov_b32 s40, 0
s_branch L_go9
L_st10:
s_sub_u32 s40, s40, 1
s_cbranch_scc1 L_sx10
buffer_load_dwordx4 v[100:103], v227, s[20:23], s63 offen offset:512 sc1
buffer_load_dwordx4 v[24:27], v236, s[20:23], s63 offen offset:512 sc1
s_waitcnt vmcnt(0)
v_max_u16 v2, v100, v24
v_cmp_eq_u16 vcc, -1, v2
s_cbranch_vccnz L_st10
s_branch L_go10
L_sx10:
s_mov_b32 s40, 0
s_branch L_go10
L_st11:
s_sub_u32 s40, s40, 1
s_cbranch_scc1 L_sx11
buffer_load_dwordx4 v[28:31], v236, s[20:23], s63 offen offset:768 sc1
buffer_load_dwordx4 v[32:35], v236, s[20:23], s63 offen offset:1024 sc1
s_waitcnt vmcnt(0)
v_max_u16 v2, v28, v32
v_cmp_eq_u16 vcc, -1, v2
s_cbranch_vccnz L_st11
s_branch L_go11
L_sx11:
s_mov_b32 s40, 0
s_branch L_go11
L_st12:
s_sub_u32 s40, s40, 1
s_cbranch_scc1 L_sx12
buffer_load_dwordx4 v[36:39], v227, s[20:23], s63 offen offset:768 sc1
buffer_load_dwordx4 v[40:43], v227, s[20:23], s63 offen offset:1024 sc1
s_waitcnt vmcnt(0)
v_max_u16 v2, v36, v40
v_cmp_eq_u16 vcc, -1, v2
s_cbranch_vccnz L_st12
s_branch L_go12
L_sx12:
s_mov_b32 s40, 0
s_branch L_go12
L_st13:
s_sub_u32 s40, s40, 1
s_cbranch_scc1 L_sx13
buffer_load_dwordx4 v[44:47], v227, s[20:23], s64 offen offset:0 sc1
buffer_load_dwordx4 v[48:51], v227, s[20:23], s64 offen offset:256 sc1
s_waitcnt vmcnt(0)
v_max_u16 v2, v44, v48
v_cmp_eq_u16 vcc, -1, v2
s_cbranch_vccnz L_st13
s_branch L_go13
L_sx13:
s_mov_b32 s40, 0
s_branch L_go13
L_pad_14:
s_setpc_b64 s[100:101]
L_st14:
s_sub_u32 s40, s40, 1
s_cbranch_scc1 L_sx14
buffer_load_dwordx4 v[52:55], v227, s[20:23], s64 offen offset:512 sc1
buffer_load_dwordx4 v[56:59], v227, s[20:23], s64 offen offset:768 sc1
s_waitcnt vmcnt(0)
v_max_u16 v2, v52, v56
v_cmp_eq_u16 vcc, -1, v2
s_cbranch_vccnz L_st14
s_branch L_go14
L_sx14:
s_mov_b32 s40, 0
s_branch L_go14
L_st15:
s_sub_u32 s40, s40, 1
s_cbranch_scc1 L_sx15
buffer_load_dwordx4 v[60:63], v227, s[20:23], s64 offen offset:1024 sc1
s_waitcnt vmcnt(0)
v_cmp_eq_u16 vcc, -1, v60
s_cbranch_vccnz L_st15
s_branch L_go15
L_sx15:
s_mov_b32 s40, 0
s_branch L_go15
L_gl_9g:
buffer_store_dwordx4 v[32:35], v1, s[16:19], s3 offen sc1
s_branch L_gl_9b
L_pad_15:
s_setpc_b64 s[100:101]
L_h0:
s_setprio 2
v_lshrrev_b32 v1, 3, v0
v_and_b32 v2, 2, v1
v_xor_b32 v2, v2, v0
v_and_b32 v2, 7, v2
s_lshl_b32 s3, s36, 7
v_lshl_add_u32 v2, v2, 4, s3
v_mul_u32_u24 v3, 3840, v1
v_add_u32 v24, v3, v2
v_xor_b32 v27, 64, v24
v_add_u32 v27, 30720, v27
v_mov_b32 v55, 0
v_add_u32 v25, 256, v24
v_add_u32 v26, 512, v24
v_add_u32 v28, 256, v27
v_add_u32 v29, 512, v27
v_lshrrev_b32 v1, 4, v0
v_lshlrev_b32 v1, 3, v1
s_lshl_b32 s3, s36, 7
buffer_load_dwordx2 v[244:245], v1, s[28:31], s3 offen offset:0
buffer_load_dwordx2 v[246:247], v1, s[28:31], s3 offen offset:32
buffer_load_dwordx2 v[248:249], v1, s[28:31], s3 offen offset:64
buffer_load_dwordx2 v[250:251], v1, s[28:31], s3 offen offset:96
s_waitcnt vmcnt(4)
s_barrier
s_mov_b32 s42, 1
s_mov_b32 s65, 45056
L_wl:
s_add_u32 s69, s69, 1
s_cmp_eq_u32 s69, 10
s_cselect_b32 s69, 0, s69
s_add_u32 s61, s61, 36864
s_cmp_eq_u32 s61, 155648
s_cselect_b32 s61, 8192, s61
s_mul_i32 s63, s69, 245760
s_add_u32 m0, s61, 12288
s_nop 0
buffer_load_dwordx4 v24, s[8:11], s63 offen offset:0 lds
buffer_load_dwordx4 v25, s[8:11], s63 offen offset:1024 lds
buffer_load_dwordx4 v26, s[8:11], s63 offen offset:2048 lds
s_addk_i32 m0, 3072
s_nop 0
buffer_load_dwordx4 v27, s[8:11], s63 offen offset:0 lds
buffer_load_dwordx4 v28, s[8:11], s63 offen offset:1024 lds
buffer_load_dwordx4 v29, s[8:11], s63 offen offset:2048 lds
s_addk_i32 m0, 3072
s_add_u32 s63, s63, 61440
buffer_load_dwordx4 v24, s[8:11], s63 offen offset:0 lds
buffer_load_dwordx4 v25, s[8:11], s63 offen offset:1024 lds
buffer_load_dwordx4 v26, s[8:11], s63 offen offset:2048 lds
s_addk_i32 m0, 3072
s_nop 0
buffer_load_dwordx4 v27, s[8:11], s63 offen offset:0 lds
buffer_load_dwordx4 v28, s[8:11], s63 offen offset:1024 lds
buffer_load_dwordx4 v29, s[8:11], s63 offen offset:2048 lds
s_addk_i32 m0, 3072
s_add_u32 s63, s63, 61440
buffer_load_dwordx4 v24, s[8:11], s63 offen offset:0 lds
buffer_load_dwordx4 v25, s[8:11], s63 offen offset:1024 lds
buffer_load_dwordx4 v26, s[8:11], s63 offen offset:2048 lds
s_addk_i32 m0, 3072
s_nop 0
buffer_load_dwordx4 v27, s[8:11], s63 offen offset:0 lds
buffer_load_dwordx4 v28, s[8:11], s63 offen offset:1024 lds
buffer_load_dwordx4 v29, s[8:11], s63 offen offset:2048 lds
s_addk_i32 m0, 3072
s_add_u32 s63, s63, 61440
buffer_load_dwordx4 v24, s[8:11], s63 offen offset:0 lds
buffer_load_dwordx4 v25, s[8:11], s63 offen offset:1024 lds
buffer_load_dwordx4 v26, s[8:11], s63 offen offset:2048 lds
s_addk_i32 m0, 3072
s_nop 0
buffer_load_dwordx4 v27, s[8:11], s63 offen offset:0 lds
buffer_load_dwordx4 v28, s[8:11], s63 offen offset:1024 lds
buffer_load_dwordx4 v29, s[8:11], s63 offen offset:2048 lds
s_mov_b32 s0, s65
s_mov_b32 s65, s61
s_cmp_eq_u32 s57, s42
s_waitcnt vmcnt(24) lgkmcnt(0)
s_barrier
s_cbranch_scc0 L_wc
s_call_b64 s[100:101], L_xcap
L_wc:
s_add_u32 s42, s42, 1
s_cmp_lt_u32 s42, 9
s_cbranch_scc1 L_wl
s_branch L_h8
L_pad_21:
s_setpc_b64 s[100:101]
L_c23:
ds_read_b64 v[96:97], v202 offset:0
ds_read_b64 v[98:99], v202 offset:1152
ds_read_b64 v[116:117], v206 offset:0
ds_read_b64 v[118:119], v207 offset:0
ds_read_b64 v[100:101], v203 offset:0
ds_read_b64 v[102:103], v203 offset:1152
ds_read_b64 v[120:121], v208 offset:0
ds_read_b64 v[122:123], v209 offset:0
ds_read_b64 v[104:105], v201 offset:0
ds_read_b64 v[106:107], v201 offset:1152
ds_read_b64 v[124:125], v210 offset:0
ds_read_b64 v[126:127], v211 offset:0
s_add_u32 s0, s37, 1
s_sub_u32 s1, 5, s37
s_min_u32 s0, s0, s1
s_lshl_b32 s0, s0, 4
s_sub_u32 s1, 64, s0
s_cmp_le_u32 s37, 2
s_cselect_b32 s1, s1, 16
s_bfm_b64 s[100:101], s0, s1
s_waitcnt lgkmcnt(8)
v_mfma_f32_16x16x32_bf16 v[152:155], v[96:99], v[116:119], 0
s_waitcnt lgkmcnt(4)
v_mfma_f32_16x16x32_bf16 v[156:159], v[100:103], v[120:123], 0
s_waitcnt lgkmcnt(0)
v_mfma_f32_16x16x32_bf16 v[152:155], v[104:107], v[124:127], v[152:155]
v_add_u32 v1, 128, v222
v_cndmask_b32 v2, v1, v222, s[44:45]
ds_read_b64 v[168:169], v2 offset:0
v_cndmask_b32 v2, v1, v222, s[46:47]
ds_read_b64 v[170:171], v2 offset:32
v_cndmask_b32 v2, v1, v222, s[48:49]
ds_read_b64 v[172:173], v2 offset:64
v_cndmask_b32 v2, v1, v222, s[50:51]
ds_read_b64 v[174:175], v2 offset:96
ds_read_b32 v5, v223
v_permlane16_swap_b32 v152, v156
v_permlane16_swap_b32 v153, v157
v_permlane16_swap_b32 v154, v158
v_permlane16_swap_b32 v155, v159
v_cndmask_b32 v2, v156, v152, s[44:45]
v_cndmask_b32 v3, v157, v153, s[46:47]
v_cndmask_b32 v194, v158, v154, s[48:49]
v_cndmask_b32 v195, v159, v155, s[50:51]
v_or_b32 v192, 0xffff, v2
v_perm_b32 v193, v3, v2, s55
s_cmp_eq_u32 s41, 1
s_cbranch_scc0 L_gl_22g
buffer_store_dwordx4 v[192:195], v224, s[20:23], s54 offen
L_gl_22b:
v_mov_b32 v184, 0
v_mov_b32 v185, 0
v_mov_b32 v186, 0
v_mov_b32 v187, 0
v_mov_b32 v188, 0
v_mov_b32 v189, 0
v_mov_b32 v190, 0
v_mov_b32 v191, 0
ds_read_b64_tr_b16 v[72:73], v217 offset:0
ds_read_b64_tr_b16 v[74:75], v217 offset:1152
ds_read_b64_tr_b16 v[76:77], v218 offset:0
ds_read_b64_tr_b16 v[78:79], v218 offset:1152
s_waitcnt lgkmcnt(0)
v_mul_f32 v5, 0x3ea52b5c, v5
buffer_load_dwordx4 v[92:95], v225, s[20:23], s54 offen sc1
s_waitcnt vmcnt(0)
v_cmp_eq_u32 vcc, -1, v92
s_cbranch_vccnz L_h0rl
L_h0gl:
s_lshl_b32 s0, s32, 2
s_add_u32 s0, s0, 1744
v_mov_b32 v1, s0
ds_write_b32 v1, v1
v_perm_b32 v92, v92, v93, s56
v_add_f32 v193, v3, v93
v_add_f32 v194, v194, v94
v_add_f32 v195, v195, v95
v_add_f32 v192, v2, v92
v_fma_f32 v192, v192, v168, v169
v_fma_f32 v193, v193, v170, v171
v_fma_f32 v194, v194, v172, v173
v_fma_f32 v195, v195, v174, v175
v_max3_f32 v6, v192, v193, v194
v_max_f32 v6, v6, v195
v_mov_b32 v7, v6
s_nop 1
v_permlane32_swap_b32 v6, v7
v_max_f32 v6, v6, v7
v_mul_f32 v6, v6, v5
v_fma_f32 v192, v192, v5, -v6
v_fma_f32 v193, v193, v5, -v6
v_fma_f32 v194, v194, v5, -v6
v_fma_f32 v195, v195, v5, -v6
v_exp_f32 v192, v192
v_exp_f32 v193, v193
v_exp_f32 v194, v194
v_exp_f32 v195, v195
v_add_f32 v6, v192, v193
v_add_f32 v7, v194, v195
v_add_f32 v6, v6, v7
v_mov_b32 v7, v6
v_mul_f32 v192, v192, v168
v_mul_f32 v193, v193, v170
v_permlane32_swap_b32 v6, v7
v_mul_f32 v194, v194, v172
v_add_f32 v6, v6, v7
v_rcp_f32 v6, v6
v_mul_f32 v195, v195, v174
v_mul_f32 v192, v192, v6
v_mul_f32 v193, v193, v6
v_mul_f32 v194, v194, v6
v_mul_f32 v195, v195, v6
v_cvt_pk_bf16_f32 v192, v192, v193
v_cvt_pk_bf16_f32 v193, v194, v195
s_mov_b64 exec, s[52:53]
v_and_b32 v184, v220, v192
v_bfi_b32 v188, v220, 0, v192
v_and_b32 v185, v221, v193
v_bfi_b32 v189, v221, 0, v193
s_not_b64 exec, exec
v_and_b32 v186, v220, v192
v_bfi_b32 v190, v220, 0, v192
v_and_b32 v187, v221, v193
v_bfi_b32 v191, v221, 0, v193
s_mov_b64 exec, -1
v_permlane16_swap_b32 v184, v188
v_permlane16_swap_b32 v185, v189
v_permlane16_swap_b32 v186, v190
v_permlane16_swap_b32 v187, v191
s_nop 1
v_mfma_f32_16x16x32_bf16 v[152:155], v[72:75], v[184:187], 0
v_mfma_f32_16x16x32_bf16 v[156:159], v[76:79], v[184:187], 0
v_mfma_f32_16x16x32_bf16 v[160:163], v[76:79], v[188:191], 0
s_mov_b32 exec_lo, 0xffff0000
s_nop 4
v_cvt_pk_bf16_f32 v80, v152, v153
v_cvt_pk_bf16_f32 v81, v154, v155
v_cvt_pk_bf16_f32 v82, v156, v157
v_cvt_pk_bf16_f32 v83, v158, v159
s_mov_b64 exec, s[100:101]
v_cvt_pk_bf16_f32 v82, v160, v161
v_cvt_pk_bf16_f32 v83, v162, v163
s_mov_b32 exec_lo, 0xffff0000
s_mov_b32 exec_hi, 0xffffffff
s_cmp_eq_u32 s41, 1
s_cbranch_scc0 L_gl_23g
buffer_store_dwordx4 v[80:83], v226, s[20:23], s54 offen
L_gl_23b:
s_endpgm
L_pad_24:
s_setpc_b64 s[100:101]
L_gl_22g:
buffer_store_dwordx4 v[192:195], v224, s[20:23], s54 offen sc1
s_branch L_gl_22b
L_h0rl:
s_sub_u32 s40, s40, 1
s_cbranch_scc1 L_h0xl
buffer_load_dwordx4 v[92:95], v225, s[20:23], s54 offen sc1
s_waitcnt vmcnt(0)
v_cmp_eq_u32 vcc, -1, v92
s_cbranch_vccnz L_h0rl
s_branch L_h0gl
L_h0xl:
s_mov_b32 s40, 0
s_branch L_h0gl
L_gl_23g:
buffer_store_dwordx4 v[80:83], v226, s[20:23], s54 offen sc1
s_branch L_gl_23b
.p2align 12
L_pb_16:
L_cons:
v_and_b32 v1, 15, v0
v_lshrrev_b32 v2, 4, v0
v_mov_b32 v7, 1792
s_mul_i32 s0, s44, 2304
s_movk_i32 s1, 144
v_bfe_u32 v3, v0, 2, 1
v_and_b32 v4, 3, v0
v_lshlrev_b32 v4, 1, v4
v_lshl_add_u32 v3, v3, 3, v4
v_bfe_u32 v4, v0, 3, 1
v_add_u32 v3, v3, v4
s_add_u32 s3, s0, 17408
v_mov_b32 v4, s3
v_mad_u32_u24 v3, v3, s1, v4
s_add_u32 s3, s0, 4736
v_mov_b32 v4, s3
v_mad_u32_u24 v4, v1, s1, v4
s_mov_b32 s52, 0xff00ff
s_mov_b32 s53, 0xff00ff
v_add_u32 v5, s51, v2
v_lshl_add_u32 v200, v5, 3, v3
v_lshl_add_u32 v5, v5, 3, v4
v_cndmask_b32 v204, v7, v5, s[52:53]
v_cndmask_b32 v205, v5, v7, s[52:53]
v_add_u32 v5, s46, v2
v_lshl_add_u32 v202, v5, 3, v3
v_lshl_add_u32 v5, v5, 3, v4
v_cmp_gt_u32 vcc, s47, v2
s_nop 1
v_cndmask_b32 v5, v7, v5, vcc
v_cndmask_b32 v206, v7, v5, s[52:53]
v_cndmask_b32 v207, v5, v7, s[52:53]
v_add_u32 v5, s48, v2
v_min_u32 v5, 15, v5
v_lshl_add_u32 v203, v5, 3, v3
v_lshl_add_u32 v5, v5, 3, v4
v_cmp_gt_u32 vcc, s49, v2
s_nop 1
v_cndmask_b32 v5, v7, v5, vcc
v_cndmask_b32 v208, v7, v5, s[52:53]
v_cndmask_b32 v209, v5, v7, s[52:53]
s_sub_u32 s3, s51, 1
v_mad_u32_u24 v5, v2, 5, s3
s_add_u32 s3, s46, 4
v_mov_b32 v6, s3
s_mov_b64 vcc, 0xffff
v_cndmask_b32 v5, v5, v6, vcc
v_min_u32 v5, 15, v5
v_lshl_add_u32 v201, v5, 3, v3
v_lshl_add_u32 v5, v5, 3, v4
s_cmp_eq_u32 s47, 5
s_cselect_b64 vcc, 0xff, 0
v_cndmask_b32 v210, v7, v5, vcc
s_lshl_b64 vcc, vcc, 8
v_cndmask_b32 v211, v7, v5, vcc
s_bfm_b64 vcc, 8, 16
v_cndmask_b32 v212, v7, v5, vcc
s_bfm_b64 vcc, 8, 24
v_cndmask_b32 v213, v7, v5, vcc
s_bfm_b64 vcc, 8, 32
v_cndmask_b32 v214, v7, v5, vcc
s_bfm_b64 vcc, 8, 40
v_cndmask_b32 v215, v7, v5, vcc
s_mul_i32 s0, s44, 2304
s_movk_i32 s1, 144
v_bfe_u32 v3, v0, 2, 3
v_lshrrev_b32 v4, 5, v0
v_lshl_add_u32 v3, v3, 1, v4
s_add_u32 s3, s0, 31232
v_mov_b32 v4, s3
v_mad_u32_u24 v3, v3, s1, v4
v_and_b32 v4, 3, v0
s_mov_b32 s54, 0x11111111
s_mov_b32 s55, 0x11111111
v_add_u32 v5, s51, v4
v_lshl_add_u32 v216, v5, 3, v3
v_add_u32 v7, 32, v216
s_cmp_eq_u32 s50, 1
s_cselect_b32 s3, -1, 12
s_cselect_b32 s56, 2, -1
v_add_u32 v5, s3, v4
v_lshl_add_u32 v5, v5, 3, v3
v_cndmask_b32 v217, v5, v7, s[54:55]
v_add_u32 v7, 40, v7
v_add_u32 v5, s56, v4
v_add_u32 v6, 10, v5
v_cmp_gt_i32 vcc, s51, v5
s_nop 1
v_cndmask_b32 v5, v6, v5, vcc
v_lshl_add_u32 v5, v5, 3, v3
v_cndmask_b32 v218, v5, v7, s[54:55]
s_lshl_b32 s0, s44, 8
v_lshrrev_b32 v4, 5, v0
v_and_or_b32 v3, v0, 8, v4
s_add_u32 s3, s0, 8
v_lshl_add_u32 v222, v3, 4, s3
v_and_b32 v1, 15, v0
s_add_u32 s3, s0, 132
v_lshl_add_u32 v223, v1, 4, s3
s_lshr_b32 s3, s39, 8
s_mul_i32 s3, s3, 52429
s_lshr_b32 s3, s3, 18
s_lshl_b32 s0, s44, 5
s_add_u32 s3, s3, s0
s_sub_u32 s3, 2047, s3
v_mad_i32_i24 v234, v1, -2, s3
v_lshrrev_b32 v2, 4, v0
v_and_or_b32 v3, v0, 8, v2
v_and_b32 v4, 0x70, v233
v_bfrev_b32 v6, 1
s_lshl_b32 s3, s44, 4
v_add_u32 v5, s3, v3
s_lshl_b32 s3, s60, 3
v_cmp_gt_u32 vcc, s3, v5
v_mul_u32_u24 v5, 2560, v5
v_add3_u32 v5, v5, v4, s39
v_cndmask_b32 v227, v6, v5, vcc
s_lshl_b32 s3, s36, 7
v_add_u32 v226, s3, v227
v_bfe_u32 v3, v0, 4, 1
v_cmp_eq_u32 s[54:55], s50, v3
s_cmp_lg_u32 s37, 0
s_cselect_b64 s[0:1], -1, s[54:55]
s_and_b64 vcc, vcc, s[0:1]
s_cmp_lg_u32 s37, 4
s_cselect_b64 s[0:1], 0, s[54:55]
s_andn2_b64 vcc, vcc, s[0:1]
v_cndmask_b32 v225, v6, v226, vcc
s_cmp_le_u32 s37, 3
s_cselect_b32 s3, 2560, 0
s_sub_u32 s3, s3, 128
v_mov_b32 v4, s3
s_cmp_ge_u32 s37, 2
s_cselect_b32 s3, 2560, 0
s_add_u32 s3, s3, 128
v_mov_b32 v5, s3
v_cndmask_b32 v4, v4, v5, s[54:55]
v_mul_u32_u24 v3, 2560, v3
v_sub_u32 v4, v4, v3
v_add_u32 v4, v4, v226
v_cndmask_b32 v224, v6, v4, vcc
v_and_b32 v1, 15, v0
v_bfrev_b32 v6, 1
v_bfe_u32 v3, v0, 4, 1
v_lshrrev_b32 v4, 5, v0
v_lshl_add_u32 v3, v3, 1, v4
s_lshl_b32 s3, s36, 7
v_lshl_add_u32 v4, v3, 4, s3
s_lshl_b32 s3, s44, 4
v_add_u32 v5, s3, v1
s_lshl_b32 s3, s60, 3
v_cmp_gt_u32 vcc, s3, v5
v_mul_u32_u24 v5, 2560, v5
v_add3_u32 v5, v5, v4, s39
v_cndmask_b32 v232, v6, v5, vcc
v_bfe_u32 v3, v0, 3, 2
v_lshlrev_b32 v3, 2, v3
v_and_or_b32 v3, v0, 3, v3
v_lshlrev_b32 v3, 3, v3
v_bfe_u32 v4, v0, 2, 2
v_lshl_add_u32 v3, v4, 7, v3
v_lshrrev_b32 v2, 4, v0
s_mov_b32 s44, 0x0
s_mov_b32 s45, 0x1010101
s_mov_b32 s46, 0x3030303
s_mov_b32 s47, 0x7070707
s_mov_b32 s48, 0xf0f0f0f
s_mov_b32 s49, 0x1f1f1f1f
s_mov_b32 s50, 0x3f3f3f3f
s_mov_b32 s51, 0x7f7f7f7f
s_movk_i32 s54, 10240
s_mov_b32 s55, 0x07060501
s_mov_b32 s56, 0x0706000c
v_mov_b32 v5, 0xffff
v_mov_b32 v6, 0xffff0000
v_cndmask_b32 v1, 0, v5, s[44:45]
v_cndmask_b32 v4, 0, v6, s[46:47]
v_or_b32 v220, v1, v4
v_cndmask_b32 v1, 0, v5, s[48:49]
v_cndmask_b32 v4, 0, v6, s[50:51]
v_or_b32 v221, v1, v4
s_lshl_b32 s3, s38, 5
v_xor_b32 v3, s3, v3
v_mul_u32_u24 v4, 3072, v2
v_add_u32 v3, v3, v4
v_add_u32 v244, 20480, v3
s_mov_b32 s42, 0
v_mov_b32 v3, 0
v_lshlrev_b32 v2, 2, v0
s_mov_b32 exec_hi, 0
ds_write_b32 v2, v3 offset:1728
ds_write_b32 v2, v3 offset:2880
s_mov_b64 exec, -1
v_and_b32 v1, 15, v0
v_lshrrev_b32 v2, 4, v0
v_lshrrev_b32 v3, 1, v1
v_xor_b32 v3, v3, v2
v_lshlrev_b32 v3, 4, v3
v_lshl_add_u32 v3, v1, 7, v3
v_add_u32 v245, 8192, v3
v_xor_b32 v246, 64, v245
v_mul_u32_u24 v3, 144, v1
v_lshl_add_u32 v3, v2, 3, v3
s_lshl_b32 s3, s38, 5
s_add_u32 s3, s3, 3584
v_add_u32 v247, s3, v3
v_lshlrev_b32 v248, 4, v1
s_cmp_eq_u32 s32, 0
s_cbranch_scc0 L_cw0
s_call_b64 s[100:101], L_pad_2
L_cw0:
s_cmp_eq_u32 s32, 1
s_cbranch_scc0 L_cw1
s_call_b64 s[100:101], L_pad_15
L_cw1:
s_cmp_eq_u32 s32, 2
s_cbranch_scc0 L_cw2
s_call_b64 s[100:101], L_pad_18
L_cw2:
s_cmp_eq_u32 s32, 3
s_cbranch_scc0 L_cw3
L_cw3:
s_cmp_eq_u32 s69, 9
s_cselect_b32 s3, -2457600, 0
s_add_u32 s3, s3, 245760
v_add_u32 v254, s3, v254
s_mul_i32 s3, s38, 3072
s_add_u32 m0, s3, 57344
s_mov_b32 s0, 122880
buffer_load_dwordx4 v254, s[8:11], 0 offen offset:0 lds
s_addk_i32 m0, -256
s_nop 0
buffer_load_dwordx4 v254, s[8:11], 0 offen offset:1280 lds
s_addk_i32 m0, -256
s_nop 0
buffer_load_dwordx4 v254, s[8:11], 0 offen offset:2560 lds
s_addk_i32 m0, 12800
s_nop 0
buffer_load_dwordx4 v254, s[8:11], s0 offen offset:0 lds
s_addk_i32 m0, -256
s_nop 0
buffer_load_dwordx4 v254, s[8:11], s0 offen offset:1280 lds
s_addk_i32 m0, -256
s_nop 0
buffer_load_dwordx4 v254, s[8:11], s0 offen offset:2560 lds
v_mov_b32 v4, -1
v_mov_b32 v5, -1
v_mov_b32 v6, -1
v_mov_b32 v7, -1
v_lshrrev_b32 v1, 3, v0
v_mul_u32_u24 v1, 2560, v1
v_and_b32 v2, 0x70, v233
s_lshl_b32 s3, s36, 7
s_add_u32 s3, s3, s39
v_add3_u32 v1, v1, v2, s3
s_mul_i32 s0, s38, 20480
s_add_u32 s1, s0, 81920
s_add_u32 s3, s38, 8
s_cmp_lt_u32 s3, s60
s_cselect_b32 s3, s1, 0x80000000
s_add_u32 s3, s3, 81920
buffer_store_dwordx4 v[4:7], v1, s[20:23], s0 offen
buffer_store_dwordx4 v[4:7], v1, s[20:23], s1 offen
buffer_store_dwordx4 v[4:7], v1, s[20:23], s3 offen
v_lshrrev_b32 v1, 4, v0
v_mul_u32_u24 v1, 2304, v1
v_add_u32 v1, v1, v233
s_mul_i32 s1, s43, 15360
s_lshl_b32 s3, s36, 8
s_add_u32 s1, s1, s3
s_and_b32 s3, s38, 1
s_mul_i32 s3, s3, 7680
s_add_u32 s1, s1, s3
s_add_u32 s1, s1, 2097152
s_cmp_lt_u32 s38, 2
s_cselect_b32 s1, s1, 0x80000000
s_mov_b32 exec_hi, 0xffff
buffer_store_dwordx4 v[4:7], v1, s[16:19], s1 offen
s_mov_b64 exec, -1
s_cmp_lt_u32 s32, 2
s_cselect_b32 s57, s57, 99
s_mov_b32 s65, 8192
s_min_u32 s62, s57, 1
s_waitcnt vmcnt(10) lgkmcnt(0)
s_barrier
ds_read_b64_tr_b16 v[156:157], v244 offset:1024
ds_read_b64_tr_b16 v[158:159], v244 offset:1536
ds_read_b128 v[80:83], v245 offset:0
ds_read_b128 v[84:87], v245 offset:2048
ds_read_b128 v[88:91], v245 offset:4096
ds_read_b128 v[92:95], v245 offset:6144
ds_read_b128 v[96:99], v245 offset:8192
ds_read_b128 v[100:103], v245 offset:10240
ds_read_b64_tr_b16 v[160:161], v244 offset:2048
ds_read_b64_tr_b16 v[162:163], v244 offset:2560
ds_read_b64_tr_b16 v[152:153], v244 offset:0
ds_read_b64_tr_b16 v[154:155], v244 offset:512
s_waitcnt lgkmcnt(4)
v_mfma_f32_16x16x32_bf16 v[32:35], v[156:159], v[80:83], 0
ds_read_b64_tr_b16 v[168:169], v244 offset:13312
v_mfma_f32_16x16x32_bf16 v[36:39], v[156:159], v[84:87], 0
ds_read_b64_tr_b16 v[170:171], v244 offset:13824
v_mfma_f32_16x16x32_bf16 v[40:43], v[156:159], v[88:91], 0
ds_read_b128 v[104:107], v246 offset:0
v_mfma_f32_16x16x32_bf16 v[44:47], v[156:159], v[92:95], 0
ds_read_b128 v[108:111], v246 offset:2048
v_mfma_f32_16x16x32_bf16 v[48:51], v[156:159], v[96:99], 0
ds_read_b128 v[112:115], v246 offset:4096
v_mfma_f32_16x16x32_bf16 v[52:55], v[156:159], v[100:103], 0
ds_read_b128 v[116:119], v246 offset:6144
s_waitcnt lgkmcnt(8)
v_mfma_f32_16x16x32_bf16 v[56:59], v[160:163], v[80:83], 0
ds_read_b128 v[120:123], v246 offset:8192
v_mfma_f32_16x16x32_bf16 v[60:63], v[160:163], v[84:87], 0
ds_read_b128 v[124:127], v246 offset:10240
v_mfma_f32_16x16x32_bf16 v[64:67], v[160:163], v[88:91], 0
ds_read_b64_tr_b16 v[172:173], v244 offset:14336
v_mfma_f32_16x16x32_bf16 v[68:71], v[160:163], v[92:95], 0
ds_read_b64_tr_b16 v[174:175], v244 offset:14848
v_mfma_f32_16x16x32_bf16 v[72:75], v[160:163], v[96:99], 0
ds_read_b64_tr_b16 v[164:165], v244 offset:12288
v_mfma_f32_16x16x32_bf16 v[76:79], v[160:163], v[100:103], 0
ds_read_b64_tr_b16 v[166:167], v244 offset:12800
s_waitcnt lgkmcnt(12)
v_mfma_f32_16x16x32_bf16 v[8:11], v[152:155], v[80:83], 0
s_add_u32 s3, s65, 36864
s_cmp_eq_u32 s3, 155648
v_mfma_f32_16x16x32_bf16 v[12:15], v[152:155], v[84:87], 0
s_cselect_b32 s3, 8192, s3
s_sub_u32 s63, s3, s65
v_mfma_f32_16x16x32_bf16 v[16:19], v[152:155], v[88:91], 0
s_mov_b32 s65, s3
v_add_u32 v245, s63, v245
v_mfma_f32_16x16x32_bf16 v[20:23], v[152:155], v[92:95], 0
v_add_u32 v244, s63, v244
v_add_u32 v246, s63, v246
v_mfma_f32_16x16x32_bf16 v[24:27], v[152:155], v[96:99], 0
v_mfma_f32_16x16x32_bf16 v[28:31], v[152:155], v[100:103], 0
s_add_u32 s42, s42, 1
s_cmp_lt_u32 s42, 9
s_waitcnt lgkmcnt(4)
v_mfma_f32_16x16x32_bf16 v[32:35], v[168:171], v[104:107], v[32:35]
v_mfma_f32_16x16x32_bf16 v[36:39], v[168:171], v[108:111], v[36:39]
v_mfma_f32_16x16x32_bf16 v[40:43], v[168:171], v[112:115], v[40:43]
v_mfma_f32_16x16x32_bf16 v[44:47], v[168:171], v[116:119], v[44:47]
v_mfma_f32_16x16x32_bf16 v[48:51], v[168:171], v[120:123], v[48:51]
v_mfma_f32_16x16x32_bf16 v[52:55], v[168:171], v[124:127], v[52:55]
s_waitcnt lgkmcnt(2)
v_mfma_f32_16x16x32_bf16 v[56:59], v[172:175], v[104:107], v[56:59]
v_mfma_f32_16x16x32_bf16 v[60:63], v[172:175], v[108:111], v[60:63]
v_mfma_f32_16x16x32_bf16 v[64:67], v[172:175], v[112:115], v[64:67]
v_mfma_f32_16x16x32_bf16 v[68:71], v[172:175], v[116:119], v[68:71]
v_mfma_f32_16x16x32_bf16 v[72:75], v[172:175], v[120:123], v[72:75]
s_waitcnt vmcnt(4) lgkmcnt(0)
v_mfma_f32_16x16x32_bf16 v[76:79], v[172:175], v[124:127], v[76:79]
s_branch L_pb_17
L_pad_25:
s_setpc_b64 s[100:101]
L_ev:
s_cmp_eq_u32 s42, 1
s_cbranch_scc0 L_ev1
s_waitcnt vmcnt(0)
L_ev1:
s_max_u32 s62, s57, 1
s_cmp_eq_u32 s42, s57
s_cbranch_scc0 L_evb
s_sub_u32 s0, s65, s63
v_add_u32 v1, s0, v235
ds_read_b64 v[236:237], v1
v_xor_b32 v2, 32, v1
ds_read_b64 v[238:239], v2
v_xor_b32 v3, 64, v1
ds_read_b64 v[240:241], v3
v_xor_b32 v4, 96, v1
ds_read_b64 v[242:243], v4
s_branch L_evb
L_gs:
v_mov_b32 v4, -1
v_mov_b32 v5, -1
v_mov_b32 v6, -1
v_mov_b32 v7, -1
v_lshrrev_b32 v1, 3, v0
v_mul_u32_u24 v1, 2560, v1
v_and_b32 v2, 0x70, v233
s_lshl_b32 s3, s36, 7
s_add_u32 s3, s3, s39
v_add3_u32 v1, v1, v2, s3
s_mul_i32 s0, s38, 20480
s_add_u32 s1, s0, 81920
s_add_u32 s3, s38, 8
s_cmp_lt_u32 s3, s60
s_cselect_b32 s3, s1, 0x80000000
s_add_u32 s3, s3, 81920
buffer_store_dwordx4 v[4:7], v1, s[20:23], s0 offen sc1
buffer_store_dwordx4 v[4:7], v1, s[20:23], s1 offen sc1
buffer_store_dwordx4 v[4:7], v1, s[20:23], s3 offen sc1
v_lshrrev_b32 v1, 4, v0
v_mul_u32_u24 v1, 2304, v1
v_add_u32 v1, v1, v233
s_mul_i32 s1, s43, 15360
s_lshl_b32 s3, s36, 8
s_add_u32 s1, s1, s3
s_and_b32 s3, s38, 1
s_mul_i32 s3, s3, 7680
s_add_u32 s1, s1, s3
s_add_u32 s1, s1, 2097152
s_cmp_lt_u32 s38, 2
s_cselect_b32 s1, s1, 0x80000000
s_mov_b32 exec_hi, 0xffff
buffer_store_dwordx4 v[4:7], v1, s[16:19], s1 offen sc1
s_mov_b64 exec, -1
s_waitcnt vmcnt(0)
s_barrier
s_barrier
s_branch L_gsb
.p2align 12
L_pad_18:
s_setpc_b64 s[100:101]
L_pb_17:
L_cloop:
s_barrier
ds_read_b64_tr_b16 v[156:157], v244 offset:1024
ds_read_b64_tr_b16 v[158:159], v244 offset:1536
v_mfma_f32_16x16x32_bf16 v[8:11], v[164:167], v[104:107], v[8:11]
ds_read_b128 v[80:83], v245 offset:0
v_mfma_f32_16x16x32_bf16 v[12:15], v[164:167], v[108:111], v[12:15]
ds_read_b128 v[84:87], v245 offset:2048
v_mfma_f32_16x16x32_bf16 v[16:19], v[164:167], v[112:115], v[16:19]
ds_read_b128 v[88:91], v245 offset:4096
v_mfma_f32_16x16x32_bf16 v[20:23], v[164:167], v[116:119], v[20:23]
ds_read_b128 v[92:95], v245 offset:6144
v_mfma_f32_16x16x32_bf16 v[24:27], v[164:167], v[120:123], v[24:27]
ds_read_b128 v[96:99], v245 offset:8192
v_mfma_f32_16x16x32_bf16 v[28:31], v[164:167], v[124:127], v[28:31]
ds_read_b128 v[100:103], v245 offset:10240
s_waitcnt lgkmcnt(5)
v_mfma_f32_16x16x32_bf16 v[32:35], v[156:159], v[80:83], v[32:35]
ds_read_b64_tr_b16 v[160:161], v244 offset:2048
s_waitcnt lgkmcnt(5)
v_mfma_f32_16x16x32_bf16 v[36:39], v[156:159], v[84:87], v[36:39]
ds_read_b64_tr_b16 v[162:163], v244 offset:2560
s_waitcnt lgkmcnt(5)
v_mfma_f32_16x16x32_bf16 v[40:43], v[156:159], v[88:91], v[40:43]
ds_read_b64_tr_b16 v[152:153], v244 offset:0
s_waitcnt lgkmcnt(5)
v_mfma_f32_16x16x32_bf16 v[44:47], v[156:159], v[92:95], v[44:47]
ds_read_b64_tr_b16 v[154:155], v244 offset:512
s_waitcnt lgkmcnt(5)
v_mfma_f32_16x16x32_bf16 v[48:51], v[156:159], v[96:99], v[48:51]
ds_read_b64_tr_b16 v[168:169], v244 offset:13312
s_waitcnt lgkmcnt(5)
v_mfma_f32_16x16x32_bf16 v[52:55], v[156:159], v[100:103], v[52:55]
ds_read_b64_tr_b16 v[170:171], v244 offset:13824
s_waitcnt lgkmcnt(4)
v_mfma_f32_16x16x32_bf16 v[56:59], v[160:163], v[80:83], v[56:59]
ds_read_b128 v[104:107], v246 offset:0
v_mfma_f32_16x16x32_bf16 v[60:63], v[160:163], v[84:87], v[60:63]
ds_read_b128 v[108:111], v246 offset:2048
v_mfma_f32_16x16x32_bf16 v[64:67], v[160:163], v[88:91], v[64:67]
ds_read_b128 v[112:115], v246 offset:4096
v_mfma_f32_16x16x32_bf16 v[68:71], v[160:163], v[92:95], v[68:71]
ds_read_b128 v[116:119], v246 offset:6144
v_mfma_f32_16x16x32_bf16 v[72:75], v[160:163], v[96:99], v[72:75]
ds_read_b128 v[120:123], v246 offset:8192
v_mfma_f32_16x16x32_bf16 v[76:79], v[160:163], v[100:103], v[76:79]
ds_read_b128 v[124:127], v246 offset:10240
s_waitcnt lgkmcnt(8)
v_mfma_f32_16x16x32_bf16 v[8:11], v[152:155], v[80:83], v[8:11]
ds_read_b64_tr_b16 v[172:173], v244 offset:14336
v_mfma_f32_16x16x32_bf16 v[12:15], v[152:155], v[84:87], v[12:15]
ds_read_b64_tr_b16 v[174:175], v244 offset:14848
v_mfma_f32_16x16x32_bf16 v[16:19], v[152:155], v[88:91], v[16:19]
ds_read_b64_tr_b16 v[164:165], v244 offset:12288
v_mfma_f32_16x16x32_bf16 v[20:23], v[152:155], v[92:95], v[20:23]
ds_read_b64_tr_b16 v[166:167], v244 offset:12800
v_mfma_f32_16x16x32_bf16 v[24:27], v[152:155], v[96:99], v[24:27]
s_add_u32 s3, s65, 36864
s_cmp_eq_u32 s3, 155648
v_mfma_f32_16x16x32_bf16 v[28:31], v[152:155], v[100:103], v[28:31]
s_cselect_b32 s3, 8192, s3
s_sub_u32 s63, s3, s65
s_waitcnt lgkmcnt(4)
v_mfma_f32_16x16x32_bf16 v[32:35], v[168:171], v[104:107], v[32:35]
s_mov_b32 s65, s3
v_add_u32 v245, s63, v245
v_mfma_f32_16x16x32_bf16 v[36:39], v[168:171], v[108:111], v[36:39]
v_add_u32 v244, s63, v244
v_add_u32 v246, s63, v246
v_mfma_f32_16x16x32_bf16 v[40:43], v[168:171], v[112:115], v[40:43]
s_cmp_eq_u32 s42, s62
s_cbranch_scc1 L_ev
L_evb:
v_mfma_f32_16x16x32_bf16 v[44:47], v[168:171], v[116:119], v[44:47]
v_mfma_f32_16x16x32_bf16 v[48:51], v[168:171], v[120:123], v[48:51]
s_add_u32 s42, s42, 1
s_cmp_lt_u32 s42, 9
v_mfma_f32_16x16x32_bf16 v[52:55], v[168:171], v[124:127], v[52:55]
s_waitcnt lgkmcnt(2)
v_mfma_f32_16x16x32_bf16 v[56:59], v[172:175], v[104:107], v[56:59]
v_mfma_f32_16x16x32_bf16 v[60:63], v[172:175], v[108:111], v[60:63]
v_mfma_f32_16x16x32_bf16 v[64:67], v[172:175], v[112:115], v[64:67]
v_mfma_f32_16x16x32_bf16 v[68:71], v[172:175], v[116:119], v[68:71]
v_mfma_f32_16x16x32_bf16 v[72:75], v[172:175], v[120:123], v[72:75]
s_waitcnt lgkmcnt(0)
v_mfma_f32_16x16x32_bf16 v[76:79], v[172:175], v[124:127], v[76:79]
s_cbranch_scc1 L_cloop
v_mov_b32 v1, 1728
ds_read_b32 v1, v1
ds_read2_b64 v[180:183], v248 offset0:0 offset1:32
ds_read2_b64 v[184:187], v248 offset0:64 offset1:96
ds_read2_b64 v[188:191], v248 offset0:128 offset1:160
s_waitcnt lgkmcnt(0)
v_readfirstlane_b32 s41, v1
s_barrier
s_cmp_eq_u32 s41, 1
s_cbranch_scc0 L_gs
L_gsb:
ds_read_b64_tr_b16 v[156:157], v244 offset:1024
ds_read_b64_tr_b16 v[158:159], v244 offset:1536
v_mfma_f32_16x16x32_bf16 v[8:11], v[164:167], v[104:107], v[8:11]
ds_read_b128 v[80:83], v245 offset:0
v_mfma_f32_16x16x32_bf16 v[12:15], v[164:167], v[108:111], v[12:15]
ds_read_b128 v[84:87], v245 offset:2048
v_mfma_f32_16x16x32_bf16 v[16:19], v[164:167], v[112:115], v[16:19]
ds_read_b128 v[88:91], v245 offset:4096
v_mfma_f32_16x16x32_bf16 v[20:23], v[164:167], v[116:119], v[20:23]
ds_read_b128 v[92:95], v245 offset:6144
v_mfma_f32_16x16x32_bf16 v[24:27], v[164:167], v[120:123], v[24:27]
ds_read_b128 v[96:99], v245 offset:8192
v_mfma_f32_16x16x32_bf16 v[28:31], v[164:167], v[124:127], v[28:31]
ds_read_b128 v[100:103], v245 offset:10240
ds_read_b64_tr_b16 v[176:177], v244 offset:13312
ds_read_b64_tr_b16 v[178:179], v244 offset:13824
s_waitcnt lgkmcnt(7)
v_mfma_f32_16x16x32_bf16 v[32:35], v[156:159], v[80:83], v[32:35]
ds_read_b128 v[128:131], v246 offset:0
s_waitcnt lgkmcnt(7)
v_mfma_f32_16x16x32_bf16 v[36:39], v[156:159], v[84:87], v[36:39]
ds_read_b128 v[132:135], v246 offset:2048
s_waitcnt lgkmcnt(7)
v_mfma_f32_16x16x32_bf16 v[40:43], v[156:159], v[88:91], v[40:43]
ds_read_b128 v[136:139], v246 offset:4096
s_waitcnt lgkmcnt(7)
v_mfma_f32_16x16x32_bf16 v[44:47], v[156:159], v[92:95], v[44:47]
ds_read_b128 v[140:143], v246 offset:6144
s_waitcnt lgkmcnt(7)
v_mfma_f32_16x16x32_bf16 v[48:51], v[156:159], v[96:99], v[48:51]
ds_read_b128 v[144:147], v246 offset:8192
s_waitcnt lgkmcnt(7)
v_mfma_f32_16x16x32_bf16 v[52:55], v[156:159], v[100:103], v[52:55]
ds_read_b128 v[148:151], v246 offset:10240
s_waitcnt lgkmcnt(5)
v_mfma_f32_16x16x32_bf16 v[32:35], v[176:179], v[128:131], v[32:35]
ds_read_b64_tr_b16 v[160:161], v244 offset:2048
s_waitcnt lgkmcnt(5)
v_mfma_f32_16x16x32_bf16 v[36:39], v[176:179], v[132:135], v[36:39]
ds_read_b64_tr_b16 v[162:163], v244 offset:2560
s_waitcnt lgkmcnt(5)
v_mfma_f32_16x16x32_bf16 v[40:43], v[176:179], v[136:139], v[40:43]
ds_read_b64_tr_b16 v[152:153], v244 offset:0
s_waitcnt lgkmcnt(5)
v_mfma_f32_16x16x32_bf16 v[44:47], v[176:179], v[140:143], v[44:47]
ds_read_b64_tr_b16 v[154:155], v244 offset:512
s_waitcnt lgkmcnt(5)
v_mfma_f32_16x16x32_bf16 v[48:51], v[176:179], v[144:147], v[48:51]
ds_read_b64_tr_b16 v[172:173], v244 offset:14336
s_waitcnt lgkmcnt(5)
v_mfma_f32_16x16x32_bf16 v[52:55], v[176:179], v[148:151], v[52:55]
ds_read_b64_tr_b16 v[174:175], v244 offset:14848
s_waitcnt lgkmcnt(4)
v_mfma_f32_16x16x32_bf16 v[56:59], v[160:163], v[80:83], v[56:59]
ds_read_b64_tr_b16 v[164:165], v244 offset:12288
ds_read_b64_tr_b16 v[166:167], v244 offset:12800
v_mov_b32_dpp v192, v32 row_newbcast:0 row_mask:0xf bank_mask:0xf
v_mov_b32_dpp v193, v33 row_newbcast:0 row_mask:0xf bank_mask:0xf
v_mov_b32_dpp v194, v34 row_newbcast:0 row_mask:0xf bank_mask:0xf
v_mov_b32_dpp v195, v35 row_newbcast:0 row_mask:0xf bank_mask:0xf
v_fmac_f32 v32, v192, v180
v_fmac_f32 v33, v193, v180
v_fmac_f32 v34, v194, v180
v_mfma_f32_16x16x32_bf16 v[60:63], v[160:163], v[84:87], v[60:63]
v_fmac_f32 v35, v195, v180
v_cvt_pk_bf16_f32 v32, v32, v33
v_cvt_pk_bf16_f32 v33, v34, v35
v_mfma_f32_16x16x32_bf16 v[64:67], v[160:163], v[88:91], v[64:67]
ds_write_b64 v247, v[32:33] offset:13824
v_fmac_f32 v36, v192, v182
v_fmac_f32 v37, v193, v182
v_fmac_f32 v38, v194, v182
v_mfma_f32_16x16x32_bf16 v[68:71], v[160:163], v[92:95], v[68:71]
v_fmac_f32 v39, v195, v182
v_cvt_pk_bf16_f32 v36, v36, v37
v_cvt_pk_bf16_f32 v37, v38, v39
v_mfma_f32_16x16x32_bf16 v[72:75], v[160:163], v[96:99], v[72:75]
ds_write_b64 v247, v[36:37] offset:16128
v_fmac_f32 v40, v192, v184
v_fmac_f32 v41, v193, v184
v_fmac_f32 v42, v194, v184
v_mfma_f32_16x16x32_bf16 v[76:79], v[160:163], v[100:103], v[76:79]
v_fmac_f32 v43, v195, v184
v_cvt_pk_bf16_f32 v40, v40, v41
v_cvt_pk_bf16_f32 v41, v42, v43
s_waitcnt lgkmcnt(4)
v_mfma_f32_16x16x32_bf16 v[56:59], v[172:175], v[128:131], v[56:59]
ds_write_b64 v247, v[40:41] offset:18432
v_fmac_f32 v44, v192, v186
v_fmac_f32 v45, v193, v186
v_fmac_f32 v46, v194, v186
v_mfma_f32_16x16x32_bf16 v[60:63], v[172:175], v[132:135], v[60:63]
v_fmac_f32 v47, v195, v186
v_cvt_pk_bf16_f32 v44, v44, v45
v_cvt_pk_bf16_f32 v45, v46, v47
v_mfma_f32_16x16x32_bf16 v[64:67], v[172:175], v[136:139], v[64:67]
ds_write_b64 v247, v[44:45] offset:20736
v_fmac_f32 v48, v192, v188
v_fmac_f32 v49, v193, v188
v_fmac_f32 v50, v194, v188
v_mfma_f32_16x16x32_bf16 v[68:71], v[172:175], v[140:143], v[68:71]
v_fmac_f32 v51, v195, v188
v_cvt_pk_bf16_f32 v48, v48, v49
v_cvt_pk_bf16_f32 v49, v50, v51
v_mfma_f32_16x16x32_bf16 v[72:75], v[172:175], v[144:147], v[72:75]
ds_write_b64 v247, v[48:49] offset:23040
v_fmac_f32 v52, v192, v190
v_fmac_f32 v53, v193, v190
v_fmac_f32 v54, v194, v190
v_mfma_f32_16x16x32_bf16 v[76:79], v[172:175], v[148:151], v[76:79]
v_fmac_f32 v55, v195, v190
v_cvt_pk_bf16_f32 v52, v52, v53
v_cvt_pk_bf16_f32 v53, v54, v55
ds_write_b64 v247, v[52:53] offset:25344
v_mfma_f32_16x16x32_bf16 v[8:11], v[152:155], v[80:83], v[8:11]
v_mov_b32_dpp v192, v56 row_newbcast:0 row_mask:0xf bank_mask:0xf
v_mov_b32_dpp v193, v57 row_newbcast:0 row_mask:0xf bank_mask:0xf
v_mov_b32_dpp v194, v58 row_newbcast:0 row_mask:0xf bank_mask:0xf
v_mov_b32_dpp v195, v59 row_newbcast:0 row_mask:0xf bank_mask:0xf
v_fmac_f32 v56, v192, v180
v_fmac_f32 v57, v193, v180
v_fmac_f32 v58, v194, v180
v_mfma_f32_16x16x32_bf16 v[12:15], v[152:155], v[84:87], v[12:15]
v_fmac_f32 v59, v195, v180
v_cvt_pk_bf16_f32 v56, v56, v57
v_cvt_pk_bf16_f32 v57, v58, v59
v_mfma_f32_16x16x32_bf16 v[16:19], v[152:155], v[88:91], v[16:19]
s_waitcnt lgkmcnt(0)
s_barrier
ds_write_b64 v247, v[56:57] offset:27648
v_fmac_f32 v60, v192, v182
v_fmac_f32 v61, v193, v182
v_fmac_f32 v62, v194, v182
v_mfma_f32_16x16x32_bf16 v[20:23], v[152:155], v[92:95], v[20:23]
v_fmac_f32 v63, v195, v182
v_cvt_pk_bf16_f32 v60, v60, v61
v_cvt_pk_bf16_f32 v61, v62, v63
v_mfma_f32_16x16x32_bf16 v[24:27], v[152:155], v[96:99], v[24:27]
ds_write_b64 v247, v[60:61] offset:29952
v_fmac_f32 v64, v192, v184
v_fmac_f32 v65, v193, v184
v_fmac_f32 v66, v194, v184
v_mfma_f32_16x16x32_bf16 v[28:31], v[152:155], v[100:103], v[28:31]
v_fmac_f32 v67, v195, v184
v_cvt_pk_bf16_f32 v64, v64, v65
v_cvt_pk_bf16_f32 v65, v66, v67
v_mfma_f32_16x16x32_bf16 v[8:11], v[164:167], v[128:131], v[8:11]
ds_write_b64 v247, v[64:65] offset:32256
v_fmac_f32 v68, v192, v186
v_fmac_f32 v69, v193, v186
v_fmac_f32 v70, v194, v186
v_mfma_f32_16x16x32_bf16 v[12:15], v[164:167], v[132:135], v[12:15]
v_fmac_f32 v71, v195, v186
v_cvt_pk_bf16_f32 v68, v68, v69
v_cvt_pk_bf16_f32 v69, v70, v71
v_mfma_f32_16x16x32_bf16 v[16:19], v[164:167], v[136:139], v[16:19]
ds_write_b64 v247, v[68:69] offset:34560
v_fmac_f32 v72, v192, v188
v_fmac_f32 v73, v193, v188
v_fmac_f32 v74, v194, v188
v_mfma_f32_16x16x32_bf16 v[20:23], v[164:167], v[140:143], v[20:23]
v_fmac_f32 v75, v195, v188
v_cvt_pk_bf16_f32 v72, v72, v73
v_cvt_pk_bf16_f32 v73, v74, v75
v_mfma_f32_16x16x32_bf16 v[24:27], v[164:167], v[144:147], v[24:27]
ds_write_b64 v247, v[72:73] offset:36864
v_fmac_f32 v76, v192, v190
v_fmac_f32 v77, v193, v190
v_fmac_f32 v78, v194, v190
v_mfma_f32_16x16x32_bf16 v[28:31], v[164:167], v[148:151], v[28:31]
v_fmac_f32 v79, v195, v190
v_cvt_pk_bf16_f32 v76, v76, v77
v_cvt_pk_bf16_f32 v77, v78, v79
ds_write_b64 v247, v[76:77] offset:39168
v_mov_b32_dpp v192, v8 row_newbcast:0 row_mask:0xf bank_mask:0xf
v_mov_b32_dpp v193, v9 row_newbcast:0 row_mask:0xf bank_mask:0xf
v_mov_b32_dpp v194, v10 row_newbcast:0 row_mask:0xf bank_mask:0xf
v_mov_b32_dpp v195, v11 row_newbcast:0 row_mask:0xf bank_mask:0xf
v_pk_fma_f32 v[8:9], v[192:193], v[180:181], v[8:9] op_sel_hi:[1,0,1]
v_pk_fma_f32 v[10:11], v[194:195], v[180:181], v[10:11] op_sel_hi:[1,0,1]
v_cvt_pk_bf16_f32 v8, v8, v9
v_cvt_pk_bf16_f32 v9, v10, v11
ds_write_b64 v247, v[8:9] offset:0
v_pk_fma_f32 v[12:13], v[192:193], v[182:183], v[12:13] op_sel_hi:[1,0,1]
v_pk_fma_f32 v[14:15], v[194:195], v[182:183], v[14:15] op_sel_hi:[1,0,1]
v_cvt_pk_bf16_f32 v12, v12, v13
v_cvt_pk_bf16_f32 v13, v14, v15
ds_write_b64 v247, v[12:13] offset:2304
v_pk_fma_f32 v[16:17], v[192:193], v[184:185], v[16:17] op_sel_hi:[1,0,1]
v_pk_fma_f32 v[18:19], v[194:195], v[184:185], v[18:19] op_sel_hi:[1,0,1]
v_cvt_pk_bf16_f32 v16, v16, v17
v_cvt_pk_bf16_f32 v17, v18, v19
ds_write_b64 v247, v[16:17] offset:4608
v_pk_fma_f32 v[20:21], v[192:193], v[186:187], v[20:21] op_sel_hi:[1,0,1]
v_pk_fma_f32 v[22:23], v[194:195], v[186:187], v[22:23] op_sel_hi:[1,0,1]
v_cvt_pk_bf16_f32 v20, v20, v21
v_cvt_pk_bf16_f32 v21, v22, v23
ds_write_b64 v247, v[20:21] offset:6912
v_pk_fma_f32 v[24:25], v[192:193], v[188:189], v[24:25] op_sel_hi:[1,0,1]
v_pk_fma_f32 v[26:27], v[194:195], v[188:189], v[26:27] op_sel_hi:[1,0,1]
v_cvt_pk_bf16_f32 v24, v24, v25
v_cvt_pk_bf16_f32 v25, v26, v27
ds_write_b64 v247, v[24:25] offset:9216
v_pk_fma_f32 v[28:29], v[192:193], v[190:191], v[28:29] op_sel_hi:[1,0,1]
v_pk_fma_f32 v[30:31], v[194:195], v[190:191], v[30:31] op_sel_hi:[1,0,1]
v_cvt_pk_bf16_f32 v28, v28, v29
v_cvt_pk_bf16_f32 v29, v30, v31
ds_write_b64 v247, v[28:29] offset:11520
s_waitcnt lgkmcnt(0)
s_barrier
s_cmp_lt_u32 s32, 2
s_cbranch_scc0 L_c23
ds_read_b64 v[108:109], v200 offset:0
ds_read_b64 v[110:111], v200 offset:1152
ds_read_b64 v[128:129], v204 offset:0
ds_read_b64 v[130:131], v205 offset:0
ds_read_b64 v[112:113], v200 offset:40
ds_read_b64 v[114:115], v200 offset:1192
ds_read_b64 v[132:133], v204 offset:40
ds_read_b64 v[134:135], v205 offset:40
ds_read_b64 v[104:105], v201 offset:0
ds_read_b64 v[106:107], v201 offset:1152
ds_read_b64 v[136:137], v212 offset:0
ds_read_b64 v[138:139], v213 offset:0
ds_read_b64 v[140:141], v214 offset:0
ds_read_b64 v[142:143], v215 offset:0
v_mov_b32 v176, 0
v_mov_b32 v177, 0
v_mov_b32 v178, 0
v_mov_b32 v179, 0
v_mov_b32 v180, 0
v_mov_b32 v181, 0
v_mov_b32 v182, 0
v_mov_b32 v183, 0
s_waitcnt lgkmcnt(10)
v_mfma_f32_16x16x32_bf16 v[160:163], v[108:111], v[128:131], 0
s_waitcnt lgkmcnt(6)
v_mfma_f32_16x16x32_bf16 v[164:167], v[112:115], v[132:135], 0
v_add_u32 v1, 128, v222
v_cndmask_b32 v2, v1, v222, s[44:45]
ds_read_b64 v[168:169], v2 offset:0
v_cndmask_b32 v2, v1, v222, s[46:47]
ds_read_b64 v[170:171], v2 offset:32
v_cndmask_b32 v2, v1, v222, s[48:49]
ds_read_b64 v[172:173], v2 offset:64
v_cndmask_b32 v2, v1, v222, s[50:51]
ds_read_b64 v[174:175], v2 offset:96
ds_read_b32 v5, v223
s_waitcnt lgkmcnt(7)
v_mfma_f32_16x16x32_bf16 v[160:163], v[104:107], v[136:139], v[160:163]
s_waitcnt lgkmcnt(5)
v_mfma_f32_16x16x32_bf16 v[164:167], v[104:107], v[140:143], v[164:167]
s_nop 7
v_permlane16_swap_b32 v160, v164
v_permlane16_swap_b32 v161, v165
v_permlane16_swap_b32 v162, v166
v_permlane16_swap_b32 v163, v167
v_cndmask_b32 v196, v164, v160, s[44:45]
v_cndmask_b32 v197, v165, v161, s[46:47]
v_cndmask_b32 v198, v166, v162, s[48:49]
v_cndmask_b32 v199, v167, v163, s[50:51]
s_waitcnt lgkmcnt(0)
v_mul_f32 v5, 0x3ea52b5c, v5
v_fma_f32 v196, v196, v168, v169
v_fma_f32 v197, v197, v170, v171
v_fma_f32 v198, v198, v172, v173
v_fma_f32 v199, v199, v174, v175
v_max3_f32 v6, v196, v197, v198
v_max_f32 v6, v6, v199
v_mov_b32 v7, v6
s_nop 1
v_permlane32_swap_b32 v6, v7
v_max_f32 v6, v6, v7
v_mul_f32 v6, v6, v5
v_fma_f32 v196, v196, v5, -v6
v_fma_f32 v197, v197, v5, -v6
v_fma_f32 v198, v198, v5, -v6
v_fma_f32 v199, v199, v5, -v6
v_exp_f32 v196, v196
v_exp_f32 v197, v197
v_exp_f32 v198, v198
v_exp_f32 v199, v199
ds_read_b64_tr_b16 v[64:65], v216 offset:0
ds_read_b64_tr_b16 v[66:67], v216 offset:1152
ds_read_b64_tr_b16 v[68:69], v216 offset:40
ds_read_b64_tr_b16 v[70:71], v216 offset:1192
ds_read_b64_tr_b16 v[72:73], v217 offset:0
ds_read_b64_tr_b16 v[74:75], v217 offset:1152
ds_read_b64_tr_b16 v[76:77], v218 offset:0
ds_read_b64_tr_b16 v[78:79], v218 offset:1152
v_add_f32 v6, v196, v197
v_add_f32 v7, v198, v199
v_add_f32 v6, v6, v7
v_mov_b32 v7, v6
v_mul_f32 v196, v196, v168
v_mul_f32 v197, v197, v170
v_permlane32_swap_b32 v6, v7
v_mul_f32 v198, v198, v172
v_add_f32 v6, v6, v7
v_rcp_f32 v6, v6
v_mul_f32 v199, v199, v174
v_mul_f32 v196, v196, v6
v_mul_f32 v197, v197, v6
v_mul_f32 v198, v198, v6
v_mul_f32 v199, v199, v6
v_cvt_pk_bf16_f32 v196, v196, v197
v_cvt_pk_bf16_f32 v197, v198, v199
s_mov_b64 exec, s[52:53]
v_and_b32 v176, v220, v196
v_bfi_b32 v180, v220, 0, v196
v_and_b32 v177, v221, v197
v_bfi_b32 v181, v221, 0, v197
s_not_b64 exec, exec
v_and_b32 v178, v220, v196
v_bfi_b32 v182, v220, 0, v196
v_and_b32 v179, v221, v197
v_bfi_b32 v183, v221, 0, v197
s_mov_b64 exec, -1
v_permlane16_swap_b32 v176, v180
v_permlane16_swap_b32 v177, v181
v_permlane16_swap_b32 v178, v182
v_permlane16_swap_b32 v179, v183
s_waitcnt lgkmcnt(0)
s_nop 0
v_mfma_f32_16x16x32_bf16 v[152:155], v[64:67], v[176:179], 0
v_mfma_f32_16x16x32_bf16 v[156:159], v[68:71], v[180:183], 0
v_mfma_f32_16x16x32_bf16 v[160:163], v[72:75], v[176:179], 0
v_mfma_f32_16x16x32_bf16 v[164:167], v[76:79], v[180:183], 0
s_nop 4
v_cvt_pk_bf16_f32 v196, v152, v153
v_cvt_pk_bf16_f32 v197, v154, v155
v_cvt_pk_bf16_f32 v198, v156, v157
v_cvt_pk_bf16_f32 v199, v158, v159
s_cmp_eq_u32 s41, 1
s_cbranch_scc0 L_gl_19g
buffer_store_dwordx4 v[196:199], v226, s[20:23], 0 offen
L_gl_19b:
s_lshl_b32 s0, s32, 2
s_add_u32 s0, s0, 1752
v_mov_b32 v1, s0
ds_read_b32 v1, v1
v_cvt_pk_bf16_f32 v80, v160, v161
v_cvt_pk_bf16_f32 v81, v162, v163
v_cvt_pk_bf16_f32 v82, v164, v165
v_cvt_pk_bf16_f32 v83, v166, v167
s_waitcnt lgkmcnt(0)
v_cmp_eq_u32 vcc, 0, v1
s_cbranch_vccnz L_spr
L_sbr:
s_mov_b64 exec, 0xffff
s_cmp_eq_u32 s41, 1
s_cbranch_scc0 L_gl_20g
buffer_store_dwordx4 v[80:83], v226, s[20:23], s54 offen
L_gl_20b:
s_mov_b64 exec, -1
v_lshrrev_b32 v1, 4, v0
v_lshlrev_b32 v1, 3, v1
s_lshl_b32 s3, s36, 7
buffer_load_dwordx2 v[244:245], v1, s[28:31], s3 offen offset:0
buffer_load_dwordx2 v[246:247], v1, s[28:31], s3 offen offset:32
buffer_load_dwordx2 v[248:249], v1, s[28:31], s3 offen offset:64
buffer_load_dwordx2 v[250:251], v1, s[28:31], s3 offen offset:96
v_lshlrev_b32 v8, 16, v236
v_and_b32 v9, 0xffff0000, v236
v_lshlrev_b32 v10, 16, v237
v_and_b32 v11, 0xffff0000, v237
v_lshlrev_b32 v12, 16, v238
v_and_b32 v13, 0xffff0000, v238
v_lshlrev_b32 v14, 16, v239
v_and_b32 v15, 0xffff0000, v239
v_lshlrev_b32 v16, 16, v240
v_and_b32 v17, 0xffff0000, v240
v_lshlrev_b32 v18, 16, v241
v_and_b32 v19, 0xffff0000, v241
v_lshlrev_b32 v20, 16, v242
v_and_b32 v21, 0xffff0000, v242
v_lshlrev_b32 v22, 16, v243
v_and_b32 v23, 0xffff0000, v243
s_lshl_b32 s0, s32, 13
s_add_u32 s0, s0, 57344
v_add_u32 v4, s0, v233
s_lshl_b32 s0, s32, 2
s_add_u32 s0, s0, 1760
s_waitcnt vmcnt(0)
s_mov_b32 s3, 0x3f803f80
v_mov_b32 v236, s3
v_mov_b32 v237, s3
v_mov_b32 v238, s3
v_mov_b32 v239, s3
s_mov_b32 exec_lo, 0x11111111
s_mov_b32 exec_hi, 0x11111111
v_mov_b32 v244, s3
v_mov_b32 v245, s3
v_mov_b32 v246, s3
v_mov_b32 v247, s3
v_mov_b32 v248, s3
v_mov_b32 v249, s3
v_mov_b32 v250, s3
v_mov_b32 v251, s3
s_mov_b64 exec, -1
v_mfma_f32_16x16x32_bf16 v[252:255], v[244:247], v[236:239], 0
v_mfma_f32_16x16x32_bf16 v[252:255], v[248:251], v[236:239], v[252:255]
v_mov_b32 v2, s0
L_fx:
s_sleep 1
ds_read_b32 v1, v2
s_waitcnt lgkmcnt(0)
v_cmp_ne_u32 vcc, 2, v1
s_cbranch_vccnz L_fx
s_setprio 2
ds_read_b128 v[24:27], v4 offset:0
ds_read_b128 v[28:31], v4 offset:1024
ds_read_b128 v[32:35], v4 offset:2048
ds_read_b128 v[36:39], v4 offset:3072
ds_read_b128 v[40:43], v4 offset:4096
ds_read_b128 v[44:47], v4 offset:5120
ds_read_b128 v[48:51], v4 offset:6144
ds_read_b128 v[52:55], v4 offset:7168
s_waitcnt lgkmcnt(7)
v_add_f32 v8, v8, v24
v_add_f32 v9, v9, v25
v_add_f32 v10, v10, v26
v_add_f32 v11, v11, v27
s_waitcnt lgkmcnt(6)
v_add_f32 v12, v12, v28
v_add_f32 v13, v13, v29
v_add_f32 v14, v14, v30
v_add_f32 v15, v15, v31
s_waitcnt lgkmcnt(5)
v_add_f32 v16, v16, v32
v_add_f32 v17, v17, v33
v_add_f32 v18, v18, v34
v_add_f32 v19, v19, v35
s_waitcnt lgkmcnt(4)
v_add_f32 v20, v20, v36
v_add_f32 v21, v21, v37
v_add_f32 v22, v22, v38
v_add_f32 v23, v23, v39
s_waitcnt lgkmcnt(3)
v_add_f32 v8, v8, v40
v_add_f32 v9, v9, v41
v_add_f32 v10, v10, v42
v_add_f32 v11, v11, v43
s_waitcnt lgkmcnt(2)
v_add_f32 v12, v12, v44
v_add_f32 v13, v13, v45
v_add_f32 v14, v14, v46
v_add_f32 v15, v15, v47
s_waitcnt lgkmcnt(1)
v_add_f32 v16, v16, v48
v_add_f32 v17, v17, v49
v_add_f32 v18, v18, v50
v_add_f32 v19, v19, v51
s_waitcnt lgkmcnt(0)
v_add_f32 v20, v20, v52
v_add_f32 v21, v21, v53
v_add_f32 v22, v22, v54
v_add_f32 v23, v23, v55
s_branch L_tail
L_gl_19g:
buffer_store_dwordx4 v[196:199], v226, s[20:23], 0 offen sc1
s_branch L_gl_19b
L_spr:
s_sleep 1
v_mov_b32 v1, s0
ds_read_b32 v1, v1
s_waitcnt lgkmcnt(0)
v_cmp_eq_u32 vcc, 0, v1
s_cbranch_vccnz L_spr
s_branch L_sbr
L_gl_20g:
buffer_store_dwordx4 v[80:83], v226, s[20:23], s54 offen sc1
s_branch L_gl_20b
L_moe:
s_cmp_ge_u32 s34, 32
s_cbranch_scc1 L_end
s_lshr_b32 s32, s32, 6
v_and_b32 v0, 63, v0
s_lshl_b32 s36, s33, 1
s_add_u32 s36, s36, s34
s_sub_u32 s36, s36, 30
s_mov_b32 s40, 524288
v_lshlrev_b32 v6, 4, v0
v_mov_b32 v132, 0
v_mov_b32 v133, 0
v_mov_b32 v144, 0
s_waitcnt lgkmcnt(0)
s_mov_b64 s[16:17], s[66:67]
s_mov_b32 s18, 0x10000000
s_mov_b32 s19, 0x20000
s_mov_b64 s[24:25], s[64:65]
s_mov_b32 s26, 0x100
s_mov_b32 s27, 0x20000
s_mov_b64 s[4:5], s[54:55]
s_mov_b32 s6, 0x1e0000
s_mov_b32 s7, 0x20000
s_mov_b64 s[8:9], s[56:57]
s_mov_b32 s10, 0x1e0000
s_mov_b32 s11, 0x20000
s_mov_b64 s[12:13], s[60:61]
s_mov_b32 s14, 0x1e0000
s_mov_b32 s15, 0x20000
s_mov_b64 s[20:21], s[62:63]
s_mov_b32 s22, 0x280000
s_mov_b32 s23, 0x20000
v_mov_b32 v8, -1
v_mov_b32 v9, -1
v_mov_b32 v10, -1
v_mov_b32 v11, -1
s_lshl_b32 s0, s36, 14
s_lshl_b32 s3, s32, 11
s_add_u32 s0, s0, s3
s_add_u32 s0, s0, 3145728
buffer_store_dwordx4 v[8:11], v6, s[16:19], s0 offen offset:0 sc1
buffer_store_dwordx4 v[8:11], v6, s[16:19], s0 offen offset:1024 sc1
s_and_b32 s44, s36, 1
s_mul_i32 s0, s33, 384
s_lshl_b32 s1, s44, 8
s_add_u32 s1, s1, s0
s_mul_i32 s3, s32, 24576
s_add_u32 s1, s1, s3
v_lshrrev_b32 v1, 3, v0
v_mul_u32_u24 v1, 3072, v1
s_lshr_b32 s3, s32, 1
v_xor_b32 v2, s3, v0
v_and_b32 v2, 7, v2
v_lshl_add_u32 v1, v2, 4, v1
v_add_u32 v4, s1, v1
v_xor_b32 v5, 64, v4
s_lshl_b32 s1, s44, 6
s_add_u32 s0, s0, s1
s_and_b32 s3, s32, 3
s_mul_i32 s1, s3, 49152
s_add_u32 s0, s0, s1
s_add_u32 s0, s0, 128
v_lshrrev_b32 v1, 2, v0
v_mul_u32_u24 v1, 3072, v1
v_xor_b32 v2, s3, v0
v_and_b32 v2, 3, v2
v_lshl_add_u32 v1, v2, 4, v1
v_add_u32 v249, s0, v1
s_cmp_lt_u32 s32, 4
s_cselect_b64 s[28:29], s[4:5], s[8:9]
s_cselect_b32 s62, 0, 128
s_mov_b32 s30, 0x1e0000
s_mov_b32 s31, 0x20000
s_lshl_b32 s61, s32, 10
s_add_u32 s62, s62, s61
s_mul_i32 s44, s44, 983040
s_mul_i32 s46, s36, 122880
s_cmp_lt_u32 s32, 5
s_cbranch_scc1 L_r0
s_add_u32 s45, s44, 0
s_add_u32 m0, s61, 0
s_nop 0
buffer_load_dwordx4 v4, s[4:7], s45 offen lds
s_add_u32 m0, s61, 8192
s_nop 0
buffer_load_dwordx4 v5, s[8:11], s45 offen lds
s_add_u32 s45, s44, 0
s_add_u32 m0, s62, 16384
s_nop 0
buffer_load_dwordx4 v249, s[28:31], s45 offen lds
s_waitcnt vmcnt(3)
s_barrier
s_branch L_r1
L_r0:
s_waitcnt vmcnt(0)
s_barrier
s_cmp_eq_u32 s32, 0
s_cbranch_scc0 L_nroot
s_lshl_b32 s0, s36, 4
v_mov_b32 v8, 1
s_mov_b64 exec, 1
buffer_store_dword v8, off, s[24:27], s0 sc1
s_mov_b64 exec, -1
L_nroot:
s_add_u32 s45, s44, 0
s_add_u32 m0, s61, 0
s_nop 0
buffer_load_dwordx4 v4, s[4:7], s45 offen lds
s_add_u32 m0, s61, 8192
s_nop 0
buffer_load_dwordx4 v5, s[8:11], s45 offen lds
s_add_u32 s45, s44, 0
s_add_u32 m0, s62, 16384
s_nop 0
buffer_load_dwordx4 v249, s[28:31], s45 offen lds
L_r1:
s_add_u32 s45, s44, 196608
s_add_u32 m0, s61, 42240
s_nop 0
buffer_load_dwordx4 v4, s[4:7], s45 offen lds
s_add_u32 m0, s61, 50432
s_nop 0
buffer_load_dwordx4 v5, s[8:11], s45 offen lds
s_add_u32 s45, s44, 196608
s_add_u32 m0, s62, 58624
s_nop 0
buffer_load_dwordx4 v249, s[28:31], s45 offen lds
v_lshrrev_b32 v1, 5, v0
v_bfe_u32 v2, v0, 2, 1
v_lshl_add_u32 v1, v1, 2, v2
v_bfe_u32 v2, v0, 4, 1
v_bfe_u32 v3, v0, 3, 1
v_lshl_add_u32 v3, v3, 1, v2
v_lshl_add_u32 v1, v3, 4, v1
v_xor_b32 v3, s32, v3
v_and_b32 v2, 1, v0
v_lshlrev_b32 v2, 3, v2
v_lshl_add_u32 v2, v3, 4, v2
v_bfe_u32 v3, v0, 1, 1
v_lshl_add_u32 v251, v1, 6, v2
v_mul_u32_u24 v8, 4224, v3
v_add_u32 v251, v251, v8
v_lshl_add_u32 v250, v1, 7, v2
v_mul_u32_u24 v8, 8256, v3
v_xor_b32 v250, v250, v8
v_mov_b32 v228, 0
v_mov_b32 v229, 0
v_mov_b32 v230, 0
v_mov_b32 v231, 0
v_mov_b32 v232, 0
v_mov_b32 v233, 0
v_mov_b32 v234, 0
v_mov_b32 v235, 0
v_mov_b32 v1, 0x4444
v_mov_b32 v2, 0xeeee
s_mov_b32 vcc_lo, 0xaaaaaaaa
s_mov_b32 vcc_hi, 0xaaaaaaaa
v_cndmask_b32 v7, v1, v2, vcc
v_and_b32 v1, 48, v0
v_and_b32 v2, 1, v0
v_lshlrev_b32 v2, 4, v2
v_lshl_add_u32 v252, v1, 1, v2
v_add_u32 v254, 126720, v252
v_add_u32 v252, 127232, v252
v_add_u32 v1, 126848, v1
v_mov_b32 v2, 126912
v_cndmask_b32 v255, v1, v2, vcc
v_mov_b32 v3, 0
v_lshl_add_u32 v2, v0, 2, v2
s_mov_b32 exec_hi, 0
ds_write_b32 v2, v3
s_mov_b64 exec, -1
s_and_b32 s3, s36, 1
s_cselect_b32 s0, 4, 0
s_cselect_b32 s1, -4, 8
s_add_u32 s0, s0, s32
v_bfe_u32 v1, v0, 4, 1
v_mul_i32_i24 v1, s1, v1
v_add_u32 v1, s0, v1
v_lshrrev_b32 v2, 1, v1
v_lshlrev_b32 v2, 2, v2
v_and_or_b32 v2, v1, 1, v2
v_and_or_b32 v2, v0, 2, v2
v_bfe_u32 v3, v0, 2, 1
v_lshl_add_u32 v2, v2, 1, v3
v_and_b32 v3, 1, v0
v_lshl_add_u32 v2, v2, 1, v3
v_and_b32 v3, 7, v0
v_lshl_add_u32 v3, v1, 3, v3
v_cmp_gt_u32 vcc, 8, v1
s_nop 1
v_cndmask_b32 v2, v3, v2, vcc
v_lshlrev_b32 v2, 1, v2
v_add_u32 v253, 126720, v2
s_lshl_b32 s47, s32, 15
s_lshl_b32 s3, s36, 6
s_add_u32 s47, s47, s3
s_add_u32 s47, s47, 3162112
v_lshrrev_b32 v1, 2, v0
v_and_b32 v2, 3, v0
v_lshlrev_b32 v2, 4, v2
v_lshl_add_u32 v2, v1, 10, v2
v_lshlrev_b32 v1, 4, v1
v_add_u32 v1, 4032, v1
s_mov_b64 vcc, 0xffff
v_cndmask_b32 v246, v1, v2, vcc
s_cmp_lt_u32 s32, 4
s_cselect_b32 s50, 0x00ff0000, 0
s_or_b32 s50, s50, 0xff
s_mov_b32 s51, 0
s_sub_u32 s3, s32, 4
s_lshl_b32 s3, s3, 4
s_add_u32 s52, s3, s36
s_mul_i32 s3, s52, 52
s_lshr_b32 s3, s3, 8
s_mul_i32 s3, s3, 27648
s_lshl_b32 s53, s52, 10
s_add_u32 s53, s53, s3
s_add_u32 s53, s53, 3162112
s_mov_b32 s49, 131072
s_mov_b32 s63, 0
s_mul_i32 s3, s52, 52
s_lshr_b32 s3, s3, 8
s_mul_i32 s0, s3, 5
s_sub_u32 s0, s52, s0
s_mul_i32 s3, s3, 80
s_lshl_b32 s1, s0, 2
s_cmp_eq_u32 s0, 4
s_cselect_b32 s1, 64, s1
s_cselect_b32 s0, 0, 4
s_cselect_b32 s48, 2, 0
s_add_u32 s3, s3, s1
v_bfe_u32 v1, v0, 4, 1
v_lshrrev_b32 v2, 5, v0
v_lshl_add_u32 v1, v1, 1, v2
v_lshlrev_b32 v1, s0, v1
v_and_b32 v2, 3, v0
v_lshlrev_b32 v2, s48, v2
v_add3_u32 v1, v1, v2, s3
v_lshlrev_b32 v128, 1, v1
v_lshlrev_b32 v129, 2, v1
v_lshrrev_b32 v1, 4, v0
v_bfe_u32 v2, v0, 2, 2
v_lshl_add_u32 v1, v1, 3, v2
v_mul_u32_u24 v1, 1280, v1
v_and_b32 v3, 1, v0
v_lshl_add_u32 v1, v3, 3, v1
v_bfe_u32 v2, v0, 2, 3
v_lshlrev_b32 v2, 1, v2
v_bfe_u32 v3, v0, 1, 1
s_mul_i32 s0, s32, 10
s_add_u32 s3, s0, 0
v_add_u32 v236, s3, v3
v_xor_b32 v236, v236, v2
v_lshl_add_u32 v236, v236, 4, v1
s_add_u32 s3, s0, 2
v_add_u32 v237, s3, v3
v_xor_b32 v237, v237, v2
v_lshl_add_u32 v237, v237, 4, v1
s_add_u32 s3, s0, 4
v_add_u32 v238, s3, v3
v_xor_b32 v238, v238, v2
v_lshl_add_u32 v238, v238, 4, v1
s_add_u32 s3, s0, 6
v_add_u32 v239, s3, v3
v_xor_b32 v239, v239, v2
v_lshl_add_u32 v239, v239, 4, v1
s_add_u32 s3, s0, 8
v_add_u32 v240, s3, v3
v_xor_b32 v240, v240, v2
v_lshl_add_u32 v240, v240, 4, v1
s_waitcnt vmcnt(3) lgkmcnt(0)
s_barrier
s_add_u32 s45, s44, 393216
s_add_u32 m0, s61, 84480
s_nop 0
buffer_load_dwordx4 v4, s[4:7], s45 offen lds
s_add_u32 m0, s61, 92672
s_nop 0
buffer_load_dwordx4 v5, s[8:11], s45 offen lds
s_add_u32 s45, s44, 393216
s_add_u32 m0, s62, 100864
s_nop 0
buffer_load_dwordx4 v249, s[28:31], s45 offen lds
v_add_u32 v1, 0, v250
ds_read_b64_tr_b16 v[8:9], v1 offset:0
ds_read_b64_tr_b16 v[10:11], v1 offset:256
ds_read_b64_tr_b16 v[12:13], v1 offset:1024
ds_read_b64_tr_b16 v[14:15], v1 offset:1280
s_cmp_lt_u32 s32, 4
s_cbranch_scc0 L_g0
v_add_u32 v1, 16384, v251
ds_read_b64_tr_b16 v[88:89], v1 offset:0
ds_read_b64_tr_b16 v[90:91], v1 offset:128
ds_read_b64_tr_b16 v[92:93], v1 offset:512
ds_read_b64_tr_b16 v[94:95], v1 offset:640
L_g0:
s_waitcnt vmcnt(3) lgkmcnt(0)
s_barrier
s_add_u32 s45, s44, 589824
s_add_u32 m0, s61, 0
s_nop 0
buffer_load_dwordx4 v4, s[4:7], s45 offen lds
s_add_u32 m0, s61, 8192
s_nop 0
buffer_load_dwordx4 v5, s[8:11], s45 offen lds
s_add_u32 s45, s44, 589824
s_add_u32 m0, s62, 16384
s_nop 0
buffer_load_dwordx4 v249, s[28:31], s45 offen lds
v_add_u32 v1, 42240, v250
ds_read_b64_tr_b16 v[16:17], v1 offset:0
ds_read_b64_tr_b16 v[18:19], v1 offset:256
ds_read_b64_tr_b16 v[20:21], v1 offset:1024
ds_read_b64_tr_b16 v[22:23], v1 offset:1280
s_cmp_lt_u32 s32, 4
s_cbranch_scc0 L_g1
v_add_u32 v1, 58624, v251
ds_read_b64_tr_b16 v[96:97], v1 offset:0
ds_read_b64_tr_b16 v[98:99], v1 offset:128
ds_read_b64_tr_b16 v[100:101], v1 offset:512
ds_read_b64_tr_b16 v[102:103], v1 offset:640
L_g1:
s_waitcnt vmcnt(3) lgkmcnt(0)
s_barrier
s_add_u32 s45, s44, 786432
s_add_u32 m0, s61, 42240
s_nop 0
buffer_load_dwordx4 v4, s[4:7], s45 offen lds
s_add_u32 m0, s61, 50432
s_nop 0
buffer_load_dwordx4 v5, s[8:11], s45 offen lds
s_add_u32 s45, s44, 786432
s_add_u32 m0, s62, 58624
s_nop 0
buffer_load_dwordx4 v249, s[28:31], s45 offen lds
v_add_u32 v1, 84480, v250
ds_read_b64_tr_b16 v[24:25], v1 offset:0
ds_read_b64_tr_b16 v[26:27], v1 offset:256
ds_read_b64_tr_b16 v[28:29], v1 offset:1024
ds_read_b64_tr_b16 v[30:31], v1 offset:1280
s_cmp_lt_u32 s32, 4
s_cbranch_scc0 L_g2
v_add_u32 v1, 100864, v251
ds_read_b64_tr_b16 v[104:105], v1 offset:0
ds_read_b64_tr_b16 v[106:107], v1 offset:128
ds_read_b64_tr_b16 v[108:109], v1 offset:512
ds_read_b64_tr_b16 v[110:111], v1 offset:640
L_g2:
s_waitcnt vmcnt(3) lgkmcnt(0)
s_barrier
s_sub_u32 s45, 983040, s44
s_add_u32 m0, s61, 84480
s_nop 0
buffer_load_dwordx4 v4, s[4:7], s45 offen lds
s_add_u32 m0, s61, 92672
s_nop 0
buffer_load_dwordx4 v5, s[8:11], s45 offen lds
s_sub_u32 s45, 1179648, s44
s_add_u32 m0, s61, 100864
s_nop 0
buffer_load_dwordx4 v4, s[4:7], s45 offen lds
s_add_u32 m0, s61, 109056
s_nop 0
buffer_load_dwordx4 v5, s[8:11], s45 offen lds
v_add_u32 v1, 0, v250
ds_read_b64_tr_b16 v[32:33], v1 offset:0
ds_read_b64_tr_b16 v[34:35], v1 offset:256
ds_read_b64_tr_b16 v[36:37], v1 offset:1024
ds_read_b64_tr_b16 v[38:39], v1 offset:1280
s_cmp_lt_u32 s32, 4
s_cbranch_scc0 L_g3
v_add_u32 v1, 16384, v251
ds_read_b64_tr_b16 v[112:113], v1 offset:0
ds_read_b64_tr_b16 v[114:115], v1 offset:128
ds_read_b64_tr_b16 v[116:117], v1 offset:512
ds_read_b64_tr_b16 v[118:119], v1 offset:640
L_g3:
s_waitcnt vmcnt(4) lgkmcnt(0)
s_barrier
s_sub_u32 s45, 1376256, s44
s_add_u32 m0, s61, 0
s_nop 0
buffer_load_dwordx4 v4, s[4:7], s45 offen lds
s_add_u32 m0, s61, 8192
s_nop 0
buffer_load_dwordx4 v5, s[8:11], s45 offen lds
s_sub_u32 s45, 1572864, s44
s_add_u32 m0, s61, 16384
s_nop 0
buffer_load_dwordx4 v4, s[4:7], s45 offen lds
s_add_u32 m0, s61, 24576
s_nop 0
buffer_load_dwordx4 v5, s[8:11], s45 offen lds
v_add_u32 v1, 42240, v250
ds_read_b64_tr_b16 v[40:41], v1 offset:0
ds_read_b64_tr_b16 v[42:43], v1 offset:256
ds_read_b64_tr_b16 v[44:45], v1 offset:1024
ds_read_b64_tr_b16 v[46:47], v1 offset:1280
s_cmp_lt_u32 s32, 4
s_cbranch_scc0 L_g4
v_add_u32 v1, 58624, v251
ds_read_b64_tr_b16 v[120:121], v1 offset:0
ds_read_b64_tr_b16 v[122:123], v1 offset:128
ds_read_b64_tr_b16 v[124:125], v1 offset:512
ds_read_b64_tr_b16 v[126:127], v1 offset:640
L_g4:
s_waitcnt vmcnt(4) lgkmcnt(0)
s_barrier
s_sub_u32 s45, 1769472, s44
s_add_u32 m0, s61, 42240
s_nop 0
buffer_load_dwordx4 v4, s[4:7], s45 offen lds
s_add_u32 m0, s61, 50432
s_nop 0
buffer_load_dwordx4 v5, s[8:11], s45 offen lds
v_add_u32 v1, 84480, v250
ds_read_b64_tr_b16 v[48:49], v1 offset:0
ds_read_b64_tr_b16 v[50:51], v1 offset:256
ds_read_b64_tr_b16 v[52:53], v1 offset:1024
ds_read_b64_tr_b16 v[54:55], v1 offset:1280
v_add_u32 v1, 100864, v250
ds_read_b64_tr_b16 v[56:57], v1 offset:0
ds_read_b64_tr_b16 v[58:59], v1 offset:256
ds_read_b64_tr_b16 v[60:61], v1 offset:1024
ds_read_b64_tr_b16 v[62:63], v1 offset:1280
v_and_b32 v248, 0xf0, v6
buffer_load_dword v247, v248, s[24:27], 0 offen sc1
s_waitcnt vmcnt(3) lgkmcnt(0)
s_barrier
s_lshl_b32 s3, s32, 6
s_addk_i32 s3, 0
v_add_u32 v1, s3, v0
v_mul_u32_u24 v2, 52429, v1
v_lshrrev_b32 v2, 22, v2
v_and_b32 v3, 3, v2
v_lshlrev_b32 v3, 1, v3
v_and_or_b32 v3, v2, 8, v3
v_xor_b32 v1, v1, v3
v_lshlrev_b32 v1, 4, v1
s_add_u32 m0, s61, 84480
s_add_u32 s3, s46, 0
buffer_load_dwordx4 v1, s[12:15], s3 offen lds
s_lshl_b32 s3, s32, 6
s_addk_i32 s3, 512
v_add_u32 v1, s3, v0
v_mul_u32_u24 v2, 52429, v1
v_lshrrev_b32 v2, 22, v2
v_and_b32 v3, 3, v2
v_lshlrev_b32 v3, 1, v3
v_and_or_b32 v3, v2, 8, v3
v_xor_b32 v1, v1, v3
v_lshlrev_b32 v1, 4, v1
s_add_u32 m0, s61, 92672
s_add_u32 s3, s46, 0
buffer_load_dwordx4 v1, s[12:15], s3 offen lds
s_lshl_b32 s3, s32, 6
s_addk_i32 s3, 1024
v_add_u32 v1, s3, v0
v_mul_u32_u24 v2, 52429, v1
v_lshrrev_b32 v2, 22, v2
v_and_b32 v3, 3, v2
v_lshlrev_b32 v3, 1, v3
v_and_or_b32 v3, v2, 8, v3
v_xor_b32 v1, v1, v3
v_lshlrev_b32 v1, 4, v1
s_add_u32 m0, s61, 100864
s_add_u32 s3, s46, 0
buffer_load_dwordx4 v1, s[12:15], s3 offen lds
s_lshl_b32 s3, s32, 6
s_addk_i32 s3, 1536
v_add_u32 v1, s3, v0
v_mul_u32_u24 v2, 52429, v1
v_lshrrev_b32 v2, 22, v2
v_and_b32 v3, 3, v2
v_lshlrev_b32 v3, 1, v3
v_and_or_b32 v3, v2, 8, v3
v_xor_b32 v1, v1, v3
v_lshlrev_b32 v1, 4, v1
s_add_u32 m0, s61, 109056
s_add_u32 s3, s46, 0
buffer_load_dwordx4 v1, s[12:15], s3 offen lds
s_lshl_b32 s3, s32, 6
s_addk_i32 s3, 2048
v_add_u32 v1, s3, v0
v_mul_u32_u24 v2, 52429, v1
v_lshrrev_b32 v2, 22, v2
v_and_b32 v3, 3, v2
v_lshlrev_b32 v3, 1, v3
v_and_or_b32 v3, v2, 8, v3
v_xor_b32 v1, v1, v3
v_lshlrev_b32 v1, 4, v1
s_add_u32 m0, s61, 117248
s_add_u32 s3, s46, 0
buffer_load_dwordx4 v1, s[12:15], s3 offen lds
v_add_u32 v1, 0, v250
ds_read_b64_tr_b16 v[64:65], v1 offset:0
ds_read_b64_tr_b16 v[66:67], v1 offset:256
ds_read_b64_tr_b16 v[68:69], v1 offset:1024
ds_read_b64_tr_b16 v[70:71], v1 offset:1280
v_add_u32 v1, 16384, v250
ds_read_b64_tr_b16 v[72:73], v1 offset:0
ds_read_b64_tr_b16 v[74:75], v1 offset:256
ds_read_b64_tr_b16 v[76:77], v1 offset:1024
ds_read_b64_tr_b16 v[78:79], v1 offset:1280
s_waitcnt vmcnt(5) lgkmcnt(0)
s_barrier
s_lshl_b32 s3, s32, 6
s_addk_i32 s3, 0
v_add_u32 v1, s3, v0
v_mul_u32_u24 v2, 52429, v1
v_lshrrev_b32 v2, 22, v2
v_and_b32 v3, 3, v2
v_lshlrev_b32 v3, 1, v3
v_and_or_b32 v3, v2, 8, v3
v_xor_b32 v1, v1, v3
v_lshlrev_b32 v1, 4, v1
s_add_u32 m0, s61, 0
s_add_u32 s3, s46, 40960
buffer_load_dwordx4 v1, s[12:15], s3 offen lds
s_lshl_b32 s3, s32, 6
s_addk_i32 s3, 512
v_add_u32 v1, s3, v0
v_mul_u32_u24 v2, 52429, v1
v_lshrrev_b32 v2, 22, v2
v_and_b32 v3, 3, v2
v_lshlrev_b32 v3, 1, v3
v_and_or_b32 v3, v2, 8, v3
v_xor_b32 v1, v1, v3
v_lshlrev_b32 v1, 4, v1
s_add_u32 m0, s61, 8192
s_add_u32 s3, s46, 40960
buffer_load_dwordx4 v1, s[12:15], s3 offen lds
s_lshl_b32 s3, s32, 6
s_addk_i32 s3, 1024
v_add_u32 v1, s3, v0
v_mul_u32_u24 v2, 52429, v1
v_lshrrev_b32 v2, 22, v2
v_and_b32 v3, 3, v2
v_lshlrev_b32 v3, 1, v3
v_and_or_b32 v3, v2, 8, v3
v_xor_b32 v1, v1, v3
v_lshlrev_b32 v1, 4, v1
s_add_u32 m0, s61, 16384
s_add_u32 s3, s46, 40960
buffer_load_dwordx4 v1, s[12:15], s3 offen lds
s_lshl_b32 s3, s32, 6
s_addk_i32 s3, 1536
v_add_u32 v1, s3, v0
v_mul_u32_u24 v2, 52429, v1
v_lshrrev_b32 v2, 22, v2
v_and_b32 v3, 3, v2
v_lshlrev_b32 v3, 1, v3
v_and_or_b32 v3, v2, 8, v3
v_xor_b32 v1, v1, v3
v_lshlrev_b32 v1, 4, v1
s_add_u32 m0, s61, 24576
s_add_u32 s3, s46, 40960
buffer_load_dwordx4 v1, s[12:15], s3 offen lds
s_lshl_b32 s3, s32, 6
s_addk_i32 s3, 2048
v_add_u32 v1, s3, v0
v_mul_u32_u24 v2, 52429, v1
v_lshrrev_b32 v2, 22, v2
v_and_b32 v3, 3, v2
v_lshlrev_b32 v3, 1, v3
v_and_or_b32 v3, v2, 8, v3
v_xor_b32 v1, v1, v3
v_lshlrev_b32 v1, 4, v1
s_add_u32 m0, s61, 32768
s_add_u32 s3, s46, 40960
buffer_load_dwordx4 v1, s[12:15], s3 offen lds
v_add_u32 v1, 42240, v250
ds_read_b64_tr_b16 v[80:81], v1 offset:0
ds_read_b64_tr_b16 v[82:83], v1 offset:256
ds_read_b64_tr_b16 v[84:85], v1 offset:1024
ds_read_b64_tr_b16 v[86:87], v1 offset:1280
s_waitcnt vmcnt(5) lgkmcnt(0)
s_barrier
s_lshl_b32 s3, s32, 6
s_addk_i32 s3, 0
v_add_u32 v1, s3, v0
v_mul_u32_u24 v2, 52429, v1
v_lshrrev_b32 v2, 22, v2
v_and_b32 v3, 3, v2
v_lshlrev_b32 v3, 1, v3
v_and_or_b32 v3, v2, 8, v3
v_xor_b32 v1, v1, v3
v_lshlrev_b32 v1, 4, v1
s_add_u32 m0, s61, 42240
s_add_u32 s3, s46, 81920
buffer_load_dwordx4 v1, s[12:15], s3 offen lds
s_lshl_b32 s3, s32, 6
s_addk_i32 s3, 512
v_add_u32 v1, s3, v0
v_mul_u32_u24 v2, 52429, v1
v_lshrrev_b32 v2, 22, v2
v_and_b32 v3, 3, v2
v_lshlrev_b32 v3, 1, v3
v_and_or_b32 v3, v2, 8, v3
v_xor_b32 v1, v1, v3
v_lshlrev_b32 v1, 4, v1
s_add_u32 m0, s61, 50432
s_add_u32 s3, s46, 81920
buffer_load_dwordx4 v1, s[12:15], s3 offen lds
s_lshl_b32 s3, s32, 6
s_addk_i32 s3, 1024
v_add_u32 v1, s3, v0
v_mul_u32_u24 v2, 52429, v1
v_lshrrev_b32 v2, 22, v2
v_and_b32 v3, 3, v2
v_lshlrev_b32 v3, 1, v3
v_and_or_b32 v3, v2, 8, v3
v_xor_b32 v1, v1, v3
v_lshlrev_b32 v1, 4, v1
s_add_u32 m0, s61, 58624
s_add_u32 s3, s46, 81920
buffer_load_dwordx4 v1, s[12:15], s3 offen lds
s_lshl_b32 s3, s32, 6
s_addk_i32 s3, 1536
v_add_u32 v1, s3, v0
v_mul_u32_u24 v2, 52429, v1
v_lshrrev_b32 v2, 22, v2
v_and_b32 v3, 3, v2
v_lshlrev_b32 v3, 1, v3
v_and_or_b32 v3, v2, 8, v3
v_xor_b32 v1, v1, v3
v_lshlrev_b32 v1, 4, v1
s_add_u32 m0, s61, 66816
s_add_u32 s3, s46, 81920
buffer_load_dwordx4 v1, s[12:15], s3 offen lds
s_lshl_b32 s3, s32, 6
s_addk_i32 s3, 2048
v_add_u32 v1, s3, v0
v_mul_u32_u24 v2, 52429, v1
v_lshrrev_b32 v2, 22, v2
v_and_b32 v3, 3, v2
v_lshlrev_b32 v3, 1, v3
v_and_or_b32 v3, v2, 8, v3
v_xor_b32 v1, v1, v3
v_lshlrev_b32 v1, 4, v1
s_add_u32 m0, s61, 75008
s_add_u32 s3, s46, 81920
buffer_load_dwordx4 v1, s[12:15], s3 offen lds
v_add_u32 v1, 84480, v236
ds_read_b64_tr_b16 v[168:169], v1 offset:0
ds_read_b64_tr_b16 v[170:171], v1 offset:5120
v_add_u32 v1, 84480, v237
ds_read_b64_tr_b16 v[180:181], v1 offset:0
ds_read_b64_tr_b16 v[182:183], v1 offset:5120
v_add_u32 v1, 84480, v238
ds_read_b64_tr_b16 v[192:193], v1 offset:0
ds_read_b64_tr_b16 v[194:195], v1 offset:5120
v_add_u32 v1, 84480, v239
ds_read_b64_tr_b16 v[204:205], v1 offset:0
ds_read_b64_tr_b16 v[206:207], v1 offset:5120
v_add_u32 v1, 84480, v240
ds_read_b64_tr_b16 v[216:217], v1 offset:0
ds_read_b64_tr_b16 v[218:219], v1 offset:5120
s_waitcnt vmcnt(5) lgkmcnt(0)
s_barrier
s_sub_u32 s45, 983040, s44
s_add_u32 m0, s62, 84480
s_nop 0
buffer_load_dwordx4 v249, s[28:31], s45 offen lds
s_sub_u32 s45, 1179648, s44
s_add_u32 m0, s62, 92928
s_nop 0
buffer_load_dwordx4 v249, s[28:31], s45 offen lds
s_sub_u32 s45, 1376256, s44
s_add_u32 m0, s62, 101376
s_nop 0
buffer_load_dwordx4 v249, s[28:31], s45 offen lds
s_sub_u32 s45, 1572864, s44
s_add_u32 m0, s62, 109824
s_nop 0
buffer_load_dwordx4 v249, s[28:31], s45 offen lds
s_sub_u32 s45, 1769472, s44
s_add_u32 m0, s62, 118272
s_nop 0
buffer_load_dwordx4 v249, s[28:31], s45 offen lds
v_add_u32 v1, 0, v236
ds_read_b64_tr_b16 v[172:173], v1 offset:0
ds_read_b64_tr_b16 v[174:175], v1 offset:5120
v_add_u32 v1, 0, v237
ds_read_b64_tr_b16 v[184:185], v1 offset:0
ds_read_b64_tr_b16 v[186:187], v1 offset:5120
v_add_u32 v1, 0, v238
ds_read_b64_tr_b16 v[196:197], v1 offset:0
ds_read_b64_tr_b16 v[198:199], v1 offset:5120
v_add_u32 v1, 0, v239
ds_read_b64_tr_b16 v[208:209], v1 offset:0
ds_read_b64_tr_b16 v[210:211], v1 offset:5120
v_add_u32 v1, 0, v240
ds_read_b64_tr_b16 v[220:221], v1 offset:0
ds_read_b64_tr_b16 v[222:223], v1 offset:5120
s_waitcnt vmcnt(5) lgkmcnt(0)
s_barrier
v_add_u32 v1, 42240, v236
ds_read_b64_tr_b16 v[176:177], v1 offset:0
ds_read_b64_tr_b16 v[178:179], v1 offset:5120
v_add_u32 v1, 42240, v237
ds_read_b64_tr_b16 v[188:189], v1 offset:0
ds_read_b64_tr_b16 v[190:191], v1 offset:5120
v_add_u32 v1, 42240, v238
ds_read_b64_tr_b16 v[200:201], v1 offset:0
ds_read_b64_tr_b16 v[202:203], v1 offset:5120
v_add_u32 v1, 42240, v239
ds_read_b64_tr_b16 v[212:213], v1 offset:0
ds_read_b64_tr_b16 v[214:215], v1 offset:5120
v_add_u32 v1, 42240, v240
ds_read_b64_tr_b16 v[224:225], v1 offset:0
ds_read_b64_tr_b16 v[226:227], v1 offset:5120
s_waitcnt vmcnt(0) lgkmcnt(0)
s_barrier
s_cmp_lt_u32 s32, 4
s_cbranch_scc0 L_g11
v_add_u32 v1, 84480, v251
ds_read_b64_tr_b16 v[128:129], v1 offset:0
ds_read_b64_tr_b16 v[130:131], v1 offset:128
ds_read_b64_tr_b16 v[132:133], v1 offset:512
ds_read_b64_tr_b16 v[134:135], v1 offset:640
v_add_u32 v1, 92928, v251
ds_read_b64_tr_b16 v[136:137], v1 offset:0
ds_read_b64_tr_b16 v[138:139], v1 offset:128
ds_read_b64_tr_b16 v[140:141], v1 offset:512
ds_read_b64_tr_b16 v[142:143], v1 offset:640
v_add_u32 v1, 101376, v251
ds_read_b64_tr_b16 v[144:145], v1 offset:0
ds_read_b64_tr_b16 v[146:147], v1 offset:128
ds_read_b64_tr_b16 v[148:149], v1 offset:512
ds_read_b64_tr_b16 v[150:151], v1 offset:640
v_add_u32 v1, 109824, v251
ds_read_b64_tr_b16 v[152:153], v1 offset:0
ds_read_b64_tr_b16 v[154:155], v1 offset:128
ds_read_b64_tr_b16 v[156:157], v1 offset:512
ds_read_b64_tr_b16 v[158:159], v1 offset:640
v_add_u32 v1, 118272, v251
ds_read_b64_tr_b16 v[160:161], v1 offset:0
ds_read_b64_tr_b16 v[162:163], v1 offset:128
ds_read_b64_tr_b16 v[164:165], v1 offset:512
ds_read_b64_tr_b16 v[166:167], v1 offset:640
L_g11:
s_branch L_pb_26
.p2align 12
L_pb_26:
s_call_b64 s[100:101], L_pad_27
s_call_b64 s[100:101], L_pad_28
s_call_b64 s[100:101], L_pad_29
v_mov_b32 v5, v246
v_mov_b32 v4, 126976
s_mov_b32 s61, 0
s_cmp_lt_u32 s32, 7
s_cbranch_scc1 L_np
L_rt:
v_cmp_ne_u32 vcc, 1, v247
s_cbranch_vccz L_rtg
buffer_load_dword v247, v248, s[24:27], 0 offen sc1
s_waitcnt vmcnt(0)
s_sub_u32 s40, s40, 1
s_cbranch_scc0 L_rt
s_mov_b32 s40, 0
L_rtg:
v_bfe_u32 v1, v0, 2, 3
v_lshlrev_b32 v1, 15, v1
v_and_b32 v2, 3, v0
v_min_u32 v2, 2, v2
v_mul_u32_u24 v3, 1280, v2
s_mov_b32 s0, 3145728
v_add3_u32 v147, v3, v1, s0
v_lshl_add_u32 v144, v2, 7, v1
s_mul_i32 s0, s36, 384
s_add_u32 s64, s0, 3167232
s_and_b32 s3, s36, 1
s_mul_i32 s3, s3, 640
v_add_u32 v132, s3, v6
v_subrev_u32 v2, 1280, v132
v_min_u32 v132, v132, v2
s_sub_u32 s3, 1024, s3
v_add_u32 v133, s3, v6
s_mov_b32 s54, 0
s_mov_b32 s55, 0x80000000
s_mov_b32 s60, 1073741824
s_setprio 3
v_mov_b32 v140, -1
v_mov_b32 v141, -1
v_mov_b32 v142, -1
s_mov_b32 m0, 127232
s_mov_b64 exec, -1
buffer_load_dwordx4 v132, s[16:19], s55 offen sc1 lds
s_mov_b32 m0, 128256
s_mov_b64 exec, 0xffff
buffer_load_dwordx4 v133, s[16:19], s55 offen sc1 lds
s_mov_b64 exec, 0x77777777
buffer_atomic_umin v140, v144, s[16:19], s64 offen sc0 sc1
s_sleep 2
s_mov_b32 m0, 127232
s_mov_b64 exec, -1
buffer_load_dwordx4 v132, s[16:19], s55 offen sc1 lds
s_mov_b32 m0, 128256
s_mov_b64 exec, 0xffff
buffer_load_dwordx4 v133, s[16:19], s55 offen sc1 lds
s_mov_b64 exec, 0x77777777
buffer_atomic_umin v141, v144, s[16:19], s64 offen sc0 sc1
s_sleep 2
L_pl0:
s_mov_b32 m0, 127232
s_mov_b64 exec, -1
s_nop 0
buffer_load_dwordx4 v132, s[16:19], s55 offen sc1 lds
s_mov_b32 m0, 128256
s_mov_b64 exec, 0xffff
buffer_load_dwordx4 v133, s[16:19], s55 offen sc1 lds
s_mov_b64 exec, 0x77777777
buffer_atomic_umin v142, v144, s[16:19], s64 offen sc0 sc1
s_mov_b32 s62, 0
s_cmp_eq_u32 s61, 2
s_cbranch_scc1 L_ab
L_pi0:
s_waitcnt vmcnt(6)
v_cmp_lt_u32 vcc, s54, v140
s_sub_u32 s60, s60, 1
s_cbranch_vccz L_pw
s_cselect_b32 s0, s61, 1
s_max_i32 s60, s60, 0
v_cmp_eq_u32 s[58:59], -1, v140
v_mov_b32 v146, v140
s_andn2_b64 vcc, vcc, s[58:59]
s_cbranch_scc0 L_pq0
s_mov_b64 exec, -1
v_cndmask_b32 v146, 0, v146, vcc
s_lshl_b32 s61, s61, 1
s_nop 0
v_max_u32_dpp v236, v146, v146 row_ror:8 row_mask:0xf bank_mask:0xf
s_nop 1
v_max_u32_dpp v236, v236, v236 row_ror:4 row_mask:0xf bank_mask:0xf
s_nop 1
v_max_u32_dpp v236, v236, v236 row_ror:2 row_mask:0xf bank_mask:0xf
s_nop 1
v_max_u32_dpp v236, v236, v236 row_ror:1 row_mask:0xf bank_mask:0xf
v_mov_b32 v237, v236
s_mov_b32 s60, 2
s_nop 0
v_permlane16_swap_b32 v236, v237
v_max_u32 v236, v236, v237
s_mov_b32 exec_hi, 0
v_cmpx_eq_u32 vcc, v236, v146
ds_write_b64 v4, v[146:147]
s_nop 2
v_readfirstlane_b32 s55, v147
v_readfirstlane_b32 s54, v146
s_branch L_pl1
L_pq0:
s_cmp_eq_u32 s0, 0
s_cselect_b32 s61, 1, s61
s_cbranch_scc1 L_pg
s_sleep 2
L_pl1:
s_mov_b32 m0, 127232
s_mov_b64 exec, -1
s_nop 0
buffer_load_dwordx4 v132, s[16:19], s55 offen sc1 lds
s_mov_b32 m0, 128256
s_mov_b64 exec, 0xffff
buffer_load_dwordx4 v133, s[16:19], s55 offen sc1 lds
s_mov_b64 exec, 0x77777777
buffer_atomic_umin v140, v144, s[16:19], s64 offen sc0 sc1
s_mov_b32 s62, 1
s_cmp_eq_u32 s61, 2
s_cbranch_scc1 L_ab
L_pi1:
s_waitcnt vmcnt(6)
v_cmp_lt_u32 vcc, s54, v141
s_sub_u32 s60, s60, 1
s_cbranch_vccz L_pw
s_cselect_b32 s0, s61, 1
s_max_i32 s60, s60, 0
v_cmp_eq_u32 s[58:59], -1, v141
v_mov_b32 v146, v141
s_andn2_b64 vcc, vcc, s[58:59]
s_cbranch_scc0 L_pq1
s_mov_b64 exec, -1
v_cndmask_b32 v146, 0, v146, vcc
s_lshl_b32 s61, s61, 1
s_nop 0
v_max_u32_dpp v236, v146, v146 row_ror:8 row_mask:0xf bank_mask:0xf
s_nop 1
v_max_u32_dpp v236, v236, v236 row_ror:4 row_mask:0xf bank_mask:0xf
s_nop 1
v_max_u32_dpp v236, v236, v236 row_ror:2 row_mask:0xf bank_mask:0xf
s_nop 1
v_max_u32_dpp v236, v236, v236 row_ror:1 row_mask:0xf bank_mask:0xf
v_mov_b32 v237, v236
s_mov_b32 s60, 2
s_nop 0
v_permlane16_swap_b32 v236, v237
v_max_u32 v236, v236, v237
s_mov_b32 exec_hi, 0
v_cmpx_eq_u32 vcc, v236, v146
ds_write_b64 v4, v[146:147]
s_nop 2
v_readfirstlane_b32 s55, v147
v_readfirstlane_b32 s54, v146
s_branch L_pl2
L_pq1:
s_cmp_eq_u32 s0, 0
s_cselect_b32 s61, 1, s61
s_cbranch_scc1 L_pg
s_sleep 2
L_pl2:
s_mov_b32 m0, 127232
s_mov_b64 exec, -1
s_nop 0
buffer_load_dwordx4 v132, s[16:19], s55 offen sc1 lds
s_mov_b32 m0, 128256
s_mov_b64 exec, 0xffff
buffer_load_dwordx4 v133, s[16:19], s55 offen sc1 lds
s_mov_b64 exec, 0x77777777
buffer_atomic_umin v141, v144, s[16:19], s64 offen sc0 sc1
s_mov_b32 s62, 2
s_cmp_eq_u32 s61, 2
s_cbranch_scc1 L_ab
L_pi2:
s_waitcnt vmcnt(6)
v_cmp_lt_u32 vcc, s54, v142
s_sub_u32 s60, s60, 1
s_cbranch_vccz L_pw
s_cselect_b32 s0, s61, 1
s_max_i32 s60, s60, 0
v_cmp_eq_u32 s[58:59], -1, v142
v_mov_b32 v146, v142
s_andn2_b64 vcc, vcc, s[58:59]
s_cbranch_scc0 L_pq2
s_mov_b64 exec, -1
v_cndmask_b32 v146, 0, v146, vcc
s_lshl_b32 s61, s61, 1
s_nop 0
v_max_u32_dpp v236, v146, v146 row_ror:8 row_mask:0xf bank_mask:0xf
s_nop 1
v_max_u32_dpp v236, v236, v236 row_ror:4 row_mask:0xf bank_mask:0xf
s_nop 1
v_max_u32_dpp v236, v236, v236 row_ror:2 row_mask:0xf bank_mask:0xf
s_nop 1
v_max_u32_dpp v236, v236, v236 row_ror:1 row_mask:0xf bank_mask:0xf
v_mov_b32 v237, v236
s_mov_b32 s60, 2
s_nop 0
v_permlane16_swap_b32 v236, v237
v_max_u32 v236, v236, v237
s_mov_b32 exec_hi, 0
v_cmpx_eq_u32 vcc, v236, v146
ds_write_b64 v4, v[146:147]
s_nop 2
v_readfirstlane_b32 s55, v147
v_readfirstlane_b32 s54, v146
s_branch L_pl0
L_pq2:
s_cmp_eq_u32 s0, 0
s_cselect_b32 s61, 1, s61
s_cbranch_scc1 L_pg
s_sleep 2
s_sub_u32 s40, s40, 1
s_cbranch_scc0 L_pl0
s_mov_b32 s40, 0
s_waitcnt vmcnt(0)
s_cmp_eq_u32 s0, s0
L_pw:
s_cbranch_scc0 L_pv
s_cmp_eq_u32 s61, 1
s_mov_b32 s61, 0
s_mov_b64 exec, -1
s_cbranch_scc1 L_bb
s_branch L_pg
L_pv:
s_cmp_eq_u32 s60, 0
s_waitcnt vmcnt(4)
s_cbranch_scc1 L_pg
s_cmp_eq_u32 s60, 1
s_waitcnt vmcnt(1)
s_branch L_pg
L_ab:
s_mov_b64 exec, -1
v_mov_b32 v2, 126928
ds_write_b32 v2, v2
s_branch L_bb
L_xf:
s_mov_b32 m0, 127232
s_mov_b64 exec, -1
buffer_load_dwordx4 v132, s[16:19], s55 offen sc1 lds
s_mov_b32 m0, 128256
s_mov_b64 exec, 0xffff
buffer_load_dwordx4 v133, s[16:19], s55 offen sc1 lds
s_waitcnt vmcnt(0)
L_pg:
s_mov_b64 exec, -1
L_np:
s_waitcnt lgkmcnt(0)
s_barrier
s_cmp_lt_u32 s32, 4
s_cbranch_scc1 L_xh
ds_read_b64 v[2:3], v4
ds_read_b128 v[88:91], v252 offset:0
ds_read_b128 v[92:95], v252 offset:128
ds_read_b128 v[96:99], v252 offset:256
ds_read_b128 v[100:103], v252 offset:384
ds_read_b128 v[104:107], v252 offset:512
ds_read_b128 v[108:111], v252 offset:640
ds_read_b128 v[112:115], v252 offset:768
ds_read_b128 v[116:119], v252 offset:896
ds_read_b128 v[120:123], v252 offset:1024
ds_read_b128 v[124:127], v252 offset:1152
s_cmp_eq_u32 s61, 0
s_cbranch_scc1 L_sl0
s_mov_b32 m0, 127232
s_mov_b64 exec, -1
buffer_load_dwordx4 v132, s[16:19], s55 offen sc1 lds
s_mov_b32 m0, 128256
s_mov_b64 exec, 0xffff
buffer_load_dwordx4 v133, s[16:19], s55 offen sc1 lds
s_mov_b64 exec, 0x77777777
buffer_atomic_umin v140, v144, s[16:19], s64 offen sc0 sc1
s_mov_b64 exec, -1
L_sl0:
s_waitcnt lgkmcnt(10)
v_readfirstlane_b32 s56, v2
v_readfirstlane_b32 s57, v3
s_waitcnt lgkmcnt(9)
v_smfmac_f32_16x16x64_bf16 v[228:231], v[88:91], v[8:15], v7
s_and_b32 s0, s57, 0x7fff
s_add_u32 s57, s57, s0
s_add_u32 s57, s57, 4096
s_and_b32 s1, s56, 0xfffff800
s_waitcnt lgkmcnt(8)
v_smfmac_f32_16x16x64_bf16 v[228:231], v[92:95], v[16:23], v7
s_ashr_i32 s3, s1, 31
s_not_b32 s3, s3
s_or_b32 s3, s3, 0x80000000
s_xor_b32 s1, s1, s3
s_waitcnt lgkmcnt(7)
v_smfmac_f32_16x16x64_bf16 v[228:231], v[96:99], v[24:31], v7
s_andn2_b32 s56, 2047, s56
s_mul_i32 s56, s56, 1280
v_mov_b32 v130, s1
s_waitcnt lgkmcnt(6)
v_smfmac_f32_16x16x64_bf16 v[228:231], v[100:103], v[32:39], v7
v_mul_f32 v130, 0xbfb8aa3b, v130
s_waitcnt lgkmcnt(5)
v_smfmac_f32_16x16x64_bf16 v[228:231], v[104:107], v[40:47], v7
v_exp_f32 v130, v130
s_waitcnt lgkmcnt(4)
v_smfmac_f32_16x16x64_bf16 v[228:231], v[108:111], v[48:55], v7
v_add_f32 v130, 1.0, v130
s_waitcnt lgkmcnt(3)
v_smfmac_f32_16x16x64_bf16 v[228:231], v[112:115], v[56:63], v7
v_rcp_f32 v130, v130
s_waitcnt lgkmcnt(2)
v_smfmac_f32_16x16x64_bf16 v[228:231], v[116:119], v[64:71], v7
s_waitcnt lgkmcnt(1)
v_smfmac_f32_16x16x64_bf16 v[228:231], v[120:123], v[72:79], v7
s_waitcnt lgkmcnt(0)
v_smfmac_f32_16x16x64_bf16 v[228:231], v[124:127], v[80:87], v7
s_cmp_eq_u32 s61, 0
s_cbranch_scc1 L_sl1
s_mov_b32 m0, 127232
s_mov_b64 exec, -1
buffer_load_dwordx4 v132, s[16:19], s55 offen sc1 lds
s_mov_b32 m0, 128256
s_mov_b64 exec, 0xffff
buffer_load_dwordx4 v133, s[16:19], s55 offen sc1 lds
s_mov_b64 exec, 0x77777777
buffer_atomic_umin v141, v144, s[16:19], s64 offen sc0 sc1
s_mov_b64 exec, -1
L_sl1:
s_branch L_xj
L_pad_27:
s_setpc_b64 s[100:101]
L_xh:
ds_read_b128 v[236:239], v252 offset:0
ds_read_b128 v[240:243], v252 offset:128
ds_read_b128 v[244:247], v252 offset:256
ds_read_b128 v[248:251], v252 offset:384
s_waitcnt lgkmcnt(3)
v_smfmac_f32_16x16x64_bf16 v[228:231], v[236:239], v[8:15], v7
v_smfmac_f32_16x16x64_bf16 v[232:235], v[236:239], v[88:95], v7
ds_read_b128 v[236:239], v252 offset:512
s_waitcnt lgkmcnt(3)
v_smfmac_f32_16x16x64_bf16 v[228:231], v[240:243], v[16:23], v7
v_smfmac_f32_16x16x64_bf16 v[232:235], v[240:243], v[96:103], v7
ds_read_b128 v[240:243], v252 offset:640
s_waitcnt lgkmcnt(3)
v_smfmac_f32_16x16x64_bf16 v[228:231], v[244:247], v[24:31], v7
v_smfmac_f32_16x16x64_bf16 v[232:235], v[244:247], v[104:111], v7
ds_read_b128 v[244:247], v252 offset:768
s_waitcnt lgkmcnt(3)
v_smfmac_f32_16x16x64_bf16 v[228:231], v[248:251], v[32:39], v7
v_smfmac_f32_16x16x64_bf16 v[232:235], v[248:251], v[112:119], v7
ds_read_b128 v[248:251], v252 offset:896
s_waitcnt lgkmcnt(3)
v_smfmac_f32_16x16x64_bf16 v[228:231], v[236:239], v[40:47], v7
v_smfmac_f32_16x16x64_bf16 v[232:235], v[236:239], v[120:127], v7
ds_read_b128 v[236:239], v252 offset:1024
s_waitcnt lgkmcnt(3)
v_smfmac_f32_16x16x64_bf16 v[228:231], v[240:243], v[48:55], v7
v_smfmac_f32_16x16x64_bf16 v[232:235], v[240:243], v[128:135], v7
ds_read_b128 v[240:243], v252 offset:1152
s_waitcnt lgkmcnt(3)
v_smfmac_f32_16x16x64_bf16 v[228:231], v[244:247], v[56:63], v7
v_smfmac_f32_16x16x64_bf16 v[232:235], v[244:247], v[136:143], v7
s_waitcnt lgkmcnt(2)
v_smfmac_f32_16x16x64_bf16 v[228:231], v[248:251], v[64:71], v7
v_smfmac_f32_16x16x64_bf16 v[232:235], v[248:251], v[144:151], v7
s_waitcnt lgkmcnt(1)
v_smfmac_f32_16x16x64_bf16 v[228:231], v[236:239], v[72:79], v7
v_smfmac_f32_16x16x64_bf16 v[232:235], v[236:239], v[152:159], v7
s_waitcnt lgkmcnt(0)
v_smfmac_f32_16x16x64_bf16 v[228:231], v[240:243], v[80:87], v7
v_smfmac_f32_16x16x64_bf16 v[232:235], v[240:243], v[160:167], v7
L_xj:
s_mov_b64 vcc, 0xffff
s_nop 5
v_add_f32 v1, v228, v229
v_add_f32 v2, v232, v233
v_cndmask_b32 v1, v2, v1, vcc
v_cmp_u_f32 vcc, v1, v1
s_cbranch_vccnz L_xn
L_xnb:
v_mul_f32 v2, 0xbfb8aa3b, v1
v_exp_f32 v2, v2
v_mul_f32_dpp v3, v1, v1 row_ror:8 row_mask:0xf bank_mask:0xf
v_add_f32 v2, 1.0, v2
v_rcp_f32 v2, v2
s_nop 0
v_mul_f32 v1, v2, v3
v_cvt_pk_bf16_f32 v1, v1, v1
s_mov_b64 exec, s[50:51]
ds_write_b16 v253, v1
s_mov_b64 exec, -1
s_cmp_eq_u32 s61, 0
s_cbranch_scc0 L_pl0
L_bb:
v_mov_b32 v2, 126928
s_waitcnt lgkmcnt(0)
s_barrier
ds_read_b32 v1, v2
ds_read_b128 v[236:239], v255
ds_read_b128 v[240:243], v254
s_waitcnt lgkmcnt(2)
v_cmp_ne_u32 vcc, 0, v1
s_cbranch_vccnz L_xsr
L_xsgo:
s_waitcnt lgkmcnt(1)
v_mfma_f32_16x16x32_bf16 v[24:27], v[236:239], v[224:227], 0
v_mfma_f32_16x16x32_bf16 v[8:11], v[236:239], v[176:179], 0
v_mfma_f32_16x16x32_bf16 v[12:15], v[236:239], v[188:191], 0
v_mfma_f32_16x16x32_bf16 v[16:19], v[236:239], v[200:203], 0
v_mfma_f32_16x16x32_bf16 v[20:23], v[236:239], v[212:215], 0
s_waitcnt lgkmcnt(0)
s_nop 0
v_smfmac_f32_16x16x64_bf16 v[24:27], v[240:243], v[216:223], v7
v_smfmac_f32_16x16x64_bf16 v[8:11], v[240:243], v[168:175], v7
v_smfmac_f32_16x16x64_bf16 v[12:15], v[240:243], v[180:187], v7
v_smfmac_f32_16x16x64_bf16 v[16:19], v[240:243], v[192:199], v7
v_smfmac_f32_16x16x64_bf16 v[20:23], v[240:243], v[204:211], v7
s_nop 3
v_add_f32 v1, v24, v25
v_add_f32 v32, v8, v9
v_add_f32 v33, v12, v13
v_add_f32 v34, v16, v17
v_add_f32 v35, v20, v21
v_mov_b32_dpp v32, v1 quad_perm:[0,0,0,0] row_mask:0x2 bank_mask:0xf
v_mov_b32_dpp v33, v1 quad_perm:[1,1,1,1] row_mask:0x2 bank_mask:0xf
v_mov_b32_dpp v34, v1 quad_perm:[2,2,2,2] row_mask:0x2 bank_mask:0xf
v_mov_b32_dpp v35, v1 quad_perm:[3,3,3,3] row_mask:0x2 bank_mask:0xf
s_mov_b64 exec, 0x1111ffff
buffer_store_dwordx4 v[32:35], v5, s[16:19], s47 offen sc1
s_mov_b64 exec, -1
s_cmp_lt_u32 s52, 40
s_cbranch_scc0 L_mfin
buffer_load_dword v44, v129, s[16:19], s57 offen sc1
buffer_load_dwordx4 v[40:43], v6, s[16:19], s53 offen sc1
L_fd:
buffer_load_dword v52, v129, s[16:19], s57 offen sc1
buffer_load_dwordx4 v[48:51], v6, s[16:19], s53 offen sc1
s_waitcnt vmcnt(2)
v_max3_u32 v1, v40, v42, v44
v_cmp_eq_u32 vcc, -1, v1
s_cbranch_vccz L_fg0
buffer_load_dword v44, v129, s[16:19], s57 offen sc1
buffer_load_dwordx4 v[40:43], v6, s[16:19], s53 offen sc1
s_waitcnt vmcnt(2)
v_max3_u32 v1, v48, v50, v52
v_cmp_eq_u32 vcc, -1, v1
s_cbranch_vccz L_fg1
s_sub_u32 s40, s40, 1
s_cbranch_scc0 L_fd
L_fg1:
v_permlane32_swap_b32 v48, v49
v_permlane32_swap_b32 v50, v51
v_add_f32 v48, v48, v49
v_add_f32 v50, v50, v51
s_nop 1
v_permlane16_swap_b32 v48, v50
v_add_f32 v48, v48, v50
s_nop 1
v_add_f32_dpp v48, v48, v48 row_ror:4 row_mask:0xf bank_mask:0xf
s_nop 1
v_add_f32_dpp v48, v48, v48 row_ror:8 row_mask:0xf bank_mask:0xf
v_fma_f32 v8, v48, v130, v52
v_cvt_pk_bf16_f32 v8, v8, v8
s_mov_b32 exec_lo, 0xf000f
s_mov_b32 exec_hi, 0xf000f
buffer_store_short v8, v128, s[20:23], s56 offen
s_endpgm
L_pad_28:
s_setpc_b64 s[100:101]
L_fg0:
v_permlane32_swap_b32 v40, v41
v_permlane32_swap_b32 v42, v43
v_add_f32 v40, v40, v41
v_add_f32 v42, v42, v43
s_nop 1
v_permlane16_swap_b32 v40, v42
v_add_f32 v40, v40, v42
s_nop 1
v_add_f32_dpp v40, v40, v40 row_ror:4 row_mask:0xf bank_mask:0xf
s_nop 1
v_add_f32_dpp v40, v40, v40 row_ror:8 row_mask:0xf bank_mask:0xf
v_fma_f32 v8, v40, v130, v44
v_cvt_pk_bf16_f32 v8, v8, v8
s_mov_b32 exec_lo, 0xf000f
s_mov_b32 exec_hi, 0xf000f
buffer_store_short v8, v128, s[20:23], s56 offen
L_mfin:
s_endpgm
L_pad_29:
s_setpc_b64 s[100:101]
L_xn:
v_mov_b32 v2, 126928
ds_write_b32 v2, v2
s_branch L_xnb
L_xsr:
s_sub_u32 s49, s49, 1
s_cbranch_scc1 L_xsgo
v_mov_b32 v228, 0
v_mov_b32 v229, 0
v_mov_b32 v230, 0
v_mov_b32 v231, 0
v_mov_b32 v232, 0
v_mov_b32 v233, 0
v_mov_b32 v234, 0
v_mov_b32 v235, 0
s_waitcnt lgkmcnt(0)
s_barrier
s_cmp_eq_u32 s32, 7
s_cbranch_scc0 L_np
ds_write_b32 v2, v228
s_cmp_eq_u32 s61, 2
s_cbranch_scc0 L_xf
s_mov_b32 s61, 0
s_mov_b64 exec, 0x77777777
s_cmp_eq_u32 s62, 0
s_cbranch_scc1 L_pi0
s_cmp_eq_u32 s62, 1
s_cbranch_scc1 L_pi1
s_branch L_pi2
L_end:
s_endpgm
.section .rodata,"a"
.p2align 6
.amdhsa_kernel sequential_preLN__sliding_local_dilated__moe_arch_mod__prompt_kernel
  .amdhsa_next_free_vgpr 256
  .amdhsa_next_free_sgpr 102
  .amdhsa_accum_offset 256
  .amdhsa_group_segment_fixed_size 0
  .amdhsa_kernarg_size 88
  .amdhsa_user_sgpr_count 2
  .amdhsa_user_sgpr_kernarg_segment_ptr 1
  .amdhsa_system_sgpr_workgroup_id_x 1
  .amdhsa_float_denorm_mode_32 3
.end_amdhsa_kernel
```

```asm
; @launch grid=(256,1,1) block=(512,1,1) lds=163840
.amdgcn_target "amdgcn-amd-amdhsa--gfx950"
.text
.p2align 12
.globl sequential_preLN__sliding_local_dilated__moe_arch_mod__prompt_kernel
.p2align 8
.type sequential_preLN__sliding_local_dilated__moe_arch_mod__prompt_kernel,@function
sequential_preLN__sliding_local_dilated__moe_arch_mod__prompt_kernel:
s_load_dwordx16 s[44:59], s[0:1], 0
s_load_dwordx8 s[60:67], s[0:1], 56
s_lshr_b32 s34, s2, 3
s_and_b32 s33, s2, 7
v_readfirstlane_b32 s32, v0
s_getpc_b64 s[100:101]
L_pc:
s_mul_i32 s3, s34, 9
v_min_u32 v2, 8, v0
v_add_lshl_u32 v2, v2, s3, 7
v_min_u32 v2, L_end-L_pc, v2
s_cmp_ge_u32 s34, 30
s_cbranch_scc1 L_moe
global_load_dword v255, v2, s[100:101]
s_mul_i32 s35, s34, 26
s_lshr_b32 s35, s35, 8
s_mul_i32 s3, s35, 10
s_sub_u32 s36, s34, s3
s_lshr_b32 s32, s32, 6
s_lshl_b32 s3, s33, 2
s_lshr_b32 s3, 0x68354972, s3
s_and_b32 s41, s3, 15
s_add_u32 s3, s36, s41
s_sub_u32 s68, s3, 10
s_cselect_b32 s69, s3, s68
s_mul_i32 s3, s69, 245760
s_lshl_b32 s68, s36, 7
s_add_u32 s3, s3, s68
v_lshrrev_b32 v1, 3, v0
v_lshrrev_b32 v3, 4, v0
v_and_b32 v2, 2, v1
v_and_or_b32 v2, v3, 4, v2
v_xor_b32 v2, v2, v0
v_and_b32 v2, 7, v2
v_mul_u32_u24 v4, 3840, v1
v_lshl_add_u32 v4, v2, 4, v4
v_add_u32 v4, s3, v4
s_mul_i32 s3, s32, 3072
s_add_u32 m0, s3, 20480
v_and_b32 v0, 63, v0
s_and_b32 s38, s32, 3
s_lshr_b32 s3, s33, 1
s_lshl_b32 s3, s3, 9
s_mul_i32 s68, s35, 176
s_add_u32 s3, s3, s68
s_and_b32 s68, s33, 1
s_add_u32 s3, s3, s68
s_mul_i32 s39, s3, 1280
s_sub_u32 s42, s32, 5
s_mul_i32 s3, s42, 81920
s_add_u32 s3, s3, s39
s_sub_u32 s3, s3, 20480
v_lshrrev_b32 v1, 3, v0
v_lshrrev_b32 v3, 4, v0
v_xor_b32 v3, v3, v0
v_and_b32 v3, 7, v3
v_mul_u32_u24 v1, 2560, v1
v_lshl_add_u32 v1, v3, 4, v1
v_add_u32 v24, s3, v1
s_add_u32 s3, s42, s35
s_cmp_eq_u32 s3, 4
s_cselect_b32 s3, 0x80000000, 0
v_xor_b32 v25, 64, v24
v_add_u32 v25, 20480, v25
v_add_u32 v26, 40960, v24
v_add_u32 v27, 40960, v25
v_or_b32 v27, s3, v27
s_mov_b32 s6, 0x280000
s_mov_b32 s7, 0x20000
s_mov_b32 s10, 0x258000
s_mov_b32 s11, 0x20000
s_mov_b32 s14, 0xc8000
s_mov_b32 s15, 0x20000
s_mov_b32 s18, 0x10000000
s_mov_b32 s19, 0x20000
s_mov_b32 s22, 0x280000
s_mov_b32 s23, 0x20000
s_mov_b32 s26, 0x100
s_mov_b32 s27, 0x20000
s_mov_b32 s30, 0x500
s_mov_b32 s31, 0x20000
s_waitcnt lgkmcnt(0)
global_load_lds_dwordx4 v4, s[46:47]
s_addk_i32 m0, -256
s_mov_b64 s[4:5], s[44:45]
global_load_lds_dwordx4 v4, s[46:47] offset:1280
s_addk_i32 m0, -256
s_mov_b64 s[20:21], s[62:63]
global_load_lds_dwordx4 v4, s[46:47] offset:2560
s_mov_b64 s[24:25], s[64:65]
s_mov_b64 s[16:17], s[66:67]
s_mov_b64 s[8:9], s[46:47]
s_mov_b64 s[12:13], s[48:49]
s_mov_b64 s[28:29], s[52:53]
s_cmp_eq_u32 s32, 4
s_cselect_b64 s[96:97], s[54:55], s[58:59]
s_cmp_eq_u32 s32, 5
s_cselect_b64 s[96:97], s[56:57], s[96:97]
s_cmp_lt_u32 s32, 5
s_cbranch_scc1 L_nx
s_lshl_b32 s64, s42, 12
s_cselect_b32 s62, -1, 0xffffff00
s_lshl_b32 s63, s69, 7
s_mov_b32 s61, 8192
s_add_u32 m0, s61, s64
s_mov_b32 exec_lo, s62
buffer_load_dwordx4 v24, s[4:7], s63 offen lds
s_addk_i32 m0, 1024
s_mov_b32 exec_lo, -1
buffer_load_dwordx4 v25, s[4:7], s63 offen lds
s_addk_i32 m0, 1024
s_nop 0
buffer_load_dwordx4 v26, s[4:7], s63 offen lds
s_addk_i32 m0, 1024
s_nop 0
buffer_load_dwordx4 v27, s[4:7], s63 offen lds
L_nx:
v_mov_b32 v254, v4
s_mov_b32 s40, 524288
s_mul_i32 s43, s33, 3
s_add_u32 s43, s43, s35
s_sub_u32 s3, s36, 5
s_cselect_b32 s37, s36, s3
s_lshl_b32 s3, s32, 2
s_lshr_b32 s44, 0x32105454, s3
s_and_b32 s44, s44, 7
s_lshr_b32 s45, s38, 1
s_add_u32 s45, s45, 4
s_cmp_eq_u32 s35, 2
s_cselect_b32 s60, 10, 11
s_sub_u32 s57, 10, s41
v_lshlrev_b32 v233, 4, v0
s_mul_i32 s58, s43, 6
s_add_u32 s58, s58, s44
s_mul_i32 s58, s58, 2560
s_add_u32 s58, s58, 2097152
s_lshl_b32 s59, s33, 15
s_add_u32 s59, s59, 3145728
s_sub_u32 s51, 5, s37
s_add_u32 s1, s37, 1
s_sub_u32 s3, 15, s37
s_cmp_le_u32 s37, 2
s_cselect_b32 s46, 0, s3
s_cselect_b32 s47, s51, s1
s_cselect_b32 s48, s3, 0
s_cselect_b32 s49, s1, s51
s_cselect_b32 s50, 1, 0
v_and_b32 v3, 15, v0
v_add_u32 v3, 8, v3
v_lshrrev_b32 v4, 1, v3
v_lshrrev_b32 v5, 5, v0
v_xor_b32 v4, v4, v5
v_and_b32 v4, 7, v4
v_lshlrev_b32 v4, 4, v4
v_lshl_add_u32 v4, v3, 7, v4
v_bfe_u32 v5, v0, 4, 1
v_lshl_add_u32 v4, v5, 3, v4
s_lshl_b32 s3, s44, 11
v_add_u32 v235, s3, v4
s_cmp_lt_u32 s32, 4
s_cbranch_scc1 L_cons
s_add_u32 s69, s69, 1
s_cmp_eq_u32 s69, 10
s_cselect_b32 s69, 0, s69
s_lshl_b32 s63, s69, 7
s_mov_b32 s61, 45056
v_and_b32 v1, 15, v0
v_lshrrev_b32 v2, 4, v0
v_mov_b32 v7, 1792
s_mul_i32 s0, s44, 2304
s_movk_i32 s1, 144
v_bfe_u32 v3, v0, 2, 1
v_and_b32 v4, 3, v0
v_lshlrev_b32 v4, 1, v4
v_lshl_add_u32 v3, v3, 3, v4
v_bfe_u32 v4, v0, 3, 1
v_add_u32 v3, v3, v4
s_add_u32 s3, s0, 17408
v_mov_b32 v4, s3
v_mad_u32_u24 v3, v3, s1, v4
s_add_u32 s3, s0, 4736
v_mov_b32 v4, s3
v_mad_u32_u24 v4, v1, s1, v4
s_mov_b32 s52, 0xff00ff
s_mov_b32 s53, 0xff00ff
v_add_u32 v5, s51, v2
v_lshl_add_u32 v200, v5, 3, v3
v_lshl_add_u32 v5, v5, 3, v4
v_cndmask_b32 v204, v7, v5, s[52:53]
v_cndmask_b32 v205, v5, v7, s[52:53]
v_add_u32 v5, s46, v2
v_lshl_add_u32 v202, v5, 3, v3
v_lshl_add_u32 v5, v5, 3, v4
v_cmp_gt_u32 vcc, s47, v2
s_nop 1
v_cndmask_b32 v5, v7, v5, vcc
v_cndmask_b32 v206, v7, v5, s[52:53]
v_cndmask_b32 v207, v5, v7, s[52:53]
v_add_u32 v5, s48, v2
v_min_u32 v5, 15, v5
v_lshl_add_u32 v203, v5, 3, v3
v_lshl_add_u32 v5, v5, 3, v4
v_cmp_gt_u32 vcc, s49, v2
s_nop 1
v_cndmask_b32 v5, v7, v5, vcc
v_cndmask_b32 v208, v7, v5, s[52:53]
v_cndmask_b32 v209, v5, v7, s[52:53]
s_sub_u32 s3, s51, 1
v_mad_u32_u24 v5, v2, 5, s3
s_add_u32 s3, s46, 4
v_mov_b32 v6, s3
s_mov_b64 vcc, 0xffff
v_cndmask_b32 v5, v5, v6, vcc
v_min_u32 v5, 15, v5
v_lshl_add_u32 v201, v5, 3, v3
v_lshl_add_u32 v5, v5, 3, v4
s_cmp_eq_u32 s47, 5
s_cselect_b64 vcc, 0xff, 0
v_cndmask_b32 v210, v7, v5, vcc
s_lshl_b64 vcc, vcc, 8
v_cndmask_b32 v211, v7, v5, vcc
s_bfm_b64 vcc, 8, 16
v_cndmask_b32 v212, v7, v5, vcc
s_bfm_b64 vcc, 8, 24
v_cndmask_b32 v213, v7, v5, vcc
s_bfm_b64 vcc, 8, 32
v_cndmask_b32 v214, v7, v5, vcc
s_bfm_b64 vcc, 8, 40
v_cndmask_b32 v215, v7, v5, vcc
s_mul_i32 s0, s44, 2304
s_movk_i32 s1, 144
v_bfe_u32 v3, v0, 2, 3
v_lshrrev_b32 v4, 5, v0
v_lshl_add_u32 v3, v3, 1, v4
s_add_u32 s3, s0, 31232
v_mov_b32 v4, s3
v_mad_u32_u24 v3, v3, s1, v4
v_and_b32 v4, 3, v0
s_mov_b32 s54, 0x11111111
s_mov_b32 s55, 0x11111111
v_add_u32 v5, s51, v4
v_lshl_add_u32 v216, v5, 3, v3
v_add_u32 v7, 32, v216
s_cmp_eq_u32 s50, 1
s_cselect_b32 s3, -1, 12
s_cselect_b32 s56, 2, -1
v_add_u32 v5, s3, v4
v_lshl_add_u32 v5, v5, 3, v3
v_cndmask_b32 v217, v5, v7, s[54:55]
v_add_u32 v7, 40, v7
v_add_u32 v5, s56, v4
v_add_u32 v6, 10, v5
v_cmp_gt_i32 vcc, s51, v5
s_nop 1
v_cndmask_b32 v5, v6, v5, vcc
v_lshl_add_u32 v5, v5, 3, v3
v_cndmask_b32 v218, v5, v7, s[54:55]
s_lshl_b32 s0, s44, 8
v_lshrrev_b32 v4, 5, v0
v_and_or_b32 v3, v0, 8, v4
s_add_u32 s3, s0, 8
v_lshl_add_u32 v222, v3, 4, s3
v_and_b32 v1, 15, v0
s_add_u32 s3, s0, 132
v_lshl_add_u32 v223, v1, 4, s3
s_lshr_b32 s3, s39, 8
s_mul_i32 s3, s3, 52429
s_lshr_b32 s3, s3, 18
s_lshl_b32 s0, s44, 5
s_add_u32 s3, s3, s0
s_sub_u32 s3, 2047, s3
v_mad_i32_i24 v234, v1, -2, s3
v_lshrrev_b32 v2, 4, v0
v_and_or_b32 v3, v0, 8, v2
v_and_b32 v4, 0x70, v233
v_bfrev_b32 v6, 1
s_lshl_b32 s3, s45, 4
v_add_u32 v5, s3, v3
s_lshl_b32 s3, s60, 3
v_cmp_gt_u32 vcc, s3, v5
v_mul_u32_u24 v5, 2560, v5
v_add3_u32 v5, v5, v4, s39
v_cndmask_b32 v236, v6, v5, vcc
s_lshl_b32 s3, s44, 4
v_add_u32 v5, s3, v3
s_lshl_b32 s3, s60, 3
v_cmp_gt_u32 vcc, s3, v5
v_mul_u32_u24 v5, 2560, v5
v_add3_u32 v5, v5, v4, s39
v_cndmask_b32 v227, v6, v5, vcc
s_lshl_b32 s3, s36, 7
v_add_u32 v226, s3, v227
v_bfe_u32 v3, v0, 4, 1
v_cmp_eq_u32 s[54:55], s50, v3
s_cmp_lg_u32 s37, 0
s_cselect_b64 s[0:1], -1, s[54:55]
s_and_b64 vcc, vcc, s[0:1]
s_cmp_lg_u32 s37, 4
s_cselect_b64 s[0:1], 0, s[54:55]
s_andn2_b64 vcc, vcc, s[0:1]
v_cndmask_b32 v225, v6, v226, vcc
s_cmp_le_u32 s37, 3
s_cselect_b32 s3, 2560, 0
s_sub_u32 s3, s3, 128
v_mov_b32 v4, s3
s_cmp_ge_u32 s37, 2
s_cselect_b32 s3, 2560, 0
s_add_u32 s3, s3, 128
v_mov_b32 v5, s3
v_cndmask_b32 v4, v4, v5, s[54:55]
v_mul_u32_u24 v3, 2560, v3
v_sub_u32 v4, v4, v3
v_add_u32 v4, v4, v226
v_cndmask_b32 v224, v6, v4, vcc
v_and_b32 v1, 15, v0
v_bfrev_b32 v6, 1
v_bfe_u32 v3, v0, 4, 1
v_lshrrev_b32 v4, 5, v0
v_lshl_add_u32 v3, v3, 1, v4
s_lshl_b32 s3, s36, 7
v_lshl_add_u32 v4, v3, 4, s3
s_lshl_b32 s3, s44, 4
v_add_u32 v5, s3, v1
s_lshl_b32 s3, s60, 3
v_cmp_gt_u32 vcc, s3, v5
v_mul_u32_u24 v5, 2560, v5
v_add3_u32 v5, v5, v4, s39
v_cndmask_b32 v232, v6, v5, vcc
v_bfe_u32 v3, v0, 3, 2
v_lshlrev_b32 v3, 2, v3
v_and_or_b32 v3, v0, 3, v3
v_lshlrev_b32 v3, 3, v3
v_bfe_u32 v4, v0, 2, 2
v_lshl_add_u32 v3, v4, 7, v3
v_lshrrev_b32 v2, 4, v0
s_and_b32 s3, s32, 1
s_lshl_b32 s3, s3, 12
s_add_u32 s3, s3, 81920
v_lshl_add_u32 v4, v2, 10, v3
v_add_u32 v228, s3, v4
v_xor_b32 v229, 32, v228
v_xor_b32 v230, 64, v228
v_xor_b32 v231, 96, v228
s_mov_b32 s44, 0x0
s_mov_b32 s45, 0x1010101
s_mov_b32 s46, 0x3030303
s_mov_b32 s47, 0x7070707
s_mov_b32 s48, 0xf0f0f0f
s_mov_b32 s49, 0x1f1f1f1f
s_mov_b32 s50, 0x3f3f3f3f
s_mov_b32 s51, 0x7f7f7f7f
s_movk_i32 s54, 10240
s_mov_b32 s55, 0x07060501
s_mov_b32 s56, 0x0706000c
v_mov_b32 v5, 0xffff
v_mov_b32 v6, 0xffff0000
v_cndmask_b32 v1, 0, v5, s[44:45]
v_cndmask_b32 v4, 0, v6, s[46:47]
v_or_b32 v220, v1, v4
v_cndmask_b32 v1, 0, v5, s[48:49]
v_cndmask_b32 v4, 0, v6, s[50:51]
v_or_b32 v221, v1, v4
v_lshrrev_b32 v1, 3, v0
v_and_b32 v2, 2, v1
v_xor_b32 v2, v2, v0
s_lshl_b32 s3, s32, 2
v_xor_b32 v2, s3, v2
v_and_b32 v2, 7, v2
s_lshl_b32 s3, s36, 7
v_lshl_add_u32 v2, v2, 4, s3
v_and_b32 v3, 3, v1
v_mul_u32_u24 v3, 1280, v3
v_add_u32 v2, v3, v2
v_lshrrev_b32 v3, 5, v0
v_mul_u32_u24 v3, 5120, v3
v_sub_u32 v4, 5120, v3
v_mad_u32_u24 v56, v3, 5, v2
v_mad_u32_u24 v57, v3, 3, v2
v_mad_u32_u24 v58, v3, 13, v2
v_mad_u32_u24 v59, v4, 3, v2
v_mad_u32_u24 v60, v4, 13, v2
s_mul_i32 s3, s38, 3
v_lshrrev_b32 v1, 2, v0
v_add_u32 v1, s3, v1
s_add_u32 s3, s3, 3
s_min_u32 s3, s3, s60
v_cmp_gt_u32 vcc, s3, v1
v_and_b32 v2, 3, v0
v_lshl_add_u32 v1, v1, 3, v2
v_mul_u32_u24 v1, 2560, v1
s_lshl_b32 s0, s36, 7
s_add_u32 s3, s0, s39
v_add_u32 v1, s3, v1
v_bfrev_b32 v2, 1
v_cndmask_b32 v61, v2, v1, vcc
s_mul_i32 s3, s38, 3
v_min_u32 v1, 2, v0
v_add_u32 v1, s3, v1
v_lshrrev_b32 v2, 1, v1
v_mul_u32_u24 v2, 2304, v2
v_lshl_add_u32 v1, v1, 7, v2
s_mul_i32 s3, s43, 15360
s_lshl_b32 s0, s36, 8
s_add_u32 s3, s3, s0
s_add_u32 s3, s3, 2097152
v_add_u32 v63, s3, v1
s_mul_i32 s3, s34, 9
v_min_u32 v1, 8, v0
v_add_u32 v1, s3, v1
v_min_u32 v1, 255, v1
v_cmp_le_u32 vcc, 128, v1
v_mul_u32_u24 v1, 3072, v1
s_mul_i32 s3, s33, 384
s_add_u32 s3, s3, 1572864
v_add_u32 v1, s3, v1
v_subrev_u32 v2, 1376000, v1
v_cndmask_b32 v1, v1, v2, vcc
s_mul_i32 s3, s33, 60
s_lshl_b32 s0, s34, 1
s_add_u32 s3, s3, s0
s_and_b32 s0, s32, 1
s_add_u32 s3, s3, s0
s_lshl_b32 s3, s3, 12
v_min_u32 v2, 31, v0
v_lshl_add_u32 v2, v2, 7, s3
s_cmp_ge_u32 s32, 6
s_cselect_b64 vcc, -1, 0
v_cndmask_b32 v84, v1, v2, vcc
v_mov_b32 v176, 0
v_mov_b32 v177, 0
v_mov_b32 v178, 0
v_mov_b32 v179, 0
v_mov_b32 v180, 0
v_mov_b32 v181, 0
v_mov_b32 v182, 0
v_mov_b32 v183, 0
v_mov_b32 v184, 0
v_mov_b32 v185, 0
v_mov_b32 v186, 0
v_mov_b32 v187, 0
v_mov_b32 v188, 0
v_mov_b32 v189, 0
v_mov_b32 v190, 0
v_mov_b32 v191, 0
s_lshl_b32 s0, s38, 12
s_add_u32 s0, s0, 57344
v_add_u32 v237, s0, v233
s_and_b32 s0, s38, 2
s_lshl_b32 s0, s0, 1
s_add_u32 s0, s0, 1760
v_mov_b32 v238, s0
v_mov_b32 v239, 1744
v_cmp_eq_u32 vcc, 0, v0
s_nop 1
v_cndmask_b32 v240, 0, 1, vcc
s_cmp_eq_u32 s32, 4
s_cbranch_scc1 L_h0
v_mov_b32 v4, 0x3f803f80
v_mov_b32 v5, v4
v_lshrrev_b32 v1, 4, v0
v_mul_u32_u24 v1, 36736, v1
v_lshl_add_u32 v1, v0, 3, v1
ds_write_b64 v1, v[4:5] offset:8192
s_sub_u32 s0, s32, 5
s_mul_i32 s3, s43, 3
s_add_u32 s3, s3, s0
s_mul_i32 s3, s3, 2560
s_add_u32 s67, s3, 2621440
s_mul_i32 s3, s35, 1280
s_add_u32 s3, s3, s59
s_add_u32 s66, s3, 12288
v_min_u32 v1, 9, v0
v_lshl_add_u32 v55, v1, 7, s66
s_lshl_b32 s68, s36, 7
s_add_u32 s68, s68, s66
v_and_b32 v1, 15, v0
v_lshrrev_b32 v2, 5, v0
v_lshl_add_u32 v2, v2, 4, v1
s_lshl_b32 s0, s0, 5
v_add_lshl_u32 v52, v2, s0, 4
v_lshrrev_b32 v2, 4, v0
v_lshrrev_b32 v3, 1, v1
v_xor_b32 v3, v3, v2
v_lshlrev_b32 v3, 4, v3
v_lshl_add_u32 v3, v1, 7, v3
v_add_u32 v54, s64, v3
s_cmp_lt_u32 s39, 2560
s_cselect_b32 s3, 128, 0
v_mov_b32 v1, 0xf149f2ca
v_cmp_gt_u32 vcc, s3, v52
s_nop 1
v_cndmask_b32 v53, 0, v1, vcc
s_setprio 1
s_add_u32 m0, s61, s64
s_mov_b32 exec_lo, s62
buffer_load_dwordx4 v24, s[4:7], s63 offen lds
s_addk_i32 m0, 1024
s_mov_b32 exec_lo, -1
buffer_load_dwordx4 v25, s[4:7], s63 offen lds
s_addk_i32 m0, 1024
s_nop 0
buffer_load_dwordx4 v26, s[4:7], s63 offen lds
s_addk_i32 m0, 1024
s_nop 0
buffer_load_dwordx4 v27, s[4:7], s63 offen lds
v_lshrrev_b32 v1, 4, v0
v_lshlrev_b32 v1, 3, v1
s_lshl_b32 s3, s36, 7
buffer_load_dwordx2 v[244:245], v1, s[28:31], s3 offen offset:0
buffer_load_dwordx2 v[246:247], v1, s[28:31], s3 offen offset:32
buffer_load_dwordx2 v[248:249], v1, s[28:31], s3 offen offset:64
buffer_load_dwordx2 v[250:251], v1, s[28:31], s3 offen offset:96
v_mov_b32 v64, 0x3f803f80
v_mov_b32 v65, 0x3f803f80
v_mov_b32 v66, 0x3f803f80
v_mov_b32 v67, 0x3f803f80
s_waitcnt vmcnt(8) lgkmcnt(0)
s_barrier
v_xor_b32 v1, 64, v54
ds_read_b128 v[36:39], v54 offset:8192
ds_read_b128 v[40:43], v1 offset:8192
ds_read_b128 v[44:47], v54 offset:10240
ds_read_b128 v[48:51], v1 offset:10240
s_lshl_b32 s3, s36, 8
s_add_u32 s3, s3, s67
v_and_b32 v2, 0xf0, v233
s_mov_b32 s0, 0xaaaaaaaa
s_mov_b32 s1, s0
s_mov_b32 vcc_lo, 0xcccccccc
s_mov_b32 vcc_hi, 0xcccccccc
s_waitcnt lgkmcnt(3)
v_mfma_f32_16x16x32_bf16 v[96:99], v[36:39], v[36:39], 0
v_mfma_f32_16x16x32_bf16 v[100:103], v[64:67], v[36:39], 0
s_waitcnt lgkmcnt(2)
v_mfma_f32_16x16x32_bf16 v[96:99], v[40:43], v[40:43], v[96:99]
v_mfma_f32_16x16x32_bf16 v[100:103], v[64:67], v[40:43], v[100:103]
s_waitcnt lgkmcnt(1)
v_mfma_f32_16x16x32_bf16 v[104:107], v[44:47], v[44:47], 0
v_mfma_f32_16x16x32_bf16 v[108:111], v[64:67], v[44:47], 0
s_waitcnt lgkmcnt(0)
v_mfma_f32_16x16x32_bf16 v[104:107], v[48:51], v[48:51], v[104:107]
v_mfma_f32_16x16x32_bf16 v[108:111], v[64:67], v[48:51], v[108:111]
s_nop 0
v_cndmask_b32 v96, v96, v97, s[0:1]
v_cndmask_b32 v98, v98, v99, s[0:1]
v_cndmask_b32 v29, v96, v98, vcc
v_mov_b32 v28, v100
s_nop 1
v_cndmask_b32 v104, v104, v105, s[0:1]
v_cndmask_b32 v106, v106, v107, s[0:1]
v_cndmask_b32 v31, v104, v106, vcc
v_mov_b32 v30, v108
s_mov_b32 exec_lo, 0xf0000f
s_mov_b32 exec_hi, 0xf0000f00
buffer_store_dwordx4 v[28:31], v2, s[16:19], s3 offen sc1
s_mov_b64 exec, -1
v_mov_b32 v44, 0
v_mov_b32 v45, 0
v_mov_b32 v46, 0
v_mov_b32 v47, 0
s_add_u32 s69, s69, 1
s_cmp_eq_u32 s69, 10
s_cselect_b32 s69, 0, s69
s_lshl_b32 s63, s69, 7
s_mov_b32 s61, 81920
s_add_u32 m0, s61, s64
s_mov_b32 exec_lo, s62
buffer_load_dwordx4 v24, s[4:7], s63 offen lds
s_addk_i32 m0, 1024
s_mov_b32 exec_lo, -1
buffer_load_dwordx4 v25, s[4:7], s63 offen lds
s_addk_i32 m0, 1024
s_nop 0
buffer_load_dwordx4 v26, s[4:7], s63 offen lds
s_addk_i32 m0, 1024
s_nop 0
buffer_load_dwordx4 v27, s[4:7], s63 offen lds
s_branch L_pb_1
.p2align 12
L_pad_2:
s_setpc_b64 s[100:101]
L_pb_1:
s_waitcnt vmcnt(5) lgkmcnt(0)
s_cmp_eq_u32 s32, 5
s_cbranch_scc0 L_o5a
s_lshl_b32 s0, s33, 5
v_and_b32 v1, 16, v0
buffer_load_dword v32, v1, s[24:27], s0 offen sc1
L_o5a:
s_barrier
s_mul_i32 s3, s2, 3
s_add_u32 s3, s3, s32
s_sub_u32 s3, s3, 5
s_mul_i32 s3, s3, 1152
v_lshlrev_b32 v1, 7, v0
s_mov_b64 exec, 0x1ff
buffer_load_dword v255, v1, s[12:15], s3 offen
s_mov_b64 exec, -1
s_add_u32 s69, s69, 1
s_cmp_eq_u32 s69, 10
s_cselect_b32 s69, 0, s69
s_lshl_b32 s63, s69, 7
s_mov_b32 s61, 118784
s_add_u32 m0, s61, s64
s_mov_b32 exec_lo, s62
buffer_load_dwordx4 v24, s[4:7], s63 offen lds
s_addk_i32 m0, 1024
s_mov_b32 exec_lo, -1
buffer_load_dwordx4 v25, s[4:7], s63 offen lds
s_addk_i32 m0, 1024
s_nop 0
buffer_load_dwordx4 v26, s[4:7], s63 offen lds
s_addk_i32 m0, 1024
s_nop 0
buffer_load_dwordx4 v27, s[4:7], s63 offen lds
s_cmp_eq_u32 s57, 1
s_cbranch_scc0 L_xc1
s_mov_b32 s0, 45056
s_call_b64 s[100:101], L_xcap
L_xc1:
s_cmp_eq_u32 s32, 7
s_cbranch_scc0 L_wm1
s_call_b64 s[100:101], L_pad_8
s_call_b64 s[100:101], L_pad_24
L_wm1:
s_waitcnt vmcnt(5) lgkmcnt(0)
s_barrier
s_cmp_eq_u32 s32, 5
s_cbranch_scc0 L_o5c
s_waitcnt lgkmcnt(0)
v_cmp_ne_u32 vcc, 1, v32
s_cmp_eq_u64 vcc, 0
s_cbranch_scc0 L_era
L_ega:
s_getreg_b32 s0, hwreg(HW_REG_XCC_ID, 0, 4)
v_mov_b32 v1, s0
s_mov_b64 exec, 1
buffer_store_dword v1, off, s[16:19], s68 sc1
s_mov_b64 exec, -1
L_o5c:
s_add_u32 s69, s69, 1
s_cmp_eq_u32 s69, 10
s_cselect_b32 s69, 0, s69
s_lshl_b32 s63, s69, 7
s_mov_b32 s61, 8192
s_add_u32 m0, s61, s64
s_mov_b32 exec_lo, s62
buffer_load_dwordx4 v24, s[4:7], s63 offen lds
s_addk_i32 m0, 1024
s_mov_b32 exec_lo, -1
buffer_load_dwordx4 v25, s[4:7], s63 offen lds
s_addk_i32 m0, 1024
s_nop 0
buffer_load_dwordx4 v26, s[4:7], s63 offen lds
s_addk_i32 m0, 1024
s_nop 0
buffer_load_dwordx4 v27, s[4:7], s63 offen lds
s_cmp_eq_u32 s57, 2
s_cbranch_scc0 L_xc2
s_mov_b32 s0, 81920
s_call_b64 s[100:101], L_xcap
L_xc2:
s_cmp_eq_u32 s32, 7
s_cbranch_scc0 L_wm2
s_call_b64 s[100:101], L_pad_11
s_call_b64 s[100:101], L_pad_25
L_wm2:
s_cmp_eq_u32 s32, 5
s_cbranch_scc1 L_w52
s_waitcnt vmcnt(4)
L_w52:
s_waitcnt vmcnt(5) lgkmcnt(0)
s_barrier
s_add_u32 s69, s69, 1
s_cmp_eq_u32 s69, 10
s_cselect_b32 s69, 0, s69
s_lshl_b32 s63, s69, 7
s_mov_b32 s61, 45056
s_add_u32 m0, s61, s64
s_mov_b32 exec_lo, s62
buffer_load_dwordx4 v24, s[4:7], s63 offen lds
s_addk_i32 m0, 1024
s_mov_b32 exec_lo, -1
buffer_load_dwordx4 v25, s[4:7], s63 offen lds
s_addk_i32 m0, 1024
s_nop 0
buffer_load_dwordx4 v26, s[4:7], s63 offen lds
s_addk_i32 m0, 1024
s_nop 0
buffer_load_dwordx4 v27, s[4:7], s63 offen lds
s_cmp_eq_u32 s57, 3
s_cbranch_scc0 L_xc3
s_mov_b32 s0, 118784
s_call_b64 s[100:101], L_xcap
L_xc3:
s_cmp_eq_u32 s32, 7
s_cbranch_scc0 L_wm3
s_call_b64 s[100:101], L_pad_12
L_wm3:
s_waitcnt vmcnt(4) lgkmcnt(0)
s_barrier
s_add_u32 s69, s69, 1
s_cmp_eq_u32 s69, 10
s_cselect_b32 s69, 0, s69
s_lshl_b32 s63, s69, 7
s_mov_b32 s61, 81920
s_add_u32 m0, s61, s64
s_mov_b32 exec_lo, s62
buffer_load_dwordx4 v24, s[4:7], s63 offen lds
s_addk_i32 m0, 1024
s_mov_b32 exec_lo, -1
buffer_load_dwordx4 v25, s[4:7], s63 offen lds
s_addk_i32 m0, 1024
s_nop 0
buffer_load_dwordx4 v26, s[4:7], s63 offen lds
s_addk_i32 m0, 1024
s_nop 0
buffer_load_dwordx4 v27, s[4:7], s63 offen lds
s_cmp_eq_u32 s57, 4
s_cbranch_scc0 L_xc4
s_mov_b32 s0, 8192
s_call_b64 s[100:101], L_xcap
L_xc4:
s_cmp_eq_u32 s32, 7
s_cbranch_scc0 L_wm4
s_call_b64 s[100:101], L_pad_13
L_wm4:
s_waitcnt vmcnt(4) lgkmcnt(0)
s_cmp_eq_u32 s32, 5
s_cbranch_scc0 L_o5b
s_buffer_load_dword s71, s[16:19], s66 offset:0 glc
s_buffer_load_dword s73, s[16:19], s66 offset:128 glc
s_buffer_load_dword s75, s[16:19], s66 offset:256 glc
s_buffer_load_dword s77, s[16:19], s66 offset:384 glc
s_buffer_load_dword s83, s[16:19], s66 offset:512 glc
s_buffer_load_dword s85, s[16:19], s66 offset:640 glc
s_buffer_load_dword s89, s[16:19], s66 offset:768 glc
s_buffer_load_dword s91, s[16:19], s66 offset:896 glc
s_buffer_load_dword s93, s[16:19], s66 offset:1024 glc
s_buffer_load_dword s95, s[16:19], s66 offset:1152 glc
L_o5b:
s_barrier
s_add_u32 s69, s69, 1
s_cmp_eq_u32 s69, 10
s_cselect_b32 s69, 0, s69
s_lshl_b32 s63, s69, 7
s_mov_b32 s61, 118784
s_add_u32 m0, s61, s64
s_mov_b32 exec_lo, s62
buffer_load_dwordx4 v24, s[4:7], s63 offen lds
s_addk_i32 m0, 1024
s_mov_b32 exec_lo, -1
buffer_load_dwordx4 v25, s[4:7], s63 offen lds
s_addk_i32 m0, 1024
s_nop 0
buffer_load_dwordx4 v26, s[4:7], s63 offen lds
s_addk_i32 m0, 1024
s_nop 0
buffer_load_dwordx4 v27, s[4:7], s63 offen lds
s_cmp_eq_u32 s57, 5
s_cbranch_scc0 L_xc5
s_mov_b32 s0, 45056
s_call_b64 s[100:101], L_xcap
L_xc5:
s_cmp_eq_u32 s32, 5
s_cbranch_scc0 L_o5d
s_waitcnt lgkmcnt(0)
s_max_u32 s0, s71, s73
s_max_u32 s0, s0, s75
s_max_u32 s0, s0, s77
s_max_u32 s0, s0, s83
s_max_u32 s0, s0, s85
s_max_u32 s0, s0, s89
s_max_u32 s0, s0, s91
s_max_u32 s0, s0, s93
s_max_u32 s0, s0, s95
s_cmp_lg_u32 s0, -1
s_cbranch_scc0 L_erb
L_egb:
s_min_u32 s1, s71, s73
s_min_u32 s1, s1, s75
s_min_u32 s1, s1, s77
s_min_u32 s1, s1, s83
s_min_u32 s1, s1, s85
s_min_u32 s1, s1, s89
s_min_u32 s1, s1, s91
s_min_u32 s1, s1, s93
s_min_u32 s1, s1, s95
s_cmp_eq_u32 s0, s1
s_cselect_b32 s0, 1, 0
v_mov_b32 v1, 1728
v_mov_b32 v2, s0
ds_write_b32 v1, v2
L_o5d:
s_cmp_eq_u32 s32, 7
s_cbranch_scc0 L_wm5
s_call_b64 s[100:101], L_pad_14
L_wm5:
s_waitcnt vmcnt(4) lgkmcnt(0)
s_barrier
buffer_load_dwordx4 v[36:39], v233, s[16:19], s67 offen offset:0 sc1
buffer_load_dwordx4 v[40:43], v233, s[16:19], s67 offen offset:1024 sc1
s_mov_b32 exec_hi, 0
buffer_load_dwordx4 v[44:47], v233, s[16:19], s67 offen offset:2048 sc1
s_mov_b32 exec_hi, -1
s_add_u32 s69, s69, 1
s_cmp_eq_u32 s69, 10
s_cselect_b32 s69, 0, s69
s_lshl_b32 s63, s69, 7
s_mov_b32 s61, 8192
s_add_u32 m0, s61, s64
s_mov_b32 exec_lo, s62
buffer_load_dwordx4 v24, s[4:7], s63 offen lds
s_addk_i32 m0, 1024
s_mov_b32 exec_lo, -1
buffer_load_dwordx4 v25, s[4:7], s63 offen lds
s_addk_i32 m0, 1024
s_nop 0
buffer_load_dwordx4 v26, s[4:7], s63 offen lds
s_addk_i32 m0, 1024
s_nop 0
buffer_load_dwordx4 v27, s[4:7], s63 offen lds
s_cmp_eq_u32 s57, 6
s_cbranch_scc0 L_xc6
s_mov_b32 s0, 81920
s_call_b64 s[100:101], L_xcap
L_xc6:
s_cmp_eq_u32 s32, 7
s_cbranch_scc0 L_wm6
s_call_b64 s[100:101], L_pad_21
L_wm6:
s_waitcnt vmcnt(7) lgkmcnt(0)
s_barrier
s_add_u32 s69, s69, 1
s_cmp_eq_u32 s69, 10
s_cselect_b32 s69, 0, s69
s_lshl_b32 s63, s69, 7
s_mov_b32 s61, 45056
s_add_u32 m0, s61, s64
s_mov_b32 exec_lo, s62
buffer_load_dwordx4 v24, s[4:7], s63 offen lds
s_addk_i32 m0, 1024
s_mov_b32 exec_lo, -1
buffer_load_dwordx4 v25, s[4:7], s63 offen lds
s_addk_i32 m0, 1024
s_nop 0
buffer_load_dwordx4 v26, s[4:7], s63 offen lds
s_addk_i32 m0, 1024
s_nop 0
buffer_load_dwordx4 v27, s[4:7], s63 offen lds
s_cmp_eq_u32 s57, 7
s_cbranch_scc0 L_xc7
s_mov_b32 s0, 118784
s_call_b64 s[100:101], L_xcap
L_xc7:
s_waitcnt vmcnt(8)
v_add_f32 v36, v36, v40
v_add_f32 v37, v37, v41
v_add_f32 v38, v38, v42
v_add_f32 v39, v39, v43
v_add_f32 v36, v36, v44
v_add_f32 v37, v37, v45
v_add_f32 v38, v38, v46
v_add_f32 v39, v39, v47
s_nop 0
v_permlane32_swap_b32 v36, v38
v_permlane32_swap_b32 v37, v39
v_add_f32 v36, v36, v38
v_add_f32 v37, v37, v39
v_mov_b32 v38, v36
v_mov_b32 v39, v37
s_mov_b32 s1, 0x3acccccd
v_mov_b32 v1, 0x3727c5ac
v_permlane16_swap_b32 v36, v38
v_permlane16_swap_b32 v37, v39
v_add_f32 v36, v36, v38
v_add_f32 v37, v37, v39
v_mul_f32 v36, 0xbacccccd, v36
v_fma_f32 v2, v37, s1, v1
v_fma_f32 v2, -v36, v36, v2
v_max_f32 v2, v2, v1
v_rsq_f32 v37, v2
v_mov_b32 v39, v53
v_mov_b32 v38, v37
ds_write_b128 v52, v[36:39] offset:0
s_waitcnt vmcnt(4) lgkmcnt(0)
s_barrier
s_cmp_eq_u32 s57, 8
s_cbranch_scc0 L_xc8
s_mov_b32 s0, 8192
s_call_b64 s[100:101], L_xcap
L_xc8:
L_h8:
s_mul_i32 s66, s38, 5120
s_lshl_b32 s3, s38, 10
s_add_u32 m0, s3, 81920
s_add_u32 s3, s66, 25600
buffer_load_dwordx4 v56, s[12:15], s3 offen lds
s_addk_i32 m0, 4096
s_add_u32 s3, s66, 102400
buffer_load_dwordx4 v56, s[12:15], s3 offen lds
s_addk_i32 m0, 4096
s_add_u32 s3, s66, 179200
buffer_load_dwordx4 v56, s[12:15], s3 offen lds
s_addk_i32 m0, 4096
s_add_u32 s3, s66, 256000
buffer_load_dwordx4 v56, s[12:15], s3 offen lds
s_addk_i32 m0, 4096
s_add_u32 s3, s66, 332800
buffer_load_dwordx4 v56, s[12:15], s3 offen lds
s_addk_i32 m0, 4096
s_add_u32 s3, s66, 435200
buffer_load_dwordx4 v56, s[12:15], s3 offen lds
s_addk_i32 m0, 4096
s_add_u32 s3, s66, 512000
buffer_load_dwordx4 v56, s[12:15], s3 offen lds
s_addk_i32 m0, 4096
s_add_u32 s3, s66, 588800
buffer_load_dwordx4 v56, s[12:15], s3 offen lds
v_add_u32 v1, 128, v222
v_cndmask_b32 v2, v1, v222, s[44:45]
ds_read_b64 v[168:169], v2 offset:0
v_cndmask_b32 v2, v1, v222, s[46:47]
ds_read_b64 v[170:171], v2 offset:32
v_cndmask_b32 v2, v1, v222, s[48:49]
ds_read_b64 v[172:173], v2 offset:64
v_cndmask_b32 v2, v1, v222, s[50:51]
ds_read_b64 v[174:175], v2 offset:96
ds_read_b32 v5, v223
v_mov_b32 v1, 1728
ds_read_b32 v1, v1
s_waitcnt lgkmcnt(0)
v_readfirstlane_b32 s41, v1
s_waitcnt vmcnt(8)
s_barrier
s_cmp_eq_u32 s41, 1
s_cbranch_scc0 L_gh_3g
L_gh_3b:
s_addk_i32 m0, 4096
s_add_u32 s3, s66, 665600
buffer_load_dwordx4 v56, s[12:15], s3 offen lds
s_addk_i32 m0, 4096
s_add_u32 s3, s66, 742400
buffer_load_dwordx4 v56, s[12:15], s3 offen lds
buffer_load_dword v62, v61, s[20:23], s54 offen
buffer_load_dword v63, v63, s[16:19], 0 offen
global_load_dword v84, v84, s[96:97]
v_lshlrev_b32 v8, 16, v72
v_and_b32 v9, 0xffff0000, v72
v_lshlrev_b32 v10, 16, v73
v_and_b32 v11, 0xffff0000, v73
v_lshlrev_b32 v12, 16, v74
v_and_b32 v13, 0xffff0000, v74
v_lshlrev_b32 v14, 16, v75
v_and_b32 v15, 0xffff0000, v75
v_lshlrev_b32 v16, 16, v76
v_and_b32 v17, 0xffff0000, v76
v_lshlrev_b32 v18, 16, v77
v_and_b32 v19, 0xffff0000, v77
v_lshlrev_b32 v20, 16, v78
v_and_b32 v21, 0xffff0000, v78
v_lshlrev_b32 v22, 16, v79
v_and_b32 v23, 0xffff0000, v79
s_mov_b32 s3, 0x3f803f80
v_mov_b32 v64, s3
v_mov_b32 v65, s3
v_mov_b32 v66, s3
v_mov_b32 v67, s3
s_mov_b32 exec_lo, 0x11111111
s_mov_b32 exec_hi, 0x11111111
v_mov_b32 v244, s3
v_mov_b32 v245, s3
v_mov_b32 v246, s3
v_mov_b32 v247, s3
v_mov_b32 v248, s3
v_mov_b32 v249, s3
v_mov_b32 v250, s3
v_mov_b32 v251, s3
s_mov_b64 exec, -1
v_mfma_f32_16x16x32_bf16 v[252:255], v[244:247], v[64:67], 0
v_mfma_f32_16x16x32_bf16 v[252:255], v[248:251], v[64:67], v[252:255]
s_and_b32 s3, s32, 1
s_lshl_b32 s61, s3, 7
s_xor_b32 s62, s61, 128
s_add_u32 s63, s62, s54
s_add_u32 s64, s61, s54
s_lshl_b32 s3, s3, 13
s_sub_u32 s65, 4096, s3
s_add_u32 s0, s37, 1
s_sub_u32 s1, 5, s37
s_min_u32 s0, s0, s1
s_lshl_b32 s0, s0, 4
s_sub_u32 s1, 64, s0
s_cmp_le_u32 s37, 2
s_cselect_b32 s1, s1, 16
s_bfm_b64 s[100:101], s0, s1
v_mul_f32 v5, 0x3ea52b5c, v5
s_barrier
ds_read_b64 v[96:97], v202 offset:0
ds_read_b64 v[98:99], v202 offset:1152
ds_read_b64 v[100:101], v203 offset:0
ds_read_b64 v[102:103], v203 offset:1152
ds_read_b64 v[104:105], v201 offset:0
ds_read_b64 v[106:107], v201 offset:1152
ds_read_b64 v[108:109], v200 offset:0
ds_read_b64 v[110:111], v200 offset:1152
ds_read_b64 v[112:113], v200 offset:40
ds_read_b64 v[114:115], v200 offset:1192
s_cmp_eq_u32 s38, 1
s_cbranch_scc1 L_woe1
s_cmp_eq_u32 s38, 2
s_cbranch_scc1 L_woe2
s_cmp_eq_u32 s38, 3
s_cbranch_scc1 L_woe3
s_addk_i32 m0, 4096
s_mov_b32 s3, 46080
buffer_load_dwordx4 v56, s[12:15], s3 offen lds
s_addk_i32 m0, 4096
s_mov_b32 s3, 122880
buffer_load_dwordx4 v56, s[12:15], s3 offen lds
s_addk_i32 m0, 4096
s_mov_b32 s3, 199680
buffer_load_dwordx4 v56, s[12:15], s3 offen lds
s_addk_i32 m0, 4096
s_mov_b32 s3, 276480
buffer_load_dwordx4 v56, s[12:15], s3 offen lds
s_addk_i32 m0, 4096
s_mov_b32 s3, 353280
buffer_load_dwordx4 v56, s[12:15], s3 offen lds
s_addk_i32 m0, 4096
s_mov_b32 s3, 455680
buffer_load_dwordx4 v56, s[12:15], s3 offen lds
s_addk_i32 m0, 4096
s_mov_b32 s3, 532480
buffer_load_dwordx4 v56, s[12:15], s3 offen lds
s_addk_i32 m0, 4096
s_mov_b32 s3, 609280
buffer_load_dwordx4 v56, s[12:15], s3 offen lds
s_addk_i32 m0, 4096
s_mov_b32 s3, 686080
buffer_load_dwordx4 v56, s[12:15], s3 offen lds
s_addk_i32 m0, 4096
s_mov_b32 s3, 762880
buffer_load_dwordx4 v56, s[12:15], s3 offen lds
L_woe:
buffer_load_dword v62, v61, s[20:23], 0 offen
s_setprio 1
s_waitcnt vmcnt(16)
s_barrier
ds_read_b64 v[116:117], v206 offset:0
ds_read_b64 v[118:119], v207 offset:0
ds_read_b64 v[120:121], v208 offset:0
ds_read_b64 v[122:123], v209 offset:0
ds_read_b64 v[124:125], v210 offset:0
ds_read_b64 v[126:127], v211 offset:0
ds_read_b64 v[128:129], v204 offset:0
ds_read_b64 v[130:131], v205 offset:0
ds_read_b64 v[132:133], v204 offset:40
ds_read_b64 v[134:135], v205 offset:40
s_waitcnt lgkmcnt(8)
v_mfma_f32_16x16x32_bf16 v[152:155], v[96:99], v[116:119], 0
ds_read_b64 v[136:137], v212 offset:0
ds_read_b64 v[138:139], v213 offset:0
s_waitcnt lgkmcnt(8)
v_mfma_f32_16x16x32_bf16 v[156:159], v[100:103], v[120:123], 0
ds_read_b64 v[140:141], v214 offset:0
ds_read_b64 v[142:143], v215 offset:0
s_waitcnt lgkmcnt(8)
v_mfma_f32_16x16x32_bf16 v[152:155], v[104:107], v[124:127], v[152:155]
s_waitcnt lgkmcnt(6)
v_mfma_f32_16x16x32_bf16 v[160:163], v[108:111], v[128:131], 0
s_waitcnt lgkmcnt(4)
v_mfma_f32_16x16x32_bf16 v[164:167], v[112:115], v[132:135], 0
s_waitcnt lgkmcnt(2)
v_mfma_f32_16x16x32_bf16 v[160:163], v[104:107], v[136:139], v[160:163]
s_waitcnt lgkmcnt(0)
v_mfma_f32_16x16x32_bf16 v[164:167], v[104:107], v[140:143], v[164:167]
v_permlane16_swap_b32 v152, v156
v_permlane16_swap_b32 v153, v157
v_permlane16_swap_b32 v154, v158
v_permlane16_swap_b32 v155, v159
v_cndmask_b32 v2, v156, v152, s[44:45]
v_cndmask_b32 v3, v157, v153, s[46:47]
v_cndmask_b32 v194, v158, v154, s[48:49]
v_cndmask_b32 v195, v159, v155, s[50:51]
v_or_b32 v192, 0xffff, v2
v_perm_b32 v193, v3, v2, s55
s_cmp_eq_u32 s41, 1
s_cbranch_scc0 L_gl_4g
buffer_store_dwordx4 v[192:195], v224, s[20:23], s54 offen
L_gl_4b:
v_permlane16_swap_b32 v160, v164
v_permlane16_swap_b32 v161, v165
v_permlane16_swap_b32 v162, v166
v_permlane16_swap_b32 v163, v167
v_cndmask_b32 v196, v164, v160, s[44:45]
v_cndmask_b32 v197, v165, v161, s[46:47]
v_cndmask_b32 v198, v166, v162, s[48:49]
v_cndmask_b32 v199, v167, v163, s[50:51]
v_fma_f32 v196, v196, v168, v169
v_fma_f32 v197, v197, v170, v171
v_fma_f32 v198, v198, v172, v173
v_fma_f32 v199, v199, v174, v175
v_max3_f32 v6, v196, v197, v198
v_max_f32 v6, v6, v199
v_mov_b32 v7, v6
s_nop 1
v_permlane32_swap_b32 v6, v7
v_max_f32 v6, v6, v7
v_mul_f32 v6, v6, v5
v_fma_f32 v196, v196, v5, -v6
v_fma_f32 v197, v197, v5, -v6
v_fma_f32 v198, v198, v5, -v6
v_fma_f32 v199, v199, v5, -v6
v_exp_f32 v196, v196
v_exp_f32 v197, v197
v_exp_f32 v198, v198
v_exp_f32 v199, v199
ds_read_b64_tr_b16 v[64:65], v216 offset:0
ds_read_b64_tr_b16 v[66:67], v216 offset:1152
ds_read_b64_tr_b16 v[68:69], v216 offset:40
ds_read_b64_tr_b16 v[70:71], v216 offset:1192
ds_read_b64_tr_b16 v[72:73], v217 offset:0
ds_read_b64_tr_b16 v[74:75], v217 offset:1152
ds_read_b64_tr_b16 v[76:77], v218 offset:0
ds_read_b64_tr_b16 v[78:79], v218 offset:1152
v_add_f32 v6, v196, v197
v_add_f32 v7, v198, v199
v_add_f32 v6, v6, v7
v_mov_b32 v7, v6
v_mul_f32 v196, v196, v168
v_mul_f32 v197, v197, v170
v_permlane32_swap_b32 v6, v7
v_mul_f32 v198, v198, v172
v_add_f32 v6, v6, v7
v_rcp_f32 v6, v6
v_mul_f32 v199, v199, v174
v_mul_f32 v196, v196, v6
v_mul_f32 v197, v197, v6
v_mul_f32 v198, v198, v6
v_mul_f32 v199, v199, v6
v_cvt_pk_bf16_f32 v196, v196, v197
v_cvt_pk_bf16_f32 v197, v198, v199
s_mov_b64 exec, s[52:53]
v_and_b32 v176, v220, v196
v_bfi_b32 v180, v220, 0, v196
v_and_b32 v177, v221, v197
v_bfi_b32 v181, v221, 0, v197
s_not_b64 exec, exec
v_and_b32 v178, v220, v196
v_bfi_b32 v182, v220, 0, v196
v_and_b32 v179, v221, v197
v_bfi_b32 v183, v221, 0, v197
s_mov_b64 exec, -1
v_permlane16_swap_b32 v176, v180
v_permlane16_swap_b32 v177, v181
v_permlane16_swap_b32 v178, v182
v_permlane16_swap_b32 v179, v183
buffer_load_dwordx4 v[92:95], v225, s[20:23], s54 offen sc1
s_waitcnt lgkmcnt(0)
v_mfma_f32_16x16x32_bf16 v[152:155], v[64:67], v[176:179], 0
v_mfma_f32_16x16x32_bf16 v[156:159], v[68:71], v[180:183], 0
v_mfma_f32_16x16x32_bf16 v[160:163], v[72:75], v[176:179], 0
v_mfma_f32_16x16x32_bf16 v[164:167], v[76:79], v[180:183], 0
s_nop 4
v_cvt_pk_bf16_f32 v196, v152, v153
v_cvt_pk_bf16_f32 v197, v154, v155
v_cvt_pk_bf16_f32 v198, v156, v157
v_cvt_pk_bf16_f32 v199, v158, v159
s_cmp_eq_u32 s41, 1
s_cbranch_scc0 L_gl_5g
buffer_store_dwordx4 v[196:199], v226, s[20:23], 0 offen
L_gl_5b:
v_cvt_pk_bf16_f32 v80, v160, v161
v_cvt_pk_bf16_f32 v81, v162, v163
v_cvt_pk_bf16_f32 v82, v164, v165
v_cvt_pk_bf16_f32 v83, v166, v167
ds_read_b64_tr_b16 v[104:105], v228 offset:0
ds_read_b64_tr_b16 v[106:107], v228 offset:512
ds_read_b64_tr_b16 v[108:109], v229 offset:0
ds_read_b64_tr_b16 v[110:111], v229 offset:512
ds_read_b64_tr_b16 v[112:113], v230 offset:0
ds_read_b64_tr_b16 v[114:115], v230 offset:512
ds_read_b64_tr_b16 v[116:117], v231 offset:0
ds_read_b64_tr_b16 v[118:119], v231 offset:512
ds_read_b64_tr_b16 v[120:121], v228 offset:8192
ds_read_b64_tr_b16 v[122:123], v228 offset:8704
ds_read_b64_tr_b16 v[124:125], v229 offset:8192
ds_read_b64_tr_b16 v[126:127], v229 offset:8704
ds_read_b64_tr_b16 v[128:129], v230 offset:8192
ds_read_b64_tr_b16 v[130:131], v230 offset:8704
ds_read_b64_tr_b16 v[132:133], v231 offset:8192
ds_read_b64_tr_b16 v[134:135], v231 offset:8704
ds_read_b64_tr_b16 v[136:137], v228 offset:16384
ds_read_b64_tr_b16 v[138:139], v228 offset:16896
ds_read_b64_tr_b16 v[140:141], v229 offset:16384
ds_read_b64_tr_b16 v[142:143], v229 offset:16896
ds_read_b64_tr_b16 v[144:145], v230 offset:16384
ds_read_b64_tr_b16 v[146:147], v230 offset:16896
ds_read_b64_tr_b16 v[148:149], v231 offset:16384
ds_read_b64_tr_b16 v[150:151], v231 offset:16896
s_waitcnt vmcnt(1)
v_cmp_eq_u32 vcc, -1, v92
s_cbranch_vccnz L_h0rh
L_h0gh:
s_mov_b64 exec, 1
ds_add_u32 v239, v240
s_mov_b64 exec, -1
v_perm_b32 v92, v92, v93, s56
v_add_f32 v193, v3, v93
v_add_f32 v194, v194, v94
v_add_f32 v195, v195, v95
v_add_f32 v192, v2, v92
v_fma_f32 v192, v192, v168, v169
v_fma_f32 v193, v193, v170, v171
v_fma_f32 v194, v194, v172, v173
v_fma_f32 v195, v195, v174, v175
v_max3_f32 v6, v192, v193, v194
v_max_f32 v6, v6, v195
v_mov_b32 v7, v6
s_nop 1
v_permlane32_swap_b32 v6, v7
v_max_f32 v6, v6, v7
v_mul_f32 v6, v6, v5
v_fma_f32 v192, v192, v5, -v6
v_fma_f32 v193, v193, v5, -v6
v_fma_f32 v194, v194, v5, -v6
v_fma_f32 v195, v195, v5, -v6
v_exp_f32 v192, v192
v_exp_f32 v193, v193
v_exp_f32 v194, v194
v_exp_f32 v195, v195
buffer_load_dwordx4 v[24:27], v227, s[20:23], s61 offen offset:0 sc1
buffer_load_dwordx4 v[28:31], v227, s[20:23], s61 offen offset:256 sc1
buffer_load_dwordx4 v[32:35], v227, s[20:23], s61 offen offset:512 sc1
buffer_load_dwordx4 v[36:39], v227, s[20:23], s61 offen offset:768 sc1
buffer_load_dwordx4 v[40:43], v227, s[20:23], s61 offen offset:1024 sc1
buffer_load_dwordx4 v[44:47], v227, s[20:23], s62 offen offset:0 sc1
v_add_f32 v6, v192, v193
v_add_f32 v7, v194, v195
v_add_f32 v6, v6, v7
v_mov_b32 v7, v6
v_mul_f32 v192, v192, v168
v_mul_f32 v193, v193, v170
v_permlane32_swap_b32 v6, v7
v_mul_f32 v194, v194, v172
v_add_f32 v6, v6, v7
v_rcp_f32 v6, v6
v_mul_f32 v195, v195, v174
v_mul_f32 v192, v192, v6
v_mul_f32 v193, v193, v6
v_mul_f32 v194, v194, v6
v_mul_f32 v195, v195, v6
v_cvt_pk_bf16_f32 v192, v192, v193
v_cvt_pk_bf16_f32 v193, v194, v195
s_mov_b64 exec, s[52:53]
v_and_b32 v184, v220, v192
v_bfi_b32 v188, v220, 0, v192
v_and_b32 v185, v221, v193
v_bfi_b32 v189, v221, 0, v193
s_not_b64 exec, exec
v_and_b32 v186, v220, v192
v_bfi_b32 v190, v220, 0, v192
v_and_b32 v187, v221, v193
v_bfi_b32 v191, v221, 0, v193
s_mov_b64 exec, -1
v_permlane16_swap_b32 v184, v188
v_permlane16_swap_b32 v185, v189
v_permlane16_swap_b32 v186, v190
v_permlane16_swap_b32 v187, v191
s_nop 1
v_mfma_f32_16x16x32_bf16 v[152:155], v[72:75], v[184:187], 0
v_mfma_f32_16x16x32_bf16 v[156:159], v[76:79], v[184:187], 0
v_mfma_f32_16x16x32_bf16 v[160:163], v[76:79], v[188:191], 0
ds_read_b32 v1, v239
s_mov_b32 exec_lo, 0xffff0000
s_nop 3
v_cvt_pk_bf16_f32 v80, v152, v153
v_cvt_pk_bf16_f32 v81, v154, v155
v_cvt_pk_bf16_f32 v82, v156, v157
v_cvt_pk_bf16_f32 v83, v158, v159
s_mov_b64 exec, s[100:101]
v_cvt_pk_bf16_f32 v82, v160, v161
v_cvt_pk_bf16_f32 v83, v162, v163
s_mov_b64 exec, -1
s_cmp_eq_u32 s41, 1
s_cbranch_scc0 L_gl_6g
buffer_store_dwordx4 v[80:83], v226, s[20:23], s54 offen
L_gl_6b:
s_branch L_pb_7
.p2align 12
L_pad_8:
s_setpc_b64 s[100:101]
L_pb_7:
s_waitcnt lgkmcnt(0)
v_cmp_ne_u32 vcc, 4, v1
s_cbranch_vccnz L_spw
L_sbw:
s_waitcnt vmcnt(5)
v_max_u16 v2, v24, v28
v_cmp_eq_u16 vcc, -1, v2
s_cbranch_vccnz L_st0
L_go0:
v_mfma_f32_16x16x32_bf16 v[8:11], v[104:107], v[24:27], v[8:11]
buffer_load_dwordx4 v[48:51], v236, s[20:23], s62 offen offset:0 sc1
ds_read_b64_tr_b16 v[152:153], v228 offset:24576
v_mfma_f32_16x16x32_bf16 v[12:15], v[108:111], v[24:27], v[12:15]
ds_read_b64_tr_b16 v[154:155], v228 offset:25088
ds_read_b64_tr_b16 v[156:157], v229 offset:24576
v_mfma_f32_16x16x32_bf16 v[16:19], v[112:115], v[24:27], v[16:19]
ds_read_b64_tr_b16 v[158:159], v229 offset:25088
ds_read_b64_tr_b16 v[160:161], v230 offset:24576
v_mfma_f32_16x16x32_bf16 v[20:23], v[116:119], v[24:27], v[20:23]
ds_read_b64_tr_b16 v[162:163], v230 offset:25088
ds_read_b64_tr_b16 v[164:165], v231 offset:24576
v_mfma_f32_16x16x32_bf16 v[8:11], v[120:123], v[28:31], v[8:11]
buffer_load_dwordx4 v[52:55], v227, s[20:23], s62 offen offset:256 sc1
ds_read_b64_tr_b16 v[166:167], v231 offset:25088
v_mfma_f32_16x16x32_bf16 v[12:15], v[124:127], v[28:31], v[12:15]
ds_read_b64_tr_b16 v[168:169], v228 offset:32768
s_waitcnt vmcnt(5)
v_max_u16 v2, v32, v36
v_cmp_eq_u16 vcc, -1, v2
v_mfma_f32_16x16x32_bf16 v[16:19], v[128:131], v[28:31], v[16:19]
ds_read_b64_tr_b16 v[170:171], v228 offset:33280
s_cbranch_vccnz L_st1
L_go1:
v_mfma_f32_16x16x32_bf16 v[20:23], v[132:135], v[28:31], v[20:23]
ds_read_b64_tr_b16 v[172:173], v229 offset:32768
v_mfma_f32_16x16x32_bf16 v[8:11], v[136:139], v[32:35], v[8:11]
buffer_load_dwordx4 v[56:59], v236, s[20:23], s62 offen offset:256 sc1
ds_read_b64_tr_b16 v[174:175], v229 offset:33280
v_mfma_f32_16x16x32_bf16 v[12:15], v[140:143], v[32:35], v[12:15]
ds_read_b64_tr_b16 v[176:177], v230 offset:32768
ds_read_b64_tr_b16 v[178:179], v230 offset:33280
v_mfma_f32_16x16x32_bf16 v[16:19], v[144:147], v[32:35], v[16:19]
ds_read_b64_tr_b16 v[180:181], v231 offset:32768
ds_read_b64_tr_b16 v[182:183], v231 offset:33280
v_mfma_f32_16x16x32_bf16 v[20:23], v[148:151], v[32:35], v[20:23]
v_add_u32 v228, s65, v228
ds_read_b64_tr_b16 v[184:185], v228 offset:0
ds_read_b64_tr_b16 v[186:187], v228 offset:512
s_waitcnt lgkmcnt(10)
v_mfma_f32_16x16x32_bf16 v[8:11], v[152:155], v[36:39], v[8:11]
buffer_load_dwordx4 v[60:63], v227, s[20:23], s62 offen offset:512 sc1
v_add_u32 v229, s65, v229
ds_read_b64_tr_b16 v[188:189], v229 offset:0
v_mfma_f32_16x16x32_bf16 v[12:15], v[156:159], v[36:39], v[12:15]
buffer_load_dwordx4 v[64:67], v236, s[20:23], s62 offen offset:512 sc1
ds_read_b64_tr_b16 v[190:191], v229 offset:512
s_waitcnt vmcnt(7)
v_cmp_eq_u16 vcc, -1, v40
v_mfma_f32_16x16x32_bf16 v[16:19], v[160:163], v[36:39], v[16:19]
v_add_u32 v230, s65, v230
ds_read_b64_tr_b16 v[192:193], v230 offset:0
s_cbranch_vccnz L_st2
L_go2:
v_mfma_f32_16x16x32_bf16 v[20:23], v[164:167], v[36:39], v[20:23]
ds_read_b64_tr_b16 v[194:195], v230 offset:512
s_waitcnt lgkmcnt(6)
v_mfma_f32_16x16x32_bf16 v[8:11], v[168:171], v[40:43], v[8:11]
buffer_load_dwordx4 v[68:71], v227, s[20:23], s62 offen offset:768 sc1
v_add_u32 v231, s65, v231
ds_read_b64_tr_b16 v[196:197], v231 offset:0
v_mfma_f32_16x16x32_bf16 v[12:15], v[172:175], v[40:43], v[12:15]
buffer_load_dwordx4 v[72:75], v236, s[20:23], s62 offen offset:768 sc1
ds_read_b64_tr_b16 v[198:199], v231 offset:512
s_waitcnt vmcnt(6)
v_max_u16 v2, v44, v48
v_cmp_eq_u16 vcc, -1, v2
v_mfma_f32_16x16x32_bf16 v[16:19], v[176:179], v[40:43], v[16:19]
ds_read_b64_tr_b16 v[104:105], v228 offset:8192
s_cbranch_vccnz L_st3
L_go3:
v_mfma_f32_16x16x32_bf16 v[20:23], v[180:183], v[40:43], v[20:23]
ds_read_b64_tr_b16 v[106:107], v228 offset:8704
s_waitcnt lgkmcnt(8)
v_mfma_f32_16x16x32_bf16 v[8:11], v[184:187], v[44:47], v[8:11]
buffer_load_dwordx4 v[76:79], v227, s[20:23], s62 offen offset:1024 sc1
ds_read_b64_tr_b16 v[108:109], v229 offset:8192
v_mfma_f32_16x16x32_bf16 v[200:203], v[184:187], v[48:51], 0
ds_read_b64_tr_b16 v[110:111], v229 offset:8704
ds_read_b64_tr_b16 v[112:113], v230 offset:8192
s_waitcnt lgkmcnt(9)
v_mfma_f32_16x16x32_bf16 v[12:15], v[188:191], v[44:47], v[12:15]
ds_read_b64_tr_b16 v[114:115], v230 offset:8704
ds_read_b64_tr_b16 v[116:117], v231 offset:8192
v_mfma_f32_16x16x32_bf16 v[204:207], v[188:191], v[48:51], 0
ds_read_b64_tr_b16 v[118:119], v231 offset:8704
ds_read_b64_tr_b16 v[120:121], v228 offset:16384
s_waitcnt lgkmcnt(11)
v_mfma_f32_16x16x32_bf16 v[16:19], v[192:195], v[44:47], v[16:19]
buffer_load_dwordx4 v[80:83], v236, s[20:23], s62 offen offset:1024 sc1
ds_read_b64_tr_b16 v[122:123], v228 offset:16896
v_mfma_f32_16x16x32_bf16 v[208:211], v[192:195], v[48:51], 0
ds_read_b64_tr_b16 v[124:125], v229 offset:16384
s_waitcnt vmcnt(6)
v_max_u16 v2, v52, v56
v_cmp_eq_u16 vcc, -1, v2
s_waitcnt lgkmcnt(11)
v_mfma_f32_16x16x32_bf16 v[20:23], v[196:199], v[44:47], v[20:23]
ds_read_b64_tr_b16 v[126:127], v229 offset:16896
s_cbranch_vccnz L_st4
L_go4:
v_mfma_f32_16x16x32_bf16 v[212:215], v[196:199], v[48:51], 0
ds_read_b64_tr_b16 v[128:129], v230 offset:16384
s_waitcnt lgkmcnt(11)
v_mfma_f32_16x16x32_bf16 v[8:11], v[104:107], v[52:55], v[8:11]
buffer_load_dwordx4 v[84:87], v227, s[20:23], s63 offen offset:0 sc1
ds_read_b64_tr_b16 v[130:131], v230 offset:16896
s_waitcnt lgkmcnt(6)
v_mfma_f32_16x16x32_bf16 v[200:203], v[104:107], v[56:59], v[200:203]
ds_read_b64_tr_b16 v[132:133], v231 offset:16384
ds_read_b64_tr_b16 v[134:135], v231 offset:16896
v_mfma_f32_16x16x32_bf16 v[12:15], v[108:111], v[52:55], v[12:15]
ds_read_b64_tr_b16 v[136:137], v228 offset:24576
ds_read_b64_tr_b16 v[138:139], v228 offset:25088
v_mfma_f32_16x16x32_bf16 v[204:207], v[108:111], v[56:59], v[204:207]
ds_read_b64_tr_b16 v[140:141], v229 offset:24576
ds_read_b64_tr_b16 v[142:143], v229 offset:25088
v_mfma_f32_16x16x32_bf16 v[16:19], v[112:115], v[52:55], v[16:19]
buffer_load_dwordx4 v[88:91], v236, s[20:23], s63 offen offset:0 sc1
ds_read_b64_tr_b16 v[144:145], v230 offset:24576
v_mfma_f32_16x16x32_bf16 v[208:211], v[112:115], v[56:59], v[208:211]
ds_read_b64_tr_b16 v[146:147], v230 offset:25088
s_waitcnt vmcnt(6)
v_max_u16 v2, v60, v64
v_cmp_eq_u16 vcc, -1, v2
v_mfma_f32_16x16x32_bf16 v[20:23], v[116:119], v[52:55], v[20:23]
ds_read_b64_tr_b16 v[148:149], v231 offset:24576
s_cbranch_vccnz L_st5
L_go5:
v_mfma_f32_16x16x32_bf16 v[212:215], v[116:119], v[56:59], v[212:215]
ds_read_b64_tr_b16 v[150:151], v231 offset:25088
s_waitcnt lgkmcnt(8)
v_mfma_f32_16x16x32_bf16 v[8:11], v[120:123], v[60:63], v[8:11]
buffer_load_dwordx4 v[92:95], v227, s[20:23], s63 offen offset:256 sc1
ds_read_b64_tr_b16 v[152:153], v228 offset:32768
v_mfma_f32_16x16x32_bf16 v[200:203], v[120:123], v[64:67], v[200:203]
ds_read_b64_tr_b16 v[154:155], v228 offset:33280
ds_read_b64_tr_b16 v[156:157], v229 offset:32768
v_mfma_f32_16x16x32_bf16 v[12:15], v[124:127], v[60:63], v[12:15]
ds_read_b64_tr_b16 v[158:159], v229 offset:33280
ds_read_b64_tr_b16 v[160:161], v230 offset:32768
v_mfma_f32_16x16x32_bf16 v[204:207], v[124:127], v[64:67], v[204:207]
ds_read_b64_tr_b16 v[162:163], v230 offset:33280
ds_read_b64_tr_b16 v[164:165], v231 offset:32768
v_mfma_f32_16x16x32_bf16 v[16:19], v[128:131], v[60:63], v[16:19]
buffer_load_dwordx4 v[96:99], v236, s[20:23], s63 offen offset:256 sc1
ds_read_b64_tr_b16 v[166:167], v231 offset:33280
v_mfma_f32_16x16x32_bf16 v[208:211], v[128:131], v[64:67], v[208:211]
v_add_u32 v228, 40960, v228
ds_read_b64_tr_b16 v[168:169], v228 offset:0
s_waitcnt vmcnt(6)
v_max_u16 v2, v68, v72
v_cmp_eq_u16 vcc, -1, v2
v_mfma_f32_16x16x32_bf16 v[20:23], v[132:135], v[60:63], v[20:23]
ds_read_b64_tr_b16 v[170:171], v228 offset:512
s_cbranch_vccnz L_st6
L_go6:
v_mfma_f32_16x16x32_bf16 v[212:215], v[132:135], v[64:67], v[212:215]
v_add_u32 v229, 40960, v229
ds_read_b64_tr_b16 v[172:173], v229 offset:0
s_waitcnt lgkmcnt(11)
v_mfma_f32_16x16x32_bf16 v[8:11], v[136:139], v[68:71], v[8:11]
buffer_load_dwordx4 v[100:103], v227, s[20:23], s63 offen offset:512 sc1
ds_read_b64_tr_b16 v[174:175], v229 offset:512
v_mfma_f32_16x16x32_bf16 v[200:203], v[136:139], v[72:75], v[200:203]
v_add_u32 v230, 40960, v230
ds_read_b64_tr_b16 v[176:177], v230 offset:0
ds_read_b64_tr_b16 v[178:179], v230 offset:512
v_mfma_f32_16x16x32_bf16 v[12:15], v[140:143], v[68:71], v[12:15]
v_add_u32 v231, 40960, v231
ds_read_b64_tr_b16 v[180:181], v231 offset:0
ds_read_b64_tr_b16 v[182:183], v231 offset:512
v_mfma_f32_16x16x32_bf16 v[204:207], v[140:143], v[72:75], v[204:207]
ds_read_b64_tr_b16 v[184:185], v228 offset:8192
ds_read_b64_tr_b16 v[186:187], v228 offset:8704
v_mfma_f32_16x16x32_bf16 v[16:19], v[144:147], v[68:71], v[16:19]
buffer_load_dwordx4 v[24:27], v236, s[20:23], s63 offen offset:512 sc1
ds_read_b64_tr_b16 v[188:189], v229 offset:8192
v_mfma_f32_16x16x32_bf16 v[208:211], v[144:147], v[72:75], v[208:211]
ds_read_b64_tr_b16 v[190:191], v229 offset:8704
s_waitcnt vmcnt(6)
v_max_u16 v2, v76, v80
v_cmp_eq_u16 vcc, -1, v2
v_mfma_f32_16x16x32_bf16 v[20:23], v[148:151], v[68:71], v[20:23]
ds_read_b64_tr_b16 v[192:193], v230 offset:8192
s_cbranch_vccnz L_st7
L_go7:
v_mfma_f32_16x16x32_bf16 v[212:215], v[148:151], v[72:75], v[212:215]
ds_read_b64_tr_b16 v[194:195], v230 offset:8704
s_waitcnt lgkmcnt(14)
v_mfma_f32_16x16x32_bf16 v[8:11], v[152:155], v[76:79], v[8:11]
buffer_load_dwordx4 v[28:31], v236, s[20:23], s63 offen offset:768 sc1
ds_read_b64_tr_b16 v[196:197], v231 offset:8192
v_mfma_f32_16x16x32_bf16 v[200:203], v[152:155], v[80:83], v[200:203]
ds_read_b64_tr_b16 v[198:199], v231 offset:8704
ds_read_b64_tr_b16 v[104:105], v228 offset:16384
v_mfma_f32_16x16x32_bf16 v[12:15], v[156:159], v[76:79], v[12:15]
ds_read_b64_tr_b16 v[106:107], v228 offset:16896
ds_read_b64_tr_b16 v[108:109], v229 offset:16384
v_mfma_f32_16x16x32_bf16 v[204:207], v[156:159], v[80:83], v[204:207]
ds_read_b64_tr_b16 v[110:111], v229 offset:16896
ds_read_b64_tr_b16 v[112:113], v230 offset:16384
v_mfma_f32_16x16x32_bf16 v[16:19], v[160:163], v[76:79], v[16:19]
buffer_load_dwordx4 v[32:35], v236, s[20:23], s63 offen offset:1024 sc1
ds_read_b64_tr_b16 v[114:115], v230 offset:16896
v_mfma_f32_16x16x32_bf16 v[208:211], v[160:163], v[80:83], v[208:211]
ds_read_b64_tr_b16 v[116:117], v231 offset:16384
s_waitcnt vmcnt(6)
v_max_u16 v2, v84, v88
v_cmp_eq_u16 vcc, -1, v2
v_mfma_f32_16x16x32_bf16 v[20:23], v[164:167], v[76:79], v[20:23]
ds_read_b64_tr_b16 v[118:119], v231 offset:16896
s_cbranch_vccnz L_st8
L_go8:
v_mfma_f32_16x16x32_bf16 v[212:215], v[164:167], v[80:83], v[212:215]
ds_read_b64_tr_b16 v[120:121], v228 offset:24576
s_waitcnt lgkmcnt(15)
v_mfma_f32_16x16x32_bf16 v[8:11], v[168:171], v[84:87], v[8:11]
buffer_load_dwordx4 v[36:39], v227, s[20:23], s63 offen offset:768 sc1
ds_read_b64_tr_b16 v[122:123], v228 offset:25088
v_mfma_f32_16x16x32_bf16 v[200:203], v[168:171], v[88:91], v[200:203]
ds_read_b64_tr_b16 v[124:125], v229 offset:24576
ds_read_b64_tr_b16 v[126:127], v229 offset:25088
v_mfma_f32_16x16x32_bf16 v[12:15], v[172:175], v[84:87], v[12:15]
ds_read_b64_tr_b16 v[128:129], v230 offset:24576
ds_read_b64_tr_b16 v[130:131], v230 offset:25088
v_mfma_f32_16x16x32_bf16 v[204:207], v[172:175], v[88:91], v[204:207]
ds_read_b64_tr_b16 v[132:133], v231 offset:24576
ds_read_b64_tr_b16 v[134:135], v231 offset:25088
v_mfma_f32_16x16x32_bf16 v[16:19], v[176:179], v[84:87], v[16:19]
buffer_load_dwordx4 v[40:43], v227, s[20:23], s63 offen offset:1024 sc1
ds_read_b64_tr_b16 v[136:137], v228 offset:32768
v_mfma_f32_16x16x32_bf16 v[208:211], v[176:179], v[88:91], v[208:211]
ds_read_b64_tr_b16 v[138:139], v228 offset:33280
s_waitcnt vmcnt(6)
v_max_u16 v2, v92, v96
v_cmp_eq_u16 vcc, -1, v2
v_mfma_f32_16x16x32_bf16 v[20:23], v[180:183], v[84:87], v[20:23]
ds_read_b64_tr_b16 v[140:141], v229 offset:32768
s_cbranch_vccnz L_st9
L_go9:
v_mfma_f32_16x16x32_bf16 v[212:215], v[180:183], v[88:91], v[212:215]
ds_read_b64_tr_b16 v[142:143], v229 offset:33280
s_waitcnt lgkmcnt(15)
v_mfma_f32_16x16x32_bf16 v[8:11], v[184:187], v[92:95], v[8:11]
buffer_load_dwordx4 v[44:47], v227, s[20:23], s64 offen offset:0 sc1
ds_read_b64_tr_b16 v[144:145], v230 offset:32768
v_mfma_f32_16x16x32_bf16 v[200:203], v[184:187], v[96:99], v[200:203]
ds_read_b64_tr_b16 v[146:147], v230 offset:33280
ds_read_b64_tr_b16 v[148:149], v231 offset:32768
v_mfma_f32_16x16x32_bf16 v[12:15], v[188:191], v[92:95], v[12:15]
ds_read_b64_tr_b16 v[150:151], v231 offset:33280
v_subrev_u32 v228, s65, v228
ds_read_b64_tr_b16 v[152:153], v228 offset:0
v_mfma_f32_16x16x32_bf16 v[204:207], v[188:191], v[96:99], v[204:207]
ds_read_b64_tr_b16 v[154:155], v228 offset:512
v_subrev_u32 v229, s65, v229
ds_read_b64_tr_b16 v[156:157], v229 offset:0
v_mfma_f32_16x16x32_bf16 v[16:19], v[192:195], v[92:95], v[16:19]
buffer_load_dwordx4 v[48:51], v227, s[20:23], s64 offen offset:256 sc1
ds_read_b64_tr_b16 v[158:159], v229 offset:512
v_mfma_f32_16x16x32_bf16 v[208:211], v[192:195], v[96:99], v[208:211]
v_subrev_u32 v230, s65, v230
ds_read_b64_tr_b16 v[160:161], v230 offset:0
s_waitcnt vmcnt(6)
v_max_u16 v2, v100, v24
v_cmp_eq_u16 vcc, -1, v2
v_mfma_f32_16x16x32_bf16 v[20:23], v[196:199], v[92:95], v[20:23]
ds_read_b64_tr_b16 v[162:163], v230 offset:512
s_cbranch_vccnz L_st10
L_go10:
v_mfma_f32_16x16x32_bf16 v[212:215], v[196:199], v[96:99], v[212:215]
v_subrev_u32 v231, s65, v231
ds_read_b64_tr_b16 v[164:165], v231 offset:0
s_waitcnt lgkmcnt(15)
v_mfma_f32_16x16x32_bf16 v[8:11], v[104:107], v[100:103], v[8:11]
buffer_load_dwordx4 v[52:55], v227, s[20:23], s64 offen offset:512 sc1
ds_read_b64_tr_b16 v[166:167], v231 offset:512
v_mfma_f32_16x16x32_bf16 v[200:203], v[104:107], v[24:27], v[200:203]
ds_read_b64_tr_b16 v[168:169], v228 offset:8192
ds_read_b64_tr_b16 v[170:171], v228 offset:8704
v_mfma_f32_16x16x32_bf16 v[12:15], v[108:111], v[100:103], v[12:15]
ds_read_b64_tr_b16 v[172:173], v229 offset:8192
ds_read_b64_tr_b16 v[174:175], v229 offset:8704
v_mfma_f32_16x16x32_bf16 v[204:207], v[108:111], v[24:27], v[204:207]
ds_read_b64_tr_b16 v[176:177], v230 offset:8192
ds_read_b64_tr_b16 v[178:179], v230 offset:8704
v_mfma_f32_16x16x32_bf16 v[16:19], v[112:115], v[100:103], v[16:19]
buffer_load_dwordx4 v[56:59], v227, s[20:23], s64 offen offset:768 sc1
ds_read_b64_tr_b16 v[180:181], v231 offset:8192
v_mfma_f32_16x16x32_bf16 v[208:211], v[112:115], v[24:27], v[208:211]
ds_read_b64_tr_b16 v[182:183], v231 offset:8704
s_waitcnt vmcnt(6)
v_max_u16 v2, v28, v32
v_cmp_eq_u16 vcc, -1, v2
v_mfma_f32_16x16x32_bf16 v[20:23], v[116:119], v[100:103], v[20:23]
ds_read_b64_tr_b16 v[184:185], v228 offset:16384
s_cbranch_vccnz L_st11
L_go11:
v_mfma_f32_16x16x32_bf16 v[212:215], v[116:119], v[24:27], v[212:215]
ds_read_b64_tr_b16 v[186:187], v228 offset:16896
v_mfma_f32_16x16x32_bf16 v[200:203], v[120:123], v[28:31], v[200:203]
buffer_load_dwordx4 v[60:63], v227, s[20:23], s64 offen offset:1024 sc1
ds_read_b64_tr_b16 v[188:189], v229 offset:16384
v_mfma_f32_16x16x32_bf16 v[204:207], v[124:127], v[28:31], v[204:207]
ds_read_b64_tr_b16 v[190:191], v229 offset:16896
ds_read_b64_tr_b16 v[192:193], v230 offset:16384
v_mfma_f32_16x16x32_bf16 v[208:211], v[128:131], v[28:31], v[208:211]
ds_read_b64_tr_b16 v[194:195], v230 offset:16896
ds_read_b64_tr_b16 v[196:197], v231 offset:16384
v_mfma_f32_16x16x32_bf16 v[212:215], v[132:135], v[28:31], v[212:215]
ds_read_b64_tr_b16 v[198:199], v231 offset:16896
ds_read_b64_tr_b16 v[104:105], v228 offset:24576
s_waitcnt lgkmcnt(15)
v_mfma_f32_16x16x32_bf16 v[200:203], v[136:139], v[32:35], v[200:203]
ds_read_b64_tr_b16 v[106:107], v228 offset:25088
ds_read_b64_tr_b16 v[108:109], v229 offset:24576
v_mfma_f32_16x16x32_bf16 v[204:207], v[140:143], v[32:35], v[204:207]
ds_read_b64_tr_b16 v[110:111], v229 offset:25088
s_waitcnt vmcnt(5)
v_max_u16 v2, v36, v40
v_cmp_eq_u16 vcc, -1, v2
v_mfma_f32_16x16x32_bf16 v[208:211], v[144:147], v[32:35], v[208:211]
ds_read_b64_tr_b16 v[112:113], v230 offset:24576
s_cbranch_vccnz L_st12
L_go12:
v_mfma_f32_16x16x32_bf16 v[212:215], v[148:151], v[32:35], v[212:215]
ds_read_b64_tr_b16 v[114:115], v230 offset:25088
v_mfma_f32_16x16x32_bf16 v[8:11], v[120:123], v[36:39], v[8:11]
ds_read_b64_tr_b16 v[116:117], v231 offset:24576
ds_read_b64_tr_b16 v[118:119], v231 offset:25088
v_mfma_f32_16x16x32_bf16 v[12:15], v[124:127], v[36:39], v[12:15]
ds_write_b128 v237, v[200:203] offset:0
v_mfma_f32_16x16x32_bf16 v[16:19], v[128:131], v[36:39], v[16:19]
ds_write_b128 v237, v[204:207] offset:1024
v_mfma_f32_16x16x32_bf16 v[20:23], v[132:135], v[36:39], v[20:23]
ds_write_b128 v237, v[208:211] offset:2048
v_mfma_f32_16x16x32_bf16 v[8:11], v[136:139], v[40:43], v[8:11]
ds_read_b64_tr_b16 v[120:121], v228 offset:32768
ds_read_b64_tr_b16 v[122:123], v228 offset:33280
v_mfma_f32_16x16x32_bf16 v[12:15], v[140:143], v[40:43], v[12:15]
ds_read_b64_tr_b16 v[124:125], v229 offset:32768
s_waitcnt vmcnt(3)
v_max_u16 v2, v44, v48
v_cmp_eq_u16 vcc, -1, v2
v_mfma_f32_16x16x32_bf16 v[16:19], v[144:147], v[40:43], v[16:19]
ds_write_b128 v237, v[212:215] offset:3072
s_cbranch_vccnz L_st13
L_go13:
v_mfma_f32_16x16x32_bf16 v[20:23], v[148:151], v[40:43], v[20:23]
s_mov_b64 exec, 1
ds_add_u32 v238, v240
s_mov_b64 exec, -1
v_mfma_f32_16x16x32_bf16 v[8:11], v[152:155], v[44:47], v[8:11]
ds_read_b64_tr_b16 v[126:127], v229 offset:33280
ds_read_b64_tr_b16 v[128:129], v230 offset:32768
v_mfma_f32_16x16x32_bf16 v[12:15], v[156:159], v[44:47], v[12:15]
ds_read_b64_tr_b16 v[130:131], v230 offset:33280
ds_read_b64_tr_b16 v[132:133], v231 offset:32768
v_mfma_f32_16x16x32_bf16 v[16:19], v[160:163], v[44:47], v[16:19]
ds_read_b64_tr_b16 v[134:135], v231 offset:33280
v_mfma_f32_16x16x32_bf16 v[20:23], v[164:167], v[44:47], v[20:23]
s_waitcnt lgkmcnt(15)
v_mfma_f32_16x16x32_bf16 v[8:11], v[168:171], v[48:51], v[8:11]
v_mfma_f32_16x16x32_bf16 v[12:15], v[172:175], v[48:51], v[12:15]
s_waitcnt vmcnt(1)
v_max_u16 v2, v52, v56
v_cmp_eq_u16 vcc, -1, v2
v_mfma_f32_16x16x32_bf16 v[16:19], v[176:179], v[48:51], v[16:19]
s_cbranch_vccnz L_st14
L_go14:
v_mfma_f32_16x16x32_bf16 v[20:23], v[180:183], v[48:51], v[20:23]
v_mfma_f32_16x16x32_bf16 v[8:11], v[184:187], v[52:55], v[8:11]
v_mfma_f32_16x16x32_bf16 v[12:15], v[188:191], v[52:55], v[12:15]
v_mfma_f32_16x16x32_bf16 v[16:19], v[192:195], v[52:55], v[16:19]
v_mfma_f32_16x16x32_bf16 v[20:23], v[196:199], v[52:55], v[20:23]
s_waitcnt lgkmcnt(13)
v_mfma_f32_16x16x32_bf16 v[8:11], v[104:107], v[56:59], v[8:11]
v_mfma_f32_16x16x32_bf16 v[12:15], v[108:111], v[56:59], v[12:15]
s_waitcnt vmcnt(0)
v_cmp_eq_u16 vcc, -1, v60
v_mfma_f32_16x16x32_bf16 v[16:19], v[112:115], v[56:59], v[16:19]
s_cbranch_vccnz L_st15
L_go15:
v_mfma_f32_16x16x32_bf16 v[20:23], v[116:119], v[56:59], v[20:23]
s_waitcnt lgkmcnt(8)
v_mfma_f32_16x16x32_bf16 v[8:11], v[120:123], v[60:63], v[8:11]
s_waitcnt lgkmcnt(4)
v_mfma_f32_16x16x32_bf16 v[12:15], v[124:127], v[60:63], v[12:15]
s_waitcnt lgkmcnt(2)
v_mfma_f32_16x16x32_bf16 v[16:19], v[128:131], v[60:63], v[16:19]
s_waitcnt lgkmcnt(0)
v_mfma_f32_16x16x32_bf16 v[20:23], v[132:135], v[60:63], v[20:23]
L_tail:
s_nop 1
v_cvt_pk_bf16_f32 v24, v8, v9
v_cvt_pk_bf16_f32 v25, v10, v11
v_cvt_pk_bf16_f32 v26, v12, v13
v_cvt_pk_bf16_f32 v27, v14, v15
v_cvt_pk_bf16_f32 v28, v16, v17
v_cvt_pk_bf16_f32 v29, v18, v19
v_cvt_pk_bf16_f32 v30, v20, v21
v_cvt_pk_bf16_f32 v31, v22, v23
v_mfma_f32_16x16x32_bf16 v[36:39], v[24:27], v[24:27], 0
v_mfma_f32_16x16x32_bf16 v[32:35], v[244:247], v[24:27], 0
v_mfma_f32_16x16x32_bf16 v[36:39], v[28:31], v[28:31], v[36:39]
v_mfma_f32_16x16x32_bf16 v[32:35], v[248:251], v[28:31], v[32:35]
s_mov_b32 s0, 0x22222222
s_mov_b32 s1, s0
s_mov_b32 s44, 0x44444444
s_mov_b32 s45, s44
s_mov_b32 vcc_lo, 0x88888888
s_mov_b32 vcc_hi, 0x88888888
s_lshl_b32 s3, s36, 8
s_add_u32 s3, s3, s58
v_and_b32 v1, 0xf0, v233
v_cndmask_b32 v36, v36, v37, s[0:1]
v_cndmask_b32 v38, v38, v39, vcc
s_or_b64 vcc, vcc, s[44:45]
v_cndmask_b32 v34, v36, v38, vcc
v_mov_b32 v35, v253
s_mov_b32 exec_lo, 0xf0000f
s_mov_b32 exec_hi, 0xf0000f00
s_cmp_eq_u32 s41, 1
s_cbranch_scc0 L_gl_9g
buffer_store_dwordx4 v[32:35], v1, s[16:19], s3 offen
L_gl_9b:
s_mov_b64 exec, -1
v_mov_b32 v48, 0
v_mov_b32 v49, 0
v_mov_b32 v50, 0
v_mov_b32 v51, 0
v_mov_b32 v4, 1.0
s_mov_b32 s0, 0xbacccccd
s_mov_b32 s1, 0x3acccccd
v_mov_b32 v5, 0x3727c5ac
s_mov_b32 s44, 0xfffff800
v_mov_b32 v1, 1732
v_cmp_le_i32 s[46:47], 0, v232
s_mul_i32 s48, s35, 1280
s_lshl_b32 s3, s36, 7
s_add_u32 s48, s48, s3
s_lshl_b32 s49, s48, 1
s_add_u32 s48, s48, s59
s_add_u32 s49, s49, s59
s_add_u32 s49, s49, 4096
s_lshl_b32 s3, s35, 7
s_add_u32 s3, s3, s59
s_add_u32 s3, s3, 21504
s_and_b32 s45, s36, 15
s_lshl_b32 s45, s45, 3
s_add_u32 s45, s45, s32
v_mul_u32_u24 v70, 384, v0
v_and_b32 v69, 48, v0
v_lshlrev_b32 v68, 1, v69
s_add_u32 s45, s36, 5
v_mov_b32 v71, 1
L_e2:
buffer_load_dwordx4 v[40:43], v233, s[16:19], s58 offen sc1
buffer_load_dwordx4 v[44:47], v233, s[16:19], s58 offen offset:1024 sc1
s_mov_b32 exec_hi, 0
buffer_load_dwordx4 v[48:51], v233, s[16:19], s58 offen offset:2048 sc1
s_mov_b32 exec_hi, -1
s_sub_u32 s40, s40, 1
s_waitcnt vmcnt(1)
v_pk_add_f32 v[40:41], v[40:41], v[44:45]
v_pk_add_f32 v[42:43], v[42:43], v[46:47]
s_waitcnt vmcnt(0)
v_pk_add_f32 v[40:41], v[40:41], v[48:49]
v_pk_add_f32 v[42:43], v[42:43], v[50:51]
v_cmp_u_f32 vcc, v40, v40
s_cbranch_scc1 L_e2go
s_cbranch_vccnz L_e2
L_e2go:
v_mfma_f32_16x16x4_f32 v[52:55], v4, v40, 0
v_mfma_f32_16x16x4_f32 v[60:63], v4, v42, 0
v_mfma_f32_16x16x4_f32 v[64:67], v4, v43, 0
v_mfma_f32_16x16x4_f32 v[56:59], v4, v41, 0
s_nop 6
v_mul_f32 v6, s0, v52
v_fma_f32 v7, v60, s1, v5
v_fma_f32 v7, -v6, v6, v7
v_max_f32 v7, v7, v5
v_rsq_f32 v2, v7
v_fma_f32 v7, v6, v64, v56
v_mul_f32 v7, v7, v2
v_mul_f32 v3, v6, v2
v_ashrrev_i32 v6, 31, v7
v_or_b32 v6, 0x80000000, v6
v_xor_b32 v7, v7, v6
v_and_or_b32 v7, v7, s44, v234
v_cndmask_b32 v7, 0, v7, s[46:47]
v_pk_fma_f32 v[72:73], v[8:9], v[2:3], v[2:3] op_sel:[0,0,1] op_sel_hi:[1,0,1]
v_pk_fma_f32 v[74:75], v[10:11], v[2:3], v[2:3] op_sel:[0,0,1] op_sel_hi:[1,0,1]
v_max_u32_dpp v6, v7, v7 row_ror:8 row_mask:0xf bank_mask:0xf
s_mov_b64 exec, 255
ds_max_u32 v1, v6
s_mov_b64 exec, 1
ds_add_rtn_u32 v71, v1, v71 offset:4
s_mov_b64 exec, -1
ds_read_b32 v6, v1
v_pk_fma_f32 v[76:77], v[12:13], v[2:3], v[2:3] op_sel:[0,0,1] op_sel_hi:[1,0,1]
v_pk_fma_f32 v[78:79], v[14:15], v[2:3], v[2:3] op_sel:[0,0,1] op_sel_hi:[1,0,1]
v_pk_fma_f32 v[80:81], v[16:17], v[2:3], v[2:3] op_sel:[0,0,1] op_sel_hi:[1,0,1]
v_pk_fma_f32 v[82:83], v[18:19], v[2:3], v[2:3] op_sel:[0,0,1] op_sel_hi:[1,0,1]
v_pk_fma_f32 v[84:85], v[20:21], v[2:3], v[2:3] op_sel:[0,0,1] op_sel_hi:[1,0,1]
v_pk_fma_f32 v[86:87], v[22:23], v[2:3], v[2:3] op_sel:[0,0,1] op_sel_hi:[1,0,1]
v_cvt_pk_bf16_f32 v88, v72, v73
v_cvt_pk_bf16_f32 v89, v74, v75
v_cvt_pk_bf16_f32 v90, v76, v77
v_cvt_pk_bf16_f32 v91, v78, v79
s_waitcnt lgkmcnt(0)
v_readfirstlane_b32 s0, v71
s_cmp_eq_u32 s0, s45
s_cbranch_scc0 L_nk
s_mov_b64 exec, 0xffff
buffer_store_dword v6, v70, s[16:19], s3 offen sc1
s_mov_b64 exec, -1
L_nk:
s_barrier
ds_read_b32 v1, v1
v_cvt_pk_bf16_f32 v92, v80, v81
v_cvt_pk_bf16_f32 v93, v82, v83
v_cvt_pk_bf16_f32 v94, v84, v85
v_cvt_pk_bf16_f32 v95, v86, v87
v_pk_add_f32 v[72:73], v[72:73], v[8:9]
v_pk_add_f32 v[74:75], v[74:75], v[10:11]
v_pk_add_f32 v[76:77], v[76:77], v[12:13]
v_pk_add_f32 v[78:79], v[78:79], v[14:15]
v_pk_add_f32 v[80:81], v[80:81], v[16:17]
v_pk_add_f32 v[82:83], v[82:83], v[18:19]
v_pk_add_f32 v[84:85], v[84:85], v[20:21]
v_pk_add_f32 v[86:87], v[86:87], v[22:23]
s_waitcnt lgkmcnt(0)
v_cmp_eq_u32 s[46:47], v1, v7
s_and_b64 exec, s[46:47], -1
s_cbranch_scc0 L_nc
buffer_store_dwordx4 v[88:91], v68, s[16:19], s48 offen sc1
buffer_store_dwordx4 v[92:95], v68, s[16:19], s48 offen offset:16 sc1
L_nc:
s_mov_b64 exec, -1
v_cvt_pk_bf16_f32 v96, v72, v73
v_cvt_pk_bf16_f32 v97, v74, v75
v_cvt_pk_bf16_f32 v98, v76, v77
v_cvt_pk_bf16_f32 v99, v78, v79
v_cvt_pk_bf16_f32 v100, v80, v81
v_cvt_pk_bf16_f32 v101, v82, v83
v_cvt_pk_bf16_f32 v102, v84, v85
v_cvt_pk_bf16_f32 v103, v86, v87
v_permlane16_swap_b32 v96, v98
v_permlane16_swap_b32 v97, v99
v_permlane16_swap_b32 v100, v102
v_permlane16_swap_b32 v101, v103
s_not_b64 exec, s[46:47]
buffer_store_dwordx4 v[96:99], v232, s[20:23], 0 offen offset:0
buffer_store_dwordx4 v[100:103], v232, s[20:23], 0 offen offset:64
s_and_b64 exec, s[46:47], -1
s_cbranch_scc0 L_fin
buffer_store_dwordx4 v[96:99], v232, s[20:23], 0 offen offset:0 sc1
buffer_store_dwordx4 v[100:103], v232, s[20:23], 0 offen offset:64 sc1
s_waitcnt vmcnt(0)
buffer_store_dwordx4 v[72:75], v69, s[16:19], s49 offen offset:0 sc1
buffer_store_dwordx4 v[76:79], v69, s[16:19], s49 offen offset:64 sc1
buffer_store_dwordx4 v[80:83], v69, s[16:19], s49 offen offset:128 sc1
buffer_store_dwordx4 v[84:87], v69, s[16:19], s49 offen offset:192 sc1
L_fin:
s_endpgm
.p2align 12
L_pb_10:
L_pad_11:
s_setpc_b64 s[100:101]
L_era:
s_sub_u32 s40, s40, 1
s_cbranch_scc1 L_exa
s_lshl_b32 s0, s33, 5
v_and_b32 v1, 16, v0
buffer_load_dword v32, v1, s[24:27], s0 offen sc1
s_waitcnt vmcnt(0)
s_waitcnt lgkmcnt(0)
v_cmp_ne_u32 vcc, 1, v32
s_cmp_eq_u64 vcc, 0
s_cbranch_scc0 L_era
s_branch L_ega
L_exa:
s_mov_b32 s40, 0
s_branch L_ega
L_erb:
s_sub_u32 s40, s40, 1
s_cbranch_scc1 L_exb
s_buffer_load_dword s71, s[16:19], s66 offset:0 glc
s_buffer_load_dword s73, s[16:19], s66 offset:128 glc
s_buffer_load_dword s75, s[16:19], s66 offset:256 glc
s_buffer_load_dword s77, s[16:19], s66 offset:384 glc
s_buffer_load_dword s83, s[16:19], s66 offset:512 glc
s_buffer_load_dword s85, s[16:19], s66 offset:640 glc
s_buffer_load_dword s89, s[16:19], s66 offset:768 glc
s_buffer_load_dword s91, s[16:19], s66 offset:896 glc
s_buffer_load_dword s93, s[16:19], s66 offset:1024 glc
s_buffer_load_dword s95, s[16:19], s66 offset:1152 glc
s_waitcnt lgkmcnt(0)
s_max_u32 s0, s71, s73
s_max_u32 s0, s0, s75
s_max_u32 s0, s0, s77
s_max_u32 s0, s0, s83
s_max_u32 s0, s0, s85
s_max_u32 s0, s0, s89
s_max_u32 s0, s0, s91
s_max_u32 s0, s0, s93
s_max_u32 s0, s0, s95
s_cmp_lg_u32 s0, -1
s_cbranch_scc0 L_erb
s_branch L_egb
L_exb:
s_mov_b32 s40, 0
s_branch L_egb
L_gh_3g:
s_barrier
s_cmp_eq_u32 s32, 5
s_cbranch_scc0 L_gh_3e
v_mov_b32 v1, 1
s_mov_b64 exec, 1
buffer_store_dword v1, off, s[16:19], s68 offset:64 sc1
s_mov_b64 exec, -1
L_gh_3p:
buffer_load_dword v1, v55, s[16:19], 0 offen offset:64 sc1
s_waitcnt vmcnt(0)
v_cmp_ne_u32 vcc, 1, v1
s_cbranch_vccz L_gh_3e
s_sub_u32 s40, s40, 1
s_cbranch_scc0 L_gh_3p
s_mov_b32 s40, 0
L_gh_3e:
s_barrier
s_branch L_gh_3b
L_xcap:
v_add_u32 v1, s0, v235
ds_read_b64 v[72:73], v1
v_xor_b32 v2, 32, v1
ds_read_b64 v[74:75], v2
v_xor_b32 v3, 64, v1
ds_read_b64 v[76:77], v3
v_xor_b32 v4, 96, v1
ds_read_b64 v[78:79], v4
s_setpc_b64 s[100:101]
L_woe1:
s_addk_i32 m0, 4096
s_mov_b32 s3, 0
buffer_load_dwordx4 v57, s[12:15], s3 offen lds
s_addk_i32 m0, 4096
s_mov_b32 s3, 81920
buffer_load_dwordx4 v57, s[12:15], s3 offen lds
s_addk_i32 m0, 4096
s_mov_b32 s3, 163840
buffer_load_dwordx4 v58, s[12:15], s3 offen lds
s_addk_i32 m0, 4096
s_mov_b32 s3, 245760
buffer_load_dwordx4 v60, s[12:15], s3 offen lds
s_addk_i32 m0, 4096
s_mov_b32 s3, 327680
buffer_load_dwordx4 v60, s[12:15], s3 offen lds
s_addk_i32 m0, 4096
s_mov_b32 s3, 409600
buffer_load_dwordx4 v57, s[12:15], s3 offen lds
s_addk_i32 m0, 4096
s_mov_b32 s3, 491520
buffer_load_dwordx4 v57, s[12:15], s3 offen lds
s_addk_i32 m0, 4096
s_mov_b32 s3, 573440
buffer_load_dwordx4 v58, s[12:15], s3 offen lds
s_addk_i32 m0, 4096
s_mov_b32 s3, 655360
buffer_load_dwordx4 v60, s[12:15], s3 offen lds
s_addk_i32 m0, 4096
s_mov_b32 s3, 737280
buffer_load_dwordx4 v60, s[12:15], s3 offen lds
s_branch L_woe
L_woe2:
s_addk_i32 m0, 4096
s_mov_b32 s3, 5120
buffer_load_dwordx4 v57, s[12:15], s3 offen lds
s_addk_i32 m0, 4096
s_mov_b32 s3, 87040
buffer_load_dwordx4 v58, s[12:15], s3 offen lds
s_addk_i32 m0, 4096
s_mov_b32 s3, 168960
buffer_load_dwordx4 v58, s[12:15], s3 offen lds
s_addk_i32 m0, 4096
s_mov_b32 s3, 250880
buffer_load_dwordx4 v60, s[12:15], s3 offen lds
s_addk_i32 m0, 4096
s_mov_b32 s3, 384000
buffer_load_dwordx4 v59, s[12:15], s3 offen lds
s_addk_i32 m0, 4096
s_mov_b32 s3, 414720
buffer_load_dwordx4 v57, s[12:15], s3 offen lds
s_addk_i32 m0, 4096
s_mov_b32 s3, 496640
buffer_load_dwordx4 v58, s[12:15], s3 offen lds
s_addk_i32 m0, 4096
s_mov_b32 s3, 578560
buffer_load_dwordx4 v58, s[12:15], s3 offen lds
s_addk_i32 m0, 4096
s_mov_b32 s3, 660480
buffer_load_dwordx4 v60, s[12:15], s3 offen lds
s_addk_i32 m0, 4096
s_mov_b32 s3, 793600
buffer_load_dwordx4 v59, s[12:15], s3 offen lds
s_branch L_woe
L_pad_12:
s_setpc_b64 s[100:101]
L_woe3:
s_addk_i32 m0, 4096
s_mov_b32 s3, 10240
buffer_load_dwordx4 v58, s[12:15], s3 offen lds
s_addk_i32 m0, 4096
s_mov_b32 s3, 92160
buffer_load_dwordx4 v58, s[12:15], s3 offen lds
s_addk_i32 m0, 4096
s_mov_b32 s3, 174080
buffer_load_dwordx4 v58, s[12:15], s3 offen lds
s_addk_i32 m0, 4096
s_mov_b32 s3, 307200
buffer_load_dwordx4 v59, s[12:15], s3 offen lds
s_addk_i32 m0, 4096
s_mov_b32 s3, 389120
buffer_load_dwordx4 v59, s[12:15], s3 offen lds
s_addk_i32 m0, 4096
s_mov_b32 s3, 419840
buffer_load_dwordx4 v58, s[12:15], s3 offen lds
s_addk_i32 m0, 4096
s_mov_b32 s3, 501760
buffer_load_dwordx4 v58, s[12:15], s3 offen lds
s_addk_i32 m0, 4096
s_mov_b32 s3, 583680
buffer_load_dwordx4 v58, s[12:15], s3 offen lds
s_addk_i32 m0, 4096
s_mov_b32 s3, 716800
buffer_load_dwordx4 v59, s[12:15], s3 offen lds
s_addk_i32 m0, 4096
s_mov_b32 s3, 798720
buffer_load_dwordx4 v59, s[12:15], s3 offen lds
s_branch L_woe
L_gl_4g:
buffer_store_dwordx4 v[192:195], v224, s[20:23], s54 offen sc1
s_branch L_gl_4b
L_gl_5g:
buffer_store_dwordx4 v[196:199], v226, s[20:23], 0 offen sc1
s_branch L_gl_5b
L_h0rh:
s_sub_u32 s40, s40, 1
s_cbranch_scc1 L_h0xh
buffer_load_dwordx4 v[92:95], v225, s[20:23], s54 offen sc1
s_waitcnt vmcnt(0)
v_cmp_eq_u32 vcc, -1, v92
s_cbranch_vccnz L_h0rh
s_branch L_h0gh
L_h0xh:
s_mov_b32 s40, 0
s_branch L_h0gh
L_gl_6g:
buffer_store_dwordx4 v[80:83], v226, s[20:23], s54 offen sc1
s_branch L_gl_6b
L_spw:
v_mov_b32 v1, 1744
ds_read_b32 v1, v1
s_waitcnt lgkmcnt(0)
v_cmp_ne_u32 vcc, 4, v1
s_cbranch_vccnz L_spw
s_branch L_sbw
L_st0:
s_sub_u32 s40, s40, 1
s_cbranch_scc1 L_sx0
buffer_load_dwordx4 v[24:27], v227, s[20:23], s61 offen offset:0 sc1
buffer_load_dwordx4 v[28:31], v227, s[20:23], s61 offen offset:256 sc1
s_waitcnt vmcnt(0)
v_max_u16 v2, v24, v28
v_cmp_eq_u16 vcc, -1, v2
s_cbranch_vccnz L_st0
s_branch L_go0
L_sx0:
s_mov_b32 s40, 0
s_branch L_go0
L_st1:
s_sub_u32 s40, s40, 1
s_cbranch_scc1 L_sx1
buffer_load_dwordx4 v[32:35], v227, s[20:23], s61 offen offset:512 sc1
buffer_load_dwordx4 v[36:39], v227, s[20:23], s61 offen offset:768 sc1
s_waitcnt vmcnt(0)
v_max_u16 v2, v32, v36
v_cmp_eq_u16 vcc, -1, v2
s_cbranch_vccnz L_st1
s_branch L_go1
L_sx1:
s_mov_b32 s40, 0
s_branch L_go1
L_st2:
s_sub_u32 s40, s40, 1
s_cbranch_scc1 L_sx2
buffer_load_dwordx4 v[40:43], v227, s[20:23], s61 offen offset:1024 sc1
s_waitcnt vmcnt(0)
v_cmp_eq_u16 vcc, -1, v40
s_cbranch_vccnz L_st2
s_branch L_go2
L_sx2:
s_mov_b32 s40, 0
s_branch L_go2
L_st3:
s_sub_u32 s40, s40, 1
s_cbranch_scc1 L_sx3
buffer_load_dwordx4 v[44:47], v227, s[20:23], s62 offen offset:0 sc1
buffer_load_dwordx4 v[48:51], v236, s[20:23], s62 offen offset:0 sc1
s_waitcnt vmcnt(0)
v_max_u16 v2, v44, v48
v_cmp_eq_u16 vcc, -1, v2
s_cbranch_vccnz L_st3
s_branch L_go3
L_sx3:
s_mov_b32 s40, 0
s_branch L_go3
L_st4:
s_sub_u32 s40, s40, 1
s_cbranch_scc1 L_sx4
buffer_load_dwordx4 v[52:55], v227, s[20:23], s62 offen offset:256 sc1
buffer_load_dwordx4 v[56:59], v236, s[20:23], s62 offen offset:256 sc1
s_waitcnt vmcnt(0)
v_max_u16 v2, v52, v56
v_cmp_eq_u16 vcc, -1, v2
s_cbranch_vccnz L_st4
s_branch L_go4
L_sx4:
s_mov_b32 s40, 0
s_branch L_go4
L_pad_13:
s_setpc_b64 s[100:101]
L_st5:
s_sub_u32 s40, s40, 1
s_cbranch_scc1 L_sx5
buffer_load_dwordx4 v[60:63], v227, s[20:23], s62 offen offset:512 sc1
buffer_load_dwordx4 v[64:67], v236, s[20:23], s62 offen offset:512 sc1
s_waitcnt vmcnt(0)
v_max_u16 v2, v60, v64
v_cmp_eq_u16 vcc, -1, v2
s_cbranch_vccnz L_st5
s_branch L_go5
L_sx5:
s_mov_b32 s40, 0
s_branch L_go5
L_st6:
s_sub_u32 s40, s40, 1
s_cbranch_scc1 L_sx6
buffer_load_dwordx4 v[68:71], v227, s[20:23], s62 offen offset:768 sc1
buffer_load_dwordx4 v[72:75], v236, s[20:23], s62 offen offset:768 sc1
s_waitcnt vmcnt(0)
v_max_u16 v2, v68, v72
v_cmp_eq_u16 vcc, -1, v2
s_cbranch_vccnz L_st6
s_branch L_go6
L_sx6:
s_mov_b32 s40, 0
s_branch L_go6
L_st7:
s_sub_u32 s40, s40, 1
s_cbranch_scc1 L_sx7
buffer_load_dwordx4 v[76:79], v227, s[20:23], s62 offen offset:1024 sc1
buffer_load_dwordx4 v[80:83], v236, s[20:23], s62 offen offset:1024 sc1
s_waitcnt vmcnt(0)
v_max_u16 v2, v76, v80
v_cmp_eq_u16 vcc, -1, v2
s_cbranch_vccnz L_st7
s_branch L_go7
L_sx7:
s_mov_b32 s40, 0
s_branch L_go7
L_st8:
s_sub_u32 s40, s40, 1
s_cbranch_scc1 L_sx8
buffer_load_dwordx4 v[84:87], v227, s[20:23], s63 offen offset:0 sc1
buffer_load_dwordx4 v[88:91], v236, s[20:23], s63 offen offset:0 sc1
s_waitcnt vmcnt(0)
v_max_u16 v2, v84, v88
v_cmp_eq_u16 vcc, -1, v2
s_cbranch_vccnz L_st8
s_branch L_go8
L_sx8:
s_mov_b32 s40, 0
s_branch L_go8
L_st9:
s_sub_u32 s40, s40, 1
s_cbranch_scc1 L_sx9
buffer_load_dwordx4 v[92:95], v227, s[20:23], s63 offen offset:256 sc1
buffer_load_dwordx4 v[96:99], v236, s[20:23], s63 offen offset:256 sc1
s_waitcnt vmcnt(0)
v_max_u16 v2, v92, v96
v_cmp_eq_u16 vcc, -1, v2
s_cbranch_vccnz L_st9
s_branch L_go9
L_sx9:
s_mov_b32 s40, 0
s_branch L_go9
L_st10:
s_sub_u32 s40, s40, 1
s_cbranch_scc1 L_sx10
buffer_load_dwordx4 v[100:103], v227, s[20:23], s63 offen offset:512 sc1
buffer_load_dwordx4 v[24:27], v236, s[20:23], s63 offen offset:512 sc1
s_waitcnt vmcnt(0)
v_max_u16 v2, v100, v24
v_cmp_eq_u16 vcc, -1, v2
s_cbranch_vccnz L_st10
s_branch L_go10
L_sx10:
s_mov_b32 s40, 0
s_branch L_go10
L_st11:
s_sub_u32 s40, s40, 1
s_cbranch_scc1 L_sx11
buffer_load_dwordx4 v[28:31], v236, s[20:23], s63 offen offset:768 sc1
buffer_load_dwordx4 v[32:35], v236, s[20:23], s63 offen offset:1024 sc1
s_waitcnt vmcnt(0)
v_max_u16 v2, v28, v32
v_cmp_eq_u16 vcc, -1, v2
s_cbranch_vccnz L_st11
s_branch L_go11
L_sx11:
s_mov_b32 s40, 0
s_branch L_go11
L_st12:
s_sub_u32 s40, s40, 1
s_cbranch_scc1 L_sx12
buffer_load_dwordx4 v[36:39], v227, s[20:23], s63 offen offset:768 sc1
buffer_load_dwordx4 v[40:43], v227, s[20:23], s63 offen offset:1024 sc1
s_waitcnt vmcnt(0)
v_max_u16 v2, v36, v40
v_cmp_eq_u16 vcc, -1, v2
s_cbranch_vccnz L_st12
s_branch L_go12
L_sx12:
s_mov_b32 s40, 0
s_branch L_go12
L_st13:
s_sub_u32 s40, s40, 1
s_cbranch_scc1 L_sx13
buffer_load_dwordx4 v[44:47], v227, s[20:23], s64 offen offset:0 sc1
buffer_load_dwordx4 v[48:51], v227, s[20:23], s64 offen offset:256 sc1
s_waitcnt vmcnt(0)
v_max_u16 v2, v44, v48
v_cmp_eq_u16 vcc, -1, v2
s_cbranch_vccnz L_st13
s_branch L_go13
L_sx13:
s_mov_b32 s40, 0
s_branch L_go13
L_pad_14:
s_setpc_b64 s[100:101]
L_st14:
s_sub_u32 s40, s40, 1
s_cbranch_scc1 L_sx14
buffer_load_dwordx4 v[52:55], v227, s[20:23], s64 offen offset:512 sc1
buffer_load_dwordx4 v[56:59], v227, s[20:23], s64 offen offset:768 sc1
s_waitcnt vmcnt(0)
v_max_u16 v2, v52, v56
v_cmp_eq_u16 vcc, -1, v2
s_cbranch_vccnz L_st14
s_branch L_go14
L_sx14:
s_mov_b32 s40, 0
s_branch L_go14
L_st15:
s_sub_u32 s40, s40, 1
s_cbranch_scc1 L_sx15
buffer_load_dwordx4 v[60:63], v227, s[20:23], s64 offen offset:1024 sc1
s_waitcnt vmcnt(0)
v_cmp_eq_u16 vcc, -1, v60
s_cbranch_vccnz L_st15
s_branch L_go15
L_sx15:
s_mov_b32 s40, 0
s_branch L_go15
L_gl_9g:
buffer_store_dwordx4 v[32:35], v1, s[16:19], s3 offen sc1
s_branch L_gl_9b
L_pad_15:
s_setpc_b64 s[100:101]
L_h0:
s_setprio 2
v_lshrrev_b32 v1, 3, v0
v_and_b32 v2, 2, v1
v_xor_b32 v2, v2, v0
v_and_b32 v2, 7, v2
s_lshl_b32 s3, s36, 7
v_lshl_add_u32 v2, v2, 4, s3
v_mul_u32_u24 v3, 3840, v1
v_add_u32 v24, v3, v2
v_xor_b32 v27, 64, v24
v_add_u32 v27, 30720, v27
v_mov_b32 v55, 0
v_add_u32 v25, 256, v24
v_add_u32 v26, 512, v24
v_add_u32 v28, 256, v27
v_add_u32 v29, 512, v27
v_lshrrev_b32 v1, 4, v0
v_lshlrev_b32 v1, 3, v1
s_lshl_b32 s3, s36, 7
buffer_load_dwordx2 v[244:245], v1, s[28:31], s3 offen offset:0
buffer_load_dwordx2 v[246:247], v1, s[28:31], s3 offen offset:32
buffer_load_dwordx2 v[248:249], v1, s[28:31], s3 offen offset:64
buffer_load_dwordx2 v[250:251], v1, s[28:31], s3 offen offset:96
s_waitcnt vmcnt(4)
s_barrier
s_mov_b32 s42, 1
s_mov_b32 s65, 45056
L_wl:
s_add_u32 s69, s69, 1
s_cmp_eq_u32 s69, 10
s_cselect_b32 s69, 0, s69
s_add_u32 s61, s61, 36864
s_cmp_eq_u32 s61, 155648
s_cselect_b32 s61, 8192, s61
s_mul_i32 s63, s69, 245760
s_add_u32 m0, s61, 12288
s_nop 0
buffer_load_dwordx4 v24, s[8:11], s63 offen offset:0 lds
buffer_load_dwordx4 v25, s[8:11], s63 offen offset:1024 lds
buffer_load_dwordx4 v26, s[8:11], s63 offen offset:2048 lds
s_addk_i32 m0, 3072
s_nop 0
buffer_load_dwordx4 v27, s[8:11], s63 offen offset:0 lds
buffer_load_dwordx4 v28, s[8:11], s63 offen offset:1024 lds
buffer_load_dwordx4 v29, s[8:11], s63 offen offset:2048 lds
s_addk_i32 m0, 3072
s_add_u32 s63, s63, 61440
buffer_load_dwordx4 v24, s[8:11], s63 offen offset:0 lds
buffer_load_dwordx4 v25, s[8:11], s63 offen offset:1024 lds
buffer_load_dwordx4 v26, s[8:11], s63 offen offset:2048 lds
s_addk_i32 m0, 3072
s_nop 0
buffer_load_dwordx4 v27, s[8:11], s63 offen offset:0 lds
buffer_load_dwordx4 v28, s[8:11], s63 offen offset:1024 lds
buffer_load_dwordx4 v29, s[8:11], s63 offen offset:2048 lds
s_addk_i32 m0, 3072
s_add_u32 s63, s63, 61440
buffer_load_dwordx4 v24, s[8:11], s63 offen offset:0 lds
buffer_load_dwordx4 v25, s[8:11], s63 offen offset:1024 lds
buffer_load_dwordx4 v26, s[8:11], s63 offen offset:2048 lds
s_addk_i32 m0, 3072
s_nop 0
buffer_load_dwordx4 v27, s[8:11], s63 offen offset:0 lds
buffer_load_dwordx4 v28, s[8:11], s63 offen offset:1024 lds
buffer_load_dwordx4 v29, s[8:11], s63 offen offset:2048 lds
s_addk_i32 m0, 3072
s_add_u32 s63, s63, 61440
buffer_load_dwordx4 v24, s[8:11], s63 offen offset:0 lds
buffer_load_dwordx4 v25, s[8:11], s63 offen offset:1024 lds
buffer_load_dwordx4 v26, s[8:11], s63 offen offset:2048 lds
s_addk_i32 m0, 3072
s_nop 0
buffer_load_dwordx4 v27, s[8:11], s63 offen offset:0 lds
buffer_load_dwordx4 v28, s[8:11], s63 offen offset:1024 lds
buffer_load_dwordx4 v29, s[8:11], s63 offen offset:2048 lds
s_mov_b32 s0, s65
s_mov_b32 s65, s61
s_cmp_eq_u32 s57, s42
s_waitcnt vmcnt(24) lgkmcnt(0)
s_barrier
s_cbranch_scc0 L_wc
s_call_b64 s[100:101], L_xcap
L_wc:
s_add_u32 s42, s42, 1
s_cmp_lt_u32 s42, 9
s_cbranch_scc1 L_wl
s_branch L_h8
L_pad_21:
s_setpc_b64 s[100:101]
L_c23:
ds_read_b64 v[96:97], v202 offset:0
ds_read_b64 v[98:99], v202 offset:1152
ds_read_b64 v[116:117], v206 offset:0
ds_read_b64 v[118:119], v207 offset:0
ds_read_b64 v[100:101], v203 offset:0
ds_read_b64 v[102:103], v203 offset:1152
ds_read_b64 v[120:121], v208 offset:0
ds_read_b64 v[122:123], v209 offset:0
ds_read_b64 v[104:105], v201 offset:0
ds_read_b64 v[106:107], v201 offset:1152
ds_read_b64 v[124:125], v210 offset:0
ds_read_b64 v[126:127], v211 offset:0
s_add_u32 s0, s37, 1
s_sub_u32 s1, 5, s37
s_min_u32 s0, s0, s1
s_lshl_b32 s0, s0, 4
s_sub_u32 s1, 64, s0
s_cmp_le_u32 s37, 2
s_cselect_b32 s1, s1, 16
s_bfm_b64 s[100:101], s0, s1
s_waitcnt lgkmcnt(8)
v_mfma_f32_16x16x32_bf16 v[152:155], v[96:99], v[116:119], 0
s_waitcnt lgkmcnt(4)
v_mfma_f32_16x16x32_bf16 v[156:159], v[100:103], v[120:123], 0
s_waitcnt lgkmcnt(0)
v_mfma_f32_16x16x32_bf16 v[152:155], v[104:107], v[124:127], v[152:155]
v_add_u32 v1, 128, v222
v_cndmask_b32 v2, v1, v222, s[44:45]
ds_read_b64 v[168:169], v2 offset:0
v_cndmask_b32 v2, v1, v222, s[46:47]
ds_read_b64 v[170:171], v2 offset:32
v_cndmask_b32 v2, v1, v222, s[48:49]
ds_read_b64 v[172:173], v2 offset:64
v_cndmask_b32 v2, v1, v222, s[50:51]
ds_read_b64 v[174:175], v2 offset:96
ds_read_b32 v5, v223
v_permlane16_swap_b32 v152, v156
v_permlane16_swap_b32 v153, v157
v_permlane16_swap_b32 v154, v158
v_permlane16_swap_b32 v155, v159
v_cndmask_b32 v2, v156, v152, s[44:45]
v_cndmask_b32 v3, v157, v153, s[46:47]
v_cndmask_b32 v194, v158, v154, s[48:49]
v_cndmask_b32 v195, v159, v155, s[50:51]
v_or_b32 v192, 0xffff, v2
v_perm_b32 v193, v3, v2, s55
s_cmp_eq_u32 s41, 1
s_cbranch_scc0 L_gl_22g
buffer_store_dwordx4 v[192:195], v224, s[20:23], s54 offen
L_gl_22b:
v_mov_b32 v184, 0
v_mov_b32 v185, 0
v_mov_b32 v186, 0
v_mov_b32 v187, 0
v_mov_b32 v188, 0
v_mov_b32 v189, 0
v_mov_b32 v190, 0
v_mov_b32 v191, 0
ds_read_b64_tr_b16 v[72:73], v217 offset:0
ds_read_b64_tr_b16 v[74:75], v217 offset:1152
ds_read_b64_tr_b16 v[76:77], v218 offset:0
ds_read_b64_tr_b16 v[78:79], v218 offset:1152
s_waitcnt lgkmcnt(0)
v_mul_f32 v5, 0x3ea52b5c, v5
buffer_load_dwordx4 v[92:95], v225, s[20:23], s54 offen sc1
s_waitcnt vmcnt(0)
v_cmp_eq_u32 vcc, -1, v92
s_cbranch_vccnz L_h0rl
L_h0gl:
s_lshl_b32 s0, s32, 2
s_add_u32 s0, s0, 1744
v_mov_b32 v1, s0
ds_write_b32 v1, v1
v_perm_b32 v92, v92, v93, s56
v_add_f32 v193, v3, v93
v_add_f32 v194, v194, v94
v_add_f32 v195, v195, v95
v_add_f32 v192, v2, v92
v_fma_f32 v192, v192, v168, v169
v_fma_f32 v193, v193, v170, v171
v_fma_f32 v194, v194, v172, v173
v_fma_f32 v195, v195, v174, v175
v_max3_f32 v6, v192, v193, v194
v_max_f32 v6, v6, v195
v_mov_b32 v7, v6
s_nop 1
v_permlane32_swap_b32 v6, v7
v_max_f32 v6, v6, v7
v_mul_f32 v6, v6, v5
v_fma_f32 v192, v192, v5, -v6
v_fma_f32 v193, v193, v5, -v6
v_fma_f32 v194, v194, v5, -v6
v_fma_f32 v195, v195, v5, -v6
v_exp_f32 v192, v192
v_exp_f32 v193, v193
v_exp_f32 v194, v194
v_exp_f32 v195, v195
v_add_f32 v6, v192, v193
v_add_f32 v7, v194, v195
v_add_f32 v6, v6, v7
v_mov_b32 v7, v6
v_mul_f32 v192, v192, v168
v_mul_f32 v193, v193, v170
v_permlane32_swap_b32 v6, v7
v_mul_f32 v194, v194, v172
v_add_f32 v6, v6, v7
v_rcp_f32 v6, v6
v_mul_f32 v195, v195, v174
v_mul_f32 v192, v192, v6
v_mul_f32 v193, v193, v6
v_mul_f32 v194, v194, v6
v_mul_f32 v195, v195, v6
v_cvt_pk_bf16_f32 v192, v192, v193
v_cvt_pk_bf16_f32 v193, v194, v195
s_mov_b64 exec, s[52:53]
v_and_b32 v184, v220, v192
v_bfi_b32 v188, v220, 0, v192
v_and_b32 v185, v221, v193
v_bfi_b32 v189, v221, 0, v193
s_not_b64 exec, exec
v_and_b32 v186, v220, v192
v_bfi_b32 v190, v220, 0, v192
v_and_b32 v187, v221, v193
v_bfi_b32 v191, v221, 0, v193
s_mov_b64 exec, -1
v_permlane16_swap_b32 v184, v188
v_permlane16_swap_b32 v185, v189
v_permlane16_swap_b32 v186, v190
v_permlane16_swap_b32 v187, v191
s_nop 1
v_mfma_f32_16x16x32_bf16 v[152:155], v[72:75], v[184:187], 0
v_mfma_f32_16x16x32_bf16 v[156:159], v[76:79], v[184:187], 0
v_mfma_f32_16x16x32_bf16 v[160:163], v[76:79], v[188:191], 0
s_mov_b32 exec_lo, 0xffff0000
s_nop 4
v_cvt_pk_bf16_f32 v80, v152, v153
v_cvt_pk_bf16_f32 v81, v154, v155
v_cvt_pk_bf16_f32 v82, v156, v157
v_cvt_pk_bf16_f32 v83, v158, v159
s_mov_b64 exec, s[100:101]
v_cvt_pk_bf16_f32 v82, v160, v161
v_cvt_pk_bf16_f32 v83, v162, v163
s_mov_b32 exec_lo, 0xffff0000
s_mov_b32 exec_hi, 0xffffffff
s_cmp_eq_u32 s41, 1
s_cbranch_scc0 L_gl_23g
buffer_store_dwordx4 v[80:83], v226, s[20:23], s54 offen
L_gl_23b:
s_endpgm
L_pad_24:
s_setpc_b64 s[100:101]
L_gl_22g:
buffer_store_dwordx4 v[192:195], v224, s[20:23], s54 offen sc1
s_branch L_gl_22b
L_h0rl:
s_sub_u32 s40, s40, 1
s_cbranch_scc1 L_h0xl
buffer_load_dwordx4 v[92:95], v225, s[20:23], s54 offen sc1
s_waitcnt vmcnt(0)
v_cmp_eq_u32 vcc, -1, v92
s_cbranch_vccnz L_h0rl
s_branch L_h0gl
L_h0xl:
s_mov_b32 s40, 0
s_branch L_h0gl
L_gl_23g:
buffer_store_dwordx4 v[80:83], v226, s[20:23], s54 offen sc1
s_branch L_gl_23b
.p2align 12
L_pb_16:
L_cons:
v_and_b32 v1, 15, v0
v_lshrrev_b32 v2, 4, v0
v_mov_b32 v7, 1792
s_mul_i32 s0, s44, 2304
s_movk_i32 s1, 144
v_bfe_u32 v3, v0, 2, 1
v_and_b32 v4, 3, v0
v_lshlrev_b32 v4, 1, v4
v_lshl_add_u32 v3, v3, 3, v4
v_bfe_u32 v4, v0, 3, 1
v_add_u32 v3, v3, v4
s_add_u32 s3, s0, 17408
v_mov_b32 v4, s3
v_mad_u32_u24 v3, v3, s1, v4
s_add_u32 s3, s0, 4736
v_mov_b32 v4, s3
v_mad_u32_u24 v4, v1, s1, v4
s_mov_b32 s52, 0xff00ff
s_mov_b32 s53, 0xff00ff
v_add_u32 v5, s51, v2
v_lshl_add_u32 v200, v5, 3, v3
v_lshl_add_u32 v5, v5, 3, v4
v_cndmask_b32 v204, v7, v5, s[52:53]
v_cndmask_b32 v205, v5, v7, s[52:53]
v_add_u32 v5, s46, v2
v_lshl_add_u32 v202, v5, 3, v3
v_lshl_add_u32 v5, v5, 3, v4
v_cmp_gt_u32 vcc, s47, v2
s_nop 1
v_cndmask_b32 v5, v7, v5, vcc
v_cndmask_b32 v206, v7, v5, s[52:53]
v_cndmask_b32 v207, v5, v7, s[52:53]
v_add_u32 v5, s48, v2
v_min_u32 v5, 15, v5
v_lshl_add_u32 v203, v5, 3, v3
v_lshl_add_u32 v5, v5, 3, v4
v_cmp_gt_u32 vcc, s49, v2
s_nop 1
v_cndmask_b32 v5, v7, v5, vcc
v_cndmask_b32 v208, v7, v5, s[52:53]
v_cndmask_b32 v209, v5, v7, s[52:53]
s_sub_u32 s3, s51, 1
v_mad_u32_u24 v5, v2, 5, s3
s_add_u32 s3, s46, 4
v_mov_b32 v6, s3
s_mov_b64 vcc, 0xffff
v_cndmask_b32 v5, v5, v6, vcc
v_min_u32 v5, 15, v5
v_lshl_add_u32 v201, v5, 3, v3
v_lshl_add_u32 v5, v5, 3, v4
s_cmp_eq_u32 s47, 5
s_cselect_b64 vcc, 0xff, 0
v_cndmask_b32 v210, v7, v5, vcc
s_lshl_b64 vcc, vcc, 8
v_cndmask_b32 v211, v7, v5, vcc
s_bfm_b64 vcc, 8, 16
v_cndmask_b32 v212, v7, v5, vcc
s_bfm_b64 vcc, 8, 24
v_cndmask_b32 v213, v7, v5, vcc
s_bfm_b64 vcc, 8, 32
v_cndmask_b32 v214, v7, v5, vcc
s_bfm_b64 vcc, 8, 40
v_cndmask_b32 v215, v7, v5, vcc
s_mul_i32 s0, s44, 2304
s_movk_i32 s1, 144
v_bfe_u32 v3, v0, 2, 3
v_lshrrev_b32 v4, 5, v0
v_lshl_add_u32 v3, v3, 1, v4
s_add_u32 s3, s0, 31232
v_mov_b32 v4, s3
v_mad_u32_u24 v3, v3, s1, v4
v_and_b32 v4, 3, v0
s_mov_b32 s54, 0x11111111
s_mov_b32 s55, 0x11111111
v_add_u32 v5, s51, v4
v_lshl_add_u32 v216, v5, 3, v3
v_add_u32 v7, 32, v216
s_cmp_eq_u32 s50, 1
s_cselect_b32 s3, -1, 12
s_cselect_b32 s56, 2, -1
v_add_u32 v5, s3, v4
v_lshl_add_u32 v5, v5, 3, v3
v_cndmask_b32 v217, v5, v7, s[54:55]
v_add_u32 v7, 40, v7
v_add_u32 v5, s56, v4
v_add_u32 v6, 10, v5
v_cmp_gt_i32 vcc, s51, v5
s_nop 1
v_cndmask_b32 v5, v6, v5, vcc
v_lshl_add_u32 v5, v5, 3, v3
v_cndmask_b32 v218, v5, v7, s[54:55]
s_lshl_b32 s0, s44, 8
v_lshrrev_b32 v4, 5, v0
v_and_or_b32 v3, v0, 8, v4
s_add_u32 s3, s0, 8
v_lshl_add_u32 v222, v3, 4, s3
v_and_b32 v1, 15, v0
s_add_u32 s3, s0, 132
v_lshl_add_u32 v223, v1, 4, s3
s_lshr_b32 s3, s39, 8
s_mul_i32 s3, s3, 52429
s_lshr_b32 s3, s3, 18
s_lshl_b32 s0, s44, 5
s_add_u32 s3, s3, s0
s_sub_u32 s3, 2047, s3
v_mad_i32_i24 v234, v1, -2, s3
v_lshrrev_b32 v2, 4, v0
v_and_or_b32 v3, v0, 8, v2
v_and_b32 v4, 0x70, v233
v_bfrev_b32 v6, 1
s_lshl_b32 s3, s44, 4
v_add_u32 v5, s3, v3
s_lshl_b32 s3, s60, 3
v_cmp_gt_u32 vcc, s3, v5
v_mul_u32_u24 v5, 2560, v5
v_add3_u32 v5, v5, v4, s39
v_cndmask_b32 v227, v6, v5, vcc
s_lshl_b32 s3, s36, 7
v_add_u32 v226, s3, v227
v_bfe_u32 v3, v0, 4, 1
v_cmp_eq_u32 s[54:55], s50, v3
s_cmp_lg_u32 s37, 0
s_cselect_b64 s[0:1], -1, s[54:55]
s_and_b64 vcc, vcc, s[0:1]
s_cmp_lg_u32 s37, 4
s_cselect_b64 s[0:1], 0, s[54:55]
s_andn2_b64 vcc, vcc, s[0:1]
v_cndmask_b32 v225, v6, v226, vcc
s_cmp_le_u32 s37, 3
s_cselect_b32 s3, 2560, 0
s_sub_u32 s3, s3, 128
v_mov_b32 v4, s3
s_cmp_ge_u32 s37, 2
s_cselect_b32 s3, 2560, 0
s_add_u32 s3, s3, 128
v_mov_b32 v5, s3
v_cndmask_b32 v4, v4, v5, s[54:55]
v_mul_u32_u24 v3, 2560, v3
v_sub_u32 v4, v4, v3
v_add_u32 v4, v4, v226
v_cndmask_b32 v224, v6, v4, vcc
v_and_b32 v1, 15, v0
v_bfrev_b32 v6, 1
v_bfe_u32 v3, v0, 4, 1
v_lshrrev_b32 v4, 5, v0
v_lshl_add_u32 v3, v3, 1, v4
s_lshl_b32 s3, s36, 7
v_lshl_add_u32 v4, v3, 4, s3
s_lshl_b32 s3, s44, 4
v_add_u32 v5, s3, v1
s_lshl_b32 s3, s60, 3
v_cmp_gt_u32 vcc, s3, v5
v_mul_u32_u24 v5, 2560, v5
v_add3_u32 v5, v5, v4, s39
v_cndmask_b32 v232, v6, v5, vcc
v_bfe_u32 v3, v0, 3, 2
v_lshlrev_b32 v3, 2, v3
v_and_or_b32 v3, v0, 3, v3
v_lshlrev_b32 v3, 3, v3
v_bfe_u32 v4, v0, 2, 2
v_lshl_add_u32 v3, v4, 7, v3
v_lshrrev_b32 v2, 4, v0
s_mov_b32 s44, 0x0
s_mov_b32 s45, 0x1010101
s_mov_b32 s46, 0x3030303
s_mov_b32 s47, 0x7070707
s_mov_b32 s48, 0xf0f0f0f
s_mov_b32 s49, 0x1f1f1f1f
s_mov_b32 s50, 0x3f3f3f3f
s_mov_b32 s51, 0x7f7f7f7f
s_movk_i32 s54, 10240
s_mov_b32 s55, 0x07060501
s_mov_b32 s56, 0x0706000c
v_mov_b32 v5, 0xffff
v_mov_b32 v6, 0xffff0000
v_cndmask_b32 v1, 0, v5, s[44:45]
v_cndmask_b32 v4, 0, v6, s[46:47]
v_or_b32 v220, v1, v4
v_cndmask_b32 v1, 0, v5, s[48:49]
v_cndmask_b32 v4, 0, v6, s[50:51]
v_or_b32 v221, v1, v4
s_lshl_b32 s3, s38, 5
v_xor_b32 v3, s3, v3
v_mul_u32_u24 v4, 3072, v2
v_add_u32 v3, v3, v4
v_add_u32 v244, 20480, v3
s_mov_b32 s42, 0
v_mov_b32 v3, 0
v_lshlrev_b32 v2, 2, v0
s_mov_b32 exec_hi, 0
ds_write_b32 v2, v3 offset:1728
ds_write_b32 v2, v3 offset:2880
s_mov_b64 exec, -1
v_and_b32 v1, 15, v0
v_lshrrev_b32 v2, 4, v0
v_lshrrev_b32 v3, 1, v1
v_xor_b32 v3, v3, v2
v_lshlrev_b32 v3, 4, v3
v_lshl_add_u32 v3, v1, 7, v3
v_add_u32 v245, 8192, v3
v_xor_b32 v246, 64, v245
v_mul_u32_u24 v3, 144, v1
v_lshl_add_u32 v3, v2, 3, v3
s_lshl_b32 s3, s38, 5
s_add_u32 s3, s3, 3584
v_add_u32 v247, s3, v3
v_lshlrev_b32 v248, 4, v1
s_cmp_eq_u32 s32, 0
s_cbranch_scc0 L_cw0
s_call_b64 s[100:101], L_pad_2
L_cw0:
s_cmp_eq_u32 s32, 1
s_cbranch_scc0 L_cw1
s_call_b64 s[100:101], L_pad_15
L_cw1:
s_cmp_eq_u32 s32, 2
s_cbranch_scc0 L_cw2
s_call_b64 s[100:101], L_pad_18
L_cw2:
s_cmp_eq_u32 s32, 3
s_cbranch_scc0 L_cw3
L_cw3:
s_cmp_eq_u32 s69, 9
s_cselect_b32 s3, -2457600, 0
s_add_u32 s3, s3, 245760
v_add_u32 v254, s3, v254
s_mul_i32 s3, s38, 3072
s_add_u32 m0, s3, 57344
s_mov_b32 s0, 122880
buffer_load_dwordx4 v254, s[8:11], 0 offen offset:0 lds
s_addk_i32 m0, -256
s_nop 0
buffer_load_dwordx4 v254, s[8:11], 0 offen offset:1280 lds
s_addk_i32 m0, -256
s_nop 0
buffer_load_dwordx4 v254, s[8:11], 0 offen offset:2560 lds
s_addk_i32 m0, 12800
s_nop 0
buffer_load_dwordx4 v254, s[8:11], s0 offen offset:0 lds
s_addk_i32 m0, -256
s_nop 0
buffer_load_dwordx4 v254, s[8:11], s0 offen offset:1280 lds
s_addk_i32 m0, -256
s_nop 0
buffer_load_dwordx4 v254, s[8:11], s0 offen offset:2560 lds
v_mov_b32 v4, -1
v_mov_b32 v5, -1
v_mov_b32 v6, -1
v_mov_b32 v7, -1
v_lshrrev_b32 v1, 3, v0
v_mul_u32_u24 v1, 2560, v1
v_and_b32 v2, 0x70, v233
s_lshl_b32 s3, s36, 7
s_add_u32 s3, s3, s39
v_add3_u32 v1, v1, v2, s3
s_mul_i32 s0, s38, 20480
s_add_u32 s1, s0, 81920
s_add_u32 s3, s38, 8
s_cmp_lt_u32 s3, s60
s_cselect_b32 s3, s1, 0x80000000
s_add_u32 s3, s3, 81920
buffer_store_dwordx4 v[4:7], v1, s[20:23], s0 offen
buffer_store_dwordx4 v[4:7], v1, s[20:23], s1 offen
buffer_store_dwordx4 v[4:7], v1, s[20:23], s3 offen
v_lshrrev_b32 v1, 4, v0
v_mul_u32_u24 v1, 2304, v1
v_add_u32 v1, v1, v233
s_mul_i32 s1, s43, 15360
s_lshl_b32 s3, s36, 8
s_add_u32 s1, s1, s3
s_and_b32 s3, s38, 1
s_mul_i32 s3, s3, 7680
s_add_u32 s1, s1, s3
s_add_u32 s1, s1, 2097152
s_cmp_lt_u32 s38, 2
s_cselect_b32 s1, s1, 0x80000000
s_mov_b32 exec_hi, 0xffff
buffer_store_dwordx4 v[4:7], v1, s[16:19], s1 offen
s_mov_b64 exec, -1
s_cmp_lt_u32 s32, 2
s_cselect_b32 s57, s57, 99
s_mov_b32 s65, 8192
s_min_u32 s62, s57, 1
s_waitcnt vmcnt(10) lgkmcnt(0)
s_barrier
ds_read_b64_tr_b16 v[156:157], v244 offset:1024
ds_read_b64_tr_b16 v[158:159], v244 offset:1536
ds_read_b128 v[80:83], v245 offset:0
ds_read_b128 v[84:87], v245 offset:2048
ds_read_b128 v[88:91], v245 offset:4096
ds_read_b128 v[92:95], v245 offset:6144
ds_read_b128 v[96:99], v245 offset:8192
ds_read_b128 v[100:103], v245 offset:10240
ds_read_b64_tr_b16 v[160:161], v244 offset:2048
ds_read_b64_tr_b16 v[162:163], v244 offset:2560
ds_read_b64_tr_b16 v[152:153], v244 offset:0
ds_read_b64_tr_b16 v[154:155], v244 offset:512
s_waitcnt lgkmcnt(4)
v_mfma_f32_16x16x32_bf16 v[32:35], v[156:159], v[80:83], 0
ds_read_b64_tr_b16 v[168:169], v244 offset:13312
v_mfma_f32_16x16x32_bf16 v[36:39], v[156:159], v[84:87], 0
ds_read_b64_tr_b16 v[170:171], v244 offset:13824
v_mfma_f32_16x16x32_bf16 v[40:43], v[156:159], v[88:91], 0
ds_read_b128 v[104:107], v246 offset:0
v_mfma_f32_16x16x32_bf16 v[44:47], v[156:159], v[92:95], 0
ds_read_b128 v[108:111], v246 offset:2048
v_mfma_f32_16x16x32_bf16 v[48:51], v[156:159], v[96:99], 0
ds_read_b128 v[112:115], v246 offset:4096
v_mfma_f32_16x16x32_bf16 v[52:55], v[156:159], v[100:103], 0
ds_read_b128 v[116:119], v246 offset:6144
s_waitcnt lgkmcnt(8)
v_mfma_f32_16x16x32_bf16 v[56:59], v[160:163], v[80:83], 0
ds_read_b128 v[120:123], v246 offset:8192
v_mfma_f32_16x16x32_bf16 v[60:63], v[160:163], v[84:87], 0
ds_read_b128 v[124:127], v246 offset:10240
v_mfma_f32_16x16x32_bf16 v[64:67], v[160:163], v[88:91], 0
ds_read_b64_tr_b16 v[172:173], v244 offset:14336
v_mfma_f32_16x16x32_bf16 v[68:71], v[160:163], v[92:95], 0
ds_read_b64_tr_b16 v[174:175], v244 offset:14848
v_mfma_f32_16x16x32_bf16 v[72:75], v[160:163], v[96:99], 0
ds_read_b64_tr_b16 v[164:165], v244 offset:12288
v_mfma_f32_16x16x32_bf16 v[76:79], v[160:163], v[100:103], 0
ds_read_b64_tr_b16 v[166:167], v244 offset:12800
s_waitcnt lgkmcnt(12)
v_mfma_f32_16x16x32_bf16 v[8:11], v[152:155], v[80:83], 0
s_add_u32 s3, s65, 36864
s_cmp_eq_u32 s3, 155648
v_mfma_f32_16x16x32_bf16 v[12:15], v[152:155], v[84:87], 0
s_cselect_b32 s3, 8192, s3
s_sub_u32 s63, s3, s65
v_mfma_f32_16x16x32_bf16 v[16:19], v[152:155], v[88:91], 0
s_mov_b32 s65, s3
v_add_u32 v245, s63, v245
v_mfma_f32_16x16x32_bf16 v[20:23], v[152:155], v[92:95], 0
v_add_u32 v244, s63, v244
v_add_u32 v246, s63, v246
v_mfma_f32_16x16x32_bf16 v[24:27], v[152:155], v[96:99], 0
v_mfma_f32_16x16x32_bf16 v[28:31], v[152:155], v[100:103], 0
s_add_u32 s42, s42, 1
s_cmp_lt_u32 s42, 9
s_waitcnt lgkmcnt(4)
v_mfma_f32_16x16x32_bf16 v[32:35], v[168:171], v[104:107], v[32:35]
v_mfma_f32_16x16x32_bf16 v[36:39], v[168:171], v[108:111], v[36:39]
v_mfma_f32_16x16x32_bf16 v[40:43], v[168:171], v[112:115], v[40:43]
v_mfma_f32_16x16x32_bf16 v[44:47], v[168:171], v[116:119], v[44:47]
v_mfma_f32_16x16x32_bf16 v[48:51], v[168:171], v[120:123], v[48:51]
v_mfma_f32_16x16x32_bf16 v[52:55], v[168:171], v[124:127], v[52:55]
s_waitcnt lgkmcnt(2)
v_mfma_f32_16x16x32_bf16 v[56:59], v[172:175], v[104:107], v[56:59]
v_mfma_f32_16x16x32_bf16 v[60:63], v[172:175], v[108:111], v[60:63]
v_mfma_f32_16x16x32_bf16 v[64:67], v[172:175], v[112:115], v[64:67]
v_mfma_f32_16x16x32_bf16 v[68:71], v[172:175], v[116:119], v[68:71]
v_mfma_f32_16x16x32_bf16 v[72:75], v[172:175], v[120:123], v[72:75]
s_waitcnt vmcnt(4) lgkmcnt(0)
v_mfma_f32_16x16x32_bf16 v[76:79], v[172:175], v[124:127], v[76:79]
s_branch L_pb_17
L_pad_25:
s_setpc_b64 s[100:101]
L_ev:
s_cmp_eq_u32 s42, 1
s_cbranch_scc0 L_ev1
s_waitcnt vmcnt(0)
L_ev1:
s_max_u32 s62, s57, 1
s_cmp_eq_u32 s42, s57
s_cbranch_scc0 L_evb
s_sub_u32 s0, s65, s63
v_add_u32 v1, s0, v235
ds_read_b64 v[236:237], v1
v_xor_b32 v2, 32, v1
ds_read_b64 v[238:239], v2
v_xor_b32 v3, 64, v1
ds_read_b64 v[240:241], v3
v_xor_b32 v4, 96, v1
ds_read_b64 v[242:243], v4
s_branch L_evb
L_gs:
v_mov_b32 v4, -1
v_mov_b32 v5, -1
v_mov_b32 v6, -1
v_mov_b32 v7, -1
v_lshrrev_b32 v1, 3, v0
v_mul_u32_u24 v1, 2560, v1
v_and_b32 v2, 0x70, v233
s_lshl_b32 s3, s36, 7
s_add_u32 s3, s3, s39
v_add3_u32 v1, v1, v2, s3
s_mul_i32 s0, s38, 20480
s_add_u32 s1, s0, 81920
s_add_u32 s3, s38, 8
s_cmp_lt_u32 s3, s60
s_cselect_b32 s3, s1, 0x80000000
s_add_u32 s3, s3, 81920
buffer_store_dwordx4 v[4:7], v1, s[20:23], s0 offen sc1
buffer_store_dwordx4 v[4:7], v1, s[20:23], s1 offen sc1
buffer_store_dwordx4 v[4:7], v1, s[20:23], s3 offen sc1
v_lshrrev_b32 v1, 4, v0
v_mul_u32_u24 v1, 2304, v1
v_add_u32 v1, v1, v233
s_mul_i32 s1, s43, 15360
s_lshl_b32 s3, s36, 8
s_add_u32 s1, s1, s3
s_and_b32 s3, s38, 1
s_mul_i32 s3, s3, 7680
s_add_u32 s1, s1, s3
s_add_u32 s1, s1, 2097152
s_cmp_lt_u32 s38, 2
s_cselect_b32 s1, s1, 0x80000000
s_mov_b32 exec_hi, 0xffff
buffer_store_dwordx4 v[4:7], v1, s[16:19], s1 offen sc1
s_mov_b64 exec, -1
s_waitcnt vmcnt(0)
s_barrier
s_barrier
s_branch L_gsb
.p2align 12
L_pad_18:
s_setpc_b64 s[100:101]
L_pb_17:
L_cloop:
s_barrier
ds_read_b64_tr_b16 v[156:157], v244 offset:1024
ds_read_b64_tr_b16 v[158:159], v244 offset:1536
v_mfma_f32_16x16x32_bf16 v[8:11], v[164:167], v[104:107], v[8:11]
ds_read_b128 v[80:83], v245 offset:0
v_mfma_f32_16x16x32_bf16 v[12:15], v[164:167], v[108:111], v[12:15]
ds_read_b128 v[84:87], v245 offset:2048
v_mfma_f32_16x16x32_bf16 v[16:19], v[164:167], v[112:115], v[16:19]
ds_read_b128 v[88:91], v245 offset:4096
v_mfma_f32_16x16x32_bf16 v[20:23], v[164:167], v[116:119], v[20:23]
ds_read_b128 v[92:95], v245 offset:6144
v_mfma_f32_16x16x32_bf16 v[24:27], v[164:167], v[120:123], v[24:27]
ds_read_b128 v[96:99], v245 offset:8192
v_mfma_f32_16x16x32_bf16 v[28:31], v[164:167], v[124:127], v[28:31]
ds_read_b128 v[100:103], v245 offset:10240
s_waitcnt lgkmcnt(5)
v_mfma_f32_16x16x32_bf16 v[32:35], v[156:159], v[80:83], v[32:35]
ds_read_b64_tr_b16 v[160:161], v244 offset:2048
s_waitcnt lgkmcnt(5)
v_mfma_f32_16x16x32_bf16 v[36:39], v[156:159], v[84:87], v[36:39]
ds_read_b64_tr_b16 v[162:163], v244 offset:2560
s_waitcnt lgkmcnt(5)
v_mfma_f32_16x16x32_bf16 v[40:43], v[156:159], v[88:91], v[40:43]
ds_read_b64_tr_b16 v[152:153], v244 offset:0
s_waitcnt lgkmcnt(5)
v_mfma_f32_16x16x32_bf16 v[44:47], v[156:159], v[92:95], v[44:47]
ds_read_b64_tr_b16 v[154:155], v244 offset:512
s_waitcnt lgkmcnt(5)
v_mfma_f32_16x16x32_bf16 v[48:51], v[156:159], v[96:99], v[48:51]
ds_read_b64_tr_b16 v[168:169], v244 offset:13312
s_waitcnt lgkmcnt(5)
v_mfma_f32_16x16x32_bf16 v[52:55], v[156:159], v[100:103], v[52:55]
ds_read_b64_tr_b16 v[170:171], v244 offset:13824
s_waitcnt lgkmcnt(4)
v_mfma_f32_16x16x32_bf16 v[56:59], v[160:163], v[80:83], v[56:59]
ds_read_b128 v[104:107], v246 offset:0
v_mfma_f32_16x16x32_bf16 v[60:63], v[160:163], v[84:87], v[60:63]
ds_read_b128 v[108:111], v246 offset:2048
v_mfma_f32_16x16x32_bf16 v[64:67], v[160:163], v[88:91], v[64:67]
ds_read_b128 v[112:115], v246 offset:4096
v_mfma_f32_16x16x32_bf16 v[68:71], v[160:163], v[92:95], v[68:71]
ds_read_b128 v[116:119], v246 offset:6144
v_mfma_f32_16x16x32_bf16 v[72:75], v[160:163], v[96:99], v[72:75]
ds_read_b128 v[120:123], v246 offset:8192
v_mfma_f32_16x16x32_bf16 v[76:79], v[160:163], v[100:103], v[76:79]
ds_read_b128 v[124:127], v246 offset:10240
s_waitcnt lgkmcnt(8)
v_mfma_f32_16x16x32_bf16 v[8:11], v[152:155], v[80:83], v[8:11]
ds_read_b64_tr_b16 v[172:173], v244 offset:14336
v_mfma_f32_16x16x32_bf16 v[12:15], v[152:155], v[84:87], v[12:15]
ds_read_b64_tr_b16 v[174:175], v244 offset:14848
v_mfma_f32_16x16x32_bf16 v[16:19], v[152:155], v[88:91], v[16:19]
ds_read_b64_tr_b16 v[164:165], v244 offset:12288
v_mfma_f32_16x16x32_bf16 v[20:23], v[152:155], v[92:95], v[20:23]
ds_read_b64_tr_b16 v[166:167], v244 offset:12800
v_mfma_f32_16x16x32_bf16 v[24:27], v[152:155], v[96:99], v[24:27]
s_add_u32 s3, s65, 36864
s_cmp_eq_u32 s3, 155648
v_mfma_f32_16x16x32_bf16 v[28:31], v[152:155], v[100:103], v[28:31]
s_cselect_b32 s3, 8192, s3
s_sub_u32 s63, s3, s65
s_waitcnt lgkmcnt(4)
v_mfma_f32_16x16x32_bf16 v[32:35], v[168:171], v[104:107], v[32:35]
s_mov_b32 s65, s3
v_add_u32 v245, s63, v245
v_mfma_f32_16x16x32_bf16 v[36:39], v[168:171], v[108:111], v[36:39]
v_add_u32 v244, s63, v244
v_add_u32 v246, s63, v246
v_mfma_f32_16x16x32_bf16 v[40:43], v[168:171], v[112:115], v[40:43]
s_cmp_eq_u32 s42, s62
s_cbranch_scc1 L_ev
L_evb:
v_mfma_f32_16x16x32_bf16 v[44:47], v[168:171], v[116:119], v[44:47]
v_mfma_f32_16x16x32_bf16 v[48:51], v[168:171], v[120:123], v[48:51]
s_add_u32 s42, s42, 1
s_cmp_lt_u32 s42, 9
v_mfma_f32_16x16x32_bf16 v[52:55], v[168:171], v[124:127], v[52:55]
s_waitcnt lgkmcnt(2)
v_mfma_f32_16x16x32_bf16 v[56:59], v[172:175], v[104:107], v[56:59]
v_mfma_f32_16x16x32_bf16 v[60:63], v[172:175], v[108:111], v[60:63]
v_mfma_f32_16x16x32_bf16 v[64:67], v[172:175], v[112:115], v[64:67]
v_mfma_f32_16x16x32_bf16 v[68:71], v[172:175], v[116:119], v[68:71]
v_mfma_f32_16x16x32_bf16 v[72:75], v[172:175], v[120:123], v[72:75]
s_waitcnt lgkmcnt(0)
v_mfma_f32_16x16x32_bf16 v[76:79], v[172:175], v[124:127], v[76:79]
s_cbranch_scc1 L_cloop
v_mov_b32 v1, 1728
ds_read_b32 v1, v1
ds_read2_b64 v[180:183], v248 offset0:0 offset1:32
ds_read2_b64 v[184:187], v248 offset0:64 offset1:96
ds_read2_b64 v[188:191], v248 offset0:128 offset1:160
s_waitcnt lgkmcnt(0)
v_readfirstlane_b32 s41, v1
s_barrier
s_cmp_eq_u32 s41, 1
s_cbranch_scc0 L_gs
L_gsb:
ds_read_b64_tr_b16 v[156:157], v244 offset:1024
ds_read_b64_tr_b16 v[158:159], v244 offset:1536
v_mfma_f32_16x16x32_bf16 v[8:11], v[164:167], v[104:107], v[8:11]
ds_read_b128 v[80:83], v245 offset:0
v_mfma_f32_16x16x32_bf16 v[12:15], v[164:167], v[108:111], v[12:15]
ds_read_b128 v[84:87], v245 offset:2048
v_mfma_f32_16x16x32_bf16 v[16:19], v[164:167], v[112:115], v[16:19]
ds_read_b128 v[88:91], v245 offset:4096
v_mfma_f32_16x16x32_bf16 v[20:23], v[164:167], v[116:119], v[20:23]
ds_read_b128 v[92:95], v245 offset:6144
v_mfma_f32_16x16x32_bf16 v[24:27], v[164:167], v[120:123], v[24:27]
ds_read_b128 v[96:99], v245 offset:8192
v_mfma_f32_16x16x32_bf16 v[28:31], v[164:167], v[124:127], v[28:31]
ds_read_b128 v[100:103], v245 offset:10240
ds_read_b64_tr_b16 v[176:177], v244 offset:13312
ds_read_b64_tr_b16 v[178:179], v244 offset:13824
s_waitcnt lgkmcnt(7)
v_mfma_f32_16x16x32_bf16 v[32:35], v[156:159], v[80:83], v[32:35]
ds_read_b128 v[128:131], v246 offset:0
s_waitcnt lgkmcnt(7)
v_mfma_f32_16x16x32_bf16 v[36:39], v[156:159], v[84:87], v[36:39]
ds_read_b128 v[132:135], v246 offset:2048
s_waitcnt lgkmcnt(7)
v_mfma_f32_16x16x32_bf16 v[40:43], v[156:159], v[88:91], v[40:43]
ds_read_b128 v[136:139], v246 offset:4096
s_waitcnt lgkmcnt(7)
v_mfma_f32_16x16x32_bf16 v[44:47], v[156:159], v[92:95], v[44:47]
ds_read_b128 v[140:143], v246 offset:6144
s_waitcnt lgkmcnt(7)
v_mfma_f32_16x16x32_bf16 v[48:51], v[156:159], v[96:99], v[48:51]
ds_read_b128 v[144:147], v246 offset:8192
s_waitcnt lgkmcnt(7)
v_mfma_f32_16x16x32_bf16 v[52:55], v[156:159], v[100:103], v[52:55]
ds_read_b128 v[148:151], v246 offset:10240
s_waitcnt lgkmcnt(5)
v_mfma_f32_16x16x32_bf16 v[32:35], v[176:179], v[128:131], v[32:35]
ds_read_b64_tr_b16 v[160:161], v244 offset:2048
s_waitcnt lgkmcnt(5)
v_mfma_f32_16x16x32_bf16 v[36:39], v[176:179], v[132:135], v[36:39]
ds_read_b64_tr_b16 v[162:163], v244 offset:2560
s_waitcnt lgkmcnt(5)
v_mfma_f32_16x16x32_bf16 v[40:43], v[176:179], v[136:139], v[40:43]
ds_read_b64_tr_b16 v[152:153], v244 offset:0
s_waitcnt lgkmcnt(5)
v_mfma_f32_16x16x32_bf16 v[44:47], v[176:179], v[140:143], v[44:47]
ds_read_b64_tr_b16 v[154:155], v244 offset:512
s_waitcnt lgkmcnt(5)
v_mfma_f32_16x16x32_bf16 v[48:51], v[176:179], v[144:147], v[48:51]
ds_read_b64_tr_b16 v[172:173], v244 offset:14336
s_waitcnt lgkmcnt(5)
v_mfma_f32_16x16x32_bf16 v[52:55], v[176:179], v[148:151], v[52:55]
ds_read_b64_tr_b16 v[174:175], v244 offset:14848
s_waitcnt lgkmcnt(4)
v_mfma_f32_16x16x32_bf16 v[56:59], v[160:163], v[80:83], v[56:59]
ds_read_b64_tr_b16 v[164:165], v244 offset:12288
ds_read_b64_tr_b16 v[166:167], v244 offset:12800
v_mov_b32_dpp v192, v32 row_newbcast:0 row_mask:0xf bank_mask:0xf
v_mov_b32_dpp v193, v33 row_newbcast:0 row_mask:0xf bank_mask:0xf
v_mov_b32_dpp v194, v34 row_newbcast:0 row_mask:0xf bank_mask:0xf
v_mov_b32_dpp v195, v35 row_newbcast:0 row_mask:0xf bank_mask:0xf
v_fmac_f32 v32, v192, v180
v_fmac_f32 v33, v193, v180
v_fmac_f32 v34, v194, v180
v_mfma_f32_16x16x32_bf16 v[60:63], v[160:163], v[84:87], v[60:63]
v_fmac_f32 v35, v195, v180
v_cvt_pk_bf16_f32 v32, v32, v33
v_cvt_pk_bf16_f32 v33, v34, v35
v_mfma_f32_16x16x32_bf16 v[64:67], v[160:163], v[88:91], v[64:67]
ds_write_b64 v247, v[32:33] offset:13824
v_fmac_f32 v36, v192, v182
v_fmac_f32 v37, v193, v182
v_fmac_f32 v38, v194, v182
v_mfma_f32_16x16x32_bf16 v[68:71], v[160:163], v[92:95], v[68:71]
v_fmac_f32 v39, v195, v182
v_cvt_pk_bf16_f32 v36, v36, v37
v_cvt_pk_bf16_f32 v37, v38, v39
v_mfma_f32_16x16x32_bf16 v[72:75], v[160:163], v[96:99], v[72:75]
ds_write_b64 v247, v[36:37] offset:16128
v_fmac_f32 v40, v192, v184
v_fmac_f32 v41, v193, v184
v_fmac_f32 v42, v194, v184
v_mfma_f32_16x16x32_bf16 v[76:79], v[160:163], v[100:103], v[76:79]
v_fmac_f32 v43, v195, v184
v_cvt_pk_bf16_f32 v40, v40, v41
v_cvt_pk_bf16_f32 v41, v42, v43
s_waitcnt lgkmcnt(4)
v_mfma_f32_16x16x32_bf16 v[56:59], v[172:175], v[128:131], v[56:59]
ds_write_b64 v247, v[40:41] offset:18432
v_fmac_f32 v44, v192, v186
v_fmac_f32 v45, v193, v186
v_fmac_f32 v46, v194, v186
v_mfma_f32_16x16x32_bf16 v[60:63], v[172:175], v[132:135], v[60:63]
v_fmac_f32 v47, v195, v186
v_cvt_pk_bf16_f32 v44, v44, v45
v_cvt_pk_bf16_f32 v45, v46, v47
v_mfma_f32_16x16x32_bf16 v[64:67], v[172:175], v[136:139], v[64:67]
ds_write_b64 v247, v[44:45] offset:20736
v_fmac_f32 v48, v192, v188
v_fmac_f32 v49, v193, v188
v_fmac_f32 v50, v194, v188
v_mfma_f32_16x16x32_bf16 v[68:71], v[172:175], v[140:143], v[68:71]
v_fmac_f32 v51, v195, v188
v_cvt_pk_bf16_f32 v48, v48, v49
v_cvt_pk_bf16_f32 v49, v50, v51
v_mfma_f32_16x16x32_bf16 v[72:75], v[172:175], v[144:147], v[72:75]
ds_write_b64 v247, v[48:49] offset:23040
v_fmac_f32 v52, v192, v190
v_fmac_f32 v53, v193, v190
v_fmac_f32 v54, v194, v190
v_mfma_f32_16x16x32_bf16 v[76:79], v[172:175], v[148:151], v[76:79]
v_fmac_f32 v55, v195, v190
v_cvt_pk_bf16_f32 v52, v52, v53
v_cvt_pk_bf16_f32 v53, v54, v55
ds_write_b64 v247, v[52:53] offset:25344
v_mfma_f32_16x16x32_bf16 v[8:11], v[152:155], v[80:83], v[8:11]
v_mov_b32_dpp v192, v56 row_newbcast:0 row_mask:0xf bank_mask:0xf
v_mov_b32_dpp v193, v57 row_newbcast:0 row_mask:0xf bank_mask:0xf
v_mov_b32_dpp v194, v58 row_newbcast:0 row_mask:0xf bank_mask:0xf
v_mov_b32_dpp v195, v59 row_newbcast:0 row_mask:0xf bank_mask:0xf
v_fmac_f32 v56, v192, v180
v_fmac_f32 v57, v193, v180
v_fmac_f32 v58, v194, v180
v_mfma_f32_16x16x32_bf16 v[12:15], v[152:155], v[84:87], v[12:15]
v_fmac_f32 v59, v195, v180
v_cvt_pk_bf16_f32 v56, v56, v57
v_cvt_pk_bf16_f32 v57, v58, v59
v_mfma_f32_16x16x32_bf16 v[16:19], v[152:155], v[88:91], v[16:19]
s_waitcnt lgkmcnt(0)
s_barrier
ds_write_b64 v247, v[56:57] offset:27648
v_fmac_f32 v60, v192, v182
v_fmac_f32 v61, v193, v182
v_fmac_f32 v62, v194, v182
v_mfma_f32_16x16x32_bf16 v[20:23], v[152:155], v[92:95], v[20:23]
v_fmac_f32 v63, v195, v182
v_cvt_pk_bf16_f32 v60, v60, v61
v_cvt_pk_bf16_f32 v61, v62, v63
v_mfma_f32_16x16x32_bf16 v[24:27], v[152:155], v[96:99], v[24:27]
ds_write_b64 v247, v[60:61] offset:29952
v_fmac_f32 v64, v192, v184
v_fmac_f32 v65, v193, v184
v_fmac_f32 v66, v194, v184
v_mfma_f32_16x16x32_bf16 v[28:31], v[152:155], v[100:103], v[28:31]
v_fmac_f32 v67, v195, v184
v_cvt_pk_bf16_f32 v64, v64, v65
v_cvt_pk_bf16_f32 v65, v66, v67
v_mfma_f32_16x16x32_bf16 v[8:11], v[164:167], v[128:131], v[8:11]
ds_write_b64 v247, v[64:65] offset:32256
v_fmac_f32 v68, v192, v186
v_fmac_f32 v69, v193, v186
v_fmac_f32 v70, v194, v186
v_mfma_f32_16x16x32_bf16 v[12:15], v[164:167], v[132:135], v[12:15]
v_fmac_f32 v71, v195, v186
v_cvt_pk_bf16_f32 v68, v68, v69
v_cvt_pk_bf16_f32 v69, v70, v71
v_mfma_f32_16x16x32_bf16 v[16:19], v[164:167], v[136:139], v[16:19]
ds_write_b64 v247, v[68:69] offset:34560
v_fmac_f32 v72, v192, v188
v_fmac_f32 v73, v193, v188
v_fmac_f32 v74, v194, v188
v_mfma_f32_16x16x32_bf16 v[20:23], v[164:167], v[140:143], v[20:23]
v_fmac_f32 v75, v195, v188
v_cvt_pk_bf16_f32 v72, v72, v73
v_cvt_pk_bf16_f32 v73, v74, v75
v_mfma_f32_16x16x32_bf16 v[24:27], v[164:167], v[144:147], v[24:27]
ds_write_b64 v247, v[72:73] offset:36864
v_fmac_f32 v76, v192, v190
v_fmac_f32 v77, v193, v190
v_fmac_f32 v78, v194, v190
v_mfma_f32_16x16x32_bf16 v[28:31], v[164:167], v[148:151], v[28:31]
v_fmac_f32 v79, v195, v190
v_cvt_pk_bf16_f32 v76, v76, v77
v_cvt_pk_bf16_f32 v77, v78, v79
ds_write_b64 v247, v[76:77] offset:39168
v_mov_b32_dpp v192, v8 row_newbcast:0 row_mask:0xf bank_mask:0xf
v_mov_b32_dpp v193, v9 row_newbcast:0 row_mask:0xf bank_mask:0xf
v_mov_b32_dpp v194, v10 row_newbcast:0 row_mask:0xf bank_mask:0xf
v_mov_b32_dpp v195, v11 row_newbcast:0 row_mask:0xf bank_mask:0xf
v_pk_fma_f32 v[8:9], v[192:193], v[180:181], v[8:9] op_sel_hi:[1,0,1]
v_pk_fma_f32 v[10:11], v[194:195], v[180:181], v[10:11] op_sel_hi:[1,0,1]
v_cvt_pk_bf16_f32 v8, v8, v9
v_cvt_pk_bf16_f32 v9, v10, v11
ds_write_b64 v247, v[8:9] offset:0
v_pk_fma_f32 v[12:13], v[192:193], v[182:183], v[12:13] op_sel_hi:[1,0,1]
v_pk_fma_f32 v[14:15], v[194:195], v[182:183], v[14:15] op_sel_hi:[1,0,1]
v_cvt_pk_bf16_f32 v12, v12, v13
v_cvt_pk_bf16_f32 v13, v14, v15
ds_write_b64 v247, v[12:13] offset:2304
v_pk_fma_f32 v[16:17], v[192:193], v[184:185], v[16:17] op_sel_hi:[1,0,1]
v_pk_fma_f32 v[18:19], v[194:195], v[184:185], v[18:19] op_sel_hi:[1,0,1]
v_cvt_pk_bf16_f32 v16, v16, v17
v_cvt_pk_bf16_f32 v17, v18, v19
ds_write_b64 v247, v[16:17] offset:4608
v_pk_fma_f32 v[20:21], v[192:193], v[186:187], v[20:21] op_sel_hi:[1,0,1]
v_pk_fma_f32 v[22:23], v[194:195], v[186:187], v[22:23] op_sel_hi:[1,0,1]
v_cvt_pk_bf16_f32 v20, v20, v21
v_cvt_pk_bf16_f32 v21, v22, v23
ds_write_b64 v247, v[20:21] offset:6912
v_pk_fma_f32 v[24:25], v[192:193], v[188:189], v[24:25] op_sel_hi:[1,0,1]
v_pk_fma_f32 v[26:27], v[194:195], v[188:189], v[26:27] op_sel_hi:[1,0,1]
v_cvt_pk_bf16_f32 v24, v24, v25
v_cvt_pk_bf16_f32 v25, v26, v27
ds_write_b64 v247, v[24:25] offset:9216
v_pk_fma_f32 v[28:29], v[192:193], v[190:191], v[28:29] op_sel_hi:[1,0,1]
v_pk_fma_f32 v[30:31], v[194:195], v[190:191], v[30:31] op_sel_hi:[1,0,1]
v_cvt_pk_bf16_f32 v28, v28, v29
v_cvt_pk_bf16_f32 v29, v30, v31
ds_write_b64 v247, v[28:29] offset:11520
s_waitcnt lgkmcnt(0)
s_barrier
s_cmp_lt_u32 s32, 2
s_cbranch_scc0 L_c23
ds_read_b64 v[108:109], v200 offset:0
ds_read_b64 v[110:111], v200 offset:1152
ds_read_b64 v[128:129], v204 offset:0
ds_read_b64 v[130:131], v205 offset:0
ds_read_b64 v[112:113], v200 offset:40
ds_read_b64 v[114:115], v200 offset:1192
ds_read_b64 v[132:133], v204 offset:40
ds_read_b64 v[134:135], v205 offset:40
ds_read_b64 v[104:105], v201 offset:0
ds_read_b64 v[106:107], v201 offset:1152
ds_read_b64 v[136:137], v212 offset:0
ds_read_b64 v[138:139], v213 offset:0
ds_read_b64 v[140:141], v214 offset:0
ds_read_b64 v[142:143], v215 offset:0
v_mov_b32 v176, 0
v_mov_b32 v177, 0
v_mov_b32 v178, 0
v_mov_b32 v179, 0
v_mov_b32 v180, 0
v_mov_b32 v181, 0
v_mov_b32 v182, 0
v_mov_b32 v183, 0
s_waitcnt lgkmcnt(10)
v_mfma_f32_16x16x32_bf16 v[160:163], v[108:111], v[128:131], 0
s_waitcnt lgkmcnt(6)
v_mfma_f32_16x16x32_bf16 v[164:167], v[112:115], v[132:135], 0
v_add_u32 v1, 128, v222
v_cndmask_b32 v2, v1, v222, s[44:45]
ds_read_b64 v[168:169], v2 offset:0
v_cndmask_b32 v2, v1, v222, s[46:47]
ds_read_b64 v[170:171], v2 offset:32
v_cndmask_b32 v2, v1, v222, s[48:49]
ds_read_b64 v[172:173], v2 offset:64
v_cndmask_b32 v2, v1, v222, s[50:51]
ds_read_b64 v[174:175], v2 offset:96
ds_read_b32 v5, v223
s_waitcnt lgkmcnt(7)
v_mfma_f32_16x16x32_bf16 v[160:163], v[104:107], v[136:139], v[160:163]
s_waitcnt lgkmcnt(5)
v_mfma_f32_16x16x32_bf16 v[164:167], v[104:107], v[140:143], v[164:167]
s_nop 7
v_permlane16_swap_b32 v160, v164
v_permlane16_swap_b32 v161, v165
v_permlane16_swap_b32 v162, v166
v_permlane16_swap_b32 v163, v167
v_cndmask_b32 v196, v164, v160, s[44:45]
v_cndmask_b32 v197, v165, v161, s[46:47]
v_cndmask_b32 v198, v166, v162, s[48:49]
v_cndmask_b32 v199, v167, v163, s[50:51]
s_waitcnt lgkmcnt(0)
v_mul_f32 v5, 0x3ea52b5c, v5
v_fma_f32 v196, v196, v168, v169
v_fma_f32 v197, v197, v170, v171
v_fma_f32 v198, v198, v172, v173
v_fma_f32 v199, v199, v174, v175
v_max3_f32 v6, v196, v197, v198
v_max_f32 v6, v6, v199
v_mov_b32 v7, v6
s_nop 1
v_permlane32_swap_b32 v6, v7
v_max_f32 v6, v6, v7
v_mul_f32 v6, v6, v5
v_fma_f32 v196, v196, v5, -v6
v_fma_f32 v197, v197, v5, -v6
v_fma_f32 v198, v198, v5, -v6
v_fma_f32 v199, v199, v5, -v6
v_exp_f32 v196, v196
v_exp_f32 v197, v197
v_exp_f32 v198, v198
v_exp_f32 v199, v199
ds_read_b64_tr_b16 v[64:65], v216 offset:0
ds_read_b64_tr_b16 v[66:67], v216 offset:1152
ds_read_b64_tr_b16 v[68:69], v216 offset:40
ds_read_b64_tr_b16 v[70:71], v216 offset:1192
ds_read_b64_tr_b16 v[72:73], v217 offset:0
ds_read_b64_tr_b16 v[74:75], v217 offset:1152
ds_read_b64_tr_b16 v[76:77], v218 offset:0
ds_read_b64_tr_b16 v[78:79], v218 offset:1152
v_add_f32 v6, v196, v197
v_add_f32 v7, v198, v199
v_add_f32 v6, v6, v7
v_mov_b32 v7, v6
v_mul_f32 v196, v196, v168
v_mul_f32 v197, v197, v170
v_permlane32_swap_b32 v6, v7
v_mul_f32 v198, v198, v172
v_add_f32 v6, v6, v7
v_rcp_f32 v6, v6
v_mul_f32 v199, v199, v174
v_mul_f32 v196, v196, v6
v_mul_f32 v197, v197, v6
v_mul_f32 v198, v198, v6
v_mul_f32 v199, v199, v6
v_cvt_pk_bf16_f32 v196, v196, v197
v_cvt_pk_bf16_f32 v197, v198, v199
s_mov_b64 exec, s[52:53]
v_and_b32 v176, v220, v196
v_bfi_b32 v180, v220, 0, v196
v_and_b32 v177, v221, v197
v_bfi_b32 v181, v221, 0, v197
s_not_b64 exec, exec
v_and_b32 v178, v220, v196
v_bfi_b32 v182, v220, 0, v196
v_and_b32 v179, v221, v197
v_bfi_b32 v183, v221, 0, v197
s_mov_b64 exec, -1
v_permlane16_swap_b32 v176, v180
v_permlane16_swap_b32 v177, v181
v_permlane16_swap_b32 v178, v182
v_permlane16_swap_b32 v179, v183
s_waitcnt lgkmcnt(0)
s_nop 0
v_mfma_f32_16x16x32_bf16 v[152:155], v[64:67], v[176:179], 0
v_mfma_f32_16x16x32_bf16 v[156:159], v[68:71], v[180:183], 0
v_mfma_f32_16x16x32_bf16 v[160:163], v[72:75], v[176:179], 0
v_mfma_f32_16x16x32_bf16 v[164:167], v[76:79], v[180:183], 0
s_nop 4
v_cvt_pk_bf16_f32 v196, v152, v153
v_cvt_pk_bf16_f32 v197, v154, v155
v_cvt_pk_bf16_f32 v198, v156, v157
v_cvt_pk_bf16_f32 v199, v158, v159
s_cmp_eq_u32 s41, 1
s_cbranch_scc0 L_gl_19g
buffer_store_dwordx4 v[196:199], v226, s[20:23], 0 offen
L_gl_19b:
s_lshl_b32 s0, s32, 2
s_add_u32 s0, s0, 1752
v_mov_b32 v1, s0
ds_read_b32 v1, v1
v_cvt_pk_bf16_f32 v80, v160, v161
v_cvt_pk_bf16_f32 v81, v162, v163
v_cvt_pk_bf16_f32 v82, v164, v165
v_cvt_pk_bf16_f32 v83, v166, v167
s_waitcnt lgkmcnt(0)
v_cmp_eq_u32 vcc, 0, v1
s_cbranch_vccnz L_spr
L_sbr:
s_mov_b64 exec, 0xffff
s_cmp_eq_u32 s41, 1
s_cbranch_scc0 L_gl_20g
buffer_store_dwordx4 v[80:83], v226, s[20:23], s54 offen
L_gl_20b:
s_mov_b64 exec, -1
v_lshrrev_b32 v1, 4, v0
v_lshlrev_b32 v1, 3, v1
s_lshl_b32 s3, s36, 7
buffer_load_dwordx2 v[244:245], v1, s[28:31], s3 offen offset:0
buffer_load_dwordx2 v[246:247], v1, s[28:31], s3 offen offset:32
buffer_load_dwordx2 v[248:249], v1, s[28:31], s3 offen offset:64
buffer_load_dwordx2 v[250:251], v1, s[28:31], s3 offen offset:96
v_lshlrev_b32 v8, 16, v236
v_and_b32 v9, 0xffff0000, v236
v_lshlrev_b32 v10, 16, v237
v_and_b32 v11, 0xffff0000, v237
v_lshlrev_b32 v12, 16, v238
v_and_b32 v13, 0xffff0000, v238
v_lshlrev_b32 v14, 16, v239
v_and_b32 v15, 0xffff0000, v239
v_lshlrev_b32 v16, 16, v240
v_and_b32 v17, 0xffff0000, v240
v_lshlrev_b32 v18, 16, v241
v_and_b32 v19, 0xffff0000, v241
v_lshlrev_b32 v20, 16, v242
v_and_b32 v21, 0xffff0000, v242
v_lshlrev_b32 v22, 16, v243
v_and_b32 v23, 0xffff0000, v243
s_lshl_b32 s0, s32, 13
s_add_u32 s0, s0, 57344
v_add_u32 v4, s0, v233
s_lshl_b32 s0, s32, 2
s_add_u32 s0, s0, 1760
s_waitcnt vmcnt(0)
s_mov_b32 s3, 0x3f803f80
v_mov_b32 v236, s3
v_mov_b32 v237, s3
v_mov_b32 v238, s3
v_mov_b32 v239, s3
s_mov_b32 exec_lo, 0x11111111
s_mov_b32 exec_hi, 0x11111111
v_mov_b32 v244, s3
v_mov_b32 v245, s3
v_mov_b32 v246, s3
v_mov_b32 v247, s3
v_mov_b32 v248, s3
v_mov_b32 v249, s3
v_mov_b32 v250, s3
v_mov_b32 v251, s3
s_mov_b64 exec, -1
v_mfma_f32_16x16x32_bf16 v[252:255], v[244:247], v[236:239], 0
v_mfma_f32_16x16x32_bf16 v[252:255], v[248:251], v[236:239], v[252:255]
v_mov_b32 v2, s0
L_fx:
s_sleep 1
ds_read_b32 v1, v2
s_waitcnt lgkmcnt(0)
v_cmp_ne_u32 vcc, 2, v1
s_cbranch_vccnz L_fx
s_setprio 2
ds_read_b128 v[24:27], v4 offset:0
ds_read_b128 v[28:31], v4 offset:1024
ds_read_b128 v[32:35], v4 offset:2048
ds_read_b128 v[36:39], v4 offset:3072
ds_read_b128 v[40:43], v4 offset:4096
ds_read_b128 v[44:47], v4 offset:5120
ds_read_b128 v[48:51], v4 offset:6144
ds_read_b128 v[52:55], v4 offset:7168
s_waitcnt lgkmcnt(7)
v_add_f32 v8, v8, v24
v_add_f32 v9, v9, v25
v_add_f32 v10, v10, v26
v_add_f32 v11, v11, v27
s_waitcnt lgkmcnt(6)
v_add_f32 v12, v12, v28
v_add_f32 v13, v13, v29
v_add_f32 v14, v14, v30
v_add_f32 v15, v15, v31
s_waitcnt lgkmcnt(5)
v_add_f32 v16, v16, v32
v_add_f32 v17, v17, v33
v_add_f32 v18, v18, v34
v_add_f32 v19, v19, v35
s_waitcnt lgkmcnt(4)
v_add_f32 v20, v20, v36
v_add_f32 v21, v21, v37
v_add_f32 v22, v22, v38
v_add_f32 v23, v23, v39
s_waitcnt lgkmcnt(3)
v_add_f32 v8, v8, v40
v_add_f32 v9, v9, v41
v_add_f32 v10, v10, v42
v_add_f32 v11, v11, v43
s_waitcnt lgkmcnt(2)
v_add_f32 v12, v12, v44
v_add_f32 v13, v13, v45
v_add_f32 v14, v14, v46
v_add_f32 v15, v15, v47
s_waitcnt lgkmcnt(1)
v_add_f32 v16, v16, v48
v_add_f32 v17, v17, v49
v_add_f32 v18, v18, v50
v_add_f32 v19, v19, v51
s_waitcnt lgkmcnt(0)
v_add_f32 v20, v20, v52
v_add_f32 v21, v21, v53
v_add_f32 v22, v22, v54
v_add_f32 v23, v23, v55
s_branch L_tail
L_gl_19g:
buffer_store_dwordx4 v[196:199], v226, s[20:23], 0 offen sc1
s_branch L_gl_19b
L_spr:
s_sleep 1
v_mov_b32 v1, s0
ds_read_b32 v1, v1
s_waitcnt lgkmcnt(0)
v_cmp_eq_u32 vcc, 0, v1
s_cbranch_vccnz L_spr
s_branch L_sbr
L_gl_20g:
buffer_store_dwordx4 v[80:83], v226, s[20:23], s54 offen sc1
s_branch L_gl_20b
L_moe:
s_cmp_ge_u32 s34, 32
s_cbranch_scc1 L_end
s_lshr_b32 s32, s32, 6
v_and_b32 v0, 63, v0
s_lshl_b32 s36, s33, 1
s_add_u32 s36, s36, s34
s_sub_u32 s36, s36, 30
s_mov_b32 s40, 524288
v_lshlrev_b32 v6, 4, v0
v_mov_b32 v132, 0
v_mov_b32 v133, 0
v_mov_b32 v144, 0
s_waitcnt lgkmcnt(0)
s_mov_b64 s[16:17], s[66:67]
s_mov_b32 s18, 0x10000000
s_mov_b32 s19, 0x20000
s_mov_b64 s[24:25], s[64:65]
s_mov_b32 s26, 0x100
s_mov_b32 s27, 0x20000
s_mov_b64 s[4:5], s[54:55]
s_mov_b32 s6, 0x1e0000
s_mov_b32 s7, 0x20000
s_mov_b64 s[8:9], s[56:57]
s_mov_b32 s10, 0x1e0000
s_mov_b32 s11, 0x20000
s_mov_b64 s[12:13], s[60:61]
s_mov_b32 s14, 0x1e0000
s_mov_b32 s15, 0x20000
s_mov_b64 s[20:21], s[62:63]
s_mov_b32 s22, 0x280000
s_mov_b32 s23, 0x20000
v_mov_b32 v8, -1
v_mov_b32 v9, -1
v_mov_b32 v10, -1
v_mov_b32 v11, -1
s_lshl_b32 s0, s36, 14
s_lshl_b32 s3, s32, 11
s_add_u32 s0, s0, s3
s_add_u32 s0, s0, 3145728
buffer_store_dwordx4 v[8:11], v6, s[16:19], s0 offen offset:0 sc1
buffer_store_dwordx4 v[8:11], v6, s[16:19], s0 offen offset:1024 sc1
s_and_b32 s44, s36, 1
s_mul_i32 s0, s33, 384
s_lshl_b32 s1, s44, 8
s_add_u32 s1, s1, s0
s_mul_i32 s3, s32, 24576
s_add_u32 s1, s1, s3
v_lshrrev_b32 v1, 3, v0
v_mul_u32_u24 v1, 3072, v1
s_lshr_b32 s3, s32, 1
v_xor_b32 v2, s3, v0
v_and_b32 v2, 7, v2
v_lshl_add_u32 v1, v2, 4, v1
v_add_u32 v4, s1, v1
v_xor_b32 v5, 64, v4
s_lshl_b32 s1, s44, 6
s_add_u32 s0, s0, s1
s_and_b32 s3, s32, 3
s_mul_i32 s1, s3, 49152
s_add_u32 s0, s0, s1
s_add_u32 s0, s0, 128
v_lshrrev_b32 v1, 2, v0
v_mul_u32_u24 v1, 3072, v1
v_xor_b32 v2, s3, v0
v_and_b32 v2, 3, v2
v_lshl_add_u32 v1, v2, 4, v1
v_add_u32 v249, s0, v1
s_cmp_lt_u32 s32, 4
s_cselect_b64 s[28:29], s[4:5], s[8:9]
s_cselect_b32 s62, 0, 128
s_mov_b32 s30, 0x1e0000
s_mov_b32 s31, 0x20000
s_lshl_b32 s61, s32, 10
s_add_u32 s62, s62, s61
s_mul_i32 s44, s44, 983040
s_mul_i32 s46, s36, 122880
s_and_b32 s3, s36, 1
s_cselect_b32 s65, 40960, 0
s_cselect_b32 s66, 0, 81920
s_add_u32 s65, s65, s46
s_add_u32 s66, s66, s46
s_add_u32 s67, s65, 40960
s_cmp_lt_u32 s32, 5
s_cbranch_scc1 L_r0
s_add_u32 s45, s44, 0
s_add_u32 m0, s61, 0
s_nop 0
buffer_load_dwordx4 v4, s[4:7], s45 offen lds
s_add_u32 m0, s61, 8192
s_nop 0
buffer_load_dwordx4 v5, s[8:11], s45 offen lds
s_add_u32 s45, s44, 0
s_add_u32 m0, s62, 16384
s_nop 0
buffer_load_dwordx4 v249, s[28:31], s45 offen lds
s_waitcnt vmcnt(3)
s_barrier
s_branch L_r1
L_r0:
s_waitcnt vmcnt(0)
s_barrier
s_cmp_eq_u32 s32, 0
s_cbranch_scc0 L_nroot
s_lshl_b32 s0, s36, 4
v_mov_b32 v8, 1
s_mov_b64 exec, 1
buffer_store_dword v8, off, s[24:27], s0 sc1
s_mov_b64 exec, -1
L_nroot:
s_add_u32 s45, s44, 0
s_add_u32 m0, s61, 0
s_nop 0
buffer_load_dwordx4 v4, s[4:7], s45 offen lds
s_add_u32 m0, s61, 8192
s_nop 0
buffer_load_dwordx4 v5, s[8:11], s45 offen lds
s_add_u32 s45, s44, 0
s_add_u32 m0, s62, 16384
s_nop 0
buffer_load_dwordx4 v249, s[28:31], s45 offen lds
L_r1:
s_add_u32 s45, s44, 196608
s_add_u32 m0, s61, 42240
s_nop 0
buffer_load_dwordx4 v4, s[4:7], s45 offen lds
s_add_u32 m0, s61, 50432
s_nop 0
buffer_load_dwordx4 v5, s[8:11], s45 offen lds
s_add_u32 s45, s44, 196608
s_add_u32 m0, s62, 58624
s_nop 0
buffer_load_dwordx4 v249, s[28:31], s45 offen lds
v_lshrrev_b32 v1, 5, v0
v_bfe_u32 v2, v0, 2, 1
v_lshl_add_u32 v1, v1, 2, v2
v_bfe_u32 v2, v0, 4, 1
v_bfe_u32 v3, v0, 3, 1
v_lshl_add_u32 v3, v3, 1, v2
v_lshl_add_u32 v1, v3, 4, v1
v_xor_b32 v3, s32, v3
v_and_b32 v2, 1, v0
v_lshlrev_b32 v2, 3, v2
v_lshl_add_u32 v2, v3, 4, v2
v_bfe_u32 v3, v0, 1, 1
v_lshl_add_u32 v251, v1, 6, v2
v_mul_u32_u24 v8, 4224, v3
v_add_u32 v251, v251, v8
v_lshl_add_u32 v250, v1, 7, v2
v_mul_u32_u24 v8, 8256, v3
v_xor_b32 v250, v250, v8
v_mov_b32 v228, 0
v_mov_b32 v229, 0
v_mov_b32 v230, 0
v_mov_b32 v231, 0
v_mov_b32 v232, 0
v_mov_b32 v233, 0
v_mov_b32 v234, 0
v_mov_b32 v235, 0
v_mov_b32 v1, 0x4444
v_mov_b32 v2, 0xeeee
s_mov_b32 vcc_lo, 0xaaaaaaaa
s_mov_b32 vcc_hi, 0xaaaaaaaa
v_cndmask_b32 v7, v1, v2, vcc
v_and_b32 v1, 48, v0
v_and_b32 v2, 1, v0
v_lshlrev_b32 v2, 4, v2
v_lshl_add_u32 v252, v1, 1, v2
v_add_u32 v254, 126720, v252
v_add_u32 v252, 127232, v252
v_add_u32 v1, 126848, v1
v_mov_b32 v2, 126912
v_cndmask_b32 v255, v1, v2, vcc
v_mov_b32 v3, 0
v_lshl_add_u32 v2, v0, 2, v2
s_mov_b32 exec_hi, 0
ds_write_b32 v2, v3
s_mov_b64 exec, -1
s_and_b32 s0, s32, 4
s_add_u32 s0, s0, s32
v_bfe_u32 v1, v0, 4, 1
v_lshl_add_u32 v1, v1, 2, s0
v_lshrrev_b32 v2, 1, v1
v_lshlrev_b32 v2, 2, v2
v_and_or_b32 v2, v1, 1, v2
v_and_or_b32 v2, v0, 2, v2
v_bfe_u32 v3, v0, 2, 1
v_lshl_add_u32 v2, v2, 1, v3
v_and_b32 v3, 1, v0
v_lshl_add_u32 v2, v2, 1, v3
v_and_b32 v3, 7, v0
v_lshl_add_u32 v3, v1, 3, v3
v_cmp_gt_u32 vcc, 8, v1
s_nop 1
v_cndmask_b32 v2, v3, v2, vcc
v_lshlrev_b32 v2, 1, v2
v_add_u32 v253, 126720, v2
s_lshl_b32 s47, s32, 15
s_lshl_b32 s3, s36, 6
s_add_u32 s47, s47, s3
s_add_u32 s47, s47, 3162112
v_lshrrev_b32 v1, 2, v0
v_and_b32 v2, 3, v0
v_lshlrev_b32 v2, 4, v2
v_lshl_add_u32 v2, v1, 10, v2
v_lshlrev_b32 v1, 4, v1
v_add_u32 v1, 4032, v1
s_mov_b64 vcc, 0xffff
v_cndmask_b32 v246, v1, v2, vcc
s_cmp_lt_u32 s32, 4
s_cselect_b32 s50, 0x00ff0000, 0
s_or_b32 s50, s50, 0xff
s_mov_b32 s51, 0
s_sub_u32 s3, s32, 4
s_lshl_b32 s3, s3, 4
s_add_u32 s52, s3, s36
s_mul_i32 s3, s52, 52
s_lshr_b32 s3, s3, 8
s_mul_i32 s3, s3, 27648
s_lshl_b32 s53, s52, 10
s_add_u32 s53, s53, s3
s_add_u32 s53, s53, 3162112
s_mov_b32 s49, 131072
s_mov_b32 s63, 0
s_mul_i32 s3, s52, 52
s_lshr_b32 s3, s3, 8
s_mul_i32 s0, s3, 5
s_sub_u32 s0, s52, s0
s_mul_i32 s3, s3, 80
s_lshl_b32 s1, s0, 2
s_cmp_eq_u32 s0, 4
s_cselect_b32 s1, 64, s1
s_cselect_b32 s0, 0, 4
s_cselect_b32 s48, 2, 0
s_add_u32 s3, s3, s1
v_bfe_u32 v1, v0, 4, 1
v_lshrrev_b32 v2, 5, v0
v_lshl_add_u32 v1, v1, 1, v2
v_lshlrev_b32 v1, s0, v1
v_and_b32 v2, 3, v0
v_lshlrev_b32 v2, s48, v2
v_add3_u32 v1, v1, v2, s3
v_lshlrev_b32 v128, 1, v1
v_lshlrev_b32 v129, 2, v1
v_lshrrev_b32 v1, 4, v0
v_bfe_u32 v2, v0, 2, 2
v_lshl_add_u32 v1, v1, 3, v2
v_mul_u32_u24 v1, 1280, v1
v_and_b32 v3, 1, v0
v_lshl_add_u32 v1, v3, 3, v1
v_bfe_u32 v2, v0, 2, 3
v_lshlrev_b32 v2, 1, v2
v_bfe_u32 v3, v0, 1, 1
s_mul_i32 s0, s32, 10
s_add_u32 s3, s0, 0
v_add_u32 v236, s3, v3
v_xor_b32 v236, v236, v2
v_lshl_add_u32 v236, v236, 4, v1
s_add_u32 s3, s0, 2
v_add_u32 v237, s3, v3
v_xor_b32 v237, v237, v2
v_lshl_add_u32 v237, v237, 4, v1
s_add_u32 s3, s0, 4
v_add_u32 v238, s3, v3
v_xor_b32 v238, v238, v2
v_lshl_add_u32 v238, v238, 4, v1
s_add_u32 s3, s0, 6
v_add_u32 v239, s3, v3
v_xor_b32 v239, v239, v2
v_lshl_add_u32 v239, v239, 4, v1
s_add_u32 s3, s0, 8
v_add_u32 v240, s3, v3
v_xor_b32 v240, v240, v2
v_lshl_add_u32 v240, v240, 4, v1
s_waitcnt vmcnt(3) lgkmcnt(0)
s_barrier
s_add_u32 s45, s44, 393216
s_add_u32 m0, s61, 84480
s_nop 0
buffer_load_dwordx4 v4, s[4:7], s45 offen lds
s_add_u32 m0, s61, 92672
s_nop 0
buffer_load_dwordx4 v5, s[8:11], s45 offen lds
s_add_u32 s45, s44, 393216
s_add_u32 m0, s62, 100864
s_nop 0
buffer_load_dwordx4 v249, s[28:31], s45 offen lds
v_add_u32 v1, 0, v250
ds_read_b64_tr_b16 v[8:9], v1 offset:0
ds_read_b64_tr_b16 v[10:11], v1 offset:256
ds_read_b64_tr_b16 v[12:13], v1 offset:1024
ds_read_b64_tr_b16 v[14:15], v1 offset:1280
s_cmp_lt_u32 s32, 4
s_cbranch_scc0 L_g0
v_add_u32 v1, 16384, v251
ds_read_b64_tr_b16 v[88:89], v1 offset:0
ds_read_b64_tr_b16 v[90:91], v1 offset:128
ds_read_b64_tr_b16 v[92:93], v1 offset:512
ds_read_b64_tr_b16 v[94:95], v1 offset:640
L_g0:
s_waitcnt vmcnt(3) lgkmcnt(0)
s_barrier
s_add_u32 s45, s44, 589824
s_add_u32 m0, s61, 0
s_nop 0
buffer_load_dwordx4 v4, s[4:7], s45 offen lds
s_add_u32 m0, s61, 8192
s_nop 0
buffer_load_dwordx4 v5, s[8:11], s45 offen lds
s_add_u32 s45, s44, 589824
s_add_u32 m0, s62, 16384
s_nop 0
buffer_load_dwordx4 v249, s[28:31], s45 offen lds
v_add_u32 v1, 42240, v250
ds_read_b64_tr_b16 v[16:17], v1 offset:0
ds_read_b64_tr_b16 v[18:19], v1 offset:256
ds_read_b64_tr_b16 v[20:21], v1 offset:1024
ds_read_b64_tr_b16 v[22:23], v1 offset:1280
s_cmp_lt_u32 s32, 4
s_cbranch_scc0 L_g1
v_add_u32 v1, 58624, v251
ds_read_b64_tr_b16 v[96:97], v1 offset:0
ds_read_b64_tr_b16 v[98:99], v1 offset:128
ds_read_b64_tr_b16 v[100:101], v1 offset:512
ds_read_b64_tr_b16 v[102:103], v1 offset:640
L_g1:
s_waitcnt vmcnt(3) lgkmcnt(0)
s_barrier
s_add_u32 s45, s44, 786432
s_add_u32 m0, s61, 42240
s_nop 0
buffer_load_dwordx4 v4, s[4:7], s45 offen lds
s_add_u32 m0, s61, 50432
s_nop 0
buffer_load_dwordx4 v5, s[8:11], s45 offen lds
s_add_u32 s45, s44, 786432
s_add_u32 m0, s62, 58624
s_nop 0
buffer_load_dwordx4 v249, s[28:31], s45 offen lds
v_add_u32 v1, 84480, v250
ds_read_b64_tr_b16 v[24:25], v1 offset:0
ds_read_b64_tr_b16 v[26:27], v1 offset:256
ds_read_b64_tr_b16 v[28:29], v1 offset:1024
ds_read_b64_tr_b16 v[30:31], v1 offset:1280
s_cmp_lt_u32 s32, 4
s_cbranch_scc0 L_g2
v_add_u32 v1, 100864, v251
ds_read_b64_tr_b16 v[104:105], v1 offset:0
ds_read_b64_tr_b16 v[106:107], v1 offset:128
ds_read_b64_tr_b16 v[108:109], v1 offset:512
ds_read_b64_tr_b16 v[110:111], v1 offset:640
L_g2:
s_waitcnt vmcnt(3) lgkmcnt(0)
s_barrier
s_sub_u32 s45, 983040, s44
s_add_u32 m0, s61, 84480
s_nop 0
buffer_load_dwordx4 v4, s[4:7], s45 offen lds
s_add_u32 m0, s61, 92672
s_nop 0
buffer_load_dwordx4 v5, s[8:11], s45 offen lds
s_sub_u32 s45, 1179648, s44
s_add_u32 m0, s61, 100864
s_nop 0
buffer_load_dwordx4 v4, s[4:7], s45 offen lds
s_add_u32 m0, s61, 109056
s_nop 0
buffer_load_dwordx4 v5, s[8:11], s45 offen lds
v_add_u32 v1, 0, v250
ds_read_b64_tr_b16 v[32:33], v1 offset:0
ds_read_b64_tr_b16 v[34:35], v1 offset:256
ds_read_b64_tr_b16 v[36:37], v1 offset:1024
ds_read_b64_tr_b16 v[38:39], v1 offset:1280
s_cmp_lt_u32 s32, 4
s_cbranch_scc0 L_g3
v_add_u32 v1, 16384, v251
ds_read_b64_tr_b16 v[112:113], v1 offset:0
ds_read_b64_tr_b16 v[114:115], v1 offset:128
ds_read_b64_tr_b16 v[116:117], v1 offset:512
ds_read_b64_tr_b16 v[118:119], v1 offset:640
L_g3:
s_waitcnt vmcnt(4) lgkmcnt(0)
s_barrier
s_sub_u32 s45, 1376256, s44
s_add_u32 m0, s61, 0
s_nop 0
buffer_load_dwordx4 v4, s[4:7], s45 offen lds
s_add_u32 m0, s61, 8192
s_nop 0
buffer_load_dwordx4 v5, s[8:11], s45 offen lds
s_sub_u32 s45, 1572864, s44
s_add_u32 m0, s61, 16384
s_nop 0
buffer_load_dwordx4 v4, s[4:7], s45 offen lds
s_add_u32 m0, s61, 24576
s_nop 0
buffer_load_dwordx4 v5, s[8:11], s45 offen lds
v_add_u32 v1, 42240, v250
ds_read_b64_tr_b16 v[40:41], v1 offset:0
ds_read_b64_tr_b16 v[42:43], v1 offset:256
ds_read_b64_tr_b16 v[44:45], v1 offset:1024
ds_read_b64_tr_b16 v[46:47], v1 offset:1280
s_cmp_lt_u32 s32, 4
s_cbranch_scc0 L_g4
v_add_u32 v1, 58624, v251
ds_read_b64_tr_b16 v[120:121], v1 offset:0
ds_read_b64_tr_b16 v[122:123], v1 offset:128
ds_read_b64_tr_b16 v[124:125], v1 offset:512
ds_read_b64_tr_b16 v[126:127], v1 offset:640
L_g4:
s_waitcnt vmcnt(4) lgkmcnt(0)
s_barrier
s_sub_u32 s45, 1769472, s44
s_add_u32 m0, s61, 42240
s_nop 0
buffer_load_dwordx4 v4, s[4:7], s45 offen lds
s_add_u32 m0, s61, 50432
s_nop 0
buffer_load_dwordx4 v5, s[8:11], s45 offen lds
v_add_u32 v1, 84480, v250
ds_read_b64_tr_b16 v[48:49], v1 offset:0
ds_read_b64_tr_b16 v[50:51], v1 offset:256
ds_read_b64_tr_b16 v[52:53], v1 offset:1024
ds_read_b64_tr_b16 v[54:55], v1 offset:1280
v_add_u32 v1, 100864, v250
ds_read_b64_tr_b16 v[56:57], v1 offset:0
ds_read_b64_tr_b16 v[58:59], v1 offset:256
ds_read_b64_tr_b16 v[60:61], v1 offset:1024
ds_read_b64_tr_b16 v[62:63], v1 offset:1280
v_and_b32 v248, 0xf0, v6
buffer_load_dword v247, v248, s[24:27], 0 offen sc1
s_waitcnt vmcnt(3) lgkmcnt(0)
s_barrier
s_lshl_b32 s3, s32, 6
s_addk_i32 s3, 0
v_add_u32 v1, s3, v0
v_mul_u32_u24 v2, 52429, v1
v_lshrrev_b32 v2, 22, v2
v_and_b32 v3, 3, v2
v_lshlrev_b32 v3, 1, v3
v_and_or_b32 v3, v2, 8, v3
v_xor_b32 v1, v1, v3
v_lshlrev_b32 v1, 4, v1
s_add_u32 m0, s61, 84480
s_nop 0
buffer_load_dwordx4 v1, s[12:15], s65 offen lds
s_lshl_b32 s3, s32, 6
s_addk_i32 s3, 512
v_add_u32 v1, s3, v0
v_mul_u32_u24 v2, 52429, v1
v_lshrrev_b32 v2, 22, v2
v_and_b32 v3, 3, v2
v_lshlrev_b32 v3, 1, v3
v_and_or_b32 v3, v2, 8, v3
v_xor_b32 v1, v1, v3
v_lshlrev_b32 v1, 4, v1
s_add_u32 m0, s61, 92672
s_nop 0
buffer_load_dwordx4 v1, s[12:15], s65 offen lds
s_lshl_b32 s3, s32, 6
s_addk_i32 s3, 1024
v_add_u32 v1, s3, v0
v_mul_u32_u24 v2, 52429, v1
v_lshrrev_b32 v2, 22, v2
v_and_b32 v3, 3, v2
v_lshlrev_b32 v3, 1, v3
v_and_or_b32 v3, v2, 8, v3
v_xor_b32 v1, v1, v3
v_lshlrev_b32 v1, 4, v1
s_add_u32 m0, s61, 100864
s_nop 0
buffer_load_dwordx4 v1, s[12:15], s65 offen lds
s_lshl_b32 s3, s32, 6
s_addk_i32 s3, 1536
v_add_u32 v1, s3, v0
v_mul_u32_u24 v2, 52429, v1
v_lshrrev_b32 v2, 22, v2
v_and_b32 v3, 3, v2
v_lshlrev_b32 v3, 1, v3
v_and_or_b32 v3, v2, 8, v3
v_xor_b32 v1, v1, v3
v_lshlrev_b32 v1, 4, v1
s_add_u32 m0, s61, 109056
s_nop 0
buffer_load_dwordx4 v1, s[12:15], s65 offen lds
s_lshl_b32 s3, s32, 6
s_addk_i32 s3, 2048
v_add_u32 v1, s3, v0
v_mul_u32_u24 v2, 52429, v1
v_lshrrev_b32 v2, 22, v2
v_and_b32 v3, 3, v2
v_lshlrev_b32 v3, 1, v3
v_and_or_b32 v3, v2, 8, v3
v_xor_b32 v1, v1, v3
v_lshlrev_b32 v1, 4, v1
s_add_u32 m0, s61, 117248
s_nop 0
buffer_load_dwordx4 v1, s[12:15], s65 offen lds
v_add_u32 v1, 0, v250
ds_read_b64_tr_b16 v[64:65], v1 offset:0
ds_read_b64_tr_b16 v[66:67], v1 offset:256
ds_read_b64_tr_b16 v[68:69], v1 offset:1024
ds_read_b64_tr_b16 v[70:71], v1 offset:1280
v_add_u32 v1, 16384, v250
ds_read_b64_tr_b16 v[72:73], v1 offset:0
ds_read_b64_tr_b16 v[74:75], v1 offset:256
ds_read_b64_tr_b16 v[76:77], v1 offset:1024
ds_read_b64_tr_b16 v[78:79], v1 offset:1280
s_waitcnt vmcnt(5) lgkmcnt(0)
s_barrier
s_lshl_b32 s3, s32, 6
s_addk_i32 s3, 0
v_add_u32 v1, s3, v0
v_mul_u32_u24 v2, 52429, v1
v_lshrrev_b32 v2, 22, v2
v_and_b32 v3, 3, v2
v_lshlrev_b32 v3, 1, v3
v_and_or_b32 v3, v2, 8, v3
v_xor_b32 v1, v1, v3
v_lshlrev_b32 v1, 4, v1
s_add_u32 m0, s61, 0
s_nop 0
buffer_load_dwordx4 v1, s[12:15], s66 offen lds
s_lshl_b32 s3, s32, 6
s_addk_i32 s3, 512
v_add_u32 v1, s3, v0
v_mul_u32_u24 v2, 52429, v1
v_lshrrev_b32 v2, 22, v2
v_and_b32 v3, 3, v2
v_lshlrev_b32 v3, 1, v3
v_and_or_b32 v3, v2, 8, v3
v_xor_b32 v1, v1, v3
v_lshlrev_b32 v1, 4, v1
s_add_u32 m0, s61, 8192
s_nop 0
buffer_load_dwordx4 v1, s[12:15], s66 offen lds
s_lshl_b32 s3, s32, 6
s_addk_i32 s3, 1024
v_add_u32 v1, s3, v0
v_mul_u32_u24 v2, 52429, v1
v_lshrrev_b32 v2, 22, v2
v_and_b32 v3, 3, v2
v_lshlrev_b32 v3, 1, v3
v_and_or_b32 v3, v2, 8, v3
v_xor_b32 v1, v1, v3
v_lshlrev_b32 v1, 4, v1
s_add_u32 m0, s61, 16384
s_nop 0
buffer_load_dwordx4 v1, s[12:15], s66 offen lds
s_lshl_b32 s3, s32, 6
s_addk_i32 s3, 1536
v_add_u32 v1, s3, v0
v_mul_u32_u24 v2, 52429, v1
v_lshrrev_b32 v2, 22, v2
v_and_b32 v3, 3, v2
v_lshlrev_b32 v3, 1, v3
v_and_or_b32 v3, v2, 8, v3
v_xor_b32 v1, v1, v3
v_lshlrev_b32 v1, 4, v1
s_add_u32 m0, s61, 24576
s_nop 0
buffer_load_dwordx4 v1, s[12:15], s66 offen lds
s_lshl_b32 s3, s32, 6
s_addk_i32 s3, 2048
v_add_u32 v1, s3, v0
v_mul_u32_u24 v2, 52429, v1
v_lshrrev_b32 v2, 22, v2
v_and_b32 v3, 3, v2
v_lshlrev_b32 v3, 1, v3
v_and_or_b32 v3, v2, 8, v3
v_xor_b32 v1, v1, v3
v_lshlrev_b32 v1, 4, v1
s_add_u32 m0, s61, 32768
s_nop 0
buffer_load_dwordx4 v1, s[12:15], s66 offen lds
v_add_u32 v1, 42240, v250
ds_read_b64_tr_b16 v[80:81], v1 offset:0
ds_read_b64_tr_b16 v[82:83], v1 offset:256
ds_read_b64_tr_b16 v[84:85], v1 offset:1024
ds_read_b64_tr_b16 v[86:87], v1 offset:1280
s_waitcnt vmcnt(5) lgkmcnt(0)
s_barrier
s_lshl_b32 s3, s32, 6
s_addk_i32 s3, 0
v_add_u32 v1, s3, v0
v_mul_u32_u24 v2, 52429, v1
v_lshrrev_b32 v2, 22, v2
v_and_b32 v3, 3, v2
v_lshlrev_b32 v3, 1, v3
v_and_or_b32 v3, v2, 8, v3
v_xor_b32 v1, v1, v3
v_lshlrev_b32 v1, 4, v1
s_add_u32 m0, s61, 42240
s_nop 0
buffer_load_dwordx4 v1, s[12:15], s67 offen lds
s_lshl_b32 s3, s32, 6
s_addk_i32 s3, 512
v_add_u32 v1, s3, v0
v_mul_u32_u24 v2, 52429, v1
v_lshrrev_b32 v2, 22, v2
v_and_b32 v3, 3, v2
v_lshlrev_b32 v3, 1, v3
v_and_or_b32 v3, v2, 8, v3
v_xor_b32 v1, v1, v3
v_lshlrev_b32 v1, 4, v1
s_add_u32 m0, s61, 50432
s_nop 0
buffer_load_dwordx4 v1, s[12:15], s67 offen lds
s_lshl_b32 s3, s32, 6
s_addk_i32 s3, 1024
v_add_u32 v1, s3, v0
v_mul_u32_u24 v2, 52429, v1
v_lshrrev_b32 v2, 22, v2
v_and_b32 v3, 3, v2
v_lshlrev_b32 v3, 1, v3
v_and_or_b32 v3, v2, 8, v3
v_xor_b32 v1, v1, v3
v_lshlrev_b32 v1, 4, v1
s_add_u32 m0, s61, 58624
s_nop 0
buffer_load_dwordx4 v1, s[12:15], s67 offen lds
s_lshl_b32 s3, s32, 6
s_addk_i32 s3, 1536
v_add_u32 v1, s3, v0
v_mul_u32_u24 v2, 52429, v1
v_lshrrev_b32 v2, 22, v2
v_and_b32 v3, 3, v2
v_lshlrev_b32 v3, 1, v3
v_and_or_b32 v3, v2, 8, v3
v_xor_b32 v1, v1, v3
v_lshlrev_b32 v1, 4, v1
s_add_u32 m0, s61, 66816
s_nop 0
buffer_load_dwordx4 v1, s[12:15], s67 offen lds
s_lshl_b32 s3, s32, 6
s_addk_i32 s3, 2048
v_add_u32 v1, s3, v0
v_mul_u32_u24 v2, 52429, v1
v_lshrrev_b32 v2, 22, v2
v_and_b32 v3, 3, v2
v_lshlrev_b32 v3, 1, v3
v_and_or_b32 v3, v2, 8, v3
v_xor_b32 v1, v1, v3
v_lshlrev_b32 v1, 4, v1
s_add_u32 m0, s61, 75008
s_nop 0
buffer_load_dwordx4 v1, s[12:15], s67 offen lds
v_add_u32 v1, 84480, v236
ds_read_b64_tr_b16 v[168:169], v1 offset:0
ds_read_b64_tr_b16 v[170:171], v1 offset:5120
v_add_u32 v1, 84480, v237
ds_read_b64_tr_b16 v[180:181], v1 offset:0
ds_read_b64_tr_b16 v[182:183], v1 offset:5120
v_add_u32 v1, 84480, v238
ds_read_b64_tr_b16 v[192:193], v1 offset:0
ds_read_b64_tr_b16 v[194:195], v1 offset:5120
v_add_u32 v1, 84480, v239
ds_read_b64_tr_b16 v[204:205], v1 offset:0
ds_read_b64_tr_b16 v[206:207], v1 offset:5120
v_add_u32 v1, 84480, v240
ds_read_b64_tr_b16 v[216:217], v1 offset:0
ds_read_b64_tr_b16 v[218:219], v1 offset:5120
s_waitcnt vmcnt(5) lgkmcnt(0)
s_barrier
s_sub_u32 s45, 983040, s44
s_add_u32 m0, s62, 84480
s_nop 0
buffer_load_dwordx4 v249, s[28:31], s45 offen lds
s_sub_u32 s45, 1179648, s44
s_add_u32 m0, s62, 92928
s_nop 0
buffer_load_dwordx4 v249, s[28:31], s45 offen lds
s_sub_u32 s45, 1376256, s44
s_add_u32 m0, s62, 101376
s_nop 0
buffer_load_dwordx4 v249, s[28:31], s45 offen lds
s_sub_u32 s45, 1572864, s44
s_add_u32 m0, s62, 109824
s_nop 0
buffer_load_dwordx4 v249, s[28:31], s45 offen lds
s_sub_u32 s45, 1769472, s44
s_add_u32 m0, s62, 118272
s_nop 0
buffer_load_dwordx4 v249, s[28:31], s45 offen lds
v_add_u32 v1, 0, v236
ds_read_b64_tr_b16 v[172:173], v1 offset:0
ds_read_b64_tr_b16 v[174:175], v1 offset:5120
v_add_u32 v1, 0, v237
ds_read_b64_tr_b16 v[184:185], v1 offset:0
ds_read_b64_tr_b16 v[186:187], v1 offset:5120
v_add_u32 v1, 0, v238
ds_read_b64_tr_b16 v[196:197], v1 offset:0
ds_read_b64_tr_b16 v[198:199], v1 offset:5120
v_add_u32 v1, 0, v239
ds_read_b64_tr_b16 v[208:209], v1 offset:0
ds_read_b64_tr_b16 v[210:211], v1 offset:5120
v_add_u32 v1, 0, v240
ds_read_b64_tr_b16 v[220:221], v1 offset:0
ds_read_b64_tr_b16 v[222:223], v1 offset:5120
s_waitcnt vmcnt(5) lgkmcnt(0)
s_barrier
v_add_u32 v1, 42240, v236
ds_read_b64_tr_b16 v[176:177], v1 offset:0
ds_read_b64_tr_b16 v[178:179], v1 offset:5120
v_add_u32 v1, 42240, v237
ds_read_b64_tr_b16 v[188:189], v1 offset:0
ds_read_b64_tr_b16 v[190:191], v1 offset:5120
v_add_u32 v1, 42240, v238
ds_read_b64_tr_b16 v[200:201], v1 offset:0
ds_read_b64_tr_b16 v[202:203], v1 offset:5120
v_add_u32 v1, 42240, v239
ds_read_b64_tr_b16 v[212:213], v1 offset:0
ds_read_b64_tr_b16 v[214:215], v1 offset:5120
v_add_u32 v1, 42240, v240
ds_read_b64_tr_b16 v[224:225], v1 offset:0
ds_read_b64_tr_b16 v[226:227], v1 offset:5120
s_waitcnt vmcnt(0) lgkmcnt(0)
s_barrier
s_cmp_lt_u32 s32, 4
s_cbranch_scc0 L_g11
v_add_u32 v1, 84480, v251
ds_read_b64_tr_b16 v[128:129], v1 offset:0
ds_read_b64_tr_b16 v[130:131], v1 offset:128
ds_read_b64_tr_b16 v[132:133], v1 offset:512
ds_read_b64_tr_b16 v[134:135], v1 offset:640
v_add_u32 v1, 92928, v251
ds_read_b64_tr_b16 v[136:137], v1 offset:0
ds_read_b64_tr_b16 v[138:139], v1 offset:128
ds_read_b64_tr_b16 v[140:141], v1 offset:512
ds_read_b64_tr_b16 v[142:143], v1 offset:640
v_add_u32 v1, 101376, v251
ds_read_b64_tr_b16 v[144:145], v1 offset:0
ds_read_b64_tr_b16 v[146:147], v1 offset:128
ds_read_b64_tr_b16 v[148:149], v1 offset:512
ds_read_b64_tr_b16 v[150:151], v1 offset:640
v_add_u32 v1, 109824, v251
ds_read_b64_tr_b16 v[152:153], v1 offset:0
ds_read_b64_tr_b16 v[154:155], v1 offset:128
ds_read_b64_tr_b16 v[156:157], v1 offset:512
ds_read_b64_tr_b16 v[158:159], v1 offset:640
v_add_u32 v1, 118272, v251
ds_read_b64_tr_b16 v[160:161], v1 offset:0
ds_read_b64_tr_b16 v[162:163], v1 offset:128
ds_read_b64_tr_b16 v[164:165], v1 offset:512
ds_read_b64_tr_b16 v[166:167], v1 offset:640
L_g11:
s_branch L_pb_26
.p2align 12
L_pb_26:
s_call_b64 s[100:101], L_pad_27
s_call_b64 s[100:101], L_pad_28
s_call_b64 s[100:101], L_pad_29
s_call_b64 s[100:101], L_pad_30
v_mov_b32 v5, v246
v_mov_b32 v4, 126976
s_mov_b32 s61, 0
s_cmp_lt_u32 s32, 7
s_cbranch_scc1 L_np
L_rt:
v_cmp_ne_u32 vcc, 1, v247
s_cbranch_vccz L_rtg
buffer_load_dword v247, v248, s[24:27], 0 offen sc1
s_waitcnt vmcnt(0)
s_sub_u32 s40, s40, 1
s_cbranch_scc0 L_rt
s_mov_b32 s40, 0
L_rtg:
v_bfe_u32 v1, v0, 2, 3
v_lshlrev_b32 v1, 15, v1
v_and_b32 v2, 3, v0
v_min_u32 v2, 2, v2
v_mul_u32_u24 v3, 1280, v2
s_mov_b32 s0, 3145728
v_add3_u32 v147, v3, v1, s0
v_lshl_add_u32 v144, v2, 7, v1
s_mul_i32 s0, s36, 384
s_add_u32 s64, s0, 3167232
s_and_b32 s3, s36, 1
s_mul_i32 s3, s3, 640
v_add_u32 v132, s3, v6
v_subrev_u32 v2, 1280, v132
v_min_u32 v132, v132, v2
s_sub_u32 s3, 1024, s3
v_add_u32 v133, s3, v6
s_mov_b32 s54, 0
s_mov_b32 s55, 0x80000000
s_mov_b32 s60, 1073741824
s_setprio 3
v_mov_b32 v140, -1
v_mov_b32 v141, -1
v_mov_b32 v142, -1
s_mov_b32 m0, 127232
s_mov_b64 exec, -1
buffer_load_dwordx4 v132, s[16:19], s55 offen sc1 lds
s_mov_b32 m0, 128256
s_mov_b64 exec, 0xffff
buffer_load_dwordx4 v133, s[16:19], s55 offen sc1 lds
s_mov_b64 exec, 0x77777777
buffer_atomic_umin v140, v144, s[16:19], s64 offen sc0 sc1
s_sleep 2
s_mov_b32 m0, 127232
s_mov_b64 exec, -1
buffer_load_dwordx4 v132, s[16:19], s55 offen sc1 lds
s_mov_b32 m0, 128256
s_mov_b64 exec, 0xffff
buffer_load_dwordx4 v133, s[16:19], s55 offen sc1 lds
s_mov_b64 exec, 0x77777777
buffer_atomic_umin v141, v144, s[16:19], s64 offen sc0 sc1
s_sleep 2
L_pl0:
s_mov_b32 m0, 127232
s_mov_b64 exec, -1
s_nop 0
buffer_load_dwordx4 v132, s[16:19], s55 offen sc1 lds
s_mov_b32 m0, 128256
s_mov_b64 exec, 0xffff
buffer_load_dwordx4 v133, s[16:19], s55 offen sc1 lds
s_mov_b64 exec, 0x77777777
buffer_atomic_umin v142, v144, s[16:19], s64 offen sc0 sc1
s_mov_b32 s62, 0
s_cmp_eq_u32 s61, 2
s_cbranch_scc1 L_ab
L_pi0:
s_waitcnt vmcnt(6)
v_cmp_lt_u32 vcc, s54, v140
s_sub_u32 s60, s60, 1
s_cbranch_vccz L_pw
s_cselect_b32 s0, s61, 1
s_max_i32 s60, s60, 0
v_cmp_eq_u32 s[58:59], -1, v140
v_mov_b32 v146, v140
s_andn2_b64 vcc, vcc, s[58:59]
s_cbranch_scc0 L_pq0
s_mov_b64 exec, -1
v_cndmask_b32 v146, 0, v146, vcc
s_lshl_b32 s61, s61, 1
s_nop 0
v_max_u32_dpp v236, v146, v146 row_ror:8 row_mask:0xf bank_mask:0xf
s_nop 1
v_max_u32_dpp v236, v236, v236 row_ror:4 row_mask:0xf bank_mask:0xf
s_nop 1
v_max_u32_dpp v236, v236, v236 row_ror:2 row_mask:0xf bank_mask:0xf
s_nop 1
v_max_u32_dpp v236, v236, v236 row_ror:1 row_mask:0xf bank_mask:0xf
v_mov_b32 v237, v236
s_mov_b32 s60, 2
s_nop 0
v_permlane16_swap_b32 v236, v237
v_max_u32 v236, v236, v237
s_mov_b32 exec_hi, 0
v_cmpx_eq_u32 vcc, v236, v146
ds_write_b64 v4, v[146:147]
s_nop 2
v_readfirstlane_b32 s55, v147
v_readfirstlane_b32 s54, v146
s_branch L_pl1
L_pq0:
s_cmp_eq_u32 s0, 0
s_cselect_b32 s61, 1, s61
s_cbranch_scc1 L_pg
s_sleep 2
L_pl1:
s_mov_b32 m0, 127232
s_mov_b64 exec, -1
s_nop 0
buffer_load_dwordx4 v132, s[16:19], s55 offen sc1 lds
s_mov_b32 m0, 128256
s_mov_b64 exec, 0xffff
buffer_load_dwordx4 v133, s[16:19], s55 offen sc1 lds
s_mov_b64 exec, 0x77777777
buffer_atomic_umin v140, v144, s[16:19], s64 offen sc0 sc1
s_mov_b32 s62, 1
s_cmp_eq_u32 s61, 2
s_cbranch_scc1 L_ab
L_pi1:
s_waitcnt vmcnt(6)
v_cmp_lt_u32 vcc, s54, v141
s_sub_u32 s60, s60, 1
s_cbranch_vccz L_pw
s_cselect_b32 s0, s61, 1
s_max_i32 s60, s60, 0
v_cmp_eq_u32 s[58:59], -1, v141
v_mov_b32 v146, v141
s_andn2_b64 vcc, vcc, s[58:59]
s_cbranch_scc0 L_pq1
s_mov_b64 exec, -1
v_cndmask_b32 v146, 0, v146, vcc
s_lshl_b32 s61, s61, 1
s_nop 0
v_max_u32_dpp v236, v146, v146 row_ror:8 row_mask:0xf bank_mask:0xf
s_nop 1
v_max_u32_dpp v236, v236, v236 row_ror:4 row_mask:0xf bank_mask:0xf
s_nop 1
v_max_u32_dpp v236, v236, v236 row_ror:2 row_mask:0xf bank_mask:0xf
s_nop 1
v_max_u32_dpp v236, v236, v236 row_ror:1 row_mask:0xf bank_mask:0xf
v_mov_b32 v237, v236
s_mov_b32 s60, 2
s_nop 0
v_permlane16_swap_b32 v236, v237
v_max_u32 v236, v236, v237
s_mov_b32 exec_hi, 0
v_cmpx_eq_u32 vcc, v236, v146
ds_write_b64 v4, v[146:147]
s_nop 2
v_readfirstlane_b32 s55, v147
v_readfirstlane_b32 s54, v146
s_branch L_pl2
L_pq1:
s_cmp_eq_u32 s0, 0
s_cselect_b32 s61, 1, s61
s_cbranch_scc1 L_pg
s_sleep 2
L_pl2:
s_mov_b32 m0, 127232
s_mov_b64 exec, -1
s_nop 0
buffer_load_dwordx4 v132, s[16:19], s55 offen sc1 lds
s_mov_b32 m0, 128256
s_mov_b64 exec, 0xffff
buffer_load_dwordx4 v133, s[16:19], s55 offen sc1 lds
s_mov_b64 exec, 0x77777777
buffer_atomic_umin v141, v144, s[16:19], s64 offen sc0 sc1
s_mov_b32 s62, 2
s_cmp_eq_u32 s61, 2
s_cbranch_scc1 L_ab
L_pi2:
s_waitcnt vmcnt(6)
v_cmp_lt_u32 vcc, s54, v142
s_sub_u32 s60, s60, 1
s_cbranch_vccz L_pw
s_cselect_b32 s0, s61, 1
s_max_i32 s60, s60, 0
v_cmp_eq_u32 s[58:59], -1, v142
v_mov_b32 v146, v142
s_andn2_b64 vcc, vcc, s[58:59]
s_cbranch_scc0 L_pq2
s_mov_b64 exec, -1
v_cndmask_b32 v146, 0, v146, vcc
s_lshl_b32 s61, s61, 1
s_nop 0
v_max_u32_dpp v236, v146, v146 row_ror:8 row_mask:0xf bank_mask:0xf
s_nop 1
v_max_u32_dpp v236, v236, v236 row_ror:4 row_mask:0xf bank_mask:0xf
s_nop 1
v_max_u32_dpp v236, v236, v236 row_ror:2 row_mask:0xf bank_mask:0xf
s_nop 1
v_max_u32_dpp v236, v236, v236 row_ror:1 row_mask:0xf bank_mask:0xf
v_mov_b32 v237, v236
s_mov_b32 s60, 2
s_nop 0
v_permlane16_swap_b32 v236, v237
v_max_u32 v236, v236, v237
s_mov_b32 exec_hi, 0
v_cmpx_eq_u32 vcc, v236, v146
ds_write_b64 v4, v[146:147]
s_nop 2
v_readfirstlane_b32 s55, v147
v_readfirstlane_b32 s54, v146
s_branch L_pl0
L_pq2:
s_cmp_eq_u32 s0, 0
s_cselect_b32 s61, 1, s61
s_cbranch_scc1 L_pg
s_sleep 2
s_sub_u32 s40, s40, 1
s_cbranch_scc0 L_pl0
s_mov_b32 s40, 0
s_waitcnt vmcnt(0)
s_cmp_eq_u32 s0, s0
L_pw:
s_cbranch_scc0 L_pv
s_cmp_eq_u32 s61, 1
s_mov_b32 s61, 0
s_mov_b64 exec, -1
s_cbranch_scc1 L_bb
s_branch L_pg
L_pv:
s_cmp_eq_u32 s60, 0
s_waitcnt vmcnt(4)
s_cbranch_scc1 L_pg
s_cmp_eq_u32 s60, 1
s_waitcnt vmcnt(1)
s_branch L_pg
L_ab:
s_mov_b64 exec, -1
ds_write_b32 v4, v4 offset:16
s_branch L_bb
L_xf:
s_mov_b32 m0, 127232
s_mov_b64 exec, -1
buffer_load_dwordx4 v132, s[16:19], s55 offen sc1 lds
s_mov_b32 m0, 128256
s_mov_b64 exec, 0xffff
buffer_load_dwordx4 v133, s[16:19], s55 offen sc1 lds
s_waitcnt vmcnt(0)
L_pg:
s_mov_b64 exec, -1
L_np:
s_waitcnt lgkmcnt(0)
s_barrier
s_cmp_lt_u32 s32, 4
s_cbranch_scc1 L_xh
ds_read_b64 v[2:3], v4
ds_read_b128 v[88:91], v252 offset:0
ds_read_b128 v[92:95], v252 offset:128
ds_read_b128 v[96:99], v252 offset:256
ds_read_b128 v[100:103], v252 offset:384
ds_read_b128 v[104:107], v252 offset:512
ds_read_b128 v[108:111], v252 offset:640
ds_read_b128 v[112:115], v252 offset:768
ds_read_b128 v[116:119], v252 offset:896
ds_read_b128 v[120:123], v252 offset:1024
ds_read_b128 v[124:127], v252 offset:1152
s_cmp_eq_u32 s61, 0
s_cbranch_scc1 L_sl0
s_mov_b32 m0, 127232
s_mov_b64 exec, -1
buffer_load_dwordx4 v132, s[16:19], s55 offen sc1 lds
s_mov_b32 m0, 128256
s_mov_b64 exec, 0xffff
buffer_load_dwordx4 v133, s[16:19], s55 offen sc1 lds
s_mov_b64 exec, 0x77777777
buffer_atomic_umin v140, v144, s[16:19], s64 offen sc0 sc1
s_mov_b64 exec, -1
L_sl0:
s_waitcnt lgkmcnt(10)
v_readfirstlane_b32 s56, v2
v_readfirstlane_b32 s57, v3
s_waitcnt lgkmcnt(9)
v_smfmac_f32_16x16x64_bf16 v[228:231], v[88:91], v[8:15], v7
s_and_b32 s0, s57, 0x7fff
s_add_u32 s57, s57, s0
s_add_u32 s57, s57, 4096
s_and_b32 s1, s56, 0xfffff800
s_waitcnt lgkmcnt(8)
v_smfmac_f32_16x16x64_bf16 v[228:231], v[92:95], v[16:23], v7
s_ashr_i32 s3, s1, 31
s_not_b32 s3, s3
s_or_b32 s3, s3, 0x80000000
s_xor_b32 s1, s1, s3
s_waitcnt lgkmcnt(7)
v_smfmac_f32_16x16x64_bf16 v[228:231], v[96:99], v[24:31], v7
s_andn2_b32 s56, 2047, s56
s_mul_i32 s56, s56, 1280
v_mov_b32 v130, s1
s_waitcnt lgkmcnt(6)
v_smfmac_f32_16x16x64_bf16 v[228:231], v[100:103], v[32:39], v7
v_mul_f32 v130, 0xbfb8aa3b, v130
s_waitcnt lgkmcnt(5)
v_smfmac_f32_16x16x64_bf16 v[228:231], v[104:107], v[40:47], v7
v_exp_f32 v130, v130
s_waitcnt lgkmcnt(4)
v_smfmac_f32_16x16x64_bf16 v[228:231], v[108:111], v[48:55], v7
v_add_f32 v130, 1.0, v130
s_waitcnt lgkmcnt(3)
v_smfmac_f32_16x16x64_bf16 v[228:231], v[112:115], v[56:63], v7
v_rcp_f32 v130, v130
s_waitcnt lgkmcnt(2)
v_smfmac_f32_16x16x64_bf16 v[228:231], v[116:119], v[64:71], v7
s_waitcnt lgkmcnt(1)
v_smfmac_f32_16x16x64_bf16 v[228:231], v[120:123], v[72:79], v7
s_waitcnt lgkmcnt(0)
v_smfmac_f32_16x16x64_bf16 v[228:231], v[124:127], v[80:87], v7
s_cmp_eq_u32 s61, 0
s_cbranch_scc1 L_sl1
s_mov_b32 m0, 127232
s_mov_b64 exec, -1
buffer_load_dwordx4 v132, s[16:19], s55 offen sc1 lds
s_mov_b32 m0, 128256
s_mov_b64 exec, 0xffff
buffer_load_dwordx4 v133, s[16:19], s55 offen sc1 lds
s_mov_b64 exec, 0x77777777
buffer_atomic_umin v141, v144, s[16:19], s64 offen sc0 sc1
s_mov_b64 exec, -1
L_sl1:
s_branch L_xj
L_pad_27:
s_setpc_b64 s[100:101]
L_xh:
ds_read_b128 v[236:239], v252 offset:0
ds_read_b128 v[240:243], v252 offset:128
ds_read_b128 v[244:247], v252 offset:256
ds_read_b128 v[248:251], v252 offset:384
s_waitcnt lgkmcnt(3)
v_smfmac_f32_16x16x64_bf16 v[228:231], v[236:239], v[8:15], v7
v_smfmac_f32_16x16x64_bf16 v[232:235], v[236:239], v[88:95], v7
ds_read_b128 v[236:239], v252 offset:512
s_waitcnt lgkmcnt(3)
v_smfmac_f32_16x16x64_bf16 v[228:231], v[240:243], v[16:23], v7
v_smfmac_f32_16x16x64_bf16 v[232:235], v[240:243], v[96:103], v7
ds_read_b128 v[240:243], v252 offset:640
s_waitcnt lgkmcnt(3)
v_smfmac_f32_16x16x64_bf16 v[228:231], v[244:247], v[24:31], v7
v_smfmac_f32_16x16x64_bf16 v[232:235], v[244:247], v[104:111], v7
ds_read_b128 v[244:247], v252 offset:768
s_waitcnt lgkmcnt(3)
v_smfmac_f32_16x16x64_bf16 v[228:231], v[248:251], v[32:39], v7
v_smfmac_f32_16x16x64_bf16 v[232:235], v[248:251], v[112:119], v7
ds_read_b128 v[248:251], v252 offset:896
s_waitcnt lgkmcnt(3)
v_smfmac_f32_16x16x64_bf16 v[228:231], v[236:239], v[40:47], v7
v_smfmac_f32_16x16x64_bf16 v[232:235], v[236:239], v[120:127], v7
ds_read_b128 v[236:239], v252 offset:1024
s_waitcnt lgkmcnt(3)
v_smfmac_f32_16x16x64_bf16 v[228:231], v[240:243], v[48:55], v7
v_smfmac_f32_16x16x64_bf16 v[232:235], v[240:243], v[128:135], v7
ds_read_b128 v[240:243], v252 offset:1152
s_waitcnt lgkmcnt(3)
v_smfmac_f32_16x16x64_bf16 v[228:231], v[244:247], v[56:63], v7
v_smfmac_f32_16x16x64_bf16 v[232:235], v[244:247], v[136:143], v7
s_waitcnt lgkmcnt(2)
v_smfmac_f32_16x16x64_bf16 v[228:231], v[248:251], v[64:71], v7
v_smfmac_f32_16x16x64_bf16 v[232:235], v[248:251], v[144:151], v7
s_waitcnt lgkmcnt(1)
v_smfmac_f32_16x16x64_bf16 v[228:231], v[236:239], v[72:79], v7
v_smfmac_f32_16x16x64_bf16 v[232:235], v[236:239], v[152:159], v7
s_waitcnt lgkmcnt(0)
v_smfmac_f32_16x16x64_bf16 v[228:231], v[240:243], v[80:87], v7
v_smfmac_f32_16x16x64_bf16 v[232:235], v[240:243], v[160:167], v7
L_xj:
s_mov_b64 vcc, 0xffff
s_nop 5
v_add_f32 v1, v228, v229
v_add_f32 v2, v232, v233
v_cndmask_b32 v1, v2, v1, vcc
v_mul_f32 v2, 0xbfb8aa3b, v1
v_cmp_u_f32 vcc, v1, v1
v_exp_f32 v2, v2
v_mul_f32_dpp v3, v1, v1 row_ror:8 row_mask:0xf bank_mask:0xf
v_add_f32 v2, 1.0, v2
v_rcp_f32 v2, v2
s_mov_b64 exec, s[50:51]
v_mul_f32 v1, v2, v3
v_cvt_pk_bf16_f32 v1, v1, v1
ds_write_b16 v253, v1
s_mov_b64 exec, -1
s_cbranch_vccnz L_xn
L_xnb:
s_cmp_eq_u32 s61, 0
s_cbranch_scc0 L_pl0
L_bb:
s_waitcnt lgkmcnt(0)
s_barrier
ds_read_b32 v1, v4 offset:16
ds_read_b128 v[236:239], v255
ds_read_b128 v[240:243], v254
s_waitcnt lgkmcnt(2)
v_cmp_ne_u32 vcc, 0, v1
s_cbranch_vccnz L_xsr
L_xsgo:
s_waitcnt lgkmcnt(1)
v_mfma_f32_16x16x32_bf16 v[24:27], v[236:239], v[224:227], 0
v_mfma_f32_16x16x32_bf16 v[8:11], v[236:239], v[176:179], 0
v_mfma_f32_16x16x32_bf16 v[12:15], v[236:239], v[188:191], 0
v_mfma_f32_16x16x32_bf16 v[16:19], v[236:239], v[200:203], 0
v_mfma_f32_16x16x32_bf16 v[20:23], v[236:239], v[212:215], 0
s_waitcnt lgkmcnt(0)
s_nop 0
v_smfmac_f32_16x16x64_bf16 v[24:27], v[240:243], v[216:223], v7
v_smfmac_f32_16x16x64_bf16 v[8:11], v[240:243], v[168:175], v7
v_smfmac_f32_16x16x64_bf16 v[12:15], v[240:243], v[180:187], v7
v_smfmac_f32_16x16x64_bf16 v[16:19], v[240:243], v[192:199], v7
v_smfmac_f32_16x16x64_bf16 v[20:23], v[240:243], v[204:211], v7
s_nop 3
v_add_f32 v1, v24, v25
v_add_f32 v32, v8, v9
v_add_f32 v33, v12, v13
v_add_f32 v34, v16, v17
v_add_f32 v35, v20, v21
v_mov_b32_dpp v32, v1 quad_perm:[0,0,0,0] row_mask:0x2 bank_mask:0xf
v_mov_b32_dpp v33, v1 quad_perm:[1,1,1,1] row_mask:0x2 bank_mask:0xf
v_mov_b32_dpp v34, v1 quad_perm:[2,2,2,2] row_mask:0x2 bank_mask:0xf
v_mov_b32_dpp v35, v1 quad_perm:[3,3,3,3] row_mask:0x2 bank_mask:0xf
s_mov_b64 exec, 0x1111ffff
buffer_store_dwordx4 v[32:35], v5, s[16:19], s47 offen sc1
s_mov_b64 exec, -1
s_cmp_lt_u32 s52, 40
s_cbranch_scc0 L_mfin
buffer_load_dword v44, v129, s[16:19], s57 offen sc1
buffer_load_dwordx4 v[40:43], v6, s[16:19], s53 offen sc1
s_sleep 1
buffer_load_dword v52, v129, s[16:19], s57 offen sc1
buffer_load_dwordx4 v[48:51], v6, s[16:19], s53 offen sc1
s_sleep 1
L_fd:
buffer_load_dword v60, v129, s[16:19], s57 offen sc1
buffer_load_dwordx4 v[56:59], v6, s[16:19], s53 offen sc1
s_waitcnt vmcnt(4)
v_max3_u32 v1, v40, v42, v44
v_cmp_eq_u32 vcc, -1, v1
s_cbranch_vccz L_fg0
s_sleep 1
buffer_load_dword v44, v129, s[16:19], s57 offen sc1
buffer_load_dwordx4 v[40:43], v6, s[16:19], s53 offen sc1
s_waitcnt vmcnt(4)
v_max3_u32 v1, v48, v50, v52
v_cmp_eq_u32 vcc, -1, v1
s_cbranch_vccz L_fg1
s_sleep 1
buffer_load_dword v52, v129, s[16:19], s57 offen sc1
buffer_load_dwordx4 v[48:51], v6, s[16:19], s53 offen sc1
s_waitcnt vmcnt(4)
v_max3_u32 v1, v56, v58, v60
v_cmp_eq_u32 vcc, -1, v1
s_cbranch_vccz L_fg2
s_sleep 1
s_sub_u32 s40, s40, 1
s_cbranch_scc0 L_fd
L_fg2:
v_permlane32_swap_b32 v56, v57
v_permlane32_swap_b32 v58, v59
v_add_f32 v56, v56, v57
v_add_f32 v58, v58, v59
s_nop 1
v_permlane16_swap_b32 v56, v58
v_add_f32 v56, v56, v58
s_nop 1
v_add_f32_dpp v56, v56, v56 row_ror:4 row_mask:0xf bank_mask:0xf
s_nop 1
v_add_f32_dpp v56, v56, v56 row_ror:8 row_mask:0xf bank_mask:0xf
v_fma_f32 v8, v56, v130, v60
v_cvt_pk_bf16_f32 v8, v8, v8
s_mov_b32 exec_lo, 0xf000f
s_mov_b32 exec_hi, 0xf000f
buffer_store_short v8, v128, s[20:23], s56 offen
s_endpgm
L_pad_28:
s_setpc_b64 s[100:101]
L_fg1:
v_permlane32_swap_b32 v48, v49
v_permlane32_swap_b32 v50, v51
v_add_f32 v48, v48, v49
v_add_f32 v50, v50, v51
s_nop 1
v_permlane16_swap_b32 v48, v50
v_add_f32 v48, v48, v50
s_nop 1
v_add_f32_dpp v48, v48, v48 row_ror:4 row_mask:0xf bank_mask:0xf
s_nop 1
v_add_f32_dpp v48, v48, v48 row_ror:8 row_mask:0xf bank_mask:0xf
v_fma_f32 v8, v48, v130, v52
v_cvt_pk_bf16_f32 v8, v8, v8
s_mov_b32 exec_lo, 0xf000f
s_mov_b32 exec_hi, 0xf000f
buffer_store_short v8, v128, s[20:23], s56 offen
s_endpgm
L_pad_29:
s_setpc_b64 s[100:101]
L_fg0:
v_permlane32_swap_b32 v40, v41
v_permlane32_swap_b32 v42, v43
v_add_f32 v40, v40, v41
v_add_f32 v42, v42, v43
s_nop 1
v_permlane16_swap_b32 v40, v42
v_add_f32 v40, v40, v42
s_nop 1
v_add_f32_dpp v40, v40, v40 row_ror:4 row_mask:0xf bank_mask:0xf
s_nop 1
v_add_f32_dpp v40, v40, v40 row_ror:8 row_mask:0xf bank_mask:0xf
v_fma_f32 v8, v40, v130, v44
v_cvt_pk_bf16_f32 v8, v8, v8
s_mov_b32 exec_lo, 0xf000f
s_mov_b32 exec_hi, 0xf000f
buffer_store_short v8, v128, s[20:23], s56 offen
L_mfin:
s_endpgm
L_pad_30:
s_setpc_b64 s[100:101]
L_xn:
ds_write_b32 v4, v4 offset:16
s_branch L_xnb
L_xsr:
s_sub_u32 s49, s49, 1
s_cbranch_scc1 L_xsgo
v_mov_b32 v228, 0
v_mov_b32 v229, 0
v_mov_b32 v232, 0
v_mov_b32 v233, 0
s_waitcnt lgkmcnt(0)
s_barrier
s_cmp_eq_u32 s32, 7
s_cbranch_scc0 L_np
ds_write_b32 v4, v228 offset:16
s_cmp_eq_u32 s61, 2
s_cbranch_scc0 L_xf
s_mov_b32 s61, 0
s_mov_b64 exec, 0x77777777
s_cmp_eq_u32 s62, 0
s_cbranch_scc1 L_pi0
s_cmp_eq_u32 s62, 1
s_cbranch_scc1 L_pi1
s_branch L_pi2
L_end:
s_endpgm
.section .rodata,"a"
.p2align 6
.amdhsa_kernel sequential_preLN__sliding_local_dilated__moe_arch_mod__prompt_kernel
  .amdhsa_next_free_vgpr 256
  .amdhsa_next_free_sgpr 102
  .amdhsa_accum_offset 256
  .amdhsa_group_segment_fixed_size 0
  .amdhsa_kernarg_size 88
  .amdhsa_user_sgpr_count 2
  .amdhsa_user_sgpr_kernarg_segment_ptr 1
  .amdhsa_system_sgpr_workgroup_id_x 1
  .amdhsa_float_denorm_mode_32 3
.end_amdhsa_kernel
```

```asm
; @launch grid=(256,1,1) block=(512,1,1) lds=163840
.amdgcn_target "amdgcn-amd-amdhsa--gfx950"
.text
.p2align 12
.globl sequential_preLN__sliding_local_dilated__moe_arch_mod__prompt_kernel
.p2align 8
.type sequential_preLN__sliding_local_dilated__moe_arch_mod__prompt_kernel,@function
sequential_preLN__sliding_local_dilated__moe_arch_mod__prompt_kernel:
s_load_dwordx16 s[44:59], s[0:1], 0
s_load_dwordx8 s[60:67], s[0:1], 56
s_lshr_b32 s34, s2, 3
s_and_b32 s33, s2, 7
v_readfirstlane_b32 s32, v0
s_getpc_b64 s[100:101]
L_pc:
s_mul_i32 s3, s34, 9
v_min_u32 v2, 8, v0
v_add_lshl_u32 v2, v2, s3, 7
v_min_u32 v2, L_end-L_pc, v2
s_cmp_ge_u32 s34, 30
s_cbranch_scc1 L_moe
global_load_dword v255, v2, s[100:101]
s_mul_i32 s35, s34, 26
s_lshr_b32 s35, s35, 8
s_mul_i32 s3, s35, 10
s_sub_u32 s36, s34, s3
s_lshr_b32 s32, s32, 6
s_lshl_b32 s3, s33, 2
s_lshr_b32 s3, 0x68354972, s3
s_and_b32 s41, s3, 15
s_add_u32 s3, s36, s41
s_sub_u32 s68, s3, 10
s_cselect_b32 s69, s3, s68
s_mul_i32 s3, s69, 245760
s_lshl_b32 s68, s36, 7
s_add_u32 s3, s3, s68
v_lshrrev_b32 v1, 3, v0
v_lshrrev_b32 v3, 4, v0
v_and_b32 v2, 2, v1
v_and_or_b32 v2, v3, 4, v2
v_xor_b32 v2, v2, v0
v_and_b32 v2, 7, v2
v_mul_u32_u24 v4, 3840, v1
v_lshl_add_u32 v4, v2, 4, v4
v_add_u32 v4, s3, v4
s_mul_i32 s3, s32, 3072
s_add_u32 m0, s3, 20480
v_and_b32 v0, 63, v0
s_and_b32 s38, s32, 3
s_lshr_b32 s3, s33, 1
s_lshl_b32 s3, s3, 9
s_mul_i32 s68, s35, 176
s_add_u32 s3, s3, s68
s_and_b32 s68, s33, 1
s_add_u32 s3, s3, s68
s_mul_i32 s39, s3, 1280
s_sub_u32 s42, s32, 5
s_mul_i32 s3, s42, 81920
s_add_u32 s3, s3, s39
s_sub_u32 s3, s3, 20480
v_lshrrev_b32 v1, 3, v0
v_lshrrev_b32 v3, 4, v0
v_xor_b32 v3, v3, v0
v_and_b32 v3, 7, v3
v_mul_u32_u24 v1, 2560, v1
v_lshl_add_u32 v1, v3, 4, v1
v_add_u32 v24, s3, v1
s_add_u32 s3, s42, s35
s_cmp_eq_u32 s3, 4
s_cselect_b32 s3, 0x80000000, 0
v_xor_b32 v25, 64, v24
v_add_u32 v25, 20480, v25
v_add_u32 v26, 40960, v24
v_add_u32 v27, 40960, v25
v_or_b32 v27, s3, v27
s_mov_b32 s6, 0x280000
s_mov_b32 s7, 0x20000
s_mov_b32 s10, 0x258000
s_mov_b32 s11, 0x20000
s_mov_b32 s14, 0xc8000
s_mov_b32 s15, 0x20000
s_mov_b32 s18, 0x10000000
s_mov_b32 s19, 0x20000
s_mov_b32 s22, 0x280000
s_mov_b32 s23, 0x20000
s_mov_b32 s26, 0x100
s_mov_b32 s27, 0x20000
s_mov_b32 s30, 0x500
s_mov_b32 s31, 0x20000
s_waitcnt lgkmcnt(0)
global_load_lds_dwordx4 v4, s[46:47]
s_addk_i32 m0, -256
s_mov_b64 s[4:5], s[44:45]
global_load_lds_dwordx4 v4, s[46:47] offset:1280
s_addk_i32 m0, -256
s_mov_b64 s[20:21], s[62:63]
global_load_lds_dwordx4 v4, s[46:47] offset:2560
s_mov_b64 s[24:25], s[64:65]
s_mov_b64 s[16:17], s[66:67]
s_mov_b64 s[8:9], s[46:47]
s_mov_b64 s[12:13], s[48:49]
s_mov_b64 s[28:29], s[52:53]
s_cmp_eq_u32 s32, 4
s_cselect_b64 s[96:97], s[54:55], s[58:59]
s_cmp_eq_u32 s32, 5
s_cselect_b64 s[96:97], s[56:57], s[96:97]
s_cmp_lt_u32 s32, 5
s_cbranch_scc1 L_nx
s_lshl_b32 s64, s42, 12
s_cselect_b32 s62, -1, 0xffffff00
s_lshl_b32 s63, s69, 7
s_mov_b32 s61, 8192
s_add_u32 m0, s61, s64
s_mov_b32 exec_lo, s62
buffer_load_dwordx4 v24, s[4:7], s63 offen lds
s_addk_i32 m0, 1024
s_mov_b32 exec_lo, -1
buffer_load_dwordx4 v25, s[4:7], s63 offen lds
s_addk_i32 m0, 1024
s_nop 0
buffer_load_dwordx4 v26, s[4:7], s63 offen lds
s_addk_i32 m0, 1024
s_nop 0
buffer_load_dwordx4 v27, s[4:7], s63 offen lds
L_nx:
v_mov_b32 v254, v4
s_mov_b32 s40, 524288
s_mul_i32 s43, s33, 3
s_add_u32 s43, s43, s35
s_sub_u32 s3, s36, 5
s_cselect_b32 s37, s36, s3
s_lshl_b32 s3, s32, 2
s_lshr_b32 s44, 0x32105454, s3
s_and_b32 s44, s44, 7
s_lshr_b32 s45, s38, 1
s_add_u32 s45, s45, 4
s_cmp_eq_u32 s35, 2
s_cselect_b32 s60, 10, 11
s_sub_u32 s57, 10, s41
v_lshlrev_b32 v233, 4, v0
s_mul_i32 s58, s43, 6
s_add_u32 s58, s58, s44
s_mul_i32 s58, s58, 2560
s_add_u32 s58, s58, 2097152
s_lshl_b32 s59, s33, 15
s_add_u32 s59, s59, 3145728
s_sub_u32 s51, 5, s37
s_add_u32 s1, s37, 1
s_sub_u32 s3, 15, s37
s_cmp_le_u32 s37, 2
s_cselect_b32 s46, 0, s3
s_cselect_b32 s47, s51, s1
s_cselect_b32 s48, s3, 0
s_cselect_b32 s49, s1, s51
s_cselect_b32 s50, 1, 0
v_and_b32 v3, 15, v0
v_add_u32 v3, 8, v3
v_lshrrev_b32 v4, 1, v3
v_lshrrev_b32 v5, 5, v0
v_xor_b32 v4, v4, v5
v_and_b32 v4, 7, v4
v_lshlrev_b32 v4, 4, v4
v_lshl_add_u32 v4, v3, 7, v4
v_bfe_u32 v5, v0, 4, 1
v_lshl_add_u32 v4, v5, 3, v4
s_lshl_b32 s3, s44, 11
v_add_u32 v235, s3, v4
s_cmp_lt_u32 s32, 4
s_cbranch_scc1 L_cons
s_add_u32 s69, s69, 1
s_cmp_eq_u32 s69, 10
s_cselect_b32 s69, 0, s69
s_lshl_b32 s63, s69, 7
s_mov_b32 s61, 45056
v_and_b32 v1, 15, v0
v_lshrrev_b32 v2, 4, v0
v_mov_b32 v7, 1792
s_mul_i32 s0, s44, 2304
s_movk_i32 s1, 144
v_bfe_u32 v3, v0, 2, 1
v_and_b32 v4, 3, v0
v_lshlrev_b32 v4, 1, v4
v_lshl_add_u32 v3, v3, 3, v4
v_bfe_u32 v4, v0, 3, 1
v_add_u32 v3, v3, v4
s_add_u32 s3, s0, 17408
v_mov_b32 v4, s3
v_mad_u32_u24 v3, v3, s1, v4
s_add_u32 s3, s0, 4736
v_mov_b32 v4, s3
v_mad_u32_u24 v4, v1, s1, v4
s_mov_b32 s52, 0xff00ff
s_mov_b32 s53, 0xff00ff
v_add_u32 v5, s51, v2
v_lshl_add_u32 v200, v5, 3, v3
v_lshl_add_u32 v5, v5, 3, v4
v_cndmask_b32 v204, v7, v5, s[52:53]
v_cndmask_b32 v205, v5, v7, s[52:53]
v_add_u32 v5, s46, v2
v_lshl_add_u32 v202, v5, 3, v3
v_lshl_add_u32 v5, v5, 3, v4
v_cmp_gt_u32 vcc, s47, v2
s_nop 1
v_cndmask_b32 v5, v7, v5, vcc
v_cndmask_b32 v206, v7, v5, s[52:53]
v_cndmask_b32 v207, v5, v7, s[52:53]
v_add_u32 v5, s48, v2
v_min_u32 v5, 15, v5
v_lshl_add_u32 v203, v5, 3, v3
v_lshl_add_u32 v5, v5, 3, v4
v_cmp_gt_u32 vcc, s49, v2
s_nop 1
v_cndmask_b32 v5, v7, v5, vcc
v_cndmask_b32 v208, v7, v5, s[52:53]
v_cndmask_b32 v209, v5, v7, s[52:53]
s_sub_u32 s3, s51, 1
v_mad_u32_u24 v5, v2, 5, s3
s_add_u32 s3, s46, 4
v_mov_b32 v6, s3
s_mov_b64 vcc, 0xffff
v_cndmask_b32 v5, v5, v6, vcc
v_min_u32 v5, 15, v5
v_lshl_add_u32 v201, v5, 3, v3
v_lshl_add_u32 v5, v5, 3, v4
s_cmp_eq_u32 s47, 5
s_cselect_b64 vcc, 0xff, 0
v_cndmask_b32 v210, v7, v5, vcc
s_lshl_b64 vcc, vcc, 8
v_cndmask_b32 v211, v7, v5, vcc
s_bfm_b64 vcc, 8, 16
v_cndmask_b32 v212, v7, v5, vcc
s_bfm_b64 vcc, 8, 24
v_cndmask_b32 v213, v7, v5, vcc
s_bfm_b64 vcc, 8, 32
v_cndmask_b32 v214, v7, v5, vcc
s_bfm_b64 vcc, 8, 40
v_cndmask_b32 v215, v7, v5, vcc
s_mul_i32 s0, s44, 2304
s_movk_i32 s1, 144
v_bfe_u32 v3, v0, 2, 3
v_lshrrev_b32 v4, 5, v0
v_lshl_add_u32 v3, v3, 1, v4
s_add_u32 s3, s0, 31232
v_mov_b32 v4, s3
v_mad_u32_u24 v3, v3, s1, v4
v_and_b32 v4, 3, v0
s_mov_b32 s54, 0x11111111
s_mov_b32 s55, 0x11111111
v_add_u32 v5, s51, v4
v_lshl_add_u32 v216, v5, 3, v3
v_add_u32 v7, 32, v216
s_cmp_eq_u32 s50, 1
s_cselect_b32 s3, -1, 12
s_cselect_b32 s56, 2, -1
v_add_u32 v5, s3, v4
v_lshl_add_u32 v5, v5, 3, v3
v_cndmask_b32 v217, v5, v7, s[54:55]
v_add_u32 v7, 40, v7
v_add_u32 v5, s56, v4
v_add_u32 v6, 10, v5
v_cmp_gt_i32 vcc, s51, v5
s_nop 1
v_cndmask_b32 v5, v6, v5, vcc
v_lshl_add_u32 v5, v5, 3, v3
v_cndmask_b32 v218, v5, v7, s[54:55]
s_lshl_b32 s0, s44, 8
v_lshrrev_b32 v4, 5, v0
v_and_or_b32 v3, v0, 8, v4
s_add_u32 s3, s0, 8
v_lshl_add_u32 v222, v3, 4, s3
v_and_b32 v1, 15, v0
s_add_u32 s3, s0, 132
v_lshl_add_u32 v223, v1, 4, s3
s_lshr_b32 s3, s39, 8
s_mul_i32 s3, s3, 52429
s_lshr_b32 s3, s3, 18
s_lshl_b32 s0, s44, 5
s_add_u32 s3, s3, s0
s_sub_u32 s3, 2047, s3
v_mad_i32_i24 v234, v1, -2, s3
v_lshrrev_b32 v2, 4, v0
v_and_or_b32 v3, v0, 8, v2
v_and_b32 v4, 0x70, v233
v_bfrev_b32 v6, 1
s_lshl_b32 s3, s45, 4
v_add_u32 v5, s3, v3
s_lshl_b32 s3, s60, 3
v_cmp_gt_u32 vcc, s3, v5
v_mul_u32_u24 v5, 2560, v5
v_add3_u32 v5, v5, v4, s39
v_cndmask_b32 v236, v6, v5, vcc
s_lshl_b32 s3, s44, 4
v_add_u32 v5, s3, v3
s_lshl_b32 s3, s60, 3
v_cmp_gt_u32 vcc, s3, v5
v_mul_u32_u24 v5, 2560, v5
v_add3_u32 v5, v5, v4, s39
v_cndmask_b32 v227, v6, v5, vcc
s_lshl_b32 s3, s36, 7
v_add_u32 v226, s3, v227
v_bfe_u32 v3, v0, 4, 1
v_cmp_eq_u32 s[54:55], s50, v3
s_cmp_lg_u32 s37, 0
s_cselect_b64 s[0:1], -1, s[54:55]
s_and_b64 vcc, vcc, s[0:1]
s_cmp_lg_u32 s37, 4
s_cselect_b64 s[0:1], 0, s[54:55]
s_andn2_b64 vcc, vcc, s[0:1]
v_cndmask_b32 v225, v6, v226, vcc
s_cmp_le_u32 s37, 3
s_cselect_b32 s3, 2560, 0
s_sub_u32 s3, s3, 128
v_mov_b32 v4, s3
s_cmp_ge_u32 s37, 2
s_cselect_b32 s3, 2560, 0
s_add_u32 s3, s3, 128
v_mov_b32 v5, s3
v_cndmask_b32 v4, v4, v5, s[54:55]
v_mul_u32_u24 v3, 2560, v3
v_sub_u32 v4, v4, v3
v_add_u32 v4, v4, v226
v_cndmask_b32 v224, v6, v4, vcc
v_and_b32 v1, 15, v0
v_bfrev_b32 v6, 1
v_bfe_u32 v3, v0, 4, 1
v_lshrrev_b32 v4, 5, v0
v_lshl_add_u32 v3, v3, 1, v4
s_lshl_b32 s3, s36, 7
v_lshl_add_u32 v4, v3, 4, s3
s_lshl_b32 s3, s44, 4
v_add_u32 v5, s3, v1
s_lshl_b32 s3, s60, 3
v_cmp_gt_u32 vcc, s3, v5
v_mul_u32_u24 v5, 2560, v5
v_add3_u32 v5, v5, v4, s39
v_cndmask_b32 v232, v6, v5, vcc
v_bfe_u32 v3, v0, 3, 2
v_lshlrev_b32 v3, 2, v3
v_and_or_b32 v3, v0, 3, v3
v_lshlrev_b32 v3, 3, v3
v_bfe_u32 v4, v0, 2, 2
v_lshl_add_u32 v3, v4, 7, v3
v_lshrrev_b32 v2, 4, v0
s_and_b32 s3, s32, 1
s_lshl_b32 s3, s3, 12
s_add_u32 s3, s3, 81920
v_lshl_add_u32 v4, v2, 10, v3
v_add_u32 v228, s3, v4
v_xor_b32 v229, 32, v228
v_xor_b32 v230, 64, v228
v_xor_b32 v231, 96, v228
s_mov_b32 s44, 0x0
s_mov_b32 s45, 0x1010101
s_mov_b32 s46, 0x3030303
s_mov_b32 s47, 0x7070707
s_mov_b32 s48, 0xf0f0f0f
s_mov_b32 s49, 0x1f1f1f1f
s_mov_b32 s50, 0x3f3f3f3f
s_mov_b32 s51, 0x7f7f7f7f
s_movk_i32 s54, 10240
s_mov_b32 s55, 0x07060501
s_mov_b32 s56, 0x0706000c
v_mov_b32 v5, 0xffff
v_mov_b32 v6, 0xffff0000
v_cndmask_b32 v1, 0, v5, s[44:45]
v_cndmask_b32 v4, 0, v6, s[46:47]
v_or_b32 v220, v1, v4
v_cndmask_b32 v1, 0, v5, s[48:49]
v_cndmask_b32 v4, 0, v6, s[50:51]
v_or_b32 v221, v1, v4
v_lshrrev_b32 v1, 3, v0
v_and_b32 v2, 2, v1
v_xor_b32 v2, v2, v0
s_lshl_b32 s3, s32, 2
v_xor_b32 v2, s3, v2
v_and_b32 v2, 7, v2
s_lshl_b32 s3, s36, 7
v_lshl_add_u32 v2, v2, 4, s3
v_and_b32 v3, 3, v1
v_mul_u32_u24 v3, 1280, v3
v_add_u32 v2, v3, v2
v_lshrrev_b32 v3, 5, v0
v_mul_u32_u24 v3, 5120, v3
v_sub_u32 v4, 5120, v3
v_mad_u32_u24 v56, v3, 5, v2
v_mad_u32_u24 v57, v3, 3, v2
v_mad_u32_u24 v58, v3, 13, v2
v_mad_u32_u24 v59, v4, 3, v2
v_mad_u32_u24 v60, v4, 13, v2
s_mul_i32 s3, s38, 3
v_lshrrev_b32 v1, 2, v0
v_add_u32 v1, s3, v1
s_add_u32 s3, s3, 3
s_min_u32 s3, s3, s60
v_cmp_gt_u32 vcc, s3, v1
v_and_b32 v2, 3, v0
v_lshl_add_u32 v1, v1, 3, v2
v_mul_u32_u24 v1, 2560, v1
s_lshl_b32 s0, s36, 7
s_add_u32 s3, s0, s39
v_add_u32 v1, s3, v1
v_bfrev_b32 v2, 1
v_cndmask_b32 v61, v2, v1, vcc
s_mul_i32 s3, s38, 3
v_min_u32 v1, 2, v0
v_add_u32 v1, s3, v1
v_lshrrev_b32 v2, 1, v1
v_mul_u32_u24 v2, 2304, v2
v_lshl_add_u32 v1, v1, 7, v2
s_mul_i32 s3, s43, 15360
s_lshl_b32 s0, s36, 8
s_add_u32 s3, s3, s0
s_add_u32 s3, s3, 2097152
v_add_u32 v63, s3, v1
s_mul_i32 s3, s34, 9
v_min_u32 v1, 8, v0
v_add_u32 v1, s3, v1
v_min_u32 v1, 255, v1
v_cmp_le_u32 vcc, 128, v1
v_mul_u32_u24 v1, 3072, v1
s_mul_i32 s3, s33, 384
s_add_u32 s3, s3, 1572864
v_add_u32 v1, s3, v1
v_subrev_u32 v2, 1376000, v1
v_cndmask_b32 v1, v1, v2, vcc
s_mul_i32 s3, s33, 60
s_lshl_b32 s0, s34, 1
s_add_u32 s3, s3, s0
s_and_b32 s0, s32, 1
s_add_u32 s3, s3, s0
s_lshl_b32 s3, s3, 12
v_min_u32 v2, 31, v0
v_lshl_add_u32 v2, v2, 7, s3
s_cmp_ge_u32 s32, 6
s_cselect_b64 vcc, -1, 0
v_cndmask_b32 v84, v1, v2, vcc
v_mov_b32 v176, 0
v_mov_b32 v177, 0
v_mov_b32 v178, 0
v_mov_b32 v179, 0
v_mov_b32 v180, 0
v_mov_b32 v181, 0
v_mov_b32 v182, 0
v_mov_b32 v183, 0
v_mov_b32 v184, 0
v_mov_b32 v185, 0
v_mov_b32 v186, 0
v_mov_b32 v187, 0
v_mov_b32 v188, 0
v_mov_b32 v189, 0
v_mov_b32 v190, 0
v_mov_b32 v191, 0
s_lshl_b32 s0, s38, 12
s_add_u32 s0, s0, 57344
v_add_u32 v237, s0, v233
s_and_b32 s0, s38, 2
s_lshl_b32 s0, s0, 1
s_add_u32 s0, s0, 1760
v_mov_b32 v238, s0
v_mov_b32 v239, 1744
v_cmp_eq_u32 vcc, 0, v0
s_nop 1
v_cndmask_b32 v240, 0, 1, vcc
s_cmp_eq_u32 s32, 4
s_cbranch_scc1 L_h0
v_mov_b32 v4, 0x3f803f80
v_mov_b32 v5, v4
v_lshrrev_b32 v1, 4, v0
v_mul_u32_u24 v1, 36736, v1
v_lshl_add_u32 v1, v0, 3, v1
ds_write_b64 v1, v[4:5] offset:8192
s_sub_u32 s0, s32, 5
s_mul_i32 s3, s43, 3
s_add_u32 s3, s3, s0
s_mul_i32 s3, s3, 2560
s_add_u32 s67, s3, 2621440
s_mul_i32 s3, s35, 1280
s_add_u32 s3, s3, s59
s_add_u32 s66, s3, 12288
v_min_u32 v1, 9, v0
v_lshl_add_u32 v55, v1, 7, s66
s_lshl_b32 s68, s36, 7
s_add_u32 s68, s68, s66
v_and_b32 v1, 15, v0
v_lshrrev_b32 v2, 5, v0
v_lshl_add_u32 v2, v2, 4, v1
s_lshl_b32 s0, s0, 5
v_add_lshl_u32 v52, v2, s0, 4
v_lshrrev_b32 v2, 4, v0
v_lshrrev_b32 v3, 1, v1
v_xor_b32 v3, v3, v2
v_lshlrev_b32 v3, 4, v3
v_lshl_add_u32 v3, v1, 7, v3
v_add_u32 v54, s64, v3
s_cmp_lt_u32 s39, 2560
s_cselect_b32 s3, 128, 0
v_mov_b32 v1, 0xf149f2ca
v_cmp_gt_u32 vcc, s3, v52
s_nop 1
v_cndmask_b32 v53, 0, v1, vcc
s_setprio 1
s_add_u32 m0, s61, s64
s_mov_b32 exec_lo, s62
buffer_load_dwordx4 v24, s[4:7], s63 offen lds
s_addk_i32 m0, 1024
s_mov_b32 exec_lo, -1
buffer_load_dwordx4 v25, s[4:7], s63 offen lds
s_addk_i32 m0, 1024
s_nop 0
buffer_load_dwordx4 v26, s[4:7], s63 offen lds
s_addk_i32 m0, 1024
s_nop 0
buffer_load_dwordx4 v27, s[4:7], s63 offen lds
v_lshrrev_b32 v1, 4, v0
v_lshlrev_b32 v1, 3, v1
s_lshl_b32 s3, s36, 7
buffer_load_dwordx2 v[244:245], v1, s[28:31], s3 offen offset:0
buffer_load_dwordx2 v[246:247], v1, s[28:31], s3 offen offset:32
buffer_load_dwordx2 v[248:249], v1, s[28:31], s3 offen offset:64
buffer_load_dwordx2 v[250:251], v1, s[28:31], s3 offen offset:96
v_mov_b32 v64, 0x3f803f80
v_mov_b32 v65, 0x3f803f80
v_mov_b32 v66, 0x3f803f80
v_mov_b32 v67, 0x3f803f80
s_waitcnt vmcnt(8) lgkmcnt(0)
s_barrier
v_xor_b32 v1, 64, v54
ds_read_b128 v[36:39], v54 offset:8192
ds_read_b128 v[40:43], v1 offset:8192
ds_read_b128 v[44:47], v54 offset:10240
ds_read_b128 v[48:51], v1 offset:10240
s_lshl_b32 s3, s36, 8
s_add_u32 s3, s3, s67
v_and_b32 v2, 0xf0, v233
s_mov_b32 s0, 0xaaaaaaaa
s_mov_b32 s1, s0
s_mov_b32 vcc_lo, 0xcccccccc
s_mov_b32 vcc_hi, 0xcccccccc
s_waitcnt lgkmcnt(3)
v_mfma_f32_16x16x32_bf16 v[96:99], v[36:39], v[36:39], 0
v_mfma_f32_16x16x32_bf16 v[100:103], v[64:67], v[36:39], 0
s_waitcnt lgkmcnt(2)
v_mfma_f32_16x16x32_bf16 v[96:99], v[40:43], v[40:43], v[96:99]
v_mfma_f32_16x16x32_bf16 v[100:103], v[64:67], v[40:43], v[100:103]
s_waitcnt lgkmcnt(1)
v_mfma_f32_16x16x32_bf16 v[104:107], v[44:47], v[44:47], 0
v_mfma_f32_16x16x32_bf16 v[108:111], v[64:67], v[44:47], 0
s_waitcnt lgkmcnt(0)
v_mfma_f32_16x16x32_bf16 v[104:107], v[48:51], v[48:51], v[104:107]
v_mfma_f32_16x16x32_bf16 v[108:111], v[64:67], v[48:51], v[108:111]
s_nop 0
v_cndmask_b32 v96, v96, v97, s[0:1]
v_cndmask_b32 v98, v98, v99, s[0:1]
v_cndmask_b32 v29, v96, v98, vcc
v_mov_b32 v28, v100
s_nop 1
v_cndmask_b32 v104, v104, v105, s[0:1]
v_cndmask_b32 v106, v106, v107, s[0:1]
v_cndmask_b32 v31, v104, v106, vcc
v_mov_b32 v30, v108
s_mov_b32 exec_lo, 0xf0000f
s_mov_b32 exec_hi, 0xf0000f00
buffer_store_dwordx4 v[28:31], v2, s[16:19], s3 offen sc1
s_mov_b64 exec, -1
v_mov_b32 v44, 0
v_mov_b32 v45, 0
v_mov_b32 v46, 0
v_mov_b32 v47, 0
s_add_u32 s69, s69, 1
s_cmp_eq_u32 s69, 10
s_cselect_b32 s69, 0, s69
s_lshl_b32 s63, s69, 7
s_mov_b32 s61, 81920
s_add_u32 m0, s61, s64
s_mov_b32 exec_lo, s62
buffer_load_dwordx4 v24, s[4:7], s63 offen lds
s_addk_i32 m0, 1024
s_mov_b32 exec_lo, -1
buffer_load_dwordx4 v25, s[4:7], s63 offen lds
s_addk_i32 m0, 1024
s_nop 0
buffer_load_dwordx4 v26, s[4:7], s63 offen lds
s_addk_i32 m0, 1024
s_nop 0
buffer_load_dwordx4 v27, s[4:7], s63 offen lds
s_branch L_pb_1
.p2align 12
L_pad_2:
s_setpc_b64 s[100:101]
L_pb_1:
s_waitcnt vmcnt(5) lgkmcnt(0)
s_cmp_eq_u32 s32, 5
s_cbranch_scc0 L_o5a
s_lshl_b32 s0, s33, 5
v_and_b32 v1, 16, v0
buffer_load_dword v32, v1, s[24:27], s0 offen sc1
L_o5a:
s_barrier
s_mul_i32 s3, s2, 3
s_add_u32 s3, s3, s32
s_sub_u32 s3, s3, 5
s_mul_i32 s3, s3, 1152
v_lshlrev_b32 v1, 7, v0
s_mov_b64 exec, 0x1ff
buffer_load_dword v255, v1, s[12:15], s3 offen
s_mov_b64 exec, -1
s_add_u32 s69, s69, 1
s_cmp_eq_u32 s69, 10
s_cselect_b32 s69, 0, s69
s_lshl_b32 s63, s69, 7
s_mov_b32 s61, 118784
s_add_u32 m0, s61, s64
s_mov_b32 exec_lo, s62
buffer_load_dwordx4 v24, s[4:7], s63 offen lds
s_addk_i32 m0, 1024
s_mov_b32 exec_lo, -1
buffer_load_dwordx4 v25, s[4:7], s63 offen lds
s_addk_i32 m0, 1024
s_nop 0
buffer_load_dwordx4 v26, s[4:7], s63 offen lds
s_addk_i32 m0, 1024
s_nop 0
buffer_load_dwordx4 v27, s[4:7], s63 offen lds
s_cmp_eq_u32 s57, 1
s_cbranch_scc0 L_xc1
s_mov_b32 s0, 45056
s_call_b64 s[100:101], L_xcap
L_xc1:
s_cmp_eq_u32 s32, 7
s_cbranch_scc0 L_wm1
s_call_b64 s[100:101], L_pad_8
s_call_b64 s[100:101], L_pad_24
L_wm1:
s_waitcnt vmcnt(5) lgkmcnt(0)
s_barrier
s_cmp_eq_u32 s32, 5
s_cbranch_scc0 L_o5c
s_waitcnt lgkmcnt(0)
v_cmp_ne_u32 vcc, 1, v32
s_cmp_eq_u64 vcc, 0
s_cbranch_scc0 L_era
L_ega:
s_getreg_b32 s0, hwreg(HW_REG_XCC_ID, 0, 4)
v_mov_b32 v1, s0
s_mov_b64 exec, 1
buffer_store_dword v1, off, s[16:19], s68 sc1
s_mov_b64 exec, -1
L_o5c:
s_add_u32 s69, s69, 1
s_cmp_eq_u32 s69, 10
s_cselect_b32 s69, 0, s69
s_lshl_b32 s63, s69, 7
s_mov_b32 s61, 8192
s_add_u32 m0, s61, s64
s_mov_b32 exec_lo, s62
buffer_load_dwordx4 v24, s[4:7], s63 offen lds
s_addk_i32 m0, 1024
s_mov_b32 exec_lo, -1
buffer_load_dwordx4 v25, s[4:7], s63 offen lds
s_addk_i32 m0, 1024
s_nop 0
buffer_load_dwordx4 v26, s[4:7], s63 offen lds
s_addk_i32 m0, 1024
s_nop 0
buffer_load_dwordx4 v27, s[4:7], s63 offen lds
s_cmp_eq_u32 s57, 2
s_cbranch_scc0 L_xc2
s_mov_b32 s0, 81920
s_call_b64 s[100:101], L_xcap
L_xc2:
s_cmp_eq_u32 s32, 7
s_cbranch_scc0 L_wm2
s_call_b64 s[100:101], L_pad_11
s_call_b64 s[100:101], L_pad_25
L_wm2:
s_cmp_eq_u32 s32, 5
s_cbranch_scc1 L_w52
s_waitcnt vmcnt(4)
L_w52:
s_waitcnt vmcnt(5) lgkmcnt(0)
s_barrier
s_add_u32 s69, s69, 1
s_cmp_eq_u32 s69, 10
s_cselect_b32 s69, 0, s69
s_lshl_b32 s63, s69, 7
s_mov_b32 s61, 45056
s_add_u32 m0, s61, s64
s_mov_b32 exec_lo, s62
buffer_load_dwordx4 v24, s[4:7], s63 offen lds
s_addk_i32 m0, 1024
s_mov_b32 exec_lo, -1
buffer_load_dwordx4 v25, s[4:7], s63 offen lds
s_addk_i32 m0, 1024
s_nop 0
buffer_load_dwordx4 v26, s[4:7], s63 offen lds
s_addk_i32 m0, 1024
s_nop 0
buffer_load_dwordx4 v27, s[4:7], s63 offen lds
s_cmp_eq_u32 s57, 3
s_cbranch_scc0 L_xc3
s_mov_b32 s0, 118784
s_call_b64 s[100:101], L_xcap
L_xc3:
s_cmp_eq_u32 s32, 7
s_cbranch_scc0 L_wm3
s_call_b64 s[100:101], L_pad_12
L_wm3:
s_waitcnt vmcnt(4) lgkmcnt(0)
s_barrier
s_add_u32 s69, s69, 1
s_cmp_eq_u32 s69, 10
s_cselect_b32 s69, 0, s69
s_lshl_b32 s63, s69, 7
s_mov_b32 s61, 81920
s_add_u32 m0, s61, s64
s_mov_b32 exec_lo, s62
buffer_load_dwordx4 v24, s[4:7], s63 offen lds
s_addk_i32 m0, 1024
s_mov_b32 exec_lo, -1
buffer_load_dwordx4 v25, s[4:7], s63 offen lds
s_addk_i32 m0, 1024
s_nop 0
buffer_load_dwordx4 v26, s[4:7], s63 offen lds
s_addk_i32 m0, 1024
s_nop 0
buffer_load_dwordx4 v27, s[4:7], s63 offen lds
s_cmp_eq_u32 s57, 4
s_cbranch_scc0 L_xc4
s_mov_b32 s0, 8192
s_call_b64 s[100:101], L_xcap
L_xc4:
s_cmp_eq_u32 s32, 7
s_cbranch_scc0 L_wm4
s_call_b64 s[100:101], L_pad_13
L_wm4:
s_waitcnt vmcnt(4) lgkmcnt(0)
s_cmp_eq_u32 s32, 5
s_cbranch_scc0 L_o5b
s_buffer_load_dword s71, s[16:19], s66 offset:0 glc
s_buffer_load_dword s73, s[16:19], s66 offset:128 glc
s_buffer_load_dword s75, s[16:19], s66 offset:256 glc
s_buffer_load_dword s77, s[16:19], s66 offset:384 glc
s_buffer_load_dword s83, s[16:19], s66 offset:512 glc
s_buffer_load_dword s85, s[16:19], s66 offset:640 glc
s_buffer_load_dword s89, s[16:19], s66 offset:768 glc
s_buffer_load_dword s91, s[16:19], s66 offset:896 glc
s_buffer_load_dword s93, s[16:19], s66 offset:1024 glc
s_buffer_load_dword s95, s[16:19], s66 offset:1152 glc
L_o5b:
s_barrier
s_add_u32 s69, s69, 1
s_cmp_eq_u32 s69, 10
s_cselect_b32 s69, 0, s69
s_lshl_b32 s63, s69, 7
s_mov_b32 s61, 118784
s_add_u32 m0, s61, s64
s_mov_b32 exec_lo, s62
buffer_load_dwordx4 v24, s[4:7], s63 offen lds
s_addk_i32 m0, 1024
s_mov_b32 exec_lo, -1
buffer_load_dwordx4 v25, s[4:7], s63 offen lds
s_addk_i32 m0, 1024
s_nop 0
buffer_load_dwordx4 v26, s[4:7], s63 offen lds
s_addk_i32 m0, 1024
s_nop 0
buffer_load_dwordx4 v27, s[4:7], s63 offen lds
s_cmp_eq_u32 s57, 5
s_cbranch_scc0 L_xc5
s_mov_b32 s0, 45056
s_call_b64 s[100:101], L_xcap
L_xc5:
s_cmp_eq_u32 s32, 5
s_cbranch_scc0 L_o5d
s_waitcnt lgkmcnt(0)
s_max_u32 s0, s71, s73
s_max_u32 s0, s0, s75
s_max_u32 s0, s0, s77
s_max_u32 s0, s0, s83
s_max_u32 s0, s0, s85
s_max_u32 s0, s0, s89
s_max_u32 s0, s0, s91
s_max_u32 s0, s0, s93
s_max_u32 s0, s0, s95
s_cmp_lg_u32 s0, -1
s_cbranch_scc0 L_erb
L_egb:
s_min_u32 s1, s71, s73
s_min_u32 s1, s1, s75
s_min_u32 s1, s1, s77
s_min_u32 s1, s1, s83
s_min_u32 s1, s1, s85
s_min_u32 s1, s1, s89
s_min_u32 s1, s1, s91
s_min_u32 s1, s1, s93
s_min_u32 s1, s1, s95
s_cmp_eq_u32 s0, s1
s_cselect_b32 s0, 1, 0
v_mov_b32 v1, 1728
v_mov_b32 v2, s0
ds_write_b32 v1, v2
L_o5d:
s_cmp_eq_u32 s32, 7
s_cbranch_scc0 L_wm5
s_call_b64 s[100:101], L_pad_14
L_wm5:
s_waitcnt vmcnt(4) lgkmcnt(0)
s_barrier
buffer_load_dwordx4 v[36:39], v233, s[16:19], s67 offen offset:0 sc1
buffer_load_dwordx4 v[40:43], v233, s[16:19], s67 offen offset:1024 sc1
s_mov_b32 exec_hi, 0
buffer_load_dwordx4 v[44:47], v233, s[16:19], s67 offen offset:2048 sc1
s_mov_b32 exec_hi, -1
s_add_u32 s69, s69, 1
s_cmp_eq_u32 s69, 10
s_cselect_b32 s69, 0, s69
s_lshl_b32 s63, s69, 7
s_mov_b32 s61, 8192
s_add_u32 m0, s61, s64
s_mov_b32 exec_lo, s62
buffer_load_dwordx4 v24, s[4:7], s63 offen lds
s_addk_i32 m0, 1024
s_mov_b32 exec_lo, -1
buffer_load_dwordx4 v25, s[4:7], s63 offen lds
s_addk_i32 m0, 1024
s_nop 0
buffer_load_dwordx4 v26, s[4:7], s63 offen lds
s_addk_i32 m0, 1024
s_nop 0
buffer_load_dwordx4 v27, s[4:7], s63 offen lds
s_cmp_eq_u32 s57, 6
s_cbranch_scc0 L_xc6
s_mov_b32 s0, 81920
s_call_b64 s[100:101], L_xcap
L_xc6:
s_cmp_eq_u32 s32, 7
s_cbranch_scc0 L_wm6
s_call_b64 s[100:101], L_pad_21
L_wm6:
s_waitcnt vmcnt(7) lgkmcnt(0)
s_barrier
s_add_u32 s69, s69, 1
s_cmp_eq_u32 s69, 10
s_cselect_b32 s69, 0, s69
s_lshl_b32 s63, s69, 7
s_mov_b32 s61, 45056
s_add_u32 m0, s61, s64
s_mov_b32 exec_lo, s62
buffer_load_dwordx4 v24, s[4:7], s63 offen lds
s_addk_i32 m0, 1024
s_mov_b32 exec_lo, -1
buffer_load_dwordx4 v25, s[4:7], s63 offen lds
s_addk_i32 m0, 1024
s_nop 0
buffer_load_dwordx4 v26, s[4:7], s63 offen lds
s_addk_i32 m0, 1024
s_nop 0
buffer_load_dwordx4 v27, s[4:7], s63 offen lds
s_cmp_eq_u32 s57, 7
s_cbranch_scc0 L_xc7
s_mov_b32 s0, 118784
s_call_b64 s[100:101], L_xcap
L_xc7:
s_waitcnt vmcnt(8)
v_add_f32 v36, v36, v40
v_add_f32 v37, v37, v41
v_add_f32 v38, v38, v42
v_add_f32 v39, v39, v43
v_add_f32 v36, v36, v44
v_add_f32 v37, v37, v45
v_add_f32 v38, v38, v46
v_add_f32 v39, v39, v47
s_nop 0
v_permlane32_swap_b32 v36, v38
v_permlane32_swap_b32 v37, v39
v_add_f32 v36, v36, v38
v_add_f32 v37, v37, v39
v_mov_b32 v38, v36
v_mov_b32 v39, v37
s_mov_b32 s1, 0x3acccccd
v_mov_b32 v1, 0x3727c5ac
v_permlane16_swap_b32 v36, v38
v_permlane16_swap_b32 v37, v39
v_add_f32 v36, v36, v38
v_add_f32 v37, v37, v39
v_mul_f32 v36, 0xbacccccd, v36
v_fma_f32 v2, v37, s1, v1
v_fma_f32 v2, -v36, v36, v2
v_max_f32 v2, v2, v1
v_rsq_f32 v37, v2
v_mov_b32 v39, v53
v_mov_b32 v38, v37
ds_write_b128 v52, v[36:39] offset:0
s_waitcnt vmcnt(4) lgkmcnt(0)
s_barrier
s_cmp_eq_u32 s57, 8
s_cbranch_scc0 L_xc8
s_mov_b32 s0, 8192
s_call_b64 s[100:101], L_xcap
L_xc8:
L_h8:
s_mul_i32 s66, s38, 5120
s_lshl_b32 s3, s38, 10
s_add_u32 m0, s3, 81920
s_add_u32 s3, s66, 25600
buffer_load_dwordx4 v56, s[12:15], s3 offen lds
s_addk_i32 m0, 4096
s_add_u32 s3, s66, 102400
buffer_load_dwordx4 v56, s[12:15], s3 offen lds
s_addk_i32 m0, 4096
s_add_u32 s3, s66, 179200
buffer_load_dwordx4 v56, s[12:15], s3 offen lds
s_addk_i32 m0, 4096
s_add_u32 s3, s66, 256000
buffer_load_dwordx4 v56, s[12:15], s3 offen lds
s_addk_i32 m0, 4096
s_add_u32 s3, s66, 332800
buffer_load_dwordx4 v56, s[12:15], s3 offen lds
s_addk_i32 m0, 4096
s_add_u32 s3, s66, 435200
buffer_load_dwordx4 v56, s[12:15], s3 offen lds
s_addk_i32 m0, 4096
s_add_u32 s3, s66, 512000
buffer_load_dwordx4 v56, s[12:15], s3 offen lds
s_addk_i32 m0, 4096
s_add_u32 s3, s66, 588800
buffer_load_dwordx4 v56, s[12:15], s3 offen lds
v_add_u32 v1, 128, v222
v_cndmask_b32 v4, v1, v222, s[44:45]
ds_read_b64 v[168:169], v4 offset:0
v_cndmask_b32 v4, v1, v222, s[46:47]
ds_read_b64 v[170:171], v4 offset:32
v_cndmask_b32 v4, v1, v222, s[48:49]
ds_read_b64 v[172:173], v4 offset:64
v_cndmask_b32 v4, v1, v222, s[50:51]
ds_read_b64 v[174:175], v4 offset:96
ds_read_b32 v5, v223 offset:0
v_mov_b32 v1, 1728
ds_read_b32 v1, v1
s_waitcnt lgkmcnt(0)
v_readfirstlane_b32 s41, v1
s_waitcnt vmcnt(8)
s_barrier
s_cmp_eq_u32 s41, 1
s_cbranch_scc0 L_gh_3g
L_gh_3b:
s_addk_i32 m0, 4096
s_add_u32 s3, s66, 665600
buffer_load_dwordx4 v56, s[12:15], s3 offen lds
s_addk_i32 m0, 4096
s_add_u32 s3, s66, 742400
buffer_load_dwordx4 v56, s[12:15], s3 offen lds
buffer_load_dword v62, v61, s[20:23], s54 offen
buffer_load_dword v63, v63, s[16:19], 0 offen
global_load_dword v84, v84, s[96:97]
v_lshlrev_b32 v8, 16, v72
v_and_b32 v9, 0xffff0000, v72
v_lshlrev_b32 v10, 16, v73
v_and_b32 v11, 0xffff0000, v73
v_lshlrev_b32 v12, 16, v74
v_and_b32 v13, 0xffff0000, v74
v_lshlrev_b32 v14, 16, v75
v_and_b32 v15, 0xffff0000, v75
v_lshlrev_b32 v16, 16, v76
v_and_b32 v17, 0xffff0000, v76
v_lshlrev_b32 v18, 16, v77
v_and_b32 v19, 0xffff0000, v77
v_lshlrev_b32 v20, 16, v78
v_and_b32 v21, 0xffff0000, v78
v_lshlrev_b32 v22, 16, v79
v_and_b32 v23, 0xffff0000, v79
s_mov_b32 s3, 0x3f803f80
v_mov_b32 v64, s3
v_mov_b32 v65, s3
v_mov_b32 v66, s3
v_mov_b32 v67, s3
s_mov_b32 exec_lo, 0x11111111
s_mov_b32 exec_hi, 0x11111111
v_mov_b32 v244, s3
v_mov_b32 v245, s3
v_mov_b32 v246, s3
v_mov_b32 v247, s3
v_mov_b32 v248, s3
v_mov_b32 v249, s3
v_mov_b32 v250, s3
v_mov_b32 v251, s3
s_mov_b64 exec, -1
v_mfma_f32_16x16x32_bf16 v[252:255], v[244:247], v[64:67], 0
v_mfma_f32_16x16x32_bf16 v[252:255], v[248:251], v[64:67], v[252:255]
s_and_b32 s3, s32, 1
s_lshl_b32 s61, s3, 7
s_xor_b32 s62, s61, 128
s_add_u32 s63, s62, s54
s_add_u32 s64, s61, s54
s_lshl_b32 s3, s3, 13
s_sub_u32 s65, 4096, s3
s_add_u32 s0, s37, 1
s_sub_u32 s1, 5, s37
s_min_u32 s0, s0, s1
s_lshl_b32 s0, s0, 4
s_sub_u32 s1, 64, s0
s_cmp_le_u32 s37, 2
s_cselect_b32 s1, s1, 16
s_bfm_b64 s[100:101], s0, s1
v_mul_f32 v5, 0x3ea52b5c, v5
s_barrier
ds_read_b64 v[96:97], v202 offset:0
ds_read_b64 v[98:99], v202 offset:1152
ds_read_b64 v[100:101], v203 offset:0
ds_read_b64 v[102:103], v203 offset:1152
ds_read_b64 v[104:105], v201 offset:0
ds_read_b64 v[106:107], v201 offset:1152
ds_read_b64 v[108:109], v200 offset:0
ds_read_b64 v[110:111], v200 offset:1152
ds_read_b64 v[112:113], v200 offset:40
ds_read_b64 v[114:115], v200 offset:1192
s_cmp_eq_u32 s38, 1
s_cbranch_scc1 L_woe1
s_cmp_eq_u32 s38, 2
s_cbranch_scc1 L_woe2
s_cmp_eq_u32 s38, 3
s_cbranch_scc1 L_woe3
s_addk_i32 m0, 4096
s_mov_b32 s3, 46080
buffer_load_dwordx4 v56, s[12:15], s3 offen lds
s_addk_i32 m0, 4096
s_mov_b32 s3, 122880
buffer_load_dwordx4 v56, s[12:15], s3 offen lds
s_addk_i32 m0, 4096
s_mov_b32 s3, 199680
buffer_load_dwordx4 v56, s[12:15], s3 offen lds
s_addk_i32 m0, 4096
s_mov_b32 s3, 276480
buffer_load_dwordx4 v56, s[12:15], s3 offen lds
s_addk_i32 m0, 4096
s_mov_b32 s3, 353280
buffer_load_dwordx4 v56, s[12:15], s3 offen lds
s_addk_i32 m0, 4096
s_mov_b32 s3, 455680
buffer_load_dwordx4 v56, s[12:15], s3 offen lds
s_addk_i32 m0, 4096
s_mov_b32 s3, 532480
buffer_load_dwordx4 v56, s[12:15], s3 offen lds
s_addk_i32 m0, 4096
s_mov_b32 s3, 609280
buffer_load_dwordx4 v56, s[12:15], s3 offen lds
s_addk_i32 m0, 4096
s_mov_b32 s3, 686080
buffer_load_dwordx4 v56, s[12:15], s3 offen lds
s_addk_i32 m0, 4096
s_mov_b32 s3, 762880
buffer_load_dwordx4 v56, s[12:15], s3 offen lds
L_woe:
buffer_load_dword v62, v61, s[20:23], 0 offen
s_setprio 1
s_waitcnt vmcnt(16)
s_barrier
ds_read_b64 v[116:117], v206 offset:0
ds_read_b64 v[118:119], v207 offset:0
ds_read_b64 v[120:121], v208 offset:0
ds_read_b64 v[122:123], v209 offset:0
ds_read_b64 v[124:125], v210 offset:0
ds_read_b64 v[126:127], v211 offset:0
ds_read_b64 v[128:129], v204 offset:0
ds_read_b64 v[130:131], v205 offset:0
ds_read_b64 v[132:133], v204 offset:40
ds_read_b64 v[134:135], v205 offset:40
s_waitcnt lgkmcnt(8)
v_mfma_f32_16x16x32_bf16 v[152:155], v[96:99], v[116:119], 0
ds_read_b64 v[136:137], v212 offset:0
ds_read_b64 v[138:139], v213 offset:0
s_waitcnt lgkmcnt(8)
v_mfma_f32_16x16x32_bf16 v[156:159], v[100:103], v[120:123], 0
ds_read_b64 v[140:141], v214 offset:0
ds_read_b64 v[142:143], v215 offset:0
s_waitcnt lgkmcnt(8)
v_mfma_f32_16x16x32_bf16 v[152:155], v[104:107], v[124:127], v[152:155]
s_waitcnt lgkmcnt(6)
v_mfma_f32_16x16x32_bf16 v[160:163], v[108:111], v[128:131], 0
s_waitcnt lgkmcnt(4)
v_mfma_f32_16x16x32_bf16 v[164:167], v[112:115], v[132:135], 0
s_waitcnt lgkmcnt(2)
v_mfma_f32_16x16x32_bf16 v[160:163], v[104:107], v[136:139], v[160:163]
s_waitcnt lgkmcnt(0)
v_mfma_f32_16x16x32_bf16 v[164:167], v[104:107], v[140:143], v[164:167]
v_permlane16_swap_b32 v152, v156
v_permlane16_swap_b32 v153, v157
v_permlane16_swap_b32 v154, v158
v_permlane16_swap_b32 v155, v159
v_cndmask_b32 v2, v156, v152, s[44:45]
v_cndmask_b32 v3, v157, v153, s[46:47]
v_cndmask_b32 v194, v158, v154, s[48:49]
v_cndmask_b32 v195, v159, v155, s[50:51]
v_or_b32 v192, 0xffff, v2
v_perm_b32 v193, v3, v2, s55
s_cmp_eq_u32 s41, 1
s_cbranch_scc0 L_gl_4g
buffer_store_dwordx4 v[192:195], v224, s[20:23], s54 offen
L_gl_4b:
v_permlane16_swap_b32 v160, v164
v_permlane16_swap_b32 v161, v165
v_permlane16_swap_b32 v162, v166
v_permlane16_swap_b32 v163, v167
v_cndmask_b32 v196, v164, v160, s[44:45]
v_cndmask_b32 v197, v165, v161, s[46:47]
v_cndmask_b32 v198, v166, v162, s[48:49]
v_cndmask_b32 v199, v167, v163, s[50:51]
v_fma_f32 v196, v196, v168, v169
v_fma_f32 v197, v197, v170, v171
v_fma_f32 v198, v198, v172, v173
v_fma_f32 v199, v199, v174, v175
v_max3_f32 v6, v196, v197, v198
v_max_f32 v6, v6, v199
v_mov_b32 v7, v6
s_nop 1
v_permlane32_swap_b32 v6, v7
v_max_f32 v6, v6, v7
v_mul_f32 v6, v6, v5
v_fma_f32 v196, v196, v5, -v6
v_fma_f32 v197, v197, v5, -v6
v_fma_f32 v198, v198, v5, -v6
v_fma_f32 v199, v199, v5, -v6
v_exp_f32 v196, v196
v_exp_f32 v197, v197
v_exp_f32 v198, v198
v_exp_f32 v199, v199
ds_read_b64_tr_b16 v[64:65], v216 offset:0
ds_read_b64_tr_b16 v[66:67], v216 offset:1152
ds_read_b64_tr_b16 v[68:69], v216 offset:40
ds_read_b64_tr_b16 v[70:71], v216 offset:1192
ds_read_b64_tr_b16 v[72:73], v217 offset:0
ds_read_b64_tr_b16 v[74:75], v217 offset:1152
ds_read_b64_tr_b16 v[76:77], v218 offset:0
ds_read_b64_tr_b16 v[78:79], v218 offset:1152
v_add_f32 v6, v196, v197
v_add_f32 v7, v198, v199
v_add_f32 v6, v6, v7
v_mov_b32 v7, v6
v_mul_f32 v196, v196, v168
v_mul_f32 v197, v197, v170
v_permlane32_swap_b32 v6, v7
v_mul_f32 v198, v198, v172
v_add_f32 v6, v6, v7
v_rcp_f32 v6, v6
v_mul_f32 v199, v199, v174
v_mul_f32 v196, v196, v6
v_mul_f32 v197, v197, v6
v_mul_f32 v198, v198, v6
v_mul_f32 v199, v199, v6
v_cvt_pk_bf16_f32 v196, v196, v197
v_cvt_pk_bf16_f32 v197, v198, v199
s_mov_b64 exec, s[52:53]
v_and_b32 v176, v220, v196
v_bfi_b32 v180, v220, 0, v196
v_and_b32 v177, v221, v197
v_bfi_b32 v181, v221, 0, v197
s_not_b64 exec, exec
v_and_b32 v178, v220, v196
v_bfi_b32 v182, v220, 0, v196
v_and_b32 v179, v221, v197
v_bfi_b32 v183, v221, 0, v197
s_mov_b64 exec, -1
v_permlane16_swap_b32 v176, v180
v_permlane16_swap_b32 v177, v181
v_permlane16_swap_b32 v178, v182
v_permlane16_swap_b32 v179, v183
buffer_load_dwordx4 v[92:95], v225, s[20:23], s54 offen sc1
s_waitcnt lgkmcnt(0)
v_mfma_f32_16x16x32_bf16 v[152:155], v[64:67], v[176:179], 0
v_mfma_f32_16x16x32_bf16 v[156:159], v[68:71], v[180:183], 0
v_mfma_f32_16x16x32_bf16 v[160:163], v[72:75], v[176:179], 0
v_mfma_f32_16x16x32_bf16 v[164:167], v[76:79], v[180:183], 0
s_nop 4
v_cvt_pk_bf16_f32 v196, v152, v153
v_cvt_pk_bf16_f32 v197, v154, v155
v_cvt_pk_bf16_f32 v198, v156, v157
v_cvt_pk_bf16_f32 v199, v158, v159
s_cmp_eq_u32 s41, 1
s_cbranch_scc0 L_gl_5g
buffer_store_dwordx4 v[196:199], v226, s[20:23], 0 offen
L_gl_5b:
v_cvt_pk_bf16_f32 v80, v160, v161
v_cvt_pk_bf16_f32 v81, v162, v163
v_cvt_pk_bf16_f32 v82, v164, v165
v_cvt_pk_bf16_f32 v83, v166, v167
ds_read_b64_tr_b16 v[104:105], v228 offset:0
ds_read_b64_tr_b16 v[106:107], v228 offset:512
ds_read_b64_tr_b16 v[108:109], v229 offset:0
ds_read_b64_tr_b16 v[110:111], v229 offset:512
ds_read_b64_tr_b16 v[112:113], v230 offset:0
ds_read_b64_tr_b16 v[114:115], v230 offset:512
ds_read_b64_tr_b16 v[116:117], v231 offset:0
ds_read_b64_tr_b16 v[118:119], v231 offset:512
ds_read_b64_tr_b16 v[120:121], v228 offset:8192
ds_read_b64_tr_b16 v[122:123], v228 offset:8704
ds_read_b64_tr_b16 v[124:125], v229 offset:8192
ds_read_b64_tr_b16 v[126:127], v229 offset:8704
ds_read_b64_tr_b16 v[128:129], v230 offset:8192
ds_read_b64_tr_b16 v[130:131], v230 offset:8704
ds_read_b64_tr_b16 v[132:133], v231 offset:8192
ds_read_b64_tr_b16 v[134:135], v231 offset:8704
ds_read_b64_tr_b16 v[136:137], v228 offset:16384
ds_read_b64_tr_b16 v[138:139], v228 offset:16896
ds_read_b64_tr_b16 v[140:141], v229 offset:16384
ds_read_b64_tr_b16 v[142:143], v229 offset:16896
ds_read_b64_tr_b16 v[144:145], v230 offset:16384
ds_read_b64_tr_b16 v[146:147], v230 offset:16896
ds_read_b64_tr_b16 v[148:149], v231 offset:16384
ds_read_b64_tr_b16 v[150:151], v231 offset:16896
s_waitcnt vmcnt(1)
v_cmp_eq_u32 vcc, -1, v92
s_cbranch_vccnz L_h0rh
L_h0gh:
s_mov_b64 exec, 1
ds_add_u32 v239, v240
s_mov_b64 exec, -1
v_perm_b32 v92, v92, v93, s56
v_add_f32 v193, v3, v93
v_add_f32 v194, v194, v94
v_add_f32 v195, v195, v95
v_add_f32 v192, v2, v92
v_fma_f32 v192, v192, v168, v169
v_fma_f32 v193, v193, v170, v171
v_fma_f32 v194, v194, v172, v173
v_fma_f32 v195, v195, v174, v175
v_max3_f32 v6, v192, v193, v194
v_max_f32 v6, v6, v195
v_mov_b32 v7, v6
s_nop 1
v_permlane32_swap_b32 v6, v7
v_max_f32 v6, v6, v7
v_mul_f32 v6, v6, v5
v_fma_f32 v192, v192, v5, -v6
v_fma_f32 v193, v193, v5, -v6
v_fma_f32 v194, v194, v5, -v6
v_fma_f32 v195, v195, v5, -v6
v_exp_f32 v192, v192
v_exp_f32 v193, v193
v_exp_f32 v194, v194
v_exp_f32 v195, v195
buffer_load_dwordx4 v[24:27], v227, s[20:23], s61 offen offset:0 sc1
buffer_load_dwordx4 v[28:31], v227, s[20:23], s61 offen offset:256 sc1
buffer_load_dwordx4 v[32:35], v227, s[20:23], s61 offen offset:512 sc1
buffer_load_dwordx4 v[36:39], v227, s[20:23], s61 offen offset:768 sc1
buffer_load_dwordx4 v[40:43], v227, s[20:23], s61 offen offset:1024 sc1
buffer_load_dwordx4 v[44:47], v227, s[20:23], s62 offen offset:0 sc1
v_add_f32 v6, v192, v193
v_add_f32 v7, v194, v195
v_add_f32 v6, v6, v7
v_mov_b32 v7, v6
v_mul_f32 v192, v192, v168
v_mul_f32 v193, v193, v170
v_permlane32_swap_b32 v6, v7
v_mul_f32 v194, v194, v172
v_add_f32 v6, v6, v7
v_rcp_f32 v6, v6
v_mul_f32 v195, v195, v174
v_mul_f32 v192, v192, v6
v_mul_f32 v193, v193, v6
v_mul_f32 v194, v194, v6
v_mul_f32 v195, v195, v6
v_cvt_pk_bf16_f32 v192, v192, v193
v_cvt_pk_bf16_f32 v193, v194, v195
s_mov_b64 exec, s[52:53]
v_and_b32 v184, v220, v192
v_bfi_b32 v188, v220, 0, v192
v_and_b32 v185, v221, v193
v_bfi_b32 v189, v221, 0, v193
s_not_b64 exec, exec
v_and_b32 v186, v220, v192
v_bfi_b32 v190, v220, 0, v192
v_and_b32 v187, v221, v193
v_bfi_b32 v191, v221, 0, v193
s_mov_b64 exec, -1
v_permlane16_swap_b32 v184, v188
v_permlane16_swap_b32 v185, v189
v_permlane16_swap_b32 v186, v190
v_permlane16_swap_b32 v187, v191
s_nop 1
v_mfma_f32_16x16x32_bf16 v[152:155], v[72:75], v[184:187], 0
v_mfma_f32_16x16x32_bf16 v[156:159], v[76:79], v[184:187], 0
v_mfma_f32_16x16x32_bf16 v[160:163], v[76:79], v[188:191], 0
ds_read_b32 v1, v239
s_mov_b32 exec_lo, 0xffff0000
s_nop 3
v_cvt_pk_bf16_f32 v80, v152, v153
v_cvt_pk_bf16_f32 v81, v154, v155
v_cvt_pk_bf16_f32 v82, v156, v157
v_cvt_pk_bf16_f32 v83, v158, v159
s_mov_b64 exec, s[100:101]
v_cvt_pk_bf16_f32 v82, v160, v161
v_cvt_pk_bf16_f32 v83, v162, v163
s_mov_b64 exec, -1
s_cmp_eq_u32 s41, 1
s_cbranch_scc0 L_gl_6g
buffer_store_dwordx4 v[80:83], v226, s[20:23], s54 offen
L_gl_6b:
s_branch L_pb_7
.p2align 12
L_pad_8:
s_setpc_b64 s[100:101]
L_pb_7:
s_waitcnt lgkmcnt(0)
v_cmp_ne_u32 vcc, 4, v1
s_cbranch_vccnz L_spw
L_sbw:
s_waitcnt vmcnt(5)
v_max_u16 v2, v24, v28
v_cmp_eq_u16 vcc, -1, v2
s_cbranch_vccnz L_st0
L_go0:
v_mfma_f32_16x16x32_bf16 v[8:11], v[104:107], v[24:27], v[8:11]
buffer_load_dwordx4 v[48:51], v236, s[20:23], s62 offen offset:0 sc1
ds_read_b64_tr_b16 v[152:153], v228 offset:24576
v_mfma_f32_16x16x32_bf16 v[12:15], v[108:111], v[24:27], v[12:15]
ds_read_b64_tr_b16 v[154:155], v228 offset:25088
ds_read_b64_tr_b16 v[156:157], v229 offset:24576
v_mfma_f32_16x16x32_bf16 v[16:19], v[112:115], v[24:27], v[16:19]
ds_read_b64_tr_b16 v[158:159], v229 offset:25088
ds_read_b64_tr_b16 v[160:161], v230 offset:24576
v_mfma_f32_16x16x32_bf16 v[20:23], v[116:119], v[24:27], v[20:23]
ds_read_b64_tr_b16 v[162:163], v230 offset:25088
ds_read_b64_tr_b16 v[164:165], v231 offset:24576
v_mfma_f32_16x16x32_bf16 v[8:11], v[120:123], v[28:31], v[8:11]
buffer_load_dwordx4 v[52:55], v227, s[20:23], s62 offen offset:256 sc1
ds_read_b64_tr_b16 v[166:167], v231 offset:25088
v_mfma_f32_16x16x32_bf16 v[12:15], v[124:127], v[28:31], v[12:15]
ds_read_b64_tr_b16 v[168:169], v228 offset:32768
s_waitcnt vmcnt(5)
v_max_u16 v2, v32, v36
v_cmp_eq_u16 vcc, -1, v2
v_mfma_f32_16x16x32_bf16 v[16:19], v[128:131], v[28:31], v[16:19]
ds_read_b64_tr_b16 v[170:171], v228 offset:33280
s_cbranch_vccnz L_st1
L_go1:
v_mfma_f32_16x16x32_bf16 v[20:23], v[132:135], v[28:31], v[20:23]
ds_read_b64_tr_b16 v[172:173], v229 offset:32768
v_mfma_f32_16x16x32_bf16 v[8:11], v[136:139], v[32:35], v[8:11]
buffer_load_dwordx4 v[56:59], v236, s[20:23], s62 offen offset:256 sc1
ds_read_b64_tr_b16 v[174:175], v229 offset:33280
v_mfma_f32_16x16x32_bf16 v[12:15], v[140:143], v[32:35], v[12:15]
ds_read_b64_tr_b16 v[176:177], v230 offset:32768
ds_read_b64_tr_b16 v[178:179], v230 offset:33280
v_mfma_f32_16x16x32_bf16 v[16:19], v[144:147], v[32:35], v[16:19]
ds_read_b64_tr_b16 v[180:181], v231 offset:32768
ds_read_b64_tr_b16 v[182:183], v231 offset:33280
v_mfma_f32_16x16x32_bf16 v[20:23], v[148:151], v[32:35], v[20:23]
v_add_u32 v228, s65, v228
ds_read_b64_tr_b16 v[184:185], v228 offset:0
ds_read_b64_tr_b16 v[186:187], v228 offset:512
s_waitcnt lgkmcnt(10)
v_mfma_f32_16x16x32_bf16 v[8:11], v[152:155], v[36:39], v[8:11]
buffer_load_dwordx4 v[60:63], v227, s[20:23], s62 offen offset:512 sc1
v_add_u32 v229, s65, v229
ds_read_b64_tr_b16 v[188:189], v229 offset:0
v_mfma_f32_16x16x32_bf16 v[12:15], v[156:159], v[36:39], v[12:15]
buffer_load_dwordx4 v[64:67], v236, s[20:23], s62 offen offset:512 sc1
ds_read_b64_tr_b16 v[190:191], v229 offset:512
s_waitcnt vmcnt(7)
v_cmp_eq_u16 vcc, -1, v40
v_mfma_f32_16x16x32_bf16 v[16:19], v[160:163], v[36:39], v[16:19]
v_add_u32 v230, s65, v230
ds_read_b64_tr_b16 v[192:193], v230 offset:0
s_cbranch_vccnz L_st2
L_go2:
v_mfma_f32_16x16x32_bf16 v[20:23], v[164:167], v[36:39], v[20:23]
ds_read_b64_tr_b16 v[194:195], v230 offset:512
s_waitcnt lgkmcnt(6)
v_mfma_f32_16x16x32_bf16 v[8:11], v[168:171], v[40:43], v[8:11]
buffer_load_dwordx4 v[68:71], v227, s[20:23], s62 offen offset:768 sc1
v_add_u32 v231, s65, v231
ds_read_b64_tr_b16 v[196:197], v231 offset:0
v_mfma_f32_16x16x32_bf16 v[12:15], v[172:175], v[40:43], v[12:15]
buffer_load_dwordx4 v[72:75], v236, s[20:23], s62 offen offset:768 sc1
ds_read_b64_tr_b16 v[198:199], v231 offset:512
s_waitcnt vmcnt(6)
v_max_u16 v2, v44, v48
v_cmp_eq_u16 vcc, -1, v2
v_mfma_f32_16x16x32_bf16 v[16:19], v[176:179], v[40:43], v[16:19]
ds_read_b64_tr_b16 v[104:105], v228 offset:8192
s_cbranch_vccnz L_st3
L_go3:
v_mfma_f32_16x16x32_bf16 v[20:23], v[180:183], v[40:43], v[20:23]
ds_read_b64_tr_b16 v[106:107], v228 offset:8704
s_waitcnt lgkmcnt(8)
v_mfma_f32_16x16x32_bf16 v[8:11], v[184:187], v[44:47], v[8:11]
buffer_load_dwordx4 v[76:79], v227, s[20:23], s62 offen offset:1024 sc1
ds_read_b64_tr_b16 v[108:109], v229 offset:8192
v_mfma_f32_16x16x32_bf16 v[200:203], v[184:187], v[48:51], 0
ds_read_b64_tr_b16 v[110:111], v229 offset:8704
ds_read_b64_tr_b16 v[112:113], v230 offset:8192
s_waitcnt lgkmcnt(9)
v_mfma_f32_16x16x32_bf16 v[12:15], v[188:191], v[44:47], v[12:15]
ds_read_b64_tr_b16 v[114:115], v230 offset:8704
ds_read_b64_tr_b16 v[116:117], v231 offset:8192
v_mfma_f32_16x16x32_bf16 v[204:207], v[188:191], v[48:51], 0
ds_read_b64_tr_b16 v[118:119], v231 offset:8704
ds_read_b64_tr_b16 v[120:121], v228 offset:16384
s_waitcnt lgkmcnt(11)
v_mfma_f32_16x16x32_bf16 v[16:19], v[192:195], v[44:47], v[16:19]
buffer_load_dwordx4 v[80:83], v236, s[20:23], s62 offen offset:1024 sc1
ds_read_b64_tr_b16 v[122:123], v228 offset:16896
v_mfma_f32_16x16x32_bf16 v[208:211], v[192:195], v[48:51], 0
ds_read_b64_tr_b16 v[124:125], v229 offset:16384
s_waitcnt vmcnt(6)
v_max_u16 v2, v52, v56
v_cmp_eq_u16 vcc, -1, v2
s_waitcnt lgkmcnt(11)
v_mfma_f32_16x16x32_bf16 v[20:23], v[196:199], v[44:47], v[20:23]
ds_read_b64_tr_b16 v[126:127], v229 offset:16896
s_cbranch_vccnz L_st4
L_go4:
v_mfma_f32_16x16x32_bf16 v[212:215], v[196:199], v[48:51], 0
ds_read_b64_tr_b16 v[128:129], v230 offset:16384
s_waitcnt lgkmcnt(11)
v_mfma_f32_16x16x32_bf16 v[8:11], v[104:107], v[52:55], v[8:11]
buffer_load_dwordx4 v[84:87], v227, s[20:23], s63 offen offset:0 sc1
ds_read_b64_tr_b16 v[130:131], v230 offset:16896
s_waitcnt lgkmcnt(6)
v_mfma_f32_16x16x32_bf16 v[200:203], v[104:107], v[56:59], v[200:203]
ds_read_b64_tr_b16 v[132:133], v231 offset:16384
ds_read_b64_tr_b16 v[134:135], v231 offset:16896
v_mfma_f32_16x16x32_bf16 v[12:15], v[108:111], v[52:55], v[12:15]
ds_read_b64_tr_b16 v[136:137], v228 offset:24576
ds_read_b64_tr_b16 v[138:139], v228 offset:25088
v_mfma_f32_16x16x32_bf16 v[204:207], v[108:111], v[56:59], v[204:207]
ds_read_b64_tr_b16 v[140:141], v229 offset:24576
ds_read_b64_tr_b16 v[142:143], v229 offset:25088
v_mfma_f32_16x16x32_bf16 v[16:19], v[112:115], v[52:55], v[16:19]
buffer_load_dwordx4 v[88:91], v236, s[20:23], s63 offen offset:0 sc1
ds_read_b64_tr_b16 v[144:145], v230 offset:24576
v_mfma_f32_16x16x32_bf16 v[208:211], v[112:115], v[56:59], v[208:211]
ds_read_b64_tr_b16 v[146:147], v230 offset:25088
s_waitcnt vmcnt(6)
v_max_u16 v2, v60, v64
v_cmp_eq_u16 vcc, -1, v2
v_mfma_f32_16x16x32_bf16 v[20:23], v[116:119], v[52:55], v[20:23]
ds_read_b64_tr_b16 v[148:149], v231 offset:24576
s_cbranch_vccnz L_st5
L_go5:
v_mfma_f32_16x16x32_bf16 v[212:215], v[116:119], v[56:59], v[212:215]
ds_read_b64_tr_b16 v[150:151], v231 offset:25088
s_waitcnt lgkmcnt(8)
v_mfma_f32_16x16x32_bf16 v[8:11], v[120:123], v[60:63], v[8:11]
buffer_load_dwordx4 v[92:95], v227, s[20:23], s63 offen offset:256 sc1
ds_read_b64_tr_b16 v[152:153], v228 offset:32768
v_mfma_f32_16x16x32_bf16 v[200:203], v[120:123], v[64:67], v[200:203]
ds_read_b64_tr_b16 v[154:155], v228 offset:33280
ds_read_b64_tr_b16 v[156:157], v229 offset:32768
v_mfma_f32_16x16x32_bf16 v[12:15], v[124:127], v[60:63], v[12:15]
ds_read_b64_tr_b16 v[158:159], v229 offset:33280
ds_read_b64_tr_b16 v[160:161], v230 offset:32768
v_mfma_f32_16x16x32_bf16 v[204:207], v[124:127], v[64:67], v[204:207]
ds_read_b64_tr_b16 v[162:163], v230 offset:33280
ds_read_b64_tr_b16 v[164:165], v231 offset:32768
v_mfma_f32_16x16x32_bf16 v[16:19], v[128:131], v[60:63], v[16:19]
buffer_load_dwordx4 v[96:99], v236, s[20:23], s63 offen offset:256 sc1
ds_read_b64_tr_b16 v[166:167], v231 offset:33280
v_mfma_f32_16x16x32_bf16 v[208:211], v[128:131], v[64:67], v[208:211]
v_add_u32 v228, 40960, v228
ds_read_b64_tr_b16 v[168:169], v228 offset:0
s_waitcnt vmcnt(6)
v_max_u16 v2, v68, v72
v_cmp_eq_u16 vcc, -1, v2
v_mfma_f32_16x16x32_bf16 v[20:23], v[132:135], v[60:63], v[20:23]
ds_read_b64_tr_b16 v[170:171], v228 offset:512
s_cbranch_vccnz L_st6
L_go6:
v_mfma_f32_16x16x32_bf16 v[212:215], v[132:135], v[64:67], v[212:215]
v_add_u32 v229, 40960, v229
ds_read_b64_tr_b16 v[172:173], v229 offset:0
s_waitcnt lgkmcnt(11)
v_mfma_f32_16x16x32_bf16 v[8:11], v[136:139], v[68:71], v[8:11]
buffer_load_dwordx4 v[100:103], v227, s[20:23], s63 offen offset:512 sc1
ds_read_b64_tr_b16 v[174:175], v229 offset:512
v_mfma_f32_16x16x32_bf16 v[200:203], v[136:139], v[72:75], v[200:203]
v_add_u32 v230, 40960, v230
ds_read_b64_tr_b16 v[176:177], v230 offset:0
ds_read_b64_tr_b16 v[178:179], v230 offset:512
v_mfma_f32_16x16x32_bf16 v[12:15], v[140:143], v[68:71], v[12:15]
v_add_u32 v231, 40960, v231
ds_read_b64_tr_b16 v[180:181], v231 offset:0
ds_read_b64_tr_b16 v[182:183], v231 offset:512
v_mfma_f32_16x16x32_bf16 v[204:207], v[140:143], v[72:75], v[204:207]
ds_read_b64_tr_b16 v[184:185], v228 offset:8192
ds_read_b64_tr_b16 v[186:187], v228 offset:8704
v_mfma_f32_16x16x32_bf16 v[16:19], v[144:147], v[68:71], v[16:19]
buffer_load_dwordx4 v[24:27], v236, s[20:23], s63 offen offset:512 sc1
ds_read_b64_tr_b16 v[188:189], v229 offset:8192
v_mfma_f32_16x16x32_bf16 v[208:211], v[144:147], v[72:75], v[208:211]
ds_read_b64_tr_b16 v[190:191], v229 offset:8704
s_waitcnt vmcnt(6)
v_max_u16 v2, v76, v80
v_cmp_eq_u16 vcc, -1, v2
v_mfma_f32_16x16x32_bf16 v[20:23], v[148:151], v[68:71], v[20:23]
ds_read_b64_tr_b16 v[192:193], v230 offset:8192
s_cbranch_vccnz L_st7
L_go7:
v_mfma_f32_16x16x32_bf16 v[212:215], v[148:151], v[72:75], v[212:215]
ds_read_b64_tr_b16 v[194:195], v230 offset:8704
s_waitcnt lgkmcnt(14)
v_mfma_f32_16x16x32_bf16 v[8:11], v[152:155], v[76:79], v[8:11]
buffer_load_dwordx4 v[28:31], v236, s[20:23], s63 offen offset:768 sc1
ds_read_b64_tr_b16 v[196:197], v231 offset:8192
v_mfma_f32_16x16x32_bf16 v[200:203], v[152:155], v[80:83], v[200:203]
ds_read_b64_tr_b16 v[198:199], v231 offset:8704
ds_read_b64_tr_b16 v[104:105], v228 offset:16384
v_mfma_f32_16x16x32_bf16 v[12:15], v[156:159], v[76:79], v[12:15]
ds_read_b64_tr_b16 v[106:107], v228 offset:16896
ds_read_b64_tr_b16 v[108:109], v229 offset:16384
v_mfma_f32_16x16x32_bf16 v[204:207], v[156:159], v[80:83], v[204:207]
ds_read_b64_tr_b16 v[110:111], v229 offset:16896
ds_read_b64_tr_b16 v[112:113], v230 offset:16384
v_mfma_f32_16x16x32_bf16 v[16:19], v[160:163], v[76:79], v[16:19]
buffer_load_dwordx4 v[32:35], v236, s[20:23], s63 offen offset:1024 sc1
ds_read_b64_tr_b16 v[114:115], v230 offset:16896
v_mfma_f32_16x16x32_bf16 v[208:211], v[160:163], v[80:83], v[208:211]
ds_read_b64_tr_b16 v[116:117], v231 offset:16384
s_waitcnt vmcnt(6)
v_max_u16 v2, v84, v88
v_cmp_eq_u16 vcc, -1, v2
v_mfma_f32_16x16x32_bf16 v[20:23], v[164:167], v[76:79], v[20:23]
ds_read_b64_tr_b16 v[118:119], v231 offset:16896
s_cbranch_vccnz L_st8
L_go8:
v_mfma_f32_16x16x32_bf16 v[212:215], v[164:167], v[80:83], v[212:215]
ds_read_b64_tr_b16 v[120:121], v228 offset:24576
s_waitcnt lgkmcnt(15)
v_mfma_f32_16x16x32_bf16 v[8:11], v[168:171], v[84:87], v[8:11]
buffer_load_dwordx4 v[36:39], v227, s[20:23], s63 offen offset:768 sc1
ds_read_b64_tr_b16 v[122:123], v228 offset:25088
v_mfma_f32_16x16x32_bf16 v[200:203], v[168:171], v[88:91], v[200:203]
ds_read_b64_tr_b16 v[124:125], v229 offset:24576
ds_read_b64_tr_b16 v[126:127], v229 offset:25088
v_mfma_f32_16x16x32_bf16 v[12:15], v[172:175], v[84:87], v[12:15]
ds_read_b64_tr_b16 v[128:129], v230 offset:24576
ds_read_b64_tr_b16 v[130:131], v230 offset:25088
v_mfma_f32_16x16x32_bf16 v[204:207], v[172:175], v[88:91], v[204:207]
ds_read_b64_tr_b16 v[132:133], v231 offset:24576
ds_read_b64_tr_b16 v[134:135], v231 offset:25088
v_mfma_f32_16x16x32_bf16 v[16:19], v[176:179], v[84:87], v[16:19]
buffer_load_dwordx4 v[40:43], v227, s[20:23], s63 offen offset:1024 sc1
ds_read_b64_tr_b16 v[136:137], v228 offset:32768
v_mfma_f32_16x16x32_bf16 v[208:211], v[176:179], v[88:91], v[208:211]
ds_read_b64_tr_b16 v[138:139], v228 offset:33280
s_waitcnt vmcnt(6)
v_max_u16 v2, v92, v96
v_cmp_eq_u16 vcc, -1, v2
v_mfma_f32_16x16x32_bf16 v[20:23], v[180:183], v[84:87], v[20:23]
ds_read_b64_tr_b16 v[140:141], v229 offset:32768
s_cbranch_vccnz L_st9
L_go9:
v_mfma_f32_16x16x32_bf16 v[212:215], v[180:183], v[88:91], v[212:215]
ds_read_b64_tr_b16 v[142:143], v229 offset:33280
s_waitcnt lgkmcnt(15)
v_mfma_f32_16x16x32_bf16 v[8:11], v[184:187], v[92:95], v[8:11]
buffer_load_dwordx4 v[44:47], v227, s[20:23], s64 offen offset:0 sc1
ds_read_b64_tr_b16 v[144:145], v230 offset:32768
v_mfma_f32_16x16x32_bf16 v[200:203], v[184:187], v[96:99], v[200:203]
ds_read_b64_tr_b16 v[146:147], v230 offset:33280
ds_read_b64_tr_b16 v[148:149], v231 offset:32768
v_mfma_f32_16x16x32_bf16 v[12:15], v[188:191], v[92:95], v[12:15]
ds_read_b64_tr_b16 v[150:151], v231 offset:33280
v_subrev_u32 v228, s65, v228
ds_read_b64_tr_b16 v[152:153], v228 offset:0
v_mfma_f32_16x16x32_bf16 v[204:207], v[188:191], v[96:99], v[204:207]
ds_read_b64_tr_b16 v[154:155], v228 offset:512
v_subrev_u32 v229, s65, v229
ds_read_b64_tr_b16 v[156:157], v229 offset:0
v_mfma_f32_16x16x32_bf16 v[16:19], v[192:195], v[92:95], v[16:19]
buffer_load_dwordx4 v[48:51], v227, s[20:23], s64 offen offset:256 sc1
ds_read_b64_tr_b16 v[158:159], v229 offset:512
v_mfma_f32_16x16x32_bf16 v[208:211], v[192:195], v[96:99], v[208:211]
v_subrev_u32 v230, s65, v230
ds_read_b64_tr_b16 v[160:161], v230 offset:0
s_waitcnt vmcnt(6)
v_max_u16 v2, v100, v24
v_cmp_eq_u16 vcc, -1, v2
v_mfma_f32_16x16x32_bf16 v[20:23], v[196:199], v[92:95], v[20:23]
ds_read_b64_tr_b16 v[162:163], v230 offset:512
s_cbranch_vccnz L_st10
L_go10:
v_mfma_f32_16x16x32_bf16 v[212:215], v[196:199], v[96:99], v[212:215]
v_subrev_u32 v231, s65, v231
ds_read_b64_tr_b16 v[164:165], v231 offset:0
s_waitcnt lgkmcnt(15)
v_mfma_f32_16x16x32_bf16 v[8:11], v[104:107], v[100:103], v[8:11]
buffer_load_dwordx4 v[52:55], v227, s[20:23], s64 offen offset:512 sc1
ds_read_b64_tr_b16 v[166:167], v231 offset:512
v_mfma_f32_16x16x32_bf16 v[200:203], v[104:107], v[24:27], v[200:203]
ds_read_b64_tr_b16 v[168:169], v228 offset:8192
ds_read_b64_tr_b16 v[170:171], v228 offset:8704
v_mfma_f32_16x16x32_bf16 v[12:15], v[108:111], v[100:103], v[12:15]
ds_read_b64_tr_b16 v[172:173], v229 offset:8192
ds_read_b64_tr_b16 v[174:175], v229 offset:8704
v_mfma_f32_16x16x32_bf16 v[204:207], v[108:111], v[24:27], v[204:207]
ds_read_b64_tr_b16 v[176:177], v230 offset:8192
ds_read_b64_tr_b16 v[178:179], v230 offset:8704
v_mfma_f32_16x16x32_bf16 v[16:19], v[112:115], v[100:103], v[16:19]
buffer_load_dwordx4 v[56:59], v227, s[20:23], s64 offen offset:768 sc1
ds_read_b64_tr_b16 v[180:181], v231 offset:8192
v_mfma_f32_16x16x32_bf16 v[208:211], v[112:115], v[24:27], v[208:211]
ds_read_b64_tr_b16 v[182:183], v231 offset:8704
s_waitcnt vmcnt(6)
v_max_u16 v2, v28, v32
v_cmp_eq_u16 vcc, -1, v2
v_mfma_f32_16x16x32_bf16 v[20:23], v[116:119], v[100:103], v[20:23]
ds_read_b64_tr_b16 v[184:185], v228 offset:16384
s_cbranch_vccnz L_st11
L_go11:
v_mfma_f32_16x16x32_bf16 v[212:215], v[116:119], v[24:27], v[212:215]
ds_read_b64_tr_b16 v[186:187], v228 offset:16896
v_mfma_f32_16x16x32_bf16 v[200:203], v[120:123], v[28:31], v[200:203]
buffer_load_dwordx4 v[60:63], v227, s[20:23], s64 offen offset:1024 sc1
ds_read_b64_tr_b16 v[188:189], v229 offset:16384
v_mfma_f32_16x16x32_bf16 v[204:207], v[124:127], v[28:31], v[204:207]
ds_read_b64_tr_b16 v[190:191], v229 offset:16896
ds_read_b64_tr_b16 v[192:193], v230 offset:16384
v_mfma_f32_16x16x32_bf16 v[208:211], v[128:131], v[28:31], v[208:211]
ds_read_b64_tr_b16 v[194:195], v230 offset:16896
ds_read_b64_tr_b16 v[196:197], v231 offset:16384
v_mfma_f32_16x16x32_bf16 v[212:215], v[132:135], v[28:31], v[212:215]
ds_read_b64_tr_b16 v[198:199], v231 offset:16896
ds_read_b64_tr_b16 v[104:105], v228 offset:24576
s_waitcnt lgkmcnt(15)
v_mfma_f32_16x16x32_bf16 v[200:203], v[136:139], v[32:35], v[200:203]
ds_read_b64_tr_b16 v[106:107], v228 offset:25088
ds_read_b64_tr_b16 v[108:109], v229 offset:24576
v_mfma_f32_16x16x32_bf16 v[204:207], v[140:143], v[32:35], v[204:207]
ds_read_b64_tr_b16 v[110:111], v229 offset:25088
s_waitcnt vmcnt(5)
v_max_u16 v2, v36, v40
v_cmp_eq_u16 vcc, -1, v2
v_mfma_f32_16x16x32_bf16 v[208:211], v[144:147], v[32:35], v[208:211]
ds_read_b64_tr_b16 v[112:113], v230 offset:24576
s_cbranch_vccnz L_st12
L_go12:
v_mfma_f32_16x16x32_bf16 v[212:215], v[148:151], v[32:35], v[212:215]
ds_read_b64_tr_b16 v[114:115], v230 offset:25088
v_mfma_f32_16x16x32_bf16 v[8:11], v[120:123], v[36:39], v[8:11]
ds_read_b64_tr_b16 v[116:117], v231 offset:24576
ds_read_b64_tr_b16 v[118:119], v231 offset:25088
v_mfma_f32_16x16x32_bf16 v[12:15], v[124:127], v[36:39], v[12:15]
ds_write_b128 v237, v[200:203] offset:0
v_mfma_f32_16x16x32_bf16 v[16:19], v[128:131], v[36:39], v[16:19]
ds_write_b128 v237, v[204:207] offset:1024
v_mfma_f32_16x16x32_bf16 v[20:23], v[132:135], v[36:39], v[20:23]
ds_write_b128 v237, v[208:211] offset:2048
v_mfma_f32_16x16x32_bf16 v[8:11], v[136:139], v[40:43], v[8:11]
ds_read_b64_tr_b16 v[120:121], v228 offset:32768
ds_read_b64_tr_b16 v[122:123], v228 offset:33280
v_mfma_f32_16x16x32_bf16 v[12:15], v[140:143], v[40:43], v[12:15]
ds_read_b64_tr_b16 v[124:125], v229 offset:32768
s_waitcnt vmcnt(3)
v_max_u16 v2, v44, v48
v_cmp_eq_u16 vcc, -1, v2
v_mfma_f32_16x16x32_bf16 v[16:19], v[144:147], v[40:43], v[16:19]
ds_write_b128 v237, v[212:215] offset:3072
s_cbranch_vccnz L_st13
L_go13:
v_mfma_f32_16x16x32_bf16 v[20:23], v[148:151], v[40:43], v[20:23]
s_mov_b64 exec, 1
ds_add_u32 v238, v240
s_mov_b64 exec, -1
v_mfma_f32_16x16x32_bf16 v[8:11], v[152:155], v[44:47], v[8:11]
ds_read_b64_tr_b16 v[126:127], v229 offset:33280
ds_read_b64_tr_b16 v[128:129], v230 offset:32768
v_mfma_f32_16x16x32_bf16 v[12:15], v[156:159], v[44:47], v[12:15]
ds_read_b64_tr_b16 v[130:131], v230 offset:33280
ds_read_b64_tr_b16 v[132:133], v231 offset:32768
v_mfma_f32_16x16x32_bf16 v[16:19], v[160:163], v[44:47], v[16:19]
ds_read_b64_tr_b16 v[134:135], v231 offset:33280
v_mfma_f32_16x16x32_bf16 v[20:23], v[164:167], v[44:47], v[20:23]
s_waitcnt lgkmcnt(15)
v_mfma_f32_16x16x32_bf16 v[8:11], v[168:171], v[48:51], v[8:11]
v_mfma_f32_16x16x32_bf16 v[12:15], v[172:175], v[48:51], v[12:15]
s_waitcnt vmcnt(1)
v_max_u16 v2, v52, v56
v_cmp_eq_u16 vcc, -1, v2
v_mfma_f32_16x16x32_bf16 v[16:19], v[176:179], v[48:51], v[16:19]
s_cbranch_vccnz L_st14
L_go14:
v_mfma_f32_16x16x32_bf16 v[20:23], v[180:183], v[48:51], v[20:23]
v_mfma_f32_16x16x32_bf16 v[8:11], v[184:187], v[52:55], v[8:11]
v_mfma_f32_16x16x32_bf16 v[12:15], v[188:191], v[52:55], v[12:15]
v_mfma_f32_16x16x32_bf16 v[16:19], v[192:195], v[52:55], v[16:19]
v_mfma_f32_16x16x32_bf16 v[20:23], v[196:199], v[52:55], v[20:23]
s_waitcnt lgkmcnt(13)
v_mfma_f32_16x16x32_bf16 v[8:11], v[104:107], v[56:59], v[8:11]
v_mfma_f32_16x16x32_bf16 v[12:15], v[108:111], v[56:59], v[12:15]
s_waitcnt vmcnt(0)
v_cmp_eq_u16 vcc, -1, v60
v_mfma_f32_16x16x32_bf16 v[16:19], v[112:115], v[56:59], v[16:19]
s_cbranch_vccnz L_st15
L_go15:
v_mfma_f32_16x16x32_bf16 v[20:23], v[116:119], v[56:59], v[20:23]
s_waitcnt lgkmcnt(8)
v_mfma_f32_16x16x32_bf16 v[8:11], v[120:123], v[60:63], v[8:11]
s_waitcnt lgkmcnt(4)
v_mfma_f32_16x16x32_bf16 v[12:15], v[124:127], v[60:63], v[12:15]
s_waitcnt lgkmcnt(2)
v_mfma_f32_16x16x32_bf16 v[16:19], v[128:131], v[60:63], v[16:19]
s_waitcnt lgkmcnt(0)
v_mfma_f32_16x16x32_bf16 v[20:23], v[132:135], v[60:63], v[20:23]
L_tail:
s_nop 1
v_cvt_pk_bf16_f32 v24, v8, v9
v_cvt_pk_bf16_f32 v25, v10, v11
v_cvt_pk_bf16_f32 v26, v12, v13
v_cvt_pk_bf16_f32 v27, v14, v15
v_cvt_pk_bf16_f32 v28, v16, v17
v_cvt_pk_bf16_f32 v29, v18, v19
v_cvt_pk_bf16_f32 v30, v20, v21
v_cvt_pk_bf16_f32 v31, v22, v23
v_mfma_f32_16x16x32_bf16 v[36:39], v[24:27], v[24:27], 0
v_mfma_f32_16x16x32_bf16 v[32:35], v[244:247], v[24:27], 0
v_mfma_f32_16x16x32_bf16 v[36:39], v[28:31], v[28:31], v[36:39]
v_mfma_f32_16x16x32_bf16 v[32:35], v[248:251], v[28:31], v[32:35]
s_mov_b32 s0, 0x22222222
s_mov_b32 s1, s0
s_mov_b32 s44, 0x44444444
s_mov_b32 s45, s44
s_mov_b32 vcc_lo, 0x88888888
s_mov_b32 vcc_hi, 0x88888888
s_lshl_b32 s3, s36, 8
s_add_u32 s3, s3, s58
v_and_b32 v1, 0xf0, v233
v_cndmask_b32 v36, v36, v37, s[0:1]
v_cndmask_b32 v38, v38, v39, vcc
s_or_b64 vcc, vcc, s[44:45]
v_cndmask_b32 v34, v36, v38, vcc
v_mov_b32 v35, v253
s_mov_b32 exec_lo, 0xf0000f
s_mov_b32 exec_hi, 0xf0000f00
s_cmp_eq_u32 s41, 1
s_cbranch_scc0 L_gl_9g
buffer_store_dwordx4 v[32:35], v1, s[16:19], s3 offen
L_gl_9b:
s_mov_b64 exec, -1
v_mov_b32 v48, 0
v_mov_b32 v49, 0
v_mov_b32 v50, 0
v_mov_b32 v51, 0
v_mov_b32 v4, 1.0
s_mov_b32 s0, 0xbacccccd
s_mov_b32 s1, 0x3acccccd
v_mov_b32 v5, 0x3727c5ac
s_mov_b32 s44, 0xfffff800
v_mov_b32 v1, 1732
v_cmp_le_i32 s[46:47], 0, v232
s_mul_i32 s48, s35, 1280
s_lshl_b32 s3, s36, 7
s_add_u32 s48, s48, s3
s_lshl_b32 s49, s48, 1
s_add_u32 s48, s48, s59
s_add_u32 s49, s49, s59
s_add_u32 s49, s49, 4096
s_lshl_b32 s3, s35, 7
s_add_u32 s3, s3, s59
s_add_u32 s3, s3, 21504
s_and_b32 s45, s36, 15
s_lshl_b32 s45, s45, 3
s_add_u32 s45, s45, s32
v_mul_u32_u24 v70, 384, v0
v_and_b32 v69, 48, v0
v_lshlrev_b32 v68, 1, v69
s_add_u32 s45, s36, 5
v_mov_b32 v71, 1
L_e2:
buffer_load_dwordx4 v[40:43], v233, s[16:19], s58 offen sc1
buffer_load_dwordx4 v[44:47], v233, s[16:19], s58 offen offset:1024 sc1
s_mov_b32 exec_hi, 0
buffer_load_dwordx4 v[48:51], v233, s[16:19], s58 offen offset:2048 sc1
s_mov_b32 exec_hi, -1
s_sub_u32 s40, s40, 1
s_waitcnt vmcnt(1)
v_pk_add_f32 v[40:41], v[40:41], v[44:45]
v_pk_add_f32 v[42:43], v[42:43], v[46:47]
s_waitcnt vmcnt(0)
v_pk_add_f32 v[40:41], v[40:41], v[48:49]
v_pk_add_f32 v[42:43], v[42:43], v[50:51]
v_cmp_u_f32 vcc, v40, v40
s_cbranch_scc1 L_e2go
s_cbranch_vccnz L_e2
L_e2go:
v_mfma_f32_16x16x4_f32 v[52:55], v4, v40, 0
v_mfma_f32_16x16x4_f32 v[60:63], v4, v42, 0
v_mfma_f32_16x16x4_f32 v[64:67], v4, v43, 0
v_mfma_f32_16x16x4_f32 v[56:59], v4, v41, 0
s_nop 6
v_mul_f32 v6, s0, v52
v_fma_f32 v7, v60, s1, v5
v_fma_f32 v7, -v6, v6, v7
v_max_f32 v7, v7, v5
v_rsq_f32 v2, v7
v_fma_f32 v7, v6, v64, v56
v_mul_f32 v7, v7, v2
v_mul_f32 v3, v6, v2
v_ashrrev_i32 v6, 31, v7
v_or_b32 v6, 0x80000000, v6
v_xor_b32 v7, v7, v6
v_and_or_b32 v7, v7, s44, v234
v_cndmask_b32 v7, 0, v7, s[46:47]
v_pk_fma_f32 v[72:73], v[8:9], v[2:3], v[2:3] op_sel:[0,0,1] op_sel_hi:[1,0,1]
v_pk_fma_f32 v[74:75], v[10:11], v[2:3], v[2:3] op_sel:[0,0,1] op_sel_hi:[1,0,1]
v_max_u32_dpp v6, v7, v7 row_ror:8 row_mask:0xf bank_mask:0xf
s_mov_b64 exec, 255
ds_max_u32 v1, v6
s_mov_b64 exec, 1
ds_add_rtn_u32 v71, v1, v71 offset:4
s_mov_b64 exec, -1
ds_read_b32 v6, v1
v_pk_fma_f32 v[76:77], v[12:13], v[2:3], v[2:3] op_sel:[0,0,1] op_sel_hi:[1,0,1]
v_pk_fma_f32 v[78:79], v[14:15], v[2:3], v[2:3] op_sel:[0,0,1] op_sel_hi:[1,0,1]
v_pk_fma_f32 v[80:81], v[16:17], v[2:3], v[2:3] op_sel:[0,0,1] op_sel_hi:[1,0,1]
v_pk_fma_f32 v[82:83], v[18:19], v[2:3], v[2:3] op_sel:[0,0,1] op_sel_hi:[1,0,1]
v_pk_fma_f32 v[84:85], v[20:21], v[2:3], v[2:3] op_sel:[0,0,1] op_sel_hi:[1,0,1]
v_pk_fma_f32 v[86:87], v[22:23], v[2:3], v[2:3] op_sel:[0,0,1] op_sel_hi:[1,0,1]
v_cvt_pk_bf16_f32 v88, v72, v73
v_cvt_pk_bf16_f32 v89, v74, v75
v_cvt_pk_bf16_f32 v90, v76, v77
v_cvt_pk_bf16_f32 v91, v78, v79
s_waitcnt lgkmcnt(0)
v_readfirstlane_b32 s0, v71
s_cmp_eq_u32 s0, s45
s_cbranch_scc0 L_nk
s_mov_b64 exec, 0xffff
buffer_store_dword v6, v70, s[16:19], s3 offen sc1
s_mov_b64 exec, -1
L_nk:
s_barrier
ds_read_b32 v1, v1
v_cvt_pk_bf16_f32 v92, v80, v81
v_cvt_pk_bf16_f32 v93, v82, v83
v_cvt_pk_bf16_f32 v94, v84, v85
v_cvt_pk_bf16_f32 v95, v86, v87
v_pk_add_f32 v[72:73], v[72:73], v[8:9]
v_pk_add_f32 v[74:75], v[74:75], v[10:11]
v_pk_add_f32 v[76:77], v[76:77], v[12:13]
v_pk_add_f32 v[78:79], v[78:79], v[14:15]
v_pk_add_f32 v[80:81], v[80:81], v[16:17]
v_pk_add_f32 v[82:83], v[82:83], v[18:19]
v_pk_add_f32 v[84:85], v[84:85], v[20:21]
v_pk_add_f32 v[86:87], v[86:87], v[22:23]
s_waitcnt lgkmcnt(0)
v_cmp_eq_u32 s[46:47], v1, v7
s_and_b64 exec, s[46:47], -1
s_cbranch_scc0 L_nc
buffer_store_dwordx4 v[88:91], v68, s[16:19], s48 offen sc1
buffer_store_dwordx4 v[92:95], v68, s[16:19], s48 offen offset:16 sc1
L_nc:
s_mov_b64 exec, -1
v_cvt_pk_bf16_f32 v96, v72, v73
v_cvt_pk_bf16_f32 v97, v74, v75
v_cvt_pk_bf16_f32 v98, v76, v77
v_cvt_pk_bf16_f32 v99, v78, v79
v_cvt_pk_bf16_f32 v100, v80, v81
v_cvt_pk_bf16_f32 v101, v82, v83
v_cvt_pk_bf16_f32 v102, v84, v85
v_cvt_pk_bf16_f32 v103, v86, v87
v_permlane16_swap_b32 v96, v98
v_permlane16_swap_b32 v97, v99
v_permlane16_swap_b32 v100, v102
v_permlane16_swap_b32 v101, v103
s_not_b64 exec, s[46:47]
buffer_store_dwordx4 v[96:99], v232, s[20:23], 0 offen offset:0
buffer_store_dwordx4 v[100:103], v232, s[20:23], 0 offen offset:64
s_and_b64 exec, s[46:47], -1
s_cbranch_scc0 L_fin
buffer_store_dwordx4 v[96:99], v232, s[20:23], 0 offen offset:0 sc1
buffer_store_dwordx4 v[100:103], v232, s[20:23], 0 offen offset:64 sc1
s_waitcnt vmcnt(0)
buffer_store_dwordx4 v[72:75], v69, s[16:19], s49 offen offset:0 sc1
buffer_store_dwordx4 v[76:79], v69, s[16:19], s49 offen offset:64 sc1
buffer_store_dwordx4 v[80:83], v69, s[16:19], s49 offen offset:128 sc1
buffer_store_dwordx4 v[84:87], v69, s[16:19], s49 offen offset:192 sc1
L_fin:
s_endpgm
.p2align 12
L_pb_10:
L_pad_11:
s_setpc_b64 s[100:101]
L_era:
s_sub_u32 s40, s40, 1
s_cbranch_scc1 L_exa
s_lshl_b32 s0, s33, 5
v_and_b32 v1, 16, v0
buffer_load_dword v32, v1, s[24:27], s0 offen sc1
s_waitcnt vmcnt(0)
s_waitcnt lgkmcnt(0)
v_cmp_ne_u32 vcc, 1, v32
s_cmp_eq_u64 vcc, 0
s_cbranch_scc0 L_era
s_branch L_ega
L_exa:
s_mov_b32 s40, 0
s_branch L_ega
L_erb:
s_sub_u32 s40, s40, 1
s_cbranch_scc1 L_exb
s_buffer_load_dword s71, s[16:19], s66 offset:0 glc
s_buffer_load_dword s73, s[16:19], s66 offset:128 glc
s_buffer_load_dword s75, s[16:19], s66 offset:256 glc
s_buffer_load_dword s77, s[16:19], s66 offset:384 glc
s_buffer_load_dword s83, s[16:19], s66 offset:512 glc
s_buffer_load_dword s85, s[16:19], s66 offset:640 glc
s_buffer_load_dword s89, s[16:19], s66 offset:768 glc
s_buffer_load_dword s91, s[16:19], s66 offset:896 glc
s_buffer_load_dword s93, s[16:19], s66 offset:1024 glc
s_buffer_load_dword s95, s[16:19], s66 offset:1152 glc
s_waitcnt lgkmcnt(0)
s_max_u32 s0, s71, s73
s_max_u32 s0, s0, s75
s_max_u32 s0, s0, s77
s_max_u32 s0, s0, s83
s_max_u32 s0, s0, s85
s_max_u32 s0, s0, s89
s_max_u32 s0, s0, s91
s_max_u32 s0, s0, s93
s_max_u32 s0, s0, s95
s_cmp_lg_u32 s0, -1
s_cbranch_scc0 L_erb
s_branch L_egb
L_exb:
s_mov_b32 s40, 0
s_branch L_egb
L_gh_3g:
s_barrier
s_cmp_eq_u32 s32, 5
s_cbranch_scc0 L_gh_3e
v_mov_b32 v1, 1
s_mov_b64 exec, 1
buffer_store_dword v1, off, s[16:19], s68 offset:64 sc1
s_mov_b64 exec, -1
L_gh_3p:
buffer_load_dword v1, v55, s[16:19], 0 offen offset:64 sc1
s_waitcnt vmcnt(0)
v_cmp_ne_u32 vcc, 1, v1
s_cbranch_vccz L_gh_3e
s_sub_u32 s40, s40, 1
s_cbranch_scc0 L_gh_3p
s_mov_b32 s40, 0
L_gh_3e:
s_barrier
s_branch L_gh_3b
L_xcap:
v_add_u32 v1, s0, v235
ds_read_b64 v[72:73], v1
v_xor_b32 v2, 32, v1
ds_read_b64 v[74:75], v2
v_xor_b32 v3, 64, v1
ds_read_b64 v[76:77], v3
v_xor_b32 v4, 96, v1
ds_read_b64 v[78:79], v4
s_setpc_b64 s[100:101]
L_woe1:
s_addk_i32 m0, 4096
s_mov_b32 s3, 0
buffer_load_dwordx4 v57, s[12:15], s3 offen lds
s_addk_i32 m0, 4096
s_mov_b32 s3, 81920
buffer_load_dwordx4 v57, s[12:15], s3 offen lds
s_addk_i32 m0, 4096
s_mov_b32 s3, 163840
buffer_load_dwordx4 v58, s[12:15], s3 offen lds
s_addk_i32 m0, 4096
s_mov_b32 s3, 245760
buffer_load_dwordx4 v60, s[12:15], s3 offen lds
s_addk_i32 m0, 4096
s_mov_b32 s3, 327680
buffer_load_dwordx4 v60, s[12:15], s3 offen lds
s_addk_i32 m0, 4096
s_mov_b32 s3, 409600
buffer_load_dwordx4 v57, s[12:15], s3 offen lds
s_addk_i32 m0, 4096
s_mov_b32 s3, 491520
buffer_load_dwordx4 v57, s[12:15], s3 offen lds
s_addk_i32 m0, 4096
s_mov_b32 s3, 573440
buffer_load_dwordx4 v58, s[12:15], s3 offen lds
s_addk_i32 m0, 4096
s_mov_b32 s3, 655360
buffer_load_dwordx4 v60, s[12:15], s3 offen lds
s_addk_i32 m0, 4096
s_mov_b32 s3, 737280
buffer_load_dwordx4 v60, s[12:15], s3 offen lds
s_branch L_woe
L_woe2:
s_addk_i32 m0, 4096
s_mov_b32 s3, 5120
buffer_load_dwordx4 v57, s[12:15], s3 offen lds
s_addk_i32 m0, 4096
s_mov_b32 s3, 87040
buffer_load_dwordx4 v58, s[12:15], s3 offen lds
s_addk_i32 m0, 4096
s_mov_b32 s3, 168960
buffer_load_dwordx4 v58, s[12:15], s3 offen lds
s_addk_i32 m0, 4096
s_mov_b32 s3, 250880
buffer_load_dwordx4 v60, s[12:15], s3 offen lds
s_addk_i32 m0, 4096
s_mov_b32 s3, 384000
buffer_load_dwordx4 v59, s[12:15], s3 offen lds
s_addk_i32 m0, 4096
s_mov_b32 s3, 414720
buffer_load_dwordx4 v57, s[12:15], s3 offen lds
s_addk_i32 m0, 4096
s_mov_b32 s3, 496640
buffer_load_dwordx4 v58, s[12:15], s3 offen lds
s_addk_i32 m0, 4096
s_mov_b32 s3, 578560
buffer_load_dwordx4 v58, s[12:15], s3 offen lds
s_addk_i32 m0, 4096
s_mov_b32 s3, 660480
buffer_load_dwordx4 v60, s[12:15], s3 offen lds
s_addk_i32 m0, 4096
s_mov_b32 s3, 793600
buffer_load_dwordx4 v59, s[12:15], s3 offen lds
s_branch L_woe
L_pad_12:
s_setpc_b64 s[100:101]
L_woe3:
s_addk_i32 m0, 4096
s_mov_b32 s3, 10240
buffer_load_dwordx4 v58, s[12:15], s3 offen lds
s_addk_i32 m0, 4096
s_mov_b32 s3, 92160
buffer_load_dwordx4 v58, s[12:15], s3 offen lds
s_addk_i32 m0, 4096
s_mov_b32 s3, 174080
buffer_load_dwordx4 v58, s[12:15], s3 offen lds
s_addk_i32 m0, 4096
s_mov_b32 s3, 307200
buffer_load_dwordx4 v59, s[12:15], s3 offen lds
s_addk_i32 m0, 4096
s_mov_b32 s3, 389120
buffer_load_dwordx4 v59, s[12:15], s3 offen lds
s_addk_i32 m0, 4096
s_mov_b32 s3, 419840
buffer_load_dwordx4 v58, s[12:15], s3 offen lds
s_addk_i32 m0, 4096
s_mov_b32 s3, 501760
buffer_load_dwordx4 v58, s[12:15], s3 offen lds
s_addk_i32 m0, 4096
s_mov_b32 s3, 583680
buffer_load_dwordx4 v58, s[12:15], s3 offen lds
s_addk_i32 m0, 4096
s_mov_b32 s3, 716800
buffer_load_dwordx4 v59, s[12:15], s3 offen lds
s_addk_i32 m0, 4096
s_mov_b32 s3, 798720
buffer_load_dwordx4 v59, s[12:15], s3 offen lds
s_branch L_woe
L_gl_4g:
buffer_store_dwordx4 v[192:195], v224, s[20:23], s54 offen sc1
s_branch L_gl_4b
L_gl_5g:
buffer_store_dwordx4 v[196:199], v226, s[20:23], 0 offen sc1
s_branch L_gl_5b
L_h0rh:
s_sub_u32 s40, s40, 1
s_cbranch_scc1 L_h0xh
buffer_load_dwordx4 v[92:95], v225, s[20:23], s54 offen sc1
s_waitcnt vmcnt(0)
v_cmp_eq_u32 vcc, -1, v92
s_cbranch_vccnz L_h0rh
s_branch L_h0gh
L_h0xh:
s_mov_b32 s40, 0
s_branch L_h0gh
L_gl_6g:
buffer_store_dwordx4 v[80:83], v226, s[20:23], s54 offen sc1
s_branch L_gl_6b
L_spw:
v_mov_b32 v1, 1744
ds_read_b32 v1, v1
s_waitcnt lgkmcnt(0)
v_cmp_ne_u32 vcc, 4, v1
s_cbranch_vccnz L_spw
s_branch L_sbw
L_st0:
s_sub_u32 s40, s40, 1
s_cbranch_scc1 L_sx0
buffer_load_dwordx4 v[24:27], v227, s[20:23], s61 offen offset:0 sc1
buffer_load_dwordx4 v[28:31], v227, s[20:23], s61 offen offset:256 sc1
s_waitcnt vmcnt(0)
v_max_u16 v2, v24, v28
v_cmp_eq_u16 vcc, -1, v2
s_cbranch_vccnz L_st0
s_branch L_go0
L_sx0:
s_mov_b32 s40, 0
s_branch L_go0
L_st1:
s_sub_u32 s40, s40, 1
s_cbranch_scc1 L_sx1
buffer_load_dwordx4 v[32:35], v227, s[20:23], s61 offen offset:512 sc1
buffer_load_dwordx4 v[36:39], v227, s[20:23], s61 offen offset:768 sc1
s_waitcnt vmcnt(0)
v_max_u16 v2, v32, v36
v_cmp_eq_u16 vcc, -1, v2
s_cbranch_vccnz L_st1
s_branch L_go1
L_sx1:
s_mov_b32 s40, 0
s_branch L_go1
L_st2:
s_sub_u32 s40, s40, 1
s_cbranch_scc1 L_sx2
buffer_load_dwordx4 v[40:43], v227, s[20:23], s61 offen offset:1024 sc1
s_waitcnt vmcnt(0)
v_cmp_eq_u16 vcc, -1, v40
s_cbranch_vccnz L_st2
s_branch L_go2
L_sx2:
s_mov_b32 s40, 0
s_branch L_go2
L_st3:
s_sub_u32 s40, s40, 1
s_cbranch_scc1 L_sx3
buffer_load_dwordx4 v[44:47], v227, s[20:23], s62 offen offset:0 sc1
buffer_load_dwordx4 v[48:51], v236, s[20:23], s62 offen offset:0 sc1
s_waitcnt vmcnt(0)
v_max_u16 v2, v44, v48
v_cmp_eq_u16 vcc, -1, v2
s_cbranch_vccnz L_st3
s_branch L_go3
L_sx3:
s_mov_b32 s40, 0
s_branch L_go3
L_st4:
s_sub_u32 s40, s40, 1
s_cbranch_scc1 L_sx4
buffer_load_dwordx4 v[52:55], v227, s[20:23], s62 offen offset:256 sc1
buffer_load_dwordx4 v[56:59], v236, s[20:23], s62 offen offset:256 sc1
s_waitcnt vmcnt(0)
v_max_u16 v2, v52, v56
v_cmp_eq_u16 vcc, -1, v2
s_cbranch_vccnz L_st4
s_branch L_go4
L_sx4:
s_mov_b32 s40, 0
s_branch L_go4
L_pad_13:
s_setpc_b64 s[100:101]
L_st5:
s_sub_u32 s40, s40, 1
s_cbranch_scc1 L_sx5
buffer_load_dwordx4 v[60:63], v227, s[20:23], s62 offen offset:512 sc1
buffer_load_dwordx4 v[64:67], v236, s[20:23], s62 offen offset:512 sc1
s_waitcnt vmcnt(0)
v_max_u16 v2, v60, v64
v_cmp_eq_u16 vcc, -1, v2
s_cbranch_vccnz L_st5
s_branch L_go5
L_sx5:
s_mov_b32 s40, 0
s_branch L_go5
L_st6:
s_sub_u32 s40, s40, 1
s_cbranch_scc1 L_sx6
buffer_load_dwordx4 v[68:71], v227, s[20:23], s62 offen offset:768 sc1
buffer_load_dwordx4 v[72:75], v236, s[20:23], s62 offen offset:768 sc1
s_waitcnt vmcnt(0)
v_max_u16 v2, v68, v72
v_cmp_eq_u16 vcc, -1, v2
s_cbranch_vccnz L_st6
s_branch L_go6
L_sx6:
s_mov_b32 s40, 0
s_branch L_go6
L_st7:
s_sub_u32 s40, s40, 1
s_cbranch_scc1 L_sx7
buffer_load_dwordx4 v[76:79], v227, s[20:23], s62 offen offset:1024 sc1
buffer_load_dwordx4 v[80:83], v236, s[20:23], s62 offen offset:1024 sc1
s_waitcnt vmcnt(0)
v_max_u16 v2, v76, v80
v_cmp_eq_u16 vcc, -1, v2
s_cbranch_vccnz L_st7
s_branch L_go7
L_sx7:
s_mov_b32 s40, 0
s_branch L_go7
L_st8:
s_sub_u32 s40, s40, 1
s_cbranch_scc1 L_sx8
buffer_load_dwordx4 v[84:87], v227, s[20:23], s63 offen offset:0 sc1
buffer_load_dwordx4 v[88:91], v236, s[20:23], s63 offen offset:0 sc1
s_waitcnt vmcnt(0)
v_max_u16 v2, v84, v88
v_cmp_eq_u16 vcc, -1, v2
s_cbranch_vccnz L_st8
s_branch L_go8
L_sx8:
s_mov_b32 s40, 0
s_branch L_go8
L_st9:
s_sub_u32 s40, s40, 1
s_cbranch_scc1 L_sx9
buffer_load_dwordx4 v[92:95], v227, s[20:23], s63 offen offset:256 sc1
buffer_load_dwordx4 v[96:99], v236, s[20:23], s63 offen offset:256 sc1
s_waitcnt vmcnt(0)
v_max_u16 v2, v92, v96
v_cmp_eq_u16 vcc, -1, v2
s_cbranch_vccnz L_st9
s_branch L_go9
L_sx9:
s_mov_b32 s40, 0
s_branch L_go9
L_st10:
s_sub_u32 s40, s40, 1
s_cbranch_scc1 L_sx10
buffer_load_dwordx4 v[100:103], v227, s[20:23], s63 offen offset:512 sc1
buffer_load_dwordx4 v[24:27], v236, s[20:23], s63 offen offset:512 sc1
s_waitcnt vmcnt(0)
v_max_u16 v2, v100, v24
v_cmp_eq_u16 vcc, -1, v2
s_cbranch_vccnz L_st10
s_branch L_go10
L_sx10:
s_mov_b32 s40, 0
s_branch L_go10
L_st11:
s_sub_u32 s40, s40, 1
s_cbranch_scc1 L_sx11
buffer_load_dwordx4 v[28:31], v236, s[20:23], s63 offen offset:768 sc1
buffer_load_dwordx4 v[32:35], v236, s[20:23], s63 offen offset:1024 sc1
s_waitcnt vmcnt(0)
v_max_u16 v2, v28, v32
v_cmp_eq_u16 vcc, -1, v2
s_cbranch_vccnz L_st11
s_branch L_go11
L_sx11:
s_mov_b32 s40, 0
s_branch L_go11
L_st12:
s_sub_u32 s40, s40, 1
s_cbranch_scc1 L_sx12
buffer_load_dwordx4 v[36:39], v227, s[20:23], s63 offen offset:768 sc1
buffer_load_dwordx4 v[40:43], v227, s[20:23], s63 offen offset:1024 sc1
s_waitcnt vmcnt(0)
v_max_u16 v2, v36, v40
v_cmp_eq_u16 vcc, -1, v2
s_cbranch_vccnz L_st12
s_branch L_go12
L_sx12:
s_mov_b32 s40, 0
s_branch L_go12
L_st13:
s_sub_u32 s40, s40, 1
s_cbranch_scc1 L_sx13
buffer_load_dwordx4 v[44:47], v227, s[20:23], s64 offen offset:0 sc1
buffer_load_dwordx4 v[48:51], v227, s[20:23], s64 offen offset:256 sc1
s_waitcnt vmcnt(0)
v_max_u16 v2, v44, v48
v_cmp_eq_u16 vcc, -1, v2
s_cbranch_vccnz L_st13
s_branch L_go13
L_sx13:
s_mov_b32 s40, 0
s_branch L_go13
L_pad_14:
s_setpc_b64 s[100:101]
L_st14:
s_sub_u32 s40, s40, 1
s_cbranch_scc1 L_sx14
buffer_load_dwordx4 v[52:55], v227, s[20:23], s64 offen offset:512 sc1
buffer_load_dwordx4 v[56:59], v227, s[20:23], s64 offen offset:768 sc1
s_waitcnt vmcnt(0)
v_max_u16 v2, v52, v56
v_cmp_eq_u16 vcc, -1, v2
s_cbranch_vccnz L_st14
s_branch L_go14
L_sx14:
s_mov_b32 s40, 0
s_branch L_go14
L_st15:
s_sub_u32 s40, s40, 1
s_cbranch_scc1 L_sx15
buffer_load_dwordx4 v[60:63], v227, s[20:23], s64 offen offset:1024 sc1
s_waitcnt vmcnt(0)
v_cmp_eq_u16 vcc, -1, v60
s_cbranch_vccnz L_st15
s_branch L_go15
L_sx15:
s_mov_b32 s40, 0
s_branch L_go15
L_gl_9g:
buffer_store_dwordx4 v[32:35], v1, s[16:19], s3 offen sc1
s_branch L_gl_9b
L_pad_15:
s_setpc_b64 s[100:101]
L_h0:
s_setprio 2
v_lshrrev_b32 v1, 3, v0
v_and_b32 v2, 2, v1
v_xor_b32 v2, v2, v0
v_and_b32 v2, 7, v2
s_lshl_b32 s3, s36, 7
v_lshl_add_u32 v2, v2, 4, s3
v_mul_u32_u24 v3, 3840, v1
v_add_u32 v24, v3, v2
v_xor_b32 v27, 64, v24
v_add_u32 v27, 30720, v27
v_mov_b32 v55, 0
v_add_u32 v25, 256, v24
v_add_u32 v26, 512, v24
v_add_u32 v28, 256, v27
v_add_u32 v29, 512, v27
v_lshrrev_b32 v1, 4, v0
v_lshlrev_b32 v1, 3, v1
s_lshl_b32 s3, s36, 7
buffer_load_dwordx2 v[244:245], v1, s[28:31], s3 offen offset:0
buffer_load_dwordx2 v[246:247], v1, s[28:31], s3 offen offset:32
buffer_load_dwordx2 v[248:249], v1, s[28:31], s3 offen offset:64
buffer_load_dwordx2 v[250:251], v1, s[28:31], s3 offen offset:96
s_waitcnt vmcnt(4)
s_barrier
s_mov_b32 s42, 1
s_mov_b32 s65, 45056
L_wl:
s_add_u32 s69, s69, 1
s_cmp_eq_u32 s69, 10
s_cselect_b32 s69, 0, s69
s_add_u32 s61, s61, 36864
s_cmp_eq_u32 s61, 155648
s_cselect_b32 s61, 8192, s61
s_mul_i32 s63, s69, 245760
s_add_u32 m0, s61, 12288
s_nop 0
buffer_load_dwordx4 v24, s[8:11], s63 offen offset:0 lds
buffer_load_dwordx4 v25, s[8:11], s63 offen offset:1024 lds
buffer_load_dwordx4 v26, s[8:11], s63 offen offset:2048 lds
s_addk_i32 m0, 3072
s_nop 0
buffer_load_dwordx4 v27, s[8:11], s63 offen offset:0 lds
buffer_load_dwordx4 v28, s[8:11], s63 offen offset:1024 lds
buffer_load_dwordx4 v29, s[8:11], s63 offen offset:2048 lds
s_addk_i32 m0, 3072
s_add_u32 s63, s63, 61440
buffer_load_dwordx4 v24, s[8:11], s63 offen offset:0 lds
buffer_load_dwordx4 v25, s[8:11], s63 offen offset:1024 lds
buffer_load_dwordx4 v26, s[8:11], s63 offen offset:2048 lds
s_addk_i32 m0, 3072
s_nop 0
buffer_load_dwordx4 v27, s[8:11], s63 offen offset:0 lds
buffer_load_dwordx4 v28, s[8:11], s63 offen offset:1024 lds
buffer_load_dwordx4 v29, s[8:11], s63 offen offset:2048 lds
s_addk_i32 m0, 3072
s_add_u32 s63, s63, 61440
buffer_load_dwordx4 v24, s[8:11], s63 offen offset:0 lds
buffer_load_dwordx4 v25, s[8:11], s63 offen offset:1024 lds
buffer_load_dwordx4 v26, s[8:11], s63 offen offset:2048 lds
s_addk_i32 m0, 3072
s_nop 0
buffer_load_dwordx4 v27, s[8:11], s63 offen offset:0 lds
buffer_load_dwordx4 v28, s[8:11], s63 offen offset:1024 lds
buffer_load_dwordx4 v29, s[8:11], s63 offen offset:2048 lds
s_addk_i32 m0, 3072
s_add_u32 s63, s63, 61440
buffer_load_dwordx4 v24, s[8:11], s63 offen offset:0 lds
buffer_load_dwordx4 v25, s[8:11], s63 offen offset:1024 lds
buffer_load_dwordx4 v26, s[8:11], s63 offen offset:2048 lds
s_addk_i32 m0, 3072
s_nop 0
buffer_load_dwordx4 v27, s[8:11], s63 offen offset:0 lds
buffer_load_dwordx4 v28, s[8:11], s63 offen offset:1024 lds
buffer_load_dwordx4 v29, s[8:11], s63 offen offset:2048 lds
s_mov_b32 s0, s65
s_mov_b32 s65, s61
s_cmp_eq_u32 s57, s42
s_waitcnt vmcnt(24) lgkmcnt(0)
s_barrier
s_cbranch_scc0 L_wc
s_call_b64 s[100:101], L_xcap
L_wc:
s_add_u32 s42, s42, 1
s_cmp_lt_u32 s42, 9
s_cbranch_scc1 L_wl
s_branch L_h8
L_pad_21:
s_setpc_b64 s[100:101]
L_c23:
ds_read_b64 v[96:97], v202 offset:0
ds_read_b64 v[98:99], v202 offset:1152
ds_read_b64 v[116:117], v206 offset:0
ds_read_b64 v[118:119], v207 offset:0
ds_read_b64 v[100:101], v203 offset:0
ds_read_b64 v[102:103], v203 offset:1152
ds_read_b64 v[120:121], v208 offset:0
ds_read_b64 v[122:123], v209 offset:0
ds_read_b64 v[104:105], v201 offset:0
ds_read_b64 v[106:107], v201 offset:1152
ds_read_b64 v[124:125], v210 offset:0
ds_read_b64 v[126:127], v211 offset:0
s_add_u32 s0, s37, 1
s_sub_u32 s1, 5, s37
s_min_u32 s0, s0, s1
s_lshl_b32 s0, s0, 4
s_sub_u32 s1, 64, s0
s_cmp_le_u32 s37, 2
s_cselect_b32 s1, s1, 16
s_bfm_b64 s[100:101], s0, s1
s_waitcnt lgkmcnt(8)
v_mfma_f32_16x16x32_bf16 v[152:155], v[96:99], v[116:119], 0
s_waitcnt lgkmcnt(4)
v_mfma_f32_16x16x32_bf16 v[156:159], v[100:103], v[120:123], 0
s_waitcnt lgkmcnt(0)
v_mfma_f32_16x16x32_bf16 v[152:155], v[104:107], v[124:127], v[152:155]
v_add_u32 v1, 128, v222
v_cndmask_b32 v4, v1, v222, s[44:45]
ds_read_b64 v[168:169], v4 offset:0
v_cndmask_b32 v4, v1, v222, s[46:47]
ds_read_b64 v[170:171], v4 offset:32
v_cndmask_b32 v4, v1, v222, s[48:49]
ds_read_b64 v[172:173], v4 offset:64
v_cndmask_b32 v4, v1, v222, s[50:51]
ds_read_b64 v[174:175], v4 offset:96
ds_read_b32 v5, v223 offset:0
v_permlane16_swap_b32 v152, v156
v_permlane16_swap_b32 v153, v157
v_permlane16_swap_b32 v154, v158
v_permlane16_swap_b32 v155, v159
v_cndmask_b32 v2, v156, v152, s[44:45]
v_cndmask_b32 v3, v157, v153, s[46:47]
v_cndmask_b32 v194, v158, v154, s[48:49]
v_cndmask_b32 v195, v159, v155, s[50:51]
v_or_b32 v192, 0xffff, v2
v_perm_b32 v193, v3, v2, s55
s_cmp_eq_u32 s41, 1
s_cbranch_scc0 L_gl_22g
buffer_store_dwordx4 v[192:195], v224, s[20:23], s54 offen
L_gl_22b:
v_mov_b32 v184, 0
v_mov_b32 v185, 0
v_mov_b32 v186, 0
v_mov_b32 v187, 0
v_mov_b32 v188, 0
v_mov_b32 v189, 0
v_mov_b32 v190, 0
v_mov_b32 v191, 0
ds_read_b64_tr_b16 v[72:73], v217 offset:0
ds_read_b64_tr_b16 v[74:75], v217 offset:1152
ds_read_b64_tr_b16 v[76:77], v218 offset:0
ds_read_b64_tr_b16 v[78:79], v218 offset:1152
s_waitcnt lgkmcnt(0)
v_mul_f32 v5, 0x3ea52b5c, v5
buffer_load_dwordx4 v[92:95], v225, s[20:23], s54 offen sc1
s_waitcnt vmcnt(0)
v_cmp_eq_u32 vcc, -1, v92
s_cbranch_vccnz L_h0rl
L_h0gl:
s_lshl_b32 s0, s32, 2
s_add_u32 s0, s0, 1744
v_mov_b32 v1, s0
ds_write_b32 v1, v1
v_perm_b32 v92, v92, v93, s56
v_add_f32 v193, v3, v93
v_add_f32 v194, v194, v94
v_add_f32 v195, v195, v95
v_add_f32 v192, v2, v92
v_fma_f32 v192, v192, v168, v169
v_fma_f32 v193, v193, v170, v171
v_fma_f32 v194, v194, v172, v173
v_fma_f32 v195, v195, v174, v175
v_max3_f32 v6, v192, v193, v194
v_max_f32 v6, v6, v195
v_mov_b32 v7, v6
s_nop 1
v_permlane32_swap_b32 v6, v7
v_max_f32 v6, v6, v7
v_mul_f32 v6, v6, v5
v_fma_f32 v192, v192, v5, -v6
v_fma_f32 v193, v193, v5, -v6
v_fma_f32 v194, v194, v5, -v6
v_fma_f32 v195, v195, v5, -v6
v_exp_f32 v192, v192
v_exp_f32 v193, v193
v_exp_f32 v194, v194
v_exp_f32 v195, v195
v_add_f32 v6, v192, v193
v_add_f32 v7, v194, v195
v_add_f32 v6, v6, v7
v_mov_b32 v7, v6
v_mul_f32 v192, v192, v168
v_mul_f32 v193, v193, v170
v_permlane32_swap_b32 v6, v7
v_mul_f32 v194, v194, v172
v_add_f32 v6, v6, v7
v_rcp_f32 v6, v6
v_mul_f32 v195, v195, v174
v_mul_f32 v192, v192, v6
v_mul_f32 v193, v193, v6
v_mul_f32 v194, v194, v6
v_mul_f32 v195, v195, v6
v_cvt_pk_bf16_f32 v192, v192, v193
v_cvt_pk_bf16_f32 v193, v194, v195
s_mov_b64 exec, s[52:53]
v_and_b32 v184, v220, v192
v_bfi_b32 v188, v220, 0, v192
v_and_b32 v185, v221, v193
v_bfi_b32 v189, v221, 0, v193
s_not_b64 exec, exec
v_and_b32 v186, v220, v192
v_bfi_b32 v190, v220, 0, v192
v_and_b32 v187, v221, v193
v_bfi_b32 v191, v221, 0, v193
s_mov_b64 exec, -1
v_permlane16_swap_b32 v184, v188
v_permlane16_swap_b32 v185, v189
v_permlane16_swap_b32 v186, v190
v_permlane16_swap_b32 v187, v191
s_nop 1
v_mfma_f32_16x16x32_bf16 v[152:155], v[72:75], v[184:187], 0
v_mfma_f32_16x16x32_bf16 v[156:159], v[76:79], v[184:187], 0
v_mfma_f32_16x16x32_bf16 v[160:163], v[76:79], v[188:191], 0
s_mov_b32 exec_lo, 0xffff0000
s_nop 4
v_cvt_pk_bf16_f32 v80, v152, v153
v_cvt_pk_bf16_f32 v81, v154, v155
v_cvt_pk_bf16_f32 v82, v156, v157
v_cvt_pk_bf16_f32 v83, v158, v159
s_mov_b64 exec, s[100:101]
v_cvt_pk_bf16_f32 v82, v160, v161
v_cvt_pk_bf16_f32 v83, v162, v163
s_mov_b32 exec_lo, 0xffff0000
s_mov_b32 exec_hi, 0xffffffff
s_cmp_eq_u32 s41, 1
s_cbranch_scc0 L_gl_23g
buffer_store_dwordx4 v[80:83], v226, s[20:23], s54 offen
L_gl_23b:
s_endpgm
L_pad_24:
s_setpc_b64 s[100:101]
L_gl_22g:
buffer_store_dwordx4 v[192:195], v224, s[20:23], s54 offen sc1
s_branch L_gl_22b
L_h0rl:
s_sub_u32 s40, s40, 1
s_cbranch_scc1 L_h0xl
buffer_load_dwordx4 v[92:95], v225, s[20:23], s54 offen sc1
s_waitcnt vmcnt(0)
v_cmp_eq_u32 vcc, -1, v92
s_cbranch_vccnz L_h0rl
s_branch L_h0gl
L_h0xl:
s_mov_b32 s40, 0
s_branch L_h0gl
L_gl_23g:
buffer_store_dwordx4 v[80:83], v226, s[20:23], s54 offen sc1
s_branch L_gl_23b
.p2align 12
L_pb_16:
L_cons:
v_and_b32 v1, 15, v0
v_lshrrev_b32 v2, 4, v0
v_mov_b32 v7, 1792
s_mul_i32 s0, s44, 2304
s_movk_i32 s1, 144
v_bfe_u32 v3, v0, 2, 1
v_and_b32 v4, 3, v0
v_lshlrev_b32 v4, 1, v4
v_lshl_add_u32 v3, v3, 3, v4
v_bfe_u32 v4, v0, 3, 1
v_add_u32 v3, v3, v4
s_add_u32 s3, s0, 17408
v_mov_b32 v4, s3
v_mad_u32_u24 v3, v3, s1, v4
s_add_u32 s3, s0, 4736
v_mov_b32 v4, s3
v_mad_u32_u24 v4, v1, s1, v4
s_mov_b32 s52, 0xff00ff
s_mov_b32 s53, 0xff00ff
v_add_u32 v5, s51, v2
v_lshl_add_u32 v200, v5, 3, v3
v_lshl_add_u32 v5, v5, 3, v4
v_cndmask_b32 v204, v7, v5, s[52:53]
v_cndmask_b32 v205, v5, v7, s[52:53]
v_add_u32 v5, s46, v2
v_lshl_add_u32 v202, v5, 3, v3
v_lshl_add_u32 v5, v5, 3, v4
v_cmp_gt_u32 vcc, s47, v2
s_nop 1
v_cndmask_b32 v5, v7, v5, vcc
v_cndmask_b32 v206, v7, v5, s[52:53]
v_cndmask_b32 v207, v5, v7, s[52:53]
v_add_u32 v5, s48, v2
v_min_u32 v5, 15, v5
v_lshl_add_u32 v203, v5, 3, v3
v_lshl_add_u32 v5, v5, 3, v4
v_cmp_gt_u32 vcc, s49, v2
s_nop 1
v_cndmask_b32 v5, v7, v5, vcc
v_cndmask_b32 v208, v7, v5, s[52:53]
v_cndmask_b32 v209, v5, v7, s[52:53]
s_sub_u32 s3, s51, 1
v_mad_u32_u24 v5, v2, 5, s3
s_add_u32 s3, s46, 4
v_mov_b32 v6, s3
s_mov_b64 vcc, 0xffff
v_cndmask_b32 v5, v5, v6, vcc
v_min_u32 v5, 15, v5
v_lshl_add_u32 v201, v5, 3, v3
v_lshl_add_u32 v5, v5, 3, v4
s_cmp_eq_u32 s47, 5
s_cselect_b64 vcc, 0xff, 0
v_cndmask_b32 v210, v7, v5, vcc
s_lshl_b64 vcc, vcc, 8
v_cndmask_b32 v211, v7, v5, vcc
s_bfm_b64 vcc, 8, 16
v_cndmask_b32 v212, v7, v5, vcc
s_bfm_b64 vcc, 8, 24
v_cndmask_b32 v213, v7, v5, vcc
s_bfm_b64 vcc, 8, 32
v_cndmask_b32 v214, v7, v5, vcc
s_bfm_b64 vcc, 8, 40
v_cndmask_b32 v215, v7, v5, vcc
s_mul_i32 s0, s44, 2304
s_movk_i32 s1, 144
v_bfe_u32 v3, v0, 2, 3
v_lshrrev_b32 v4, 5, v0
v_lshl_add_u32 v3, v3, 1, v4
s_add_u32 s3, s0, 31232
v_mov_b32 v4, s3
v_mad_u32_u24 v3, v3, s1, v4
v_and_b32 v4, 3, v0
s_mov_b32 s54, 0x11111111
s_mov_b32 s55, 0x11111111
v_add_u32 v5, s51, v4
v_lshl_add_u32 v216, v5, 3, v3
v_add_u32 v7, 32, v216
s_cmp_eq_u32 s50, 1
s_cselect_b32 s3, -1, 12
s_cselect_b32 s56, 2, -1
v_add_u32 v5, s3, v4
v_lshl_add_u32 v5, v5, 3, v3
v_cndmask_b32 v217, v5, v7, s[54:55]
v_add_u32 v7, 40, v7
v_add_u32 v5, s56, v4
v_add_u32 v6, 10, v5
v_cmp_gt_i32 vcc, s51, v5
s_nop 1
v_cndmask_b32 v5, v6, v5, vcc
v_lshl_add_u32 v5, v5, 3, v3
v_cndmask_b32 v218, v5, v7, s[54:55]
s_lshl_b32 s0, s44, 8
v_lshrrev_b32 v4, 5, v0
v_and_or_b32 v3, v0, 8, v4
s_add_u32 s3, s0, 8
v_lshl_add_u32 v222, v3, 4, s3
v_and_b32 v1, 15, v0
s_add_u32 s3, s0, 132
v_lshl_add_u32 v223, v1, 4, s3
s_lshr_b32 s3, s39, 8
s_mul_i32 s3, s3, 52429
s_lshr_b32 s3, s3, 18
s_lshl_b32 s0, s44, 5
s_add_u32 s3, s3, s0
s_sub_u32 s3, 2047, s3
v_mad_i32_i24 v234, v1, -2, s3
v_lshrrev_b32 v2, 4, v0
v_and_or_b32 v3, v0, 8, v2
v_and_b32 v4, 0x70, v233
v_bfrev_b32 v6, 1
s_lshl_b32 s3, s44, 4
v_add_u32 v5, s3, v3
s_lshl_b32 s3, s60, 3
v_cmp_gt_u32 vcc, s3, v5
v_mul_u32_u24 v5, 2560, v5
v_add3_u32 v5, v5, v4, s39
v_cndmask_b32 v227, v6, v5, vcc
s_lshl_b32 s3, s36, 7
v_add_u32 v226, s3, v227
v_bfe_u32 v3, v0, 4, 1
v_cmp_eq_u32 s[54:55], s50, v3
s_cmp_lg_u32 s37, 0
s_cselect_b64 s[0:1], -1, s[54:55]
s_and_b64 vcc, vcc, s[0:1]
s_cmp_lg_u32 s37, 4
s_cselect_b64 s[0:1], 0, s[54:55]
s_andn2_b64 vcc, vcc, s[0:1]
v_cndmask_b32 v225, v6, v226, vcc
s_cmp_le_u32 s37, 3
s_cselect_b32 s3, 2560, 0
s_sub_u32 s3, s3, 128
v_mov_b32 v4, s3
s_cmp_ge_u32 s37, 2
s_cselect_b32 s3, 2560, 0
s_add_u32 s3, s3, 128
v_mov_b32 v5, s3
v_cndmask_b32 v4, v4, v5, s[54:55]
v_mul_u32_u24 v3, 2560, v3
v_sub_u32 v4, v4, v3
v_add_u32 v4, v4, v226
v_cndmask_b32 v224, v6, v4, vcc
v_and_b32 v1, 15, v0
v_bfrev_b32 v6, 1
v_bfe_u32 v3, v0, 4, 1
v_lshrrev_b32 v4, 5, v0
v_lshl_add_u32 v3, v3, 1, v4
s_lshl_b32 s3, s36, 7
v_lshl_add_u32 v4, v3, 4, s3
s_lshl_b32 s3, s44, 4
v_add_u32 v5, s3, v1
s_lshl_b32 s3, s60, 3
v_cmp_gt_u32 vcc, s3, v5
v_mul_u32_u24 v5, 2560, v5
v_add3_u32 v5, v5, v4, s39
v_cndmask_b32 v232, v6, v5, vcc
v_bfe_u32 v3, v0, 3, 2
v_lshlrev_b32 v3, 2, v3
v_and_or_b32 v3, v0, 3, v3
v_lshlrev_b32 v3, 3, v3
v_bfe_u32 v4, v0, 2, 2
v_lshl_add_u32 v3, v4, 7, v3
v_lshrrev_b32 v2, 4, v0
s_mov_b32 s44, 0x0
s_mov_b32 s45, 0x1010101
s_mov_b32 s46, 0x3030303
s_mov_b32 s47, 0x7070707
s_mov_b32 s48, 0xf0f0f0f
s_mov_b32 s49, 0x1f1f1f1f
s_mov_b32 s50, 0x3f3f3f3f
s_mov_b32 s51, 0x7f7f7f7f
s_movk_i32 s54, 10240
s_mov_b32 s55, 0x07060501
s_mov_b32 s56, 0x0706000c
v_mov_b32 v5, 0xffff
v_mov_b32 v6, 0xffff0000
v_cndmask_b32 v1, 0, v5, s[44:45]
v_cndmask_b32 v4, 0, v6, s[46:47]
v_or_b32 v220, v1, v4
v_cndmask_b32 v1, 0, v5, s[48:49]
v_cndmask_b32 v4, 0, v6, s[50:51]
v_or_b32 v221, v1, v4
s_lshl_b32 s3, s38, 5
v_xor_b32 v3, s3, v3
v_mul_u32_u24 v4, 3072, v2
v_add_u32 v3, v3, v4
v_add_u32 v244, 20480, v3
s_mov_b32 s42, 0
v_mov_b32 v3, 0
v_lshlrev_b32 v2, 2, v0
s_mov_b32 exec_hi, 0
ds_write_b32 v2, v3 offset:1728
ds_write_b32 v2, v3 offset:2880
s_mov_b64 exec, -1
v_and_b32 v1, 15, v0
v_lshrrev_b32 v2, 4, v0
v_lshrrev_b32 v3, 1, v1
v_xor_b32 v3, v3, v2
v_lshlrev_b32 v3, 4, v3
v_lshl_add_u32 v3, v1, 7, v3
v_add_u32 v245, 8192, v3
v_xor_b32 v246, 64, v245
v_mul_u32_u24 v3, 144, v1
v_lshl_add_u32 v3, v2, 3, v3
s_lshl_b32 s3, s38, 5
s_add_u32 s3, s3, 3584
v_add_u32 v247, s3, v3
v_lshlrev_b32 v248, 4, v1
s_cmp_eq_u32 s32, 0
s_cbranch_scc0 L_cw0
s_call_b64 s[100:101], L_pad_2
L_cw0:
s_cmp_eq_u32 s32, 1
s_cbranch_scc0 L_cw1
s_call_b64 s[100:101], L_pad_15
L_cw1:
s_cmp_eq_u32 s32, 2
s_cbranch_scc0 L_cw2
s_call_b64 s[100:101], L_pad_18
L_cw2:
s_cmp_eq_u32 s32, 3
s_cbranch_scc0 L_cw3
L_cw3:
v_mov_b32 v4, -1
v_mov_b32 v5, -1
v_mov_b32 v6, -1
v_mov_b32 v7, -1
v_lshrrev_b32 v1, 3, v0
v_mul_u32_u24 v1, 2560, v1
v_and_b32 v2, 0x70, v233
s_lshl_b32 s3, s36, 7
s_add_u32 s3, s3, s39
v_add3_u32 v1, v1, v2, s3
s_mul_i32 s0, s38, 20480
s_add_u32 s1, s0, 81920
s_add_u32 s3, s38, 8
s_cmp_lt_u32 s3, s60
s_cselect_b32 s3, s1, 0x80000000
s_add_u32 s66, s3, 81920
v_lshrrev_b32 v2, 4, v0
v_mul_u32_u24 v2, 2304, v2
v_add_u32 v2, v2, v233
s_mul_i32 s67, s43, 15360
s_lshl_b32 s3, s36, 8
s_add_u32 s67, s67, s3
s_and_b32 s3, s38, 1
s_mul_i32 s3, s3, 7680
s_add_u32 s67, s67, s3
s_add_u32 s67, s67, 2097152
s_cmp_lt_u32 s38, 2
s_cselect_b32 s67, s67, 0x80000000
s_cmp_eq_u32 s69, 9
s_cselect_b32 s3, -2457600, 0
s_add_u32 s3, s3, 245760
v_add_u32 v254, s3, v254
s_mul_i32 s3, s38, 3072
s_add_u32 m0, s3, 57344
s_mov_b32 s64, 122880
buffer_load_dwordx4 v254, s[8:11], 0 offen offset:0 lds
s_addk_i32 m0, -256
s_nop 0
buffer_load_dwordx4 v254, s[8:11], 0 offen offset:1280 lds
s_addk_i32 m0, -256
s_nop 0
buffer_load_dwordx4 v254, s[8:11], 0 offen offset:2560 lds
s_addk_i32 m0, 12800
s_nop 0
buffer_load_dwordx4 v254, s[8:11], s64 offen offset:0 lds
s_addk_i32 m0, -256
s_nop 0
buffer_load_dwordx4 v254, s[8:11], s64 offen offset:1280 lds
s_addk_i32 m0, -256
s_nop 0
buffer_load_dwordx4 v254, s[8:11], s64 offen offset:2560 lds
buffer_store_dwordx4 v[4:7], v1, s[20:23], s0 offen
buffer_store_dwordx4 v[4:7], v1, s[20:23], s1 offen
buffer_store_dwordx4 v[4:7], v1, s[20:23], s66 offen
s_mov_b32 exec_hi, 0xffff
buffer_store_dwordx4 v[4:7], v2, s[16:19], s67 offen
s_mov_b64 exec, -1
s_cmp_lt_u32 s32, 2
s_cselect_b32 s57, s57, 99
s_mov_b32 s65, 8192
s_min_u32 s62, s57, 1
s_waitcnt vmcnt(10) lgkmcnt(0)
s_barrier
ds_read_b64_tr_b16 v[156:157], v244 offset:1024
ds_read_b64_tr_b16 v[158:159], v244 offset:1536
ds_read_b128 v[80:83], v245 offset:0
ds_read_b128 v[84:87], v245 offset:2048
ds_read_b128 v[88:91], v245 offset:4096
ds_read_b128 v[92:95], v245 offset:6144
ds_read_b128 v[96:99], v245 offset:8192
ds_read_b128 v[100:103], v245 offset:10240
ds_read_b64_tr_b16 v[160:161], v244 offset:2048
ds_read_b64_tr_b16 v[162:163], v244 offset:2560
ds_read_b64_tr_b16 v[152:153], v244 offset:0
ds_read_b64_tr_b16 v[154:155], v244 offset:512
s_waitcnt lgkmcnt(4)
v_mfma_f32_16x16x32_bf16 v[32:35], v[156:159], v[80:83], 0
ds_read_b64_tr_b16 v[168:169], v244 offset:13312
v_mfma_f32_16x16x32_bf16 v[36:39], v[156:159], v[84:87], 0
ds_read_b64_tr_b16 v[170:171], v244 offset:13824
v_mfma_f32_16x16x32_bf16 v[40:43], v[156:159], v[88:91], 0
ds_read_b128 v[104:107], v246 offset:0
v_mfma_f32_16x16x32_bf16 v[44:47], v[156:159], v[92:95], 0
ds_read_b128 v[108:111], v246 offset:2048
v_mfma_f32_16x16x32_bf16 v[48:51], v[156:159], v[96:99], 0
ds_read_b128 v[112:115], v246 offset:4096
v_mfma_f32_16x16x32_bf16 v[52:55], v[156:159], v[100:103], 0
ds_read_b128 v[116:119], v246 offset:6144
s_waitcnt lgkmcnt(8)
v_mfma_f32_16x16x32_bf16 v[56:59], v[160:163], v[80:83], 0
ds_read_b128 v[120:123], v246 offset:8192
v_mfma_f32_16x16x32_bf16 v[60:63], v[160:163], v[84:87], 0
ds_read_b128 v[124:127], v246 offset:10240
v_mfma_f32_16x16x32_bf16 v[64:67], v[160:163], v[88:91], 0
ds_read_b64_tr_b16 v[172:173], v244 offset:14336
v_mfma_f32_16x16x32_bf16 v[68:71], v[160:163], v[92:95], 0
ds_read_b64_tr_b16 v[174:175], v244 offset:14848
v_mfma_f32_16x16x32_bf16 v[72:75], v[160:163], v[96:99], 0
ds_read_b64_tr_b16 v[164:165], v244 offset:12288
v_mfma_f32_16x16x32_bf16 v[76:79], v[160:163], v[100:103], 0
ds_read_b64_tr_b16 v[166:167], v244 offset:12800
s_waitcnt lgkmcnt(12)
v_mfma_f32_16x16x32_bf16 v[8:11], v[152:155], v[80:83], 0
s_add_u32 s3, s65, 36864
s_cmp_eq_u32 s3, 155648
v_mfma_f32_16x16x32_bf16 v[12:15], v[152:155], v[84:87], 0
s_cselect_b32 s3, 8192, s3
s_sub_u32 s63, s3, s65
v_mfma_f32_16x16x32_bf16 v[16:19], v[152:155], v[88:91], 0
s_mov_b32 s65, s3
v_add_u32 v245, s63, v245
v_mfma_f32_16x16x32_bf16 v[20:23], v[152:155], v[92:95], 0
v_add_u32 v244, s63, v244
v_add_u32 v246, s63, v246
v_mfma_f32_16x16x32_bf16 v[24:27], v[152:155], v[96:99], 0
v_mfma_f32_16x16x32_bf16 v[28:31], v[152:155], v[100:103], 0
s_add_u32 s42, s42, 1
s_cmp_lt_u32 s42, 9
s_waitcnt lgkmcnt(4)
v_mfma_f32_16x16x32_bf16 v[32:35], v[168:171], v[104:107], v[32:35]
v_mfma_f32_16x16x32_bf16 v[36:39], v[168:171], v[108:111], v[36:39]
v_mfma_f32_16x16x32_bf16 v[40:43], v[168:171], v[112:115], v[40:43]
v_mfma_f32_16x16x32_bf16 v[44:47], v[168:171], v[116:119], v[44:47]
v_mfma_f32_16x16x32_bf16 v[48:51], v[168:171], v[120:123], v[48:51]
v_mfma_f32_16x16x32_bf16 v[52:55], v[168:171], v[124:127], v[52:55]
s_waitcnt lgkmcnt(2)
v_mfma_f32_16x16x32_bf16 v[56:59], v[172:175], v[104:107], v[56:59]
v_mfma_f32_16x16x32_bf16 v[60:63], v[172:175], v[108:111], v[60:63]
v_mfma_f32_16x16x32_bf16 v[64:67], v[172:175], v[112:115], v[64:67]
v_mfma_f32_16x16x32_bf16 v[68:71], v[172:175], v[116:119], v[68:71]
v_mfma_f32_16x16x32_bf16 v[72:75], v[172:175], v[120:123], v[72:75]
s_waitcnt lgkmcnt(0)
v_mfma_f32_16x16x32_bf16 v[76:79], v[172:175], v[124:127], v[76:79]
s_waitcnt vmcnt(4)
s_branch L_pb_17
L_pad_25:
s_setpc_b64 s[100:101]
L_ev:
s_cmp_eq_u32 s42, 1
s_cbranch_scc0 L_ev1
s_waitcnt vmcnt(0)
L_ev1:
s_max_u32 s62, s57, 1
s_cmp_eq_u32 s42, s57
s_cbranch_scc0 L_evb
s_sub_u32 s0, s65, s63
v_add_u32 v1, s0, v235
ds_read_b64 v[236:237], v1
v_xor_b32 v2, 32, v1
ds_read_b64 v[238:239], v2
v_xor_b32 v3, 64, v1
ds_read_b64 v[240:241], v3
v_xor_b32 v4, 96, v1
ds_read_b64 v[242:243], v4
s_branch L_evb
L_gs:
v_mov_b32 v4, -1
v_mov_b32 v5, -1
v_mov_b32 v6, -1
v_mov_b32 v7, -1
v_lshrrev_b32 v1, 3, v0
v_mul_u32_u24 v1, 2560, v1
v_and_b32 v2, 0x70, v233
s_lshl_b32 s3, s36, 7
s_add_u32 s3, s3, s39
v_add3_u32 v1, v1, v2, s3
s_mul_i32 s0, s38, 20480
s_add_u32 s1, s0, 81920
s_add_u32 s3, s38, 8
s_cmp_lt_u32 s3, s60
s_cselect_b32 s3, s1, 0x80000000
s_add_u32 s66, s3, 81920
v_lshrrev_b32 v2, 4, v0
v_mul_u32_u24 v2, 2304, v2
v_add_u32 v2, v2, v233
s_mul_i32 s67, s43, 15360
s_lshl_b32 s3, s36, 8
s_add_u32 s67, s67, s3
s_and_b32 s3, s38, 1
s_mul_i32 s3, s3, 7680
s_add_u32 s67, s67, s3
s_add_u32 s67, s67, 2097152
s_cmp_lt_u32 s38, 2
s_cselect_b32 s67, s67, 0x80000000
buffer_store_dwordx4 v[4:7], v1, s[20:23], s0 offen sc1
buffer_store_dwordx4 v[4:7], v1, s[20:23], s1 offen sc1
buffer_store_dwordx4 v[4:7], v1, s[20:23], s66 offen sc1
s_mov_b32 exec_hi, 0xffff
buffer_store_dwordx4 v[4:7], v2, s[16:19], s67 offen sc1
s_mov_b64 exec, -1
s_waitcnt vmcnt(0)
s_barrier
s_barrier
s_branch L_gsb
.p2align 12
L_pad_18:
s_setpc_b64 s[100:101]
L_pb_17:
L_cloop:
s_barrier
ds_read_b64_tr_b16 v[156:157], v244 offset:1024
ds_read_b64_tr_b16 v[158:159], v244 offset:1536
v_mfma_f32_16x16x32_bf16 v[8:11], v[164:167], v[104:107], v[8:11]
ds_read_b128 v[80:83], v245 offset:0
v_mfma_f32_16x16x32_bf16 v[12:15], v[164:167], v[108:111], v[12:15]
ds_read_b128 v[84:87], v245 offset:2048
v_mfma_f32_16x16x32_bf16 v[16:19], v[164:167], v[112:115], v[16:19]
ds_read_b128 v[88:91], v245 offset:4096
v_mfma_f32_16x16x32_bf16 v[20:23], v[164:167], v[116:119], v[20:23]
ds_read_b128 v[92:95], v245 offset:6144
v_mfma_f32_16x16x32_bf16 v[24:27], v[164:167], v[120:123], v[24:27]
ds_read_b128 v[96:99], v245 offset:8192
v_mfma_f32_16x16x32_bf16 v[28:31], v[164:167], v[124:127], v[28:31]
ds_read_b128 v[100:103], v245 offset:10240
s_waitcnt lgkmcnt(5)
v_mfma_f32_16x16x32_bf16 v[32:35], v[156:159], v[80:83], v[32:35]
ds_read_b64_tr_b16 v[160:161], v244 offset:2048
s_waitcnt lgkmcnt(5)
v_mfma_f32_16x16x32_bf16 v[36:39], v[156:159], v[84:87], v[36:39]
ds_read_b64_tr_b16 v[162:163], v244 offset:2560
s_waitcnt lgkmcnt(5)
v_mfma_f32_16x16x32_bf16 v[40:43], v[156:159], v[88:91], v[40:43]
ds_read_b64_tr_b16 v[152:153], v244 offset:0
s_waitcnt lgkmcnt(5)
v_mfma_f32_16x16x32_bf16 v[44:47], v[156:159], v[92:95], v[44:47]
ds_read_b64_tr_b16 v[154:155], v244 offset:512
s_waitcnt lgkmcnt(5)
v_mfma_f32_16x16x32_bf16 v[48:51], v[156:159], v[96:99], v[48:51]
ds_read_b64_tr_b16 v[168:169], v244 offset:13312
s_waitcnt lgkmcnt(5)
v_mfma_f32_16x16x32_bf16 v[52:55], v[156:159], v[100:103], v[52:55]
ds_read_b64_tr_b16 v[170:171], v244 offset:13824
s_waitcnt lgkmcnt(4)
v_mfma_f32_16x16x32_bf16 v[56:59], v[160:163], v[80:83], v[56:59]
ds_read_b128 v[104:107], v246 offset:0
v_mfma_f32_16x16x32_bf16 v[60:63], v[160:163], v[84:87], v[60:63]
ds_read_b128 v[108:111], v246 offset:2048
v_mfma_f32_16x16x32_bf16 v[64:67], v[160:163], v[88:91], v[64:67]
ds_read_b128 v[112:115], v246 offset:4096
v_mfma_f32_16x16x32_bf16 v[68:71], v[160:163], v[92:95], v[68:71]
ds_read_b128 v[116:119], v246 offset:6144
v_mfma_f32_16x16x32_bf16 v[72:75], v[160:163], v[96:99], v[72:75]
ds_read_b128 v[120:123], v246 offset:8192
v_mfma_f32_16x16x32_bf16 v[76:79], v[160:163], v[100:103], v[76:79]
ds_read_b128 v[124:127], v246 offset:10240
s_waitcnt lgkmcnt(8)
v_mfma_f32_16x16x32_bf16 v[8:11], v[152:155], v[80:83], v[8:11]
ds_read_b64_tr_b16 v[172:173], v244 offset:14336
v_mfma_f32_16x16x32_bf16 v[12:15], v[152:155], v[84:87], v[12:15]
ds_read_b64_tr_b16 v[174:175], v244 offset:14848
v_mfma_f32_16x16x32_bf16 v[16:19], v[152:155], v[88:91], v[16:19]
ds_read_b64_tr_b16 v[164:165], v244 offset:12288
v_mfma_f32_16x16x32_bf16 v[20:23], v[152:155], v[92:95], v[20:23]
ds_read_b64_tr_b16 v[166:167], v244 offset:12800
v_mfma_f32_16x16x32_bf16 v[24:27], v[152:155], v[96:99], v[24:27]
s_add_u32 s3, s65, 36864
s_cmp_eq_u32 s3, 155648
v_mfma_f32_16x16x32_bf16 v[28:31], v[152:155], v[100:103], v[28:31]
s_cselect_b32 s3, 8192, s3
s_sub_u32 s63, s3, s65
s_waitcnt lgkmcnt(4)
v_mfma_f32_16x16x32_bf16 v[32:35], v[168:171], v[104:107], v[32:35]
s_mov_b32 s65, s3
v_add_u32 v245, s63, v245
v_mfma_f32_16x16x32_bf16 v[36:39], v[168:171], v[108:111], v[36:39]
v_add_u32 v244, s63, v244
v_add_u32 v246, s63, v246
v_mfma_f32_16x16x32_bf16 v[40:43], v[168:171], v[112:115], v[40:43]
s_cmp_eq_u32 s42, s62
s_cbranch_scc1 L_ev
L_evb:
v_mfma_f32_16x16x32_bf16 v[44:47], v[168:171], v[116:119], v[44:47]
v_mfma_f32_16x16x32_bf16 v[48:51], v[168:171], v[120:123], v[48:51]
s_add_u32 s42, s42, 1
s_cmp_lt_u32 s42, 9
v_mfma_f32_16x16x32_bf16 v[52:55], v[168:171], v[124:127], v[52:55]
s_waitcnt lgkmcnt(2)
v_mfma_f32_16x16x32_bf16 v[56:59], v[172:175], v[104:107], v[56:59]
v_mfma_f32_16x16x32_bf16 v[60:63], v[172:175], v[108:111], v[60:63]
v_mfma_f32_16x16x32_bf16 v[64:67], v[172:175], v[112:115], v[64:67]
v_mfma_f32_16x16x32_bf16 v[68:71], v[172:175], v[116:119], v[68:71]
v_mfma_f32_16x16x32_bf16 v[72:75], v[172:175], v[120:123], v[72:75]
s_waitcnt lgkmcnt(0)
v_mfma_f32_16x16x32_bf16 v[76:79], v[172:175], v[124:127], v[76:79]
s_cbranch_scc1 L_cloop
v_mov_b32 v1, 1728
ds_read_b32 v1, v1
ds_read2_b64 v[180:183], v248 offset0:0 offset1:32
ds_read2_b64 v[184:187], v248 offset0:64 offset1:96
ds_read2_b64 v[188:191], v248 offset0:128 offset1:160
s_waitcnt lgkmcnt(0)
v_readfirstlane_b32 s41, v1
s_barrier
s_cmp_eq_u32 s41, 1
s_cbranch_scc0 L_gs
L_gsb:
ds_read_b64_tr_b16 v[156:157], v244 offset:1024
ds_read_b64_tr_b16 v[158:159], v244 offset:1536
v_mfma_f32_16x16x32_bf16 v[8:11], v[164:167], v[104:107], v[8:11]
ds_read_b128 v[80:83], v245 offset:0
v_mfma_f32_16x16x32_bf16 v[12:15], v[164:167], v[108:111], v[12:15]
ds_read_b128 v[84:87], v245 offset:2048
v_mfma_f32_16x16x32_bf16 v[16:19], v[164:167], v[112:115], v[16:19]
ds_read_b128 v[88:91], v245 offset:4096
v_mfma_f32_16x16x32_bf16 v[20:23], v[164:167], v[116:119], v[20:23]
ds_read_b128 v[92:95], v245 offset:6144
v_mfma_f32_16x16x32_bf16 v[24:27], v[164:167], v[120:123], v[24:27]
ds_read_b128 v[96:99], v245 offset:8192
v_mfma_f32_16x16x32_bf16 v[28:31], v[164:167], v[124:127], v[28:31]
ds_read_b128 v[100:103], v245 offset:10240
ds_read_b64_tr_b16 v[176:177], v244 offset:13312
ds_read_b64_tr_b16 v[178:179], v244 offset:13824
s_waitcnt lgkmcnt(7)
v_mfma_f32_16x16x32_bf16 v[32:35], v[156:159], v[80:83], v[32:35]
ds_read_b128 v[128:131], v246 offset:0
s_waitcnt lgkmcnt(7)
v_mfma_f32_16x16x32_bf16 v[36:39], v[156:159], v[84:87], v[36:39]
ds_read_b128 v[132:135], v246 offset:2048
s_waitcnt lgkmcnt(7)
v_mfma_f32_16x16x32_bf16 v[40:43], v[156:159], v[88:91], v[40:43]
ds_read_b128 v[136:139], v246 offset:4096
s_waitcnt lgkmcnt(7)
v_mfma_f32_16x16x32_bf16 v[44:47], v[156:159], v[92:95], v[44:47]
ds_read_b128 v[140:143], v246 offset:6144
s_waitcnt lgkmcnt(7)
v_mfma_f32_16x16x32_bf16 v[48:51], v[156:159], v[96:99], v[48:51]
ds_read_b128 v[144:147], v246 offset:8192
s_waitcnt lgkmcnt(7)
v_mfma_f32_16x16x32_bf16 v[52:55], v[156:159], v[100:103], v[52:55]
ds_read_b128 v[148:151], v246 offset:10240
s_waitcnt lgkmcnt(5)
v_mfma_f32_16x16x32_bf16 v[32:35], v[176:179], v[128:131], v[32:35]
ds_read_b64_tr_b16 v[160:161], v244 offset:2048
s_waitcnt lgkmcnt(5)
v_mfma_f32_16x16x32_bf16 v[36:39], v[176:179], v[132:135], v[36:39]
ds_read_b64_tr_b16 v[162:163], v244 offset:2560
s_waitcnt lgkmcnt(5)
v_mfma_f32_16x16x32_bf16 v[40:43], v[176:179], v[136:139], v[40:43]
ds_read_b64_tr_b16 v[152:153], v244 offset:0
s_waitcnt lgkmcnt(5)
v_mfma_f32_16x16x32_bf16 v[44:47], v[176:179], v[140:143], v[44:47]
ds_read_b64_tr_b16 v[154:155], v244 offset:512
s_waitcnt lgkmcnt(5)
v_mfma_f32_16x16x32_bf16 v[48:51], v[176:179], v[144:147], v[48:51]
ds_read_b64_tr_b16 v[172:173], v244 offset:14336
s_waitcnt lgkmcnt(5)
v_mfma_f32_16x16x32_bf16 v[52:55], v[176:179], v[148:151], v[52:55]
ds_read_b64_tr_b16 v[174:175], v244 offset:14848
s_waitcnt lgkmcnt(4)
v_mfma_f32_16x16x32_bf16 v[56:59], v[160:163], v[80:83], v[56:59]
ds_read_b64_tr_b16 v[164:165], v244 offset:12288
ds_read_b64_tr_b16 v[166:167], v244 offset:12800
v_mov_b32_dpp v192, v32 row_newbcast:0 row_mask:0xf bank_mask:0xf
v_mov_b32_dpp v193, v33 row_newbcast:0 row_mask:0xf bank_mask:0xf
v_mov_b32_dpp v194, v34 row_newbcast:0 row_mask:0xf bank_mask:0xf
v_mov_b32_dpp v195, v35 row_newbcast:0 row_mask:0xf bank_mask:0xf
v_fmac_f32 v32, v192, v180
v_fmac_f32 v33, v193, v180
v_fmac_f32 v34, v194, v180
v_mfma_f32_16x16x32_bf16 v[60:63], v[160:163], v[84:87], v[60:63]
v_fmac_f32 v35, v195, v180
v_cvt_pk_bf16_f32 v32, v32, v33
v_cvt_pk_bf16_f32 v33, v34, v35
v_mfma_f32_16x16x32_bf16 v[64:67], v[160:163], v[88:91], v[64:67]
ds_write_b64 v247, v[32:33] offset:13824
v_fmac_f32 v36, v192, v182
v_fmac_f32 v37, v193, v182
v_fmac_f32 v38, v194, v182
v_mfma_f32_16x16x32_bf16 v[68:71], v[160:163], v[92:95], v[68:71]
v_fmac_f32 v39, v195, v182
v_cvt_pk_bf16_f32 v36, v36, v37
v_cvt_pk_bf16_f32 v37, v38, v39
v_mfma_f32_16x16x32_bf16 v[72:75], v[160:163], v[96:99], v[72:75]
ds_write_b64 v247, v[36:37] offset:16128
v_fmac_f32 v40, v192, v184
v_fmac_f32 v41, v193, v184
v_fmac_f32 v42, v194, v184
v_mfma_f32_16x16x32_bf16 v[76:79], v[160:163], v[100:103], v[76:79]
v_fmac_f32 v43, v195, v184
v_cvt_pk_bf16_f32 v40, v40, v41
v_cvt_pk_bf16_f32 v41, v42, v43
s_waitcnt lgkmcnt(4)
v_mfma_f32_16x16x32_bf16 v[56:59], v[172:175], v[128:131], v[56:59]
ds_write_b64 v247, v[40:41] offset:18432
v_fmac_f32 v44, v192, v186
v_fmac_f32 v45, v193, v186
v_fmac_f32 v46, v194, v186
v_mfma_f32_16x16x32_bf16 v[60:63], v[172:175], v[132:135], v[60:63]
v_fmac_f32 v47, v195, v186
v_cvt_pk_bf16_f32 v44, v44, v45
v_cvt_pk_bf16_f32 v45, v46, v47
v_mfma_f32_16x16x32_bf16 v[64:67], v[172:175], v[136:139], v[64:67]
ds_write_b64 v247, v[44:45] offset:20736
v_fmac_f32 v48, v192, v188
v_fmac_f32 v49, v193, v188
v_fmac_f32 v50, v194, v188
v_mfma_f32_16x16x32_bf16 v[68:71], v[172:175], v[140:143], v[68:71]
v_fmac_f32 v51, v195, v188
v_cvt_pk_bf16_f32 v48, v48, v49
v_cvt_pk_bf16_f32 v49, v50, v51
v_mfma_f32_16x16x32_bf16 v[72:75], v[172:175], v[144:147], v[72:75]
ds_write_b64 v247, v[48:49] offset:23040
v_fmac_f32 v52, v192, v190
v_fmac_f32 v53, v193, v190
v_fmac_f32 v54, v194, v190
v_mfma_f32_16x16x32_bf16 v[76:79], v[172:175], v[148:151], v[76:79]
v_fmac_f32 v55, v195, v190
v_cvt_pk_bf16_f32 v52, v52, v53
v_cvt_pk_bf16_f32 v53, v54, v55
ds_write_b64 v247, v[52:53] offset:25344
v_mfma_f32_16x16x32_bf16 v[8:11], v[152:155], v[80:83], v[8:11]
v_mov_b32_dpp v192, v56 row_newbcast:0 row_mask:0xf bank_mask:0xf
v_mov_b32_dpp v193, v57 row_newbcast:0 row_mask:0xf bank_mask:0xf
v_mov_b32_dpp v194, v58 row_newbcast:0 row_mask:0xf bank_mask:0xf
v_mov_b32_dpp v195, v59 row_newbcast:0 row_mask:0xf bank_mask:0xf
v_fmac_f32 v56, v192, v180
v_fmac_f32 v57, v193, v180
v_fmac_f32 v58, v194, v180
v_mfma_f32_16x16x32_bf16 v[12:15], v[152:155], v[84:87], v[12:15]
v_fmac_f32 v59, v195, v180
v_cvt_pk_bf16_f32 v56, v56, v57
v_cvt_pk_bf16_f32 v57, v58, v59
v_mfma_f32_16x16x32_bf16 v[16:19], v[152:155], v[88:91], v[16:19]
s_waitcnt lgkmcnt(0)
s_barrier
ds_write_b64 v247, v[56:57] offset:27648
v_fmac_f32 v60, v192, v182
v_fmac_f32 v61, v193, v182
v_fmac_f32 v62, v194, v182
v_mfma_f32_16x16x32_bf16 v[20:23], v[152:155], v[92:95], v[20:23]
v_fmac_f32 v63, v195, v182
v_cvt_pk_bf16_f32 v60, v60, v61
v_cvt_pk_bf16_f32 v61, v62, v63
v_mfma_f32_16x16x32_bf16 v[24:27], v[152:155], v[96:99], v[24:27]
ds_write_b64 v247, v[60:61] offset:29952
v_fmac_f32 v64, v192, v184
v_fmac_f32 v65, v193, v184
v_fmac_f32 v66, v194, v184
v_mfma_f32_16x16x32_bf16 v[28:31], v[152:155], v[100:103], v[28:31]
v_fmac_f32 v67, v195, v184
v_cvt_pk_bf16_f32 v64, v64, v65
v_cvt_pk_bf16_f32 v65, v66, v67
v_mfma_f32_16x16x32_bf16 v[8:11], v[164:167], v[128:131], v[8:11]
ds_write_b64 v247, v[64:65] offset:32256
v_fmac_f32 v68, v192, v186
v_fmac_f32 v69, v193, v186
v_fmac_f32 v70, v194, v186
v_mfma_f32_16x16x32_bf16 v[12:15], v[164:167], v[132:135], v[12:15]
v_fmac_f32 v71, v195, v186
v_cvt_pk_bf16_f32 v68, v68, v69
v_cvt_pk_bf16_f32 v69, v70, v71
v_mfma_f32_16x16x32_bf16 v[16:19], v[164:167], v[136:139], v[16:19]
ds_write_b64 v247, v[68:69] offset:34560
v_fmac_f32 v72, v192, v188
v_fmac_f32 v73, v193, v188
v_fmac_f32 v74, v194, v188
v_mfma_f32_16x16x32_bf16 v[20:23], v[164:167], v[140:143], v[20:23]
v_fmac_f32 v75, v195, v188
v_cvt_pk_bf16_f32 v72, v72, v73
v_cvt_pk_bf16_f32 v73, v74, v75
v_mfma_f32_16x16x32_bf16 v[24:27], v[164:167], v[144:147], v[24:27]
ds_write_b64 v247, v[72:73] offset:36864
v_fmac_f32 v76, v192, v190
v_fmac_f32 v77, v193, v190
v_fmac_f32 v78, v194, v190
v_mfma_f32_16x16x32_bf16 v[28:31], v[164:167], v[148:151], v[28:31]
v_fmac_f32 v79, v195, v190
v_cvt_pk_bf16_f32 v76, v76, v77
v_cvt_pk_bf16_f32 v77, v78, v79
ds_write_b64 v247, v[76:77] offset:39168
v_mov_b32_dpp v192, v8 row_newbcast:0 row_mask:0xf bank_mask:0xf
v_mov_b32_dpp v193, v9 row_newbcast:0 row_mask:0xf bank_mask:0xf
v_mov_b32_dpp v194, v10 row_newbcast:0 row_mask:0xf bank_mask:0xf
v_mov_b32_dpp v195, v11 row_newbcast:0 row_mask:0xf bank_mask:0xf
v_pk_fma_f32 v[8:9], v[192:193], v[180:181], v[8:9] op_sel_hi:[1,0,1]
v_pk_fma_f32 v[10:11], v[194:195], v[180:181], v[10:11] op_sel_hi:[1,0,1]
v_cvt_pk_bf16_f32 v8, v8, v9
v_cvt_pk_bf16_f32 v9, v10, v11
ds_write_b64 v247, v[8:9] offset:0
v_pk_fma_f32 v[12:13], v[192:193], v[182:183], v[12:13] op_sel_hi:[1,0,1]
v_pk_fma_f32 v[14:15], v[194:195], v[182:183], v[14:15] op_sel_hi:[1,0,1]
v_cvt_pk_bf16_f32 v12, v12, v13
v_cvt_pk_bf16_f32 v13, v14, v15
ds_write_b64 v247, v[12:13] offset:2304
v_pk_fma_f32 v[16:17], v[192:193], v[184:185], v[16:17] op_sel_hi:[1,0,1]
v_pk_fma_f32 v[18:19], v[194:195], v[184:185], v[18:19] op_sel_hi:[1,0,1]
v_cvt_pk_bf16_f32 v16, v16, v17
v_cvt_pk_bf16_f32 v17, v18, v19
ds_write_b64 v247, v[16:17] offset:4608
v_pk_fma_f32 v[20:21], v[192:193], v[186:187], v[20:21] op_sel_hi:[1,0,1]
v_pk_fma_f32 v[22:23], v[194:195], v[186:187], v[22:23] op_sel_hi:[1,0,1]
v_cvt_pk_bf16_f32 v20, v20, v21
v_cvt_pk_bf16_f32 v21, v22, v23
ds_write_b64 v247, v[20:21] offset:6912
v_pk_fma_f32 v[24:25], v[192:193], v[188:189], v[24:25] op_sel_hi:[1,0,1]
v_pk_fma_f32 v[26:27], v[194:195], v[188:189], v[26:27] op_sel_hi:[1,0,1]
v_cvt_pk_bf16_f32 v24, v24, v25
v_cvt_pk_bf16_f32 v25, v26, v27
ds_write_b64 v247, v[24:25] offset:9216
v_pk_fma_f32 v[28:29], v[192:193], v[190:191], v[28:29] op_sel_hi:[1,0,1]
v_pk_fma_f32 v[30:31], v[194:195], v[190:191], v[30:31] op_sel_hi:[1,0,1]
v_cvt_pk_bf16_f32 v28, v28, v29
v_cvt_pk_bf16_f32 v29, v30, v31
ds_write_b64 v247, v[28:29] offset:11520
s_waitcnt lgkmcnt(0)
s_barrier
s_cmp_lt_u32 s32, 2
s_cbranch_scc0 L_c23
ds_read_b64 v[108:109], v200 offset:0
ds_read_b64 v[110:111], v200 offset:1152
ds_read_b64 v[128:129], v204 offset:0
ds_read_b64 v[130:131], v205 offset:0
ds_read_b64 v[112:113], v200 offset:40
ds_read_b64 v[114:115], v200 offset:1192
ds_read_b64 v[132:133], v204 offset:40
ds_read_b64 v[134:135], v205 offset:40
ds_read_b64 v[104:105], v201 offset:0
ds_read_b64 v[106:107], v201 offset:1152
ds_read_b64 v[136:137], v212 offset:0
ds_read_b64 v[138:139], v213 offset:0
ds_read_b64 v[140:141], v214 offset:0
ds_read_b64 v[142:143], v215 offset:0
v_mov_b32 v176, 0
v_mov_b32 v177, 0
v_mov_b32 v178, 0
v_mov_b32 v179, 0
v_mov_b32 v180, 0
v_mov_b32 v181, 0
v_mov_b32 v182, 0
v_mov_b32 v183, 0
s_waitcnt lgkmcnt(10)
v_mfma_f32_16x16x32_bf16 v[160:163], v[108:111], v[128:131], 0
s_waitcnt lgkmcnt(6)
v_mfma_f32_16x16x32_bf16 v[164:167], v[112:115], v[132:135], 0
v_add_u32 v1, 128, v222
v_cndmask_b32 v4, v1, v222, s[44:45]
ds_read_b64 v[168:169], v4 offset:0
v_cndmask_b32 v4, v1, v222, s[46:47]
ds_read_b64 v[170:171], v4 offset:32
v_cndmask_b32 v4, v1, v222, s[48:49]
ds_read_b64 v[172:173], v4 offset:64
v_cndmask_b32 v4, v1, v222, s[50:51]
ds_read_b64 v[174:175], v4 offset:96
ds_read_b32 v5, v223 offset:0
s_waitcnt lgkmcnt(7)
v_mfma_f32_16x16x32_bf16 v[160:163], v[104:107], v[136:139], v[160:163]
s_waitcnt lgkmcnt(5)
v_mfma_f32_16x16x32_bf16 v[164:167], v[104:107], v[140:143], v[164:167]
s_nop 7
v_permlane16_swap_b32 v160, v164
v_permlane16_swap_b32 v161, v165
v_permlane16_swap_b32 v162, v166
v_permlane16_swap_b32 v163, v167
v_cndmask_b32 v196, v164, v160, s[44:45]
v_cndmask_b32 v197, v165, v161, s[46:47]
v_cndmask_b32 v198, v166, v162, s[48:49]
v_cndmask_b32 v199, v167, v163, s[50:51]
s_waitcnt lgkmcnt(0)
v_mul_f32 v5, 0x3ea52b5c, v5
v_fma_f32 v196, v196, v168, v169
v_fma_f32 v197, v197, v170, v171
v_fma_f32 v198, v198, v172, v173
v_fma_f32 v199, v199, v174, v175
v_max3_f32 v6, v196, v197, v198
v_max_f32 v6, v6, v199
v_mov_b32 v7, v6
s_nop 1
v_permlane32_swap_b32 v6, v7
v_max_f32 v6, v6, v7
v_mul_f32 v6, v6, v5
v_fma_f32 v196, v196, v5, -v6
v_fma_f32 v197, v197, v5, -v6
v_fma_f32 v198, v198, v5, -v6
v_fma_f32 v199, v199, v5, -v6
v_exp_f32 v196, v196
v_exp_f32 v197, v197
v_exp_f32 v198, v198
v_exp_f32 v199, v199
ds_read_b64_tr_b16 v[64:65], v216 offset:0
ds_read_b64_tr_b16 v[66:67], v216 offset:1152
ds_read_b64_tr_b16 v[68:69], v216 offset:40
ds_read_b64_tr_b16 v[70:71], v216 offset:1192
ds_read_b64_tr_b16 v[72:73], v217 offset:0
ds_read_b64_tr_b16 v[74:75], v217 offset:1152
ds_read_b64_tr_b16 v[76:77], v218 offset:0
ds_read_b64_tr_b16 v[78:79], v218 offset:1152
v_add_f32 v6, v196, v197
v_add_f32 v7, v198, v199
v_add_f32 v6, v6, v7
v_mov_b32 v7, v6
v_mul_f32 v196, v196, v168
v_mul_f32 v197, v197, v170
v_permlane32_swap_b32 v6, v7
v_mul_f32 v198, v198, v172
v_add_f32 v6, v6, v7
v_rcp_f32 v6, v6
v_mul_f32 v199, v199, v174
v_mul_f32 v196, v196, v6
v_mul_f32 v197, v197, v6
v_mul_f32 v198, v198, v6
v_mul_f32 v199, v199, v6
v_cvt_pk_bf16_f32 v196, v196, v197
v_cvt_pk_bf16_f32 v197, v198, v199
s_mov_b64 exec, s[52:53]
v_and_b32 v176, v220, v196
v_bfi_b32 v180, v220, 0, v196
v_and_b32 v177, v221, v197
v_bfi_b32 v181, v221, 0, v197
s_not_b64 exec, exec
v_and_b32 v178, v220, v196
v_bfi_b32 v182, v220, 0, v196
v_and_b32 v179, v221, v197
v_bfi_b32 v183, v221, 0, v197
s_mov_b64 exec, -1
v_permlane16_swap_b32 v176, v180
v_permlane16_swap_b32 v177, v181
v_permlane16_swap_b32 v178, v182
v_permlane16_swap_b32 v179, v183
s_waitcnt lgkmcnt(0)
s_nop 0
v_mfma_f32_16x16x32_bf16 v[152:155], v[64:67], v[176:179], 0
v_mfma_f32_16x16x32_bf16 v[156:159], v[68:71], v[180:183], 0
v_mfma_f32_16x16x32_bf16 v[160:163], v[72:75], v[176:179], 0
v_mfma_f32_16x16x32_bf16 v[164:167], v[76:79], v[180:183], 0
s_nop 4
v_cvt_pk_bf16_f32 v196, v152, v153
v_cvt_pk_bf16_f32 v197, v154, v155
v_cvt_pk_bf16_f32 v198, v156, v157
v_cvt_pk_bf16_f32 v199, v158, v159
s_cmp_eq_u32 s41, 1
s_cbranch_scc0 L_gl_19g
buffer_store_dwordx4 v[196:199], v226, s[20:23], 0 offen
L_gl_19b:
s_lshl_b32 s0, s32, 2
s_add_u32 s0, s0, 1752
v_mov_b32 v1, s0
ds_read_b32 v1, v1
v_cvt_pk_bf16_f32 v80, v160, v161
v_cvt_pk_bf16_f32 v81, v162, v163
v_cvt_pk_bf16_f32 v82, v164, v165
v_cvt_pk_bf16_f32 v83, v166, v167
s_waitcnt lgkmcnt(0)
v_cmp_eq_u32 vcc, 0, v1
s_cbranch_vccnz L_spr
L_sbr:
s_mov_b64 exec, 0xffff
s_cmp_eq_u32 s41, 1
s_cbranch_scc0 L_gl_20g
buffer_store_dwordx4 v[80:83], v226, s[20:23], s54 offen
L_gl_20b:
s_mov_b64 exec, -1
v_lshrrev_b32 v1, 4, v0
v_lshlrev_b32 v1, 3, v1
s_lshl_b32 s3, s36, 7
buffer_load_dwordx2 v[244:245], v1, s[28:31], s3 offen offset:0
buffer_load_dwordx2 v[246:247], v1, s[28:31], s3 offen offset:32
buffer_load_dwordx2 v[248:249], v1, s[28:31], s3 offen offset:64
buffer_load_dwordx2 v[250:251], v1, s[28:31], s3 offen offset:96
v_lshlrev_b32 v8, 16, v236
v_and_b32 v9, 0xffff0000, v236
v_lshlrev_b32 v10, 16, v237
v_and_b32 v11, 0xffff0000, v237
v_lshlrev_b32 v12, 16, v238
v_and_b32 v13, 0xffff0000, v238
v_lshlrev_b32 v14, 16, v239
v_and_b32 v15, 0xffff0000, v239
v_lshlrev_b32 v16, 16, v240
v_and_b32 v17, 0xffff0000, v240
v_lshlrev_b32 v18, 16, v241
v_and_b32 v19, 0xffff0000, v241
v_lshlrev_b32 v20, 16, v242
v_and_b32 v21, 0xffff0000, v242
v_lshlrev_b32 v22, 16, v243
v_and_b32 v23, 0xffff0000, v243
s_lshl_b32 s0, s32, 13
s_add_u32 s0, s0, 57344
v_add_u32 v4, s0, v233
s_lshl_b32 s0, s32, 2
s_add_u32 s0, s0, 1760
s_waitcnt vmcnt(0)
s_mov_b32 s3, 0x3f803f80
v_mov_b32 v236, s3
v_mov_b32 v237, s3
v_mov_b32 v238, s3
v_mov_b32 v239, s3
s_mov_b32 exec_lo, 0x11111111
s_mov_b32 exec_hi, 0x11111111
v_mov_b32 v244, s3
v_mov_b32 v245, s3
v_mov_b32 v246, s3
v_mov_b32 v247, s3
v_mov_b32 v248, s3
v_mov_b32 v249, s3
v_mov_b32 v250, s3
v_mov_b32 v251, s3
s_mov_b64 exec, -1
v_mfma_f32_16x16x32_bf16 v[252:255], v[244:247], v[236:239], 0
v_mfma_f32_16x16x32_bf16 v[252:255], v[248:251], v[236:239], v[252:255]
v_mov_b32 v2, s0
L_fx:
s_sleep 1
ds_read_b32 v1, v2
s_waitcnt lgkmcnt(0)
v_cmp_ne_u32 vcc, 2, v1
s_cbranch_vccnz L_fx
s_setprio 2
ds_read_b128 v[24:27], v4 offset:0
ds_read_b128 v[28:31], v4 offset:1024
ds_read_b128 v[32:35], v4 offset:2048
ds_read_b128 v[36:39], v4 offset:3072
ds_read_b128 v[40:43], v4 offset:4096
ds_read_b128 v[44:47], v4 offset:5120
ds_read_b128 v[48:51], v4 offset:6144
ds_read_b128 v[52:55], v4 offset:7168
s_waitcnt lgkmcnt(7)
v_add_f32 v8, v8, v24
v_add_f32 v9, v9, v25
v_add_f32 v10, v10, v26
v_add_f32 v11, v11, v27
s_waitcnt lgkmcnt(6)
v_add_f32 v12, v12, v28
v_add_f32 v13, v13, v29
v_add_f32 v14, v14, v30
v_add_f32 v15, v15, v31
s_waitcnt lgkmcnt(5)
v_add_f32 v16, v16, v32
v_add_f32 v17, v17, v33
v_add_f32 v18, v18, v34
v_add_f32 v19, v19, v35
s_waitcnt lgkmcnt(4)
v_add_f32 v20, v20, v36
v_add_f32 v21, v21, v37
v_add_f32 v22, v22, v38
v_add_f32 v23, v23, v39
s_waitcnt lgkmcnt(3)
v_add_f32 v8, v8, v40
v_add_f32 v9, v9, v41
v_add_f32 v10, v10, v42
v_add_f32 v11, v11, v43
s_waitcnt lgkmcnt(2)
v_add_f32 v12, v12, v44
v_add_f32 v13, v13, v45
v_add_f32 v14, v14, v46
v_add_f32 v15, v15, v47
s_waitcnt lgkmcnt(1)
v_add_f32 v16, v16, v48
v_add_f32 v17, v17, v49
v_add_f32 v18, v18, v50
v_add_f32 v19, v19, v51
s_waitcnt lgkmcnt(0)
v_add_f32 v20, v20, v52
v_add_f32 v21, v21, v53
v_add_f32 v22, v22, v54
v_add_f32 v23, v23, v55
s_branch L_tail
L_gl_19g:
buffer_store_dwordx4 v[196:199], v226, s[20:23], 0 offen sc1
s_branch L_gl_19b
L_spr:
s_sleep 1
v_mov_b32 v1, s0
ds_read_b32 v1, v1
s_waitcnt lgkmcnt(0)
v_cmp_eq_u32 vcc, 0, v1
s_cbranch_vccnz L_spr
s_branch L_sbr
L_gl_20g:
buffer_store_dwordx4 v[80:83], v226, s[20:23], s54 offen sc1
s_branch L_gl_20b
L_moe:
s_cmp_ge_u32 s34, 32
s_cbranch_scc1 L_end
s_lshr_b32 s32, s32, 6
v_and_b32 v0, 63, v0
s_lshl_b32 s36, s33, 1
s_add_u32 s36, s36, s34
s_sub_u32 s36, s36, 30
s_mov_b32 s40, 524288
v_lshlrev_b32 v6, 4, v0
v_mov_b32 v132, 0
v_mov_b32 v133, 0
v_mov_b32 v144, 0
s_waitcnt lgkmcnt(0)
s_mov_b64 s[16:17], s[66:67]
s_mov_b32 s18, 0x10000000
s_mov_b32 s19, 0x20000
s_mov_b64 s[24:25], s[64:65]
s_mov_b32 s26, 0x100
s_mov_b32 s27, 0x20000
s_mov_b64 s[4:5], s[54:55]
s_mov_b32 s6, 0x1e0000
s_mov_b32 s7, 0x20000
s_mov_b64 s[8:9], s[56:57]
s_mov_b32 s10, 0x1e0000
s_mov_b32 s11, 0x20000
s_mov_b64 s[12:13], s[60:61]
s_mov_b32 s14, 0x1e0000
s_mov_b32 s15, 0x20000
s_mov_b64 s[20:21], s[62:63]
s_mov_b32 s22, 0x280000
s_mov_b32 s23, 0x20000
v_mov_b32 v8, -1
v_mov_b32 v9, -1
v_mov_b32 v10, -1
v_mov_b32 v11, -1
s_lshl_b32 s0, s36, 14
s_lshl_b32 s3, s32, 11
s_add_u32 s0, s0, s3
s_add_u32 s0, s0, 3145728
buffer_store_dwordx4 v[8:11], v6, s[16:19], s0 offen offset:0 sc1
buffer_store_dwordx4 v[8:11], v6, s[16:19], s0 offen offset:1024 sc1
s_and_b32 s44, s36, 1
s_mul_i32 s0, s33, 384
s_lshl_b32 s1, s44, 8
s_add_u32 s1, s1, s0
s_mul_i32 s3, s32, 24576
s_add_u32 s1, s1, s3
v_lshrrev_b32 v1, 3, v0
v_mul_u32_u24 v1, 3072, v1
s_lshr_b32 s3, s32, 1
v_xor_b32 v2, s3, v0
v_and_b32 v2, 7, v2
v_lshl_add_u32 v1, v2, 4, v1
v_add_u32 v4, s1, v1
v_xor_b32 v5, 64, v4
s_lshl_b32 s1, s44, 6
s_add_u32 s0, s0, s1
s_and_b32 s3, s32, 3
s_mul_i32 s1, s3, 49152
s_add_u32 s0, s0, s1
s_add_u32 s0, s0, 128
v_lshrrev_b32 v1, 2, v0
v_mul_u32_u24 v1, 3072, v1
v_xor_b32 v2, s3, v0
v_and_b32 v2, 3, v2
v_lshl_add_u32 v1, v2, 4, v1
v_add_u32 v249, s0, v1
s_cmp_lt_u32 s32, 4
s_cselect_b64 s[28:29], s[4:5], s[8:9]
s_cselect_b32 s62, 0, 128
s_mov_b32 s30, 0x1e0000
s_mov_b32 s31, 0x20000
s_lshl_b32 s61, s32, 10
s_add_u32 s62, s62, s61
s_mul_i32 s44, s44, 983040
s_mul_i32 s46, s36, 122880
s_and_b32 s3, s36, 1
s_cselect_b32 s65, 40960, 0
s_cselect_b32 s66, 0, 81920
s_add_u32 s65, s65, s46
s_add_u32 s66, s66, s46
s_add_u32 s67, s65, 40960
s_cmp_lt_u32 s32, 5
s_cbranch_scc1 L_r0
s_add_u32 s45, s44, 0
s_add_u32 m0, s61, 0
s_nop 0
buffer_load_dwordx4 v4, s[4:7], s45 offen lds
s_add_u32 m0, s61, 8192
s_nop 0
buffer_load_dwordx4 v5, s[8:11], s45 offen lds
s_add_u32 s45, s44, 0
s_add_u32 m0, s62, 16384
s_nop 0
buffer_load_dwordx4 v249, s[28:31], s45 offen lds
s_waitcnt vmcnt(3)
s_barrier
s_branch L_r1
L_r0:
s_waitcnt vmcnt(0)
s_barrier
s_cmp_eq_u32 s32, 0
s_cbranch_scc0 L_nroot_26
s_lshl_b32 s0, s36, 4
v_mov_b32 v8, 1
s_mov_b64 exec, 1
buffer_store_dword v8, off, s[24:27], s0 sc1
s_mov_b64 exec, -1
L_nroot_26:
s_add_u32 s45, s44, 0
s_add_u32 m0, s61, 0
s_nop 0
buffer_load_dwordx4 v4, s[4:7], s45 offen lds
s_add_u32 m0, s61, 8192
s_nop 0
buffer_load_dwordx4 v5, s[8:11], s45 offen lds
s_add_u32 s45, s44, 0
s_add_u32 m0, s62, 16384
s_nop 0
buffer_load_dwordx4 v249, s[28:31], s45 offen lds
L_r1:
s_add_u32 s45, s44, 196608
s_add_u32 m0, s61, 42240
s_nop 0
buffer_load_dwordx4 v4, s[4:7], s45 offen lds
s_add_u32 m0, s61, 50432
s_nop 0
buffer_load_dwordx4 v5, s[8:11], s45 offen lds
s_add_u32 s45, s44, 196608
s_add_u32 m0, s62, 58624
s_nop 0
buffer_load_dwordx4 v249, s[28:31], s45 offen lds
v_lshrrev_b32 v1, 5, v0
v_bfe_u32 v2, v0, 2, 1
v_lshl_add_u32 v1, v1, 2, v2
v_bfe_u32 v2, v0, 4, 1
v_bfe_u32 v3, v0, 3, 1
v_lshl_add_u32 v3, v3, 1, v2
v_lshl_add_u32 v1, v3, 4, v1
v_xor_b32 v3, s32, v3
v_and_b32 v2, 1, v0
v_lshlrev_b32 v2, 3, v2
v_lshl_add_u32 v2, v3, 4, v2
v_bfe_u32 v3, v0, 1, 1
v_lshl_add_u32 v251, v1, 6, v2
v_mul_u32_u24 v8, 4224, v3
v_add_u32 v251, v251, v8
v_lshl_add_u32 v250, v1, 7, v2
v_mul_u32_u24 v8, 8256, v3
v_xor_b32 v250, v250, v8
v_mov_b32 v228, 0
v_mov_b32 v229, 0
v_mov_b32 v230, 0
v_mov_b32 v231, 0
v_mov_b32 v232, 0
v_mov_b32 v233, 0
v_mov_b32 v234, 0
v_mov_b32 v235, 0
v_mov_b32 v1, 0x4444
v_mov_b32 v2, 0xeeee
s_mov_b32 vcc_lo, 0xaaaaaaaa
s_mov_b32 vcc_hi, 0xaaaaaaaa
v_cndmask_b32 v7, v1, v2, vcc
v_and_b32 v1, 48, v0
v_and_b32 v2, 1, v0
v_lshlrev_b32 v2, 4, v2
v_lshl_add_u32 v252, v1, 1, v2
v_add_u32 v254, 126720, v252
v_add_u32 v252, 127232, v252
v_add_u32 v1, 126848, v1
v_mov_b32 v2, 126912
v_cndmask_b32 v255, v1, v2, vcc
v_mov_b32 v3, 0
v_lshl_add_u32 v2, v0, 2, v2
s_mov_b32 exec_hi, 0
ds_write_b32 v2, v3
s_mov_b64 exec, -1
s_and_b32 s0, s32, 4
s_add_u32 s0, s0, s32
v_bfe_u32 v1, v0, 4, 1
v_lshl_add_u32 v1, v1, 2, s0
v_lshrrev_b32 v2, 1, v1
v_lshlrev_b32 v2, 2, v2
v_and_or_b32 v2, v1, 1, v2
v_and_or_b32 v2, v0, 2, v2
v_bfe_u32 v3, v0, 2, 1
v_lshl_add_u32 v2, v2, 1, v3
v_and_b32 v3, 1, v0
v_lshl_add_u32 v2, v2, 1, v3
v_and_b32 v3, 7, v0
v_lshl_add_u32 v3, v1, 3, v3
v_cmp_gt_u32 vcc, 8, v1
s_nop 1
v_cndmask_b32 v2, v3, v2, vcc
v_lshlrev_b32 v2, 1, v2
v_add_u32 v253, 126720, v2
s_lshl_b32 s47, s32, 15
s_lshl_b32 s3, s36, 6
s_add_u32 s47, s47, s3
s_add_u32 s47, s47, 3162112
v_lshrrev_b32 v1, 2, v0
v_and_b32 v2, 3, v0
v_lshlrev_b32 v2, 4, v2
v_lshl_add_u32 v2, v1, 10, v2
v_lshlrev_b32 v1, 4, v1
v_add_u32 v1, 4032, v1
s_mov_b64 vcc, 0xffff
v_cndmask_b32 v246, v1, v2, vcc
s_cmp_lt_u32 s32, 4
s_cselect_b32 s50, 0x00ff0000, 0
s_or_b32 s50, s50, 0xff
s_mov_b32 s51, 0
s_sub_u32 s3, s32, 4
s_lshl_b32 s3, s3, 4
s_add_u32 s52, s3, s36
s_mul_i32 s3, s52, 52
s_lshr_b32 s3, s3, 8
s_mul_i32 s3, s3, 27648
s_lshl_b32 s53, s52, 10
s_add_u32 s53, s53, s3
s_add_u32 s53, s53, 3162112
s_mov_b32 s49, 131072
s_mov_b32 s63, 0
s_mul_i32 s3, s52, 52
s_lshr_b32 s3, s3, 8
s_mul_i32 s0, s3, 5
s_sub_u32 s0, s52, s0
s_mul_i32 s3, s3, 80
s_lshl_b32 s1, s0, 2
s_cmp_eq_u32 s0, 4
s_cselect_b32 s1, 64, s1
s_cselect_b32 s0, 0, 4
s_cselect_b32 s48, 2, 0
s_add_u32 s3, s3, s1
v_bfe_u32 v1, v0, 4, 1
v_lshrrev_b32 v2, 5, v0
v_lshl_add_u32 v1, v1, 1, v2
v_lshlrev_b32 v1, s0, v1
v_and_b32 v2, 3, v0
v_lshlrev_b32 v2, s48, v2
v_add3_u32 v1, v1, v2, s3
v_lshlrev_b32 v128, 1, v1
v_lshlrev_b32 v129, 2, v1
v_lshrrev_b32 v1, 4, v0
v_bfe_u32 v2, v0, 2, 2
v_lshl_add_u32 v1, v1, 3, v2
v_mul_u32_u24 v1, 1280, v1
v_and_b32 v3, 1, v0
v_lshl_add_u32 v1, v3, 3, v1
v_bfe_u32 v2, v0, 2, 3
v_lshlrev_b32 v2, 1, v2
v_bfe_u32 v3, v0, 1, 1
s_mul_i32 s0, s32, 10
s_add_u32 s3, s0, 0
v_add_u32 v236, s3, v3
v_xor_b32 v236, v236, v2
v_lshl_add_u32 v236, v236, 4, v1
s_add_u32 s3, s0, 2
v_add_u32 v237, s3, v3
v_xor_b32 v237, v237, v2
v_lshl_add_u32 v237, v237, 4, v1
s_add_u32 s3, s0, 4
v_add_u32 v238, s3, v3
v_xor_b32 v238, v238, v2
v_lshl_add_u32 v238, v238, 4, v1
s_add_u32 s3, s0, 6
v_add_u32 v239, s3, v3
v_xor_b32 v239, v239, v2
v_lshl_add_u32 v239, v239, 4, v1
s_add_u32 s3, s0, 8
v_add_u32 v240, s3, v3
v_xor_b32 v240, v240, v2
v_lshl_add_u32 v240, v240, 4, v1
s_waitcnt vmcnt(3) lgkmcnt(0)
s_barrier
s_add_u32 s45, s44, 393216
s_add_u32 m0, s61, 84480
s_nop 0
buffer_load_dwordx4 v4, s[4:7], s45 offen lds
s_add_u32 m0, s61, 92672
s_nop 0
buffer_load_dwordx4 v5, s[8:11], s45 offen lds
s_add_u32 s45, s44, 393216
s_add_u32 m0, s62, 100864
s_nop 0
buffer_load_dwordx4 v249, s[28:31], s45 offen lds
v_add_u32 v1, 0, v250
ds_read_b64_tr_b16 v[8:9], v1 offset:0
ds_read_b64_tr_b16 v[10:11], v1 offset:256
ds_read_b64_tr_b16 v[12:13], v1 offset:1024
ds_read_b64_tr_b16 v[14:15], v1 offset:1280
s_cmp_lt_u32 s32, 4
s_cbranch_scc0 L_g0
v_add_u32 v1, 16384, v251
ds_read_b64_tr_b16 v[88:89], v1 offset:0
ds_read_b64_tr_b16 v[90:91], v1 offset:128
ds_read_b64_tr_b16 v[92:93], v1 offset:512
ds_read_b64_tr_b16 v[94:95], v1 offset:640
L_g0:
s_waitcnt vmcnt(3) lgkmcnt(0)
s_barrier
s_add_u32 s45, s44, 589824
s_add_u32 m0, s61, 0
s_nop 0
buffer_load_dwordx4 v4, s[4:7], s45 offen lds
s_add_u32 m0, s61, 8192
s_nop 0
buffer_load_dwordx4 v5, s[8:11], s45 offen lds
s_add_u32 s45, s44, 589824
s_add_u32 m0, s62, 16384
s_nop 0
buffer_load_dwordx4 v249, s[28:31], s45 offen lds
v_add_u32 v1, 42240, v250
ds_read_b64_tr_b16 v[16:17], v1 offset:0
ds_read_b64_tr_b16 v[18:19], v1 offset:256
ds_read_b64_tr_b16 v[20:21], v1 offset:1024
ds_read_b64_tr_b16 v[22:23], v1 offset:1280
s_cmp_lt_u32 s32, 4
s_cbranch_scc0 L_g1
v_add_u32 v1, 58624, v251
ds_read_b64_tr_b16 v[96:97], v1 offset:0
ds_read_b64_tr_b16 v[98:99], v1 offset:128
ds_read_b64_tr_b16 v[100:101], v1 offset:512
ds_read_b64_tr_b16 v[102:103], v1 offset:640
L_g1:
s_waitcnt vmcnt(3) lgkmcnt(0)
s_barrier
s_add_u32 s45, s44, 786432
s_add_u32 m0, s61, 42240
s_nop 0
buffer_load_dwordx4 v4, s[4:7], s45 offen lds
s_add_u32 m0, s61, 50432
s_nop 0
buffer_load_dwordx4 v5, s[8:11], s45 offen lds
s_add_u32 s45, s44, 786432
s_add_u32 m0, s62, 58624
s_nop 0
buffer_load_dwordx4 v249, s[28:31], s45 offen lds
v_add_u32 v1, 84480, v250
ds_read_b64_tr_b16 v[24:25], v1 offset:0
ds_read_b64_tr_b16 v[26:27], v1 offset:256
ds_read_b64_tr_b16 v[28:29], v1 offset:1024
ds_read_b64_tr_b16 v[30:31], v1 offset:1280
s_cmp_lt_u32 s32, 4
s_cbranch_scc0 L_g2
v_add_u32 v1, 100864, v251
ds_read_b64_tr_b16 v[104:105], v1 offset:0
ds_read_b64_tr_b16 v[106:107], v1 offset:128
ds_read_b64_tr_b16 v[108:109], v1 offset:512
ds_read_b64_tr_b16 v[110:111], v1 offset:640
L_g2:
s_waitcnt vmcnt(3) lgkmcnt(0)
s_barrier
s_sub_u32 s45, 983040, s44
s_add_u32 m0, s61, 84480
s_nop 0
buffer_load_dwordx4 v4, s[4:7], s45 offen lds
s_add_u32 m0, s61, 92672
s_nop 0
buffer_load_dwordx4 v5, s[8:11], s45 offen lds
s_sub_u32 s45, 1179648, s44
s_add_u32 m0, s61, 100864
s_nop 0
buffer_load_dwordx4 v4, s[4:7], s45 offen lds
s_add_u32 m0, s61, 109056
s_nop 0
buffer_load_dwordx4 v5, s[8:11], s45 offen lds
v_add_u32 v1, 0, v250
ds_read_b64_tr_b16 v[32:33], v1 offset:0
ds_read_b64_tr_b16 v[34:35], v1 offset:256
ds_read_b64_tr_b16 v[36:37], v1 offset:1024
ds_read_b64_tr_b16 v[38:39], v1 offset:1280
s_cmp_lt_u32 s32, 4
s_cbranch_scc0 L_g3
v_add_u32 v1, 16384, v251
ds_read_b64_tr_b16 v[112:113], v1 offset:0
ds_read_b64_tr_b16 v[114:115], v1 offset:128
ds_read_b64_tr_b16 v[116:117], v1 offset:512
ds_read_b64_tr_b16 v[118:119], v1 offset:640
L_g3:
s_waitcnt vmcnt(4) lgkmcnt(0)
s_barrier
s_sub_u32 s45, 1376256, s44
s_add_u32 m0, s61, 0
s_nop 0
buffer_load_dwordx4 v4, s[4:7], s45 offen lds
s_add_u32 m0, s61, 8192
s_nop 0
buffer_load_dwordx4 v5, s[8:11], s45 offen lds
s_sub_u32 s45, 1572864, s44
s_add_u32 m0, s61, 16384
s_nop 0
buffer_load_dwordx4 v4, s[4:7], s45 offen lds
s_add_u32 m0, s61, 24576
s_nop 0
buffer_load_dwordx4 v5, s[8:11], s45 offen lds
v_add_u32 v1, 42240, v250
ds_read_b64_tr_b16 v[40:41], v1 offset:0
ds_read_b64_tr_b16 v[42:43], v1 offset:256
ds_read_b64_tr_b16 v[44:45], v1 offset:1024
ds_read_b64_tr_b16 v[46:47], v1 offset:1280
s_cmp_lt_u32 s32, 4
s_cbranch_scc0 L_g4
v_add_u32 v1, 58624, v251
ds_read_b64_tr_b16 v[120:121], v1 offset:0
ds_read_b64_tr_b16 v[122:123], v1 offset:128
ds_read_b64_tr_b16 v[124:125], v1 offset:512
ds_read_b64_tr_b16 v[126:127], v1 offset:640
L_g4:
s_waitcnt vmcnt(4) lgkmcnt(0)
s_barrier
s_sub_u32 s45, 1769472, s44
s_add_u32 m0, s61, 42240
s_nop 0
buffer_load_dwordx4 v4, s[4:7], s45 offen lds
s_add_u32 m0, s61, 50432
s_nop 0
buffer_load_dwordx4 v5, s[8:11], s45 offen lds
v_add_u32 v1, 84480, v250
ds_read_b64_tr_b16 v[48:49], v1 offset:0
ds_read_b64_tr_b16 v[50:51], v1 offset:256
ds_read_b64_tr_b16 v[52:53], v1 offset:1024
ds_read_b64_tr_b16 v[54:55], v1 offset:1280
v_add_u32 v1, 100864, v250
ds_read_b64_tr_b16 v[56:57], v1 offset:0
ds_read_b64_tr_b16 v[58:59], v1 offset:256
ds_read_b64_tr_b16 v[60:61], v1 offset:1024
ds_read_b64_tr_b16 v[62:63], v1 offset:1280
v_and_b32 v248, 0xf0, v6
buffer_load_dword v247, v248, s[24:27], 0 offen sc1
s_waitcnt vmcnt(3) lgkmcnt(0)
s_barrier
s_lshl_b32 s3, s32, 6
s_addk_i32 s3, 0
v_add_u32 v1, s3, v0
v_mul_u32_u24 v2, 52429, v1
v_lshrrev_b32 v2, 22, v2
v_and_b32 v3, 3, v2
v_lshlrev_b32 v3, 1, v3
v_and_or_b32 v3, v2, 8, v3
v_xor_b32 v1, v1, v3
v_lshlrev_b32 v1, 4, v1
s_add_u32 m0, s61, 84480
s_nop 0
buffer_load_dwordx4 v1, s[12:15], s65 offen lds
s_lshl_b32 s3, s32, 6
s_addk_i32 s3, 512
v_add_u32 v1, s3, v0
v_mul_u32_u24 v2, 52429, v1
v_lshrrev_b32 v2, 22, v2
v_and_b32 v3, 3, v2
v_lshlrev_b32 v3, 1, v3
v_and_or_b32 v3, v2, 8, v3
v_xor_b32 v1, v1, v3
v_lshlrev_b32 v1, 4, v1
s_add_u32 m0, s61, 92672
s_nop 0
buffer_load_dwordx4 v1, s[12:15], s65 offen lds
s_lshl_b32 s3, s32, 6
s_addk_i32 s3, 1024
v_add_u32 v1, s3, v0
v_mul_u32_u24 v2, 52429, v1
v_lshrrev_b32 v2, 22, v2
v_and_b32 v3, 3, v2
v_lshlrev_b32 v3, 1, v3
v_and_or_b32 v3, v2, 8, v3
v_xor_b32 v1, v1, v3
v_lshlrev_b32 v1, 4, v1
s_add_u32 m0, s61, 100864
s_nop 0
buffer_load_dwordx4 v1, s[12:15], s65 offen lds
s_lshl_b32 s3, s32, 6
s_addk_i32 s3, 1536
v_add_u32 v1, s3, v0
v_mul_u32_u24 v2, 52429, v1
v_lshrrev_b32 v2, 22, v2
v_and_b32 v3, 3, v2
v_lshlrev_b32 v3, 1, v3
v_and_or_b32 v3, v2, 8, v3
v_xor_b32 v1, v1, v3
v_lshlrev_b32 v1, 4, v1
s_add_u32 m0, s61, 109056
s_nop 0
buffer_load_dwordx4 v1, s[12:15], s65 offen lds
s_lshl_b32 s3, s32, 6
s_addk_i32 s3, 2048
v_add_u32 v1, s3, v0
v_mul_u32_u24 v2, 52429, v1
v_lshrrev_b32 v2, 22, v2
v_and_b32 v3, 3, v2
v_lshlrev_b32 v3, 1, v3
v_and_or_b32 v3, v2, 8, v3
v_xor_b32 v1, v1, v3
v_lshlrev_b32 v1, 4, v1
s_add_u32 m0, s61, 117248
s_nop 0
buffer_load_dwordx4 v1, s[12:15], s65 offen lds
v_add_u32 v1, 0, v250
ds_read_b64_tr_b16 v[64:65], v1 offset:0
ds_read_b64_tr_b16 v[66:67], v1 offset:256
ds_read_b64_tr_b16 v[68:69], v1 offset:1024
ds_read_b64_tr_b16 v[70:71], v1 offset:1280
v_add_u32 v1, 16384, v250
ds_read_b64_tr_b16 v[72:73], v1 offset:0
ds_read_b64_tr_b16 v[74:75], v1 offset:256
ds_read_b64_tr_b16 v[76:77], v1 offset:1024
ds_read_b64_tr_b16 v[78:79], v1 offset:1280
s_waitcnt vmcnt(5) lgkmcnt(0)
s_barrier
s_lshl_b32 s3, s32, 6
s_addk_i32 s3, 0
v_add_u32 v1, s3, v0
v_mul_u32_u24 v2, 52429, v1
v_lshrrev_b32 v2, 22, v2
v_and_b32 v3, 3, v2
v_lshlrev_b32 v3, 1, v3
v_and_or_b32 v3, v2, 8, v3
v_xor_b32 v1, v1, v3
v_lshlrev_b32 v1, 4, v1
s_add_u32 m0, s61, 0
s_nop 0
buffer_load_dwordx4 v1, s[12:15], s66 offen lds
s_lshl_b32 s3, s32, 6
s_addk_i32 s3, 512
v_add_u32 v1, s3, v0
v_mul_u32_u24 v2, 52429, v1
v_lshrrev_b32 v2, 22, v2
v_and_b32 v3, 3, v2
v_lshlrev_b32 v3, 1, v3
v_and_or_b32 v3, v2, 8, v3
v_xor_b32 v1, v1, v3
v_lshlrev_b32 v1, 4, v1
s_add_u32 m0, s61, 8192
s_nop 0
buffer_load_dwordx4 v1, s[12:15], s66 offen lds
s_lshl_b32 s3, s32, 6
s_addk_i32 s3, 1024
v_add_u32 v1, s3, v0
v_mul_u32_u24 v2, 52429, v1
v_lshrrev_b32 v2, 22, v2
v_and_b32 v3, 3, v2
v_lshlrev_b32 v3, 1, v3
v_and_or_b32 v3, v2, 8, v3
v_xor_b32 v1, v1, v3
v_lshlrev_b32 v1, 4, v1
s_add_u32 m0, s61, 16384
s_nop 0
buffer_load_dwordx4 v1, s[12:15], s66 offen lds
s_lshl_b32 s3, s32, 6
s_addk_i32 s3, 1536
v_add_u32 v1, s3, v0
v_mul_u32_u24 v2, 52429, v1
v_lshrrev_b32 v2, 22, v2
v_and_b32 v3, 3, v2
v_lshlrev_b32 v3, 1, v3
v_and_or_b32 v3, v2, 8, v3
v_xor_b32 v1, v1, v3
v_lshlrev_b32 v1, 4, v1
s_add_u32 m0, s61, 24576
s_nop 0
buffer_load_dwordx4 v1, s[12:15], s66 offen lds
s_lshl_b32 s3, s32, 6
s_addk_i32 s3, 2048
v_add_u32 v1, s3, v0
v_mul_u32_u24 v2, 52429, v1
v_lshrrev_b32 v2, 22, v2
v_and_b32 v3, 3, v2
v_lshlrev_b32 v3, 1, v3
v_and_or_b32 v3, v2, 8, v3
v_xor_b32 v1, v1, v3
v_lshlrev_b32 v1, 4, v1
s_add_u32 m0, s61, 32768
s_nop 0
buffer_load_dwordx4 v1, s[12:15], s66 offen lds
v_add_u32 v1, 42240, v250
ds_read_b64_tr_b16 v[80:81], v1 offset:0
ds_read_b64_tr_b16 v[82:83], v1 offset:256
ds_read_b64_tr_b16 v[84:85], v1 offset:1024
ds_read_b64_tr_b16 v[86:87], v1 offset:1280
s_waitcnt vmcnt(5) lgkmcnt(0)
s_barrier
s_lshl_b32 s3, s32, 6
s_addk_i32 s3, 0
v_add_u32 v1, s3, v0
v_mul_u32_u24 v2, 52429, v1
v_lshrrev_b32 v2, 22, v2
v_and_b32 v3, 3, v2
v_lshlrev_b32 v3, 1, v3
v_and_or_b32 v3, v2, 8, v3
v_xor_b32 v1, v1, v3
v_lshlrev_b32 v1, 4, v1
s_add_u32 m0, s61, 42240
s_nop 0
buffer_load_dwordx4 v1, s[12:15], s67 offen lds
s_lshl_b32 s3, s32, 6
s_addk_i32 s3, 512
v_add_u32 v1, s3, v0
v_mul_u32_u24 v2, 52429, v1
v_lshrrev_b32 v2, 22, v2
v_and_b32 v3, 3, v2
v_lshlrev_b32 v3, 1, v3
v_and_or_b32 v3, v2, 8, v3
v_xor_b32 v1, v1, v3
v_lshlrev_b32 v1, 4, v1
s_add_u32 m0, s61, 50432
s_nop 0
buffer_load_dwordx4 v1, s[12:15], s67 offen lds
s_lshl_b32 s3, s32, 6
s_addk_i32 s3, 1024
v_add_u32 v1, s3, v0
v_mul_u32_u24 v2, 52429, v1
v_lshrrev_b32 v2, 22, v2
v_and_b32 v3, 3, v2
v_lshlrev_b32 v3, 1, v3
v_and_or_b32 v3, v2, 8, v3
v_xor_b32 v1, v1, v3
v_lshlrev_b32 v1, 4, v1
s_add_u32 m0, s61, 58624
s_nop 0
buffer_load_dwordx4 v1, s[12:15], s67 offen lds
s_lshl_b32 s3, s32, 6
s_addk_i32 s3, 1536
v_add_u32 v1, s3, v0
v_mul_u32_u24 v2, 52429, v1
v_lshrrev_b32 v2, 22, v2
v_and_b32 v3, 3, v2
v_lshlrev_b32 v3, 1, v3
v_and_or_b32 v3, v2, 8, v3
v_xor_b32 v1, v1, v3
v_lshlrev_b32 v1, 4, v1
s_add_u32 m0, s61, 66816
s_nop 0
buffer_load_dwordx4 v1, s[12:15], s67 offen lds
s_lshl_b32 s3, s32, 6
s_addk_i32 s3, 2048
v_add_u32 v1, s3, v0
v_mul_u32_u24 v2, 52429, v1
v_lshrrev_b32 v2, 22, v2
v_and_b32 v3, 3, v2
v_lshlrev_b32 v3, 1, v3
v_and_or_b32 v3, v2, 8, v3
v_xor_b32 v1, v1, v3
v_lshlrev_b32 v1, 4, v1
s_add_u32 m0, s61, 75008
s_nop 0
buffer_load_dwordx4 v1, s[12:15], s67 offen lds
v_add_u32 v1, 84480, v236
ds_read_b64_tr_b16 v[168:169], v1 offset:0
ds_read_b64_tr_b16 v[170:171], v1 offset:5120
v_add_u32 v1, 84480, v237
ds_read_b64_tr_b16 v[180:181], v1 offset:0
ds_read_b64_tr_b16 v[182:183], v1 offset:5120
v_add_u32 v1, 84480, v238
ds_read_b64_tr_b16 v[192:193], v1 offset:0
ds_read_b64_tr_b16 v[194:195], v1 offset:5120
v_add_u32 v1, 84480, v239
ds_read_b64_tr_b16 v[204:205], v1 offset:0
ds_read_b64_tr_b16 v[206:207], v1 offset:5120
v_add_u32 v1, 84480, v240
ds_read_b64_tr_b16 v[216:217], v1 offset:0
ds_read_b64_tr_b16 v[218:219], v1 offset:5120
s_waitcnt vmcnt(5) lgkmcnt(0)
s_barrier
s_sub_u32 s45, 983040, s44
s_add_u32 m0, s62, 84480
s_nop 0
buffer_load_dwordx4 v249, s[28:31], s45 offen lds
s_sub_u32 s45, 1179648, s44
s_add_u32 m0, s62, 92928
s_nop 0
buffer_load_dwordx4 v249, s[28:31], s45 offen lds
s_sub_u32 s45, 1376256, s44
s_add_u32 m0, s62, 101376
s_nop 0
buffer_load_dwordx4 v249, s[28:31], s45 offen lds
s_sub_u32 s45, 1572864, s44
s_add_u32 m0, s62, 109824
s_nop 0
buffer_load_dwordx4 v249, s[28:31], s45 offen lds
s_sub_u32 s45, 1769472, s44
s_add_u32 m0, s62, 118272
s_nop 0
buffer_load_dwordx4 v249, s[28:31], s45 offen lds
v_add_u32 v1, 0, v236
ds_read_b64_tr_b16 v[172:173], v1 offset:0
ds_read_b64_tr_b16 v[174:175], v1 offset:5120
v_add_u32 v1, 0, v237
ds_read_b64_tr_b16 v[184:185], v1 offset:0
ds_read_b64_tr_b16 v[186:187], v1 offset:5120
v_add_u32 v1, 0, v238
ds_read_b64_tr_b16 v[196:197], v1 offset:0
ds_read_b64_tr_b16 v[198:199], v1 offset:5120
v_add_u32 v1, 0, v239
ds_read_b64_tr_b16 v[208:209], v1 offset:0
ds_read_b64_tr_b16 v[210:211], v1 offset:5120
v_add_u32 v1, 0, v240
ds_read_b64_tr_b16 v[220:221], v1 offset:0
ds_read_b64_tr_b16 v[222:223], v1 offset:5120
s_waitcnt vmcnt(5) lgkmcnt(0)
s_barrier
v_add_u32 v1, 42240, v236
ds_read_b64_tr_b16 v[176:177], v1 offset:0
ds_read_b64_tr_b16 v[178:179], v1 offset:5120
v_add_u32 v1, 42240, v237
ds_read_b64_tr_b16 v[188:189], v1 offset:0
ds_read_b64_tr_b16 v[190:191], v1 offset:5120
v_add_u32 v1, 42240, v238
ds_read_b64_tr_b16 v[200:201], v1 offset:0
ds_read_b64_tr_b16 v[202:203], v1 offset:5120
v_add_u32 v1, 42240, v239
ds_read_b64_tr_b16 v[212:213], v1 offset:0
ds_read_b64_tr_b16 v[214:215], v1 offset:5120
v_add_u32 v1, 42240, v240
ds_read_b64_tr_b16 v[224:225], v1 offset:0
ds_read_b64_tr_b16 v[226:227], v1 offset:5120
s_waitcnt vmcnt(0) lgkmcnt(0)
s_barrier
s_cmp_lt_u32 s32, 4
s_cbranch_scc0 L_g11
v_add_u32 v1, 84480, v251
ds_read_b64_tr_b16 v[128:129], v1 offset:0
ds_read_b64_tr_b16 v[130:131], v1 offset:128
ds_read_b64_tr_b16 v[132:133], v1 offset:512
ds_read_b64_tr_b16 v[134:135], v1 offset:640
v_add_u32 v1, 92928, v251
ds_read_b64_tr_b16 v[136:137], v1 offset:0
ds_read_b64_tr_b16 v[138:139], v1 offset:128
ds_read_b64_tr_b16 v[140:141], v1 offset:512
ds_read_b64_tr_b16 v[142:143], v1 offset:640
v_add_u32 v1, 101376, v251
ds_read_b64_tr_b16 v[144:145], v1 offset:0
ds_read_b64_tr_b16 v[146:147], v1 offset:128
ds_read_b64_tr_b16 v[148:149], v1 offset:512
ds_read_b64_tr_b16 v[150:151], v1 offset:640
v_add_u32 v1, 109824, v251
ds_read_b64_tr_b16 v[152:153], v1 offset:0
ds_read_b64_tr_b16 v[154:155], v1 offset:128
ds_read_b64_tr_b16 v[156:157], v1 offset:512
ds_read_b64_tr_b16 v[158:159], v1 offset:640
v_add_u32 v1, 118272, v251
ds_read_b64_tr_b16 v[160:161], v1 offset:0
ds_read_b64_tr_b16 v[162:163], v1 offset:128
ds_read_b64_tr_b16 v[164:165], v1 offset:512
ds_read_b64_tr_b16 v[166:167], v1 offset:640
L_g11:
s_branch L_pb_27
.p2align 12
L_pb_27:
s_call_b64 s[100:101], L_pad_28
s_call_b64 s[100:101], L_pad_29
s_call_b64 s[100:101], L_pad_30
s_call_b64 s[100:101], L_pad_31
v_mov_b32 v5, v246
v_mov_b32 v4, 126976
s_mov_b32 s61, 0
s_cmp_lt_u32 s32, 7
s_cbranch_scc1 L_np
L_rt:
v_cmp_ne_u32 vcc, 1, v247
s_cbranch_vccz L_rtg
buffer_load_dword v247, v248, s[24:27], 0 offen sc1
s_waitcnt vmcnt(0)
s_sub_u32 s40, s40, 1
s_cbranch_scc0 L_rt
s_mov_b32 s40, 0
L_rtg:
v_bfe_u32 v1, v0, 2, 3
v_lshlrev_b32 v1, 15, v1
v_and_b32 v2, 3, v0
v_min_u32 v2, 2, v2
v_mul_u32_u24 v3, 1280, v2
s_mov_b32 s0, 3145728
v_add3_u32 v147, v3, v1, s0
v_lshl_add_u32 v144, v2, 7, v1
s_mul_i32 s0, s36, 384
s_add_u32 s64, s0, 3167232
s_and_b32 s3, s36, 1
s_mul_i32 s3, s3, 640
v_add_u32 v132, s3, v6
v_subrev_u32 v2, 1280, v132
v_min_u32 v132, v132, v2
s_sub_u32 s3, 1024, s3
v_add_u32 v133, s3, v6
s_mov_b32 s54, 0
s_mov_b32 s55, 0x80000000
s_mov_b32 s60, 1073741824
s_setprio 3
v_mov_b32 v140, -1
v_mov_b32 v141, -1
v_mov_b32 v142, -1
s_mov_b32 m0, 127232
s_mov_b64 exec, -1
buffer_load_dwordx4 v132, s[16:19], s55 offen sc1 lds
s_mov_b32 m0, 128256
s_mov_b64 exec, 0xffff
buffer_load_dwordx4 v133, s[16:19], s55 offen sc1 lds
s_mov_b64 exec, 0x77777777
buffer_atomic_umin v140, v144, s[16:19], s64 offen sc0 sc1
s_sleep 2
s_mov_b32 m0, 127232
s_mov_b64 exec, -1
buffer_load_dwordx4 v132, s[16:19], s55 offen sc1 lds
s_mov_b32 m0, 128256
s_mov_b64 exec, 0xffff
buffer_load_dwordx4 v133, s[16:19], s55 offen sc1 lds
s_mov_b64 exec, 0x77777777
buffer_atomic_umin v141, v144, s[16:19], s64 offen sc0 sc1
s_sleep 2
L_pl0:
s_mov_b32 m0, 127232
s_mov_b64 exec, -1
s_nop 0
buffer_load_dwordx4 v132, s[16:19], s55 offen sc1 lds
s_mov_b32 m0, 128256
s_mov_b64 exec, 0xffff
buffer_load_dwordx4 v133, s[16:19], s55 offen sc1 lds
s_mov_b64 exec, 0x77777777
buffer_atomic_umin v142, v144, s[16:19], s64 offen sc0 sc1
s_waitcnt vmcnt(6)
v_cmp_lt_u32 vcc, s54, v140
s_sub_u32 s60, s60, 1
s_cbranch_vccz L_pw
s_cselect_b32 s0, s61, 1
s_max_i32 s60, s60, 0
v_cmp_eq_u32 s[58:59], -1, v140
v_mov_b32 v146, v140
s_andn2_b64 vcc, vcc, s[58:59]
s_cbranch_scc0 L_pq0
s_mov_b64 exec, -1
v_cndmask_b32 v146, 0, v146, vcc
s_lshl_b32 s61, s61, 1
s_nop 0
v_max_u32_dpp v236, v146, v146 row_ror:8 row_mask:0xf bank_mask:0xf
s_nop 1
v_max_u32_dpp v236, v236, v236 row_ror:4 row_mask:0xf bank_mask:0xf
s_nop 1
v_max_u32_dpp v236, v236, v236 row_ror:2 row_mask:0xf bank_mask:0xf
s_nop 1
v_max_u32_dpp v236, v236, v236 row_ror:1 row_mask:0xf bank_mask:0xf
v_mov_b32 v237, v236
s_mov_b32 s60, 2
s_nop 0
v_permlane16_swap_b32 v236, v237
v_max_u32 v236, v236, v237
s_mov_b32 exec_hi, 0
v_cmpx_eq_u32 vcc, v236, v146
ds_write_b64 v4, v[146:147]
s_nop 2
v_readfirstlane_b32 s55, v147
v_readfirstlane_b32 s54, v146
s_branch L_pl1
L_pq0:
s_sleep 2
L_pl1:
s_mov_b32 m0, 127232
s_mov_b64 exec, -1
s_nop 0
buffer_load_dwordx4 v132, s[16:19], s55 offen sc1 lds
s_mov_b32 m0, 128256
s_mov_b64 exec, 0xffff
buffer_load_dwordx4 v133, s[16:19], s55 offen sc1 lds
s_mov_b64 exec, 0x77777777
buffer_atomic_umin v140, v144, s[16:19], s64 offen sc0 sc1
s_waitcnt vmcnt(6)
v_cmp_lt_u32 vcc, s54, v141
s_sub_u32 s60, s60, 1
s_cbranch_vccz L_pw
s_cselect_b32 s0, s61, 1
s_max_i32 s60, s60, 0
v_cmp_eq_u32 s[58:59], -1, v141
v_mov_b32 v146, v141
s_andn2_b64 vcc, vcc, s[58:59]
s_cbranch_scc0 L_pq1
s_mov_b64 exec, -1
v_cndmask_b32 v146, 0, v146, vcc
s_lshl_b32 s61, s61, 1
s_nop 0
v_max_u32_dpp v236, v146, v146 row_ror:8 row_mask:0xf bank_mask:0xf
s_nop 1
v_max_u32_dpp v236, v236, v236 row_ror:4 row_mask:0xf bank_mask:0xf
s_nop 1
v_max_u32_dpp v236, v236, v236 row_ror:2 row_mask:0xf bank_mask:0xf
s_nop 1
v_max_u32_dpp v236, v236, v236 row_ror:1 row_mask:0xf bank_mask:0xf
v_mov_b32 v237, v236
s_mov_b32 s60, 2
s_nop 0
v_permlane16_swap_b32 v236, v237
v_max_u32 v236, v236, v237
s_mov_b32 exec_hi, 0
v_cmpx_eq_u32 vcc, v236, v146
ds_write_b64 v4, v[146:147]
s_nop 2
v_readfirstlane_b32 s55, v147
v_readfirstlane_b32 s54, v146
s_branch L_pl2
L_pq1:
s_sleep 2
L_pl2:
s_mov_b32 m0, 127232
s_mov_b64 exec, -1
s_nop 0
buffer_load_dwordx4 v132, s[16:19], s55 offen sc1 lds
s_mov_b32 m0, 128256
s_mov_b64 exec, 0xffff
buffer_load_dwordx4 v133, s[16:19], s55 offen sc1 lds
s_mov_b64 exec, 0x77777777
buffer_atomic_umin v141, v144, s[16:19], s64 offen sc0 sc1
s_waitcnt vmcnt(6)
v_cmp_lt_u32 vcc, s54, v142
s_sub_u32 s60, s60, 1
s_cbranch_vccz L_pw
s_cselect_b32 s0, s61, 1
s_max_i32 s60, s60, 0
v_cmp_eq_u32 s[58:59], -1, v142
v_mov_b32 v146, v142
s_andn2_b64 vcc, vcc, s[58:59]
s_cbranch_scc0 L_pq2
s_mov_b64 exec, -1
v_cndmask_b32 v146, 0, v146, vcc
s_lshl_b32 s61, s61, 1
s_nop 0
v_max_u32_dpp v236, v146, v146 row_ror:8 row_mask:0xf bank_mask:0xf
s_nop 1
v_max_u32_dpp v236, v236, v236 row_ror:4 row_mask:0xf bank_mask:0xf
s_nop 1
v_max_u32_dpp v236, v236, v236 row_ror:2 row_mask:0xf bank_mask:0xf
s_nop 1
v_max_u32_dpp v236, v236, v236 row_ror:1 row_mask:0xf bank_mask:0xf
v_mov_b32 v237, v236
s_mov_b32 s60, 2
s_nop 0
v_permlane16_swap_b32 v236, v237
v_max_u32 v236, v236, v237
s_mov_b32 exec_hi, 0
v_cmpx_eq_u32 vcc, v236, v146
ds_write_b64 v4, v[146:147]
s_nop 2
v_readfirstlane_b32 s55, v147
v_readfirstlane_b32 s54, v146
s_branch L_pl0
L_pq2:
s_sleep 2
s_sub_u32 s40, s40, 1
s_cbranch_scc0 L_pl0
s_mov_b32 s40, 0
s_waitcnt vmcnt(0)
s_cmp_eq_u32 s0, s0
L_pw:
s_cbranch_scc0 L_pv
s_branch L_pg
L_pv:
s_cmp_eq_u32 s60, 0
s_waitcnt vmcnt(4)
s_cbranch_scc1 L_pg
s_cmp_eq_u32 s60, 1
s_waitcnt vmcnt(1)
s_branch L_pg
L_xf:
s_mov_b32 m0, 127232
s_mov_b64 exec, -1
buffer_load_dwordx4 v132, s[16:19], s55 offen sc1 lds
s_mov_b32 m0, 128256
s_mov_b64 exec, 0xffff
buffer_load_dwordx4 v133, s[16:19], s55 offen sc1 lds
s_waitcnt vmcnt(0)
L_pg:
s_mov_b64 exec, -1
L_np:
s_waitcnt lgkmcnt(0)
s_barrier
s_cmp_lt_u32 s32, 4
s_cbranch_scc1 L_xh
ds_read_b64 v[2:3], v4
ds_read_b128 v[88:91], v252 offset:0
ds_read_b128 v[92:95], v252 offset:128
ds_read_b128 v[96:99], v252 offset:256
ds_read_b128 v[100:103], v252 offset:384
ds_read_b128 v[104:107], v252 offset:512
ds_read_b128 v[108:111], v252 offset:640
ds_read_b128 v[112:115], v252 offset:768
ds_read_b128 v[116:119], v252 offset:896
ds_read_b128 v[120:123], v252 offset:1024
ds_read_b128 v[124:127], v252 offset:1152
s_waitcnt lgkmcnt(10)
v_readfirstlane_b32 s56, v2
v_readfirstlane_b32 s57, v3
s_waitcnt lgkmcnt(9)
v_smfmac_f32_16x16x64_bf16 v[228:231], v[88:91], v[8:15], v7
s_and_b32 s0, s57, 0x7fff
s_add_u32 s57, s57, s0
s_add_u32 s57, s57, 4096
s_and_b32 s1, s56, 0xfffff800
s_waitcnt lgkmcnt(8)
v_smfmac_f32_16x16x64_bf16 v[228:231], v[92:95], v[16:23], v7
s_ashr_i32 s3, s1, 31
s_not_b32 s3, s3
s_or_b32 s3, s3, 0x80000000
s_xor_b32 s1, s1, s3
s_waitcnt lgkmcnt(7)
v_smfmac_f32_16x16x64_bf16 v[228:231], v[96:99], v[24:31], v7
s_andn2_b32 s56, 2047, s56
s_mul_i32 s56, s56, 1280
v_mov_b32 v130, s1
s_waitcnt lgkmcnt(6)
v_smfmac_f32_16x16x64_bf16 v[228:231], v[100:103], v[32:39], v7
v_mul_f32 v130, 0xbfb8aa3b, v130
s_waitcnt lgkmcnt(5)
v_smfmac_f32_16x16x64_bf16 v[228:231], v[104:107], v[40:47], v7
v_exp_f32 v130, v130
s_waitcnt lgkmcnt(4)
v_smfmac_f32_16x16x64_bf16 v[228:231], v[108:111], v[48:55], v7
v_add_f32 v130, 1.0, v130
s_waitcnt lgkmcnt(3)
v_smfmac_f32_16x16x64_bf16 v[228:231], v[112:115], v[56:63], v7
v_rcp_f32 v130, v130
s_waitcnt lgkmcnt(2)
v_smfmac_f32_16x16x64_bf16 v[228:231], v[116:119], v[64:71], v7
s_waitcnt lgkmcnt(1)
v_smfmac_f32_16x16x64_bf16 v[228:231], v[120:123], v[72:79], v7
s_waitcnt lgkmcnt(0)
v_smfmac_f32_16x16x64_bf16 v[228:231], v[124:127], v[80:87], v7
s_branch L_xj
L_pad_28:
s_setpc_b64 s[100:101]
L_xh:
ds_read_b128 v[236:239], v252 offset:0
ds_read_b128 v[240:243], v252 offset:128
ds_read_b128 v[244:247], v252 offset:256
ds_read_b128 v[248:251], v252 offset:384
s_waitcnt lgkmcnt(3)
v_smfmac_f32_16x16x64_bf16 v[228:231], v[236:239], v[8:15], v7
v_smfmac_f32_16x16x64_bf16 v[232:235], v[236:239], v[88:95], v7
ds_read_b128 v[236:239], v252 offset:512
s_waitcnt lgkmcnt(3)
v_smfmac_f32_16x16x64_bf16 v[228:231], v[240:243], v[16:23], v7
v_smfmac_f32_16x16x64_bf16 v[232:235], v[240:243], v[96:103], v7
ds_read_b128 v[240:243], v252 offset:640
s_waitcnt lgkmcnt(3)
v_smfmac_f32_16x16x64_bf16 v[228:231], v[244:247], v[24:31], v7
v_smfmac_f32_16x16x64_bf16 v[232:235], v[244:247], v[104:111], v7
ds_read_b128 v[244:247], v252 offset:768
s_waitcnt lgkmcnt(3)
v_smfmac_f32_16x16x64_bf16 v[228:231], v[248:251], v[32:39], v7
v_smfmac_f32_16x16x64_bf16 v[232:235], v[248:251], v[112:119], v7
ds_read_b128 v[248:251], v252 offset:896
s_waitcnt lgkmcnt(3)
v_smfmac_f32_16x16x64_bf16 v[228:231], v[236:239], v[40:47], v7
v_smfmac_f32_16x16x64_bf16 v[232:235], v[236:239], v[120:127], v7
ds_read_b128 v[236:239], v252 offset:1024
s_waitcnt lgkmcnt(3)
v_smfmac_f32_16x16x64_bf16 v[228:231], v[240:243], v[48:55], v7
v_smfmac_f32_16x16x64_bf16 v[232:235], v[240:243], v[128:135], v7
ds_read_b128 v[240:243], v252 offset:1152
s_waitcnt lgkmcnt(3)
v_smfmac_f32_16x16x64_bf16 v[228:231], v[244:247], v[56:63], v7
v_smfmac_f32_16x16x64_bf16 v[232:235], v[244:247], v[136:143], v7
s_waitcnt lgkmcnt(2)
v_smfmac_f32_16x16x64_bf16 v[228:231], v[248:251], v[64:71], v7
v_smfmac_f32_16x16x64_bf16 v[232:235], v[248:251], v[144:151], v7
s_waitcnt lgkmcnt(1)
v_smfmac_f32_16x16x64_bf16 v[228:231], v[236:239], v[72:79], v7
v_smfmac_f32_16x16x64_bf16 v[232:235], v[236:239], v[152:159], v7
s_waitcnt lgkmcnt(0)
v_smfmac_f32_16x16x64_bf16 v[228:231], v[240:243], v[80:87], v7
v_smfmac_f32_16x16x64_bf16 v[232:235], v[240:243], v[160:167], v7
L_xj:
s_mov_b64 vcc, 0xffff
s_nop 5
v_add_f32 v1, v228, v229
v_add_f32 v2, v232, v233
v_cndmask_b32 v1, v2, v1, vcc
v_mul_f32 v2, 0xbfb8aa3b, v1
v_cmp_u_f32 vcc, v1, v1
v_exp_f32 v2, v2
v_mul_f32_dpp v3, v1, v1 row_ror:8 row_mask:0xf bank_mask:0xf
v_add_f32 v2, 1.0, v2
v_rcp_f32 v2, v2
s_mov_b64 exec, s[50:51]
v_mul_f32 v1, v2, v3
v_cvt_pk_bf16_f32 v1, v1, v1
ds_write_b16 v253, v1
s_mov_b64 exec, -1
s_cbranch_vccnz L_xn
L_xnb:
L_bb:
s_waitcnt lgkmcnt(0)
s_barrier
ds_read_b32 v1, v4 offset:16
ds_read_b128 v[236:239], v255
ds_read_b128 v[240:243], v254
s_waitcnt lgkmcnt(2)
v_cmp_ne_u32 vcc, 0, v1
s_cbranch_vccnz L_xsr
L_xsgo:
s_waitcnt lgkmcnt(1)
v_mfma_f32_16x16x32_bf16 v[24:27], v[236:239], v[224:227], 0
v_mfma_f32_16x16x32_bf16 v[8:11], v[236:239], v[176:179], 0
v_mfma_f32_16x16x32_bf16 v[12:15], v[236:239], v[188:191], 0
v_mfma_f32_16x16x32_bf16 v[16:19], v[236:239], v[200:203], 0
v_mfma_f32_16x16x32_bf16 v[20:23], v[236:239], v[212:215], 0
s_waitcnt lgkmcnt(0)
s_nop 0
v_smfmac_f32_16x16x64_bf16 v[24:27], v[240:243], v[216:223], v7
v_smfmac_f32_16x16x64_bf16 v[8:11], v[240:243], v[168:175], v7
v_smfmac_f32_16x16x64_bf16 v[12:15], v[240:243], v[180:187], v7
v_smfmac_f32_16x16x64_bf16 v[16:19], v[240:243], v[192:199], v7
v_smfmac_f32_16x16x64_bf16 v[20:23], v[240:243], v[204:211], v7
s_nop 3
v_add_f32 v1, v24, v25
v_add_f32 v32, v8, v9
v_add_f32 v33, v12, v13
v_add_f32 v34, v16, v17
v_add_f32 v35, v20, v21
v_mov_b32_dpp v32, v1 quad_perm:[0,0,0,0] row_mask:0x2 bank_mask:0xf
v_mov_b32_dpp v33, v1 quad_perm:[1,1,1,1] row_mask:0x2 bank_mask:0xf
v_mov_b32_dpp v34, v1 quad_perm:[2,2,2,2] row_mask:0x2 bank_mask:0xf
v_mov_b32_dpp v35, v1 quad_perm:[3,3,3,3] row_mask:0x2 bank_mask:0xf
s_mov_b64 exec, 0x1111ffff
buffer_store_dwordx4 v[32:35], v5, s[16:19], s47 offen sc1
s_mov_b64 exec, -1
s_cmp_lt_u32 s52, 40
s_cbranch_scc0 L_mfin
buffer_load_dword v44, v129, s[16:19], s57 offen sc1
buffer_load_dwordx4 v[40:43], v6, s[16:19], s53 offen sc1
s_sleep 1
buffer_load_dword v52, v129, s[16:19], s57 offen sc1
buffer_load_dwordx4 v[48:51], v6, s[16:19], s53 offen sc1
s_sleep 1
L_fd:
buffer_load_dword v60, v129, s[16:19], s57 offen sc1
buffer_load_dwordx4 v[56:59], v6, s[16:19], s53 offen sc1
s_waitcnt vmcnt(4)
v_max3_u32 v1, v40, v42, v44
v_cmp_eq_u32 vcc, -1, v1
s_cbranch_vccz L_fg0
s_sleep 1
buffer_load_dword v44, v129, s[16:19], s57 offen sc1
buffer_load_dwordx4 v[40:43], v6, s[16:19], s53 offen sc1
s_waitcnt vmcnt(4)
v_max3_u32 v1, v48, v50, v52
v_cmp_eq_u32 vcc, -1, v1
s_cbranch_vccz L_fg1
s_sleep 1
buffer_load_dword v52, v129, s[16:19], s57 offen sc1
buffer_load_dwordx4 v[48:51], v6, s[16:19], s53 offen sc1
s_waitcnt vmcnt(4)
v_max3_u32 v1, v56, v58, v60
v_cmp_eq_u32 vcc, -1, v1
s_cbranch_vccz L_fg2
s_sleep 1
s_sub_u32 s40, s40, 1
s_cbranch_scc0 L_fd
L_fg2:
v_permlane32_swap_b32 v56, v57
v_permlane32_swap_b32 v58, v59
v_add_f32 v56, v56, v57
v_add_f32 v58, v58, v59
s_nop 1
v_permlane16_swap_b32 v56, v58
v_add_f32 v56, v56, v58
s_nop 1
v_add_f32_dpp v56, v56, v56 row_ror:4 row_mask:0xf bank_mask:0xf
s_nop 1
v_add_f32_dpp v56, v56, v56 row_ror:8 row_mask:0xf bank_mask:0xf
v_fma_f32 v8, v56, v130, v60
v_cvt_pk_bf16_f32 v8, v8, v8
s_mov_b32 exec_lo, 0xf000f
s_mov_b32 exec_hi, 0xf000f
buffer_store_short v8, v128, s[20:23], s56 offen
s_endpgm
L_pad_29:
s_setpc_b64 s[100:101]
L_fg1:
v_permlane32_swap_b32 v48, v49
v_permlane32_swap_b32 v50, v51
v_add_f32 v48, v48, v49
v_add_f32 v50, v50, v51
s_nop 1
v_permlane16_swap_b32 v48, v50
v_add_f32 v48, v48, v50
s_nop 1
v_add_f32_dpp v48, v48, v48 row_ror:4 row_mask:0xf bank_mask:0xf
s_nop 1
v_add_f32_dpp v48, v48, v48 row_ror:8 row_mask:0xf bank_mask:0xf
v_fma_f32 v8, v48, v130, v52
v_cvt_pk_bf16_f32 v8, v8, v8
s_mov_b32 exec_lo, 0xf000f
s_mov_b32 exec_hi, 0xf000f
buffer_store_short v8, v128, s[20:23], s56 offen
s_endpgm
L_pad_30:
s_setpc_b64 s[100:101]
L_fg0:
v_permlane32_swap_b32 v40, v41
v_permlane32_swap_b32 v42, v43
v_add_f32 v40, v40, v41
v_add_f32 v42, v42, v43
s_nop 1
v_permlane16_swap_b32 v40, v42
v_add_f32 v40, v40, v42
s_nop 1
v_add_f32_dpp v40, v40, v40 row_ror:4 row_mask:0xf bank_mask:0xf
s_nop 1
v_add_f32_dpp v40, v40, v40 row_ror:8 row_mask:0xf bank_mask:0xf
v_fma_f32 v8, v40, v130, v44
v_cvt_pk_bf16_f32 v8, v8, v8
s_mov_b32 exec_lo, 0xf000f
s_mov_b32 exec_hi, 0xf000f
buffer_store_short v8, v128, s[20:23], s56 offen
L_mfin:
s_endpgm
L_pad_31:
s_setpc_b64 s[100:101]
L_xn:
ds_write_b32 v4, v4 offset:16
s_branch L_xnb
L_xsr:
s_sub_u32 s49, s49, 1
s_cbranch_scc1 L_xsgo
v_mov_b32 v228, 0
v_mov_b32 v229, 0
v_mov_b32 v232, 0
v_mov_b32 v233, 0
s_waitcnt lgkmcnt(0)
s_barrier
s_cmp_eq_u32 s32, 7
s_cbranch_scc0 L_np
ds_write_b32 v4, v228 offset:16
s_cmp_eq_u32 s61, 2
s_cbranch_scc0 L_xf
s_mov_b32 s61, 0
s_mov_b64 exec, 0x77777777
s_branch L_xf
L_end:
s_endpgm
.section .rodata,"a"
.p2align 6
.amdhsa_kernel sequential_preLN__sliding_local_dilated__moe_arch_mod__prompt_kernel
  .amdhsa_next_free_vgpr 256
  .amdhsa_next_free_sgpr 102
  .amdhsa_accum_offset 256
  .amdhsa_group_segment_fixed_size 0
  .amdhsa_kernarg_size 88
  .amdhsa_user_sgpr_count 2
  .amdhsa_user_sgpr_kernarg_segment_ptr 1
  .amdhsa_system_sgpr_workgroup_id_x 1
  .amdhsa_float_denorm_mode_32 3
.end_amdhsa_kernel
```

```asm
; @launch grid=(256,1,1) block=(512,1,1) lds=163840
.amdgcn_target "amdgcn-amd-amdhsa--gfx950"
.text
.p2align 12
.globl sequential_preLN__sliding_local_dilated__moe_arch_mod__prompt_kernel
.p2align 8
.type sequential_preLN__sliding_local_dilated__moe_arch_mod__prompt_kernel,@function
sequential_preLN__sliding_local_dilated__moe_arch_mod__prompt_kernel:
s_load_dwordx16 s[44:59], s[0:1], 0
s_load_dwordx8 s[60:67], s[0:1], 56
s_lshr_b32 s34, s2, 3
s_and_b32 s33, s2, 7
v_readfirstlane_b32 s32, v0
s_getpc_b64 s[100:101]
L_pc:
s_mul_i32 s3, s34, 9
v_min_u32 v2, 8, v0
v_add_lshl_u32 v2, v2, s3, 7
v_min_u32 v2, L_end-L_pc, v2
s_cmp_ge_u32 s34, 30
s_cbranch_scc1 L_moe
global_load_dword v255, v2, s[100:101]
s_mul_i32 s35, s34, 26
s_lshr_b32 s35, s35, 8
s_mul_i32 s3, s35, 10
s_sub_u32 s36, s34, s3
s_lshr_b32 s32, s32, 6
s_lshl_b32 s3, s33, 2
s_lshr_b32 s3, 0x68354972, s3
s_and_b32 s41, s3, 15
s_add_u32 s3, s36, s41
s_sub_u32 s68, s3, 10
s_cselect_b32 s69, s3, s68
s_mul_i32 s3, s69, 245760
s_lshl_b32 s68, s36, 7
s_add_u32 s3, s3, s68
v_lshrrev_b32 v1, 3, v0
v_lshrrev_b32 v3, 4, v0
v_and_b32 v2, 2, v1
v_and_or_b32 v2, v3, 4, v2
v_xor_b32 v2, v2, v0
v_and_b32 v2, 7, v2
v_mul_u32_u24 v4, 3840, v1
v_lshl_add_u32 v4, v2, 4, v4
v_add_u32 v4, s3, v4
s_mul_i32 s3, s32, 3072
s_add_u32 m0, s3, 20480
v_and_b32 v0, 63, v0
s_and_b32 s38, s32, 3
s_lshr_b32 s3, s33, 1
s_lshl_b32 s3, s3, 9
s_mul_i32 s68, s35, 176
s_add_u32 s3, s3, s68
s_and_b32 s68, s33, 1
s_add_u32 s3, s3, s68
s_mul_i32 s39, s3, 1280
s_sub_u32 s42, s32, 5
s_mul_i32 s3, s42, 81920
s_add_u32 s3, s3, s39
s_sub_u32 s3, s3, 20480
v_lshrrev_b32 v1, 3, v0
v_lshrrev_b32 v3, 4, v0
v_xor_b32 v3, v3, v0
v_and_b32 v3, 7, v3
v_mul_u32_u24 v1, 2560, v1
v_lshl_add_u32 v1, v3, 4, v1
v_add_u32 v24, s3, v1
s_add_u32 s3, s42, s35
s_cmp_eq_u32 s3, 4
s_cselect_b32 s3, 0x80000000, 0
v_xor_b32 v25, 64, v24
v_add_u32 v25, 20480, v25
v_add_u32 v26, 40960, v24
v_add_u32 v27, 40960, v25
v_or_b32 v27, s3, v27
s_mov_b32 s6, 0x280000
s_mov_b32 s7, 0x20000
s_mov_b32 s10, 0x258000
s_mov_b32 s11, 0x20000
s_mov_b32 s14, 0xc8000
s_mov_b32 s15, 0x20000
s_mov_b32 s18, 0x10000000
s_mov_b32 s19, 0x20000
s_mov_b32 s22, 0x280000
s_mov_b32 s23, 0x20000
s_mov_b32 s26, 0x100
s_mov_b32 s27, 0x20000
s_mov_b32 s30, 0x500
s_mov_b32 s31, 0x20000
s_waitcnt lgkmcnt(0)
global_load_lds_dwordx4 v4, s[46:47]
s_addk_i32 m0, -256
s_mov_b64 s[4:5], s[44:45]
global_load_lds_dwordx4 v4, s[46:47] offset:1280
s_addk_i32 m0, -256
s_mov_b64 s[20:21], s[62:63]
global_load_lds_dwordx4 v4, s[46:47] offset:2560
s_mov_b64 s[24:25], s[64:65]
s_mov_b64 s[16:17], s[66:67]
s_mov_b64 s[8:9], s[46:47]
s_mov_b64 s[12:13], s[48:49]
s_mov_b64 s[28:29], s[52:53]
s_cmp_eq_u32 s32, 4
s_cselect_b64 s[96:97], s[54:55], s[58:59]
s_cmp_eq_u32 s32, 5
s_cselect_b64 s[96:97], s[56:57], s[96:97]
s_cmp_lt_u32 s32, 5
s_cbranch_scc1 L_nx
s_lshl_b32 s64, s42, 12
s_cselect_b32 s62, -1, 0xffffff00
s_lshl_b32 s63, s69, 7
s_mov_b32 s61, 8192
s_add_u32 m0, s61, s64
s_mov_b32 exec_lo, s62
buffer_load_dwordx4 v24, s[4:7], s63 offen lds
s_addk_i32 m0, 1024
s_mov_b32 exec_lo, -1
buffer_load_dwordx4 v25, s[4:7], s63 offen lds
s_addk_i32 m0, 1024
s_nop 0
buffer_load_dwordx4 v26, s[4:7], s63 offen lds
s_addk_i32 m0, 1024
s_nop 0
buffer_load_dwordx4 v27, s[4:7], s63 offen lds
L_nx:
v_mov_b32 v254, v4
s_mov_b32 s40, 524288
s_mul_i32 s43, s33, 3
s_add_u32 s43, s43, s35
s_sub_u32 s3, s36, 5
s_cselect_b32 s37, s36, s3
s_lshl_b32 s3, s32, 2
s_lshr_b32 s44, 0x32105454, s3
s_and_b32 s44, s44, 7
s_lshr_b32 s45, s38, 1
s_add_u32 s45, s45, 4
s_cmp_eq_u32 s35, 2
s_cselect_b32 s60, 10, 11
s_sub_u32 s57, 10, s41
v_lshlrev_b32 v233, 4, v0
s_mul_i32 s58, s43, 6
s_add_u32 s58, s58, s44
s_mul_i32 s58, s58, 2560
s_add_u32 s58, s58, 2097152
s_lshl_b32 s59, s33, 15
s_add_u32 s59, s59, 3145728
s_sub_u32 s51, 5, s37
s_add_u32 s1, s37, 1
s_sub_u32 s3, 15, s37
s_cmp_le_u32 s37, 2
s_cselect_b32 s46, 0, s3
s_cselect_b32 s47, s51, s1
s_cselect_b32 s48, s3, 0
s_cselect_b32 s49, s1, s51
s_cselect_b32 s50, 1, 0
v_and_b32 v3, 15, v0
v_add_u32 v3, 8, v3
v_lshrrev_b32 v4, 1, v3
v_lshrrev_b32 v5, 5, v0
v_xor_b32 v4, v4, v5
v_and_b32 v4, 7, v4
v_lshlrev_b32 v4, 4, v4
v_lshl_add_u32 v4, v3, 7, v4
v_bfe_u32 v5, v0, 4, 1
v_lshl_add_u32 v4, v5, 3, v4
s_lshl_b32 s3, s44, 11
v_add_u32 v235, s3, v4
s_cmp_lt_u32 s32, 4
s_cbranch_scc1 L_cons
s_add_u32 s69, s69, 1
s_cmp_eq_u32 s69, 10
s_cselect_b32 s69, 0, s69
s_lshl_b32 s63, s69, 7
s_mov_b32 s61, 45056
v_and_b32 v1, 15, v0
v_lshrrev_b32 v2, 4, v0
v_mov_b32 v7, 1792
s_mul_i32 s0, s44, 2304
s_movk_i32 s1, 144
v_bfe_u32 v3, v0, 2, 1
v_and_b32 v4, 3, v0
v_lshlrev_b32 v4, 1, v4
v_lshl_add_u32 v3, v3, 3, v4
v_bfe_u32 v4, v0, 3, 1
v_add_u32 v3, v3, v4
s_add_u32 s3, s0, 17408
v_mov_b32 v4, s3
v_mad_u32_u24 v3, v3, s1, v4
s_add_u32 s3, s0, 4736
v_mov_b32 v4, s3
v_mad_u32_u24 v4, v1, s1, v4
s_mov_b32 s52, 0xff00ff
s_mov_b32 s53, 0xff00ff
v_add_u32 v5, s51, v2
v_lshl_add_u32 v200, v5, 3, v3
v_lshl_add_u32 v5, v5, 3, v4
v_cndmask_b32 v204, v7, v5, s[52:53]
v_cndmask_b32 v205, v5, v7, s[52:53]
s_sub_u32 s3, s51, 1
v_mad_u32_u24 v5, v2, 5, s3
s_add_u32 s3, s46, 4
v_mov_b32 v6, s3
s_mov_b64 vcc, 0xffff
v_cndmask_b32 v5, v5, v6, vcc
v_min_u32 v5, 15, v5
v_lshl_add_u32 v201, v5, 3, v3
v_lshl_add_u32 v5, v5, 3, v4
s_cmp_eq_u32 s47, 5
s_cselect_b64 vcc, 0xff, 0
v_cndmask_b32 v210, v7, v5, vcc
s_lshl_b64 vcc, vcc, 8
v_cndmask_b32 v211, v7, v5, vcc
s_bfm_b64 vcc, 8, 16
v_cndmask_b32 v212, v7, v5, vcc
s_bfm_b64 vcc, 8, 24
v_cndmask_b32 v213, v7, v5, vcc
s_bfm_b64 vcc, 8, 32
v_cndmask_b32 v214, v7, v5, vcc
s_bfm_b64 vcc, 8, 40
v_cndmask_b32 v215, v7, v5, vcc
s_mul_i32 s0, s44, 2304
s_movk_i32 s1, 144
v_bfe_u32 v3, v0, 2, 3
v_lshrrev_b32 v4, 5, v0
v_lshl_add_u32 v3, v3, 1, v4
s_add_u32 s3, s0, 31232
v_mov_b32 v4, s3
v_mad_u32_u24 v3, v3, s1, v4
v_and_b32 v4, 3, v0
s_mov_b32 s54, 0x11111111
s_mov_b32 s55, 0x11111111
v_add_u32 v5, s51, v4
v_lshl_add_u32 v216, v5, 3, v3
v_add_u32 v7, 32, v216
s_cmp_eq_u32 s50, 1
s_cselect_b32 s3, -1, 12
s_cselect_b32 s56, 2, -1
v_add_u32 v5, s3, v4
v_lshl_add_u32 v5, v5, 3, v3
v_cndmask_b32 v217, v5, v7, s[54:55]
v_add_u32 v7, 40, v7
v_add_u32 v5, s56, v4
v_add_u32 v6, 10, v5
v_cmp_gt_i32 vcc, s51, v5
s_nop 1
v_cndmask_b32 v5, v6, v5, vcc
v_lshl_add_u32 v5, v5, 3, v3
v_cndmask_b32 v218, v5, v7, s[54:55]
s_lshl_b32 s0, s44, 8
v_lshrrev_b32 v4, 5, v0
v_and_or_b32 v3, v0, 8, v4
s_add_u32 s3, s0, 8
v_lshl_add_u32 v222, v3, 4, s3
v_and_b32 v1, 15, v0
s_add_u32 s3, s0, 132
v_lshl_add_u32 v223, v1, 4, s3
s_lshr_b32 s3, s39, 8
s_mul_i32 s3, s3, 52429
s_lshr_b32 s3, s3, 18
s_lshl_b32 s0, s44, 5
s_add_u32 s3, s3, s0
s_sub_u32 s3, 2047, s3
v_mad_i32_i24 v234, v1, -2, s3
v_lshrrev_b32 v2, 4, v0
v_and_or_b32 v3, v0, 8, v2
v_and_b32 v4, 0x70, v233
v_bfrev_b32 v6, 1
s_lshl_b32 s3, s45, 4
v_add_u32 v5, s3, v3
s_lshl_b32 s3, s60, 3
v_cmp_gt_u32 vcc, s3, v5
v_mul_u32_u24 v5, 2560, v5
v_add3_u32 v5, v5, v4, s39
v_cndmask_b32 v236, v6, v5, vcc
s_lshl_b32 s3, s44, 4
v_add_u32 v5, s3, v3
s_lshl_b32 s3, s60, 3
v_cmp_gt_u32 vcc, s3, v5
v_mul_u32_u24 v5, 2560, v5
v_add3_u32 v5, v5, v4, s39
v_cndmask_b32 v227, v6, v5, vcc
s_lshl_b32 s3, s36, 7
v_add_u32 v226, s3, v227
v_and_b32 v1, 15, v0
v_bfrev_b32 v6, 1
v_bfe_u32 v3, v0, 4, 1
v_lshrrev_b32 v4, 5, v0
v_lshl_add_u32 v3, v3, 1, v4
s_lshl_b32 s3, s36, 7
v_lshl_add_u32 v4, v3, 4, s3
s_lshl_b32 s3, s44, 4
v_add_u32 v5, s3, v1
s_lshl_b32 s3, s60, 3
v_cmp_gt_u32 vcc, s3, v5
v_mul_u32_u24 v5, 2560, v5
v_add3_u32 v5, v5, v4, s39
v_cndmask_b32 v232, v6, v5, vcc
v_bfe_u32 v3, v0, 3, 2
v_lshlrev_b32 v3, 2, v3
v_and_or_b32 v3, v0, 3, v3
v_lshlrev_b32 v3, 3, v3
v_bfe_u32 v4, v0, 2, 2
v_lshl_add_u32 v3, v4, 7, v3
v_lshrrev_b32 v2, 4, v0
s_and_b32 s3, s32, 1
s_lshl_b32 s3, s3, 12
s_add_u32 s3, s3, 81920
v_lshl_add_u32 v4, v2, 10, v3
v_add_u32 v228, s3, v4
v_xor_b32 v229, 32, v228
v_xor_b32 v230, 64, v228
v_xor_b32 v231, 96, v228
s_mov_b32 s44, 0x0
s_mov_b32 s45, 0x1010101
s_mov_b32 s46, 0x3030303
s_mov_b32 s47, 0x7070707
s_mov_b32 s48, 0xf0f0f0f
s_mov_b32 s49, 0x1f1f1f1f
s_mov_b32 s50, 0x3f3f3f3f
s_mov_b32 s51, 0x7f7f7f7f
s_movk_i32 s54, 10240
s_mov_b32 s55, 0x07060501
s_mov_b32 s56, 0x0706000c
v_mov_b32 v5, 0xffff
v_mov_b32 v6, 0xffff0000
v_cndmask_b32 v1, 0, v5, s[44:45]
v_cndmask_b32 v4, 0, v6, s[46:47]
v_or_b32 v220, v1, v4
v_cndmask_b32 v1, 0, v5, s[48:49]
v_cndmask_b32 v4, 0, v6, s[50:51]
v_or_b32 v221, v1, v4
v_lshrrev_b32 v1, 3, v0
v_and_b32 v2, 2, v1
v_xor_b32 v2, v2, v0
s_lshl_b32 s3, s32, 2
v_xor_b32 v2, s3, v2
v_and_b32 v2, 7, v2
s_lshl_b32 s3, s36, 7
v_lshl_add_u32 v2, v2, 4, s3
v_and_b32 v3, 3, v1
v_mul_u32_u24 v3, 1280, v3
v_add_u32 v2, v3, v2
v_lshrrev_b32 v3, 5, v0
v_mul_u32_u24 v3, 5120, v3
v_sub_u32 v4, 5120, v3
v_mad_u32_u24 v56, v3, 5, v2
v_mad_u32_u24 v57, v3, 3, v2
v_mad_u32_u24 v58, v3, 13, v2
v_mad_u32_u24 v59, v4, 3, v2
v_mad_u32_u24 v60, v4, 13, v2
s_mul_i32 s3, s38, 3
v_lshrrev_b32 v1, 2, v0
v_add_u32 v1, s3, v1
s_add_u32 s3, s3, 3
s_min_u32 s3, s3, s60
v_cmp_gt_u32 vcc, s3, v1
v_and_b32 v2, 3, v0
v_lshl_add_u32 v1, v1, 3, v2
v_mul_u32_u24 v1, 2560, v1
s_lshl_b32 s0, s36, 7
s_add_u32 s3, s0, s39
v_add_u32 v1, s3, v1
v_bfrev_b32 v2, 1
v_cndmask_b32 v61, v2, v1, vcc
s_mul_i32 s3, s38, 3
v_min_u32 v1, 2, v0
v_add_u32 v1, s3, v1
v_lshrrev_b32 v2, 1, v1
v_mul_u32_u24 v2, 2304, v2
v_lshl_add_u32 v1, v1, 7, v2
s_mul_i32 s3, s43, 15360
s_lshl_b32 s0, s36, 8
s_add_u32 s3, s3, s0
s_add_u32 s3, s3, 2097152
v_add_u32 v63, s3, v1
s_mul_i32 s3, s34, 9
v_min_u32 v1, 8, v0
v_add_u32 v1, s3, v1
v_min_u32 v1, 255, v1
v_cmp_le_u32 vcc, 128, v1
v_mul_u32_u24 v1, 3072, v1
s_mul_i32 s3, s33, 384
s_add_u32 s3, s3, 1572864
v_add_u32 v1, s3, v1
v_subrev_u32 v2, 1376000, v1
v_cndmask_b32 v1, v1, v2, vcc
s_mul_i32 s3, s33, 60
s_lshl_b32 s0, s34, 1
s_add_u32 s3, s3, s0
s_and_b32 s0, s32, 1
s_add_u32 s3, s3, s0
s_lshl_b32 s3, s3, 12
v_min_u32 v2, 31, v0
v_lshl_add_u32 v2, v2, 7, s3
s_cmp_ge_u32 s32, 6
s_cselect_b64 vcc, -1, 0
v_cndmask_b32 v84, v1, v2, vcc
v_mov_b32 v176, 0
v_mov_b32 v177, 0
v_mov_b32 v178, 0
v_mov_b32 v179, 0
v_mov_b32 v180, 0
v_mov_b32 v181, 0
v_mov_b32 v182, 0
v_mov_b32 v183, 0
s_lshl_b32 s0, s38, 8
s_add_u32 s0, s0, 73728
v_add_u32 v241, s0, v233
s_lshl_b32 s0, s38, 2
s_add_u32 s0, s0, 1768
v_mov_b32 v242, s0
s_lshl_b32 s0, s38, 12
s_add_u32 s0, s0, 57344
v_add_u32 v237, s0, v233
s_and_b32 s0, s38, 2
s_lshl_b32 s0, s0, 1
s_add_u32 s0, s0, 1760
v_mov_b32 v238, s0
v_mov_b32 v239, 1744
v_cmp_eq_u32 vcc, 0, v0
s_nop 1
v_cndmask_b32 v240, 0, 1, vcc
s_cmp_eq_u32 s32, 4
s_cbranch_scc1 L_h0
v_mov_b32 v4, 0x3f803f80
v_mov_b32 v5, v4
v_lshrrev_b32 v1, 4, v0
v_mul_u32_u24 v1, 36736, v1
v_lshl_add_u32 v1, v0, 3, v1
ds_write_b64 v1, v[4:5] offset:8192
s_sub_u32 s0, s32, 5
s_mul_i32 s3, s43, 3
s_add_u32 s3, s3, s0
s_mul_i32 s3, s3, 2560
s_add_u32 s67, s3, 2621440
s_mul_i32 s3, s35, 1280
s_add_u32 s3, s3, s59
s_add_u32 s66, s3, 12288
v_min_u32 v1, 9, v0
v_lshl_add_u32 v55, v1, 7, s66
s_lshl_b32 s68, s36, 7
s_add_u32 s68, s68, s66
v_and_b32 v1, 15, v0
v_lshrrev_b32 v2, 5, v0
v_lshl_add_u32 v2, v2, 4, v1
s_lshl_b32 s0, s0, 5
v_add_lshl_u32 v52, v2, s0, 4
v_lshrrev_b32 v2, 4, v0
v_lshrrev_b32 v3, 1, v1
v_xor_b32 v3, v3, v2
v_lshlrev_b32 v3, 4, v3
v_lshl_add_u32 v3, v1, 7, v3
v_add_u32 v54, s64, v3
s_cmp_lt_u32 s39, 2560
s_cselect_b32 s3, 128, 0
v_mov_b32 v1, 0xf149f2ca
v_cmp_gt_u32 vcc, s3, v52
s_nop 1
v_cndmask_b32 v53, 0, v1, vcc
s_setprio 1
s_add_u32 m0, s61, s64
s_mov_b32 exec_lo, s62
buffer_load_dwordx4 v24, s[4:7], s63 offen lds
s_addk_i32 m0, 1024
s_mov_b32 exec_lo, -1
buffer_load_dwordx4 v25, s[4:7], s63 offen lds
s_addk_i32 m0, 1024
s_nop 0
buffer_load_dwordx4 v26, s[4:7], s63 offen lds
s_addk_i32 m0, 1024
s_nop 0
buffer_load_dwordx4 v27, s[4:7], s63 offen lds
v_lshrrev_b32 v1, 4, v0
v_lshlrev_b32 v1, 3, v1
s_lshl_b32 s3, s36, 7
buffer_load_dwordx2 v[244:245], v1, s[28:31], s3 offen offset:0
buffer_load_dwordx2 v[246:247], v1, s[28:31], s3 offen offset:32
buffer_load_dwordx2 v[248:249], v1, s[28:31], s3 offen offset:64
buffer_load_dwordx2 v[250:251], v1, s[28:31], s3 offen offset:96
v_mov_b32 v64, 0x3f803f80
v_mov_b32 v65, 0x3f803f80
v_mov_b32 v66, 0x3f803f80
v_mov_b32 v67, 0x3f803f80
s_waitcnt vmcnt(8) lgkmcnt(0)
s_barrier
v_xor_b32 v1, 64, v54
ds_read_b128 v[36:39], v54 offset:8192
ds_read_b128 v[40:43], v1 offset:8192
ds_read_b128 v[44:47], v54 offset:10240
ds_read_b128 v[48:51], v1 offset:10240
s_lshl_b32 s3, s36, 8
s_add_u32 s3, s3, s67
v_and_b32 v2, 0xf0, v233
s_mov_b32 s0, 0xaaaaaaaa
s_mov_b32 s1, s0
s_mov_b32 vcc_lo, 0xcccccccc
s_mov_b32 vcc_hi, 0xcccccccc
s_waitcnt lgkmcnt(3)
v_mfma_f32_16x16x32_bf16 v[96:99], v[36:39], v[36:39], 0
v_mfma_f32_16x16x32_bf16 v[100:103], v[64:67], v[36:39], 0
s_waitcnt lgkmcnt(2)
v_mfma_f32_16x16x32_bf16 v[96:99], v[40:43], v[40:43], v[96:99]
v_mfma_f32_16x16x32_bf16 v[100:103], v[64:67], v[40:43], v[100:103]
s_waitcnt lgkmcnt(1)
v_mfma_f32_16x16x32_bf16 v[104:107], v[44:47], v[44:47], 0
v_mfma_f32_16x16x32_bf16 v[108:111], v[64:67], v[44:47], 0
s_waitcnt lgkmcnt(0)
v_mfma_f32_16x16x32_bf16 v[104:107], v[48:51], v[48:51], v[104:107]
v_mfma_f32_16x16x32_bf16 v[108:111], v[64:67], v[48:51], v[108:111]
s_nop 0
v_cndmask_b32 v96, v96, v97, s[0:1]
v_cndmask_b32 v98, v98, v99, s[0:1]
v_cndmask_b32 v29, v96, v98, vcc
v_mov_b32 v28, v100
s_nop 1
v_cndmask_b32 v104, v104, v105, s[0:1]
v_cndmask_b32 v106, v106, v107, s[0:1]
v_cndmask_b32 v31, v104, v106, vcc
v_mov_b32 v30, v108
s_mov_b32 exec_lo, 0xf0000f
s_mov_b32 exec_hi, 0xf0000f00
buffer_store_dwordx4 v[28:31], v2, s[16:19], s3 offen sc1
s_mov_b64 exec, -1
v_mov_b32 v44, 0
v_mov_b32 v45, 0
v_mov_b32 v46, 0
v_mov_b32 v47, 0
s_add_u32 s69, s69, 1
s_cmp_eq_u32 s69, 10
s_cselect_b32 s69, 0, s69
s_lshl_b32 s63, s69, 7
s_mov_b32 s61, 81920
s_add_u32 m0, s61, s64
s_mov_b32 exec_lo, s62
buffer_load_dwordx4 v24, s[4:7], s63 offen lds
s_addk_i32 m0, 1024
s_mov_b32 exec_lo, -1
buffer_load_dwordx4 v25, s[4:7], s63 offen lds
s_addk_i32 m0, 1024
s_nop 0
buffer_load_dwordx4 v26, s[4:7], s63 offen lds
s_addk_i32 m0, 1024
s_nop 0
buffer_load_dwordx4 v27, s[4:7], s63 offen lds
s_branch L_pb_1
.p2align 12
L_pad_2:
s_setpc_b64 s[100:101]
L_pb_1:
s_waitcnt vmcnt(5) lgkmcnt(0)
s_cmp_eq_u32 s32, 5
s_cbranch_scc0 L_o5a
s_lshl_b32 s0, s33, 5
v_and_b32 v1, 16, v0
buffer_load_dword v32, v1, s[24:27], s0 offen sc1
L_o5a:
s_barrier
s_mul_i32 s3, s2, 3
s_add_u32 s3, s3, s32
s_sub_u32 s3, s3, 5
s_mul_i32 s3, s3, 1152
v_lshlrev_b32 v1, 7, v0
s_mov_b64 exec, 0x1ff
buffer_load_dword v255, v1, s[12:15], s3 offen
s_mov_b64 exec, -1
s_add_u32 s69, s69, 1
s_cmp_eq_u32 s69, 10
s_cselect_b32 s69, 0, s69
s_lshl_b32 s63, s69, 7
s_mov_b32 s61, 118784
s_add_u32 m0, s61, s64
s_mov_b32 exec_lo, s62
buffer_load_dwordx4 v24, s[4:7], s63 offen lds
s_addk_i32 m0, 1024
s_mov_b32 exec_lo, -1
buffer_load_dwordx4 v25, s[4:7], s63 offen lds
s_addk_i32 m0, 1024
s_nop 0
buffer_load_dwordx4 v26, s[4:7], s63 offen lds
s_addk_i32 m0, 1024
s_nop 0
buffer_load_dwordx4 v27, s[4:7], s63 offen lds
s_cmp_eq_u32 s57, 1
s_cbranch_scc0 L_xc1
s_mov_b32 s0, 45056
s_call_b64 s[100:101], L_xcap
L_xc1:
s_cmp_eq_u32 s32, 7
s_cbranch_scc0 L_wm1
s_call_b64 s[100:101], L_pad_6
s_call_b64 s[100:101], L_pad_21
L_wm1:
s_waitcnt vmcnt(5) lgkmcnt(0)
s_barrier
s_cmp_eq_u32 s32, 5
s_cbranch_scc0 L_o5c
s_waitcnt lgkmcnt(0)
v_cmp_ne_u32 vcc, 1, v32
s_cmp_eq_u64 vcc, 0
s_cbranch_scc0 L_era
L_ega:
s_getreg_b32 s0, hwreg(HW_REG_XCC_ID, 0, 4)
v_mov_b32 v1, s0
s_mov_b64 exec, 1
buffer_store_dword v1, off, s[16:19], s68 sc1
s_mov_b64 exec, -1
L_o5c:
s_add_u32 s69, s69, 1
s_cmp_eq_u32 s69, 10
s_cselect_b32 s69, 0, s69
s_lshl_b32 s63, s69, 7
s_mov_b32 s61, 8192
s_add_u32 m0, s61, s64
s_mov_b32 exec_lo, s62
buffer_load_dwordx4 v24, s[4:7], s63 offen lds
s_addk_i32 m0, 1024
s_mov_b32 exec_lo, -1
buffer_load_dwordx4 v25, s[4:7], s63 offen lds
s_addk_i32 m0, 1024
s_nop 0
buffer_load_dwordx4 v26, s[4:7], s63 offen lds
s_addk_i32 m0, 1024
s_nop 0
buffer_load_dwordx4 v27, s[4:7], s63 offen lds
s_cmp_eq_u32 s57, 2
s_cbranch_scc0 L_xc2
s_mov_b32 s0, 81920
s_call_b64 s[100:101], L_xcap
L_xc2:
s_cmp_eq_u32 s32, 7
s_cbranch_scc0 L_wm2
s_call_b64 s[100:101], L_pad_7
s_call_b64 s[100:101], L_pad_22
L_wm2:
s_cmp_eq_u32 s32, 5
s_cbranch_scc1 L_w52
s_waitcnt vmcnt(4)
L_w52:
s_waitcnt vmcnt(5) lgkmcnt(0)
s_barrier
s_add_u32 s69, s69, 1
s_cmp_eq_u32 s69, 10
s_cselect_b32 s69, 0, s69
s_lshl_b32 s63, s69, 7
s_mov_b32 s61, 45056
s_add_u32 m0, s61, s64
s_mov_b32 exec_lo, s62
buffer_load_dwordx4 v24, s[4:7], s63 offen lds
s_addk_i32 m0, 1024
s_mov_b32 exec_lo, -1
buffer_load_dwordx4 v25, s[4:7], s63 offen lds
s_addk_i32 m0, 1024
s_nop 0
buffer_load_dwordx4 v26, s[4:7], s63 offen lds
s_addk_i32 m0, 1024
s_nop 0
buffer_load_dwordx4 v27, s[4:7], s63 offen lds
s_cmp_eq_u32 s57, 3
s_cbranch_scc0 L_xc3
s_mov_b32 s0, 118784
s_call_b64 s[100:101], L_xcap
L_xc3:
s_cmp_eq_u32 s32, 7
s_cbranch_scc0 L_wm3
s_call_b64 s[100:101], L_pad_10
s_call_b64 s[100:101], L_pad_27
L_wm3:
s_waitcnt vmcnt(4) lgkmcnt(0)
s_barrier
s_add_u32 s69, s69, 1
s_cmp_eq_u32 s69, 10
s_cselect_b32 s69, 0, s69
s_lshl_b32 s63, s69, 7
s_mov_b32 s61, 81920
s_add_u32 m0, s61, s64
s_mov_b32 exec_lo, s62
buffer_load_dwordx4 v24, s[4:7], s63 offen lds
s_addk_i32 m0, 1024
s_mov_b32 exec_lo, -1
buffer_load_dwordx4 v25, s[4:7], s63 offen lds
s_addk_i32 m0, 1024
s_nop 0
buffer_load_dwordx4 v26, s[4:7], s63 offen lds
s_addk_i32 m0, 1024
s_nop 0
buffer_load_dwordx4 v27, s[4:7], s63 offen lds
s_cmp_eq_u32 s57, 4
s_cbranch_scc0 L_xc4
s_mov_b32 s0, 8192
s_call_b64 s[100:101], L_xcap
L_xc4:
s_cmp_eq_u32 s32, 7
s_cbranch_scc0 L_wm4
s_call_b64 s[100:101], L_pad_11
s_call_b64 s[100:101], L_pad_28
L_wm4:
s_waitcnt vmcnt(4) lgkmcnt(0)
s_cmp_eq_u32 s32, 5
s_cbranch_scc0 L_o5b
s_buffer_load_dword s71, s[16:19], s66 offset:0 glc
s_buffer_load_dword s73, s[16:19], s66 offset:128 glc
s_buffer_load_dword s75, s[16:19], s66 offset:256 glc
s_buffer_load_dword s77, s[16:19], s66 offset:384 glc
s_buffer_load_dword s83, s[16:19], s66 offset:512 glc
s_buffer_load_dword s85, s[16:19], s66 offset:640 glc
s_buffer_load_dword s89, s[16:19], s66 offset:768 glc
s_buffer_load_dword s91, s[16:19], s66 offset:896 glc
s_buffer_load_dword s93, s[16:19], s66 offset:1024 glc
s_buffer_load_dword s95, s[16:19], s66 offset:1152 glc
L_o5b:
s_barrier
s_add_u32 s69, s69, 1
s_cmp_eq_u32 s69, 10
s_cselect_b32 s69, 0, s69
s_lshl_b32 s63, s69, 7
s_mov_b32 s61, 118784
s_add_u32 m0, s61, s64
s_mov_b32 exec_lo, s62
buffer_load_dwordx4 v24, s[4:7], s63 offen lds
s_addk_i32 m0, 1024
s_mov_b32 exec_lo, -1
buffer_load_dwordx4 v25, s[4:7], s63 offen lds
s_addk_i32 m0, 1024
s_nop 0
buffer_load_dwordx4 v26, s[4:7], s63 offen lds
s_addk_i32 m0, 1024
s_nop 0
buffer_load_dwordx4 v27, s[4:7], s63 offen lds
s_cmp_eq_u32 s57, 5
s_cbranch_scc0 L_xc5
s_mov_b32 s0, 45056
s_call_b64 s[100:101], L_xcap
L_xc5:
s_cmp_eq_u32 s32, 5
s_cbranch_scc0 L_o5d
s_waitcnt lgkmcnt(0)
s_max_u32 s0, s71, s73
s_max_u32 s0, s0, s75
s_max_u32 s0, s0, s77
s_max_u32 s0, s0, s83
s_max_u32 s0, s0, s85
s_max_u32 s0, s0, s89
s_max_u32 s0, s0, s91
s_max_u32 s0, s0, s93
s_max_u32 s0, s0, s95
s_cmp_lg_u32 s0, -1
s_cbranch_scc0 L_erb
L_egb:
s_min_u32 s1, s71, s73
s_min_u32 s1, s1, s75
s_min_u32 s1, s1, s77
s_min_u32 s1, s1, s83
s_min_u32 s1, s1, s85
s_min_u32 s1, s1, s89
s_min_u32 s1, s1, s91
s_min_u32 s1, s1, s93
s_min_u32 s1, s1, s95
s_cmp_eq_u32 s0, s1
s_cselect_b32 s0, 1, 0
v_mov_b32 v1, 1728
v_mov_b32 v2, s0
ds_write_b32 v1, v2
L_o5d:
s_cmp_eq_u32 s32, 7
s_cbranch_scc0 L_wm5
s_call_b64 s[100:101], L_pad_12
L_wm5:
s_waitcnt vmcnt(4) lgkmcnt(0)
s_barrier
buffer_load_dwordx4 v[36:39], v233, s[16:19], s67 offen offset:0 sc1
buffer_load_dwordx4 v[40:43], v233, s[16:19], s67 offen offset:1024 sc1
s_mov_b32 exec_hi, 0
buffer_load_dwordx4 v[44:47], v233, s[16:19], s67 offen offset:2048 sc1
s_mov_b32 exec_hi, -1
s_add_u32 s69, s69, 1
s_cmp_eq_u32 s69, 10
s_cselect_b32 s69, 0, s69
s_lshl_b32 s63, s69, 7
s_mov_b32 s61, 8192
s_add_u32 m0, s61, s64
s_mov_b32 exec_lo, s62
buffer_load_dwordx4 v24, s[4:7], s63 offen lds
s_addk_i32 m0, 1024
s_mov_b32 exec_lo, -1
buffer_load_dwordx4 v25, s[4:7], s63 offen lds
s_addk_i32 m0, 1024
s_nop 0
buffer_load_dwordx4 v26, s[4:7], s63 offen lds
s_addk_i32 m0, 1024
s_nop 0
buffer_load_dwordx4 v27, s[4:7], s63 offen lds
s_cmp_eq_u32 s57, 6
s_cbranch_scc0 L_xc6
s_mov_b32 s0, 81920
s_call_b64 s[100:101], L_xcap
L_xc6:
s_cmp_eq_u32 s32, 7
s_cbranch_scc0 L_wm6
s_call_b64 s[100:101], L_pad_13
L_wm6:
s_waitcnt vmcnt(7) lgkmcnt(0)
s_barrier
s_add_u32 s69, s69, 1
s_cmp_eq_u32 s69, 10
s_cselect_b32 s69, 0, s69
s_lshl_b32 s63, s69, 7
s_mov_b32 s61, 45056
s_add_u32 m0, s61, s64
s_mov_b32 exec_lo, s62
buffer_load_dwordx4 v24, s[4:7], s63 offen lds
s_addk_i32 m0, 1024
s_mov_b32 exec_lo, -1
buffer_load_dwordx4 v25, s[4:7], s63 offen lds
s_addk_i32 m0, 1024
s_nop 0
buffer_load_dwordx4 v26, s[4:7], s63 offen lds
s_addk_i32 m0, 1024
s_nop 0
buffer_load_dwordx4 v27, s[4:7], s63 offen lds
s_cmp_eq_u32 s57, 7
s_cbranch_scc0 L_xc7
s_mov_b32 s0, 118784
s_call_b64 s[100:101], L_xcap
L_xc7:
s_waitcnt vmcnt(8)
v_add_f32 v36, v36, v40
v_add_f32 v37, v37, v41
v_add_f32 v38, v38, v42
v_add_f32 v39, v39, v43
v_add_f32 v36, v36, v44
v_add_f32 v37, v37, v45
v_add_f32 v38, v38, v46
v_add_f32 v39, v39, v47
s_nop 0
v_permlane32_swap_b32 v36, v38
v_permlane32_swap_b32 v37, v39
v_add_f32 v36, v36, v38
v_add_f32 v37, v37, v39
v_mov_b32 v38, v36
v_mov_b32 v39, v37
s_mov_b32 s1, 0x3acccccd
v_mov_b32 v1, 0x3727c5ac
v_permlane16_swap_b32 v36, v38
v_permlane16_swap_b32 v37, v39
v_add_f32 v36, v36, v38
v_add_f32 v37, v37, v39
v_mul_f32 v36, 0xbacccccd, v36
v_fma_f32 v2, v37, s1, v1
v_fma_f32 v2, -v36, v36, v2
v_max_f32 v2, v2, v1
v_rsq_f32 v37, v2
v_mov_b32 v39, v53
v_mov_b32 v38, v37
ds_write_b128 v52, v[36:39] offset:0
s_waitcnt vmcnt(4) lgkmcnt(0)
s_barrier
s_cmp_eq_u32 s57, 8
s_cbranch_scc0 L_xc8
s_mov_b32 s0, 8192
s_call_b64 s[100:101], L_xcap
L_xc8:
L_h8:
s_mul_i32 s66, s38, 5120
s_lshl_b32 s3, s38, 10
s_add_u32 m0, s3, 81920
s_add_u32 s3, s66, 25600
buffer_load_dwordx4 v56, s[12:15], s3 offen lds
s_addk_i32 m0, 4096
s_add_u32 s3, s66, 102400
buffer_load_dwordx4 v56, s[12:15], s3 offen lds
s_addk_i32 m0, 4096
s_add_u32 s3, s66, 179200
buffer_load_dwordx4 v56, s[12:15], s3 offen lds
s_addk_i32 m0, 4096
s_add_u32 s3, s66, 256000
buffer_load_dwordx4 v56, s[12:15], s3 offen lds
s_addk_i32 m0, 4096
s_add_u32 s3, s66, 332800
buffer_load_dwordx4 v56, s[12:15], s3 offen lds
s_addk_i32 m0, 4096
s_add_u32 s3, s66, 435200
buffer_load_dwordx4 v56, s[12:15], s3 offen lds
s_addk_i32 m0, 4096
s_add_u32 s3, s66, 512000
buffer_load_dwordx4 v56, s[12:15], s3 offen lds
s_addk_i32 m0, 4096
s_add_u32 s3, s66, 588800
buffer_load_dwordx4 v56, s[12:15], s3 offen lds
v_add_u32 v1, 128, v222
v_cndmask_b32 v4, v1, v222, s[44:45]
ds_read_b64 v[168:169], v4 offset:0
v_cndmask_b32 v4, v1, v222, s[46:47]
ds_read_b64 v[170:171], v4 offset:32
v_cndmask_b32 v4, v1, v222, s[48:49]
ds_read_b64 v[172:173], v4 offset:64
v_cndmask_b32 v4, v1, v222, s[50:51]
ds_read_b64 v[174:175], v4 offset:96
ds_read_b32 v5, v223 offset:0
v_mov_b32 v1, 1728
ds_read_b32 v1, v1
s_waitcnt lgkmcnt(0)
v_readfirstlane_b32 s41, v1
s_waitcnt vmcnt(8)
s_barrier
s_cmp_eq_u32 s41, 1
s_cbranch_scc0 L_gh_3g
L_gh_3b:
s_addk_i32 m0, 4096
s_add_u32 s3, s66, 665600
buffer_load_dwordx4 v56, s[12:15], s3 offen lds
s_addk_i32 m0, 4096
s_add_u32 s3, s66, 742400
buffer_load_dwordx4 v56, s[12:15], s3 offen lds
buffer_load_dword v62, v61, s[20:23], 0 offen
buffer_load_dword v63, v63, s[16:19], 0 offen
global_load_dword v84, v84, s[96:97]
v_lshlrev_b32 v8, 16, v72
v_and_b32 v9, 0xffff0000, v72
v_lshlrev_b32 v10, 16, v73
v_and_b32 v11, 0xffff0000, v73
v_lshlrev_b32 v12, 16, v74
v_and_b32 v13, 0xffff0000, v74
v_lshlrev_b32 v14, 16, v75
v_and_b32 v15, 0xffff0000, v75
v_lshlrev_b32 v16, 16, v76
v_and_b32 v17, 0xffff0000, v76
v_lshlrev_b32 v18, 16, v77
v_and_b32 v19, 0xffff0000, v77
v_lshlrev_b32 v20, 16, v78
v_and_b32 v21, 0xffff0000, v78
v_lshlrev_b32 v22, 16, v79
v_and_b32 v23, 0xffff0000, v79
s_mov_b32 s3, 0x3f803f80
v_mov_b32 v64, s3
v_mov_b32 v65, s3
v_mov_b32 v66, s3
v_mov_b32 v67, s3
s_mov_b32 exec_lo, 0x11111111
s_mov_b32 exec_hi, 0x11111111
v_mov_b32 v244, s3
v_mov_b32 v245, s3
v_mov_b32 v246, s3
v_mov_b32 v247, s3
v_mov_b32 v248, s3
v_mov_b32 v249, s3
v_mov_b32 v250, s3
v_mov_b32 v251, s3
s_mov_b64 exec, -1
v_mfma_f32_16x16x32_bf16 v[252:255], v[244:247], v[64:67], 0
v_mfma_f32_16x16x32_bf16 v[252:255], v[248:251], v[64:67], v[252:255]
s_and_b32 s3, s32, 1
s_lshl_b32 s61, s3, 7
s_xor_b32 s62, s61, 128
s_add_u32 s63, s62, s54
s_add_u32 s64, s61, s54
s_lshl_b32 s3, s3, 13
s_sub_u32 s65, 4096, s3
v_mul_f32 v5, 0x3ea52b5c, v5
s_barrier
ds_read_b64 v[96:97], v200 offset:0
ds_read_b64 v[98:99], v200 offset:1152
ds_read_b64 v[100:101], v200 offset:40
ds_read_b64 v[102:103], v200 offset:1192
ds_read_b64 v[104:105], v201 offset:0
ds_read_b64 v[106:107], v201 offset:1152
s_cmp_eq_u32 s38, 1
s_cbranch_scc1 L_woe1
s_cmp_eq_u32 s38, 2
s_cbranch_scc1 L_woe2
s_cmp_eq_u32 s38, 3
s_cbranch_scc1 L_woe3
s_addk_i32 m0, 4096
s_mov_b32 s3, 46080
buffer_load_dwordx4 v56, s[12:15], s3 offen lds
s_addk_i32 m0, 4096
s_mov_b32 s3, 122880
buffer_load_dwordx4 v56, s[12:15], s3 offen lds
s_addk_i32 m0, 4096
s_mov_b32 s3, 199680
buffer_load_dwordx4 v56, s[12:15], s3 offen lds
s_addk_i32 m0, 4096
s_mov_b32 s3, 276480
buffer_load_dwordx4 v56, s[12:15], s3 offen lds
s_addk_i32 m0, 4096
s_mov_b32 s3, 353280
buffer_load_dwordx4 v56, s[12:15], s3 offen lds
s_addk_i32 m0, 4096
s_mov_b32 s3, 455680
buffer_load_dwordx4 v56, s[12:15], s3 offen lds
s_addk_i32 m0, 4096
s_mov_b32 s3, 532480
buffer_load_dwordx4 v56, s[12:15], s3 offen lds
s_addk_i32 m0, 4096
s_mov_b32 s3, 609280
buffer_load_dwordx4 v56, s[12:15], s3 offen lds
s_addk_i32 m0, 4096
s_mov_b32 s3, 686080
buffer_load_dwordx4 v56, s[12:15], s3 offen lds
s_addk_i32 m0, 4096
s_mov_b32 s3, 762880
buffer_load_dwordx4 v56, s[12:15], s3 offen lds
L_woe:
buffer_load_dword v62, v61, s[20:23], s54 offen
s_setprio 1
s_waitcnt vmcnt(14)
s_barrier
ds_read_b64 v[108:109], v204 offset:0
ds_read_b64 v[110:111], v205 offset:0
ds_read_b64 v[112:113], v204 offset:40
ds_read_b64 v[114:115], v205 offset:40
ds_read_b64 v[116:117], v212 offset:0
ds_read_b64 v[118:119], v213 offset:0
ds_read_b64 v[120:121], v214 offset:0
ds_read_b64 v[122:123], v215 offset:0
s_waitcnt lgkmcnt(6)
v_mfma_f32_16x16x32_bf16 v[160:163], v[96:99], v[108:111], 0
s_waitcnt lgkmcnt(4)
v_mfma_f32_16x16x32_bf16 v[164:167], v[100:103], v[112:115], 0
s_waitcnt lgkmcnt(2)
v_mfma_f32_16x16x32_bf16 v[160:163], v[104:107], v[116:119], v[160:163]
s_waitcnt lgkmcnt(0)
v_mfma_f32_16x16x32_bf16 v[164:167], v[104:107], v[120:123], v[164:167]
s_nop 7
v_permlane16_swap_b32 v160, v164
v_permlane16_swap_b32 v161, v165
v_permlane16_swap_b32 v162, v166
v_permlane16_swap_b32 v163, v167
v_cndmask_b32 v196, v164, v160, s[44:45]
v_cndmask_b32 v197, v165, v161, s[46:47]
v_cndmask_b32 v198, v166, v162, s[48:49]
v_cndmask_b32 v199, v167, v163, s[50:51]
v_fma_f32 v196, v196, v168, v169
v_fma_f32 v197, v197, v170, v171
v_fma_f32 v198, v198, v172, v173
v_fma_f32 v199, v199, v174, v175
v_max3_f32 v6, v196, v197, v198
v_max_f32 v6, v6, v199
v_mov_b32 v7, v6
s_nop 1
v_permlane32_swap_b32 v6, v7
v_max_f32 v6, v6, v7
v_mul_f32 v6, v6, v5
v_fma_f32 v196, v196, v5, -v6
v_fma_f32 v197, v197, v5, -v6
v_fma_f32 v198, v198, v5, -v6
v_fma_f32 v199, v199, v5, -v6
v_exp_f32 v196, v196
v_exp_f32 v197, v197
v_exp_f32 v198, v198
v_exp_f32 v199, v199
ds_read_b64_tr_b16 v[64:65], v216 offset:0
ds_read_b64_tr_b16 v[66:67], v216 offset:1152
ds_read_b64_tr_b16 v[68:69], v216 offset:40
ds_read_b64_tr_b16 v[70:71], v216 offset:1192
ds_read_b64_tr_b16 v[72:73], v217 offset:0
ds_read_b64_tr_b16 v[74:75], v217 offset:1152
ds_read_b64_tr_b16 v[76:77], v218 offset:0
ds_read_b64_tr_b16 v[78:79], v218 offset:1152
v_add_f32 v6, v196, v197
v_add_f32 v7, v198, v199
v_add_f32 v6, v6, v7
v_mov_b32 v7, v6
v_mul_f32 v196, v196, v168
v_mul_f32 v197, v197, v170
v_permlane32_swap_b32 v6, v7
v_mul_f32 v198, v198, v172
v_add_f32 v6, v6, v7
v_rcp_f32 v6, v6
v_mul_f32 v199, v199, v174
v_mul_f32 v196, v196, v6
v_mul_f32 v197, v197, v6
v_mul_f32 v198, v198, v6
v_mul_f32 v199, v199, v6
v_cvt_pk_bf16_f32 v196, v196, v197
v_cvt_pk_bf16_f32 v197, v198, v199
s_mov_b64 exec, s[52:53]
v_and_b32 v176, v220, v196
v_bfi_b32 v180, v220, 0, v196
v_and_b32 v177, v221, v197
v_bfi_b32 v181, v221, 0, v197
s_not_b64 exec, exec
v_and_b32 v178, v220, v196
v_bfi_b32 v182, v220, 0, v196
v_and_b32 v179, v221, v197
v_bfi_b32 v183, v221, 0, v197
s_mov_b64 exec, -1
v_permlane16_swap_b32 v176, v180
v_permlane16_swap_b32 v177, v181
v_permlane16_swap_b32 v178, v182
v_permlane16_swap_b32 v179, v183
s_waitcnt lgkmcnt(0)
s_nop 0
v_mfma_f32_16x16x32_bf16 v[152:155], v[64:67], v[176:179], 0
v_mfma_f32_16x16x32_bf16 v[156:159], v[68:71], v[180:183], 0
v_mfma_f32_16x16x32_bf16 v[160:163], v[72:75], v[176:179], 0
v_mfma_f32_16x16x32_bf16 v[164:167], v[76:79], v[180:183], 0
s_nop 4
v_cvt_pk_bf16_f32 v196, v152, v153
v_cvt_pk_bf16_f32 v197, v154, v155
v_cvt_pk_bf16_f32 v198, v156, v157
v_cvt_pk_bf16_f32 v199, v158, v159
s_cmp_eq_u32 s41, 1
s_cbranch_scc0 L_gl_4g
buffer_store_dwordx4 v[196:199], v226, s[20:23], 0 offen
L_gl_4b:
s_mov_b64 exec, 0xffff
v_cvt_pk_bf16_f32 v80, v160, v161
v_cvt_pk_bf16_f32 v81, v162, v163
v_cvt_pk_bf16_f32 v82, v164, v165
v_cvt_pk_bf16_f32 v83, v166, v167
ds_write_b128 v241, v[80:83] offset:0
ds_write_b32 v242, v242 offset:0
s_mov_b64 exec, -1
s_setprio 1
ds_read_b64_tr_b16 v[104:105], v228 offset:0
ds_read_b64_tr_b16 v[106:107], v228 offset:512
ds_read_b64_tr_b16 v[108:109], v229 offset:0
ds_read_b64_tr_b16 v[110:111], v229 offset:512
ds_read_b64_tr_b16 v[112:113], v230 offset:0
ds_read_b64_tr_b16 v[114:115], v230 offset:512
ds_read_b64_tr_b16 v[116:117], v231 offset:0
ds_read_b64_tr_b16 v[118:119], v231 offset:512
ds_read_b64_tr_b16 v[120:121], v228 offset:8192
ds_read_b64_tr_b16 v[122:123], v228 offset:8704
ds_read_b64_tr_b16 v[124:125], v229 offset:8192
ds_read_b64_tr_b16 v[126:127], v229 offset:8704
ds_read_b64_tr_b16 v[128:129], v230 offset:8192
ds_read_b64_tr_b16 v[130:131], v230 offset:8704
ds_read_b64_tr_b16 v[132:133], v231 offset:8192
ds_read_b64_tr_b16 v[134:135], v231 offset:8704
ds_read_b64_tr_b16 v[136:137], v228 offset:16384
ds_read_b64_tr_b16 v[138:139], v228 offset:16896
ds_read_b64_tr_b16 v[140:141], v229 offset:16384
ds_read_b64_tr_b16 v[142:143], v229 offset:16896
ds_read_b64_tr_b16 v[144:145], v230 offset:16384
ds_read_b64_tr_b16 v[146:147], v230 offset:16896
ds_read_b64_tr_b16 v[148:149], v231 offset:16384
ds_read_b64_tr_b16 v[150:151], v231 offset:16896
ds_read_b64_tr_b16 v[152:153], v228 offset:24576
ds_read_b64_tr_b16 v[154:155], v228 offset:25088
ds_read_b64_tr_b16 v[156:157], v229 offset:24576
ds_read_b64_tr_b16 v[158:159], v229 offset:25088
ds_read_b64_tr_b16 v[160:161], v230 offset:24576
ds_read_b64_tr_b16 v[162:163], v230 offset:25088
ds_read_b64_tr_b16 v[164:165], v231 offset:24576
ds_read_b64_tr_b16 v[166:167], v231 offset:25088
buffer_load_dwordx4 v[24:27], v227, s[20:23], s61 offen offset:0 sc1
buffer_load_dwordx4 v[28:31], v227, s[20:23], s61 offen offset:256 sc1
buffer_load_dwordx4 v[32:35], v227, s[20:23], s61 offen offset:512 sc1
buffer_load_dwordx4 v[36:39], v227, s[20:23], s61 offen offset:768 sc1
buffer_load_dwordx4 v[40:43], v227, s[20:23], s61 offen offset:1024 sc1
ds_read_b64_tr_b16 v[168:169], v228 offset:32768
ds_read_b64_tr_b16 v[170:171], v228 offset:33280
ds_read_b64_tr_b16 v[172:173], v229 offset:32768
ds_read_b64_tr_b16 v[174:175], v229 offset:33280
ds_read_b64_tr_b16 v[176:177], v230 offset:32768
ds_read_b64_tr_b16 v[178:179], v230 offset:33280
ds_read_b64_tr_b16 v[180:181], v231 offset:32768
ds_read_b64_tr_b16 v[182:183], v231 offset:33280
v_add_u32 v228, s65, v228
ds_read_b64_tr_b16 v[184:185], v228 offset:0
ds_read_b64_tr_b16 v[186:187], v228 offset:512
v_add_u32 v229, s65, v229
ds_read_b64_tr_b16 v[188:189], v229 offset:0
ds_read_b64_tr_b16 v[190:191], v229 offset:512
v_add_u32 v230, s65, v230
ds_read_b64_tr_b16 v[192:193], v230 offset:0
ds_read_b64_tr_b16 v[194:195], v230 offset:512
v_add_u32 v231, s65, v231
ds_read_b64_tr_b16 v[196:197], v231 offset:0
ds_read_b64_tr_b16 v[198:199], v231 offset:512
s_branch L_pb_5
L_pad_6:
s_setpc_b64 s[100:101]
L_era:
s_sub_u32 s40, s40, 1
s_cbranch_scc1 L_exa
s_lshl_b32 s0, s33, 5
v_and_b32 v1, 16, v0
buffer_load_dword v32, v1, s[24:27], s0 offen sc1
s_waitcnt vmcnt(0)
s_waitcnt lgkmcnt(0)
v_cmp_ne_u32 vcc, 1, v32
s_cmp_eq_u64 vcc, 0
s_cbranch_scc0 L_era
s_branch L_ega
L_exa:
s_mov_b32 s40, 0
s_branch L_ega
L_erb:
s_sub_u32 s40, s40, 1
s_cbranch_scc1 L_exb
s_buffer_load_dword s71, s[16:19], s66 offset:0 glc
s_buffer_load_dword s73, s[16:19], s66 offset:128 glc
s_buffer_load_dword s75, s[16:19], s66 offset:256 glc
s_buffer_load_dword s77, s[16:19], s66 offset:384 glc
s_buffer_load_dword s83, s[16:19], s66 offset:512 glc
s_buffer_load_dword s85, s[16:19], s66 offset:640 glc
s_buffer_load_dword s89, s[16:19], s66 offset:768 glc
s_buffer_load_dword s91, s[16:19], s66 offset:896 glc
s_buffer_load_dword s93, s[16:19], s66 offset:1024 glc
s_buffer_load_dword s95, s[16:19], s66 offset:1152 glc
s_waitcnt lgkmcnt(0)
s_max_u32 s0, s71, s73
s_max_u32 s0, s0, s75
s_max_u32 s0, s0, s77
s_max_u32 s0, s0, s83
s_max_u32 s0, s0, s85
s_max_u32 s0, s0, s89
s_max_u32 s0, s0, s91
s_max_u32 s0, s0, s93
s_max_u32 s0, s0, s95
s_cmp_lg_u32 s0, -1
s_cbranch_scc0 L_erb
s_branch L_egb
L_exb:
s_mov_b32 s40, 0
s_branch L_egb
L_gh_3g:
s_barrier
s_cmp_eq_u32 s32, 5
s_cbranch_scc0 L_gh_3e
v_mov_b32 v1, 1
s_mov_b64 exec, 1
buffer_store_dword v1, off, s[16:19], s68 offset:64 sc1
s_mov_b64 exec, -1
L_gh_3p:
buffer_load_dword v1, v55, s[16:19], 0 offen offset:64 sc1
s_waitcnt vmcnt(0)
v_cmp_ne_u32 vcc, 1, v1
s_cbranch_vccz L_gh_3e
s_sub_u32 s40, s40, 1
s_cbranch_scc0 L_gh_3p
s_mov_b32 s40, 0
L_gh_3e:
s_barrier
s_branch L_gh_3b
L_xcap:
v_add_u32 v1, s0, v235
ds_read_b64 v[72:73], v1
v_xor_b32 v2, 32, v1
ds_read_b64 v[74:75], v2
v_xor_b32 v3, 64, v1
ds_read_b64 v[76:77], v3
v_xor_b32 v4, 96, v1
ds_read_b64 v[78:79], v4
s_setpc_b64 s[100:101]
L_gl_4g:
buffer_store_dwordx4 v[196:199], v226, s[20:23], 0 offen sc1
s_branch L_gl_4b
.p2align 12
L_pad_7:
s_setpc_b64 s[100:101]
L_pb_5:
s_waitcnt lgkmcnt(0)
s_waitcnt vmcnt(3)
v_max_u16 v2, v24, v28
v_cmp_eq_u16 vcc, -1, v2
s_cbranch_vccnz L_st0
L_go0:
s_mov_b64 exec, 1
ds_add_u32 v239, v240
s_mov_b64 exec, -1
v_mfma_f32_16x16x32_bf16 v[8:11], v[104:107], v[24:27], v[8:11]
buffer_load_dwordx4 v[44:47], v227, s[20:23], s62 offen offset:0 sc1
ds_read_b64_tr_b16 v[104:105], v228 offset:8192
v_mfma_f32_16x16x32_bf16 v[12:15], v[108:111], v[24:27], v[12:15]
ds_read_b64_tr_b16 v[106:107], v228 offset:8704
ds_read_b64_tr_b16 v[108:109], v229 offset:8192
v_mfma_f32_16x16x32_bf16 v[16:19], v[112:115], v[24:27], v[16:19]
ds_read_b64_tr_b16 v[110:111], v229 offset:8704
ds_read_b64_tr_b16 v[112:113], v230 offset:8192
v_mfma_f32_16x16x32_bf16 v[20:23], v[116:119], v[24:27], v[20:23]
ds_read_b64_tr_b16 v[114:115], v230 offset:8704
ds_read_b64_tr_b16 v[116:117], v231 offset:8192
v_mfma_f32_16x16x32_bf16 v[8:11], v[120:123], v[28:31], v[8:11]
buffer_load_dwordx4 v[48:51], v227, s[20:23], s62 offen offset:256 sc1
ds_read_b64_tr_b16 v[118:119], v231 offset:8704
v_mfma_f32_16x16x32_bf16 v[12:15], v[124:127], v[28:31], v[12:15]
ds_read_b64_tr_b16 v[120:121], v228 offset:16384
s_waitcnt vmcnt(3)
v_max_u16 v2, v32, v36
v_cmp_eq_u16 vcc, -1, v2
v_mfma_f32_16x16x32_bf16 v[16:19], v[128:131], v[28:31], v[16:19]
ds_read_b64_tr_b16 v[122:123], v228 offset:16896
s_cbranch_vccnz L_st1
L_go1:
v_mfma_f32_16x16x32_bf16 v[20:23], v[132:135], v[28:31], v[20:23]
ds_read_b64_tr_b16 v[124:125], v229 offset:16384
v_mfma_f32_16x16x32_bf16 v[8:11], v[136:139], v[32:35], v[8:11]
buffer_load_dwordx4 v[52:55], v227, s[20:23], s62 offen offset:512 sc1
ds_read_b64_tr_b16 v[126:127], v229 offset:16896
v_mfma_f32_16x16x32_bf16 v[12:15], v[140:143], v[32:35], v[12:15]
ds_read_b64_tr_b16 v[128:129], v230 offset:16384
ds_read_b64_tr_b16 v[130:131], v230 offset:16896
v_mfma_f32_16x16x32_bf16 v[16:19], v[144:147], v[32:35], v[16:19]
ds_read_b64_tr_b16 v[132:133], v231 offset:16384
ds_read_b64_tr_b16 v[134:135], v231 offset:16896
v_mfma_f32_16x16x32_bf16 v[20:23], v[148:151], v[32:35], v[20:23]
ds_read_b64_tr_b16 v[136:137], v228 offset:24576
ds_read_b64_tr_b16 v[138:139], v228 offset:25088
v_mfma_f32_16x16x32_bf16 v[8:11], v[152:155], v[36:39], v[8:11]
buffer_load_dwordx4 v[56:59], v236, s[20:23], s62 offen offset:0 sc1
ds_read_b64_tr_b16 v[140:141], v229 offset:24576
v_mfma_f32_16x16x32_bf16 v[12:15], v[156:159], v[36:39], v[12:15]
ds_read_b64_tr_b16 v[142:143], v229 offset:25088
s_waitcnt vmcnt(4)
v_cmp_eq_u16 vcc, -1, v40
v_mfma_f32_16x16x32_bf16 v[16:19], v[160:163], v[36:39], v[16:19]
ds_read_b64_tr_b16 v[144:145], v230 offset:24576
s_cbranch_vccnz L_st2
L_go2:
v_mfma_f32_16x16x32_bf16 v[20:23], v[164:167], v[36:39], v[20:23]
ds_read_b64_tr_b16 v[146:147], v230 offset:25088
v_mfma_f32_16x16x32_bf16 v[8:11], v[168:171], v[40:43], v[8:11]
buffer_load_dwordx4 v[60:63], v227, s[20:23], s62 offen offset:768 sc1
ds_read_b64_tr_b16 v[148:149], v231 offset:24576
v_mfma_f32_16x16x32_bf16 v[12:15], v[172:175], v[40:43], v[12:15]
ds_read_b64_tr_b16 v[150:151], v231 offset:25088
s_waitcnt vmcnt(3)
v_max_u16 v2, v44, v48
v_cmp_eq_u16 vcc, -1, v2
v_mfma_f32_16x16x32_bf16 v[16:19], v[176:179], v[40:43], v[16:19]
ds_read_b32 v1, v239
ds_read_b64_tr_b16 v[152:153], v228 offset:32768
s_cbranch_vccnz L_st3
L_go3:
v_mfma_f32_16x16x32_bf16 v[20:23], v[180:183], v[40:43], v[20:23]
ds_read_b64_tr_b16 v[154:155], v228 offset:33280
v_mfma_f32_16x16x32_bf16 v[8:11], v[184:187], v[44:47], v[8:11]
buffer_load_dwordx4 v[64:67], v236, s[20:23], s62 offen offset:256 sc1
ds_read_b64_tr_b16 v[156:157], v229 offset:32768
v_mfma_f32_16x16x32_bf16 v[12:15], v[188:191], v[44:47], v[12:15]
ds_read_b64_tr_b16 v[158:159], v229 offset:33280
ds_read_b64_tr_b16 v[160:161], v230 offset:32768
v_mfma_f32_16x16x32_bf16 v[16:19], v[192:195], v[44:47], v[16:19]
ds_read_b64_tr_b16 v[162:163], v230 offset:33280
ds_read_b64_tr_b16 v[164:165], v231 offset:32768
v_mfma_f32_16x16x32_bf16 v[20:23], v[196:199], v[44:47], v[20:23]
ds_read_b64_tr_b16 v[166:167], v231 offset:33280
s_waitcnt lgkmcnt(8)
v_cmp_ne_u32 vcc, 4, v1
s_cbranch_vccnz L_spw
L_sbw:
v_add_u32 v228, 40960, v228
ds_read_b64_tr_b16 v[168:169], v228 offset:0
v_mfma_f32_16x16x32_bf16 v[8:11], v[104:107], v[48:51], v[8:11]
buffer_load_dwordx4 v[68:71], v227, s[20:23], s62 offen offset:1024 sc1
ds_read_b64_tr_b16 v[170:171], v228 offset:512
v_mfma_f32_16x16x32_bf16 v[12:15], v[108:111], v[48:51], v[12:15]
v_add_u32 v229, 40960, v229
ds_read_b64_tr_b16 v[172:173], v229 offset:0
s_waitcnt vmcnt(3)
v_max_u16 v2, v52, v56
v_cmp_eq_u16 vcc, -1, v2
v_mfma_f32_16x16x32_bf16 v[16:19], v[112:115], v[48:51], v[16:19]
ds_read_b64_tr_b16 v[174:175], v229 offset:512
s_cbranch_vccnz L_st4
L_go4:
v_mfma_f32_16x16x32_bf16 v[20:23], v[116:119], v[48:51], v[20:23]
v_add_u32 v230, 40960, v230
ds_read_b64_tr_b16 v[176:177], v230 offset:0
v_mfma_f32_16x16x32_bf16 v[8:11], v[120:123], v[52:55], v[8:11]
buffer_load_dwordx4 v[72:75], v236, s[20:23], s62 offen offset:512 sc1
ds_read_b64_tr_b16 v[178:179], v230 offset:512
v_mfma_f32_16x16x32_bf16 v[12:15], v[124:127], v[52:55], v[12:15]
v_add_u32 v231, 40960, v231
ds_read_b64_tr_b16 v[180:181], v231 offset:0
ds_read_b64_tr_b16 v[182:183], v231 offset:512
v_mfma_f32_16x16x32_bf16 v[16:19], v[128:131], v[52:55], v[16:19]
v_mfma_f32_16x16x32_bf16 v[20:23], v[132:135], v[52:55], v[20:23]
v_mfma_f32_16x16x32_bf16 v[200:203], v[184:187], v[56:59], 0
buffer_load_dwordx4 v[76:79], v236, s[20:23], s62 offen offset:768 sc1
ds_read_b64_tr_b16 v[184:185], v228 offset:8192
v_mfma_f32_16x16x32_bf16 v[204:207], v[188:191], v[56:59], 0
ds_read_b64_tr_b16 v[186:187], v228 offset:8704
s_waitcnt vmcnt(3)
v_max_u16 v2, v60, v64
v_cmp_eq_u16 vcc, -1, v2
v_mfma_f32_16x16x32_bf16 v[208:211], v[192:195], v[56:59], 0
ds_read_b64_tr_b16 v[188:189], v229 offset:8192
s_cbranch_vccnz L_st5
L_go5:
v_mfma_f32_16x16x32_bf16 v[212:215], v[196:199], v[56:59], 0
ds_read_b64_tr_b16 v[190:191], v229 offset:8704
v_mfma_f32_16x16x32_bf16 v[8:11], v[136:139], v[60:63], v[8:11]
buffer_load_dwordx4 v[80:83], v236, s[20:23], s62 offen offset:1024 sc1
ds_read_b64_tr_b16 v[192:193], v230 offset:8192
v_mfma_f32_16x16x32_bf16 v[12:15], v[140:143], v[60:63], v[12:15]
ds_read_b64_tr_b16 v[194:195], v230 offset:8704
ds_read_b64_tr_b16 v[196:197], v231 offset:8192
v_mfma_f32_16x16x32_bf16 v[16:19], v[144:147], v[60:63], v[16:19]
ds_read_b64_tr_b16 v[198:199], v231 offset:8704
v_mfma_f32_16x16x32_bf16 v[20:23], v[148:151], v[60:63], v[20:23]
v_mfma_f32_16x16x32_bf16 v[200:203], v[104:107], v[64:67], v[200:203]
buffer_load_dwordx4 v[84:87], v236, s[20:23], s63 offen offset:0 sc1
ds_read_b64_tr_b16 v[104:105], v228 offset:16384
v_mfma_f32_16x16x32_bf16 v[204:207], v[108:111], v[64:67], v[204:207]
ds_read_b64_tr_b16 v[106:107], v228 offset:16896
s_waitcnt vmcnt(3)
v_max_u16 v2, v68, v72
v_cmp_eq_u16 vcc, -1, v2
v_mfma_f32_16x16x32_bf16 v[208:211], v[112:115], v[64:67], v[208:211]
ds_read_b64_tr_b16 v[108:109], v229 offset:16384
s_cbranch_vccnz L_st6
L_go6:
v_mfma_f32_16x16x32_bf16 v[212:215], v[116:119], v[64:67], v[212:215]
ds_read_b64_tr_b16 v[110:111], v229 offset:16896
s_waitcnt lgkmcnt(15)
v_mfma_f32_16x16x32_bf16 v[8:11], v[152:155], v[68:71], v[8:11]
buffer_load_dwordx4 v[88:91], v236, s[20:23], s63 offen offset:256 sc1
ds_read_b64_tr_b16 v[112:113], v230 offset:16384
v_mfma_f32_16x16x32_bf16 v[12:15], v[156:159], v[68:71], v[12:15]
ds_read_b64_tr_b16 v[114:115], v230 offset:16896
ds_read_b64_tr_b16 v[116:117], v231 offset:16384
v_mfma_f32_16x16x32_bf16 v[16:19], v[160:163], v[68:71], v[16:19]
ds_read_b64_tr_b16 v[118:119], v231 offset:16896
v_mfma_f32_16x16x32_bf16 v[20:23], v[164:167], v[68:71], v[20:23]
v_mfma_f32_16x16x32_bf16 v[200:203], v[120:123], v[72:75], v[200:203]
buffer_load_dwordx4 v[92:95], v236, s[20:23], s63 offen offset:512 sc1
ds_read_b64_tr_b16 v[120:121], v228 offset:24576
v_mfma_f32_16x16x32_bf16 v[204:207], v[124:127], v[72:75], v[204:207]
ds_read_b64_tr_b16 v[122:123], v228 offset:25088
s_waitcnt vmcnt(3)
v_max_u16 v2, v76, v80
v_cmp_eq_u16 vcc, -1, v2
v_mfma_f32_16x16x32_bf16 v[208:211], v[128:131], v[72:75], v[208:211]
ds_read_b64_tr_b16 v[124:125], v229 offset:24576
s_cbranch_vccnz L_st7
L_go7:
v_mfma_f32_16x16x32_bf16 v[212:215], v[132:135], v[72:75], v[212:215]
ds_read_b64_tr_b16 v[126:127], v229 offset:25088
v_mfma_f32_16x16x32_bf16 v[200:203], v[136:139], v[76:79], v[200:203]
buffer_load_dwordx4 v[96:99], v236, s[20:23], s63 offen offset:768 sc1
ds_read_b64_tr_b16 v[128:129], v230 offset:24576
v_mfma_f32_16x16x32_bf16 v[204:207], v[140:143], v[76:79], v[204:207]
ds_read_b64_tr_b16 v[130:131], v230 offset:25088
ds_read_b64_tr_b16 v[132:133], v231 offset:24576
v_mfma_f32_16x16x32_bf16 v[208:211], v[144:147], v[76:79], v[208:211]
ds_read_b64_tr_b16 v[134:135], v231 offset:25088
ds_read_b64_tr_b16 v[136:137], v228 offset:32768
v_mfma_f32_16x16x32_bf16 v[212:215], v[148:151], v[76:79], v[212:215]
ds_read_b64_tr_b16 v[138:139], v228 offset:33280
ds_read_b64_tr_b16 v[140:141], v229 offset:32768
v_mfma_f32_16x16x32_bf16 v[200:203], v[152:155], v[80:83], v[200:203]
buffer_load_dwordx4 v[100:103], v236, s[20:23], s63 offen offset:1024 sc1
ds_read_b64_tr_b16 v[142:143], v229 offset:33280
v_mfma_f32_16x16x32_bf16 v[204:207], v[156:159], v[80:83], v[204:207]
ds_read_b64_tr_b16 v[144:145], v230 offset:32768
s_waitcnt vmcnt(3)
v_max_u16 v2, v84, v88
v_cmp_eq_u16 vcc, -1, v2
v_mfma_f32_16x16x32_bf16 v[208:211], v[160:163], v[80:83], v[208:211]
ds_read_b64_tr_b16 v[146:147], v230 offset:33280
s_cbranch_vccnz L_st8
L_go8:
v_mfma_f32_16x16x32_bf16 v[212:215], v[164:167], v[80:83], v[212:215]
ds_read_b64_tr_b16 v[148:149], v231 offset:32768
s_waitcnt lgkmcnt(15)
v_mfma_f32_16x16x32_bf16 v[200:203], v[168:171], v[84:87], v[200:203]
buffer_load_dwordx4 v[24:27], v227, s[20:23], s63 offen offset:0 sc1
ds_read_b64_tr_b16 v[150:151], v231 offset:33280
v_mfma_f32_16x16x32_bf16 v[204:207], v[172:175], v[84:87], v[204:207]
v_subrev_u32 v228, s65, v228
ds_read_b64_tr_b16 v[152:153], v228 offset:0
ds_read_b64_tr_b16 v[154:155], v228 offset:512
v_mfma_f32_16x16x32_bf16 v[208:211], v[176:179], v[84:87], v[208:211]
v_subrev_u32 v229, s65, v229
ds_read_b64_tr_b16 v[156:157], v229 offset:0
ds_read_b64_tr_b16 v[158:159], v229 offset:512
v_mfma_f32_16x16x32_bf16 v[212:215], v[180:183], v[84:87], v[212:215]
v_subrev_u32 v230, s65, v230
ds_read_b64_tr_b16 v[160:161], v230 offset:0
ds_read_b64_tr_b16 v[162:163], v230 offset:512
v_mfma_f32_16x16x32_bf16 v[200:203], v[184:187], v[88:91], v[200:203]
buffer_load_dwordx4 v[28:31], v227, s[20:23], s63 offen offset:256 sc1
v_subrev_u32 v231, s65, v231
ds_read_b64_tr_b16 v[164:165], v231 offset:0
v_mfma_f32_16x16x32_bf16 v[204:207], v[188:191], v[88:91], v[204:207]
ds_read_b64_tr_b16 v[166:167], v231 offset:512
s_waitcnt vmcnt(3)
v_max_u16 v2, v92, v96
v_cmp_eq_u16 vcc, -1, v2
v_mfma_f32_16x16x32_bf16 v[208:211], v[192:195], v[88:91], v[208:211]
s_cbranch_vccnz L_st9
L_go9:
v_mfma_f32_16x16x32_bf16 v[212:215], v[196:199], v[88:91], v[212:215]
v_mfma_f32_16x16x32_bf16 v[200:203], v[104:107], v[92:95], v[200:203]
buffer_load_dwordx4 v[32:35], v227, s[20:23], s63 offen offset:512 sc1
v_mfma_f32_16x16x32_bf16 v[204:207], v[108:111], v[92:95], v[204:207]
v_mfma_f32_16x16x32_bf16 v[208:211], v[112:115], v[92:95], v[208:211]
v_mfma_f32_16x16x32_bf16 v[212:215], v[116:119], v[92:95], v[212:215]
s_waitcnt lgkmcnt(15)
v_mfma_f32_16x16x32_bf16 v[200:203], v[120:123], v[96:99], v[200:203]
buffer_load_dwordx4 v[36:39], v227, s[20:23], s63 offen offset:768 sc1
v_mfma_f32_16x16x32_bf16 v[204:207], v[124:127], v[96:99], v[204:207]
s_waitcnt vmcnt(3)
v_max_u16 v2, v100, v24
v_cmp_eq_u16 vcc, -1, v2
v_mfma_f32_16x16x32_bf16 v[208:211], v[128:131], v[96:99], v[208:211]
s_cbranch_vccnz L_st10
L_go10:
v_mfma_f32_16x16x32_bf16 v[212:215], v[132:135], v[96:99], v[212:215]
s_waitcnt lgkmcnt(8)
v_mfma_f32_16x16x32_bf16 v[200:203], v[136:139], v[100:103], v[200:203]
buffer_load_dwordx4 v[40:43], v227, s[20:23], s63 offen offset:1024 sc1
v_mfma_f32_16x16x32_bf16 v[204:207], v[140:143], v[100:103], v[204:207]
v_mfma_f32_16x16x32_bf16 v[208:211], v[144:147], v[100:103], v[208:211]
v_mfma_f32_16x16x32_bf16 v[212:215], v[148:151], v[100:103], v[212:215]
v_mfma_f32_16x16x32_bf16 v[8:11], v[168:171], v[24:27], v[8:11]
buffer_load_dwordx4 v[44:47], v227, s[20:23], s64 offen offset:0 sc1
ds_read_b64_tr_b16 v[168:169], v228 offset:8192
v_mfma_f32_16x16x32_bf16 v[12:15], v[172:175], v[24:27], v[12:15]
ds_write_b128 v237, v[200:203] offset:0
s_waitcnt vmcnt(3)
v_max_u16 v2, v28, v32
v_cmp_eq_u16 vcc, -1, v2
v_mfma_f32_16x16x32_bf16 v[16:19], v[176:179], v[24:27], v[16:19]
ds_write_b128 v237, v[204:207] offset:1024
s_cbranch_vccnz L_st11
L_go11:
v_mfma_f32_16x16x32_bf16 v[20:23], v[180:183], v[24:27], v[20:23]
ds_write_b128 v237, v[208:211] offset:2048
v_mfma_f32_16x16x32_bf16 v[8:11], v[184:187], v[28:31], v[8:11]
buffer_load_dwordx4 v[48:51], v227, s[20:23], s64 offen offset:256 sc1
ds_read_b64_tr_b16 v[170:171], v228 offset:8704
v_mfma_f32_16x16x32_bf16 v[12:15], v[188:191], v[28:31], v[12:15]
ds_read_b64_tr_b16 v[172:173], v229 offset:8192
ds_read_b64_tr_b16 v[174:175], v229 offset:8704
v_mfma_f32_16x16x32_bf16 v[16:19], v[192:195], v[28:31], v[16:19]
ds_write_b128 v237, v[212:215] offset:3072
v_mfma_f32_16x16x32_bf16 v[20:23], v[196:199], v[28:31], v[20:23]
s_mov_b64 exec, 1
ds_add_u32 v238, v240
s_mov_b64 exec, -1
v_mfma_f32_16x16x32_bf16 v[8:11], v[104:107], v[32:35], v[8:11]
buffer_load_dwordx4 v[52:55], v227, s[20:23], s64 offen offset:512 sc1
ds_read_b64_tr_b16 v[176:177], v230 offset:8192
v_mfma_f32_16x16x32_bf16 v[12:15], v[108:111], v[32:35], v[12:15]
ds_read_b64_tr_b16 v[178:179], v230 offset:8704
s_waitcnt vmcnt(3)
v_max_u16 v2, v36, v40
v_cmp_eq_u16 vcc, -1, v2
v_mfma_f32_16x16x32_bf16 v[16:19], v[112:115], v[32:35], v[16:19]
ds_read_b64_tr_b16 v[180:181], v231 offset:8192
s_cbranch_vccnz L_st12
L_go12:
v_mfma_f32_16x16x32_bf16 v[20:23], v[116:119], v[32:35], v[20:23]
ds_read_b64_tr_b16 v[182:183], v231 offset:8704
v_mfma_f32_16x16x32_bf16 v[8:11], v[120:123], v[36:39], v[8:11]
buffer_load_dwordx4 v[56:59], v227, s[20:23], s64 offen offset:768 sc1
ds_read_b64_tr_b16 v[184:185], v228 offset:16384
v_mfma_f32_16x16x32_bf16 v[12:15], v[124:127], v[36:39], v[12:15]
ds_read_b64_tr_b16 v[186:187], v228 offset:16896
ds_read_b64_tr_b16 v[188:189], v229 offset:16384
v_mfma_f32_16x16x32_bf16 v[16:19], v[128:131], v[36:39], v[16:19]
ds_read_b64_tr_b16 v[190:191], v229 offset:16896
ds_read_b64_tr_b16 v[192:193], v230 offset:16384
v_mfma_f32_16x16x32_bf16 v[20:23], v[132:135], v[36:39], v[20:23]
ds_read_b64_tr_b16 v[194:195], v230 offset:16896
ds_read_b64_tr_b16 v[196:197], v231 offset:16384
v_mfma_f32_16x16x32_bf16 v[8:11], v[136:139], v[40:43], v[8:11]
buffer_load_dwordx4 v[60:63], v227, s[20:23], s64 offen offset:1024 sc1
ds_read_b64_tr_b16 v[198:199], v231 offset:16896
v_mfma_f32_16x16x32_bf16 v[12:15], v[140:143], v[40:43], v[12:15]
ds_read_b64_tr_b16 v[104:105], v228 offset:24576
s_waitcnt vmcnt(3)
v_max_u16 v2, v44, v48
v_cmp_eq_u16 vcc, -1, v2
v_mfma_f32_16x16x32_bf16 v[16:19], v[144:147], v[40:43], v[16:19]
ds_read_b64_tr_b16 v[106:107], v228 offset:25088
s_cbranch_vccnz L_st13
L_go13:
v_mfma_f32_16x16x32_bf16 v[20:23], v[148:151], v[40:43], v[20:23]
ds_read_b64_tr_b16 v[108:109], v229 offset:24576
s_waitcnt lgkmcnt(15)
v_mfma_f32_16x16x32_bf16 v[8:11], v[152:155], v[44:47], v[8:11]
ds_read_b64_tr_b16 v[110:111], v229 offset:25088
ds_read_b64_tr_b16 v[112:113], v230 offset:24576
v_mfma_f32_16x16x32_bf16 v[12:15], v[156:159], v[44:47], v[12:15]
ds_read_b64_tr_b16 v[114:115], v230 offset:25088
ds_read_b64_tr_b16 v[116:117], v231 offset:24576
v_mfma_f32_16x16x32_bf16 v[16:19], v[160:163], v[44:47], v[16:19]
ds_read_b64_tr_b16 v[118:119], v231 offset:25088
ds_read_b64_tr_b16 v[120:121], v228 offset:32768
v_mfma_f32_16x16x32_bf16 v[20:23], v[164:167], v[44:47], v[20:23]
ds_read_b64_tr_b16 v[122:123], v228 offset:33280
ds_read_b64_tr_b16 v[124:125], v229 offset:32768
s_waitcnt lgkmcnt(15)
v_mfma_f32_16x16x32_bf16 v[8:11], v[168:171], v[48:51], v[8:11]
ds_read_b64_tr_b16 v[126:127], v229 offset:33280
ds_read_b64_tr_b16 v[128:129], v230 offset:32768
v_mfma_f32_16x16x32_bf16 v[12:15], v[172:175], v[48:51], v[12:15]
ds_read_b64_tr_b16 v[130:131], v230 offset:33280
s_waitcnt vmcnt(1)
v_max_u16 v2, v52, v56
v_cmp_eq_u16 vcc, -1, v2
v_mfma_f32_16x16x32_bf16 v[16:19], v[176:179], v[48:51], v[16:19]
ds_read_b64_tr_b16 v[132:133], v231 offset:32768
s_cbranch_vccnz L_st14
L_go14:
v_mfma_f32_16x16x32_bf16 v[20:23], v[180:183], v[48:51], v[20:23]
ds_read_b64_tr_b16 v[134:135], v231 offset:33280
s_waitcnt lgkmcnt(15)
v_mfma_f32_16x16x32_bf16 v[8:11], v[184:187], v[52:55], v[8:11]
v_mfma_f32_16x16x32_bf16 v[12:15], v[188:191], v[52:55], v[12:15]
v_mfma_f32_16x16x32_bf16 v[16:19], v[192:195], v[52:55], v[16:19]
v_mfma_f32_16x16x32_bf16 v[20:23], v[196:199], v[52:55], v[20:23]
s_waitcnt lgkmcnt(8)
v_mfma_f32_16x16x32_bf16 v[8:11], v[104:107], v[56:59], v[8:11]
v_mfma_f32_16x16x32_bf16 v[12:15], v[108:111], v[56:59], v[12:15]
s_waitcnt vmcnt(0)
v_cmp_eq_u16 vcc, -1, v60
v_mfma_f32_16x16x32_bf16 v[16:19], v[112:115], v[56:59], v[16:19]
s_cbranch_vccnz L_st15
L_go15:
v_mfma_f32_16x16x32_bf16 v[20:23], v[116:119], v[56:59], v[20:23]
s_waitcnt lgkmcnt(6)
v_mfma_f32_16x16x32_bf16 v[8:11], v[120:123], v[60:63], v[8:11]
s_waitcnt lgkmcnt(4)
v_mfma_f32_16x16x32_bf16 v[12:15], v[124:127], v[60:63], v[12:15]
s_waitcnt lgkmcnt(2)
v_mfma_f32_16x16x32_bf16 v[16:19], v[128:131], v[60:63], v[16:19]
s_waitcnt lgkmcnt(0)
v_mfma_f32_16x16x32_bf16 v[20:23], v[132:135], v[60:63], v[20:23]
L_tail:
s_nop 1
v_cvt_pk_bf16_f32 v24, v8, v9
v_cvt_pk_bf16_f32 v25, v10, v11
v_cvt_pk_bf16_f32 v26, v12, v13
v_cvt_pk_bf16_f32 v27, v14, v15
v_cvt_pk_bf16_f32 v28, v16, v17
v_cvt_pk_bf16_f32 v29, v18, v19
v_cvt_pk_bf16_f32 v30, v20, v21
v_cvt_pk_bf16_f32 v31, v22, v23
v_mfma_f32_16x16x32_bf16 v[36:39], v[24:27], v[24:27], 0
v_mfma_f32_16x16x32_bf16 v[32:35], v[244:247], v[24:27], 0
v_mfma_f32_16x16x32_bf16 v[36:39], v[28:31], v[28:31], v[36:39]
v_mfma_f32_16x16x32_bf16 v[32:35], v[248:251], v[28:31], v[32:35]
s_mov_b32 s0, 0x22222222
s_mov_b32 s1, s0
s_mov_b32 s44, 0x44444444
s_mov_b32 s45, s44
s_mov_b32 vcc_lo, 0x88888888
s_mov_b32 vcc_hi, 0x88888888
s_lshl_b32 s3, s36, 8
s_add_u32 s3, s3, s58
v_and_b32 v1, 0xf0, v233
v_cndmask_b32 v36, v36, v37, s[0:1]
v_cndmask_b32 v38, v38, v39, vcc
s_or_b64 vcc, vcc, s[44:45]
v_cndmask_b32 v34, v36, v38, vcc
v_mov_b32 v35, v253
s_mov_b32 exec_lo, 0xf0000f
s_mov_b32 exec_hi, 0xf0000f00
s_cmp_eq_u32 s41, 1
s_cbranch_scc0 L_gl_8g
buffer_store_dwordx4 v[32:35], v1, s[16:19], s3 offen
L_gl_8b:
s_mov_b64 exec, -1
v_mov_b32 v48, 0
v_mov_b32 v49, 0
v_mov_b32 v50, 0
v_mov_b32 v51, 0
v_mov_b32 v4, 1.0
s_mov_b32 s0, 0xbacccccd
s_mov_b32 s1, 0x3acccccd
v_mov_b32 v5, 0x3727c5ac
s_mov_b32 s44, 0xfffff800
v_mov_b32 v1, 1732
v_cmp_le_i32 s[46:47], 0, v232
s_mul_i32 s48, s35, 1280
s_lshl_b32 s3, s36, 7
s_add_u32 s48, s48, s3
s_lshl_b32 s49, s48, 1
s_add_u32 s48, s48, s59
s_add_u32 s49, s49, s59
s_add_u32 s49, s49, 4096
s_lshl_b32 s3, s35, 7
s_add_u32 s3, s3, s59
s_add_u32 s3, s3, 21504
s_and_b32 s45, s36, 15
s_lshl_b32 s45, s45, 3
s_add_u32 s45, s45, s32
v_mul_u32_u24 v70, 384, v0
v_and_b32 v69, 48, v0
v_lshlrev_b32 v68, 1, v69
s_add_u32 s45, s36, 5
v_mov_b32 v71, 1
L_e2:
buffer_load_dwordx4 v[40:43], v233, s[16:19], s58 offen sc1
buffer_load_dwordx4 v[44:47], v233, s[16:19], s58 offen offset:1024 sc1
s_mov_b32 exec_hi, 0
buffer_load_dwordx4 v[48:51], v233, s[16:19], s58 offen offset:2048 sc1
s_mov_b32 exec_hi, -1
s_sub_u32 s40, s40, 1
s_waitcnt vmcnt(1)
v_pk_add_f32 v[40:41], v[40:41], v[44:45]
v_pk_add_f32 v[42:43], v[42:43], v[46:47]
s_waitcnt vmcnt(0)
v_pk_add_f32 v[40:41], v[40:41], v[48:49]
v_pk_add_f32 v[42:43], v[42:43], v[50:51]
v_cmp_u_f32 vcc, v40, v40
s_cbranch_scc1 L_e2go
s_cbranch_vccnz L_e2
L_e2go:
v_mfma_f32_16x16x4_f32 v[52:55], v4, v40, 0
v_mfma_f32_16x16x4_f32 v[60:63], v4, v42, 0
v_mfma_f32_16x16x4_f32 v[64:67], v4, v43, 0
v_mfma_f32_16x16x4_f32 v[56:59], v4, v41, 0
s_nop 6
v_mul_f32 v6, s0, v52
v_fma_f32 v7, v60, s1, v5
v_fma_f32 v7, -v6, v6, v7
v_max_f32 v7, v7, v5
v_rsq_f32 v2, v7
v_fma_f32 v7, v6, v64, v56
v_mul_f32 v7, v7, v2
v_mul_f32 v3, v6, v2
v_ashrrev_i32 v6, 31, v7
v_or_b32 v6, 0x80000000, v6
v_xor_b32 v7, v7, v6
v_and_or_b32 v7, v7, s44, v234
v_cndmask_b32 v7, 0, v7, s[46:47]
v_pk_fma_f32 v[72:73], v[8:9], v[2:3], v[2:3] op_sel:[0,0,1] op_sel_hi:[1,0,1]
v_pk_fma_f32 v[74:75], v[10:11], v[2:3], v[2:3] op_sel:[0,0,1] op_sel_hi:[1,0,1]
v_max_u32_dpp v6, v7, v7 row_ror:8 row_mask:0xf bank_mask:0xf
s_mov_b64 exec, 255
ds_max_u32 v1, v6
s_mov_b64 exec, 1
ds_add_rtn_u32 v71, v1, v71 offset:4
s_mov_b64 exec, -1
ds_read_b32 v6, v1
v_pk_fma_f32 v[76:77], v[12:13], v[2:3], v[2:3] op_sel:[0,0,1] op_sel_hi:[1,0,1]
v_pk_fma_f32 v[78:79], v[14:15], v[2:3], v[2:3] op_sel:[0,0,1] op_sel_hi:[1,0,1]
v_pk_fma_f32 v[80:81], v[16:17], v[2:3], v[2:3] op_sel:[0,0,1] op_sel_hi:[1,0,1]
v_pk_fma_f32 v[82:83], v[18:19], v[2:3], v[2:3] op_sel:[0,0,1] op_sel_hi:[1,0,1]
v_pk_fma_f32 v[84:85], v[20:21], v[2:3], v[2:3] op_sel:[0,0,1] op_sel_hi:[1,0,1]
v_pk_fma_f32 v[86:87], v[22:23], v[2:3], v[2:3] op_sel:[0,0,1] op_sel_hi:[1,0,1]
v_cvt_pk_bf16_f32 v88, v72, v73
v_cvt_pk_bf16_f32 v89, v74, v75
v_cvt_pk_bf16_f32 v90, v76, v77
v_cvt_pk_bf16_f32 v91, v78, v79
s_waitcnt lgkmcnt(0)
v_readfirstlane_b32 s0, v71
s_cmp_eq_u32 s0, s45
s_cbranch_scc0 L_nk
s_mov_b64 exec, 0xffff
buffer_store_dword v6, v70, s[16:19], s3 offen sc1
s_mov_b64 exec, -1
L_nk:
s_barrier
ds_read_b32 v1, v1
v_cvt_pk_bf16_f32 v92, v80, v81
v_cvt_pk_bf16_f32 v93, v82, v83
v_cvt_pk_bf16_f32 v94, v84, v85
v_cvt_pk_bf16_f32 v95, v86, v87
v_pk_add_f32 v[72:73], v[72:73], v[8:9]
v_pk_add_f32 v[74:75], v[74:75], v[10:11]
v_pk_add_f32 v[76:77], v[76:77], v[12:13]
v_pk_add_f32 v[78:79], v[78:79], v[14:15]
v_pk_add_f32 v[80:81], v[80:81], v[16:17]
v_pk_add_f32 v[82:83], v[82:83], v[18:19]
v_pk_add_f32 v[84:85], v[84:85], v[20:21]
v_pk_add_f32 v[86:87], v[86:87], v[22:23]
s_waitcnt lgkmcnt(0)
v_cmp_eq_u32 s[46:47], v1, v7
s_and_b64 exec, s[46:47], -1
s_cbranch_scc0 L_nc
buffer_store_dwordx4 v[88:91], v68, s[16:19], s48 offen sc1
buffer_store_dwordx4 v[92:95], v68, s[16:19], s48 offen offset:16 sc1
L_nc:
s_mov_b64 exec, -1
v_cvt_pk_bf16_f32 v96, v72, v73
v_cvt_pk_bf16_f32 v97, v74, v75
v_cvt_pk_bf16_f32 v98, v76, v77
v_cvt_pk_bf16_f32 v99, v78, v79
v_cvt_pk_bf16_f32 v100, v80, v81
v_cvt_pk_bf16_f32 v101, v82, v83
v_cvt_pk_bf16_f32 v102, v84, v85
v_cvt_pk_bf16_f32 v103, v86, v87
v_permlane16_swap_b32 v96, v98
v_permlane16_swap_b32 v97, v99
v_permlane16_swap_b32 v100, v102
v_permlane16_swap_b32 v101, v103
s_not_b64 exec, s[46:47]
buffer_store_dwordx4 v[96:99], v232, s[20:23], 0 offen offset:0
buffer_store_dwordx4 v[100:103], v232, s[20:23], 0 offen offset:64
s_and_b64 exec, s[46:47], -1
s_cbranch_scc0 L_fin
buffer_store_dwordx4 v[96:99], v232, s[20:23], 0 offen offset:0 sc1
buffer_store_dwordx4 v[100:103], v232, s[20:23], 0 offen offset:64 sc1
s_waitcnt vmcnt(0)
buffer_store_dwordx4 v[72:75], v69, s[16:19], s49 offen offset:0 sc1
buffer_store_dwordx4 v[76:79], v69, s[16:19], s49 offen offset:64 sc1
buffer_store_dwordx4 v[80:83], v69, s[16:19], s49 offen offset:128 sc1
buffer_store_dwordx4 v[84:87], v69, s[16:19], s49 offen offset:192 sc1
L_fin:
s_endpgm
.p2align 12
L_pb_9:
L_pad_10:
s_setpc_b64 s[100:101]
L_woe1:
s_addk_i32 m0, 4096
s_mov_b32 s3, 0
buffer_load_dwordx4 v57, s[12:15], s3 offen lds
s_addk_i32 m0, 4096
s_mov_b32 s3, 81920
buffer_load_dwordx4 v57, s[12:15], s3 offen lds
s_addk_i32 m0, 4096
s_mov_b32 s3, 163840
buffer_load_dwordx4 v58, s[12:15], s3 offen lds
s_addk_i32 m0, 4096
s_mov_b32 s3, 245760
buffer_load_dwordx4 v60, s[12:15], s3 offen lds
s_addk_i32 m0, 4096
s_mov_b32 s3, 327680
buffer_load_dwordx4 v60, s[12:15], s3 offen lds
s_addk_i32 m0, 4096
s_mov_b32 s3, 409600
buffer_load_dwordx4 v57, s[12:15], s3 offen lds
s_addk_i32 m0, 4096
s_mov_b32 s3, 491520
buffer_load_dwordx4 v57, s[12:15], s3 offen lds
s_addk_i32 m0, 4096
s_mov_b32 s3, 573440
buffer_load_dwordx4 v58, s[12:15], s3 offen lds
s_addk_i32 m0, 4096
s_mov_b32 s3, 655360
buffer_load_dwordx4 v60, s[12:15], s3 offen lds
s_addk_i32 m0, 4096
s_mov_b32 s3, 737280
buffer_load_dwordx4 v60, s[12:15], s3 offen lds
s_branch L_woe
L_woe2:
s_addk_i32 m0, 4096
s_mov_b32 s3, 5120
buffer_load_dwordx4 v57, s[12:15], s3 offen lds
s_addk_i32 m0, 4096
s_mov_b32 s3, 87040
buffer_load_dwordx4 v58, s[12:15], s3 offen lds
s_addk_i32 m0, 4096
s_mov_b32 s3, 168960
buffer_load_dwordx4 v58, s[12:15], s3 offen lds
s_addk_i32 m0, 4096
s_mov_b32 s3, 250880
buffer_load_dwordx4 v60, s[12:15], s3 offen lds
s_addk_i32 m0, 4096
s_mov_b32 s3, 384000
buffer_load_dwordx4 v59, s[12:15], s3 offen lds
s_addk_i32 m0, 4096
s_mov_b32 s3, 414720
buffer_load_dwordx4 v57, s[12:15], s3 offen lds
s_addk_i32 m0, 4096
s_mov_b32 s3, 496640
buffer_load_dwordx4 v58, s[12:15], s3 offen lds
s_addk_i32 m0, 4096
s_mov_b32 s3, 578560
buffer_load_dwordx4 v58, s[12:15], s3 offen lds
s_addk_i32 m0, 4096
s_mov_b32 s3, 660480
buffer_load_dwordx4 v60, s[12:15], s3 offen lds
s_addk_i32 m0, 4096
s_mov_b32 s3, 793600
buffer_load_dwordx4 v59, s[12:15], s3 offen lds
s_branch L_woe
L_woe3:
s_addk_i32 m0, 4096
s_mov_b32 s3, 10240
buffer_load_dwordx4 v58, s[12:15], s3 offen lds
s_addk_i32 m0, 4096
s_mov_b32 s3, 92160
buffer_load_dwordx4 v58, s[12:15], s3 offen lds
s_addk_i32 m0, 4096
s_mov_b32 s3, 174080
buffer_load_dwordx4 v58, s[12:15], s3 offen lds
s_addk_i32 m0, 4096
s_mov_b32 s3, 307200
buffer_load_dwordx4 v59, s[12:15], s3 offen lds
s_addk_i32 m0, 4096
s_mov_b32 s3, 389120
buffer_load_dwordx4 v59, s[12:15], s3 offen lds
s_addk_i32 m0, 4096
s_mov_b32 s3, 419840
buffer_load_dwordx4 v58, s[12:15], s3 offen lds
s_addk_i32 m0, 4096
s_mov_b32 s3, 501760
buffer_load_dwordx4 v58, s[12:15], s3 offen lds
s_addk_i32 m0, 4096
s_mov_b32 s3, 583680
buffer_load_dwordx4 v58, s[12:15], s3 offen lds
s_addk_i32 m0, 4096
s_mov_b32 s3, 716800
buffer_load_dwordx4 v59, s[12:15], s3 offen lds
s_addk_i32 m0, 4096
s_mov_b32 s3, 798720
buffer_load_dwordx4 v59, s[12:15], s3 offen lds
s_branch L_woe
L_spw:
v_mov_b32 v1, 1744
ds_read_b32 v1, v1
s_waitcnt lgkmcnt(0)
v_cmp_ne_u32 vcc, 4, v1
s_cbranch_vccnz L_spw
s_branch L_sbw
L_st0:
s_sub_u32 s40, s40, 1
s_cbranch_scc1 L_sx0
buffer_load_dwordx4 v[24:27], v227, s[20:23], s61 offen offset:0 sc1
buffer_load_dwordx4 v[28:31], v227, s[20:23], s61 offen offset:256 sc1
buffer_load_dwordx4 v[32:35], v227, s[20:23], s61 offen offset:512 sc1
buffer_load_dwordx4 v[36:39], v227, s[20:23], s61 offen offset:768 sc1
buffer_load_dwordx4 v[40:43], v227, s[20:23], s61 offen offset:1024 sc1
s_waitcnt vmcnt(0)
v_max_u16 v2, v24, v28
v_cmp_eq_u16 vcc, -1, v2
s_cbranch_vccnz L_st0
s_branch L_go0
L_sx0:
s_mov_b32 s40, 0
s_branch L_go0
L_pad_11:
s_setpc_b64 s[100:101]
L_st1:
s_sub_u32 s40, s40, 1
s_cbranch_scc1 L_sx1
buffer_load_dwordx4 v[32:35], v227, s[20:23], s61 offen offset:512 sc1
buffer_load_dwordx4 v[36:39], v227, s[20:23], s61 offen offset:768 sc1
buffer_load_dwordx4 v[40:43], v227, s[20:23], s61 offen offset:1024 sc1
buffer_load_dwordx4 v[44:47], v227, s[20:23], s62 offen offset:0 sc1
buffer_load_dwordx4 v[48:51], v227, s[20:23], s62 offen offset:256 sc1
s_waitcnt vmcnt(0)
v_max_u16 v2, v32, v36
v_cmp_eq_u16 vcc, -1, v2
s_cbranch_vccnz L_st1
s_branch L_go1
L_sx1:
s_mov_b32 s40, 0
s_branch L_go1
L_st2:
s_sub_u32 s40, s40, 1
s_cbranch_scc1 L_sx2
buffer_load_dwordx4 v[40:43], v227, s[20:23], s61 offen offset:1024 sc1
buffer_load_dwordx4 v[44:47], v227, s[20:23], s62 offen offset:0 sc1
buffer_load_dwordx4 v[48:51], v227, s[20:23], s62 offen offset:256 sc1
buffer_load_dwordx4 v[52:55], v227, s[20:23], s62 offen offset:512 sc1
buffer_load_dwordx4 v[56:59], v236, s[20:23], s62 offen offset:0 sc1
s_waitcnt vmcnt(0)
v_cmp_eq_u16 vcc, -1, v40
s_cbranch_vccnz L_st2
s_branch L_go2
L_sx2:
s_mov_b32 s40, 0
s_branch L_go2
L_st3:
s_sub_u32 s40, s40, 1
s_cbranch_scc1 L_sx3
buffer_load_dwordx4 v[44:47], v227, s[20:23], s62 offen offset:0 sc1
buffer_load_dwordx4 v[48:51], v227, s[20:23], s62 offen offset:256 sc1
buffer_load_dwordx4 v[52:55], v227, s[20:23], s62 offen offset:512 sc1
buffer_load_dwordx4 v[56:59], v236, s[20:23], s62 offen offset:0 sc1
buffer_load_dwordx4 v[60:63], v227, s[20:23], s62 offen offset:768 sc1
s_waitcnt vmcnt(0)
v_max_u16 v2, v44, v48
v_cmp_eq_u16 vcc, -1, v2
s_cbranch_vccnz L_st3
s_branch L_go3
L_sx3:
s_mov_b32 s40, 0
s_branch L_go3
L_st4:
s_sub_u32 s40, s40, 1
s_cbranch_scc1 L_sx4
buffer_load_dwordx4 v[52:55], v227, s[20:23], s62 offen offset:512 sc1
buffer_load_dwordx4 v[56:59], v236, s[20:23], s62 offen offset:0 sc1
buffer_load_dwordx4 v[60:63], v227, s[20:23], s62 offen offset:768 sc1
buffer_load_dwordx4 v[64:67], v236, s[20:23], s62 offen offset:256 sc1
buffer_load_dwordx4 v[68:71], v227, s[20:23], s62 offen offset:1024 sc1
s_waitcnt vmcnt(0)
v_max_u16 v2, v52, v56
v_cmp_eq_u16 vcc, -1, v2
s_cbranch_vccnz L_st4
s_branch L_go4
L_sx4:
s_mov_b32 s40, 0
s_branch L_go4
L_st5:
s_sub_u32 s40, s40, 1
s_cbranch_scc1 L_sx5
buffer_load_dwordx4 v[60:63], v227, s[20:23], s62 offen offset:768 sc1
buffer_load_dwordx4 v[64:67], v236, s[20:23], s62 offen offset:256 sc1
buffer_load_dwordx4 v[68:71], v227, s[20:23], s62 offen offset:1024 sc1
buffer_load_dwordx4 v[72:75], v236, s[20:23], s62 offen offset:512 sc1
buffer_load_dwordx4 v[76:79], v236, s[20:23], s62 offen offset:768 sc1
s_waitcnt vmcnt(0)
v_max_u16 v2, v60, v64
v_cmp_eq_u16 vcc, -1, v2
s_cbranch_vccnz L_st5
s_branch L_go5
L_sx5:
s_mov_b32 s40, 0
s_branch L_go5
L_st6:
s_sub_u32 s40, s40, 1
s_cbranch_scc1 L_sx6
buffer_load_dwordx4 v[68:71], v227, s[20:23], s62 offen offset:1024 sc1
buffer_load_dwordx4 v[72:75], v236, s[20:23], s62 offen offset:512 sc1
buffer_load_dwordx4 v[76:79], v236, s[20:23], s62 offen offset:768 sc1
buffer_load_dwordx4 v[80:83], v236, s[20:23], s62 offen offset:1024 sc1
buffer_load_dwordx4 v[84:87], v236, s[20:23], s63 offen offset:0 sc1
s_waitcnt vmcnt(0)
v_max_u16 v2, v68, v72
v_cmp_eq_u16 vcc, -1, v2
s_cbranch_vccnz L_st6
s_branch L_go6
L_sx6:
s_mov_b32 s40, 0
s_branch L_go6
L_st7:
s_sub_u32 s40, s40, 1
s_cbranch_scc1 L_sx7
buffer_load_dwordx4 v[76:79], v236, s[20:23], s62 offen offset:768 sc1
buffer_load_dwordx4 v[80:83], v236, s[20:23], s62 offen offset:1024 sc1
buffer_load_dwordx4 v[84:87], v236, s[20:23], s63 offen offset:0 sc1
buffer_load_dwordx4 v[88:91], v236, s[20:23], s63 offen offset:256 sc1
buffer_load_dwordx4 v[92:95], v236, s[20:23], s63 offen offset:512 sc1
s_waitcnt vmcnt(0)
v_max_u16 v2, v76, v80
v_cmp_eq_u16 vcc, -1, v2
s_cbranch_vccnz L_st7
s_branch L_go7
L_sx7:
s_mov_b32 s40, 0
s_branch L_go7
L_pad_12:
s_setpc_b64 s[100:101]
L_st8:
s_sub_u32 s40, s40, 1
s_cbranch_scc1 L_sx8
buffer_load_dwordx4 v[84:87], v236, s[20:23], s63 offen offset:0 sc1
buffer_load_dwordx4 v[88:91], v236, s[20:23], s63 offen offset:256 sc1
buffer_load_dwordx4 v[92:95], v236, s[20:23], s63 offen offset:512 sc1
buffer_load_dwordx4 v[96:99], v236, s[20:23], s63 offen offset:768 sc1
buffer_load_dwordx4 v[100:103], v236, s[20:23], s63 offen offset:1024 sc1
s_waitcnt vmcnt(0)
v_max_u16 v2, v84, v88
v_cmp_eq_u16 vcc, -1, v2
s_cbranch_vccnz L_st8
s_branch L_go8
L_sx8:
s_mov_b32 s40, 0
s_branch L_go8
L_st9:
s_sub_u32 s40, s40, 1
s_cbranch_scc1 L_sx9
buffer_load_dwordx4 v[92:95], v236, s[20:23], s63 offen offset:512 sc1
buffer_load_dwordx4 v[96:99], v236, s[20:23], s63 offen offset:768 sc1
buffer_load_dwordx4 v[100:103], v236, s[20:23], s63 offen offset:1024 sc1
buffer_load_dwordx4 v[24:27], v227, s[20:23], s63 offen offset:0 sc1
buffer_load_dwordx4 v[28:31], v227, s[20:23], s63 offen offset:256 sc1
s_waitcnt vmcnt(0)
v_max_u16 v2, v92, v96
v_cmp_eq_u16 vcc, -1, v2
s_cbranch_vccnz L_st9
s_branch L_go9
L_sx9:
s_mov_b32 s40, 0
s_branch L_go9
L_st10:
s_sub_u32 s40, s40, 1
s_cbranch_scc1 L_sx10
buffer_load_dwordx4 v[100:103], v236, s[20:23], s63 offen offset:1024 sc1
buffer_load_dwordx4 v[24:27], v227, s[20:23], s63 offen offset:0 sc1
buffer_load_dwordx4 v[28:31], v227, s[20:23], s63 offen offset:256 sc1
buffer_load_dwordx4 v[32:35], v227, s[20:23], s63 offen offset:512 sc1
buffer_load_dwordx4 v[36:39], v227, s[20:23], s63 offen offset:768 sc1
s_waitcnt vmcnt(0)
v_max_u16 v2, v100, v24
v_cmp_eq_u16 vcc, -1, v2
s_cbranch_vccnz L_st10
s_branch L_go10
L_sx10:
s_mov_b32 s40, 0
s_branch L_go10
L_st11:
s_sub_u32 s40, s40, 1
s_cbranch_scc1 L_sx11
buffer_load_dwordx4 v[28:31], v227, s[20:23], s63 offen offset:256 sc1
buffer_load_dwordx4 v[32:35], v227, s[20:23], s63 offen offset:512 sc1
buffer_load_dwordx4 v[36:39], v227, s[20:23], s63 offen offset:768 sc1
buffer_load_dwordx4 v[40:43], v227, s[20:23], s63 offen offset:1024 sc1
buffer_load_dwordx4 v[44:47], v227, s[20:23], s64 offen offset:0 sc1
s_waitcnt vmcnt(0)
v_max_u16 v2, v28, v32
v_cmp_eq_u16 vcc, -1, v2
s_cbranch_vccnz L_st11
s_branch L_go11
L_sx11:
s_mov_b32 s40, 0
s_branch L_go11
L_st12:
s_sub_u32 s40, s40, 1
s_cbranch_scc1 L_sx12
buffer_load_dwordx4 v[36:39], v227, s[20:23], s63 offen offset:768 sc1
buffer_load_dwordx4 v[40:43], v227, s[20:23], s63 offen offset:1024 sc1
buffer_load_dwordx4 v[44:47], v227, s[20:23], s64 offen offset:0 sc1
buffer_load_dwordx4 v[48:51], v227, s[20:23], s64 offen offset:256 sc1
buffer_load_dwordx4 v[52:55], v227, s[20:23], s64 offen offset:512 sc1
s_waitcnt vmcnt(0)
v_max_u16 v2, v36, v40
v_cmp_eq_u16 vcc, -1, v2
s_cbranch_vccnz L_st12
s_branch L_go12
L_sx12:
s_mov_b32 s40, 0
s_branch L_go12
L_st13:
s_sub_u32 s40, s40, 1
s_cbranch_scc1 L_sx13
buffer_load_dwordx4 v[44:47], v227, s[20:23], s64 offen offset:0 sc1
buffer_load_dwordx4 v[48:51], v227, s[20:23], s64 offen offset:256 sc1
buffer_load_dwordx4 v[52:55], v227, s[20:23], s64 offen offset:512 sc1
buffer_load_dwordx4 v[56:59], v227, s[20:23], s64 offen offset:768 sc1
buffer_load_dwordx4 v[60:63], v227, s[20:23], s64 offen offset:1024 sc1
s_waitcnt vmcnt(0)
v_max_u16 v2, v44, v48
v_cmp_eq_u16 vcc, -1, v2
s_cbranch_vccnz L_st13
s_branch L_go13
L_sx13:
s_mov_b32 s40, 0
s_branch L_go13
L_st14:
s_sub_u32 s40, s40, 1
s_cbranch_scc1 L_sx14
buffer_load_dwordx4 v[52:55], v227, s[20:23], s64 offen offset:512 sc1
buffer_load_dwordx4 v[56:59], v227, s[20:23], s64 offen offset:768 sc1
buffer_load_dwordx4 v[60:63], v227, s[20:23], s64 offen offset:1024 sc1
s_waitcnt vmcnt(0)
v_max_u16 v2, v52, v56
v_cmp_eq_u16 vcc, -1, v2
s_cbranch_vccnz L_st14
s_branch L_go14
L_sx14:
s_mov_b32 s40, 0
s_branch L_go14
L_st15:
s_sub_u32 s40, s40, 1
s_cbranch_scc1 L_sx15
buffer_load_dwordx4 v[60:63], v227, s[20:23], s64 offen offset:1024 sc1
s_waitcnt vmcnt(0)
v_cmp_eq_u16 vcc, -1, v60
s_cbranch_vccnz L_st15
s_branch L_go15
L_sx15:
s_mov_b32 s40, 0
s_branch L_go15
L_pad_13:
s_setpc_b64 s[100:101]
L_gl_8g:
buffer_store_dwordx4 v[32:35], v1, s[16:19], s3 offen sc1
s_branch L_gl_8b
L_pad_14:
s_setpc_b64 s[100:101]
L_h0:
s_setprio 2
v_lshrrev_b32 v1, 3, v0
v_and_b32 v2, 2, v1
v_xor_b32 v2, v2, v0
v_and_b32 v2, 7, v2
s_lshl_b32 s3, s36, 7
v_lshl_add_u32 v2, v2, 4, s3
v_mul_u32_u24 v3, 3840, v1
v_add_u32 v24, v3, v2
v_xor_b32 v27, 64, v24
v_add_u32 v27, 30720, v27
v_mov_b32 v55, 0
v_add_u32 v25, 256, v24
v_add_u32 v26, 512, v24
v_add_u32 v28, 256, v27
v_add_u32 v29, 512, v27
v_lshrrev_b32 v1, 4, v0
v_lshlrev_b32 v1, 3, v1
s_lshl_b32 s3, s36, 7
buffer_load_dwordx2 v[244:245], v1, s[28:31], s3 offen offset:0
buffer_load_dwordx2 v[246:247], v1, s[28:31], s3 offen offset:32
buffer_load_dwordx2 v[248:249], v1, s[28:31], s3 offen offset:64
buffer_load_dwordx2 v[250:251], v1, s[28:31], s3 offen offset:96
s_waitcnt vmcnt(4)
s_barrier
s_mov_b32 s42, 1
s_mov_b32 s65, 45056
L_wl:
s_add_u32 s69, s69, 1
s_cmp_eq_u32 s69, 10
s_cselect_b32 s69, 0, s69
s_add_u32 s61, s61, 36864
s_cmp_eq_u32 s61, 155648
s_cselect_b32 s61, 8192, s61
s_mul_i32 s63, s69, 245760
s_add_u32 m0, s61, 12288
s_nop 0
buffer_load_dwordx4 v24, s[8:11], s63 offen offset:0 lds
buffer_load_dwordx4 v25, s[8:11], s63 offen offset:1024 lds
buffer_load_dwordx4 v26, s[8:11], s63 offen offset:2048 lds
s_addk_i32 m0, 3072
s_nop 0
buffer_load_dwordx4 v27, s[8:11], s63 offen offset:0 lds
buffer_load_dwordx4 v28, s[8:11], s63 offen offset:1024 lds
buffer_load_dwordx4 v29, s[8:11], s63 offen offset:2048 lds
s_addk_i32 m0, 3072
s_add_u32 s63, s63, 61440
buffer_load_dwordx4 v24, s[8:11], s63 offen offset:0 lds
buffer_load_dwordx4 v25, s[8:11], s63 offen offset:1024 lds
buffer_load_dwordx4 v26, s[8:11], s63 offen offset:2048 lds
s_addk_i32 m0, 3072
s_nop 0
buffer_load_dwordx4 v27, s[8:11], s63 offen offset:0 lds
buffer_load_dwordx4 v28, s[8:11], s63 offen offset:1024 lds
buffer_load_dwordx4 v29, s[8:11], s63 offen offset:2048 lds
s_addk_i32 m0, 3072
s_add_u32 s63, s63, 61440
buffer_load_dwordx4 v24, s[8:11], s63 offen offset:0 lds
buffer_load_dwordx4 v25, s[8:11], s63 offen offset:1024 lds
buffer_load_dwordx4 v26, s[8:11], s63 offen offset:2048 lds
s_addk_i32 m0, 3072
s_nop 0
buffer_load_dwordx4 v27, s[8:11], s63 offen offset:0 lds
buffer_load_dwordx4 v28, s[8:11], s63 offen offset:1024 lds
buffer_load_dwordx4 v29, s[8:11], s63 offen offset:2048 lds
s_addk_i32 m0, 3072
s_add_u32 s63, s63, 61440
buffer_load_dwordx4 v24, s[8:11], s63 offen offset:0 lds
buffer_load_dwordx4 v25, s[8:11], s63 offen offset:1024 lds
buffer_load_dwordx4 v26, s[8:11], s63 offen offset:2048 lds
s_addk_i32 m0, 3072
s_nop 0
buffer_load_dwordx4 v27, s[8:11], s63 offen offset:0 lds
buffer_load_dwordx4 v28, s[8:11], s63 offen offset:1024 lds
buffer_load_dwordx4 v29, s[8:11], s63 offen offset:2048 lds
s_mov_b32 s0, s65
s_mov_b32 s65, s61
s_cmp_eq_u32 s57, s42
s_waitcnt vmcnt(24) lgkmcnt(0)
s_barrier
s_cbranch_scc0 L_wc
s_call_b64 s[100:101], L_xcap
L_wc:
s_add_u32 s42, s42, 1
s_cmp_lt_u32 s42, 9
s_cbranch_scc1 L_wl
s_branch L_h8
L_pad_22:
s_setpc_b64 s[100:101]
L_c23:
ds_read_b64 v[24:25], v202 offset:4608
ds_read_b64 v[26:27], v202 offset:5760
ds_read_b64 v[28:29], v204 offset:0
ds_read_b64 v[30:31], v205 offset:0
ds_read_b64 v[32:33], v203 offset:4608
ds_read_b64 v[34:35], v203 offset:5760
ds_read_b64 v[36:37], v212 offset:0
ds_read_b64 v[38:39], v213 offset:0
ds_read_b64 v[40:41], v201 offset:4608
ds_read_b64 v[42:43], v201 offset:5760
ds_read_b64 v[44:45], v214 offset:0
ds_read_b64 v[46:47], v215 offset:0
ds_read_b64 v[48:49], v202 offset:0
ds_read_b64 v[50:51], v202 offset:1152
ds_read_b64 v[52:53], v206 offset:0
ds_read_b64 v[54:55], v207 offset:0
ds_read_b64 v[56:57], v203 offset:0
ds_read_b64 v[58:59], v203 offset:1152
ds_read_b64 v[60:61], v208 offset:0
ds_read_b64 v[62:63], v209 offset:0
ds_read_b64 v[64:65], v201 offset:0
ds_read_b64 v[66:67], v201 offset:1152
ds_read_b64 v[68:69], v210 offset:0
ds_read_b64 v[70:71], v211 offset:0
s_add_u32 s0, s37, 1
s_sub_u32 s1, 5, s37
s_min_u32 s0, s0, s1
s_lshl_b32 s0, s0, 4
s_sub_u32 s1, 64, s0
s_cmp_le_u32 s37, 2
s_cselect_b32 s1, s1, 16
s_bfm_b64 s[100:101], s0, s1
s_waitcnt lgkmcnt(15)
v_mfma_f32_16x16x32_bf16 v[160:163], v[24:27], v[28:31], 0
v_mfma_f32_16x16x32_bf16 v[164:167], v[32:35], v[36:39], 0
s_waitcnt lgkmcnt(12)
v_mfma_f32_16x16x32_bf16 v[160:163], v[40:43], v[44:47], v[160:163]
s_waitcnt lgkmcnt(8)
v_mfma_f32_16x16x32_bf16 v[152:155], v[48:51], v[52:55], 0
s_waitcnt lgkmcnt(4)
v_mfma_f32_16x16x32_bf16 v[156:159], v[56:59], v[60:63], 0
s_waitcnt lgkmcnt(0)
v_mfma_f32_16x16x32_bf16 v[152:155], v[64:67], v[68:71], v[152:155]
s_nop 1
v_permlane16_swap_b32 v160, v164
v_permlane16_swap_b32 v161, v165
v_permlane16_swap_b32 v162, v166
v_permlane16_swap_b32 v163, v167
v_cndmask_b32 v84, v164, v160, s[44:45]
v_cndmask_b32 v85, v165, v161, s[46:47]
v_cndmask_b32 v90, v166, v162, s[48:49]
v_cndmask_b32 v91, v167, v163, s[50:51]
v_or_b32 v88, 0xffff, v84
v_perm_b32 v89, v85, v84, s55
s_cmp_eq_u32 s41, 1
s_cbranch_scc0 L_gl_23g
buffer_store_dwordx4 v[88:91], v230, s[20:23], s68 offen
L_gl_23b:
v_permlane16_swap_b32 v152, v156
v_permlane16_swap_b32 v153, v157
v_permlane16_swap_b32 v154, v158
v_permlane16_swap_b32 v155, v159
v_cndmask_b32 v2, v156, v152, s[44:45]
v_cndmask_b32 v3, v157, v153, s[46:47]
v_cndmask_b32 v194, v158, v154, s[48:49]
v_cndmask_b32 v195, v159, v155, s[50:51]
v_or_b32 v192, 0xffff, v2
v_perm_b32 v193, v3, v2, s55
s_cmp_eq_u32 s41, 1
s_cbranch_scc0 L_gl_24g
buffer_store_dwordx4 v[192:195], v224, s[20:23], s54 offen
L_gl_24b:
v_mov_b32 v184, 0
v_mov_b32 v185, 0
v_mov_b32 v186, 0
v_mov_b32 v187, 0
v_mov_b32 v188, 0
v_mov_b32 v189, 0
v_mov_b32 v190, 0
v_mov_b32 v191, 0
s_setprio 2
buffer_load_dwordx4 v[100:103], v229, s[20:23], s68 offen sc1
v_add_u32 v1, 128, v222
v_cndmask_b32 v4, v1, v222, s[44:45]
ds_read_b64 v[168:169], v4 offset:512
v_cndmask_b32 v4, v1, v222, s[46:47]
ds_read_b64 v[170:171], v4 offset:544
v_cndmask_b32 v4, v1, v222, s[48:49]
ds_read_b64 v[172:173], v4 offset:576
v_cndmask_b32 v4, v1, v222, s[50:51]
ds_read_b64 v[174:175], v4 offset:608
ds_read_b32 v5, v223 offset:512
ds_read_b64_tr_b16 v[72:73], v217 offset:4608
ds_read_b64_tr_b16 v[74:75], v217 offset:5760
ds_read_b64_tr_b16 v[76:77], v218 offset:4608
ds_read_b64_tr_b16 v[78:79], v218 offset:5760
s_waitcnt vmcnt(0)
v_cmp_eq_u32 vcc, -1, v100
s_cbranch_vccnz L_h0rl1
L_h0gl1:
v_perm_b32 v100, v100, v101, s56
v_add_f32 v89, v85, v101
v_add_f32 v90, v90, v102
v_add_f32 v91, v91, v103
v_add_f32 v88, v84, v100
s_waitcnt lgkmcnt(0)
v_mul_f32 v5, 0x3ea52b5c, v5
v_fma_f32 v88, v88, v168, v169
v_fma_f32 v89, v89, v170, v171
v_fma_f32 v90, v90, v172, v173
v_fma_f32 v91, v91, v174, v175
v_max3_f32 v6, v88, v89, v90
v_max_f32 v6, v6, v91
v_mov_b32 v7, v6
s_nop 1
v_permlane32_swap_b32 v6, v7
v_max_f32 v6, v6, v7
v_mul_f32 v6, v6, v5
v_fma_f32 v88, v88, v5, -v6
v_fma_f32 v89, v89, v5, -v6
v_fma_f32 v90, v90, v5, -v6
v_fma_f32 v91, v91, v5, -v6
v_exp_f32 v88, v88
v_exp_f32 v89, v89
v_exp_f32 v90, v90
v_exp_f32 v91, v91
buffer_load_dwordx4 v[92:95], v225, s[20:23], s54 offen sc1
v_add_f32 v6, v88, v89
v_add_f32 v7, v90, v91
v_add_f32 v6, v6, v7
v_mov_b32 v7, v6
v_mul_f32 v88, v88, v168
v_mul_f32 v89, v89, v170
v_permlane32_swap_b32 v6, v7
v_mul_f32 v90, v90, v172
v_add_f32 v6, v6, v7
v_rcp_f32 v6, v6
v_mul_f32 v91, v91, v174
v_mul_f32 v88, v88, v6
v_mul_f32 v89, v89, v6
v_mul_f32 v90, v90, v6
v_mul_f32 v91, v91, v6
v_cvt_pk_bf16_f32 v88, v88, v89
v_cvt_pk_bf16_f32 v89, v90, v91
ds_read_b32 v1, v250 offset:8
ds_read_b128 v[80:83], v249 offset:512
s_mov_b64 exec, s[52:53]
v_and_b32 v184, v220, v88
v_bfi_b32 v188, v220, 0, v88
v_and_b32 v185, v221, v89
v_bfi_b32 v189, v221, 0, v89
s_not_b64 exec, exec
v_and_b32 v186, v220, v88
v_bfi_b32 v190, v220, 0, v88
v_and_b32 v187, v221, v89
v_bfi_b32 v191, v221, 0, v89
s_mov_b64 exec, -1
v_permlane16_swap_b32 v184, v188
v_permlane16_swap_b32 v185, v189
v_permlane16_swap_b32 v186, v190
v_permlane16_swap_b32 v187, v191
s_nop 1
v_mfma_f32_16x16x32_bf16 v[152:155], v[72:75], v[184:187], 0
v_mfma_f32_16x16x32_bf16 v[156:159], v[76:79], v[184:187], 0
v_mfma_f32_16x16x32_bf16 v[160:163], v[76:79], v[188:191], 0
s_waitcnt lgkmcnt(0)
v_cmp_eq_u32 vcc, 0, v1
s_cbranch_vccnz L_lrl1
L_lgl1:
s_mov_b32 exec_lo, 0xffff0000
s_nop 1
v_cvt_pk_bf16_f32 v80, v152, v153
v_cvt_pk_bf16_f32 v81, v154, v155
v_cvt_pk_bf16_f32 v82, v156, v157
v_cvt_pk_bf16_f32 v83, v158, v159
s_mov_b64 exec, s[100:101]
v_cvt_pk_bf16_f32 v82, v160, v161
v_cvt_pk_bf16_f32 v83, v162, v163
s_mov_b64 exec, -1
s_cmp_eq_u32 s41, 1
s_cbranch_scc0 L_gl_25g
buffer_store_dwordx4 v[80:83], v228, s[20:23], s68 offen
L_gl_25b:
v_add_u32 v1, 128, v222
v_cndmask_b32 v4, v1, v222, s[44:45]
ds_read_b64 v[168:169], v4 offset:0
v_cndmask_b32 v4, v1, v222, s[46:47]
ds_read_b64 v[170:171], v4 offset:32
v_cndmask_b32 v4, v1, v222, s[48:49]
ds_read_b64 v[172:173], v4 offset:64
v_cndmask_b32 v4, v1, v222, s[50:51]
ds_read_b64 v[174:175], v4 offset:96
ds_read_b32 v5, v223 offset:0
ds_read_b64_tr_b16 v[72:73], v217 offset:0
ds_read_b64_tr_b16 v[74:75], v217 offset:1152
ds_read_b64_tr_b16 v[76:77], v218 offset:0
ds_read_b64_tr_b16 v[78:79], v218 offset:1152
s_waitcnt vmcnt(1)
v_cmp_eq_u32 vcc, -1, v92
s_cbranch_vccnz L_h0rl0
L_h0gl0:
v_perm_b32 v92, v92, v93, s56
v_add_f32 v193, v3, v93
v_add_f32 v194, v194, v94
v_add_f32 v195, v195, v95
v_add_f32 v192, v2, v92
s_waitcnt lgkmcnt(0)
v_mul_f32 v5, 0x3ea52b5c, v5
v_fma_f32 v192, v192, v168, v169
v_fma_f32 v193, v193, v170, v171
v_fma_f32 v194, v194, v172, v173
v_fma_f32 v195, v195, v174, v175
v_max3_f32 v6, v192, v193, v194
v_max_f32 v6, v6, v195
v_mov_b32 v7, v6
s_nop 1
v_permlane32_swap_b32 v6, v7
v_max_f32 v6, v6, v7
v_mul_f32 v6, v6, v5
v_fma_f32 v192, v192, v5, -v6
v_fma_f32 v193, v193, v5, -v6
v_fma_f32 v194, v194, v5, -v6
v_fma_f32 v195, v195, v5, -v6
v_exp_f32 v192, v192
v_exp_f32 v193, v193
v_exp_f32 v194, v194
v_exp_f32 v195, v195
v_add_f32 v6, v192, v193
v_add_f32 v7, v194, v195
v_add_f32 v6, v6, v7
v_mov_b32 v7, v6
v_mul_f32 v192, v192, v168
v_mul_f32 v193, v193, v170
v_permlane32_swap_b32 v6, v7
v_mul_f32 v194, v194, v172
v_add_f32 v6, v6, v7
v_rcp_f32 v6, v6
v_mul_f32 v195, v195, v174
v_mul_f32 v192, v192, v6
v_mul_f32 v193, v193, v6
v_mul_f32 v194, v194, v6
v_mul_f32 v195, v195, v6
v_cvt_pk_bf16_f32 v192, v192, v193
v_cvt_pk_bf16_f32 v193, v194, v195
ds_read_b32 v1, v250 offset:0
ds_read_b128 v[80:83], v249 offset:0
s_mov_b64 exec, s[52:53]
v_and_b32 v184, v220, v192
v_bfi_b32 v188, v220, 0, v192
v_and_b32 v185, v221, v193
v_bfi_b32 v189, v221, 0, v193
s_not_b64 exec, exec
v_and_b32 v186, v220, v192
v_bfi_b32 v190, v220, 0, v192
v_and_b32 v187, v221, v193
v_bfi_b32 v191, v221, 0, v193
s_mov_b64 exec, -1
v_permlane16_swap_b32 v184, v188
v_permlane16_swap_b32 v185, v189
v_permlane16_swap_b32 v186, v190
v_permlane16_swap_b32 v187, v191
s_nop 1
v_mfma_f32_16x16x32_bf16 v[152:155], v[72:75], v[184:187], 0
v_mfma_f32_16x16x32_bf16 v[156:159], v[76:79], v[184:187], 0
v_mfma_f32_16x16x32_bf16 v[160:163], v[76:79], v[188:191], 0
s_waitcnt lgkmcnt(0)
v_cmp_eq_u32 vcc, 0, v1
s_cbranch_vccnz L_lrl0
L_lgl0:
s_mov_b32 exec_lo, 0xffff0000
s_nop 1
v_cvt_pk_bf16_f32 v80, v152, v153
v_cvt_pk_bf16_f32 v81, v154, v155
v_cvt_pk_bf16_f32 v82, v156, v157
v_cvt_pk_bf16_f32 v83, v158, v159
s_mov_b64 exec, s[100:101]
v_cvt_pk_bf16_f32 v82, v160, v161
v_cvt_pk_bf16_f32 v83, v162, v163
s_mov_b64 exec, -1
s_cmp_eq_u32 s41, 1
s_cbranch_scc0 L_gl_26g
buffer_store_dwordx4 v[80:83], v226, s[20:23], s54 offen
L_gl_26b:
s_endpgm
L_pad_27:
s_setpc_b64 s[100:101]
L_gl_23g:
buffer_store_dwordx4 v[88:91], v230, s[20:23], s68 offen sc1
s_branch L_gl_23b
L_gl_24g:
buffer_store_dwordx4 v[192:195], v224, s[20:23], s54 offen sc1
s_branch L_gl_24b
L_h0rl1:
s_sub_u32 s40, s40, 1
s_cbranch_scc1 L_h0xl1
buffer_load_dwordx4 v[100:103], v229, s[20:23], s68 offen sc1
s_waitcnt vmcnt(0)
v_cmp_eq_u32 vcc, -1, v100
s_cbranch_vccnz L_h0rl1
s_branch L_h0gl1
L_h0xl1:
s_mov_b32 s40, 0
s_branch L_h0gl1
L_lrl1:
ds_read_b32 v1, v250 offset:8
ds_read_b128 v[80:83], v249 offset:512
s_waitcnt lgkmcnt(0)
v_cmp_eq_u32 vcc, 0, v1
s_cbranch_vccnz L_lrl1
s_branch L_lgl1
L_gl_25g:
buffer_store_dwordx4 v[80:83], v228, s[20:23], s68 offen sc1
s_branch L_gl_25b
L_h0rl0:
s_sub_u32 s40, s40, 1
s_cbranch_scc1 L_h0xl0
buffer_load_dwordx4 v[92:95], v225, s[20:23], s54 offen sc1
s_waitcnt vmcnt(0)
v_cmp_eq_u32 vcc, -1, v92
s_cbranch_vccnz L_h0rl0
s_branch L_h0gl0
L_h0xl0:
s_mov_b32 s40, 0
s_branch L_h0gl0
L_lrl0:
ds_read_b32 v1, v250 offset:0
ds_read_b128 v[80:83], v249 offset:0
s_waitcnt lgkmcnt(0)
v_cmp_eq_u32 vcc, 0, v1
s_cbranch_vccnz L_lrl0
s_branch L_lgl0
L_gl_26g:
buffer_store_dwordx4 v[80:83], v226, s[20:23], s54 offen sc1
s_branch L_gl_26b
.p2align 12
L_pb_15:
L_cons:
v_and_b32 v1, 15, v0
v_lshrrev_b32 v2, 4, v0
v_mov_b32 v7, 1792
s_mul_i32 s0, s44, 2304
s_movk_i32 s1, 144
v_bfe_u32 v3, v0, 2, 1
v_and_b32 v4, 3, v0
v_lshlrev_b32 v4, 1, v4
v_lshl_add_u32 v3, v3, 3, v4
v_bfe_u32 v4, v0, 3, 1
v_add_u32 v3, v3, v4
s_add_u32 s3, s0, 17408
v_mov_b32 v4, s3
v_mad_u32_u24 v3, v3, s1, v4
s_add_u32 s3, s0, 4736
v_mov_b32 v4, s3
v_mad_u32_u24 v4, v1, s1, v4
s_mov_b32 s52, 0xff00ff
s_mov_b32 s53, 0xff00ff
v_add_u32 v5, s51, v2
v_lshl_add_u32 v200, v5, 3, v3
v_lshl_add_u32 v5, v5, 3, v4
v_cndmask_b32 v204, v7, v5, s[52:53]
v_cndmask_b32 v205, v5, v7, s[52:53]
v_add_u32 v5, s46, v2
v_lshl_add_u32 v202, v5, 3, v3
v_lshl_add_u32 v5, v5, 3, v4
v_cmp_gt_u32 vcc, s47, v2
s_nop 1
v_cndmask_b32 v5, v7, v5, vcc
v_cndmask_b32 v206, v7, v5, s[52:53]
v_cndmask_b32 v207, v5, v7, s[52:53]
v_add_u32 v5, s48, v2
v_min_u32 v5, 15, v5
v_lshl_add_u32 v203, v5, 3, v3
v_lshl_add_u32 v5, v5, 3, v4
v_cmp_gt_u32 vcc, s49, v2
s_nop 1
v_cndmask_b32 v5, v7, v5, vcc
v_cndmask_b32 v208, v7, v5, s[52:53]
v_cndmask_b32 v209, v5, v7, s[52:53]
s_sub_u32 s3, s51, 1
v_mad_u32_u24 v5, v2, 5, s3
s_add_u32 s3, s46, 4
v_mov_b32 v6, s3
s_mov_b64 vcc, 0xffff
v_cndmask_b32 v5, v5, v6, vcc
v_min_u32 v5, 15, v5
v_lshl_add_u32 v201, v5, 3, v3
v_lshl_add_u32 v5, v5, 3, v4
s_cmp_eq_u32 s47, 5
s_cselect_b64 vcc, 0xff, 0
v_cndmask_b32 v210, v7, v5, vcc
s_lshl_b64 vcc, vcc, 8
v_cndmask_b32 v211, v7, v5, vcc
s_bfm_b64 vcc, 8, 16
v_cndmask_b32 v212, v7, v5, vcc
s_bfm_b64 vcc, 8, 24
v_cndmask_b32 v213, v7, v5, vcc
s_bfm_b64 vcc, 8, 32
v_cndmask_b32 v214, v7, v5, vcc
s_bfm_b64 vcc, 8, 40
v_cndmask_b32 v215, v7, v5, vcc
s_mul_i32 s0, s44, 2304
s_movk_i32 s1, 144
v_bfe_u32 v3, v0, 2, 3
v_lshrrev_b32 v4, 5, v0
v_lshl_add_u32 v3, v3, 1, v4
s_add_u32 s3, s0, 31232
v_mov_b32 v4, s3
v_mad_u32_u24 v3, v3, s1, v4
v_and_b32 v4, 3, v0
s_mov_b32 s54, 0x11111111
s_mov_b32 s55, 0x11111111
v_add_u32 v5, s51, v4
v_lshl_add_u32 v216, v5, 3, v3
v_add_u32 v7, 32, v216
s_cmp_eq_u32 s50, 1
s_cselect_b32 s3, -1, 12
s_cselect_b32 s56, 2, -1
v_add_u32 v5, s3, v4
v_lshl_add_u32 v5, v5, 3, v3
v_cndmask_b32 v217, v5, v7, s[54:55]
v_add_u32 v7, 40, v7
v_add_u32 v5, s56, v4
v_add_u32 v6, 10, v5
v_cmp_gt_i32 vcc, s51, v5
s_nop 1
v_cndmask_b32 v5, v6, v5, vcc
v_lshl_add_u32 v5, v5, 3, v3
v_cndmask_b32 v218, v5, v7, s[54:55]
s_lshl_b32 s0, s44, 8
v_lshrrev_b32 v4, 5, v0
v_and_or_b32 v3, v0, 8, v4
s_add_u32 s3, s0, 8
v_lshl_add_u32 v222, v3, 4, s3
v_and_b32 v1, 15, v0
s_add_u32 s3, s0, 132
v_lshl_add_u32 v223, v1, 4, s3
s_lshr_b32 s3, s39, 8
s_mul_i32 s3, s3, 52429
s_lshr_b32 s3, s3, 18
s_lshl_b32 s0, s44, 5
s_add_u32 s3, s3, s0
s_sub_u32 s3, 2047, s3
v_mad_i32_i24 v234, v1, -2, s3
v_lshrrev_b32 v2, 4, v0
v_and_or_b32 v3, v0, 8, v2
v_and_b32 v4, 0x70, v233
v_bfrev_b32 v6, 1
s_lshl_b32 s3, s44, 4
v_add_u32 v5, s3, v3
s_lshl_b32 s3, s60, 3
v_cmp_gt_u32 vcc, s3, v5
v_mul_u32_u24 v5, 2560, v5
v_add3_u32 v5, v5, v4, s39
v_cndmask_b32 v227, v6, v5, vcc
v_cndmask_b32 v7, v6, 0, vcc
s_lshl_b32 s3, s38, 4
v_add_u32 v5, s3, v3
s_lshl_b32 s3, s60, 3
v_cmp_gt_u32 vcc, s3, v5
v_mul_u32_u24 v5, 2560, v5
v_add3_u32 v5, v5, v4, s39
v_cndmask_b32 v227, v6, v5, vcc
s_lshl_b32 s3, s36, 7
v_add_u32 v226, s3, v227
v_bfe_u32 v3, v0, 4, 1
v_cmp_eq_u32 s[54:55], s50, v3
s_cmp_lg_u32 s37, 0
s_cselect_b64 s[0:1], -1, s[54:55]
s_and_b64 vcc, vcc, s[0:1]
s_cmp_lg_u32 s37, 4
s_cselect_b64 s[0:1], 0, s[54:55]
s_andn2_b64 vcc, vcc, s[0:1]
v_cndmask_b32 v225, v6, v226, vcc
s_cmp_le_u32 s37, 3
s_cselect_b32 s3, 2560, 0
s_sub_u32 s3, s3, 128
v_mov_b32 v4, s3
s_cmp_ge_u32 s37, 2
s_cselect_b32 s3, 2560, 0
s_add_u32 s3, s3, 128
v_mov_b32 v5, s3
v_cndmask_b32 v4, v4, v5, s[54:55]
v_mul_u32_u24 v3, 2560, v3
v_sub_u32 v4, v4, v3
v_add_u32 v4, v4, v226
v_cndmask_b32 v224, v6, v4, vcc
v_or_b32 v228, v7, v226
v_or_b32 v229, v7, v225
v_or_b32 v230, v7, v224
s_sub_u32 s3, s44, s38
s_mul_i32 s61, s3, 40960
s_add_u32 s68, s61, 10240
s_mul_i32 s0, s3, 2304
s_lshl_b32 s1, s3, 8
v_subrev_u32 v202, s0, v202
v_subrev_u32 v203, s0, v203
v_subrev_u32 v201, s0, v201
v_subrev_u32 v217, s0, v217
v_subrev_u32 v218, s0, v218
v_subrev_u32 v222, s1, v222
v_subrev_u32 v223, s1, v223
s_cmp_lt_u32 s32, 2
s_cbranch_scc1 L_q2
v_mov_b32 v204, v206
v_mov_b32 v205, v207
v_mov_b32 v212, v208
v_mov_b32 v213, v209
v_mov_b32 v214, v210
v_mov_b32 v215, v211
L_q2:
v_subrev_u32 v206, s0, v206
v_max_i32 v206, 1792, v206
v_subrev_u32 v207, s0, v207
v_max_i32 v207, 1792, v207
v_subrev_u32 v208, s0, v208
v_max_i32 v208, 1792, v208
v_subrev_u32 v209, s0, v209
v_max_i32 v209, 1792, v209
v_subrev_u32 v210, s0, v210
v_max_i32 v210, 1792, v210
v_subrev_u32 v211, s0, v211
v_max_i32 v211, 1792, v211
v_and_b32 v1, 15, v0
v_bfrev_b32 v6, 1
v_bfe_u32 v3, v0, 4, 1
v_lshrrev_b32 v4, 5, v0
v_lshl_add_u32 v3, v3, 1, v4
s_lshl_b32 s3, s36, 7
v_lshl_add_u32 v4, v3, 4, s3
s_lshl_b32 s3, s44, 4
v_add_u32 v5, s3, v1
s_lshl_b32 s3, s60, 3
v_cmp_gt_u32 vcc, s3, v5
v_mul_u32_u24 v5, 2560, v5
v_add3_u32 v5, v5, v4, s39
v_cndmask_b32 v232, v6, v5, vcc
v_bfe_u32 v3, v0, 3, 2
v_lshlrev_b32 v3, 2, v3
v_and_or_b32 v3, v0, 3, v3
v_lshlrev_b32 v3, 3, v3
v_bfe_u32 v4, v0, 2, 2
v_lshl_add_u32 v3, v4, 7, v3
v_lshrrev_b32 v2, 4, v0
s_mov_b32 s44, 0x0
s_mov_b32 s45, 0x1010101
s_mov_b32 s46, 0x3030303
s_mov_b32 s47, 0x7070707
s_mov_b32 s48, 0xf0f0f0f
s_mov_b32 s49, 0x1f1f1f1f
s_mov_b32 s50, 0x3f3f3f3f
s_mov_b32 s51, 0x7f7f7f7f
s_movk_i32 s54, 10240
s_mov_b32 s55, 0x07060501
s_mov_b32 s56, 0x0706000c
v_mov_b32 v5, 0xffff
v_mov_b32 v6, 0xffff0000
v_cndmask_b32 v1, 0, v5, s[44:45]
v_cndmask_b32 v4, 0, v6, s[46:47]
v_or_b32 v220, v1, v4
v_cndmask_b32 v1, 0, v5, s[48:49]
v_cndmask_b32 v4, 0, v6, s[50:51]
v_or_b32 v221, v1, v4
s_lshl_b32 s3, s38, 5
v_xor_b32 v3, s3, v3
v_mul_u32_u24 v4, 3072, v2
v_add_u32 v3, v3, v4
v_add_u32 v244, 20480, v3
s_mov_b32 s42, 0
v_mov_b32 v3, 0
v_lshlrev_b32 v2, 2, v0
s_mov_b32 exec_hi, 0
ds_write_b32 v2, v3 offset:1728
ds_write_b32 v2, v3 offset:2880
s_mov_b64 exec, -1
v_and_b32 v1, 15, v0
v_lshrrev_b32 v2, 4, v0
v_lshrrev_b32 v3, 1, v1
v_xor_b32 v3, v3, v2
v_lshlrev_b32 v3, 4, v3
v_lshl_add_u32 v3, v1, 7, v3
v_add_u32 v245, 8192, v3
v_xor_b32 v246, 64, v245
v_mul_u32_u24 v3, 144, v1
v_lshl_add_u32 v3, v2, 3, v3
s_lshl_b32 s3, s38, 5
s_add_u32 s3, s3, 3584
v_add_u32 v247, s3, v3
v_lshlrev_b32 v248, 4, v1
s_lshl_b32 s0, s38, 8
s_add_u32 s0, s0, 73728
v_add_u32 v249, s0, v233
s_lshl_b32 s0, s38, 2
s_add_u32 s0, s0, 1768
v_mov_b32 v250, s0
s_cmp_eq_u32 s32, 0
s_cbranch_scc0 L_cw0
s_call_b64 s[100:101], L_pad_2
L_cw0:
s_cmp_eq_u32 s32, 1
s_cbranch_scc0 L_cw1
s_call_b64 s[100:101], L_pad_14
L_cw1:
s_cmp_eq_u32 s32, 2
s_cbranch_scc0 L_cw2
s_call_b64 s[100:101], L_pad_17
L_cw2:
s_cmp_eq_u32 s32, 3
s_cbranch_scc0 L_cw3
L_cw3:
v_mov_b32 v4, -1
v_mov_b32 v5, -1
v_mov_b32 v6, -1
v_mov_b32 v7, -1
v_lshrrev_b32 v1, 3, v0
v_mul_u32_u24 v1, 2560, v1
v_and_b32 v2, 0x70, v233
s_lshl_b32 s3, s36, 7
s_add_u32 s3, s3, s39
v_add3_u32 v1, v1, v2, s3
s_mul_i32 s0, s38, 20480
s_add_u32 s1, s0, 81920
s_add_u32 s3, s38, 8
s_cmp_lt_u32 s3, s60
s_cselect_b32 s3, s1, 0x80000000
s_add_u32 s66, s3, 81920
v_lshrrev_b32 v2, 4, v0
v_mul_u32_u24 v2, 2304, v2
v_add_u32 v2, v2, v233
s_mul_i32 s67, s43, 15360
s_lshl_b32 s3, s36, 8
s_add_u32 s67, s67, s3
s_and_b32 s3, s38, 1
s_mul_i32 s3, s3, 7680
s_add_u32 s67, s67, s3
s_add_u32 s67, s67, 2097152
s_cmp_lt_u32 s38, 2
s_cselect_b32 s67, s67, 0x80000000
s_cmp_eq_u32 s69, 9
s_cselect_b32 s3, -2457600, 0
s_add_u32 s3, s3, 245760
v_add_u32 v254, s3, v254
s_mul_i32 s3, s38, 3072
s_add_u32 m0, s3, 57344
s_mov_b32 s64, 122880
buffer_load_dwordx4 v254, s[8:11], 0 offen offset:0 lds
s_addk_i32 m0, -256
s_nop 0
buffer_load_dwordx4 v254, s[8:11], 0 offen offset:1280 lds
s_addk_i32 m0, -256
s_nop 0
buffer_load_dwordx4 v254, s[8:11], 0 offen offset:2560 lds
s_addk_i32 m0, 12800
s_nop 0
buffer_load_dwordx4 v254, s[8:11], s64 offen offset:0 lds
s_addk_i32 m0, -256
s_nop 0
buffer_load_dwordx4 v254, s[8:11], s64 offen offset:1280 lds
s_addk_i32 m0, -256
s_nop 0
buffer_load_dwordx4 v254, s[8:11], s64 offen offset:2560 lds
buffer_store_dwordx4 v[4:7], v1, s[20:23], s0 offen
buffer_store_dwordx4 v[4:7], v1, s[20:23], s1 offen
buffer_store_dwordx4 v[4:7], v1, s[20:23], s66 offen
s_mov_b32 exec_hi, 0xffff
buffer_store_dwordx4 v[4:7], v2, s[16:19], s67 offen
s_mov_b64 exec, -1
s_cmp_lt_u32 s32, 2
s_cselect_b32 s57, s57, 99
s_mov_b32 s65, 8192
s_min_u32 s62, s57, 1
s_waitcnt vmcnt(10) lgkmcnt(0)
s_barrier
ds_read_b64_tr_b16 v[156:157], v244 offset:1024
ds_read_b64_tr_b16 v[158:159], v244 offset:1536
ds_read_b128 v[80:83], v245 offset:0
ds_read_b128 v[84:87], v245 offset:2048
ds_read_b128 v[88:91], v245 offset:4096
ds_read_b128 v[92:95], v245 offset:6144
ds_read_b128 v[96:99], v245 offset:8192
ds_read_b128 v[100:103], v245 offset:10240
ds_read_b64_tr_b16 v[160:161], v244 offset:2048
ds_read_b64_tr_b16 v[162:163], v244 offset:2560
ds_read_b64_tr_b16 v[152:153], v244 offset:0
ds_read_b64_tr_b16 v[154:155], v244 offset:512
s_waitcnt lgkmcnt(4)
v_mfma_f32_16x16x32_bf16 v[32:35], v[156:159], v[80:83], 0
ds_read_b64_tr_b16 v[168:169], v244 offset:13312
v_mfma_f32_16x16x32_bf16 v[36:39], v[156:159], v[84:87], 0
ds_read_b64_tr_b16 v[170:171], v244 offset:13824
v_mfma_f32_16x16x32_bf16 v[40:43], v[156:159], v[88:91], 0
ds_read_b128 v[104:107], v246 offset:0
v_mfma_f32_16x16x32_bf16 v[44:47], v[156:159], v[92:95], 0
ds_read_b128 v[108:111], v246 offset:2048
v_mfma_f32_16x16x32_bf16 v[48:51], v[156:159], v[96:99], 0
ds_read_b128 v[112:115], v246 offset:4096
v_mfma_f32_16x16x32_bf16 v[52:55], v[156:159], v[100:103], 0
ds_read_b128 v[116:119], v246 offset:6144
s_waitcnt lgkmcnt(8)
v_mfma_f32_16x16x32_bf16 v[56:59], v[160:163], v[80:83], 0
ds_read_b128 v[120:123], v246 offset:8192
v_mfma_f32_16x16x32_bf16 v[60:63], v[160:163], v[84:87], 0
ds_read_b128 v[124:127], v246 offset:10240
v_mfma_f32_16x16x32_bf16 v[64:67], v[160:163], v[88:91], 0
ds_read_b64_tr_b16 v[172:173], v244 offset:14336
v_mfma_f32_16x16x32_bf16 v[68:71], v[160:163], v[92:95], 0
ds_read_b64_tr_b16 v[174:175], v244 offset:14848
v_mfma_f32_16x16x32_bf16 v[72:75], v[160:163], v[96:99], 0
ds_read_b64_tr_b16 v[164:165], v244 offset:12288
v_mfma_f32_16x16x32_bf16 v[76:79], v[160:163], v[100:103], 0
ds_read_b64_tr_b16 v[166:167], v244 offset:12800
s_waitcnt lgkmcnt(12)
v_mfma_f32_16x16x32_bf16 v[8:11], v[152:155], v[80:83], 0
s_add_u32 s3, s65, 36864
s_cmp_eq_u32 s3, 155648
v_mfma_f32_16x16x32_bf16 v[12:15], v[152:155], v[84:87], 0
s_cselect_b32 s3, 8192, s3
s_sub_u32 s63, s3, s65
v_mfma_f32_16x16x32_bf16 v[16:19], v[152:155], v[88:91], 0
s_mov_b32 s65, s3
v_add_u32 v245, s63, v245
v_mfma_f32_16x16x32_bf16 v[20:23], v[152:155], v[92:95], 0
v_add_u32 v244, s63, v244
v_add_u32 v246, s63, v246
v_mfma_f32_16x16x32_bf16 v[24:27], v[152:155], v[96:99], 0
v_mfma_f32_16x16x32_bf16 v[28:31], v[152:155], v[100:103], 0
s_add_u32 s42, s42, 1
s_cmp_lt_u32 s42, 9
s_waitcnt lgkmcnt(4)
v_mfma_f32_16x16x32_bf16 v[32:35], v[168:171], v[104:107], v[32:35]
v_mfma_f32_16x16x32_bf16 v[36:39], v[168:171], v[108:111], v[36:39]
v_mfma_f32_16x16x32_bf16 v[40:43], v[168:171], v[112:115], v[40:43]
v_mfma_f32_16x16x32_bf16 v[44:47], v[168:171], v[116:119], v[44:47]
v_mfma_f32_16x16x32_bf16 v[48:51], v[168:171], v[120:123], v[48:51]
v_mfma_f32_16x16x32_bf16 v[52:55], v[168:171], v[124:127], v[52:55]
s_waitcnt lgkmcnt(2)
v_mfma_f32_16x16x32_bf16 v[56:59], v[172:175], v[104:107], v[56:59]
v_mfma_f32_16x16x32_bf16 v[60:63], v[172:175], v[108:111], v[60:63]
v_mfma_f32_16x16x32_bf16 v[64:67], v[172:175], v[112:115], v[64:67]
v_mfma_f32_16x16x32_bf16 v[68:71], v[172:175], v[116:119], v[68:71]
v_mfma_f32_16x16x32_bf16 v[72:75], v[172:175], v[120:123], v[72:75]
s_waitcnt lgkmcnt(0)
v_mfma_f32_16x16x32_bf16 v[76:79], v[172:175], v[124:127], v[76:79]
s_waitcnt vmcnt(4)
s_branch L_pb_16
L_pad_28:
s_setpc_b64 s[100:101]
L_ev:
s_cmp_eq_u32 s42, 1
s_cbranch_scc0 L_ev1
s_waitcnt vmcnt(0)
L_ev1:
s_max_u32 s62, s57, 1
s_cmp_eq_u32 s42, s57
s_cbranch_scc0 L_evb
s_sub_u32 s0, s65, s63
v_add_u32 v1, s0, v235
ds_read_b64 v[236:237], v1
v_xor_b32 v2, 32, v1
ds_read_b64 v[238:239], v2
v_xor_b32 v3, 64, v1
ds_read_b64 v[240:241], v3
v_xor_b32 v4, 96, v1
ds_read_b64 v[242:243], v4
s_branch L_evb
L_gs:
v_mov_b32 v4, -1
v_mov_b32 v5, -1
v_mov_b32 v6, -1
v_mov_b32 v7, -1
v_lshrrev_b32 v1, 3, v0
v_mul_u32_u24 v1, 2560, v1
v_and_b32 v2, 0x70, v233
s_lshl_b32 s3, s36, 7
s_add_u32 s3, s3, s39
v_add3_u32 v1, v1, v2, s3
s_mul_i32 s0, s38, 20480
s_add_u32 s1, s0, 81920
s_add_u32 s3, s38, 8
s_cmp_lt_u32 s3, s60
s_cselect_b32 s3, s1, 0x80000000
s_add_u32 s66, s3, 81920
v_lshrrev_b32 v2, 4, v0
v_mul_u32_u24 v2, 2304, v2
v_add_u32 v2, v2, v233
s_mul_i32 s67, s43, 15360
s_lshl_b32 s3, s36, 8
s_add_u32 s67, s67, s3
s_and_b32 s3, s38, 1
s_mul_i32 s3, s3, 7680
s_add_u32 s67, s67, s3
s_add_u32 s67, s67, 2097152
s_cmp_lt_u32 s38, 2
s_cselect_b32 s67, s67, 0x80000000
buffer_store_dwordx4 v[4:7], v1, s[20:23], s0 offen sc1
buffer_store_dwordx4 v[4:7], v1, s[20:23], s1 offen sc1
buffer_store_dwordx4 v[4:7], v1, s[20:23], s66 offen sc1
s_mov_b32 exec_hi, 0xffff
buffer_store_dwordx4 v[4:7], v2, s[16:19], s67 offen sc1
s_mov_b64 exec, -1
s_waitcnt vmcnt(0)
s_barrier
s_barrier
s_branch L_gsb
L_pad_21:
s_setpc_b64 s[100:101]
L_fsh:
s_setprio 0
v_lshrrev_b32 v1, 4, v0
v_lshlrev_b32 v1, 3, v1
s_lshl_b32 s3, s36, 7
buffer_load_dwordx2 v[244:245], v1, s[28:31], s3 offen offset:0
buffer_load_dwordx2 v[246:247], v1, s[28:31], s3 offen offset:32
buffer_load_dwordx2 v[248:249], v1, s[28:31], s3 offen offset:64
buffer_load_dwordx2 v[250:251], v1, s[28:31], s3 offen offset:96
v_lshlrev_b32 v8, 16, v236
v_and_b32 v9, 0xffff0000, v236
v_lshlrev_b32 v10, 16, v237
v_and_b32 v11, 0xffff0000, v237
v_lshlrev_b32 v12, 16, v238
v_and_b32 v13, 0xffff0000, v238
v_lshlrev_b32 v14, 16, v239
v_and_b32 v15, 0xffff0000, v239
v_lshlrev_b32 v16, 16, v240
v_and_b32 v17, 0xffff0000, v240
v_lshlrev_b32 v18, 16, v241
v_and_b32 v19, 0xffff0000, v241
v_lshlrev_b32 v20, 16, v242
v_and_b32 v21, 0xffff0000, v242
v_lshlrev_b32 v22, 16, v243
v_and_b32 v23, 0xffff0000, v243
s_lshl_b32 s0, s32, 13
s_add_u32 s0, s0, 57344
v_add_u32 v4, s0, v233
s_lshl_b32 s0, s32, 2
s_add_u32 s0, s0, 1760
s_waitcnt vmcnt(0)
s_mov_b32 s3, 0x3f803f80
v_mov_b32 v236, s3
v_mov_b32 v237, s3
v_mov_b32 v238, s3
v_mov_b32 v239, s3
s_mov_b32 exec_lo, 0x11111111
s_mov_b32 exec_hi, 0x11111111
v_mov_b32 v244, s3
v_mov_b32 v245, s3
v_mov_b32 v246, s3
v_mov_b32 v247, s3
v_mov_b32 v248, s3
v_mov_b32 v249, s3
v_mov_b32 v250, s3
v_mov_b32 v251, s3
s_mov_b64 exec, -1
v_mfma_f32_16x16x32_bf16 v[252:255], v[244:247], v[236:239], 0
v_mfma_f32_16x16x32_bf16 v[252:255], v[248:251], v[236:239], v[252:255]
v_mov_b32 v2, s0
L_fx:
s_sleep 1
ds_read_b32 v1, v2
s_waitcnt lgkmcnt(0)
v_cmp_ne_u32 vcc, 2, v1
s_cbranch_vccnz L_fx
s_setprio 2
ds_read_b128 v[24:27], v4 offset:0
ds_read_b128 v[28:31], v4 offset:1024
ds_read_b128 v[32:35], v4 offset:2048
ds_read_b128 v[36:39], v4 offset:3072
ds_read_b128 v[40:43], v4 offset:4096
ds_read_b128 v[44:47], v4 offset:5120
ds_read_b128 v[48:51], v4 offset:6144
ds_read_b128 v[52:55], v4 offset:7168
s_waitcnt lgkmcnt(7)
v_add_f32 v8, v8, v24
v_add_f32 v9, v9, v25
v_add_f32 v10, v10, v26
v_add_f32 v11, v11, v27
s_waitcnt lgkmcnt(6)
v_add_f32 v12, v12, v28
v_add_f32 v13, v13, v29
v_add_f32 v14, v14, v30
v_add_f32 v15, v15, v31
s_waitcnt lgkmcnt(5)
v_add_f32 v16, v16, v32
v_add_f32 v17, v17, v33
v_add_f32 v18, v18, v34
v_add_f32 v19, v19, v35
s_waitcnt lgkmcnt(4)
v_add_f32 v20, v20, v36
v_add_f32 v21, v21, v37
v_add_f32 v22, v22, v38
v_add_f32 v23, v23, v39
s_waitcnt lgkmcnt(3)
v_add_f32 v8, v8, v40
v_add_f32 v9, v9, v41
v_add_f32 v10, v10, v42
v_add_f32 v11, v11, v43
s_waitcnt lgkmcnt(2)
v_add_f32 v12, v12, v44
v_add_f32 v13, v13, v45
v_add_f32 v14, v14, v46
v_add_f32 v15, v15, v47
s_waitcnt lgkmcnt(1)
v_add_f32 v16, v16, v48
v_add_f32 v17, v17, v49
v_add_f32 v18, v18, v50
v_add_f32 v19, v19, v51
s_waitcnt lgkmcnt(0)
v_add_f32 v20, v20, v52
v_add_f32 v21, v21, v53
v_add_f32 v22, v22, v54
v_add_f32 v23, v23, v55
s_branch L_tail
L_moe:
s_cmp_ge_u32 s34, 32
s_cbranch_scc1 L_end
s_lshr_b32 s32, s32, 6
v_and_b32 v0, 63, v0
s_lshl_b32 s36, s33, 1
s_add_u32 s36, s36, s34
s_sub_u32 s36, s36, 30
s_mov_b32 s40, 524288
v_lshlrev_b32 v6, 4, v0
v_mov_b32 v132, 0
v_mov_b32 v133, 0
v_mov_b32 v144, 0
s_waitcnt lgkmcnt(0)
s_mov_b64 s[16:17], s[66:67]
s_mov_b32 s18, 0x10000000
s_mov_b32 s19, 0x20000
s_mov_b64 s[24:25], s[64:65]
s_mov_b32 s26, 0x100
s_mov_b32 s27, 0x20000
s_mov_b64 s[4:5], s[54:55]
s_mov_b32 s6, 0x1e0000
s_mov_b32 s7, 0x20000
s_mov_b64 s[8:9], s[56:57]
s_mov_b32 s10, 0x1e0000
s_mov_b32 s11, 0x20000
s_mov_b64 s[12:13], s[60:61]
s_mov_b32 s14, 0x1e0000
s_mov_b32 s15, 0x20000
s_mov_b64 s[20:21], s[62:63]
s_mov_b32 s22, 0x280000
s_mov_b32 s23, 0x20000
v_mov_b32 v8, -1
v_mov_b32 v9, -1
v_mov_b32 v10, -1
v_mov_b32 v11, -1
s_lshl_b32 s0, s36, 14
s_lshl_b32 s3, s32, 11
s_add_u32 s0, s0, s3
s_add_u32 s0, s0, 3145728
buffer_store_dwordx4 v[8:11], v6, s[16:19], s0 offen offset:0 sc1
buffer_store_dwordx4 v[8:11], v6, s[16:19], s0 offen offset:1024 sc1
s_and_b32 s44, s36, 1
s_mul_i32 s0, s33, 384
s_lshl_b32 s1, s44, 8
s_add_u32 s1, s1, s0
s_mul_i32 s3, s32, 24576
s_add_u32 s1, s1, s3
v_lshrrev_b32 v1, 3, v0
v_mul_u32_u24 v1, 3072, v1
s_lshr_b32 s3, s32, 1
v_xor_b32 v2, s3, v0
v_and_b32 v2, 7, v2
v_lshl_add_u32 v1, v2, 4, v1
v_add_u32 v4, s1, v1
v_xor_b32 v5, 64, v4
s_lshl_b32 s1, s44, 6
s_add_u32 s0, s0, s1
s_and_b32 s3, s32, 3
s_mul_i32 s1, s3, 49152
s_add_u32 s0, s0, s1
s_add_u32 s0, s0, 128
v_lshrrev_b32 v1, 2, v0
v_mul_u32_u24 v1, 3072, v1
v_xor_b32 v2, s3, v0
v_and_b32 v2, 3, v2
v_lshl_add_u32 v1, v2, 4, v1
v_add_u32 v249, s0, v1
s_branch L_moe2
.p2align 12
L_pad_17:
s_setpc_b64 s[100:101]
L_pb_16:
L_cloop:
s_barrier
ds_read_b64_tr_b16 v[156:157], v244 offset:1024
ds_read_b64_tr_b16 v[158:159], v244 offset:1536
v_mfma_f32_16x16x32_bf16 v[8:11], v[164:167], v[104:107], v[8:11]
ds_read_b128 v[80:83], v245 offset:0
v_mfma_f32_16x16x32_bf16 v[12:15], v[164:167], v[108:111], v[12:15]
ds_read_b128 v[84:87], v245 offset:2048
v_mfma_f32_16x16x32_bf16 v[16:19], v[164:167], v[112:115], v[16:19]
ds_read_b128 v[88:91], v245 offset:4096
v_mfma_f32_16x16x32_bf16 v[20:23], v[164:167], v[116:119], v[20:23]
ds_read_b128 v[92:95], v245 offset:6144
v_mfma_f32_16x16x32_bf16 v[24:27], v[164:167], v[120:123], v[24:27]
ds_read_b128 v[96:99], v245 offset:8192
v_mfma_f32_16x16x32_bf16 v[28:31], v[164:167], v[124:127], v[28:31]
ds_read_b128 v[100:103], v245 offset:10240
s_waitcnt lgkmcnt(5)
v_mfma_f32_16x16x32_bf16 v[32:35], v[156:159], v[80:83], v[32:35]
ds_read_b64_tr_b16 v[160:161], v244 offset:2048
s_waitcnt lgkmcnt(5)
v_mfma_f32_16x16x32_bf16 v[36:39], v[156:159], v[84:87], v[36:39]
ds_read_b64_tr_b16 v[162:163], v244 offset:2560
s_waitcnt lgkmcnt(5)
v_mfma_f32_16x16x32_bf16 v[40:43], v[156:159], v[88:91], v[40:43]
ds_read_b64_tr_b16 v[152:153], v244 offset:0
s_waitcnt lgkmcnt(5)
v_mfma_f32_16x16x32_bf16 v[44:47], v[156:159], v[92:95], v[44:47]
ds_read_b64_tr_b16 v[154:155], v244 offset:512
s_waitcnt lgkmcnt(5)
v_mfma_f32_16x16x32_bf16 v[48:51], v[156:159], v[96:99], v[48:51]
ds_read_b64_tr_b16 v[168:169], v244 offset:13312
s_waitcnt lgkmcnt(5)
v_mfma_f32_16x16x32_bf16 v[52:55], v[156:159], v[100:103], v[52:55]
ds_read_b64_tr_b16 v[170:171], v244 offset:13824
s_waitcnt lgkmcnt(4)
v_mfma_f32_16x16x32_bf16 v[56:59], v[160:163], v[80:83], v[56:59]
ds_read_b128 v[104:107], v246 offset:0
v_mfma_f32_16x16x32_bf16 v[60:63], v[160:163], v[84:87], v[60:63]
ds_read_b128 v[108:111], v246 offset:2048
v_mfma_f32_16x16x32_bf16 v[64:67], v[160:163], v[88:91], v[64:67]
ds_read_b128 v[112:115], v246 offset:4096
v_mfma_f32_16x16x32_bf16 v[68:71], v[160:163], v[92:95], v[68:71]
ds_read_b128 v[116:119], v246 offset:6144
v_mfma_f32_16x16x32_bf16 v[72:75], v[160:163], v[96:99], v[72:75]
ds_read_b128 v[120:123], v246 offset:8192
v_mfma_f32_16x16x32_bf16 v[76:79], v[160:163], v[100:103], v[76:79]
ds_read_b128 v[124:127], v246 offset:10240
s_waitcnt lgkmcnt(8)
v_mfma_f32_16x16x32_bf16 v[8:11], v[152:155], v[80:83], v[8:11]
ds_read_b64_tr_b16 v[172:173], v244 offset:14336
v_mfma_f32_16x16x32_bf16 v[12:15], v[152:155], v[84:87], v[12:15]
ds_read_b64_tr_b16 v[174:175], v244 offset:14848
v_mfma_f32_16x16x32_bf16 v[16:19], v[152:155], v[88:91], v[16:19]
ds_read_b64_tr_b16 v[164:165], v244 offset:12288
v_mfma_f32_16x16x32_bf16 v[20:23], v[152:155], v[92:95], v[20:23]
ds_read_b64_tr_b16 v[166:167], v244 offset:12800
v_mfma_f32_16x16x32_bf16 v[24:27], v[152:155], v[96:99], v[24:27]
s_add_u32 s3, s65, 36864
s_cmp_eq_u32 s3, 155648
v_mfma_f32_16x16x32_bf16 v[28:31], v[152:155], v[100:103], v[28:31]
s_cselect_b32 s3, 8192, s3
s_sub_u32 s63, s3, s65
s_waitcnt lgkmcnt(4)
v_mfma_f32_16x16x32_bf16 v[32:35], v[168:171], v[104:107], v[32:35]
s_mov_b32 s65, s3
v_add_u32 v245, s63, v245
v_mfma_f32_16x16x32_bf16 v[36:39], v[168:171], v[108:111], v[36:39]
v_add_u32 v244, s63, v244
v_add_u32 v246, s63, v246
v_mfma_f32_16x16x32_bf16 v[40:43], v[168:171], v[112:115], v[40:43]
s_cmp_eq_u32 s42, s62
s_cbranch_scc1 L_ev
L_evb:
v_mfma_f32_16x16x32_bf16 v[44:47], v[168:171], v[116:119], v[44:47]
v_mfma_f32_16x16x32_bf16 v[48:51], v[168:171], v[120:123], v[48:51]
s_add_u32 s42, s42, 1
s_cmp_lt_u32 s42, 9
v_mfma_f32_16x16x32_bf16 v[52:55], v[168:171], v[124:127], v[52:55]
s_waitcnt lgkmcnt(2)
v_mfma_f32_16x16x32_bf16 v[56:59], v[172:175], v[104:107], v[56:59]
v_mfma_f32_16x16x32_bf16 v[60:63], v[172:175], v[108:111], v[60:63]
v_mfma_f32_16x16x32_bf16 v[64:67], v[172:175], v[112:115], v[64:67]
v_mfma_f32_16x16x32_bf16 v[68:71], v[172:175], v[116:119], v[68:71]
v_mfma_f32_16x16x32_bf16 v[72:75], v[172:175], v[120:123], v[72:75]
s_waitcnt lgkmcnt(0)
v_mfma_f32_16x16x32_bf16 v[76:79], v[172:175], v[124:127], v[76:79]
s_cbranch_scc1 L_cloop
v_mov_b32 v1, 1728
ds_read_b32 v1, v1
ds_read2_b64 v[180:183], v248 offset0:0 offset1:32
ds_read2_b64 v[184:187], v248 offset0:64 offset1:96
ds_read2_b64 v[188:191], v248 offset0:128 offset1:160
s_waitcnt lgkmcnt(0)
v_readfirstlane_b32 s41, v1
s_barrier
s_cmp_eq_u32 s41, 1
s_cbranch_scc0 L_gs
L_gsb:
ds_read_b64_tr_b16 v[156:157], v244 offset:1024
ds_read_b64_tr_b16 v[158:159], v244 offset:1536
v_mfma_f32_16x16x32_bf16 v[8:11], v[164:167], v[104:107], v[8:11]
ds_read_b128 v[80:83], v245 offset:0
v_mfma_f32_16x16x32_bf16 v[12:15], v[164:167], v[108:111], v[12:15]
ds_read_b128 v[84:87], v245 offset:2048
v_mfma_f32_16x16x32_bf16 v[16:19], v[164:167], v[112:115], v[16:19]
ds_read_b128 v[88:91], v245 offset:4096
v_mfma_f32_16x16x32_bf16 v[20:23], v[164:167], v[116:119], v[20:23]
ds_read_b128 v[92:95], v245 offset:6144
v_mfma_f32_16x16x32_bf16 v[24:27], v[164:167], v[120:123], v[24:27]
ds_read_b128 v[96:99], v245 offset:8192
v_mfma_f32_16x16x32_bf16 v[28:31], v[164:167], v[124:127], v[28:31]
ds_read_b128 v[100:103], v245 offset:10240
ds_read_b64_tr_b16 v[176:177], v244 offset:13312
ds_read_b64_tr_b16 v[178:179], v244 offset:13824
s_waitcnt lgkmcnt(7)
v_mfma_f32_16x16x32_bf16 v[32:35], v[156:159], v[80:83], v[32:35]
ds_read_b128 v[128:131], v246 offset:0
s_waitcnt lgkmcnt(7)
v_mfma_f32_16x16x32_bf16 v[36:39], v[156:159], v[84:87], v[36:39]
ds_read_b128 v[132:135], v246 offset:2048
s_waitcnt lgkmcnt(7)
v_mfma_f32_16x16x32_bf16 v[40:43], v[156:159], v[88:91], v[40:43]
ds_read_b128 v[136:139], v246 offset:4096
s_waitcnt lgkmcnt(7)
v_mfma_f32_16x16x32_bf16 v[44:47], v[156:159], v[92:95], v[44:47]
ds_read_b128 v[140:143], v246 offset:6144
s_waitcnt lgkmcnt(7)
v_mfma_f32_16x16x32_bf16 v[48:51], v[156:159], v[96:99], v[48:51]
ds_read_b128 v[144:147], v246 offset:8192
s_waitcnt lgkmcnt(7)
v_mfma_f32_16x16x32_bf16 v[52:55], v[156:159], v[100:103], v[52:55]
ds_read_b128 v[148:151], v246 offset:10240
s_waitcnt lgkmcnt(5)
v_mfma_f32_16x16x32_bf16 v[32:35], v[176:179], v[128:131], v[32:35]
ds_read_b64_tr_b16 v[160:161], v244 offset:2048
s_waitcnt lgkmcnt(5)
v_mfma_f32_16x16x32_bf16 v[36:39], v[176:179], v[132:135], v[36:39]
ds_read_b64_tr_b16 v[162:163], v244 offset:2560
s_waitcnt lgkmcnt(5)
v_mfma_f32_16x16x32_bf16 v[40:43], v[176:179], v[136:139], v[40:43]
ds_read_b64_tr_b16 v[152:153], v244 offset:0
s_waitcnt lgkmcnt(5)
v_mfma_f32_16x16x32_bf16 v[44:47], v[176:179], v[140:143], v[44:47]
ds_read_b64_tr_b16 v[154:155], v244 offset:512
s_waitcnt lgkmcnt(5)
v_mfma_f32_16x16x32_bf16 v[48:51], v[176:179], v[144:147], v[48:51]
ds_read_b64_tr_b16 v[172:173], v244 offset:14336
s_waitcnt lgkmcnt(5)
v_mfma_f32_16x16x32_bf16 v[52:55], v[176:179], v[148:151], v[52:55]
ds_read_b64_tr_b16 v[174:175], v244 offset:14848
s_waitcnt lgkmcnt(4)
v_mfma_f32_16x16x32_bf16 v[56:59], v[160:163], v[80:83], v[56:59]
ds_read_b64_tr_b16 v[164:165], v244 offset:12288
ds_read_b64_tr_b16 v[166:167], v244 offset:12800
v_mov_b32_dpp v192, v32 row_newbcast:0 row_mask:0xf bank_mask:0xf
v_mov_b32_dpp v193, v33 row_newbcast:0 row_mask:0xf bank_mask:0xf
v_mov_b32_dpp v194, v34 row_newbcast:0 row_mask:0xf bank_mask:0xf
v_mov_b32_dpp v195, v35 row_newbcast:0 row_mask:0xf bank_mask:0xf
v_fmac_f32 v32, v192, v180
v_fmac_f32 v33, v193, v180
v_fmac_f32 v34, v194, v180
v_mfma_f32_16x16x32_bf16 v[60:63], v[160:163], v[84:87], v[60:63]
v_fmac_f32 v35, v195, v180
v_cvt_pk_bf16_f32 v32, v32, v33
v_cvt_pk_bf16_f32 v33, v34, v35
v_mfma_f32_16x16x32_bf16 v[64:67], v[160:163], v[88:91], v[64:67]
ds_write_b64 v247, v[32:33] offset:13824
v_fmac_f32 v36, v192, v182
v_fmac_f32 v37, v193, v182
v_fmac_f32 v38, v194, v182
v_mfma_f32_16x16x32_bf16 v[68:71], v[160:163], v[92:95], v[68:71]
v_fmac_f32 v39, v195, v182
v_cvt_pk_bf16_f32 v36, v36, v37
v_cvt_pk_bf16_f32 v37, v38, v39
v_mfma_f32_16x16x32_bf16 v[72:75], v[160:163], v[96:99], v[72:75]
ds_write_b64 v247, v[36:37] offset:16128
v_fmac_f32 v40, v192, v184
v_fmac_f32 v41, v193, v184
v_fmac_f32 v42, v194, v184
v_mfma_f32_16x16x32_bf16 v[76:79], v[160:163], v[100:103], v[76:79]
v_fmac_f32 v43, v195, v184
v_cvt_pk_bf16_f32 v40, v40, v41
v_cvt_pk_bf16_f32 v41, v42, v43
s_waitcnt lgkmcnt(4)
v_mfma_f32_16x16x32_bf16 v[56:59], v[172:175], v[128:131], v[56:59]
ds_write_b64 v247, v[40:41] offset:18432
v_fmac_f32 v44, v192, v186
v_fmac_f32 v45, v193, v186
v_fmac_f32 v46, v194, v186
v_mfma_f32_16x16x32_bf16 v[60:63], v[172:175], v[132:135], v[60:63]
v_fmac_f32 v47, v195, v186
v_cvt_pk_bf16_f32 v44, v44, v45
v_cvt_pk_bf16_f32 v45, v46, v47
v_mfma_f32_16x16x32_bf16 v[64:67], v[172:175], v[136:139], v[64:67]
ds_write_b64 v247, v[44:45] offset:20736
v_fmac_f32 v48, v192, v188
v_fmac_f32 v49, v193, v188
v_fmac_f32 v50, v194, v188
v_mfma_f32_16x16x32_bf16 v[68:71], v[172:175], v[140:143], v[68:71]
v_fmac_f32 v51, v195, v188
v_cvt_pk_bf16_f32 v48, v48, v49
v_cvt_pk_bf16_f32 v49, v50, v51
v_mfma_f32_16x16x32_bf16 v[72:75], v[172:175], v[144:147], v[72:75]
ds_write_b64 v247, v[48:49] offset:23040
v_fmac_f32 v52, v192, v190
v_fmac_f32 v53, v193, v190
v_fmac_f32 v54, v194, v190
v_mfma_f32_16x16x32_bf16 v[76:79], v[172:175], v[148:151], v[76:79]
v_fmac_f32 v55, v195, v190
v_cvt_pk_bf16_f32 v52, v52, v53
v_cvt_pk_bf16_f32 v53, v54, v55
ds_write_b64 v247, v[52:53] offset:25344
v_mfma_f32_16x16x32_bf16 v[8:11], v[152:155], v[80:83], v[8:11]
v_mov_b32_dpp v192, v56 row_newbcast:0 row_mask:0xf bank_mask:0xf
v_mov_b32_dpp v193, v57 row_newbcast:0 row_mask:0xf bank_mask:0xf
v_mov_b32_dpp v194, v58 row_newbcast:0 row_mask:0xf bank_mask:0xf
v_mov_b32_dpp v195, v59 row_newbcast:0 row_mask:0xf bank_mask:0xf
v_fmac_f32 v56, v192, v180
v_fmac_f32 v57, v193, v180
v_fmac_f32 v58, v194, v180
v_mfma_f32_16x16x32_bf16 v[12:15], v[152:155], v[84:87], v[12:15]
v_fmac_f32 v59, v195, v180
v_cvt_pk_bf16_f32 v56, v56, v57
v_cvt_pk_bf16_f32 v57, v58, v59
v_mfma_f32_16x16x32_bf16 v[16:19], v[152:155], v[88:91], v[16:19]
s_waitcnt lgkmcnt(0)
s_barrier
ds_write_b64 v247, v[56:57] offset:27648
v_fmac_f32 v60, v192, v182
v_fmac_f32 v61, v193, v182
v_fmac_f32 v62, v194, v182
v_mfma_f32_16x16x32_bf16 v[20:23], v[152:155], v[92:95], v[20:23]
v_fmac_f32 v63, v195, v182
v_cvt_pk_bf16_f32 v60, v60, v61
v_cvt_pk_bf16_f32 v61, v62, v63
v_mfma_f32_16x16x32_bf16 v[24:27], v[152:155], v[96:99], v[24:27]
ds_write_b64 v247, v[60:61] offset:29952
v_fmac_f32 v64, v192, v184
v_fmac_f32 v65, v193, v184
v_fmac_f32 v66, v194, v184
v_mfma_f32_16x16x32_bf16 v[28:31], v[152:155], v[100:103], v[28:31]
v_fmac_f32 v67, v195, v184
v_cvt_pk_bf16_f32 v64, v64, v65
v_cvt_pk_bf16_f32 v65, v66, v67
v_mfma_f32_16x16x32_bf16 v[8:11], v[164:167], v[128:131], v[8:11]
ds_write_b64 v247, v[64:65] offset:32256
v_fmac_f32 v68, v192, v186
v_fmac_f32 v69, v193, v186
v_fmac_f32 v70, v194, v186
v_mfma_f32_16x16x32_bf16 v[12:15], v[164:167], v[132:135], v[12:15]
v_fmac_f32 v71, v195, v186
v_cvt_pk_bf16_f32 v68, v68, v69
v_cvt_pk_bf16_f32 v69, v70, v71
v_mfma_f32_16x16x32_bf16 v[16:19], v[164:167], v[136:139], v[16:19]
ds_write_b64 v247, v[68:69] offset:34560
v_fmac_f32 v72, v192, v188
v_fmac_f32 v73, v193, v188
v_fmac_f32 v74, v194, v188
v_mfma_f32_16x16x32_bf16 v[20:23], v[164:167], v[140:143], v[20:23]
v_fmac_f32 v75, v195, v188
v_cvt_pk_bf16_f32 v72, v72, v73
v_cvt_pk_bf16_f32 v73, v74, v75
v_mfma_f32_16x16x32_bf16 v[24:27], v[164:167], v[144:147], v[24:27]
ds_write_b64 v247, v[72:73] offset:36864
v_fmac_f32 v76, v192, v190
v_fmac_f32 v77, v193, v190
v_fmac_f32 v78, v194, v190
v_mfma_f32_16x16x32_bf16 v[28:31], v[164:167], v[148:151], v[28:31]
v_fmac_f32 v79, v195, v190
v_cvt_pk_bf16_f32 v76, v76, v77
v_cvt_pk_bf16_f32 v77, v78, v79
ds_write_b64 v247, v[76:77] offset:39168
v_mov_b32_dpp v192, v8 row_newbcast:0 row_mask:0xf bank_mask:0xf
v_mov_b32_dpp v193, v9 row_newbcast:0 row_mask:0xf bank_mask:0xf
v_mov_b32_dpp v194, v10 row_newbcast:0 row_mask:0xf bank_mask:0xf
v_mov_b32_dpp v195, v11 row_newbcast:0 row_mask:0xf bank_mask:0xf
v_pk_fma_f32 v[8:9], v[192:193], v[180:181], v[8:9] op_sel_hi:[1,0,1]
v_pk_fma_f32 v[10:11], v[194:195], v[180:181], v[10:11] op_sel_hi:[1,0,1]
v_cvt_pk_bf16_f32 v8, v8, v9
v_cvt_pk_bf16_f32 v9, v10, v11
ds_write_b64 v247, v[8:9] offset:0
v_pk_fma_f32 v[12:13], v[192:193], v[182:183], v[12:13] op_sel_hi:[1,0,1]
v_pk_fma_f32 v[14:15], v[194:195], v[182:183], v[14:15] op_sel_hi:[1,0,1]
v_cvt_pk_bf16_f32 v12, v12, v13
v_cvt_pk_bf16_f32 v13, v14, v15
ds_write_b64 v247, v[12:13] offset:2304
v_pk_fma_f32 v[16:17], v[192:193], v[184:185], v[16:17] op_sel_hi:[1,0,1]
v_pk_fma_f32 v[18:19], v[194:195], v[184:185], v[18:19] op_sel_hi:[1,0,1]
v_cvt_pk_bf16_f32 v16, v16, v17
v_cvt_pk_bf16_f32 v17, v18, v19
ds_write_b64 v247, v[16:17] offset:4608
v_pk_fma_f32 v[20:21], v[192:193], v[186:187], v[20:21] op_sel_hi:[1,0,1]
v_pk_fma_f32 v[22:23], v[194:195], v[186:187], v[22:23] op_sel_hi:[1,0,1]
v_cvt_pk_bf16_f32 v20, v20, v21
v_cvt_pk_bf16_f32 v21, v22, v23
ds_write_b64 v247, v[20:21] offset:6912
v_pk_fma_f32 v[24:25], v[192:193], v[188:189], v[24:25] op_sel_hi:[1,0,1]
v_pk_fma_f32 v[26:27], v[194:195], v[188:189], v[26:27] op_sel_hi:[1,0,1]
v_cvt_pk_bf16_f32 v24, v24, v25
v_cvt_pk_bf16_f32 v25, v26, v27
ds_write_b64 v247, v[24:25] offset:9216
v_pk_fma_f32 v[28:29], v[192:193], v[190:191], v[28:29] op_sel_hi:[1,0,1]
v_pk_fma_f32 v[30:31], v[194:195], v[190:191], v[30:31] op_sel_hi:[1,0,1]
v_cvt_pk_bf16_f32 v28, v28, v29
v_cvt_pk_bf16_f32 v29, v30, v31
ds_write_b64 v247, v[28:29] offset:11520
s_waitcnt lgkmcnt(0)
s_barrier
s_cmp_lt_u32 s32, 2
s_cbranch_scc0 L_c23
ds_read_b64 v[24:25], v202 offset:0
ds_read_b64 v[26:27], v202 offset:1152
ds_read_b64 v[28:29], v206 offset:0
ds_read_b64 v[30:31], v207 offset:0
ds_read_b64 v[32:33], v203 offset:0
ds_read_b64 v[34:35], v203 offset:1152
ds_read_b64 v[36:37], v208 offset:0
ds_read_b64 v[38:39], v209 offset:0
ds_read_b64 v[40:41], v201 offset:0
ds_read_b64 v[42:43], v201 offset:1152
ds_read_b64 v[44:45], v210 offset:0
ds_read_b64 v[46:47], v211 offset:0
ds_read_b64 v[96:97], v200 offset:0
ds_read_b64 v[98:99], v200 offset:1152
ds_read_b64 v[100:101], v200 offset:40
ds_read_b64 v[102:103], v200 offset:1192
ds_read_b64 v[104:105], v201 offset:9216
ds_read_b64 v[106:107], v201 offset:10368
s_add_u32 s0, s37, 1
s_sub_u32 s1, 5, s37
s_min_u32 s0, s0, s1
s_lshl_b32 s0, s0, 4
s_sub_u32 s1, 64, s0
s_cmp_le_u32 s37, 2
s_cselect_b32 s1, s1, 16
s_bfm_b64 s[100:101], s0, s1
s_waitcnt lgkmcnt(14)
v_mfma_f32_16x16x32_bf16 v[152:155], v[24:27], v[28:31], 0
s_waitcnt lgkmcnt(10)
v_mfma_f32_16x16x32_bf16 v[156:159], v[32:35], v[36:39], 0
s_waitcnt lgkmcnt(6)
v_mfma_f32_16x16x32_bf16 v[152:155], v[40:43], v[44:47], v[152:155]
ds_read_b64 v[108:109], v204 offset:0
ds_read_b64 v[110:111], v205 offset:0
ds_read_b64 v[112:113], v204 offset:40
ds_read_b64 v[114:115], v205 offset:40
ds_read_b64 v[116:117], v212 offset:0
ds_read_b64 v[118:119], v213 offset:0
ds_read_b64 v[120:121], v214 offset:0
ds_read_b64 v[122:123], v215 offset:0
v_mov_b32 v176, 0
v_mov_b32 v177, 0
v_mov_b32 v178, 0
v_mov_b32 v179, 0
v_mov_b32 v180, 0
v_mov_b32 v181, 0
v_mov_b32 v182, 0
v_mov_b32 v183, 0
v_mov_b32 v184, 0
v_mov_b32 v185, 0
v_mov_b32 v186, 0
v_mov_b32 v187, 0
v_mov_b32 v188, 0
v_mov_b32 v189, 0
v_mov_b32 v190, 0
v_mov_b32 v191, 0
v_permlane16_swap_b32 v152, v156
v_permlane16_swap_b32 v153, v157
v_permlane16_swap_b32 v154, v158
v_permlane16_swap_b32 v155, v159
v_cndmask_b32 v2, v156, v152, s[44:45]
v_cndmask_b32 v3, v157, v153, s[46:47]
v_cndmask_b32 v194, v158, v154, s[48:49]
v_cndmask_b32 v195, v159, v155, s[50:51]
v_or_b32 v192, 0xffff, v2
v_perm_b32 v193, v3, v2, s55
s_cmp_eq_u32 s41, 1
s_cbranch_scc0 L_gl_18g
buffer_store_dwordx4 v[192:195], v224, s[20:23], s54 offen
L_gl_18b:
v_add_u32 v1, 128, v222
v_cndmask_b32 v4, v1, v222, s[44:45]
ds_read_b64 v[168:169], v4 offset:1024
v_cndmask_b32 v4, v1, v222, s[46:47]
ds_read_b64 v[170:171], v4 offset:1056
v_cndmask_b32 v4, v1, v222, s[48:49]
ds_read_b64 v[172:173], v4 offset:1088
v_cndmask_b32 v4, v1, v222, s[50:51]
ds_read_b64 v[174:175], v4 offset:1120
ds_read_b32 v5, v223 offset:1024
s_waitcnt lgkmcnt(11)
v_mfma_f32_16x16x32_bf16 v[160:163], v[96:99], v[108:111], 0
s_waitcnt lgkmcnt(9)
v_mfma_f32_16x16x32_bf16 v[164:167], v[100:103], v[112:115], 0
s_waitcnt lgkmcnt(7)
v_mfma_f32_16x16x32_bf16 v[160:163], v[104:107], v[116:119], v[160:163]
s_waitcnt lgkmcnt(5)
v_mfma_f32_16x16x32_bf16 v[164:167], v[104:107], v[120:123], v[164:167]
s_setprio 2
s_nop 6
v_permlane16_swap_b32 v160, v164
v_permlane16_swap_b32 v161, v165
v_permlane16_swap_b32 v162, v166
v_permlane16_swap_b32 v163, v167
v_cndmask_b32 v196, v164, v160, s[44:45]
v_cndmask_b32 v197, v165, v161, s[46:47]
v_cndmask_b32 v198, v166, v162, s[48:49]
v_cndmask_b32 v199, v167, v163, s[50:51]
s_waitcnt lgkmcnt(0)
v_mul_f32 v5, 0x3ea52b5c, v5
v_fma_f32 v196, v196, v168, v169
v_fma_f32 v197, v197, v170, v171
v_fma_f32 v198, v198, v172, v173
v_fma_f32 v199, v199, v174, v175
v_max3_f32 v6, v196, v197, v198
v_max_f32 v6, v6, v199
v_mov_b32 v7, v6
s_nop 1
v_permlane32_swap_b32 v6, v7
v_max_f32 v6, v6, v7
v_mul_f32 v6, v6, v5
v_fma_f32 v196, v196, v5, -v6
v_fma_f32 v197, v197, v5, -v6
v_fma_f32 v198, v198, v5, -v6
v_fma_f32 v199, v199, v5, -v6
v_exp_f32 v196, v196
v_exp_f32 v197, v197
v_exp_f32 v198, v198
v_exp_f32 v199, v199
ds_read_b64_tr_b16 v[64:65], v216 offset:0
ds_read_b64_tr_b16 v[66:67], v216 offset:1152
ds_read_b64_tr_b16 v[68:69], v216 offset:40
ds_read_b64_tr_b16 v[70:71], v216 offset:1192
ds_read_b64_tr_b16 v[72:73], v217 offset:9216
ds_read_b64_tr_b16 v[74:75], v217 offset:10368
ds_read_b64_tr_b16 v[76:77], v218 offset:9216
ds_read_b64_tr_b16 v[78:79], v218 offset:10368
v_add_f32 v6, v196, v197
v_add_f32 v7, v198, v199
v_add_f32 v6, v6, v7
v_mov_b32 v7, v6
v_mul_f32 v196, v196, v168
v_mul_f32 v197, v197, v170
v_permlane32_swap_b32 v6, v7
v_mul_f32 v198, v198, v172
v_add_f32 v6, v6, v7
v_rcp_f32 v6, v6
v_mul_f32 v199, v199, v174
v_mul_f32 v196, v196, v6
v_mul_f32 v197, v197, v6
v_mul_f32 v198, v198, v6
v_mul_f32 v199, v199, v6
v_cvt_pk_bf16_f32 v196, v196, v197
v_cvt_pk_bf16_f32 v197, v198, v199
s_mov_b64 exec, s[52:53]
v_and_b32 v176, v220, v196
v_bfi_b32 v180, v220, 0, v196
v_and_b32 v177, v221, v197
v_bfi_b32 v181, v221, 0, v197
s_not_b64 exec, exec
v_and_b32 v178, v220, v196
v_bfi_b32 v182, v220, 0, v196
v_and_b32 v179, v221, v197
v_bfi_b32 v183, v221, 0, v197
s_mov_b64 exec, -1
v_permlane16_swap_b32 v176, v180
v_permlane16_swap_b32 v177, v181
v_permlane16_swap_b32 v178, v182
v_permlane16_swap_b32 v179, v183
buffer_load_dwordx4 v[92:95], v225, s[20:23], s54 offen sc1
s_waitcnt lgkmcnt(0)
v_mfma_f32_16x16x32_bf16 v[152:155], v[64:67], v[176:179], 0
v_mfma_f32_16x16x32_bf16 v[156:159], v[68:71], v[180:183], 0
v_mfma_f32_16x16x32_bf16 v[160:163], v[72:75], v[176:179], 0
v_mfma_f32_16x16x32_bf16 v[164:167], v[76:79], v[180:183], 0
s_nop 4
v_cvt_pk_bf16_f32 v196, v152, v153
v_cvt_pk_bf16_f32 v197, v154, v155
v_cvt_pk_bf16_f32 v198, v156, v157
v_cvt_pk_bf16_f32 v199, v158, v159
s_cmp_eq_u32 s41, 1
s_cbranch_scc0 L_gl_19g
buffer_store_dwordx4 v[196:199], v228, s[20:23], s61 offen
L_gl_19b:
s_mov_b64 exec, 0xffff
v_cvt_pk_bf16_f32 v80, v160, v161
v_cvt_pk_bf16_f32 v81, v162, v163
v_cvt_pk_bf16_f32 v82, v164, v165
v_cvt_pk_bf16_f32 v83, v166, v167
ds_write_b128 v249, v[80:83] offset:1024
ds_write_b32 v250, v250 offset:16
s_mov_b64 exec, -1
v_add_u32 v1, 128, v222
v_cndmask_b32 v4, v1, v222, s[44:45]
ds_read_b64 v[168:169], v4 offset:0
v_cndmask_b32 v4, v1, v222, s[46:47]
ds_read_b64 v[170:171], v4 offset:32
v_cndmask_b32 v4, v1, v222, s[48:49]
ds_read_b64 v[172:173], v4 offset:64
v_cndmask_b32 v4, v1, v222, s[50:51]
ds_read_b64 v[174:175], v4 offset:96
ds_read_b32 v5, v223 offset:0
ds_read_b64_tr_b16 v[72:73], v217 offset:0
ds_read_b64_tr_b16 v[74:75], v217 offset:1152
ds_read_b64_tr_b16 v[76:77], v218 offset:0
ds_read_b64_tr_b16 v[78:79], v218 offset:1152
s_waitcnt vmcnt(1)
v_cmp_eq_u32 vcc, -1, v92
s_cbranch_vccnz L_h0re0
L_h0ge0:
v_perm_b32 v92, v92, v93, s56
v_add_f32 v193, v3, v93
v_add_f32 v194, v194, v94
v_add_f32 v195, v195, v95
v_add_f32 v192, v2, v92
s_waitcnt lgkmcnt(0)
v_mul_f32 v5, 0x3ea52b5c, v5
v_fma_f32 v192, v192, v168, v169
v_fma_f32 v193, v193, v170, v171
v_fma_f32 v194, v194, v172, v173
v_fma_f32 v195, v195, v174, v175
v_max3_f32 v6, v192, v193, v194
v_max_f32 v6, v6, v195
v_mov_b32 v7, v6
s_nop 1
v_permlane32_swap_b32 v6, v7
v_max_f32 v6, v6, v7
v_mul_f32 v6, v6, v5
v_fma_f32 v192, v192, v5, -v6
v_fma_f32 v193, v193, v5, -v6
v_fma_f32 v194, v194, v5, -v6
v_fma_f32 v195, v195, v5, -v6
v_exp_f32 v192, v192
v_exp_f32 v193, v193
v_exp_f32 v194, v194
v_exp_f32 v195, v195
v_add_f32 v6, v192, v193
v_add_f32 v7, v194, v195
v_add_f32 v6, v6, v7
v_mov_b32 v7, v6
v_mul_f32 v192, v192, v168
v_mul_f32 v193, v193, v170
v_permlane32_swap_b32 v6, v7
v_mul_f32 v194, v194, v172
v_add_f32 v6, v6, v7
v_rcp_f32 v6, v6
v_mul_f32 v195, v195, v174
v_mul_f32 v192, v192, v6
v_mul_f32 v193, v193, v6
v_mul_f32 v194, v194, v6
v_mul_f32 v195, v195, v6
v_cvt_pk_bf16_f32 v192, v192, v193
v_cvt_pk_bf16_f32 v193, v194, v195
ds_read_b32 v1, v250 offset:0
ds_read_b128 v[80:83], v249 offset:0
s_mov_b64 exec, s[52:53]
v_and_b32 v184, v220, v192
v_bfi_b32 v188, v220, 0, v192
v_and_b32 v185, v221, v193
v_bfi_b32 v189, v221, 0, v193
s_not_b64 exec, exec
v_and_b32 v186, v220, v192
v_bfi_b32 v190, v220, 0, v192
v_and_b32 v187, v221, v193
v_bfi_b32 v191, v221, 0, v193
s_mov_b64 exec, -1
v_permlane16_swap_b32 v184, v188
v_permlane16_swap_b32 v185, v189
v_permlane16_swap_b32 v186, v190
v_permlane16_swap_b32 v187, v191
s_nop 1
v_mfma_f32_16x16x32_bf16 v[152:155], v[72:75], v[184:187], 0
v_mfma_f32_16x16x32_bf16 v[156:159], v[76:79], v[184:187], 0
v_mfma_f32_16x16x32_bf16 v[160:163], v[76:79], v[188:191], 0
s_waitcnt lgkmcnt(0)
v_cmp_eq_u32 vcc, 0, v1
s_cbranch_vccnz L_lre0
L_lge0:
s_mov_b32 exec_lo, 0xffff0000
s_nop 1
v_cvt_pk_bf16_f32 v80, v152, v153
v_cvt_pk_bf16_f32 v81, v154, v155
v_cvt_pk_bf16_f32 v82, v156, v157
v_cvt_pk_bf16_f32 v83, v158, v159
s_mov_b64 exec, s[100:101]
v_cvt_pk_bf16_f32 v82, v160, v161
v_cvt_pk_bf16_f32 v83, v162, v163
s_mov_b64 exec, -1
s_cmp_eq_u32 s41, 1
s_cbranch_scc0 L_gl_20g
buffer_store_dwordx4 v[80:83], v226, s[20:23], s54 offen
L_gl_20b:
s_branch L_fsh
L_gl_18g:
buffer_store_dwordx4 v[192:195], v224, s[20:23], s54 offen sc1
s_branch L_gl_18b
L_gl_19g:
buffer_store_dwordx4 v[196:199], v228, s[20:23], s61 offen sc1
s_branch L_gl_19b
L_h0re0:
s_sub_u32 s40, s40, 1
s_cbranch_scc1 L_h0xe0
buffer_load_dwordx4 v[92:95], v225, s[20:23], s54 offen sc1
s_waitcnt vmcnt(0)
v_cmp_eq_u32 vcc, -1, v92
s_cbranch_vccnz L_h0re0
s_branch L_h0ge0
L_h0xe0:
s_mov_b32 s40, 0
s_branch L_h0ge0
L_lre0:
ds_read_b32 v1, v250 offset:0
ds_read_b128 v[80:83], v249 offset:0
s_waitcnt lgkmcnt(0)
v_cmp_eq_u32 vcc, 0, v1
s_cbranch_vccnz L_lre0
s_branch L_lge0
L_gl_20g:
buffer_store_dwordx4 v[80:83], v226, s[20:23], s54 offen sc1
s_branch L_gl_20b
L_moe2:
s_cmp_lt_u32 s32, 4
s_cselect_b64 s[28:29], s[4:5], s[8:9]
s_cselect_b32 s62, 0, 128
s_mov_b32 s30, 0x1e0000
s_mov_b32 s31, 0x20000
s_lshl_b32 s61, s32, 10
s_add_u32 s62, s62, s61
s_mul_i32 s44, s44, 983040
s_mul_i32 s46, s36, 122880
s_and_b32 s3, s36, 1
s_cselect_b32 s65, 40960, 0
s_cselect_b32 s66, 0, 81920
s_add_u32 s65, s65, s46
s_add_u32 s66, s66, s46
s_add_u32 s67, s65, 40960
s_cmp_lt_u32 s32, 5
s_cbranch_scc1 L_r0
s_add_u32 s45, s44, 0
s_add_u32 m0, s61, 0
s_nop 0
buffer_load_dwordx4 v4, s[4:7], s45 offen lds
s_add_u32 m0, s61, 8192
s_nop 0
buffer_load_dwordx4 v5, s[8:11], s45 offen lds
s_add_u32 s45, s44, 0
s_add_u32 m0, s62, 16384
s_nop 0
buffer_load_dwordx4 v249, s[28:31], s45 offen lds
s_waitcnt vmcnt(3)
s_barrier
s_branch L_r1
L_r0:
s_waitcnt vmcnt(0)
s_barrier
s_cmp_eq_u32 s32, 0
s_cbranch_scc0 L_nroot_29
s_lshl_b32 s0, s36, 4
v_mov_b32 v8, 1
s_mov_b64 exec, 1
buffer_store_dword v8, off, s[24:27], s0 sc1
s_mov_b64 exec, -1
L_nroot_29:
s_add_u32 s45, s44, 0
s_add_u32 m0, s61, 0
s_nop 0
buffer_load_dwordx4 v4, s[4:7], s45 offen lds
s_add_u32 m0, s61, 8192
s_nop 0
buffer_load_dwordx4 v5, s[8:11], s45 offen lds
s_add_u32 s45, s44, 0
s_add_u32 m0, s62, 16384
s_nop 0
buffer_load_dwordx4 v249, s[28:31], s45 offen lds
L_r1:
s_add_u32 s45, s44, 196608
s_add_u32 m0, s61, 42240
s_nop 0
buffer_load_dwordx4 v4, s[4:7], s45 offen lds
s_add_u32 m0, s61, 50432
s_nop 0
buffer_load_dwordx4 v5, s[8:11], s45 offen lds
s_add_u32 s45, s44, 196608
s_add_u32 m0, s62, 58624
s_nop 0
buffer_load_dwordx4 v249, s[28:31], s45 offen lds
v_lshrrev_b32 v1, 5, v0
v_bfe_u32 v2, v0, 2, 1
v_lshl_add_u32 v1, v1, 2, v2
v_bfe_u32 v2, v0, 4, 1
v_bfe_u32 v3, v0, 3, 1
v_lshl_add_u32 v3, v3, 1, v2
v_lshl_add_u32 v1, v3, 4, v1
v_xor_b32 v3, s32, v3
v_and_b32 v2, 1, v0
v_lshlrev_b32 v2, 3, v2
v_lshl_add_u32 v2, v3, 4, v2
v_bfe_u32 v3, v0, 1, 1
v_lshl_add_u32 v251, v1, 6, v2
v_mul_u32_u24 v8, 4224, v3
v_add_u32 v251, v251, v8
v_lshl_add_u32 v250, v1, 7, v2
v_mul_u32_u24 v8, 8256, v3
v_xor_b32 v250, v250, v8
v_mov_b32 v228, 0
v_mov_b32 v229, 0
v_mov_b32 v230, 0
v_mov_b32 v231, 0
v_mov_b32 v232, 0
v_mov_b32 v233, 0
v_mov_b32 v234, 0
v_mov_b32 v235, 0
v_mov_b32 v1, 0x4444
v_mov_b32 v2, 0xeeee
s_mov_b32 vcc_lo, 0xaaaaaaaa
s_mov_b32 vcc_hi, 0xaaaaaaaa
v_cndmask_b32 v7, v1, v2, vcc
v_and_b32 v1, 48, v0
v_and_b32 v2, 1, v0
v_lshlrev_b32 v2, 4, v2
v_lshl_add_u32 v252, v1, 1, v2
v_add_u32 v254, 126720, v252
v_add_u32 v252, 127232, v252
v_add_u32 v1, 126848, v1
v_mov_b32 v2, 126912
v_cndmask_b32 v255, v1, v2, vcc
v_mov_b32 v3, 0
v_lshl_add_u32 v2, v0, 2, v2
s_mov_b32 exec_hi, 0
ds_write_b32 v2, v3
s_mov_b64 exec, -1
s_and_b32 s0, s32, 4
s_add_u32 s0, s0, s32
v_bfe_u32 v1, v0, 4, 1
v_lshl_add_u32 v1, v1, 2, s0
v_lshrrev_b32 v2, 1, v1
v_lshlrev_b32 v2, 2, v2
v_and_or_b32 v2, v1, 1, v2
v_and_or_b32 v2, v0, 2, v2
v_bfe_u32 v3, v0, 2, 1
v_lshl_add_u32 v2, v2, 1, v3
v_and_b32 v3, 1, v0
v_lshl_add_u32 v2, v2, 1, v3
v_and_b32 v3, 7, v0
v_lshl_add_u32 v3, v1, 3, v3
v_cmp_gt_u32 vcc, 8, v1
s_nop 1
v_cndmask_b32 v2, v3, v2, vcc
v_lshlrev_b32 v2, 1, v2
v_add_u32 v253, 126720, v2
s_lshl_b32 s47, s32, 15
s_lshl_b32 s3, s36, 6
s_add_u32 s47, s47, s3
s_add_u32 s47, s47, 3162112
v_lshrrev_b32 v1, 2, v0
v_and_b32 v2, 3, v0
v_lshlrev_b32 v2, 4, v2
v_lshl_add_u32 v2, v1, 10, v2
v_lshlrev_b32 v1, 4, v1
v_add_u32 v1, 4032, v1
s_mov_b64 vcc, 0xffff
v_cndmask_b32 v246, v1, v2, vcc
s_cmp_lt_u32 s32, 4
s_cselect_b32 s50, 0x00ff0000, 0
s_or_b32 s50, s50, 0xff
s_mov_b32 s51, 0
s_sub_u32 s3, s32, 4
s_lshl_b32 s3, s3, 4
s_add_u32 s52, s3, s36
s_mul_i32 s3, s52, 52
s_lshr_b32 s3, s3, 8
s_mul_i32 s3, s3, 27648
s_lshl_b32 s53, s52, 10
s_add_u32 s53, s53, s3
s_add_u32 s53, s53, 3162112
s_mov_b32 s49, 131072
s_mov_b32 s63, 0
s_mul_i32 s3, s52, 52
s_lshr_b32 s3, s3, 8
s_mul_i32 s0, s3, 5
s_sub_u32 s0, s52, s0
s_mul_i32 s3, s3, 80
s_lshl_b32 s1, s0, 2
s_cmp_eq_u32 s0, 4
s_cselect_b32 s1, 64, s1
s_cselect_b32 s0, 0, 4
s_cselect_b32 s48, 2, 0
s_add_u32 s3, s3, s1
v_bfe_u32 v1, v0, 4, 1
v_lshrrev_b32 v2, 5, v0
v_lshl_add_u32 v1, v1, 1, v2
v_lshlrev_b32 v1, s0, v1
v_and_b32 v2, 3, v0
v_lshlrev_b32 v2, s48, v2
v_add3_u32 v1, v1, v2, s3
v_lshlrev_b32 v128, 1, v1
v_lshlrev_b32 v129, 2, v1
v_lshrrev_b32 v1, 4, v0
v_bfe_u32 v2, v0, 2, 2
v_lshl_add_u32 v1, v1, 3, v2
v_mul_u32_u24 v1, 1280, v1
v_and_b32 v3, 1, v0
v_lshl_add_u32 v1, v3, 3, v1
v_bfe_u32 v2, v0, 2, 3
v_lshlrev_b32 v2, 1, v2
v_bfe_u32 v3, v0, 1, 1
s_mul_i32 s0, s32, 10
s_add_u32 s3, s0, 0
v_add_u32 v236, s3, v3
v_xor_b32 v236, v236, v2
v_lshl_add_u32 v236, v236, 4, v1
s_add_u32 s3, s0, 2
v_add_u32 v237, s3, v3
v_xor_b32 v237, v237, v2
v_lshl_add_u32 v237, v237, 4, v1
s_add_u32 s3, s0, 4
v_add_u32 v238, s3, v3
v_xor_b32 v238, v238, v2
v_lshl_add_u32 v238, v238, 4, v1
s_add_u32 s3, s0, 6
v_add_u32 v239, s3, v3
v_xor_b32 v239, v239, v2
v_lshl_add_u32 v239, v239, 4, v1
s_add_u32 s3, s0, 8
v_add_u32 v240, s3, v3
v_xor_b32 v240, v240, v2
v_lshl_add_u32 v240, v240, 4, v1
s_waitcnt vmcnt(3) lgkmcnt(0)
s_barrier
s_add_u32 s45, s44, 393216
s_add_u32 m0, s61, 84480
s_nop 0
buffer_load_dwordx4 v4, s[4:7], s45 offen lds
s_add_u32 m0, s61, 92672
s_nop 0
buffer_load_dwordx4 v5, s[8:11], s45 offen lds
s_add_u32 s45, s44, 393216
s_add_u32 m0, s62, 100864
s_nop 0
buffer_load_dwordx4 v249, s[28:31], s45 offen lds
v_add_u32 v1, 0, v250
ds_read_b64_tr_b16 v[8:9], v1 offset:0
ds_read_b64_tr_b16 v[10:11], v1 offset:256
ds_read_b64_tr_b16 v[12:13], v1 offset:1024
ds_read_b64_tr_b16 v[14:15], v1 offset:1280
s_cmp_lt_u32 s32, 4
s_cbranch_scc0 L_g0
v_add_u32 v1, 16384, v251
ds_read_b64_tr_b16 v[88:89], v1 offset:0
ds_read_b64_tr_b16 v[90:91], v1 offset:128
ds_read_b64_tr_b16 v[92:93], v1 offset:512
ds_read_b64_tr_b16 v[94:95], v1 offset:640
L_g0:
s_waitcnt vmcnt(3) lgkmcnt(0)
s_barrier
s_add_u32 s45, s44, 589824
s_add_u32 m0, s61, 0
s_nop 0
buffer_load_dwordx4 v4, s[4:7], s45 offen lds
s_add_u32 m0, s61, 8192
s_nop 0
buffer_load_dwordx4 v5, s[8:11], s45 offen lds
s_add_u32 s45, s44, 589824
s_add_u32 m0, s62, 16384
s_nop 0
buffer_load_dwordx4 v249, s[28:31], s45 offen lds
v_add_u32 v1, 42240, v250
ds_read_b64_tr_b16 v[16:17], v1 offset:0
ds_read_b64_tr_b16 v[18:19], v1 offset:256
ds_read_b64_tr_b16 v[20:21], v1 offset:1024
ds_read_b64_tr_b16 v[22:23], v1 offset:1280
s_cmp_lt_u32 s32, 4
s_cbranch_scc0 L_g1
v_add_u32 v1, 58624, v251
ds_read_b64_tr_b16 v[96:97], v1 offset:0
ds_read_b64_tr_b16 v[98:99], v1 offset:128
ds_read_b64_tr_b16 v[100:101], v1 offset:512
ds_read_b64_tr_b16 v[102:103], v1 offset:640
L_g1:
s_waitcnt vmcnt(3) lgkmcnt(0)
s_barrier
s_add_u32 s45, s44, 786432
s_add_u32 m0, s61, 42240
s_nop 0
buffer_load_dwordx4 v4, s[4:7], s45 offen lds
s_add_u32 m0, s61, 50432
s_nop 0
buffer_load_dwordx4 v5, s[8:11], s45 offen lds
s_add_u32 s45, s44, 786432
s_add_u32 m0, s62, 58624
s_nop 0
buffer_load_dwordx4 v249, s[28:31], s45 offen lds
v_add_u32 v1, 84480, v250
ds_read_b64_tr_b16 v[24:25], v1 offset:0
ds_read_b64_tr_b16 v[26:27], v1 offset:256
ds_read_b64_tr_b16 v[28:29], v1 offset:1024
ds_read_b64_tr_b16 v[30:31], v1 offset:1280
s_cmp_lt_u32 s32, 4
s_cbranch_scc0 L_g2
v_add_u32 v1, 100864, v251
ds_read_b64_tr_b16 v[104:105], v1 offset:0
ds_read_b64_tr_b16 v[106:107], v1 offset:128
ds_read_b64_tr_b16 v[108:109], v1 offset:512
ds_read_b64_tr_b16 v[110:111], v1 offset:640
L_g2:
s_waitcnt vmcnt(3) lgkmcnt(0)
s_barrier
s_sub_u32 s45, 983040, s44
s_add_u32 m0, s61, 84480
s_nop 0
buffer_load_dwordx4 v4, s[4:7], s45 offen lds
s_add_u32 m0, s61, 92672
s_nop 0
buffer_load_dwordx4 v5, s[8:11], s45 offen lds
s_sub_u32 s45, 1179648, s44
s_add_u32 m0, s61, 100864
s_nop 0
buffer_load_dwordx4 v4, s[4:7], s45 offen lds
s_add_u32 m0, s61, 109056
s_nop 0
buffer_load_dwordx4 v5, s[8:11], s45 offen lds
v_add_u32 v1, 0, v250
ds_read_b64_tr_b16 v[32:33], v1 offset:0
ds_read_b64_tr_b16 v[34:35], v1 offset:256
ds_read_b64_tr_b16 v[36:37], v1 offset:1024
ds_read_b64_tr_b16 v[38:39], v1 offset:1280
s_cmp_lt_u32 s32, 4
s_cbranch_scc0 L_g3
v_add_u32 v1, 16384, v251
ds_read_b64_tr_b16 v[112:113], v1 offset:0
ds_read_b64_tr_b16 v[114:115], v1 offset:128
ds_read_b64_tr_b16 v[116:117], v1 offset:512
ds_read_b64_tr_b16 v[118:119], v1 offset:640
L_g3:
s_waitcnt vmcnt(4) lgkmcnt(0)
s_barrier
s_sub_u32 s45, 1376256, s44
s_add_u32 m0, s61, 0
s_nop 0
buffer_load_dwordx4 v4, s[4:7], s45 offen lds
s_add_u32 m0, s61, 8192
s_nop 0
buffer_load_dwordx4 v5, s[8:11], s45 offen lds
s_sub_u32 s45, 1572864, s44
s_add_u32 m0, s61, 16384
s_nop 0
buffer_load_dwordx4 v4, s[4:7], s45 offen lds
s_add_u32 m0, s61, 24576
s_nop 0
buffer_load_dwordx4 v5, s[8:11], s45 offen lds
v_add_u32 v1, 42240, v250
ds_read_b64_tr_b16 v[40:41], v1 offset:0
ds_read_b64_tr_b16 v[42:43], v1 offset:256
ds_read_b64_tr_b16 v[44:45], v1 offset:1024
ds_read_b64_tr_b16 v[46:47], v1 offset:1280
s_cmp_lt_u32 s32, 4
s_cbranch_scc0 L_g4
v_add_u32 v1, 58624, v251
ds_read_b64_tr_b16 v[120:121], v1 offset:0
ds_read_b64_tr_b16 v[122:123], v1 offset:128
ds_read_b64_tr_b16 v[124:125], v1 offset:512
ds_read_b64_tr_b16 v[126:127], v1 offset:640
L_g4:
s_waitcnt vmcnt(4) lgkmcnt(0)
s_barrier
s_sub_u32 s45, 1769472, s44
s_add_u32 m0, s61, 42240
s_nop 0
buffer_load_dwordx4 v4, s[4:7], s45 offen lds
s_add_u32 m0, s61, 50432
s_nop 0
buffer_load_dwordx4 v5, s[8:11], s45 offen lds
v_add_u32 v1, 84480, v250
ds_read_b64_tr_b16 v[48:49], v1 offset:0
ds_read_b64_tr_b16 v[50:51], v1 offset:256
ds_read_b64_tr_b16 v[52:53], v1 offset:1024
ds_read_b64_tr_b16 v[54:55], v1 offset:1280
v_add_u32 v1, 100864, v250
ds_read_b64_tr_b16 v[56:57], v1 offset:0
ds_read_b64_tr_b16 v[58:59], v1 offset:256
ds_read_b64_tr_b16 v[60:61], v1 offset:1024
ds_read_b64_tr_b16 v[62:63], v1 offset:1280
v_and_b32 v248, 0xf0, v6
buffer_load_dword v247, v248, s[24:27], 0 offen sc1
s_waitcnt vmcnt(3) lgkmcnt(0)
s_barrier
s_lshl_b32 s3, s32, 6
s_addk_i32 s3, 0
v_add_u32 v1, s3, v0
v_mul_u32_u24 v2, 52429, v1
v_lshrrev_b32 v2, 22, v2
v_and_b32 v3, 3, v2
v_lshlrev_b32 v3, 1, v3
v_and_or_b32 v3, v2, 8, v3
v_xor_b32 v1, v1, v3
v_lshlrev_b32 v1, 4, v1
s_add_u32 m0, s61, 84480
s_nop 0
buffer_load_dwordx4 v1, s[12:15], s65 offen lds
s_lshl_b32 s3, s32, 6
s_addk_i32 s3, 512
v_add_u32 v1, s3, v0
v_mul_u32_u24 v2, 52429, v1
v_lshrrev_b32 v2, 22, v2
v_and_b32 v3, 3, v2
v_lshlrev_b32 v3, 1, v3
v_and_or_b32 v3, v2, 8, v3
v_xor_b32 v1, v1, v3
v_lshlrev_b32 v1, 4, v1
s_add_u32 m0, s61, 92672
s_nop 0
buffer_load_dwordx4 v1, s[12:15], s65 offen lds
s_lshl_b32 s3, s32, 6
s_addk_i32 s3, 1024
v_add_u32 v1, s3, v0
v_mul_u32_u24 v2, 52429, v1
v_lshrrev_b32 v2, 22, v2
v_and_b32 v3, 3, v2
v_lshlrev_b32 v3, 1, v3
v_and_or_b32 v3, v2, 8, v3
v_xor_b32 v1, v1, v3
v_lshlrev_b32 v1, 4, v1
s_add_u32 m0, s61, 100864
s_nop 0
buffer_load_dwordx4 v1, s[12:15], s65 offen lds
s_lshl_b32 s3, s32, 6
s_addk_i32 s3, 1536
v_add_u32 v1, s3, v0
v_mul_u32_u24 v2, 52429, v1
v_lshrrev_b32 v2, 22, v2
v_and_b32 v3, 3, v2
v_lshlrev_b32 v3, 1, v3
v_and_or_b32 v3, v2, 8, v3
v_xor_b32 v1, v1, v3
v_lshlrev_b32 v1, 4, v1
s_add_u32 m0, s61, 109056
s_nop 0
buffer_load_dwordx4 v1, s[12:15], s65 offen lds
s_lshl_b32 s3, s32, 6
s_addk_i32 s3, 2048
v_add_u32 v1, s3, v0
v_mul_u32_u24 v2, 52429, v1
v_lshrrev_b32 v2, 22, v2
v_and_b32 v3, 3, v2
v_lshlrev_b32 v3, 1, v3
v_and_or_b32 v3, v2, 8, v3
v_xor_b32 v1, v1, v3
v_lshlrev_b32 v1, 4, v1
s_add_u32 m0, s61, 117248
s_nop 0
buffer_load_dwordx4 v1, s[12:15], s65 offen lds
v_add_u32 v1, 0, v250
ds_read_b64_tr_b16 v[64:65], v1 offset:0
ds_read_b64_tr_b16 v[66:67], v1 offset:256
ds_read_b64_tr_b16 v[68:69], v1 offset:1024
ds_read_b64_tr_b16 v[70:71], v1 offset:1280
v_add_u32 v1, 16384, v250
ds_read_b64_tr_b16 v[72:73], v1 offset:0
ds_read_b64_tr_b16 v[74:75], v1 offset:256
ds_read_b64_tr_b16 v[76:77], v1 offset:1024
ds_read_b64_tr_b16 v[78:79], v1 offset:1280
s_waitcnt vmcnt(5) lgkmcnt(0)
s_barrier
s_lshl_b32 s3, s32, 6
s_addk_i32 s3, 0
v_add_u32 v1, s3, v0
v_mul_u32_u24 v2, 52429, v1
v_lshrrev_b32 v2, 22, v2
v_and_b32 v3, 3, v2
v_lshlrev_b32 v3, 1, v3
v_and_or_b32 v3, v2, 8, v3
v_xor_b32 v1, v1, v3
v_lshlrev_b32 v1, 4, v1
s_add_u32 m0, s61, 0
s_nop 0
buffer_load_dwordx4 v1, s[12:15], s66 offen lds
s_lshl_b32 s3, s32, 6
s_addk_i32 s3, 512
v_add_u32 v1, s3, v0
v_mul_u32_u24 v2, 52429, v1
v_lshrrev_b32 v2, 22, v2
v_and_b32 v3, 3, v2
v_lshlrev_b32 v3, 1, v3
v_and_or_b32 v3, v2, 8, v3
v_xor_b32 v1, v1, v3
v_lshlrev_b32 v1, 4, v1
s_add_u32 m0, s61, 8192
s_nop 0
buffer_load_dwordx4 v1, s[12:15], s66 offen lds
s_lshl_b32 s3, s32, 6
s_addk_i32 s3, 1024
v_add_u32 v1, s3, v0
v_mul_u32_u24 v2, 52429, v1
v_lshrrev_b32 v2, 22, v2
v_and_b32 v3, 3, v2
v_lshlrev_b32 v3, 1, v3
v_and_or_b32 v3, v2, 8, v3
v_xor_b32 v1, v1, v3
v_lshlrev_b32 v1, 4, v1
s_add_u32 m0, s61, 16384
s_nop 0
buffer_load_dwordx4 v1, s[12:15], s66 offen lds
s_lshl_b32 s3, s32, 6
s_addk_i32 s3, 1536
v_add_u32 v1, s3, v0
v_mul_u32_u24 v2, 52429, v1
v_lshrrev_b32 v2, 22, v2
v_and_b32 v3, 3, v2
v_lshlrev_b32 v3, 1, v3
v_and_or_b32 v3, v2, 8, v3
v_xor_b32 v1, v1, v3
v_lshlrev_b32 v1, 4, v1
s_add_u32 m0, s61, 24576
s_nop 0
buffer_load_dwordx4 v1, s[12:15], s66 offen lds
s_lshl_b32 s3, s32, 6
s_addk_i32 s3, 2048
v_add_u32 v1, s3, v0
v_mul_u32_u24 v2, 52429, v1
v_lshrrev_b32 v2, 22, v2
v_and_b32 v3, 3, v2
v_lshlrev_b32 v3, 1, v3
v_and_or_b32 v3, v2, 8, v3
v_xor_b32 v1, v1, v3
v_lshlrev_b32 v1, 4, v1
s_add_u32 m0, s61, 32768
s_nop 0
buffer_load_dwordx4 v1, s[12:15], s66 offen lds
v_add_u32 v1, 42240, v250
ds_read_b64_tr_b16 v[80:81], v1 offset:0
ds_read_b64_tr_b16 v[82:83], v1 offset:256
ds_read_b64_tr_b16 v[84:85], v1 offset:1024
ds_read_b64_tr_b16 v[86:87], v1 offset:1280
s_waitcnt vmcnt(5) lgkmcnt(0)
s_barrier
s_lshl_b32 s3, s32, 6
s_addk_i32 s3, 0
v_add_u32 v1, s3, v0
v_mul_u32_u24 v2, 52429, v1
v_lshrrev_b32 v2, 22, v2
v_and_b32 v3, 3, v2
v_lshlrev_b32 v3, 1, v3
v_and_or_b32 v3, v2, 8, v3
v_xor_b32 v1, v1, v3
v_lshlrev_b32 v1, 4, v1
s_add_u32 m0, s61, 42240
s_nop 0
buffer_load_dwordx4 v1, s[12:15], s67 offen lds
s_lshl_b32 s3, s32, 6
s_addk_i32 s3, 512
v_add_u32 v1, s3, v0
v_mul_u32_u24 v2, 52429, v1
v_lshrrev_b32 v2, 22, v2
v_and_b32 v3, 3, v2
v_lshlrev_b32 v3, 1, v3
v_and_or_b32 v3, v2, 8, v3
v_xor_b32 v1, v1, v3
v_lshlrev_b32 v1, 4, v1
s_add_u32 m0, s61, 50432
s_nop 0
buffer_load_dwordx4 v1, s[12:15], s67 offen lds
s_lshl_b32 s3, s32, 6
s_addk_i32 s3, 1024
v_add_u32 v1, s3, v0
v_mul_u32_u24 v2, 52429, v1
v_lshrrev_b32 v2, 22, v2
v_and_b32 v3, 3, v2
v_lshlrev_b32 v3, 1, v3
v_and_or_b32 v3, v2, 8, v3
v_xor_b32 v1, v1, v3
v_lshlrev_b32 v1, 4, v1
s_add_u32 m0, s61, 58624
s_nop 0
buffer_load_dwordx4 v1, s[12:15], s67 offen lds
s_lshl_b32 s3, s32, 6
s_addk_i32 s3, 1536
v_add_u32 v1, s3, v0
v_mul_u32_u24 v2, 52429, v1
v_lshrrev_b32 v2, 22, v2
v_and_b32 v3, 3, v2
v_lshlrev_b32 v3, 1, v3
v_and_or_b32 v3, v2, 8, v3
v_xor_b32 v1, v1, v3
v_lshlrev_b32 v1, 4, v1
s_add_u32 m0, s61, 66816
s_nop 0
buffer_load_dwordx4 v1, s[12:15], s67 offen lds
s_lshl_b32 s3, s32, 6
s_addk_i32 s3, 2048
v_add_u32 v1, s3, v0
v_mul_u32_u24 v2, 52429, v1
v_lshrrev_b32 v2, 22, v2
v_and_b32 v3, 3, v2
v_lshlrev_b32 v3, 1, v3
v_and_or_b32 v3, v2, 8, v3
v_xor_b32 v1, v1, v3
v_lshlrev_b32 v1, 4, v1
s_add_u32 m0, s61, 75008
s_nop 0
buffer_load_dwordx4 v1, s[12:15], s67 offen lds
v_add_u32 v1, 84480, v236
ds_read_b64_tr_b16 v[168:169], v1 offset:0
ds_read_b64_tr_b16 v[170:171], v1 offset:5120
v_add_u32 v1, 84480, v237
ds_read_b64_tr_b16 v[180:181], v1 offset:0
ds_read_b64_tr_b16 v[182:183], v1 offset:5120
v_add_u32 v1, 84480, v238
ds_read_b64_tr_b16 v[192:193], v1 offset:0
ds_read_b64_tr_b16 v[194:195], v1 offset:5120
v_add_u32 v1, 84480, v239
ds_read_b64_tr_b16 v[204:205], v1 offset:0
ds_read_b64_tr_b16 v[206:207], v1 offset:5120
v_add_u32 v1, 84480, v240
ds_read_b64_tr_b16 v[216:217], v1 offset:0
ds_read_b64_tr_b16 v[218:219], v1 offset:5120
s_waitcnt vmcnt(5) lgkmcnt(0)
s_barrier
s_sub_u32 s45, 983040, s44
s_add_u32 m0, s62, 84480
s_nop 0
buffer_load_dwordx4 v249, s[28:31], s45 offen lds
s_sub_u32 s45, 1179648, s44
s_add_u32 m0, s62, 92928
s_nop 0
buffer_load_dwordx4 v249, s[28:31], s45 offen lds
s_sub_u32 s45, 1376256, s44
s_add_u32 m0, s62, 101376
s_nop 0
buffer_load_dwordx4 v249, s[28:31], s45 offen lds
s_sub_u32 s45, 1572864, s44
s_add_u32 m0, s62, 109824
s_nop 0
buffer_load_dwordx4 v249, s[28:31], s45 offen lds
s_sub_u32 s45, 1769472, s44
s_add_u32 m0, s62, 118272
s_nop 0
buffer_load_dwordx4 v249, s[28:31], s45 offen lds
v_add_u32 v1, 0, v236
ds_read_b64_tr_b16 v[172:173], v1 offset:0
ds_read_b64_tr_b16 v[174:175], v1 offset:5120
v_add_u32 v1, 0, v237
ds_read_b64_tr_b16 v[184:185], v1 offset:0
ds_read_b64_tr_b16 v[186:187], v1 offset:5120
v_add_u32 v1, 0, v238
ds_read_b64_tr_b16 v[196:197], v1 offset:0
ds_read_b64_tr_b16 v[198:199], v1 offset:5120
v_add_u32 v1, 0, v239
ds_read_b64_tr_b16 v[208:209], v1 offset:0
ds_read_b64_tr_b16 v[210:211], v1 offset:5120
v_add_u32 v1, 0, v240
ds_read_b64_tr_b16 v[220:221], v1 offset:0
ds_read_b64_tr_b16 v[222:223], v1 offset:5120
s_waitcnt vmcnt(5) lgkmcnt(0)
s_barrier
v_add_u32 v1, 42240, v236
ds_read_b64_tr_b16 v[176:177], v1 offset:0
ds_read_b64_tr_b16 v[178:179], v1 offset:5120
v_add_u32 v1, 42240, v237
ds_read_b64_tr_b16 v[188:189], v1 offset:0
ds_read_b64_tr_b16 v[190:191], v1 offset:5120
v_add_u32 v1, 42240, v238
ds_read_b64_tr_b16 v[200:201], v1 offset:0
ds_read_b64_tr_b16 v[202:203], v1 offset:5120
v_add_u32 v1, 42240, v239
ds_read_b64_tr_b16 v[212:213], v1 offset:0
ds_read_b64_tr_b16 v[214:215], v1 offset:5120
v_add_u32 v1, 42240, v240
ds_read_b64_tr_b16 v[224:225], v1 offset:0
ds_read_b64_tr_b16 v[226:227], v1 offset:5120
s_waitcnt vmcnt(0) lgkmcnt(0)
s_barrier
s_cmp_lt_u32 s32, 4
s_cbranch_scc0 L_g11
v_add_u32 v1, 84480, v251
ds_read_b64_tr_b16 v[128:129], v1 offset:0
ds_read_b64_tr_b16 v[130:131], v1 offset:128
ds_read_b64_tr_b16 v[132:133], v1 offset:512
ds_read_b64_tr_b16 v[134:135], v1 offset:640
v_add_u32 v1, 92928, v251
ds_read_b64_tr_b16 v[136:137], v1 offset:0
ds_read_b64_tr_b16 v[138:139], v1 offset:128
ds_read_b64_tr_b16 v[140:141], v1 offset:512
ds_read_b64_tr_b16 v[142:143], v1 offset:640
v_add_u32 v1, 101376, v251
ds_read_b64_tr_b16 v[144:145], v1 offset:0
ds_read_b64_tr_b16 v[146:147], v1 offset:128
ds_read_b64_tr_b16 v[148:149], v1 offset:512
ds_read_b64_tr_b16 v[150:151], v1 offset:640
v_add_u32 v1, 109824, v251
ds_read_b64_tr_b16 v[152:153], v1 offset:0
ds_read_b64_tr_b16 v[154:155], v1 offset:128
ds_read_b64_tr_b16 v[156:157], v1 offset:512
ds_read_b64_tr_b16 v[158:159], v1 offset:640
v_add_u32 v1, 118272, v251
ds_read_b64_tr_b16 v[160:161], v1 offset:0
ds_read_b64_tr_b16 v[162:163], v1 offset:128
ds_read_b64_tr_b16 v[164:165], v1 offset:512
ds_read_b64_tr_b16 v[166:167], v1 offset:640
L_g11:
s_branch L_pb_30
.p2align 12
L_pb_30:
s_call_b64 s[100:101], L_pad_31
s_call_b64 s[100:101], L_pad_32
s_call_b64 s[100:101], L_pad_33
s_call_b64 s[100:101], L_pad_34
v_mov_b32 v5, v246
v_mov_b32 v4, 126976
s_mov_b32 s61, 0
s_cmp_lt_u32 s32, 7
s_cbranch_scc1 L_np
L_rt:
v_cmp_ne_u32 vcc, 1, v247
s_cbranch_vccz L_rtg
buffer_load_dword v247, v248, s[24:27], 0 offen sc1
s_waitcnt vmcnt(0)
s_sub_u32 s40, s40, 1
s_cbranch_scc0 L_rt
s_mov_b32 s40, 0
L_rtg:
v_bfe_u32 v1, v0, 2, 3
v_lshlrev_b32 v1, 15, v1
v_and_b32 v2, 3, v0
v_min_u32 v2, 2, v2
v_mul_u32_u24 v3, 1280, v2
s_mov_b32 s0, 3145728
v_add3_u32 v147, v3, v1, s0
v_lshl_add_u32 v144, v2, 7, v1
s_mul_i32 s0, s36, 384
s_add_u32 s64, s0, 3167232
s_and_b32 s3, s36, 1
s_mul_i32 s3, s3, 640
v_add_u32 v132, s3, v6
v_subrev_u32 v2, 1280, v132
v_min_u32 v132, v132, v2
s_sub_u32 s3, 1024, s3
v_add_u32 v133, s3, v6
s_mov_b32 s54, 0
s_mov_b32 s55, 0x80000000
s_mov_b32 s60, 1073741824
s_setprio 3
v_mov_b32 v140, -1
v_mov_b32 v141, -1
v_mov_b32 v142, -1
s_mov_b32 m0, 127232
s_mov_b64 exec, -1
buffer_load_dwordx4 v132, s[16:19], s55 offen sc1 lds
s_mov_b32 m0, 128256
s_mov_b64 exec, 0xffff
buffer_load_dwordx4 v133, s[16:19], s55 offen sc1 lds
s_mov_b64 exec, 0x77777777
buffer_atomic_umin v140, v144, s[16:19], s64 offen sc0 sc1
s_sleep 2
s_mov_b32 m0, 127232
s_mov_b64 exec, -1
buffer_load_dwordx4 v132, s[16:19], s55 offen sc1 lds
s_mov_b32 m0, 128256
s_mov_b64 exec, 0xffff
buffer_load_dwordx4 v133, s[16:19], s55 offen sc1 lds
s_mov_b64 exec, 0x77777777
buffer_atomic_umin v141, v144, s[16:19], s64 offen sc0 sc1
s_sleep 2
L_pl0:
s_mov_b32 m0, 127232
s_mov_b64 exec, -1
s_nop 0
buffer_load_dwordx4 v132, s[16:19], s55 offen sc1 lds
s_mov_b32 m0, 128256
s_mov_b64 exec, 0xffff
buffer_load_dwordx4 v133, s[16:19], s55 offen sc1 lds
s_mov_b64 exec, 0x77777777
buffer_atomic_umin v142, v144, s[16:19], s64 offen sc0 sc1
s_waitcnt vmcnt(6)
v_cmp_lt_u32 vcc, s54, v140
s_sub_u32 s60, s60, 1
s_cbranch_vccz L_pw
s_cselect_b32 s0, s61, 1
s_max_i32 s60, s60, 0
v_cmp_eq_u32 s[58:59], -1, v140
v_mov_b32 v146, v140
s_andn2_b64 vcc, vcc, s[58:59]
s_cbranch_scc0 L_pq0
s_mov_b64 exec, -1
v_cndmask_b32 v146, 0, v146, vcc
s_lshl_b32 s61, s61, 1
s_nop 0
v_max_u32_dpp v236, v146, v146 row_ror:8 row_mask:0xf bank_mask:0xf
s_nop 1
v_max_u32_dpp v236, v236, v236 row_ror:4 row_mask:0xf bank_mask:0xf
s_nop 1
v_max_u32_dpp v236, v236, v236 row_ror:2 row_mask:0xf bank_mask:0xf
s_nop 1
v_max_u32_dpp v236, v236, v236 row_ror:1 row_mask:0xf bank_mask:0xf
v_mov_b32 v237, v236
s_mov_b32 s60, 2
s_nop 0
v_permlane16_swap_b32 v236, v237
v_max_u32 v236, v236, v237
s_mov_b32 exec_hi, 0
v_cmpx_eq_u32 vcc, v236, v146
ds_write_b64 v4, v[146:147]
s_nop 2
v_readfirstlane_b32 s55, v147
v_readfirstlane_b32 s54, v146
s_branch L_pl1
L_pq0:
s_sleep 2
L_pl1:
s_mov_b32 m0, 127232
s_mov_b64 exec, -1
s_nop 0
buffer_load_dwordx4 v132, s[16:19], s55 offen sc1 lds
s_mov_b32 m0, 128256
s_mov_b64 exec, 0xffff
buffer_load_dwordx4 v133, s[16:19], s55 offen sc1 lds
s_mov_b64 exec, 0x77777777
buffer_atomic_umin v140, v144, s[16:19], s64 offen sc0 sc1
s_waitcnt vmcnt(6)
v_cmp_lt_u32 vcc, s54, v141
s_sub_u32 s60, s60, 1
s_cbranch_vccz L_pw
s_cselect_b32 s0, s61, 1
s_max_i32 s60, s60, 0
v_cmp_eq_u32 s[58:59], -1, v141
v_mov_b32 v146, v141
s_andn2_b64 vcc, vcc, s[58:59]
s_cbranch_scc0 L_pq1
s_mov_b64 exec, -1
v_cndmask_b32 v146, 0, v146, vcc
s_lshl_b32 s61, s61, 1
s_nop 0
v_max_u32_dpp v236, v146, v146 row_ror:8 row_mask:0xf bank_mask:0xf
s_nop 1
v_max_u32_dpp v236, v236, v236 row_ror:4 row_mask:0xf bank_mask:0xf
s_nop 1
v_max_u32_dpp v236, v236, v236 row_ror:2 row_mask:0xf bank_mask:0xf
s_nop 1
v_max_u32_dpp v236, v236, v236 row_ror:1 row_mask:0xf bank_mask:0xf
v_mov_b32 v237, v236
s_mov_b32 s60, 2
s_nop 0
v_permlane16_swap_b32 v236, v237
v_max_u32 v236, v236, v237
s_mov_b32 exec_hi, 0
v_cmpx_eq_u32 vcc, v236, v146
ds_write_b64 v4, v[146:147]
s_nop 2
v_readfirstlane_b32 s55, v147
v_readfirstlane_b32 s54, v146
s_branch L_pl2
L_pq1:
s_sleep 2
L_pl2:
s_mov_b32 m0, 127232
s_mov_b64 exec, -1
s_nop 0
buffer_load_dwordx4 v132, s[16:19], s55 offen sc1 lds
s_mov_b32 m0, 128256
s_mov_b64 exec, 0xffff
buffer_load_dwordx4 v133, s[16:19], s55 offen sc1 lds
s_mov_b64 exec, 0x77777777
buffer_atomic_umin v141, v144, s[16:19], s64 offen sc0 sc1
s_waitcnt vmcnt(6)
v_cmp_lt_u32 vcc, s54, v142
s_sub_u32 s60, s60, 1
s_cbranch_vccz L_pw
s_cselect_b32 s0, s61, 1
s_max_i32 s60, s60, 0
v_cmp_eq_u32 s[58:59], -1, v142
v_mov_b32 v146, v142
s_andn2_b64 vcc, vcc, s[58:59]
s_cbranch_scc0 L_pq2
s_mov_b64 exec, -1
v_cndmask_b32 v146, 0, v146, vcc
s_lshl_b32 s61, s61, 1
s_nop 0
v_max_u32_dpp v236, v146, v146 row_ror:8 row_mask:0xf bank_mask:0xf
s_nop 1
v_max_u32_dpp v236, v236, v236 row_ror:4 row_mask:0xf bank_mask:0xf
s_nop 1
v_max_u32_dpp v236, v236, v236 row_ror:2 row_mask:0xf bank_mask:0xf
s_nop 1
v_max_u32_dpp v236, v236, v236 row_ror:1 row_mask:0xf bank_mask:0xf
v_mov_b32 v237, v236
s_mov_b32 s60, 2
s_nop 0
v_permlane16_swap_b32 v236, v237
v_max_u32 v236, v236, v237
s_mov_b32 exec_hi, 0
v_cmpx_eq_u32 vcc, v236, v146
ds_write_b64 v4, v[146:147]
s_nop 2
v_readfirstlane_b32 s55, v147
v_readfirstlane_b32 s54, v146
s_branch L_pl0
L_pq2:
s_sleep 2
s_sub_u32 s40, s40, 1
s_cbranch_scc0 L_pl0
s_mov_b32 s40, 0
s_waitcnt vmcnt(0)
s_cmp_eq_u32 s0, s0
L_pw:
s_cbranch_scc0 L_pv
s_branch L_pg
L_pv:
s_cmp_eq_u32 s60, 0
s_waitcnt vmcnt(4)
s_cbranch_scc1 L_pg
s_cmp_eq_u32 s60, 1
s_waitcnt vmcnt(1)
s_branch L_pg
L_xf:
s_mov_b32 m0, 127232
s_mov_b64 exec, -1
buffer_load_dwordx4 v132, s[16:19], s55 offen sc1 lds
s_mov_b32 m0, 128256
s_mov_b64 exec, 0xffff
buffer_load_dwordx4 v133, s[16:19], s55 offen sc1 lds
s_waitcnt vmcnt(0)
L_pg:
s_mov_b64 exec, -1
L_np:
s_waitcnt lgkmcnt(0)
s_barrier
s_cmp_lt_u32 s32, 4
s_cbranch_scc1 L_xh
ds_read_b64 v[2:3], v4
ds_read_b128 v[88:91], v252 offset:0
ds_read_b128 v[92:95], v252 offset:128
ds_read_b128 v[96:99], v252 offset:256
ds_read_b128 v[100:103], v252 offset:384
ds_read_b128 v[104:107], v252 offset:512
ds_read_b128 v[108:111], v252 offset:640
ds_read_b128 v[112:115], v252 offset:768
ds_read_b128 v[116:119], v252 offset:896
ds_read_b128 v[120:123], v252 offset:1024
ds_read_b128 v[124:127], v252 offset:1152
s_waitcnt lgkmcnt(10)
v_readfirstlane_b32 s56, v2
v_readfirstlane_b32 s57, v3
s_waitcnt lgkmcnt(9)
v_smfmac_f32_16x16x64_bf16 v[228:231], v[88:91], v[8:15], v7
s_and_b32 s0, s57, 0x7fff
s_add_u32 s57, s57, s0
s_add_u32 s57, s57, 4096
s_and_b32 s1, s56, 0xfffff800
s_waitcnt lgkmcnt(8)
v_smfmac_f32_16x16x64_bf16 v[228:231], v[92:95], v[16:23], v7
s_ashr_i32 s3, s1, 31
s_not_b32 s3, s3
s_or_b32 s3, s3, 0x80000000
s_xor_b32 s1, s1, s3
s_waitcnt lgkmcnt(7)
v_smfmac_f32_16x16x64_bf16 v[228:231], v[96:99], v[24:31], v7
s_andn2_b32 s56, 2047, s56
s_mul_i32 s56, s56, 1280
v_mov_b32 v130, s1
s_waitcnt lgkmcnt(6)
v_smfmac_f32_16x16x64_bf16 v[228:231], v[100:103], v[32:39], v7
v_mul_f32 v130, 0xbfb8aa3b, v130
s_waitcnt lgkmcnt(5)
v_smfmac_f32_16x16x64_bf16 v[228:231], v[104:107], v[40:47], v7
v_exp_f32 v130, v130
s_waitcnt lgkmcnt(4)
v_smfmac_f32_16x16x64_bf16 v[228:231], v[108:111], v[48:55], v7
v_add_f32 v130, 1.0, v130
s_waitcnt lgkmcnt(3)
v_smfmac_f32_16x16x64_bf16 v[228:231], v[112:115], v[56:63], v7
v_rcp_f32 v130, v130
s_waitcnt lgkmcnt(2)
v_smfmac_f32_16x16x64_bf16 v[228:231], v[116:119], v[64:71], v7
s_waitcnt lgkmcnt(1)
v_smfmac_f32_16x16x64_bf16 v[228:231], v[120:123], v[72:79], v7
s_waitcnt lgkmcnt(0)
v_smfmac_f32_16x16x64_bf16 v[228:231], v[124:127], v[80:87], v7
s_branch L_xj
L_pad_31:
s_setpc_b64 s[100:101]
L_xh:
ds_read_b128 v[236:239], v252 offset:0
ds_read_b128 v[240:243], v252 offset:128
ds_read_b128 v[244:247], v252 offset:256
ds_read_b128 v[248:251], v252 offset:384
s_waitcnt lgkmcnt(3)
v_smfmac_f32_16x16x64_bf16 v[228:231], v[236:239], v[8:15], v7
v_smfmac_f32_16x16x64_bf16 v[232:235], v[236:239], v[88:95], v7
ds_read_b128 v[236:239], v252 offset:512
s_waitcnt lgkmcnt(3)
v_smfmac_f32_16x16x64_bf16 v[228:231], v[240:243], v[16:23], v7
v_smfmac_f32_16x16x64_bf16 v[232:235], v[240:243], v[96:103], v7
ds_read_b128 v[240:243], v252 offset:640
s_waitcnt lgkmcnt(3)
v_smfmac_f32_16x16x64_bf16 v[228:231], v[244:247], v[24:31], v7
v_smfmac_f32_16x16x64_bf16 v[232:235], v[244:247], v[104:111], v7
ds_read_b128 v[244:247], v252 offset:768
s_waitcnt lgkmcnt(3)
v_smfmac_f32_16x16x64_bf16 v[228:231], v[248:251], v[32:39], v7
v_smfmac_f32_16x16x64_bf16 v[232:235], v[248:251], v[112:119], v7
ds_read_b128 v[248:251], v252 offset:896
s_waitcnt lgkmcnt(3)
v_smfmac_f32_16x16x64_bf16 v[228:231], v[236:239], v[40:47], v7
v_smfmac_f32_16x16x64_bf16 v[232:235], v[236:239], v[120:127], v7
ds_read_b128 v[236:239], v252 offset:1024
s_waitcnt lgkmcnt(3)
v_smfmac_f32_16x16x64_bf16 v[228:231], v[240:243], v[48:55], v7
v_smfmac_f32_16x16x64_bf16 v[232:235], v[240:243], v[128:135], v7
ds_read_b128 v[240:243], v252 offset:1152
s_waitcnt lgkmcnt(3)
v_smfmac_f32_16x16x64_bf16 v[228:231], v[244:247], v[56:63], v7
v_smfmac_f32_16x16x64_bf16 v[232:235], v[244:247], v[136:143], v7
s_waitcnt lgkmcnt(2)
v_smfmac_f32_16x16x64_bf16 v[228:231], v[248:251], v[64:71], v7
v_smfmac_f32_16x16x64_bf16 v[232:235], v[248:251], v[144:151], v7
s_waitcnt lgkmcnt(1)
v_smfmac_f32_16x16x64_bf16 v[228:231], v[236:239], v[72:79], v7
v_smfmac_f32_16x16x64_bf16 v[232:235], v[236:239], v[152:159], v7
s_waitcnt lgkmcnt(0)
v_smfmac_f32_16x16x64_bf16 v[228:231], v[240:243], v[80:87], v7
v_smfmac_f32_16x16x64_bf16 v[232:235], v[240:243], v[160:167], v7
L_xj:
s_mov_b64 vcc, 0xffff
s_nop 5
v_add_f32 v1, v228, v229
v_add_f32 v2, v232, v233
v_cndmask_b32 v1, v2, v1, vcc
v_mul_f32 v2, 0xbfb8aa3b, v1
v_cmp_u_f32 vcc, v1, v1
v_exp_f32 v2, v2
v_mul_f32_dpp v3, v1, v1 row_ror:8 row_mask:0xf bank_mask:0xf
v_add_f32 v2, 1.0, v2
v_rcp_f32 v2, v2
s_mov_b64 exec, s[50:51]
v_mul_f32 v1, v2, v3
v_cvt_pk_bf16_f32 v1, v1, v1
ds_write_b16 v253, v1
s_mov_b64 exec, -1
s_cbranch_vccnz L_xn
L_xnb:
L_bb:
s_waitcnt lgkmcnt(0)
s_barrier
ds_read_b32 v1, v4 offset:16
ds_read_b128 v[236:239], v255
ds_read_b128 v[240:243], v254
s_waitcnt lgkmcnt(2)
v_cmp_ne_u32 vcc, 0, v1
s_cbranch_vccnz L_xsr
L_xsgo:
s_waitcnt lgkmcnt(1)
v_mfma_f32_16x16x32_bf16 v[24:27], v[236:239], v[224:227], 0
v_mfma_f32_16x16x32_bf16 v[8:11], v[236:239], v[176:179], 0
v_mfma_f32_16x16x32_bf16 v[12:15], v[236:239], v[188:191], 0
v_mfma_f32_16x16x32_bf16 v[16:19], v[236:239], v[200:203], 0
v_mfma_f32_16x16x32_bf16 v[20:23], v[236:239], v[212:215], 0
s_waitcnt lgkmcnt(0)
s_nop 0
v_smfmac_f32_16x16x64_bf16 v[24:27], v[240:243], v[216:223], v7
v_smfmac_f32_16x16x64_bf16 v[8:11], v[240:243], v[168:175], v7
v_smfmac_f32_16x16x64_bf16 v[12:15], v[240:243], v[180:187], v7
v_smfmac_f32_16x16x64_bf16 v[16:19], v[240:243], v[192:199], v7
v_smfmac_f32_16x16x64_bf16 v[20:23], v[240:243], v[204:211], v7
s_nop 3
v_add_f32 v1, v24, v25
v_add_f32 v32, v8, v9
v_add_f32 v33, v12, v13
v_add_f32 v34, v16, v17
v_add_f32 v35, v20, v21
v_mov_b32_dpp v32, v1 quad_perm:[0,0,0,0] row_mask:0x2 bank_mask:0xf
v_mov_b32_dpp v33, v1 quad_perm:[1,1,1,1] row_mask:0x2 bank_mask:0xf
v_mov_b32_dpp v34, v1 quad_perm:[2,2,2,2] row_mask:0x2 bank_mask:0xf
v_mov_b32_dpp v35, v1 quad_perm:[3,3,3,3] row_mask:0x2 bank_mask:0xf
s_mov_b64 exec, 0x1111ffff
buffer_store_dwordx4 v[32:35], v5, s[16:19], s47 offen sc1
s_mov_b64 exec, -1
s_cmp_lt_u32 s52, 40
s_cbranch_scc0 L_mfin
buffer_load_dword v44, v129, s[16:19], s57 offen sc1
buffer_load_dwordx4 v[40:43], v6, s[16:19], s53 offen sc1
s_sleep 1
buffer_load_dword v52, v129, s[16:19], s57 offen sc1
buffer_load_dwordx4 v[48:51], v6, s[16:19], s53 offen sc1
s_sleep 1
L_fd:
buffer_load_dword v60, v129, s[16:19], s57 offen sc1
buffer_load_dwordx4 v[56:59], v6, s[16:19], s53 offen sc1
s_waitcnt vmcnt(4)
v_max3_u32 v1, v40, v42, v44
v_cmp_eq_u32 vcc, -1, v1
s_cbranch_vccz L_fg0
s_sleep 1
buffer_load_dword v44, v129, s[16:19], s57 offen sc1
buffer_load_dwordx4 v[40:43], v6, s[16:19], s53 offen sc1
s_waitcnt vmcnt(4)
v_max3_u32 v1, v48, v50, v52
v_cmp_eq_u32 vcc, -1, v1
s_cbranch_vccz L_fg1
s_sleep 1
buffer_load_dword v52, v129, s[16:19], s57 offen sc1
buffer_load_dwordx4 v[48:51], v6, s[16:19], s53 offen sc1
s_waitcnt vmcnt(4)
v_max3_u32 v1, v56, v58, v60
v_cmp_eq_u32 vcc, -1, v1
s_cbranch_vccz L_fg2
s_sleep 1
s_sub_u32 s40, s40, 1
s_cbranch_scc0 L_fd
L_fg2:
v_permlane32_swap_b32 v56, v57
v_permlane32_swap_b32 v58, v59
v_add_f32 v56, v56, v57
v_add_f32 v58, v58, v59
s_nop 1
v_permlane16_swap_b32 v56, v58
v_add_f32 v56, v56, v58
s_nop 1
v_add_f32_dpp v56, v56, v56 row_ror:4 row_mask:0xf bank_mask:0xf
s_nop 1
v_add_f32_dpp v56, v56, v56 row_ror:8 row_mask:0xf bank_mask:0xf
v_fma_f32 v8, v56, v130, v60
v_cvt_pk_bf16_f32 v8, v8, v8
s_mov_b32 exec_lo, 0xf000f
s_mov_b32 exec_hi, 0xf000f
buffer_store_short v8, v128, s[20:23], s56 offen
s_endpgm
L_pad_32:
s_setpc_b64 s[100:101]
L_fg1:
v_permlane32_swap_b32 v48, v49
v_permlane32_swap_b32 v50, v51
v_add_f32 v48, v48, v49
v_add_f32 v50, v50, v51
s_nop 1
v_permlane16_swap_b32 v48, v50
v_add_f32 v48, v48, v50
s_nop 1
v_add_f32_dpp v48, v48, v48 row_ror:4 row_mask:0xf bank_mask:0xf
s_nop 1
v_add_f32_dpp v48, v48, v48 row_ror:8 row_mask:0xf bank_mask:0xf
v_fma_f32 v8, v48, v130, v52
v_cvt_pk_bf16_f32 v8, v8, v8
s_mov_b32 exec_lo, 0xf000f
s_mov_b32 exec_hi, 0xf000f
buffer_store_short v8, v128, s[20:23], s56 offen
s_endpgm
L_pad_33:
s_setpc_b64 s[100:101]
L_fg0:
v_permlane32_swap_b32 v40, v41
v_permlane32_swap_b32 v42, v43
v_add_f32 v40, v40, v41
v_add_f32 v42, v42, v43
s_nop 1
v_permlane16_swap_b32 v40, v42
v_add_f32 v40, v40, v42
s_nop 1
v_add_f32_dpp v40, v40, v40 row_ror:4 row_mask:0xf bank_mask:0xf
s_nop 1
v_add_f32_dpp v40, v40, v40 row_ror:8 row_mask:0xf bank_mask:0xf
v_fma_f32 v8, v40, v130, v44
v_cvt_pk_bf16_f32 v8, v8, v8
s_mov_b32 exec_lo, 0xf000f
s_mov_b32 exec_hi, 0xf000f
buffer_store_short v8, v128, s[20:23], s56 offen
L_mfin:
s_endpgm
L_pad_34:
s_setpc_b64 s[100:101]
L_xn:
ds_write_b32 v4, v4 offset:16
s_branch L_xnb
L_xsr:
s_sub_u32 s49, s49, 1
s_cbranch_scc1 L_xsgo
v_mov_b32 v228, 0
v_mov_b32 v229, 0
v_mov_b32 v232, 0
v_mov_b32 v233, 0
s_waitcnt lgkmcnt(0)
s_barrier
s_cmp_eq_u32 s32, 7
s_cbranch_scc0 L_np
ds_write_b32 v4, v228 offset:16
s_cmp_eq_u32 s61, 2
s_cbranch_scc0 L_xf
s_mov_b32 s61, 0
s_mov_b64 exec, 0x77777777
s_branch L_xf
L_end:
s_endpgm
.section .rodata,"a"
.p2align 6
.amdhsa_kernel sequential_preLN__sliding_local_dilated__moe_arch_mod__prompt_kernel
  .amdhsa_next_free_vgpr 256
  .amdhsa_next_free_sgpr 102
  .amdhsa_accum_offset 256
  .amdhsa_group_segment_fixed_size 0
  .amdhsa_kernarg_size 88
  .amdhsa_user_sgpr_count 2
  .amdhsa_user_sgpr_kernarg_segment_ptr 1
  .amdhsa_system_sgpr_workgroup_id_x 1
  .amdhsa_float_denorm_mode_32 3
.end_amdhsa_kernel
```
